```python
import torch

def _softmax(x, axis=-1):
    return torch.softmax(x, dim=axis)
def _gelu(x):
    return torch.nn.functional.gelu(x, approximate="tanh")
def _silu(x):
    return torch.nn.functional.silu(x)
def _sigmoid(x):
    return torch.sigmoid(x)
def _layernorm(x, axis=-1, eps=1e-5):
    m = x.mean(dim=axis, keepdim=True)
    v = x.var(dim=axis, keepdim=True, unbiased=False)
    return (x - m) / torch.sqrt(v + eps)
def _scatter_add(tgt, idx, src, axis=0):
    return tgt.clone().index_add_(axis, idx, src)
def _segment_sum(src, seg, n):
    out = torch.zeros((n,) + src.shape[1:], dtype=src.dtype)
    return out.index_add_(0, seg, src)
def _pad(x, pw):
    flat = tuple(v for pair in reversed(pw) for v in pair)
    return torch.nn.functional.pad(x, flat)

kernel_name = 'standalone__mha_block_cached__near_ridge'

def setup_inputs():

    _w = (lambda a: (lambda t: t.to(torch.bfloat16) if t.is_floating_point() else t)(torch.as_tensor(a)))
    B, Sq, D = 32, 96, 448
    H, Sk, Dh = 16, 512, 256
    return {
        "x": _w((lambda *s: torch.randn(*s, dtype=torch.bfloat16) * 0.8)(B, Sq, D)),
        "k_cache": _w((lambda *s: torch.randn(*s, dtype=torch.bfloat16) * 0.8)(B, H, Sk, Dh)),
        "v_cache": _w((lambda *s: torch.randn(*s, dtype=torch.bfloat16) * 0.05)(B, H, Sk, Dh)),
        "wq": _w((lambda *s: torch.randn(*s, dtype=torch.bfloat16) * 0.8)(D, H * Dh) * (D ** -0.5)),
        "wo": _w((lambda *s: torch.randn(*s, dtype=torch.bfloat16) * 0.05)(H * Dh, D) * ((H * Dh) ** -0.5)),
    }

def reference(x, k_cache, v_cache, wq, wo):
    B, Sq, D = x.shape
    H, Dh = 16, 256
    q = (lambda x, *d: x.permute(*d))((x @ wq).reshape(B, Sq, H, Dh), 0, 2, 1, 3)
    scores = torch.einsum("bhqd,bhkd->bhqk", q, k_cache) * (Dh ** -0.5)
    p = _softmax(scores, axis=-1)
    o = torch.einsum("bhqk,bhkd->bhqd", p, v_cache)
    return (lambda x, *d: x.permute(*d))(o, 0, 2, 1, 3).reshape(B, Sq, H * Dh) @ wo
```

```asm
; @launch grid=(256,1,1) block=(256,1,1) lds=163840
.amdgcn_target "amdgcn-amd-amdhsa--gfx950"
.text
.globl standalone__mha_block_cached__near_ridge_kernel
.p2align 8
.type standalone__mha_block_cached__near_ridge_kernel,@function
standalone__mha_block_cached__near_ridge_kernel:
 s_cmp_ge_u32 s2, 256
 s_cbranch_scc1 L_exit0
 s_getpc_b64 s[58:59]
L_pc0:
 s_lshr_b32 s34, s2, 3
 s_lshl_b32 s34, s34, 12
 s_min_u32 s34, s34, L_end-L_pc0-4096
 v_lshl_add_u32 v37, v0, 4, s34
 v_mov_b32 v41, s59
 v_add_co_u32 v40, vcc, s58, v37
 s_nop 1
 v_addc_co_u32 v41, vcc, 0, v41, vcc
 global_load_dwordx4 v[48:51], v[40:41], off
 s_load_dwordx8 s[36:43], s[0:1], 0
 s_load_dwordx2 s[44:45], s[0:1], 32
 s_load_dwordx2 s[46:47], s[0:1], 56
 s_load_dwordx4 s[64:67], s[0:1], 40
 v_lshrrev_b32 v1, 6, v0
 v_and_b32 v0, 63, v0
 v_readfirstlane_b32 s3, v1
 s_and_b32 s34, s2, 7
 s_lshr_b32 s35, s2, 3
 s_lshr_b32 s6, s35, 0
 s_and_b32 s5, s34, 7
 s_lshl_b32 s5, s5, 0
 s_and_b32 s35, s35, 0
 s_add_u32 s5, s5, s35
 s_lshr_b32 s4, s34, 3
 s_mul_i32 s4, s4, 32
 s_add_u32 s4, s4, s6
 v_add_u32 v1, 1, v1
 v_and_b32 v1, 3, v1
 v_lshlrev_b32 v1, 8, v1
 v_lshl_add_u32 v1, v0, 2, v1
 v_add_u32 v1, 162816, v1
 v_mov_b32 v2, 0
 ds_write_b32 v1, v2
 v_add_u32 v1, -1024, v1
 ds_write_b32 v1, v2
 s_mov_b32 s57, 0
 s_lshl_b32 s71, s3, 8
 s_add_u32 s71, s71, 163072
 s_mov_b32 m0, s71
 s_cmp_lg_u32 s3, 3
 s_cbranch_scc1 L_cons
 v_lshrrev_b32 v12, 5, v0
 v_lshlrev_b32 v12, 13, v12
 v_and_b32 v13, 31, v0
 v_lshl_add_u32 v12, v13, 4, v12
 v_lshlrev_b32 v13, 4, v0
 v_lshrrev_b32 v32, 3, v0
 v_and_b32 v33, 7, v0
 v_lshrrev_b32 v34, 4, v0
 v_mul_u32_u24 v36, 896, v32
 v_add_u32 v35, 0, v34
 v_xor_b32 v35, v35, v33
 v_lshl_add_u32 v35, v35, 4, v36
 v_add_u32 v44, 0, v35
 v_add_u32 v35, 4, v34
 v_xor_b32 v35, v35, v33
 v_lshl_add_u32 v35, v35, 4, v36
 v_add_u32 v45, 6144, v35
 v_add_u32 v35, 0, v34
 v_xor_b32 v35, v35, v33
 v_lshl_add_u32 v35, v35, 4, v36
 v_add_u32 v46, 12288, v35
 v_add_u32 v35, 4, v34
 v_xor_b32 v35, v35, v33
 v_lshl_add_u32 v35, v35, 4, v36
 v_add_u32 v47, 18432, v35
 v_lshlrev_b32 v4, 1, v34
 v_xor_b32 v4, v4, v33
 v_lshlrev_b32 v4, 4, v4
 v_lshrrev_b32 v5, 5, v0
 v_and_b32 v6, 3, v32
 v_lshl_add_u32 v5, v5, 3, v6
 v_lshl_add_u32 v5, v5, 13, v4
 v_add_u32 v20, 0, v5
 v_add_u32 v21, 130048, v5
 v_add_u32 v22, 30720, v5
 v_add_u32 v23, 160768, v5
 v_mul_u32_u24 v5, 512, v32
 v_add_u32 v16, v5, v4
 v_add_u32 v17, 3072, v16
 v_add_u32 v18, 6144, v16
 v_add_u32 v19, 9216, v16
 v_mul_u32_u24 v5, 896, v32
 v_add_u32 v24, v5, v4
 v_add_u32 v25, 6144, v24
 v_add_u32 v26, 12288, v24
 v_add_u32 v27, 18432, v24
 v_mul_u32_u24 v36, 512, v32
 v_add_u32 v35, 0, v34
 v_xor_b32 v35, v35, v33
 v_lshl_add_u32 v35, v35, 4, v36
 v_add_u32 v28, 0, v35
 v_add_u32 v35, 4, v34
 v_xor_b32 v35, v35, v33
 v_lshl_add_u32 v35, v35, 4, v36
 v_add_u32 v29, 3072, v35
 v_add_u32 v35, 0, v34
 v_xor_b32 v35, v35, v33
 v_lshl_add_u32 v35, v35, 4, v36
 v_add_u32 v30, 6144, v35
 v_add_u32 v35, 4, v34
 v_xor_b32 v35, v35, v33
 v_lshl_add_u32 v35, v35, 4, v36
 v_add_u32 v31, 9216, v35
 v_min_u32 v8, 2, v0
 v_lshlrev_b32 v8, 8, v8
 v_add_u32 v8, 163072, v8
 s_waitcnt lgkmcnt(0)
 s_lshl_b32 s34, s2, 10
 s_add_u32 s34, s34, 34603008
 s_add_u32 s72, s46, s34
 s_addc_u32 s73, s47, 0
 s_and_b32 s73, s73, 0xffff
 s_mov_b32 s74, 0x400
 s_mov_b32 s75, 0x20000
 s_mul_i32 s34, s4, 86016
 s_add_u32 s8, s36, s34
 s_addc_u32 s9, s37, 0
 s_and_b32 s9, s9, 0xffff
 s_mov_b32 s10, 0x15000
 s_mov_b32 s11, 0x20000
 s_waitcnt vmcnt(28)
 s_mov_b32 m0, 0x10000
 s_mov_b32 s54, 0x0
 buffer_load_dwordx4 v44, s[8:11], s54 offen offset:0 lds
 buffer_load_dwordx4 v45, s[8:11], s54 offen offset:1024 lds
 buffer_load_dwordx4 v46, s[8:11], s54 offen offset:2048 lds
 buffer_load_dwordx4 v47, s[8:11], s54 offen offset:3072 lds
 s_waitcnt vmcnt(28)
 s_mov_b32 m0, 0x11000
 s_mov_b32 s54, 0x7000
 buffer_load_dwordx4 v44, s[8:11], s54 offen offset:0 lds
 buffer_load_dwordx4 v45, s[8:11], s54 offen offset:1024 lds
 buffer_load_dwordx4 v46, s[8:11], s54 offen offset:2048 lds
 buffer_load_dwordx4 v47, s[8:11], s54 offen offset:3072 lds
 s_waitcnt vmcnt(28)
 s_mov_b32 m0, 0x12000
 s_mov_b32 s54, 0xe000
 buffer_load_dwordx4 v44, s[8:11], s54 offen offset:0 lds
 buffer_load_dwordx4 v45, s[8:11], s54 offen offset:1024 lds
 buffer_load_dwordx4 v46, s[8:11], s54 offen offset:2048 lds
 buffer_load_dwordx4 v47, s[8:11], s54 offen offset:3072 lds
 s_lshl_b32 s34, s5, 10
 s_sub_u32 s35, 3670016, s34
 s_add_u32 s20, s42, s34
 s_addc_u32 s21, s43, 0
 s_and_b32 s21, s21, 0xffff
 s_mov_b32 s22, s35
 s_mov_b32 s23, 0x20000
 s_mul_i32 s54, s6, 114688
 buffer_load_dwordx4 v[64:67], v12, s[20:23], s54 offen
 s_add_u32 s54, s54, 16384
 buffer_load_dwordx4 v[68:71], v12, s[20:23], s54 offen
 s_add_u32 s54, s54, 16384
 buffer_load_dwordx4 v[72:75], v12, s[20:23], s54 offen
 s_add_u32 s54, s54, 16384
 buffer_load_dwordx4 v[76:79], v12, s[20:23], s54 offen
 s_add_u32 s54, s54, 16384
 buffer_load_dwordx4 v[80:83], v12, s[20:23], s54 offen
 s_add_u32 s54, s54, 16384
 buffer_load_dwordx4 v[84:87], v12, s[20:23], s54 offen
 s_add_u32 s54, s54, 16384
 buffer_load_dwordx4 v[88:91], v12, s[20:23], s54 offen
 s_mov_b32 s52, 0
 s_waitcnt vmcnt(28)
 s_mov_b32 m0, 0x0
 s_mov_b32 s54, 0x0
 buffer_load_dwordx4 v20, s[20:23], s54 offen offset:0 lds
 buffer_load_dwordx4 v21, s[20:23], s54 offen offset:1024 lds
 buffer_load_dwordx4 v22, s[20:23], s54 offen offset:2048 lds
 buffer_load_dwordx4 v23, s[20:23], s54 offen offset:3072 lds
 s_waitcnt vmcnt(28)
 s_mov_b32 m0, 0x1000
 s_mov_b32 s54, 0x40000
 buffer_load_dwordx4 v20, s[20:23], s54 offen offset:0 lds
 buffer_load_dwordx4 v21, s[20:23], s54 offen offset:1024 lds
 buffer_load_dwordx4 v22, s[20:23], s54 offen offset:2048 lds
 buffer_load_dwordx4 v23, s[20:23], s54 offen offset:3072 lds
 s_lshl_b32 s34, s4, 3
 s_add_u32 s34, s34, s5
 s_lshl_b32 s34, s34, 19
 s_add_u32 s12, s38, s34
 s_addc_u32 s13, s39, 0
 s_and_b32 s13, s13, 0xffff
 s_mov_b32 s14, 0x80000
 s_mov_b32 s15, 0x20000
 s_add_u32 s16, s40, s34
 s_addc_u32 s17, s41, 0
 s_and_b32 s17, s17, 0xffff
 s_mov_b32 s18, 0x80000
 s_mov_b32 s19, 0x20000
 s_mul_i32 s34, s5, 458752
 s_add_u32 s24, s44, s34
 s_addc_u32 s25, s45, 0
 s_and_b32 s25, s25, 0xffff
 s_mov_b32 s26, 0x70000
 s_mov_b32 s27, 0x20000
 s_barrier
 s_mov_b32 m0, 0x27c00
 s_movk_i32 s70, 8
 buffer_load_dword off, s[72:75], s70 lds
 s_waitcnt vmcnt(28)
 s_mov_b32 m0, 0x2000
 s_mov_b32 s54, 0x80
 buffer_load_dwordx4 v20, s[20:23], s54 offen offset:0 lds
 buffer_load_dwordx4 v21, s[20:23], s54 offen offset:1024 lds
 buffer_load_dwordx4 v22, s[20:23], s54 offen offset:2048 lds
 buffer_load_dwordx4 v23, s[20:23], s54 offen offset:3072 lds
 s_waitcnt vmcnt(28)
 s_mov_b32 m0, 0x3000
 s_mov_b32 s54, 0x40080
 buffer_load_dwordx4 v20, s[20:23], s54 offen offset:0 lds
 buffer_load_dwordx4 v21, s[20:23], s54 offen offset:1024 lds
 buffer_load_dwordx4 v22, s[20:23], s54 offen offset:2048 lds
 buffer_load_dwordx4 v23, s[20:23], s54 offen offset:3072 lds
 s_mov_b32 m0, 0x27c00
 s_movk_i32 s70, 12
 buffer_load_dword off, s[72:75], s70 lds
 s_waitcnt vmcnt(28)
 s_mov_b32 m0, 0x4000
 s_mov_b32 s54, 0x100
 buffer_load_dwordx4 v20, s[20:23], s54 offen offset:0 lds
 buffer_load_dwordx4 v21, s[20:23], s54 offen offset:1024 lds
 buffer_load_dwordx4 v22, s[20:23], s54 offen offset:2048 lds
 buffer_load_dwordx4 v23, s[20:23], s54 offen offset:3072 lds
 s_waitcnt vmcnt(28)
 s_mov_b32 m0, 0x5000
 s_mov_b32 s54, 0x40100
 buffer_load_dwordx4 v20, s[20:23], s54 offen offset:0 lds
 buffer_load_dwordx4 v21, s[20:23], s54 offen offset:1024 lds
 buffer_load_dwordx4 v22, s[20:23], s54 offen offset:2048 lds
 buffer_load_dwordx4 v23, s[20:23], s54 offen offset:3072 lds
 s_mov_b32 m0, 0x27c00
 s_movk_i32 s70, 16
 buffer_load_dword off, s[72:75], s70 lds
 s_waitcnt vmcnt(28)
 s_mov_b32 m0, 0x6000
 s_mov_b32 s54, 0x180
 buffer_load_dwordx4 v20, s[20:23], s54 offen offset:0 lds
 buffer_load_dwordx4 v21, s[20:23], s54 offen offset:1024 lds
 buffer_load_dwordx4 v22, s[20:23], s54 offen offset:2048 lds
 buffer_load_dwordx4 v23, s[20:23], s54 offen offset:3072 lds
 s_waitcnt vmcnt(28)
 s_mov_b32 m0, 0x7000
 s_mov_b32 s54, 0x40180
 buffer_load_dwordx4 v20, s[20:23], s54 offen offset:0 lds
 buffer_load_dwordx4 v21, s[20:23], s54 offen offset:1024 lds
 buffer_load_dwordx4 v22, s[20:23], s54 offen offset:2048 lds
 buffer_load_dwordx4 v23, s[20:23], s54 offen offset:3072 lds
 s_waitcnt vmcnt(28)
 s_mov_b32 m0, 0x13000
 s_mov_b32 s54, 0x80
 buffer_load_dwordx4 v44, s[8:11], s54 offen offset:0 lds
 buffer_load_dwordx4 v45, s[8:11], s54 offen offset:1024 lds
 buffer_load_dwordx4 v46, s[8:11], s54 offen offset:2048 lds
 buffer_load_dwordx4 v47, s[8:11], s54 offen offset:3072 lds
 s_waitcnt vmcnt(28)
 s_mov_b32 m0, 0x14000
 s_mov_b32 s54, 0x7080
 buffer_load_dwordx4 v44, s[8:11], s54 offen offset:0 lds
 buffer_load_dwordx4 v45, s[8:11], s54 offen offset:1024 lds
 buffer_load_dwordx4 v46, s[8:11], s54 offen offset:2048 lds
 buffer_load_dwordx4 v47, s[8:11], s54 offen offset:3072 lds
 s_waitcnt vmcnt(28)
 s_mov_b32 m0, 0x15000
 s_mov_b32 s54, 0xe080
 buffer_load_dwordx4 v44, s[8:11], s54 offen offset:0 lds
 buffer_load_dwordx4 v45, s[8:11], s54 offen offset:1024 lds
 buffer_load_dwordx4 v46, s[8:11], s54 offen offset:2048 lds
 buffer_load_dwordx4 v47, s[8:11], s54 offen offset:3072 lds
 s_waitcnt vmcnt(28)
 s_mov_b32 m0, 0x16000
 s_mov_b32 s54, 0x100
 buffer_load_dwordx4 v44, s[8:11], s54 offen offset:0 lds
 buffer_load_dwordx4 v45, s[8:11], s54 offen offset:1024 lds
 buffer_load_dwordx4 v46, s[8:11], s54 offen offset:2048 lds
 buffer_load_dwordx4 v47, s[8:11], s54 offen offset:3072 lds
 s_waitcnt vmcnt(28)
 s_mov_b32 m0, 0x17000
 s_mov_b32 s54, 0x7100
 buffer_load_dwordx4 v44, s[8:11], s54 offen offset:0 lds
 buffer_load_dwordx4 v45, s[8:11], s54 offen offset:1024 lds
 buffer_load_dwordx4 v46, s[8:11], s54 offen offset:2048 lds
 buffer_load_dwordx4 v47, s[8:11], s54 offen offset:3072 lds
 s_waitcnt vmcnt(28)
 s_mov_b32 m0, 0x18000
 s_mov_b32 s54, 0xe100
 buffer_load_dwordx4 v44, s[8:11], s54 offen offset:0 lds
 buffer_load_dwordx4 v45, s[8:11], s54 offen offset:1024 lds
 buffer_load_dwordx4 v46, s[8:11], s54 offen offset:2048 lds
 buffer_load_dwordx4 v47, s[8:11], s54 offen offset:3072 lds
 s_waitcnt vmcnt(28)
 s_mov_b32 m0, 0x8000
 s_mov_b32 s54, 0x80000
 buffer_load_dwordx4 v20, s[20:23], s54 offen offset:0 lds
 buffer_load_dwordx4 v21, s[20:23], s54 offen offset:1024 lds
 buffer_load_dwordx4 v22, s[20:23], s54 offen offset:2048 lds
 buffer_load_dwordx4 v23, s[20:23], s54 offen offset:3072 lds
 s_waitcnt vmcnt(28)
 s_mov_b32 m0, 0x9000
 s_mov_b32 s54, 0xc0000
 buffer_load_dwordx4 v20, s[20:23], s54 offen offset:0 lds
 buffer_load_dwordx4 v21, s[20:23], s54 offen offset:1024 lds
 buffer_load_dwordx4 v22, s[20:23], s54 offen offset:2048 lds
 buffer_load_dwordx4 v23, s[20:23], s54 offen offset:3072 lds
 s_mov_b32 m0, 0x27c00
 s_movk_i32 s70, 32
 buffer_load_dword off, s[72:75], s70 lds
 s_waitcnt vmcnt(28)
 s_mov_b32 m0, 0xa000
 s_mov_b32 s54, 0x80080
 buffer_load_dwordx4 v20, s[20:23], s54 offen offset:0 lds
 buffer_load_dwordx4 v21, s[20:23], s54 offen offset:1024 lds
 buffer_load_dwordx4 v22, s[20:23], s54 offen offset:2048 lds
 buffer_load_dwordx4 v23, s[20:23], s54 offen offset:3072 lds
 s_waitcnt vmcnt(28)
 s_mov_b32 m0, 0xb000
 s_mov_b32 s54, 0xc0080
 buffer_load_dwordx4 v20, s[20:23], s54 offen offset:0 lds
 buffer_load_dwordx4 v21, s[20:23], s54 offen offset:1024 lds
 buffer_load_dwordx4 v22, s[20:23], s54 offen offset:2048 lds
 buffer_load_dwordx4 v23, s[20:23], s54 offen offset:3072 lds
 s_waitcnt vmcnt(28)
 s_mov_b32 m0, 0xc000
 s_mov_b32 s54, 0x80100
 buffer_load_dwordx4 v20, s[20:23], s54 offen offset:0 lds
 buffer_load_dwordx4 v21, s[20:23], s54 offen offset:1024 lds
 buffer_load_dwordx4 v22, s[20:23], s54 offen offset:2048 lds
 buffer_load_dwordx4 v23, s[20:23], s54 offen offset:3072 lds
 s_waitcnt vmcnt(28)
 s_mov_b32 m0, 0xd000
 s_mov_b32 s54, 0xc0100
 buffer_load_dwordx4 v20, s[20:23], s54 offen offset:0 lds
 buffer_load_dwordx4 v21, s[20:23], s54 offen offset:1024 lds
 buffer_load_dwordx4 v22, s[20:23], s54 offen offset:2048 lds
 buffer_load_dwordx4 v23, s[20:23], s54 offen offset:3072 lds
 s_mov_b32 m0, 0x27c00
 s_movk_i32 s70, 40
 buffer_load_dword off, s[72:75], s70 lds
 s_waitcnt vmcnt(28)
 s_mov_b32 m0, 0xe000
 s_mov_b32 s54, 0x80180
 buffer_load_dwordx4 v20, s[20:23], s54 offen offset:0 lds
 buffer_load_dwordx4 v21, s[20:23], s54 offen offset:1024 lds
 buffer_load_dwordx4 v22, s[20:23], s54 offen offset:2048 lds
 buffer_load_dwordx4 v23, s[20:23], s54 offen offset:3072 lds
 s_waitcnt vmcnt(28)
 s_mov_b32 m0, 0xf000
 s_mov_b32 s54, 0xc0180
 buffer_load_dwordx4 v20, s[20:23], s54 offen offset:0 lds
 buffer_load_dwordx4 v21, s[20:23], s54 offen offset:1024 lds
 buffer_load_dwordx4 v22, s[20:23], s54 offen offset:2048 lds
 buffer_load_dwordx4 v23, s[20:23], s54 offen offset:3072 lds
 s_mov_b32 m0, 0x27c00
 s_movk_i32 s70, 44
 buffer_load_dword off, s[72:75], s70 lds
 s_waitcnt vmcnt(28)
 s_mov_b32 m0, 0x19000
 s_mov_b32 s54, 0x180
 buffer_load_dwordx4 v44, s[8:11], s54 offen offset:0 lds
 buffer_load_dwordx4 v45, s[8:11], s54 offen offset:1024 lds
 buffer_load_dwordx4 v46, s[8:11], s54 offen offset:2048 lds
 buffer_load_dwordx4 v47, s[8:11], s54 offen offset:3072 lds
 s_waitcnt vmcnt(28)
 s_mov_b32 m0, 0x1a000
 s_mov_b32 s54, 0x7180
 buffer_load_dwordx4 v44, s[8:11], s54 offen offset:0 lds
 buffer_load_dwordx4 v45, s[8:11], s54 offen offset:1024 lds
 buffer_load_dwordx4 v46, s[8:11], s54 offen offset:2048 lds
 buffer_load_dwordx4 v47, s[8:11], s54 offen offset:3072 lds
 s_waitcnt vmcnt(28)
 s_mov_b32 m0, 0x1b000
 s_mov_b32 s54, 0xe180
 buffer_load_dwordx4 v44, s[8:11], s54 offen offset:0 lds
 buffer_load_dwordx4 v45, s[8:11], s54 offen offset:1024 lds
 buffer_load_dwordx4 v46, s[8:11], s54 offen offset:2048 lds
 buffer_load_dwordx4 v47, s[8:11], s54 offen offset:3072 lds
 s_waitcnt vmcnt(28)
 s_mov_b32 m0, 0x1c000
 s_mov_b32 s54, 0x200
 buffer_load_dwordx4 v44, s[8:11], s54 offen offset:0 lds
 buffer_load_dwordx4 v45, s[8:11], s54 offen offset:1024 lds
 buffer_load_dwordx4 v46, s[8:11], s54 offen offset:2048 lds
 buffer_load_dwordx4 v47, s[8:11], s54 offen offset:3072 lds
 s_waitcnt vmcnt(28)
 s_mov_b32 m0, 0x1d000
 s_mov_b32 s54, 0x7200
 buffer_load_dwordx4 v44, s[8:11], s54 offen offset:0 lds
 buffer_load_dwordx4 v45, s[8:11], s54 offen offset:1024 lds
 buffer_load_dwordx4 v46, s[8:11], s54 offen offset:2048 lds
 buffer_load_dwordx4 v47, s[8:11], s54 offen offset:3072 lds
 s_waitcnt vmcnt(28)
 s_mov_b32 m0, 0x1e000
 s_mov_b32 s54, 0xe200
 buffer_load_dwordx4 v44, s[8:11], s54 offen offset:0 lds
 buffer_load_dwordx4 v45, s[8:11], s54 offen offset:1024 lds
 buffer_load_dwordx4 v46, s[8:11], s54 offen offset:2048 lds
 buffer_load_dwordx4 v47, s[8:11], s54 offen offset:3072 lds
 s_waitcnt vmcnt(28)
 s_mov_b32 m0, 0x1f000
 s_mov_b32 s54, 0x280
 buffer_load_dwordx4 v44, s[8:11], s54 offen offset:0 lds
 buffer_load_dwordx4 v45, s[8:11], s54 offen offset:1024 lds
 buffer_load_dwordx4 v46, s[8:11], s54 offen offset:2048 lds
 buffer_load_dwordx4 v47, s[8:11], s54 offen offset:3072 lds
 s_waitcnt vmcnt(28)
 s_mov_b32 m0, 0x20000
 s_mov_b32 s54, 0x7280
 buffer_load_dwordx4 v44, s[8:11], s54 offen offset:0 lds
 buffer_load_dwordx4 v45, s[8:11], s54 offen offset:1024 lds
 buffer_load_dwordx4 v46, s[8:11], s54 offen offset:2048 lds
 buffer_load_dwordx4 v47, s[8:11], s54 offen offset:3072 lds
 s_waitcnt vmcnt(28)
 s_mov_b32 m0, 0x21000
 s_mov_b32 s54, 0xe280
 buffer_load_dwordx4 v44, s[8:11], s54 offen offset:0 lds
 buffer_load_dwordx4 v45, s[8:11], s54 offen offset:1024 lds
 buffer_load_dwordx4 v46, s[8:11], s54 offen offset:2048 lds
 buffer_load_dwordx4 v47, s[8:11], s54 offen offset:3072 lds
 s_waitcnt vmcnt(28)
 s_mov_b32 m0, 0x22000
 s_mov_b32 s54, 0x300
 buffer_load_dwordx4 v44, s[8:11], s54 offen offset:0 lds
 buffer_load_dwordx4 v45, s[8:11], s54 offen offset:1024 lds
 buffer_load_dwordx4 v46, s[8:11], s54 offen offset:2048 lds
 buffer_load_dwordx4 v47, s[8:11], s54 offen offset:3072 lds
 s_waitcnt vmcnt(28)
 s_mov_b32 m0, 0x23000
 s_mov_b32 s54, 0x7300
 buffer_load_dwordx4 v44, s[8:11], s54 offen offset:0 lds
 buffer_load_dwordx4 v45, s[8:11], s54 offen offset:1024 lds
 buffer_load_dwordx4 v46, s[8:11], s54 offen offset:2048 lds
 buffer_load_dwordx4 v47, s[8:11], s54 offen offset:3072 lds
 s_waitcnt vmcnt(28)
 s_mov_b32 m0, 0x24000
 s_mov_b32 s54, 0xe300
 buffer_load_dwordx4 v44, s[8:11], s54 offen offset:0 lds
 buffer_load_dwordx4 v45, s[8:11], s54 offen offset:1024 lds
 buffer_load_dwordx4 v46, s[8:11], s54 offen offset:2048 lds
 buffer_load_dwordx4 v47, s[8:11], s54 offen offset:3072 lds
 s_bitcmp1_b32 s2, 3
 s_cbranch_scc0 L_nwB
 s_mul_i32 s54, s6, 114688
 s_add_u32 s54, s54, 512
 s_waitcnt vmcnt(28)
 buffer_load_dwordx4 v[64:67], v12, s[20:23], s54 offen
 s_add_u32 s54, s54, 16384
 buffer_load_dwordx4 v[68:71], v12, s[20:23], s54 offen
 s_add_u32 s54, s54, 16384
 buffer_load_dwordx4 v[72:75], v12, s[20:23], s54 offen
 s_add_u32 s54, s54, 16384
 buffer_load_dwordx4 v[76:79], v12, s[20:23], s54 offen
 s_add_u32 s54, s54, 16384
 s_waitcnt vmcnt(28)
 buffer_load_dwordx4 v[80:83], v12, s[20:23], s54 offen
 s_add_u32 s54, s54, 16384
 buffer_load_dwordx4 v[84:87], v12, s[20:23], s54 offen
 s_add_u32 s54, s54, 16384
 buffer_load_dwordx4 v[88:91], v12, s[20:23], s54 offen
 s_mul_i32 s54, s6, 7168
 s_waitcnt vmcnt(28)
 buffer_load_dwordx4 v[64:67], v13, s[24:27], s54 offen offset:0
 buffer_load_dwordx4 v[68:71], v13, s[24:27], s54 offen offset:1024
 buffer_load_dwordx4 v[72:75], v13, s[24:27], s54 offen offset:2048
 buffer_load_dwordx4 v[76:79], v13, s[24:27], s54 offen offset:3072
 s_add_u32 s54, s54, 4096
 s_waitcnt vmcnt(28)
 buffer_load_dwordx4 v[80:83], v13, s[24:27], s54 offen offset:0
 buffer_load_dwordx4 v[84:87], v13, s[24:27], s54 offen offset:1024
 buffer_load_dwordx4 v[88:91], v13, s[24:27], s54 offen offset:2048
 s_mul_i32 s54, s6, 7168
 s_add_u32 s54, s54, 229376
 s_waitcnt vmcnt(28)
 buffer_load_dwordx4 v[64:67], v13, s[24:27], s54 offen offset:0
 buffer_load_dwordx4 v[68:71], v13, s[24:27], s54 offen offset:1024
 buffer_load_dwordx4 v[72:75], v13, s[24:27], s54 offen offset:2048
 buffer_load_dwordx4 v[76:79], v13, s[24:27], s54 offen offset:3072
 s_add_u32 s54, s54, 4096
 s_waitcnt vmcnt(28)
 buffer_load_dwordx4 v[80:83], v13, s[24:27], s54 offen offset:0
 buffer_load_dwordx4 v[84:87], v13, s[24:27], s54 offen offset:1024
 buffer_load_dwordx4 v[88:91], v13, s[24:27], s54 offen offset:2048
L_nwB:
 s_cmpk_ge_u32 s52, 1
 s_cbranch_scc0 L_ls8
L_lb8:
 s_waitcnt vmcnt(28)
 s_mov_b32 m0, 0x0
 s_mov_b32 s54, 0x100000
 buffer_load_dwordx4 v20, s[20:23], s54 offen offset:0 lds
 buffer_load_dwordx4 v21, s[20:23], s54 offen offset:1024 lds
 buffer_load_dwordx4 v22, s[20:23], s54 offen offset:2048 lds
 buffer_load_dwordx4 v23, s[20:23], s54 offen offset:3072 lds
 s_waitcnt vmcnt(28)
 s_mov_b32 m0, 0x1000
 s_mov_b32 s54, 0x140000
 buffer_load_dwordx4 v20, s[20:23], s54 offen offset:0 lds
 buffer_load_dwordx4 v21, s[20:23], s54 offen offset:1024 lds
 buffer_load_dwordx4 v22, s[20:23], s54 offen offset:2048 lds
 buffer_load_dwordx4 v23, s[20:23], s54 offen offset:3072 lds
 s_cmpk_ge_u32 s52, 2
 s_cbranch_scc0 L_ls9
L_lb9:
 s_waitcnt vmcnt(28)
 s_mov_b32 m0, 0x2000
 s_mov_b32 s54, 0x180000
 buffer_load_dwordx4 v20, s[20:23], s54 offen offset:0 lds
 buffer_load_dwordx4 v21, s[20:23], s54 offen offset:1024 lds
 buffer_load_dwordx4 v22, s[20:23], s54 offen offset:2048 lds
 buffer_load_dwordx4 v23, s[20:23], s54 offen offset:3072 lds
 s_waitcnt vmcnt(28)
 s_mov_b32 m0, 0x3000
 s_mov_b32 s54, 0x1c0000
 buffer_load_dwordx4 v20, s[20:23], s54 offen offset:0 lds
 buffer_load_dwordx4 v21, s[20:23], s54 offen offset:1024 lds
 buffer_load_dwordx4 v22, s[20:23], s54 offen offset:2048 lds
 buffer_load_dwordx4 v23, s[20:23], s54 offen offset:3072 lds
 s_mov_b32 m0, 0x27c00
 s_movk_i32 s70, 68
 buffer_load_dword off, s[72:75], s70 lds
 s_cmpk_ge_u32 s52, 4
 s_cbranch_scc0 L_ls10
L_lb10:
 s_waitcnt vmcnt(28)
 s_mov_b32 m0, 0x4000
 s_mov_b32 s54, 0x200000
 buffer_load_dwordx4 v20, s[20:23], s54 offen offset:0 lds
 buffer_load_dwordx4 v21, s[20:23], s54 offen offset:1024 lds
 buffer_load_dwordx4 v22, s[20:23], s54 offen offset:2048 lds
 buffer_load_dwordx4 v23, s[20:23], s54 offen offset:3072 lds
 s_waitcnt vmcnt(28)
 s_mov_b32 m0, 0x5000
 s_mov_b32 s54, 0x240000
 buffer_load_dwordx4 v20, s[20:23], s54 offen offset:0 lds
 buffer_load_dwordx4 v21, s[20:23], s54 offen offset:1024 lds
 buffer_load_dwordx4 v22, s[20:23], s54 offen offset:2048 lds
 buffer_load_dwordx4 v23, s[20:23], s54 offen offset:3072 lds
 s_waitcnt vmcnt(28)
 s_mov_b32 m0, 0x6000
 s_mov_b32 s54, 0x280000
 buffer_load_dwordx4 v20, s[20:23], s54 offen offset:0 lds
 buffer_load_dwordx4 v21, s[20:23], s54 offen offset:1024 lds
 buffer_load_dwordx4 v22, s[20:23], s54 offen offset:2048 lds
 buffer_load_dwordx4 v23, s[20:23], s54 offen offset:3072 lds
 s_waitcnt vmcnt(28)
 s_mov_b32 m0, 0x7000
 s_mov_b32 s54, 0x2c0000
 buffer_load_dwordx4 v20, s[20:23], s54 offen offset:0 lds
 buffer_load_dwordx4 v21, s[20:23], s54 offen offset:1024 lds
 buffer_load_dwordx4 v22, s[20:23], s54 offen offset:2048 lds
 buffer_load_dwordx4 v23, s[20:23], s54 offen offset:3072 lds
 s_mov_b32 m0, 0x27c00
 s_movk_i32 s70, 76
 buffer_load_dword off, s[72:75], s70 lds
 s_cmpk_ge_u32 s52, 6
 s_cbranch_scc0 L_ls12
L_lb12:
 s_waitcnt vmcnt(28)
 s_mov_b32 m0, 0x8000
 s_mov_b32 s54, 0x300000
 buffer_load_dwordx4 v20, s[20:23], s54 offen offset:0 lds
 buffer_load_dwordx4 v21, s[20:23], s54 offen offset:1024 lds
 buffer_load_dwordx4 v22, s[20:23], s54 offen offset:2048 lds
 buffer_load_dwordx4 v23, s[20:23], s54 offen offset:3072 lds
 s_waitcnt vmcnt(28)
 s_mov_b32 m0, 0x9000
 s_mov_b32 s54, 0x340000
 buffer_load_dwordx4 v20, s[20:23], s54 offen offset:0 lds
 buffer_load_dwordx4 v21, s[20:23], s54 offen offset:1024 lds
 buffer_load_dwordx4 v22, s[20:23], s54 offen offset:2048 lds
 buffer_load_dwordx4 v23, s[20:23], s54 offen offset:3072 lds
 s_waitcnt vmcnt(28)
 s_mov_b32 m0, 0xa000
 s_mov_b32 s54, 0x100080
 buffer_load_dwordx4 v20, s[20:23], s54 offen offset:0 lds
 buffer_load_dwordx4 v21, s[20:23], s54 offen offset:1024 lds
 buffer_load_dwordx4 v22, s[20:23], s54 offen offset:2048 lds
 buffer_load_dwordx4 v23, s[20:23], s54 offen offset:3072 lds
 s_waitcnt vmcnt(28)
 s_mov_b32 m0, 0xb000
 s_mov_b32 s54, 0x140080
 buffer_load_dwordx4 v20, s[20:23], s54 offen offset:0 lds
 buffer_load_dwordx4 v21, s[20:23], s54 offen offset:1024 lds
 buffer_load_dwordx4 v22, s[20:23], s54 offen offset:2048 lds
 buffer_load_dwordx4 v23, s[20:23], s54 offen offset:3072 lds
 s_mov_b32 m0, 0x27c00
 s_movk_i32 s70, 84
 buffer_load_dword off, s[72:75], s70 lds
 s_waitcnt vmcnt(28)
 s_mov_b32 m0, 0x10000
 s_mov_b32 s54, 0x180080
 buffer_load_dwordx4 v20, s[20:23], s54 offen offset:0 lds
 buffer_load_dwordx4 v21, s[20:23], s54 offen offset:1024 lds
 buffer_load_dwordx4 v22, s[20:23], s54 offen offset:2048 lds
 buffer_load_dwordx4 v23, s[20:23], s54 offen offset:3072 lds
 s_waitcnt vmcnt(28)
 s_mov_b32 m0, 0x11000
 s_mov_b32 s54, 0x1c0080
 buffer_load_dwordx4 v20, s[20:23], s54 offen offset:0 lds
 buffer_load_dwordx4 v21, s[20:23], s54 offen offset:1024 lds
 buffer_load_dwordx4 v22, s[20:23], s54 offen offset:2048 lds
 buffer_load_dwordx4 v23, s[20:23], s54 offen offset:3072 lds
 s_waitcnt vmcnt(28)
 s_mov_b32 m0, 0x12000
 s_mov_b32 s54, 0x200080
 buffer_load_dwordx4 v20, s[20:23], s54 offen offset:0 lds
 buffer_load_dwordx4 v21, s[20:23], s54 offen offset:1024 lds
 buffer_load_dwordx4 v22, s[20:23], s54 offen offset:2048 lds
 buffer_load_dwordx4 v23, s[20:23], s54 offen offset:3072 lds
 s_waitcnt vmcnt(28)
 s_mov_b32 m0, 0x13000
 s_mov_b32 s54, 0x240080
 buffer_load_dwordx4 v20, s[20:23], s54 offen offset:0 lds
 buffer_load_dwordx4 v21, s[20:23], s54 offen offset:1024 lds
 buffer_load_dwordx4 v22, s[20:23], s54 offen offset:2048 lds
 buffer_load_dwordx4 v23, s[20:23], s54 offen offset:3072 lds
 s_mov_b32 m0, 0x27c00
 s_movk_i32 s70, 92
 buffer_load_dword off, s[72:75], s70 lds
 s_waitcnt vmcnt(28)
 s_mov_b32 m0, 0x14000
 s_mov_b32 s54, 0x280080
 buffer_load_dwordx4 v20, s[20:23], s54 offen offset:0 lds
 buffer_load_dwordx4 v21, s[20:23], s54 offen offset:1024 lds
 buffer_load_dwordx4 v22, s[20:23], s54 offen offset:2048 lds
 buffer_load_dwordx4 v23, s[20:23], s54 offen offset:3072 lds
 s_waitcnt vmcnt(28)
 s_mov_b32 m0, 0x15000
 s_mov_b32 s54, 0x2c0080
 buffer_load_dwordx4 v20, s[20:23], s54 offen offset:0 lds
 buffer_load_dwordx4 v21, s[20:23], s54 offen offset:1024 lds
 buffer_load_dwordx4 v22, s[20:23], s54 offen offset:2048 lds
 buffer_load_dwordx4 v23, s[20:23], s54 offen offset:3072 lds
 s_waitcnt vmcnt(28)
 s_mov_b32 m0, 0x16000
 s_mov_b32 s54, 0x300080
 buffer_load_dwordx4 v20, s[20:23], s54 offen offset:0 lds
 buffer_load_dwordx4 v21, s[20:23], s54 offen offset:1024 lds
 buffer_load_dwordx4 v22, s[20:23], s54 offen offset:2048 lds
 buffer_load_dwordx4 v23, s[20:23], s54 offen offset:3072 lds
 s_waitcnt vmcnt(28)
 s_mov_b32 m0, 0x17000
 s_mov_b32 s54, 0x340080
 buffer_load_dwordx4 v20, s[20:23], s54 offen offset:0 lds
 buffer_load_dwordx4 v21, s[20:23], s54 offen offset:1024 lds
 buffer_load_dwordx4 v22, s[20:23], s54 offen offset:2048 lds
 buffer_load_dwordx4 v23, s[20:23], s54 offen offset:3072 lds
 s_mov_b32 m0, 0x27c00
 s_movk_i32 s70, 100
 buffer_load_dword off, s[72:75], s70 lds
 s_cmpk_ge_u32 s52, 8
 s_cbranch_scc0 L_ls18
L_lb18:
 s_waitcnt vmcnt(28)
 s_mov_b32 m0, 0xc000
 s_mov_b32 s54, 0x100100
 buffer_load_dwordx4 v20, s[20:23], s54 offen offset:0 lds
 buffer_load_dwordx4 v21, s[20:23], s54 offen offset:1024 lds
 buffer_load_dwordx4 v22, s[20:23], s54 offen offset:2048 lds
 buffer_load_dwordx4 v23, s[20:23], s54 offen offset:3072 lds
 s_waitcnt vmcnt(28)
 s_mov_b32 m0, 0xd000
 s_mov_b32 s54, 0x140100
 buffer_load_dwordx4 v20, s[20:23], s54 offen offset:0 lds
 buffer_load_dwordx4 v21, s[20:23], s54 offen offset:1024 lds
 buffer_load_dwordx4 v22, s[20:23], s54 offen offset:2048 lds
 buffer_load_dwordx4 v23, s[20:23], s54 offen offset:3072 lds
 s_waitcnt vmcnt(28)
 s_mov_b32 m0, 0xe000
 s_mov_b32 s54, 0x180100
 buffer_load_dwordx4 v20, s[20:23], s54 offen offset:0 lds
 buffer_load_dwordx4 v21, s[20:23], s54 offen offset:1024 lds
 buffer_load_dwordx4 v22, s[20:23], s54 offen offset:2048 lds
 buffer_load_dwordx4 v23, s[20:23], s54 offen offset:3072 lds
 s_waitcnt vmcnt(28)
 s_mov_b32 m0, 0xf000
 s_mov_b32 s54, 0x1c0100
 buffer_load_dwordx4 v20, s[20:23], s54 offen offset:0 lds
 buffer_load_dwordx4 v21, s[20:23], s54 offen offset:1024 lds
 buffer_load_dwordx4 v22, s[20:23], s54 offen offset:2048 lds
 buffer_load_dwordx4 v23, s[20:23], s54 offen offset:3072 lds
 s_mov_b32 m0, 0x27c00
 s_movk_i32 s70, 108
 buffer_load_dword off, s[72:75], s70 lds
 s_cmpk_ge_u32 s52, 10
 s_cbranch_scc0 L_ls20
L_lb20:
 s_waitcnt vmcnt(28)
 s_mov_b32 m0, 0x18000
 s_mov_b32 s54, 0x200100
 buffer_load_dwordx4 v20, s[20:23], s54 offen offset:0 lds
 buffer_load_dwordx4 v21, s[20:23], s54 offen offset:1024 lds
 buffer_load_dwordx4 v22, s[20:23], s54 offen offset:2048 lds
 buffer_load_dwordx4 v23, s[20:23], s54 offen offset:3072 lds
 s_waitcnt vmcnt(28)
 s_mov_b32 m0, 0x19000
 s_mov_b32 s54, 0x240100
 buffer_load_dwordx4 v20, s[20:23], s54 offen offset:0 lds
 buffer_load_dwordx4 v21, s[20:23], s54 offen offset:1024 lds
 buffer_load_dwordx4 v22, s[20:23], s54 offen offset:2048 lds
 buffer_load_dwordx4 v23, s[20:23], s54 offen offset:3072 lds
 s_waitcnt vmcnt(28)
 s_mov_b32 m0, 0x1a000
 s_mov_b32 s54, 0x280100
 buffer_load_dwordx4 v20, s[20:23], s54 offen offset:0 lds
 buffer_load_dwordx4 v21, s[20:23], s54 offen offset:1024 lds
 buffer_load_dwordx4 v22, s[20:23], s54 offen offset:2048 lds
 buffer_load_dwordx4 v23, s[20:23], s54 offen offset:3072 lds
 s_waitcnt vmcnt(28)
 s_mov_b32 m0, 0x1b000
 s_mov_b32 s54, 0x2c0100
 buffer_load_dwordx4 v20, s[20:23], s54 offen offset:0 lds
 buffer_load_dwordx4 v21, s[20:23], s54 offen offset:1024 lds
 buffer_load_dwordx4 v22, s[20:23], s54 offen offset:2048 lds
 buffer_load_dwordx4 v23, s[20:23], s54 offen offset:3072 lds
 s_mov_b32 m0, 0x27c00
 s_movk_i32 s70, 116
 buffer_load_dword off, s[72:75], s70 lds
 s_waitcnt vmcnt(28)
 s_mov_b32 m0, 0x1c000
 s_mov_b32 s54, 0x300100
 buffer_load_dwordx4 v20, s[20:23], s54 offen offset:0 lds
 buffer_load_dwordx4 v21, s[20:23], s54 offen offset:1024 lds
 buffer_load_dwordx4 v22, s[20:23], s54 offen offset:2048 lds
 buffer_load_dwordx4 v23, s[20:23], s54 offen offset:3072 lds
 s_waitcnt vmcnt(28)
 s_mov_b32 m0, 0x1d000
 s_mov_b32 s54, 0x340100
 buffer_load_dwordx4 v20, s[20:23], s54 offen offset:0 lds
 buffer_load_dwordx4 v21, s[20:23], s54 offen offset:1024 lds
 buffer_load_dwordx4 v22, s[20:23], s54 offen offset:2048 lds
 buffer_load_dwordx4 v23, s[20:23], s54 offen offset:3072 lds
 s_waitcnt vmcnt(28)
 s_mov_b32 m0, 0x1e000
 s_mov_b32 s54, 0x100180
 buffer_load_dwordx4 v20, s[20:23], s54 offen offset:0 lds
 buffer_load_dwordx4 v21, s[20:23], s54 offen offset:1024 lds
 buffer_load_dwordx4 v22, s[20:23], s54 offen offset:2048 lds
 buffer_load_dwordx4 v23, s[20:23], s54 offen offset:3072 lds
 s_waitcnt vmcnt(28)
 s_mov_b32 m0, 0x1f000
 s_mov_b32 s54, 0x140180
 buffer_load_dwordx4 v20, s[20:23], s54 offen offset:0 lds
 buffer_load_dwordx4 v21, s[20:23], s54 offen offset:1024 lds
 buffer_load_dwordx4 v22, s[20:23], s54 offen offset:2048 lds
 buffer_load_dwordx4 v23, s[20:23], s54 offen offset:3072 lds
 s_mov_b32 m0, 0x27c00
 s_movk_i32 s70, 124
 buffer_load_dword off, s[72:75], s70 lds
 s_waitcnt vmcnt(28)
 s_mov_b32 m0, 0x20000
 s_mov_b32 s54, 0x180180
 buffer_load_dwordx4 v20, s[20:23], s54 offen offset:0 lds
 buffer_load_dwordx4 v21, s[20:23], s54 offen offset:1024 lds
 buffer_load_dwordx4 v22, s[20:23], s54 offen offset:2048 lds
 buffer_load_dwordx4 v23, s[20:23], s54 offen offset:3072 lds
 s_waitcnt vmcnt(28)
 s_mov_b32 m0, 0x21000
 s_mov_b32 s54, 0x1c0180
 buffer_load_dwordx4 v20, s[20:23], s54 offen offset:0 lds
 buffer_load_dwordx4 v21, s[20:23], s54 offen offset:1024 lds
 buffer_load_dwordx4 v22, s[20:23], s54 offen offset:2048 lds
 buffer_load_dwordx4 v23, s[20:23], s54 offen offset:3072 lds
 s_waitcnt vmcnt(28)
 s_mov_b32 m0, 0x22000
 s_mov_b32 s54, 0x200180
 buffer_load_dwordx4 v20, s[20:23], s54 offen offset:0 lds
 buffer_load_dwordx4 v21, s[20:23], s54 offen offset:1024 lds
 buffer_load_dwordx4 v22, s[20:23], s54 offen offset:2048 lds
 buffer_load_dwordx4 v23, s[20:23], s54 offen offset:3072 lds
 s_waitcnt vmcnt(28)
 s_mov_b32 m0, 0x23000
 s_mov_b32 s54, 0x240180
 buffer_load_dwordx4 v20, s[20:23], s54 offen offset:0 lds
 buffer_load_dwordx4 v21, s[20:23], s54 offen offset:1024 lds
 buffer_load_dwordx4 v22, s[20:23], s54 offen offset:2048 lds
 buffer_load_dwordx4 v23, s[20:23], s54 offen offset:3072 lds
 s_mov_b32 m0, 0x27c00
 s_movk_i32 s70, 132
 buffer_load_dword off, s[72:75], s70 lds
 s_waitcnt vmcnt(28)
 s_mov_b32 m0, 0x24000
 s_mov_b32 s54, 0x280180
 buffer_load_dwordx4 v20, s[20:23], s54 offen offset:0 lds
 buffer_load_dwordx4 v21, s[20:23], s54 offen offset:1024 lds
 buffer_load_dwordx4 v22, s[20:23], s54 offen offset:2048 lds
 buffer_load_dwordx4 v23, s[20:23], s54 offen offset:3072 lds
 s_waitcnt vmcnt(28)
 s_mov_b32 m0, 0x25000
 s_mov_b32 s54, 0x2c0180
 buffer_load_dwordx4 v20, s[20:23], s54 offen offset:0 lds
 buffer_load_dwordx4 v21, s[20:23], s54 offen offset:1024 lds
 buffer_load_dwordx4 v22, s[20:23], s54 offen offset:2048 lds
 buffer_load_dwordx4 v23, s[20:23], s54 offen offset:3072 lds
 s_waitcnt vmcnt(28)
 s_mov_b32 m0, 0x0
 s_mov_b32 s54, 0x300180
 buffer_load_dwordx4 v20, s[20:23], s54 offen offset:0 lds
 buffer_load_dwordx4 v21, s[20:23], s54 offen offset:1024 lds
 buffer_load_dwordx4 v22, s[20:23], s54 offen offset:2048 lds
 buffer_load_dwordx4 v23, s[20:23], s54 offen offset:3072 lds
 s_waitcnt vmcnt(28)
 s_mov_b32 m0, 0x1000
 s_mov_b32 s54, 0x340180
 buffer_load_dwordx4 v20, s[20:23], s54 offen offset:0 lds
 buffer_load_dwordx4 v21, s[20:23], s54 offen offset:1024 lds
 buffer_load_dwordx4 v22, s[20:23], s54 offen offset:2048 lds
 buffer_load_dwordx4 v23, s[20:23], s54 offen offset:3072 lds
 s_mov_b32 m0, 0x27c00
 s_movk_i32 s70, 140
 buffer_load_dword off, s[72:75], s70 lds
 s_bitcmp1_b32 s2, 3
 s_cbranch_scc1 L_nwA
 s_mul_i32 s54, s6, 114688
 s_add_u32 s54, s54, 512
 s_waitcnt vmcnt(28)
 buffer_load_dwordx4 v[64:67], v12, s[20:23], s54 offen
 s_add_u32 s54, s54, 16384
 buffer_load_dwordx4 v[68:71], v12, s[20:23], s54 offen
 s_add_u32 s54, s54, 16384
 buffer_load_dwordx4 v[72:75], v12, s[20:23], s54 offen
 s_add_u32 s54, s54, 16384
 buffer_load_dwordx4 v[76:79], v12, s[20:23], s54 offen
 s_add_u32 s54, s54, 16384
 s_waitcnt vmcnt(28)
 buffer_load_dwordx4 v[80:83], v12, s[20:23], s54 offen
 s_add_u32 s54, s54, 16384
 buffer_load_dwordx4 v[84:87], v12, s[20:23], s54 offen
 s_add_u32 s54, s54, 16384
 buffer_load_dwordx4 v[88:91], v12, s[20:23], s54 offen
 s_mul_i32 s54, s6, 7168
 s_waitcnt vmcnt(28)
 buffer_load_dwordx4 v[64:67], v13, s[24:27], s54 offen offset:0
 buffer_load_dwordx4 v[68:71], v13, s[24:27], s54 offen offset:1024
 buffer_load_dwordx4 v[72:75], v13, s[24:27], s54 offen offset:2048
 buffer_load_dwordx4 v[76:79], v13, s[24:27], s54 offen offset:3072
 s_add_u32 s54, s54, 4096
 s_waitcnt vmcnt(28)
 buffer_load_dwordx4 v[80:83], v13, s[24:27], s54 offen offset:0
 buffer_load_dwordx4 v[84:87], v13, s[24:27], s54 offen offset:1024
 buffer_load_dwordx4 v[88:91], v13, s[24:27], s54 offen offset:2048
 s_mul_i32 s54, s6, 7168
 s_add_u32 s54, s54, 229376
 s_waitcnt vmcnt(28)
 buffer_load_dwordx4 v[64:67], v13, s[24:27], s54 offen offset:0
 buffer_load_dwordx4 v[68:71], v13, s[24:27], s54 offen offset:1024
 buffer_load_dwordx4 v[72:75], v13, s[24:27], s54 offen offset:2048
 buffer_load_dwordx4 v[76:79], v13, s[24:27], s54 offen offset:3072
 s_add_u32 s54, s54, 4096
 s_waitcnt vmcnt(28)
 buffer_load_dwordx4 v[80:83], v13, s[24:27], s54 offen offset:0
 buffer_load_dwordx4 v[84:87], v13, s[24:27], s54 offen offset:1024
 buffer_load_dwordx4 v[88:91], v13, s[24:27], s54 offen offset:2048
L_nwA:
 s_waitcnt vmcnt(28)
 s_mov_b32 m0, 0x2000
 s_mov_b32 s54, 0x0
 buffer_load_dwordx4 v28, s[12:15], s54 offen offset:0 nt lds
 buffer_load_dwordx4 v29, s[12:15], s54 offen offset:1024 nt lds
 buffer_load_dwordx4 v30, s[12:15], s54 offen offset:2048 nt lds
 buffer_load_dwordx4 v31, s[12:15], s54 offen offset:3072 nt lds
 s_waitcnt vmcnt(28)
 s_mov_b32 m0, 0x3000
 s_mov_b32 s54, 0x80
 buffer_load_dwordx4 v28, s[12:15], s54 offen offset:0 nt lds
 buffer_load_dwordx4 v29, s[12:15], s54 offen offset:1024 nt lds
 buffer_load_dwordx4 v30, s[12:15], s54 offen offset:2048 nt lds
 buffer_load_dwordx4 v31, s[12:15], s54 offen offset:3072 nt lds
 s_cmpk_ge_u32 s52, 12
 s_cbranch_scc0 L_ls29
L_lb29:
 s_waitcnt vmcnt(28)
 s_mov_b32 m0, 0x4000
 s_mov_b32 s54, 0x100
 buffer_load_dwordx4 v28, s[12:15], s54 offen offset:0 nt lds
 buffer_load_dwordx4 v29, s[12:15], s54 offen offset:1024 nt lds
 buffer_load_dwordx4 v30, s[12:15], s54 offen offset:2048 nt lds
 buffer_load_dwordx4 v31, s[12:15], s54 offen offset:3072 nt lds
 s_waitcnt vmcnt(28)
 s_mov_b32 m0, 0x5000
 s_mov_b32 s54, 0x180
 buffer_load_dwordx4 v28, s[12:15], s54 offen offset:0 nt lds
 buffer_load_dwordx4 v29, s[12:15], s54 offen offset:1024 nt lds
 buffer_load_dwordx4 v30, s[12:15], s54 offen offset:2048 nt lds
 buffer_load_dwordx4 v31, s[12:15], s54 offen offset:3072 nt lds
 s_mov_b32 m0, 0x27c00
 s_movk_i32 s70, 148
 buffer_load_dword off, s[72:75], s70 lds
 s_waitcnt vmcnt(28)
 s_mov_b32 m0, 0x6000
 s_mov_b32 s54, 0x200
 buffer_load_dwordx4 v20, s[20:23], s54 offen offset:0 lds
 buffer_load_dwordx4 v21, s[20:23], s54 offen offset:1024 lds
 buffer_load_dwordx4 v22, s[20:23], s54 offen offset:2048 lds
 buffer_load_dwordx4 v23, s[20:23], s54 offen offset:3072 lds
 s_waitcnt vmcnt(28)
 s_mov_b32 m0, 0x7000
 s_mov_b32 s54, 0x40200
 buffer_load_dwordx4 v20, s[20:23], s54 offen offset:0 lds
 buffer_load_dwordx4 v21, s[20:23], s54 offen offset:1024 lds
 buffer_load_dwordx4 v22, s[20:23], s54 offen offset:2048 lds
 buffer_load_dwordx4 v23, s[20:23], s54 offen offset:3072 lds
 s_mov_b32 m0, 0x27c00
 s_movk_i32 s70, 152
 buffer_load_dword off, s[72:75], s70 lds
 s_cmpk_ge_u32 s52, 14
 s_cbranch_scc0 L_ls43
L_lb43:
 s_waitcnt vmcnt(28)
 s_mov_b32 m0, 0x8000
 s_mov_b32 s54, 0x80200
 buffer_load_dwordx4 v20, s[20:23], s54 offen offset:0 lds
 buffer_load_dwordx4 v21, s[20:23], s54 offen offset:1024 lds
 buffer_load_dwordx4 v22, s[20:23], s54 offen offset:2048 lds
 buffer_load_dwordx4 v23, s[20:23], s54 offen offset:3072 lds
 s_waitcnt vmcnt(28)
 s_mov_b32 m0, 0x9000
 s_mov_b32 s54, 0xc0200
 buffer_load_dwordx4 v20, s[20:23], s54 offen offset:0 lds
 buffer_load_dwordx4 v21, s[20:23], s54 offen offset:1024 lds
 buffer_load_dwordx4 v22, s[20:23], s54 offen offset:2048 lds
 buffer_load_dwordx4 v23, s[20:23], s54 offen offset:3072 lds
 s_cmpk_ge_u32 s52, 16
 s_cbranch_scc0 L_ls33
L_lb33:
 s_waitcnt vmcnt(28)
 s_mov_b32 m0, 0xa000
 s_mov_b32 s54, 0x4000
 buffer_load_dwordx4 v28, s[12:15], s54 offen offset:0 nt lds
 buffer_load_dwordx4 v29, s[12:15], s54 offen offset:1024 nt lds
 buffer_load_dwordx4 v30, s[12:15], s54 offen offset:2048 nt lds
 buffer_load_dwordx4 v31, s[12:15], s54 offen offset:3072 nt lds
 s_waitcnt vmcnt(28)
 s_mov_b32 m0, 0x10000
 s_mov_b32 s54, 0x0
 buffer_load_dwordx4 v16, s[16:19], s54 offen offset:0 nt lds
 buffer_load_dwordx4 v17, s[16:19], s54 offen offset:1024 nt lds
 buffer_load_dwordx4 v18, s[16:19], s54 offen offset:2048 nt lds
 buffer_load_dwordx4 v19, s[16:19], s54 offen offset:3072 nt lds
 s_waitcnt vmcnt(28)
 s_mov_b32 m0, 0xb000
 s_mov_b32 s54, 0x4080
 buffer_load_dwordx4 v28, s[12:15], s54 offen offset:0 nt lds
 buffer_load_dwordx4 v29, s[12:15], s54 offen offset:1024 nt lds
 buffer_load_dwordx4 v30, s[12:15], s54 offen offset:2048 nt lds
 buffer_load_dwordx4 v31, s[12:15], s54 offen offset:3072 nt lds
 s_waitcnt vmcnt(28)
 s_mov_b32 m0, 0x11000
 s_mov_b32 s54, 0x80
 buffer_load_dwordx4 v16, s[16:19], s54 offen offset:0 nt lds
 buffer_load_dwordx4 v17, s[16:19], s54 offen offset:1024 nt lds
 buffer_load_dwordx4 v18, s[16:19], s54 offen offset:2048 nt lds
 buffer_load_dwordx4 v19, s[16:19], s54 offen offset:3072 nt lds
 s_cmpk_ge_u32 s52, 18
 s_cbranch_scc0 L_ls34
L_lb34:
 s_waitcnt vmcnt(28)
 s_mov_b32 m0, 0x12000
 s_mov_b32 s54, 0x4100
 buffer_load_dwordx4 v28, s[12:15], s54 offen offset:0 nt lds
 buffer_load_dwordx4 v29, s[12:15], s54 offen offset:1024 nt lds
 buffer_load_dwordx4 v30, s[12:15], s54 offen offset:2048 nt lds
 buffer_load_dwordx4 v31, s[12:15], s54 offen offset:3072 nt lds
 s_waitcnt vmcnt(28)
 s_mov_b32 m0, 0x14000
 s_mov_b32 s54, 0x100
 buffer_load_dwordx4 v16, s[16:19], s54 offen offset:0 nt lds
 buffer_load_dwordx4 v17, s[16:19], s54 offen offset:1024 nt lds
 buffer_load_dwordx4 v18, s[16:19], s54 offen offset:2048 nt lds
 buffer_load_dwordx4 v19, s[16:19], s54 offen offset:3072 nt lds
 s_waitcnt vmcnt(28)
 s_mov_b32 m0, 0x13000
 s_mov_b32 s54, 0x4180
 buffer_load_dwordx4 v28, s[12:15], s54 offen offset:0 nt lds
 buffer_load_dwordx4 v29, s[12:15], s54 offen offset:1024 nt lds
 buffer_load_dwordx4 v30, s[12:15], s54 offen offset:2048 nt lds
 buffer_load_dwordx4 v31, s[12:15], s54 offen offset:3072 nt lds
 s_mov_b32 m0, 0x27c00
 s_movk_i32 s70, 168
 buffer_load_dword off, s[72:75], s70 lds
 s_waitcnt vmcnt(28)
 s_mov_b32 m0, 0x15000
 s_mov_b32 s54, 0x180
 buffer_load_dwordx4 v16, s[16:19], s54 offen offset:0 nt lds
 buffer_load_dwordx4 v17, s[16:19], s54 offen offset:1024 nt lds
 buffer_load_dwordx4 v18, s[16:19], s54 offen offset:2048 nt lds
 buffer_load_dwordx4 v19, s[16:19], s54 offen offset:3072 nt lds
 s_cmpk_ge_u32 s52, 20
 s_cbranch_scc0 L_ls37
L_lb37:
 s_waitcnt vmcnt(28)
 s_mov_b32 m0, 0x16000
 s_mov_b32 s54, 0x8000
 buffer_load_dwordx4 v28, s[12:15], s54 offen offset:0 nt lds
 buffer_load_dwordx4 v29, s[12:15], s54 offen offset:1024 nt lds
 buffer_load_dwordx4 v30, s[12:15], s54 offen offset:2048 nt lds
 buffer_load_dwordx4 v31, s[12:15], s54 offen offset:3072 nt lds
 s_waitcnt vmcnt(28)
 s_mov_b32 m0, 0xc000
 s_mov_b32 s54, 0x4000
 buffer_load_dwordx4 v16, s[16:19], s54 offen offset:0 nt lds
 buffer_load_dwordx4 v17, s[16:19], s54 offen offset:1024 nt lds
 buffer_load_dwordx4 v18, s[16:19], s54 offen offset:2048 nt lds
 buffer_load_dwordx4 v19, s[16:19], s54 offen offset:3072 nt lds
 s_waitcnt vmcnt(28)
 s_mov_b32 m0, 0x17000
 s_mov_b32 s54, 0x8080
 buffer_load_dwordx4 v28, s[12:15], s54 offen offset:0 nt lds
 buffer_load_dwordx4 v29, s[12:15], s54 offen offset:1024 nt lds
 buffer_load_dwordx4 v30, s[12:15], s54 offen offset:2048 nt lds
 buffer_load_dwordx4 v31, s[12:15], s54 offen offset:3072 nt lds
 s_mov_b32 m0, 0x27c00
 s_movk_i32 s70, 176
 buffer_load_dword off, s[72:75], s70 lds
 s_waitcnt vmcnt(28)
 s_mov_b32 m0, 0xd000
 s_mov_b32 s54, 0x4080
 buffer_load_dwordx4 v16, s[16:19], s54 offen offset:0 nt lds
 buffer_load_dwordx4 v17, s[16:19], s54 offen offset:1024 nt lds
 buffer_load_dwordx4 v18, s[16:19], s54 offen offset:2048 nt lds
 buffer_load_dwordx4 v19, s[16:19], s54 offen offset:3072 nt lds
 s_cmpk_ge_u32 s52, 22
 s_cbranch_scc0 L_ls38
L_lb38:
 s_waitcnt vmcnt(28)
 s_mov_b32 m0, 0xe000
 s_mov_b32 s54, 0x8100
 buffer_load_dwordx4 v28, s[12:15], s54 offen offset:0 nt lds
 buffer_load_dwordx4 v29, s[12:15], s54 offen offset:1024 nt lds
 buffer_load_dwordx4 v30, s[12:15], s54 offen offset:2048 nt lds
 buffer_load_dwordx4 v31, s[12:15], s54 offen offset:3072 nt lds
 s_waitcnt vmcnt(28)
 s_mov_b32 m0, 0x18000
 s_mov_b32 s54, 0x4100
 buffer_load_dwordx4 v16, s[16:19], s54 offen offset:0 nt lds
 buffer_load_dwordx4 v17, s[16:19], s54 offen offset:1024 nt lds
 buffer_load_dwordx4 v18, s[16:19], s54 offen offset:2048 nt lds
 buffer_load_dwordx4 v19, s[16:19], s54 offen offset:3072 nt lds
 s_waitcnt vmcnt(28)
 s_mov_b32 m0, 0xf000
 s_mov_b32 s54, 0x8180
 buffer_load_dwordx4 v28, s[12:15], s54 offen offset:0 nt lds
 buffer_load_dwordx4 v29, s[12:15], s54 offen offset:1024 nt lds
 buffer_load_dwordx4 v30, s[12:15], s54 offen offset:2048 nt lds
 buffer_load_dwordx4 v31, s[12:15], s54 offen offset:3072 nt lds
 s_mov_b32 m0, 0x27c00
 s_movk_i32 s70, 184
 buffer_load_dword off, s[72:75], s70 lds
 s_waitcnt vmcnt(28)
 s_mov_b32 m0, 0x19000
 s_mov_b32 s54, 0x4180
 buffer_load_dwordx4 v16, s[16:19], s54 offen offset:0 nt lds
 buffer_load_dwordx4 v17, s[16:19], s54 offen offset:1024 nt lds
 buffer_load_dwordx4 v18, s[16:19], s54 offen offset:2048 nt lds
 buffer_load_dwordx4 v19, s[16:19], s54 offen offset:3072 nt lds
 s_cmpk_ge_u32 s52, 24
 s_cbranch_scc0 L_ls41
L_lb41:
 s_waitcnt vmcnt(28)
 s_mov_b32 m0, 0x1a000
 s_mov_b32 s54, 0xc000
 buffer_load_dwordx4 v28, s[12:15], s54 offen offset:0 nt lds
 buffer_load_dwordx4 v29, s[12:15], s54 offen offset:1024 nt lds
 buffer_load_dwordx4 v30, s[12:15], s54 offen offset:2048 nt lds
 buffer_load_dwordx4 v31, s[12:15], s54 offen offset:3072 nt lds
 s_waitcnt vmcnt(28)
 s_mov_b32 m0, 0x1c000
 s_mov_b32 s54, 0x8000
 buffer_load_dwordx4 v16, s[16:19], s54 offen offset:0 nt lds
 buffer_load_dwordx4 v17, s[16:19], s54 offen offset:1024 nt lds
 buffer_load_dwordx4 v18, s[16:19], s54 offen offset:2048 nt lds
 buffer_load_dwordx4 v19, s[16:19], s54 offen offset:3072 nt lds
 s_waitcnt vmcnt(28)
 s_mov_b32 m0, 0x1b000
 s_mov_b32 s54, 0xc080
 buffer_load_dwordx4 v28, s[12:15], s54 offen offset:0 nt lds
 buffer_load_dwordx4 v29, s[12:15], s54 offen offset:1024 nt lds
 buffer_load_dwordx4 v30, s[12:15], s54 offen offset:2048 nt lds
 buffer_load_dwordx4 v31, s[12:15], s54 offen offset:3072 nt lds
 s_mov_b32 m0, 0x27c00
 s_movk_i32 s70, 192
 buffer_load_dword off, s[72:75], s70 lds
 s_waitcnt vmcnt(28)
 s_mov_b32 m0, 0x1d000
 s_mov_b32 s54, 0x8080
 buffer_load_dwordx4 v16, s[16:19], s54 offen offset:0 nt lds
 buffer_load_dwordx4 v17, s[16:19], s54 offen offset:1024 nt lds
 buffer_load_dwordx4 v18, s[16:19], s54 offen offset:2048 nt lds
 buffer_load_dwordx4 v19, s[16:19], s54 offen offset:3072 nt lds
 s_cmpk_ge_u32 s52, 26
 s_cbranch_scc0 L_ls42
L_lb42:
 s_waitcnt vmcnt(28)
 s_mov_b32 m0, 0x1e000
 s_mov_b32 s54, 0xc100
 buffer_load_dwordx4 v28, s[12:15], s54 offen offset:0 nt lds
 buffer_load_dwordx4 v29, s[12:15], s54 offen offset:1024 nt lds
 buffer_load_dwordx4 v30, s[12:15], s54 offen offset:2048 nt lds
 buffer_load_dwordx4 v31, s[12:15], s54 offen offset:3072 nt lds
 s_waitcnt vmcnt(28)
 s_mov_b32 m0, 0x20000
 s_mov_b32 s54, 0x8100
 buffer_load_dwordx4 v16, s[16:19], s54 offen offset:0 nt lds
 buffer_load_dwordx4 v17, s[16:19], s54 offen offset:1024 nt lds
 buffer_load_dwordx4 v18, s[16:19], s54 offen offset:2048 nt lds
 buffer_load_dwordx4 v19, s[16:19], s54 offen offset:3072 nt lds
 s_waitcnt vmcnt(28)
 s_mov_b32 m0, 0x1f000
 s_mov_b32 s54, 0xc180
 buffer_load_dwordx4 v28, s[12:15], s54 offen offset:0 nt lds
 buffer_load_dwordx4 v29, s[12:15], s54 offen offset:1024 nt lds
 buffer_load_dwordx4 v30, s[12:15], s54 offen offset:2048 nt lds
 buffer_load_dwordx4 v31, s[12:15], s54 offen offset:3072 nt lds
 s_mov_b32 m0, 0x27c00
 s_movk_i32 s70, 200
 buffer_load_dword off, s[72:75], s70 lds
 s_waitcnt vmcnt(28)
 s_mov_b32 m0, 0x21000
 s_mov_b32 s54, 0x8180
 buffer_load_dwordx4 v16, s[16:19], s54 offen offset:0 nt lds
 buffer_load_dwordx4 v17, s[16:19], s54 offen offset:1024 nt lds
 buffer_load_dwordx4 v18, s[16:19], s54 offen offset:2048 nt lds
 buffer_load_dwordx4 v19, s[16:19], s54 offen offset:3072 nt lds
 s_mov_b32 m0, 0x27c00
 s_movk_i32 s70, 204
 buffer_load_dword off, s[72:75], s70 lds
 s_cmpk_ge_u32 s52, 28
 s_cbranch_scc0 L_ls44
L_lb44:
 s_waitcnt vmcnt(28)
 s_mov_b32 m0, 0x0
 s_mov_b32 s54, 0x100200
 buffer_load_dwordx4 v20, s[20:23], s54 offen offset:0 lds
 buffer_load_dwordx4 v21, s[20:23], s54 offen offset:1024 lds
 buffer_load_dwordx4 v22, s[20:23], s54 offen offset:2048 lds
 buffer_load_dwordx4 v23, s[20:23], s54 offen offset:3072 lds
 s_waitcnt vmcnt(28)
 s_mov_b32 m0, 0x1000
 s_mov_b32 s54, 0x140200
 buffer_load_dwordx4 v20, s[20:23], s54 offen offset:0 lds
 buffer_load_dwordx4 v21, s[20:23], s54 offen offset:1024 lds
 buffer_load_dwordx4 v22, s[20:23], s54 offen offset:2048 lds
 buffer_load_dwordx4 v23, s[20:23], s54 offen offset:3072 lds
 s_mov_b32 m0, 0x27c00
 s_movk_i32 s70, 208
 buffer_load_dword off, s[72:75], s70 lds
 s_cmpk_ge_u32 s52, 30
 s_cbranch_scc0 L_ls49
L_lb49:
 s_waitcnt vmcnt(28)
 s_mov_b32 m0, 0x2000
 s_mov_b32 s54, 0x180200
 buffer_load_dwordx4 v20, s[20:23], s54 offen offset:0 lds
 buffer_load_dwordx4 v21, s[20:23], s54 offen offset:1024 lds
 buffer_load_dwordx4 v22, s[20:23], s54 offen offset:2048 lds
 buffer_load_dwordx4 v23, s[20:23], s54 offen offset:3072 lds
 s_waitcnt vmcnt(28)
 s_mov_b32 m0, 0x3000
 s_mov_b32 s54, 0x1c0200
 buffer_load_dwordx4 v20, s[20:23], s54 offen offset:0 lds
 buffer_load_dwordx4 v21, s[20:23], s54 offen offset:1024 lds
 buffer_load_dwordx4 v22, s[20:23], s54 offen offset:2048 lds
 buffer_load_dwordx4 v23, s[20:23], s54 offen offset:3072 lds
 s_waitcnt vmcnt(28)
 s_mov_b32 m0, 0x22000
 s_mov_b32 s54, 0x10000
 buffer_load_dwordx4 v28, s[12:15], s54 offen offset:0 nt lds
 buffer_load_dwordx4 v29, s[12:15], s54 offen offset:1024 nt lds
 buffer_load_dwordx4 v30, s[12:15], s54 offen offset:2048 nt lds
 buffer_load_dwordx4 v31, s[12:15], s54 offen offset:3072 nt lds
 s_waitcnt vmcnt(28)
 s_mov_b32 m0, 0x24000
 s_mov_b32 s54, 0xc000
 buffer_load_dwordx4 v16, s[16:19], s54 offen offset:0 nt lds
 buffer_load_dwordx4 v17, s[16:19], s54 offen offset:1024 nt lds
 buffer_load_dwordx4 v18, s[16:19], s54 offen offset:2048 nt lds
 buffer_load_dwordx4 v19, s[16:19], s54 offen offset:3072 nt lds
 s_waitcnt vmcnt(28)
 s_mov_b32 m0, 0x23000
 s_mov_b32 s54, 0x10080
 buffer_load_dwordx4 v28, s[12:15], s54 offen offset:0 nt lds
 buffer_load_dwordx4 v29, s[12:15], s54 offen offset:1024 nt lds
 buffer_load_dwordx4 v30, s[12:15], s54 offen offset:2048 nt lds
 buffer_load_dwordx4 v31, s[12:15], s54 offen offset:3072 nt lds
 s_waitcnt vmcnt(28)
 s_mov_b32 m0, 0x25000
 s_mov_b32 s54, 0xc080
 buffer_load_dwordx4 v16, s[16:19], s54 offen offset:0 nt lds
 buffer_load_dwordx4 v17, s[16:19], s54 offen offset:1024 nt lds
 buffer_load_dwordx4 v18, s[16:19], s54 offen offset:2048 nt lds
 buffer_load_dwordx4 v19, s[16:19], s54 offen offset:3072 nt lds
 s_cmpk_ge_u32 s52, 33
 s_cbranch_scc0 L_ls46
L_lb46:
 s_cmpk_ge_u32 s52, 35
 s_cbranch_scc0 L_ls48
L_lb48:
 s_waitcnt vmcnt(28)
 s_mov_b32 m0, 0x12000
 s_mov_b32 s54, 0x10100
 buffer_load_dwordx4 v28, s[12:15], s54 offen offset:0 nt lds
 buffer_load_dwordx4 v29, s[12:15], s54 offen offset:1024 nt lds
 buffer_load_dwordx4 v30, s[12:15], s54 offen offset:2048 nt lds
 buffer_load_dwordx4 v31, s[12:15], s54 offen offset:3072 nt lds
 s_waitcnt vmcnt(28)
 s_mov_b32 m0, 0x10000
 s_mov_b32 s54, 0xc100
 buffer_load_dwordx4 v16, s[16:19], s54 offen offset:0 nt lds
 buffer_load_dwordx4 v17, s[16:19], s54 offen offset:1024 nt lds
 buffer_load_dwordx4 v18, s[16:19], s54 offen offset:2048 nt lds
 buffer_load_dwordx4 v19, s[16:19], s54 offen offset:3072 nt lds
 s_waitcnt vmcnt(28)
 s_mov_b32 m0, 0x13000
 s_mov_b32 s54, 0x10180
 buffer_load_dwordx4 v28, s[12:15], s54 offen offset:0 nt lds
 buffer_load_dwordx4 v29, s[12:15], s54 offen offset:1024 nt lds
 buffer_load_dwordx4 v30, s[12:15], s54 offen offset:2048 nt lds
 buffer_load_dwordx4 v31, s[12:15], s54 offen offset:3072 nt lds
 s_mov_b32 m0, 0x27c00
 s_movk_i32 s70, 224
 buffer_load_dword off, s[72:75], s70 lds
 s_waitcnt vmcnt(28)
 s_mov_b32 m0, 0x11000
 s_mov_b32 s54, 0xc180
 buffer_load_dwordx4 v16, s[16:19], s54 offen offset:0 nt lds
 buffer_load_dwordx4 v17, s[16:19], s54 offen offset:1024 nt lds
 buffer_load_dwordx4 v18, s[16:19], s54 offen offset:2048 nt lds
 buffer_load_dwordx4 v19, s[16:19], s54 offen offset:3072 nt lds
 s_mov_b32 m0, 0x27c00
 s_movk_i32 s70, 228
 buffer_load_dword off, s[72:75], s70 lds
 s_waitcnt vmcnt(28)
 s_mov_b32 m0, 0x4000
 s_mov_b32 s54, 0x200200
 buffer_load_dwordx4 v20, s[20:23], s54 offen offset:0 lds
 buffer_load_dwordx4 v21, s[20:23], s54 offen offset:1024 lds
 buffer_load_dwordx4 v22, s[20:23], s54 offen offset:2048 lds
 buffer_load_dwordx4 v23, s[20:23], s54 offen offset:3072 lds
 s_waitcnt vmcnt(28)
 s_mov_b32 m0, 0x5000
 s_mov_b32 s54, 0x240200
 buffer_load_dwordx4 v20, s[20:23], s54 offen offset:0 lds
 buffer_load_dwordx4 v21, s[20:23], s54 offen offset:1024 lds
 buffer_load_dwordx4 v22, s[20:23], s54 offen offset:2048 lds
 buffer_load_dwordx4 v23, s[20:23], s54 offen offset:3072 lds
 s_mov_b32 m0, 0x27c00
 s_movk_i32 s70, 232
 buffer_load_dword off, s[72:75], s70 lds
 s_waitcnt vmcnt(28)
 s_mov_b32 m0, 0x6000
 s_mov_b32 s54, 0x280200
 buffer_load_dwordx4 v20, s[20:23], s54 offen offset:0 lds
 buffer_load_dwordx4 v21, s[20:23], s54 offen offset:1024 lds
 buffer_load_dwordx4 v22, s[20:23], s54 offen offset:2048 lds
 buffer_load_dwordx4 v23, s[20:23], s54 offen offset:3072 lds
 s_waitcnt vmcnt(28)
 s_mov_b32 m0, 0x7000
 s_mov_b32 s54, 0x2c0200
 buffer_load_dwordx4 v20, s[20:23], s54 offen offset:0 lds
 buffer_load_dwordx4 v21, s[20:23], s54 offen offset:1024 lds
 buffer_load_dwordx4 v22, s[20:23], s54 offen offset:2048 lds
 buffer_load_dwordx4 v23, s[20:23], s54 offen offset:3072 lds
 s_cmpk_ge_u32 s52, 37
 s_cbranch_scc0 L_ls53
L_lb53:
 s_waitcnt vmcnt(28)
 s_mov_b32 m0, 0x14000
 s_mov_b32 s54, 0x14000
 buffer_load_dwordx4 v28, s[12:15], s54 offen offset:0 nt lds
 buffer_load_dwordx4 v29, s[12:15], s54 offen offset:1024 nt lds
 buffer_load_dwordx4 v30, s[12:15], s54 offen offset:2048 nt lds
 buffer_load_dwordx4 v31, s[12:15], s54 offen offset:3072 nt lds
 s_waitcnt vmcnt(28)
 s_mov_b32 m0, 0x16000
 s_mov_b32 s54, 0x10000
 buffer_load_dwordx4 v16, s[16:19], s54 offen offset:0 nt lds
 buffer_load_dwordx4 v17, s[16:19], s54 offen offset:1024 nt lds
 buffer_load_dwordx4 v18, s[16:19], s54 offen offset:2048 nt lds
 buffer_load_dwordx4 v19, s[16:19], s54 offen offset:3072 nt lds
 s_waitcnt vmcnt(28)
 s_mov_b32 m0, 0x15000
 s_mov_b32 s54, 0x14080
 buffer_load_dwordx4 v28, s[12:15], s54 offen offset:0 nt lds
 buffer_load_dwordx4 v29, s[12:15], s54 offen offset:1024 nt lds
 buffer_load_dwordx4 v30, s[12:15], s54 offen offset:2048 nt lds
 buffer_load_dwordx4 v31, s[12:15], s54 offen offset:3072 nt lds
 s_waitcnt vmcnt(28)
 s_mov_b32 m0, 0x17000
 s_mov_b32 s54, 0x10080
 buffer_load_dwordx4 v16, s[16:19], s54 offen offset:0 nt lds
 buffer_load_dwordx4 v17, s[16:19], s54 offen offset:1024 nt lds
 buffer_load_dwordx4 v18, s[16:19], s54 offen offset:2048 nt lds
 buffer_load_dwordx4 v19, s[16:19], s54 offen offset:3072 nt lds
 s_cmpk_ge_u32 s52, 39
 s_cbranch_scc0 L_ls54
L_lb54:
 s_waitcnt vmcnt(28)
 s_mov_b32 m0, 0xe000
 s_mov_b32 s54, 0x14100
 buffer_load_dwordx4 v28, s[12:15], s54 offen offset:0 nt lds
 buffer_load_dwordx4 v29, s[12:15], s54 offen offset:1024 nt lds
 buffer_load_dwordx4 v30, s[12:15], s54 offen offset:2048 nt lds
 buffer_load_dwordx4 v31, s[12:15], s54 offen offset:3072 nt lds
 s_waitcnt vmcnt(28)
 s_mov_b32 m0, 0xc000
 s_mov_b32 s54, 0x10100
 buffer_load_dwordx4 v16, s[16:19], s54 offen offset:0 nt lds
 buffer_load_dwordx4 v17, s[16:19], s54 offen offset:1024 nt lds
 buffer_load_dwordx4 v18, s[16:19], s54 offen offset:2048 nt lds
 buffer_load_dwordx4 v19, s[16:19], s54 offen offset:3072 nt lds
 s_waitcnt vmcnt(28)
 s_mov_b32 m0, 0xf000
 s_mov_b32 s54, 0x14180
 buffer_load_dwordx4 v28, s[12:15], s54 offen offset:0 nt lds
 buffer_load_dwordx4 v29, s[12:15], s54 offen offset:1024 nt lds
 buffer_load_dwordx4 v30, s[12:15], s54 offen offset:2048 nt lds
 buffer_load_dwordx4 v31, s[12:15], s54 offen offset:3072 nt lds
 s_mov_b32 m0, 0x27c00
 s_movk_i32 s70, 248
 buffer_load_dword off, s[72:75], s70 lds
 s_waitcnt vmcnt(28)
 s_mov_b32 m0, 0xd000
 s_mov_b32 s54, 0x10180
 buffer_load_dwordx4 v16, s[16:19], s54 offen offset:0 nt lds
 buffer_load_dwordx4 v17, s[16:19], s54 offen offset:1024 nt lds
 buffer_load_dwordx4 v18, s[16:19], s54 offen offset:2048 nt lds
 buffer_load_dwordx4 v19, s[16:19], s54 offen offset:3072 nt lds
 s_mov_b32 m0, 0x27c00
 s_movk_i32 s70, 252
 buffer_load_dword off, s[72:75], s70 lds
 s_waitcnt vmcnt(28)
 s_mov_b32 m0, 0xa000
 s_mov_b32 s54, 0x300200
 buffer_load_dwordx4 v20, s[20:23], s54 offen offset:0 lds
 buffer_load_dwordx4 v21, s[20:23], s54 offen offset:1024 lds
 buffer_load_dwordx4 v22, s[20:23], s54 offen offset:2048 lds
 buffer_load_dwordx4 v23, s[20:23], s54 offen offset:3072 lds
 s_waitcnt vmcnt(28)
 s_mov_b32 m0, 0xb000
 s_mov_b32 s54, 0x340200
 buffer_load_dwordx4 v20, s[20:23], s54 offen offset:0 lds
 buffer_load_dwordx4 v21, s[20:23], s54 offen offset:1024 lds
 buffer_load_dwordx4 v22, s[20:23], s54 offen offset:2048 lds
 buffer_load_dwordx4 v23, s[20:23], s54 offen offset:3072 lds
 s_mov_b32 m0, 0x27c00
 s_movk_i32 s70, 256
 buffer_load_dword off, s[72:75], s70 lds
 s_cmpk_ge_u32 s52, 45
 s_cbranch_scc0 L_ls61
L_lb61:
 s_waitcnt vmcnt(28)
 s_mov_b32 m0, 0x8000
 s_mov_b32 s54, 0x280
 buffer_load_dwordx4 v20, s[20:23], s54 offen offset:0 lds
 buffer_load_dwordx4 v21, s[20:23], s54 offen offset:1024 lds
 buffer_load_dwordx4 v22, s[20:23], s54 offen offset:2048 lds
 buffer_load_dwordx4 v23, s[20:23], s54 offen offset:3072 lds
 s_waitcnt vmcnt(28)
 s_mov_b32 m0, 0x9000
 s_mov_b32 s54, 0x40280
 buffer_load_dwordx4 v20, s[20:23], s54 offen offset:0 lds
 buffer_load_dwordx4 v21, s[20:23], s54 offen offset:1024 lds
 buffer_load_dwordx4 v22, s[20:23], s54 offen offset:2048 lds
 buffer_load_dwordx4 v23, s[20:23], s54 offen offset:3072 lds
 s_waitcnt vmcnt(28)
 s_mov_b32 m0, 0x18000
 s_mov_b32 s54, 0x18000
 buffer_load_dwordx4 v28, s[12:15], s54 offen offset:0 nt lds
 buffer_load_dwordx4 v29, s[12:15], s54 offen offset:1024 nt lds
 buffer_load_dwordx4 v30, s[12:15], s54 offen offset:2048 nt lds
 buffer_load_dwordx4 v31, s[12:15], s54 offen offset:3072 nt lds
 s_waitcnt vmcnt(28)
 s_mov_b32 m0, 0x1a000
 s_mov_b32 s54, 0x14000
 buffer_load_dwordx4 v16, s[16:19], s54 offen offset:0 nt lds
 buffer_load_dwordx4 v17, s[16:19], s54 offen offset:1024 nt lds
 buffer_load_dwordx4 v18, s[16:19], s54 offen offset:2048 nt lds
 buffer_load_dwordx4 v19, s[16:19], s54 offen offset:3072 nt lds
 s_waitcnt vmcnt(28)
 s_mov_b32 m0, 0x19000
 s_mov_b32 s54, 0x18080
 buffer_load_dwordx4 v28, s[12:15], s54 offen offset:0 nt lds
 buffer_load_dwordx4 v29, s[12:15], s54 offen offset:1024 nt lds
 buffer_load_dwordx4 v30, s[12:15], s54 offen offset:2048 nt lds
 buffer_load_dwordx4 v31, s[12:15], s54 offen offset:3072 nt lds
 s_waitcnt vmcnt(28)
 s_mov_b32 m0, 0x1b000
 s_mov_b32 s54, 0x14080
 buffer_load_dwordx4 v16, s[16:19], s54 offen offset:0 nt lds
 buffer_load_dwordx4 v17, s[16:19], s54 offen offset:1024 nt lds
 buffer_load_dwordx4 v18, s[16:19], s54 offen offset:2048 nt lds
 buffer_load_dwordx4 v19, s[16:19], s54 offen offset:3072 nt lds
 s_waitcnt vmcnt(28)
 s_mov_b32 m0, 0x1e000
 s_mov_b32 s54, 0x18100
 buffer_load_dwordx4 v28, s[12:15], s54 offen offset:0 nt lds
 buffer_load_dwordx4 v29, s[12:15], s54 offen offset:1024 nt lds
 buffer_load_dwordx4 v30, s[12:15], s54 offen offset:2048 nt lds
 buffer_load_dwordx4 v31, s[12:15], s54 offen offset:3072 nt lds
 s_waitcnt vmcnt(28)
 s_mov_b32 m0, 0x1c000
 s_mov_b32 s54, 0x14100
 buffer_load_dwordx4 v16, s[16:19], s54 offen offset:0 nt lds
 buffer_load_dwordx4 v17, s[16:19], s54 offen offset:1024 nt lds
 buffer_load_dwordx4 v18, s[16:19], s54 offen offset:2048 nt lds
 buffer_load_dwordx4 v19, s[16:19], s54 offen offset:3072 nt lds
 s_waitcnt vmcnt(28)
 s_mov_b32 m0, 0x1f000
 s_mov_b32 s54, 0x18180
 buffer_load_dwordx4 v28, s[12:15], s54 offen offset:0 nt lds
 buffer_load_dwordx4 v29, s[12:15], s54 offen offset:1024 nt lds
 buffer_load_dwordx4 v30, s[12:15], s54 offen offset:2048 nt lds
 buffer_load_dwordx4 v31, s[12:15], s54 offen offset:3072 nt lds
 s_mov_b32 m0, 0x27c00
 s_movk_i32 s70, 272
 buffer_load_dword off, s[72:75], s70 lds
 s_waitcnt vmcnt(28)
 s_mov_b32 m0, 0x1d000
 s_mov_b32 s54, 0x14180
 buffer_load_dwordx4 v16, s[16:19], s54 offen offset:0 nt lds
 buffer_load_dwordx4 v17, s[16:19], s54 offen offset:1024 nt lds
 buffer_load_dwordx4 v18, s[16:19], s54 offen offset:2048 nt lds
 buffer_load_dwordx4 v19, s[16:19], s54 offen offset:3072 nt lds
 s_mov_b32 m0, 0x27c00
 s_movk_i32 s70, 276
 buffer_load_dword off, s[72:75], s70 lds
 s_waitcnt vmcnt(28)
 s_mov_b32 m0, 0x0
 s_mov_b32 s54, 0x80280
 buffer_load_dwordx4 v20, s[20:23], s54 offen offset:0 lds
 buffer_load_dwordx4 v21, s[20:23], s54 offen offset:1024 lds
 buffer_load_dwordx4 v22, s[20:23], s54 offen offset:2048 lds
 buffer_load_dwordx4 v23, s[20:23], s54 offen offset:3072 lds
 s_waitcnt vmcnt(28)
 s_mov_b32 m0, 0x1000
 s_mov_b32 s54, 0xc0280
 buffer_load_dwordx4 v20, s[20:23], s54 offen offset:0 lds
 buffer_load_dwordx4 v21, s[20:23], s54 offen offset:1024 lds
 buffer_load_dwordx4 v22, s[20:23], s54 offen offset:2048 lds
 buffer_load_dwordx4 v23, s[20:23], s54 offen offset:3072 lds
 s_mov_b32 m0, 0x27c00
 s_movk_i32 s70, 280
 buffer_load_dword off, s[72:75], s70 lds
 s_cmpk_ge_u32 s52, 51
 s_cbranch_scc0 L_ls67
L_lb67:
 s_waitcnt vmcnt(28)
 s_mov_b32 m0, 0x2000
 s_mov_b32 s54, 0x100280
 buffer_load_dwordx4 v20, s[20:23], s54 offen offset:0 lds
 buffer_load_dwordx4 v21, s[20:23], s54 offen offset:1024 lds
 buffer_load_dwordx4 v22, s[20:23], s54 offen offset:2048 lds
 buffer_load_dwordx4 v23, s[20:23], s54 offen offset:3072 lds
 s_waitcnt vmcnt(28)
 s_mov_b32 m0, 0x3000
 s_mov_b32 s54, 0x140280
 buffer_load_dwordx4 v20, s[20:23], s54 offen offset:0 lds
 buffer_load_dwordx4 v21, s[20:23], s54 offen offset:1024 lds
 buffer_load_dwordx4 v22, s[20:23], s54 offen offset:2048 lds
 buffer_load_dwordx4 v23, s[20:23], s54 offen offset:3072 lds
 s_sub_u32 s34, s4, s6
 s_lshl_b32 s34, s34, 3
 s_add_u32 s34, s34, s6
 s_mul_i32 s34, s34, 86016
 s_add_u32 s76, s46, s34
 s_addc_u32 s77, s47, 0
 s_and_b32 s77, s77, 0xffff
 s_mov_b32 s78, 0x1275000
 s_mov_b32 s79, 0x20000
 s_lshl_b32 s34, s4, 12
 s_add_u32 s34, s34, 33554432
 s_add_u32 s80, s46, s34
 s_addc_u32 s81, s47, 0
 s_and_b32 s81, s81, 0xffff
 s_mov_b32 s82, 0x1000
 s_mov_b32 s83, 0x20000
 s_lshl_b32 s53, s5, 9
 s_mul_i32 s34, s4, 86016
 s_add_u32 s84, s64, s34
 s_addc_u32 s85, s65, 0
 s_and_b32 s85, s85, 0xffff
 s_mov_b32 s86, 0x15000
 s_mov_b32 s87, 0x20000
 s_lshl_b32 s34, s4, 3
 s_add_u32 s88, s66, s34
 s_addc_u32 s89, s67, 0
 s_and_b32 s89, s89, 0xffff
 s_mov_b32 s90, 0x4
 s_mov_b32 s91, 0x20000
 v_lshrrev_b32 v48, 4, v13
 s_mul_i32 s44, s5, 3
 s_add_u32 s44, s44, 0
 s_lshl_b32 s38, s44, 10
 s_cmp_ge_u32 s44, 12
 s_cselect_b32 s41, 128, 0
 s_cselect_b32 s45, 12, 0
 s_sub_u32 s44, s44, s45
 s_lshr_b32 s45, s44, 2
 s_mul_i32 s45, s45, 28672
 s_add_u32 s41, s41, s45
 s_and_b32 s45, s44, 1
 s_mul_i32 s45, s45, 14336
 s_add_u32 s41, s41, s45
 s_and_b32 s45, s44, 2
 s_lshl_b32 s45, s45, 5
 s_add_u32 s41, s41, s45
 s_mul_i32 s44, s5, 3
 s_add_u32 s44, s44, 1
 s_lshl_b32 s39, s44, 10
 s_cmp_ge_u32 s44, 12
 s_cselect_b32 s42, 128, 0
 s_cselect_b32 s45, 12, 0
 s_sub_u32 s44, s44, s45
 s_lshr_b32 s45, s44, 2
 s_mul_i32 s45, s45, 28672
 s_add_u32 s42, s42, s45
 s_and_b32 s45, s44, 1
 s_mul_i32 s45, s45, 14336
 s_add_u32 s42, s42, s45
 s_and_b32 s45, s44, 2
 s_lshl_b32 s45, s45, 5
 s_add_u32 s42, s42, s45
 s_mul_i32 s44, s5, 3
 s_add_u32 s44, s44, 2
 s_lshl_b32 s40, s44, 10
 s_cmp_ge_u32 s44, 12
 s_cselect_b32 s43, 128, 0
 s_cselect_b32 s45, 12, 0
 s_sub_u32 s44, s44, s45
 s_lshr_b32 s45, s44, 2
 s_mul_i32 s45, s45, 28672
 s_add_u32 s43, s43, s45
 s_and_b32 s45, s44, 1
 s_mul_i32 s45, s45, 14336
 s_add_u32 s43, s43, s45
 s_and_b32 s45, s44, 2
 s_lshl_b32 s45, s45, 5
 s_add_u32 s43, s43, s45
 v_and_b32 v58, 15, v48
 v_mul_u32_u24 v50, 896, v58
 v_lshrrev_b32 v58, 4, v48
 v_lshl_add_u32 v50, v58, 3, v50
 v_lshlrev_b32 v49, 2, v48
 s_mov_b32 s56, 0xffff0000
 s_waitcnt vmcnt(28)
 s_mov_b32 m0, 0x20000
 s_mov_b32 s54, 0x1c000
 buffer_load_dwordx4 v28, s[12:15], s54 offen offset:0 nt lds
 buffer_load_dwordx4 v29, s[12:15], s54 offen offset:1024 nt lds
 buffer_load_dwordx4 v30, s[12:15], s54 offen offset:2048 nt lds
 buffer_load_dwordx4 v31, s[12:15], s54 offen offset:3072 nt lds
 s_waitcnt vmcnt(28)
 s_mov_b32 m0, 0x22000
 s_mov_b32 s54, 0x18000
 buffer_load_dwordx4 v16, s[16:19], s54 offen offset:0 nt lds
 buffer_load_dwordx4 v17, s[16:19], s54 offen offset:1024 nt lds
 buffer_load_dwordx4 v18, s[16:19], s54 offen offset:2048 nt lds
 buffer_load_dwordx4 v19, s[16:19], s54 offen offset:3072 nt lds
 s_waitcnt vmcnt(28)
 s_mov_b32 m0, 0x21000
 s_mov_b32 s54, 0x1c080
 buffer_load_dwordx4 v28, s[12:15], s54 offen offset:0 nt lds
 buffer_load_dwordx4 v29, s[12:15], s54 offen offset:1024 nt lds
 buffer_load_dwordx4 v30, s[12:15], s54 offen offset:2048 nt lds
 buffer_load_dwordx4 v31, s[12:15], s54 offen offset:3072 nt lds
 s_waitcnt vmcnt(28)
 s_mov_b32 m0, 0x23000
 s_mov_b32 s54, 0x18080
 buffer_load_dwordx4 v16, s[16:19], s54 offen offset:0 nt lds
 buffer_load_dwordx4 v17, s[16:19], s54 offen offset:1024 nt lds
 buffer_load_dwordx4 v18, s[16:19], s54 offen offset:2048 nt lds
 buffer_load_dwordx4 v19, s[16:19], s54 offen offset:3072 nt lds
 s_waitcnt vmcnt(28)
 s_mov_b32 m0, 0x12000
 s_mov_b32 s54, 0x1c100
 buffer_load_dwordx4 v28, s[12:15], s54 offen offset:0 nt lds
 buffer_load_dwordx4 v29, s[12:15], s54 offen offset:1024 nt lds
 buffer_load_dwordx4 v30, s[12:15], s54 offen offset:2048 nt lds
 buffer_load_dwordx4 v31, s[12:15], s54 offen offset:3072 nt lds
 s_waitcnt vmcnt(28)
 s_mov_b32 m0, 0x24000
 s_mov_b32 s54, 0x18100
 buffer_load_dwordx4 v16, s[16:19], s54 offen offset:0 nt lds
 buffer_load_dwordx4 v17, s[16:19], s54 offen offset:1024 nt lds
 buffer_load_dwordx4 v18, s[16:19], s54 offen offset:2048 nt lds
 buffer_load_dwordx4 v19, s[16:19], s54 offen offset:3072 nt lds
 s_waitcnt vmcnt(28)
 s_mov_b32 m0, 0x13000
 s_mov_b32 s54, 0x1c180
 buffer_load_dwordx4 v28, s[12:15], s54 offen offset:0 nt lds
 buffer_load_dwordx4 v29, s[12:15], s54 offen offset:1024 nt lds
 buffer_load_dwordx4 v30, s[12:15], s54 offen offset:2048 nt lds
 buffer_load_dwordx4 v31, s[12:15], s54 offen offset:3072 nt lds
 s_mov_b32 m0, 0x27c00
 s_movk_i32 s70, 296
 buffer_load_dword off, s[72:75], s70 lds
 s_waitcnt vmcnt(28)
 s_mov_b32 m0, 0x25000
 s_mov_b32 s54, 0x18180
 buffer_load_dwordx4 v16, s[16:19], s54 offen offset:0 nt lds
 buffer_load_dwordx4 v17, s[16:19], s54 offen offset:1024 nt lds
 buffer_load_dwordx4 v18, s[16:19], s54 offen offset:2048 nt lds
 buffer_load_dwordx4 v19, s[16:19], s54 offen offset:3072 nt lds
 s_mov_b32 m0, 0x27c00
 s_movk_i32 s70, 300
 buffer_load_dword off, s[72:75], s70 lds
 s_waitcnt vmcnt(28)
 s_mov_b32 m0, 0x4000
 s_mov_b32 s54, 0x180280
 buffer_load_dwordx4 v20, s[20:23], s54 offen offset:0 lds
 buffer_load_dwordx4 v21, s[20:23], s54 offen offset:1024 lds
 buffer_load_dwordx4 v22, s[20:23], s54 offen offset:2048 lds
 buffer_load_dwordx4 v23, s[20:23], s54 offen offset:3072 lds
 s_waitcnt vmcnt(28)
 s_mov_b32 m0, 0x5000
 s_mov_b32 s54, 0x1c0280
 buffer_load_dwordx4 v20, s[20:23], s54 offen offset:0 lds
 buffer_load_dwordx4 v21, s[20:23], s54 offen offset:1024 lds
 buffer_load_dwordx4 v22, s[20:23], s54 offen offset:2048 lds
 buffer_load_dwordx4 v23, s[20:23], s54 offen offset:3072 lds
 s_mov_b32 m0, 0x27c00
 s_movk_i32 s70, 304
 buffer_load_dword off, s[72:75], s70 lds
 s_cmpk_ge_u32 s52, 57
 s_cbranch_scc0 L_ls73
L_lb73:
 s_waitcnt vmcnt(28)
 s_mov_b32 m0, 0x6000
 s_mov_b32 s54, 0x200280
 buffer_load_dwordx4 v20, s[20:23], s54 offen offset:0 lds
 buffer_load_dwordx4 v21, s[20:23], s54 offen offset:1024 lds
 buffer_load_dwordx4 v22, s[20:23], s54 offen offset:2048 lds
 buffer_load_dwordx4 v23, s[20:23], s54 offen offset:3072 lds
 s_waitcnt vmcnt(28)
 s_mov_b32 m0, 0x7000
 s_mov_b32 s54, 0x240280
 buffer_load_dwordx4 v20, s[20:23], s54 offen offset:0 lds
 buffer_load_dwordx4 v21, s[20:23], s54 offen offset:1024 lds
 buffer_load_dwordx4 v22, s[20:23], s54 offen offset:2048 lds
 buffer_load_dwordx4 v23, s[20:23], s54 offen offset:3072 lds
 s_waitcnt vmcnt(28)
 s_mov_b32 m0, 0x10000
 s_mov_b32 s54, 0x20000
 buffer_load_dwordx4 v28, s[12:15], s54 offen offset:0 nt lds
 buffer_load_dwordx4 v29, s[12:15], s54 offen offset:1024 nt lds
 buffer_load_dwordx4 v30, s[12:15], s54 offen offset:2048 nt lds
 buffer_load_dwordx4 v31, s[12:15], s54 offen offset:3072 nt lds
 s_waitcnt vmcnt(28)
 s_mov_b32 m0, 0x14000
 s_mov_b32 s54, 0x1c000
 buffer_load_dwordx4 v16, s[16:19], s54 offen offset:0 nt lds
 buffer_load_dwordx4 v17, s[16:19], s54 offen offset:1024 nt lds
 buffer_load_dwordx4 v18, s[16:19], s54 offen offset:2048 nt lds
 buffer_load_dwordx4 v19, s[16:19], s54 offen offset:3072 nt lds
 s_waitcnt vmcnt(28)
 s_mov_b32 m0, 0x11000
 s_mov_b32 s54, 0x20080
 buffer_load_dwordx4 v28, s[12:15], s54 offen offset:0 nt lds
 buffer_load_dwordx4 v29, s[12:15], s54 offen offset:1024 nt lds
 buffer_load_dwordx4 v30, s[12:15], s54 offen offset:2048 nt lds
 buffer_load_dwordx4 v31, s[12:15], s54 offen offset:3072 nt lds
 s_waitcnt vmcnt(28)
 s_mov_b32 m0, 0x15000
 s_mov_b32 s54, 0x1c080
 buffer_load_dwordx4 v16, s[16:19], s54 offen offset:0 nt lds
 buffer_load_dwordx4 v17, s[16:19], s54 offen offset:1024 nt lds
 buffer_load_dwordx4 v18, s[16:19], s54 offen offset:2048 nt lds
 buffer_load_dwordx4 v19, s[16:19], s54 offen offset:3072 nt lds
 s_waitcnt vmcnt(28)
 s_mov_b32 m0, 0xe000
 s_mov_b32 s54, 0x20100
 buffer_load_dwordx4 v28, s[12:15], s54 offen offset:0 nt lds
 buffer_load_dwordx4 v29, s[12:15], s54 offen offset:1024 nt lds
 buffer_load_dwordx4 v30, s[12:15], s54 offen offset:2048 nt lds
 buffer_load_dwordx4 v31, s[12:15], s54 offen offset:3072 nt lds
 s_waitcnt vmcnt(28)
 s_mov_b32 m0, 0x16000
 s_mov_b32 s54, 0x1c100
 buffer_load_dwordx4 v16, s[16:19], s54 offen offset:0 nt lds
 buffer_load_dwordx4 v17, s[16:19], s54 offen offset:1024 nt lds
 buffer_load_dwordx4 v18, s[16:19], s54 offen offset:2048 nt lds
 buffer_load_dwordx4 v19, s[16:19], s54 offen offset:3072 nt lds
 s_waitcnt vmcnt(28)
 s_mov_b32 m0, 0xf000
 s_mov_b32 s54, 0x20180
 buffer_load_dwordx4 v28, s[12:15], s54 offen offset:0 nt lds
 buffer_load_dwordx4 v29, s[12:15], s54 offen offset:1024 nt lds
 buffer_load_dwordx4 v30, s[12:15], s54 offen offset:2048 nt lds
 buffer_load_dwordx4 v31, s[12:15], s54 offen offset:3072 nt lds
 s_mov_b32 m0, 0x27c00
 s_movk_i32 s70, 320
 buffer_load_dword off, s[72:75], s70 lds
 s_waitcnt vmcnt(28)
 s_mov_b32 m0, 0x17000
 s_mov_b32 s54, 0x1c180
 buffer_load_dwordx4 v16, s[16:19], s54 offen offset:0 nt lds
 buffer_load_dwordx4 v17, s[16:19], s54 offen offset:1024 nt lds
 buffer_load_dwordx4 v18, s[16:19], s54 offen offset:2048 nt lds
 buffer_load_dwordx4 v19, s[16:19], s54 offen offset:3072 nt lds
 s_mov_b32 m0, 0x27c00
 s_movk_i32 s70, 324
 buffer_load_dword off, s[72:75], s70 lds
 s_waitcnt vmcnt(28)
 s_mov_b32 m0, 0xa000
 s_mov_b32 s54, 0x280280
 buffer_load_dwordx4 v20, s[20:23], s54 offen offset:0 lds
 buffer_load_dwordx4 v21, s[20:23], s54 offen offset:1024 lds
 buffer_load_dwordx4 v22, s[20:23], s54 offen offset:2048 lds
 buffer_load_dwordx4 v23, s[20:23], s54 offen offset:3072 lds
 s_waitcnt vmcnt(28)
 s_mov_b32 m0, 0xb000
 s_mov_b32 s54, 0x2c0280
 buffer_load_dwordx4 v20, s[20:23], s54 offen offset:0 lds
 buffer_load_dwordx4 v21, s[20:23], s54 offen offset:1024 lds
 buffer_load_dwordx4 v22, s[20:23], s54 offen offset:2048 lds
 buffer_load_dwordx4 v23, s[20:23], s54 offen offset:3072 lds
 s_cmpk_ge_u32 s52, 63
 s_cbranch_scc0 L_ls75
L_lb75:
 s_waitcnt vmcnt(28)
 s_mov_b32 m0, 0x8000
 s_mov_b32 s54, 0x300280
 buffer_load_dwordx4 v20, s[20:23], s54 offen offset:0 lds
 buffer_load_dwordx4 v21, s[20:23], s54 offen offset:1024 lds
 buffer_load_dwordx4 v22, s[20:23], s54 offen offset:2048 lds
 buffer_load_dwordx4 v23, s[20:23], s54 offen offset:3072 lds
 s_waitcnt vmcnt(28)
 s_mov_b32 m0, 0x9000
 s_mov_b32 s54, 0x340280
 buffer_load_dwordx4 v20, s[20:23], s54 offen offset:0 lds
 buffer_load_dwordx4 v21, s[20:23], s54 offen offset:1024 lds
 buffer_load_dwordx4 v22, s[20:23], s54 offen offset:2048 lds
 buffer_load_dwordx4 v23, s[20:23], s54 offen offset:3072 lds
 s_mov_b32 m0, 0x27c00
 s_movk_i32 s70, 332
 buffer_load_dword off, s[72:75], s70 lds
 s_waitcnt vmcnt(28)
 s_mov_b32 m0, 0xc000
 s_mov_b32 s54, 0x24000
 buffer_load_dwordx4 v28, s[12:15], s54 offen offset:0 nt lds
 buffer_load_dwordx4 v29, s[12:15], s54 offen offset:1024 nt lds
 buffer_load_dwordx4 v30, s[12:15], s54 offen offset:2048 nt lds
 buffer_load_dwordx4 v31, s[12:15], s54 offen offset:3072 nt lds
 s_waitcnt vmcnt(28)
 s_mov_b32 m0, 0x18000
 s_mov_b32 s54, 0x20000
 buffer_load_dwordx4 v16, s[16:19], s54 offen offset:0 nt lds
 buffer_load_dwordx4 v17, s[16:19], s54 offen offset:1024 nt lds
 buffer_load_dwordx4 v18, s[16:19], s54 offen offset:2048 nt lds
 buffer_load_dwordx4 v19, s[16:19], s54 offen offset:3072 nt lds
 s_waitcnt vmcnt(28)
 s_mov_b32 m0, 0xd000
 s_mov_b32 s54, 0x24080
 buffer_load_dwordx4 v28, s[12:15], s54 offen offset:0 nt lds
 buffer_load_dwordx4 v29, s[12:15], s54 offen offset:1024 nt lds
 buffer_load_dwordx4 v30, s[12:15], s54 offen offset:2048 nt lds
 buffer_load_dwordx4 v31, s[12:15], s54 offen offset:3072 nt lds
 s_waitcnt vmcnt(28)
 s_mov_b32 m0, 0x19000
 s_mov_b32 s54, 0x20080
 buffer_load_dwordx4 v16, s[16:19], s54 offen offset:0 nt lds
 buffer_load_dwordx4 v17, s[16:19], s54 offen offset:1024 nt lds
 buffer_load_dwordx4 v18, s[16:19], s54 offen offset:2048 nt lds
 buffer_load_dwordx4 v19, s[16:19], s54 offen offset:3072 nt lds
 s_waitcnt vmcnt(28)
 s_mov_b32 m0, 0x1e000
 s_mov_b32 s54, 0x24100
 buffer_load_dwordx4 v28, s[12:15], s54 offen offset:0 nt lds
 buffer_load_dwordx4 v29, s[12:15], s54 offen offset:1024 nt lds
 buffer_load_dwordx4 v30, s[12:15], s54 offen offset:2048 nt lds
 buffer_load_dwordx4 v31, s[12:15], s54 offen offset:3072 nt lds
 s_waitcnt vmcnt(28)
 s_mov_b32 m0, 0x1a000
 s_mov_b32 s54, 0x20100
 buffer_load_dwordx4 v16, s[16:19], s54 offen offset:0 nt lds
 buffer_load_dwordx4 v17, s[16:19], s54 offen offset:1024 nt lds
 buffer_load_dwordx4 v18, s[16:19], s54 offen offset:2048 nt lds
 buffer_load_dwordx4 v19, s[16:19], s54 offen offset:3072 nt lds
 s_waitcnt vmcnt(28)
 s_mov_b32 m0, 0x1f000
 s_mov_b32 s54, 0x24180
 buffer_load_dwordx4 v28, s[12:15], s54 offen offset:0 nt lds
 buffer_load_dwordx4 v29, s[12:15], s54 offen offset:1024 nt lds
 buffer_load_dwordx4 v30, s[12:15], s54 offen offset:2048 nt lds
 buffer_load_dwordx4 v31, s[12:15], s54 offen offset:3072 nt lds
 s_mov_b32 m0, 0x27c00
 s_movk_i32 s70, 344
 buffer_load_dword off, s[72:75], s70 lds
 s_waitcnt vmcnt(28)
 s_mov_b32 m0, 0x1b000
 s_mov_b32 s54, 0x20180
 buffer_load_dwordx4 v16, s[16:19], s54 offen offset:0 nt lds
 buffer_load_dwordx4 v17, s[16:19], s54 offen offset:1024 nt lds
 buffer_load_dwordx4 v18, s[16:19], s54 offen offset:2048 nt lds
 buffer_load_dwordx4 v19, s[16:19], s54 offen offset:3072 nt lds
 s_mov_b32 m0, 0x27c00
 s_movk_i32 s70, 348
 buffer_load_dword off, s[72:75], s70 lds
 s_waitcnt vmcnt(28)
 s_mov_b32 m0, 0x0
 s_mov_b32 s54, 0x300
 buffer_load_dwordx4 v20, s[20:23], s54 offen offset:0 lds
 buffer_load_dwordx4 v21, s[20:23], s54 offen offset:1024 lds
 buffer_load_dwordx4 v22, s[20:23], s54 offen offset:2048 lds
 buffer_load_dwordx4 v23, s[20:23], s54 offen offset:3072 lds
 s_waitcnt vmcnt(28)
 s_mov_b32 m0, 0x1000
 s_mov_b32 s54, 0x40300
 buffer_load_dwordx4 v20, s[20:23], s54 offen offset:0 lds
 buffer_load_dwordx4 v21, s[20:23], s54 offen offset:1024 lds
 buffer_load_dwordx4 v22, s[20:23], s54 offen offset:2048 lds
 buffer_load_dwordx4 v23, s[20:23], s54 offen offset:3072 lds
 s_cmpk_ge_u32 s52, 69
 s_cbranch_scc0 L_ls81
L_lb81:
 s_waitcnt vmcnt(28)
 s_mov_b32 m0, 0x2000
 s_mov_b32 s54, 0x80300
 buffer_load_dwordx4 v20, s[20:23], s54 offen offset:0 lds
 buffer_load_dwordx4 v21, s[20:23], s54 offen offset:1024 lds
 buffer_load_dwordx4 v22, s[20:23], s54 offen offset:2048 lds
 buffer_load_dwordx4 v23, s[20:23], s54 offen offset:3072 lds
 s_waitcnt vmcnt(28)
 s_mov_b32 m0, 0x3000
 s_mov_b32 s54, 0xc0300
 buffer_load_dwordx4 v20, s[20:23], s54 offen offset:0 lds
 buffer_load_dwordx4 v21, s[20:23], s54 offen offset:1024 lds
 buffer_load_dwordx4 v22, s[20:23], s54 offen offset:2048 lds
 buffer_load_dwordx4 v23, s[20:23], s54 offen offset:3072 lds
 s_mov_b32 m0, 0x27c00
 s_movk_i32 s70, 356
 buffer_load_dword off, s[72:75], s70 lds
 s_waitcnt vmcnt(28)
 s_mov_b32 m0, 0x1c000
 s_mov_b32 s54, 0x28000
 buffer_load_dwordx4 v28, s[12:15], s54 offen offset:0 nt lds
 buffer_load_dwordx4 v29, s[12:15], s54 offen offset:1024 nt lds
 buffer_load_dwordx4 v30, s[12:15], s54 offen offset:2048 nt lds
 buffer_load_dwordx4 v31, s[12:15], s54 offen offset:3072 nt lds
 s_waitcnt vmcnt(28)
 s_mov_b32 m0, 0x20000
 s_mov_b32 s54, 0x24000
 buffer_load_dwordx4 v16, s[16:19], s54 offen offset:0 nt lds
 buffer_load_dwordx4 v17, s[16:19], s54 offen offset:1024 nt lds
 buffer_load_dwordx4 v18, s[16:19], s54 offen offset:2048 nt lds
 buffer_load_dwordx4 v19, s[16:19], s54 offen offset:3072 nt lds
 s_waitcnt vmcnt(28)
 s_mov_b32 m0, 0x1d000
 s_mov_b32 s54, 0x28080
 buffer_load_dwordx4 v28, s[12:15], s54 offen offset:0 nt lds
 buffer_load_dwordx4 v29, s[12:15], s54 offen offset:1024 nt lds
 buffer_load_dwordx4 v30, s[12:15], s54 offen offset:2048 nt lds
 buffer_load_dwordx4 v31, s[12:15], s54 offen offset:3072 nt lds
 s_waitcnt vmcnt(28)
 s_mov_b32 m0, 0x21000
 s_mov_b32 s54, 0x24080
 buffer_load_dwordx4 v16, s[16:19], s54 offen offset:0 nt lds
 buffer_load_dwordx4 v17, s[16:19], s54 offen offset:1024 nt lds
 buffer_load_dwordx4 v18, s[16:19], s54 offen offset:2048 nt lds
 buffer_load_dwordx4 v19, s[16:19], s54 offen offset:3072 nt lds
 s_waitcnt vmcnt(28)
 s_mov_b32 m0, 0x12000
 s_mov_b32 s54, 0x28100
 buffer_load_dwordx4 v28, s[12:15], s54 offen offset:0 nt lds
 buffer_load_dwordx4 v29, s[12:15], s54 offen offset:1024 nt lds
 buffer_load_dwordx4 v30, s[12:15], s54 offen offset:2048 nt lds
 buffer_load_dwordx4 v31, s[12:15], s54 offen offset:3072 nt lds
 s_waitcnt vmcnt(28)
 s_mov_b32 m0, 0x22000
 s_mov_b32 s54, 0x24100
 buffer_load_dwordx4 v16, s[16:19], s54 offen offset:0 nt lds
 buffer_load_dwordx4 v17, s[16:19], s54 offen offset:1024 nt lds
 buffer_load_dwordx4 v18, s[16:19], s54 offen offset:2048 nt lds
 buffer_load_dwordx4 v19, s[16:19], s54 offen offset:3072 nt lds
 s_waitcnt vmcnt(28)
 s_mov_b32 m0, 0x13000
 s_mov_b32 s54, 0x28180
 buffer_load_dwordx4 v28, s[12:15], s54 offen offset:0 nt lds
 buffer_load_dwordx4 v29, s[12:15], s54 offen offset:1024 nt lds
 buffer_load_dwordx4 v30, s[12:15], s54 offen offset:2048 nt lds
 buffer_load_dwordx4 v31, s[12:15], s54 offen offset:3072 nt lds
 s_mov_b32 m0, 0x27c00
 s_movk_i32 s70, 368
 buffer_load_dword off, s[72:75], s70 lds
 s_waitcnt vmcnt(28)
 s_mov_b32 m0, 0x23000
 s_mov_b32 s54, 0x24180
 buffer_load_dwordx4 v16, s[16:19], s54 offen offset:0 nt lds
 buffer_load_dwordx4 v17, s[16:19], s54 offen offset:1024 nt lds
 buffer_load_dwordx4 v18, s[16:19], s54 offen offset:2048 nt lds
 buffer_load_dwordx4 v19, s[16:19], s54 offen offset:3072 nt lds
 s_mov_b32 m0, 0x27c00
 s_movk_i32 s70, 372
 buffer_load_dword off, s[72:75], s70 lds
 s_waitcnt vmcnt(28)
 s_mov_b32 m0, 0x4000
 s_mov_b32 s54, 0x100300
 buffer_load_dwordx4 v20, s[20:23], s54 offen offset:0 lds
 buffer_load_dwordx4 v21, s[20:23], s54 offen offset:1024 lds
 buffer_load_dwordx4 v22, s[20:23], s54 offen offset:2048 lds
 buffer_load_dwordx4 v23, s[20:23], s54 offen offset:3072 lds
 s_waitcnt vmcnt(28)
 s_mov_b32 m0, 0x5000
 s_mov_b32 s54, 0x140300
 buffer_load_dwordx4 v20, s[20:23], s54 offen offset:0 lds
 buffer_load_dwordx4 v21, s[20:23], s54 offen offset:1024 lds
 buffer_load_dwordx4 v22, s[20:23], s54 offen offset:2048 lds
 buffer_load_dwordx4 v23, s[20:23], s54 offen offset:3072 lds
 s_cmpk_ge_u32 s52, 75
 s_cbranch_scc0 L_ls87
L_lb87:
 s_waitcnt vmcnt(28)
 s_mov_b32 m0, 0x6000
 s_mov_b32 s54, 0x180300
 buffer_load_dwordx4 v20, s[20:23], s54 offen offset:0 lds
 buffer_load_dwordx4 v21, s[20:23], s54 offen offset:1024 lds
 buffer_load_dwordx4 v22, s[20:23], s54 offen offset:2048 lds
 buffer_load_dwordx4 v23, s[20:23], s54 offen offset:3072 lds
 s_waitcnt vmcnt(28)
 s_mov_b32 m0, 0x7000
 s_mov_b32 s54, 0x1c0300
 buffer_load_dwordx4 v20, s[20:23], s54 offen offset:0 lds
 buffer_load_dwordx4 v21, s[20:23], s54 offen offset:1024 lds
 buffer_load_dwordx4 v22, s[20:23], s54 offen offset:2048 lds
 buffer_load_dwordx4 v23, s[20:23], s54 offen offset:3072 lds
 s_mov_b32 m0, 0x27c00
 s_movk_i32 s70, 380
 buffer_load_dword off, s[72:75], s70 lds
 s_waitcnt vmcnt(28)
 s_mov_b32 m0, 0x24000
 s_mov_b32 s54, 0x2c000
 buffer_load_dwordx4 v28, s[12:15], s54 offen offset:0 nt lds
 buffer_load_dwordx4 v29, s[12:15], s54 offen offset:1024 nt lds
 buffer_load_dwordx4 v30, s[12:15], s54 offen offset:2048 nt lds
 buffer_load_dwordx4 v31, s[12:15], s54 offen offset:3072 nt lds
 s_waitcnt vmcnt(28)
 s_mov_b32 m0, 0x10000
 s_mov_b32 s54, 0x28000
 buffer_load_dwordx4 v16, s[16:19], s54 offen offset:0 nt lds
 buffer_load_dwordx4 v17, s[16:19], s54 offen offset:1024 nt lds
 buffer_load_dwordx4 v18, s[16:19], s54 offen offset:2048 nt lds
 buffer_load_dwordx4 v19, s[16:19], s54 offen offset:3072 nt lds
 s_waitcnt vmcnt(28)
 s_mov_b32 m0, 0x25000
 s_mov_b32 s54, 0x2c080
 buffer_load_dwordx4 v28, s[12:15], s54 offen offset:0 nt lds
 buffer_load_dwordx4 v29, s[12:15], s54 offen offset:1024 nt lds
 buffer_load_dwordx4 v30, s[12:15], s54 offen offset:2048 nt lds
 buffer_load_dwordx4 v31, s[12:15], s54 offen offset:3072 nt lds
 s_waitcnt vmcnt(28)
 s_mov_b32 m0, 0x11000
 s_mov_b32 s54, 0x28080
 buffer_load_dwordx4 v16, s[16:19], s54 offen offset:0 nt lds
 buffer_load_dwordx4 v17, s[16:19], s54 offen offset:1024 nt lds
 buffer_load_dwordx4 v18, s[16:19], s54 offen offset:2048 nt lds
 buffer_load_dwordx4 v19, s[16:19], s54 offen offset:3072 nt lds
 s_waitcnt vmcnt(28)
 s_mov_b32 m0, 0xe000
 s_mov_b32 s54, 0x2c100
 buffer_load_dwordx4 v28, s[12:15], s54 offen offset:0 nt lds
 buffer_load_dwordx4 v29, s[12:15], s54 offen offset:1024 nt lds
 buffer_load_dwordx4 v30, s[12:15], s54 offen offset:2048 nt lds
 buffer_load_dwordx4 v31, s[12:15], s54 offen offset:3072 nt lds
 s_waitcnt vmcnt(28)
 s_mov_b32 m0, 0x14000
 s_mov_b32 s54, 0x28100
 buffer_load_dwordx4 v16, s[16:19], s54 offen offset:0 nt lds
 buffer_load_dwordx4 v17, s[16:19], s54 offen offset:1024 nt lds
 buffer_load_dwordx4 v18, s[16:19], s54 offen offset:2048 nt lds
 buffer_load_dwordx4 v19, s[16:19], s54 offen offset:3072 nt lds
 s_waitcnt vmcnt(28)
 s_mov_b32 m0, 0xf000
 s_mov_b32 s54, 0x2c180
 buffer_load_dwordx4 v28, s[12:15], s54 offen offset:0 nt lds
 buffer_load_dwordx4 v29, s[12:15], s54 offen offset:1024 nt lds
 buffer_load_dwordx4 v30, s[12:15], s54 offen offset:2048 nt lds
 buffer_load_dwordx4 v31, s[12:15], s54 offen offset:3072 nt lds
 s_mov_b32 m0, 0x27c00
 s_movk_i32 s70, 392
 buffer_load_dword off, s[72:75], s70 lds
 s_waitcnt vmcnt(28)
 s_mov_b32 m0, 0x15000
 s_mov_b32 s54, 0x28180
 buffer_load_dwordx4 v16, s[16:19], s54 offen offset:0 nt lds
 buffer_load_dwordx4 v17, s[16:19], s54 offen offset:1024 nt lds
 buffer_load_dwordx4 v18, s[16:19], s54 offen offset:2048 nt lds
 buffer_load_dwordx4 v19, s[16:19], s54 offen offset:3072 nt lds
 s_mov_b32 m0, 0x27c00
 s_movk_i32 s70, 396
 buffer_load_dword off, s[72:75], s70 lds
 s_waitcnt vmcnt(28)
 s_mov_b32 m0, 0xa000
 s_mov_b32 s54, 0x200300
 buffer_load_dwordx4 v20, s[20:23], s54 offen offset:0 lds
 buffer_load_dwordx4 v21, s[20:23], s54 offen offset:1024 lds
 buffer_load_dwordx4 v22, s[20:23], s54 offen offset:2048 lds
 buffer_load_dwordx4 v23, s[20:23], s54 offen offset:3072 lds
 s_waitcnt vmcnt(28)
 s_mov_b32 m0, 0xb000
 s_mov_b32 s54, 0x240300
 buffer_load_dwordx4 v20, s[20:23], s54 offen offset:0 lds
 buffer_load_dwordx4 v21, s[20:23], s54 offen offset:1024 lds
 buffer_load_dwordx4 v22, s[20:23], s54 offen offset:2048 lds
 buffer_load_dwordx4 v23, s[20:23], s54 offen offset:3072 lds
 s_cmpk_ge_u32 s52, 76
 s_cbranch_scc0 L_ls93
L_lb93:
 s_waitcnt vmcnt(28)
 s_mov_b32 m0, 0x8000
 s_mov_b32 s54, 0x280300
 buffer_load_dwordx4 v20, s[20:23], s54 offen offset:0 lds
 buffer_load_dwordx4 v21, s[20:23], s54 offen offset:1024 lds
 buffer_load_dwordx4 v22, s[20:23], s54 offen offset:2048 lds
 buffer_load_dwordx4 v23, s[20:23], s54 offen offset:3072 lds
 s_waitcnt vmcnt(28)
 s_mov_b32 m0, 0x9000
 s_mov_b32 s54, 0x2c0300
 buffer_load_dwordx4 v20, s[20:23], s54 offen offset:0 lds
 buffer_load_dwordx4 v21, s[20:23], s54 offen offset:1024 lds
 buffer_load_dwordx4 v22, s[20:23], s54 offen offset:2048 lds
 buffer_load_dwordx4 v23, s[20:23], s54 offen offset:3072 lds
 s_mov_b32 m0, 0x27c00
 s_movk_i32 s70, 404
 buffer_load_dword off, s[72:75], s70 lds
 s_cmpk_ge_u32 s52, 82
 s_cbranch_scc0 L_ls94
L_lb94:
 s_waitcnt vmcnt(28)
 s_mov_b32 m0, 0x0
 s_mov_b32 s54, 0x300300
 buffer_load_dwordx4 v20, s[20:23], s54 offen offset:0 lds
 buffer_load_dwordx4 v21, s[20:23], s54 offen offset:1024 lds
 buffer_load_dwordx4 v22, s[20:23], s54 offen offset:2048 lds
 buffer_load_dwordx4 v23, s[20:23], s54 offen offset:3072 lds
 s_waitcnt vmcnt(28)
 s_mov_b32 m0, 0x1000
 s_mov_b32 s54, 0x340300
 buffer_load_dwordx4 v20, s[20:23], s54 offen offset:0 lds
 buffer_load_dwordx4 v21, s[20:23], s54 offen offset:1024 lds
 buffer_load_dwordx4 v22, s[20:23], s54 offen offset:2048 lds
 buffer_load_dwordx4 v23, s[20:23], s54 offen offset:3072 lds
 s_mov_b32 m0, 0x27c00
 s_movk_i32 s70, 408
 buffer_load_dword off, s[72:75], s70 lds
 s_waitcnt vmcnt(28)
 s_mov_b32 m0, 0x2000
 s_mov_b32 s54, 0x380
 buffer_load_dwordx4 v20, s[20:23], s54 offen offset:0 lds
 buffer_load_dwordx4 v21, s[20:23], s54 offen offset:1024 lds
 buffer_load_dwordx4 v22, s[20:23], s54 offen offset:2048 lds
 buffer_load_dwordx4 v23, s[20:23], s54 offen offset:3072 lds
 s_waitcnt vmcnt(28)
 s_mov_b32 m0, 0x3000
 s_mov_b32 s54, 0x40380
 buffer_load_dwordx4 v20, s[20:23], s54 offen offset:0 lds
 buffer_load_dwordx4 v21, s[20:23], s54 offen offset:1024 lds
 buffer_load_dwordx4 v22, s[20:23], s54 offen offset:2048 lds
 buffer_load_dwordx4 v23, s[20:23], s54 offen offset:3072 lds
 s_waitcnt vmcnt(28)
 s_mov_b32 m0, 0x16000
 s_mov_b32 s54, 0x30000
 buffer_load_dwordx4 v28, s[12:15], s54 offen offset:0 nt lds
 buffer_load_dwordx4 v29, s[12:15], s54 offen offset:1024 nt lds
 buffer_load_dwordx4 v30, s[12:15], s54 offen offset:2048 nt lds
 buffer_load_dwordx4 v31, s[12:15], s54 offen offset:3072 nt lds
 s_waitcnt vmcnt(28)
 s_mov_b32 m0, 0xc000
 s_mov_b32 s54, 0x2c000
 buffer_load_dwordx4 v16, s[16:19], s54 offen offset:0 nt lds
 buffer_load_dwordx4 v17, s[16:19], s54 offen offset:1024 nt lds
 buffer_load_dwordx4 v18, s[16:19], s54 offen offset:2048 nt lds
 buffer_load_dwordx4 v19, s[16:19], s54 offen offset:3072 nt lds
 s_waitcnt vmcnt(28)
 s_mov_b32 m0, 0x17000
 s_mov_b32 s54, 0x30080
 buffer_load_dwordx4 v28, s[12:15], s54 offen offset:0 nt lds
 buffer_load_dwordx4 v29, s[12:15], s54 offen offset:1024 nt lds
 buffer_load_dwordx4 v30, s[12:15], s54 offen offset:2048 nt lds
 buffer_load_dwordx4 v31, s[12:15], s54 offen offset:3072 nt lds
 s_waitcnt vmcnt(28)
 s_mov_b32 m0, 0xd000
 s_mov_b32 s54, 0x2c080
 buffer_load_dwordx4 v16, s[16:19], s54 offen offset:0 nt lds
 buffer_load_dwordx4 v17, s[16:19], s54 offen offset:1024 nt lds
 buffer_load_dwordx4 v18, s[16:19], s54 offen offset:2048 nt lds
 buffer_load_dwordx4 v19, s[16:19], s54 offen offset:3072 nt lds
 s_waitcnt vmcnt(28)
 s_mov_b32 m0, 0x1e000
 s_mov_b32 s54, 0x30100
 buffer_load_dwordx4 v28, s[12:15], s54 offen offset:0 nt lds
 buffer_load_dwordx4 v29, s[12:15], s54 offen offset:1024 nt lds
 buffer_load_dwordx4 v30, s[12:15], s54 offen offset:2048 nt lds
 buffer_load_dwordx4 v31, s[12:15], s54 offen offset:3072 nt lds
 s_waitcnt vmcnt(28)
 s_mov_b32 m0, 0x18000
 s_mov_b32 s54, 0x2c100
 buffer_load_dwordx4 v16, s[16:19], s54 offen offset:0 nt lds
 buffer_load_dwordx4 v17, s[16:19], s54 offen offset:1024 nt lds
 buffer_load_dwordx4 v18, s[16:19], s54 offen offset:2048 nt lds
 buffer_load_dwordx4 v19, s[16:19], s54 offen offset:3072 nt lds
 s_waitcnt vmcnt(28)
 s_mov_b32 m0, 0x1f000
 s_mov_b32 s54, 0x30180
 buffer_load_dwordx4 v28, s[12:15], s54 offen offset:0 nt lds
 buffer_load_dwordx4 v29, s[12:15], s54 offen offset:1024 nt lds
 buffer_load_dwordx4 v30, s[12:15], s54 offen offset:2048 nt lds
 buffer_load_dwordx4 v31, s[12:15], s54 offen offset:3072 nt lds
 s_mov_b32 m0, 0x27c00
 s_movk_i32 s70, 424
 buffer_load_dword off, s[72:75], s70 lds
 s_waitcnt vmcnt(28)
 s_mov_b32 m0, 0x19000
 s_mov_b32 s54, 0x2c180
 buffer_load_dwordx4 v16, s[16:19], s54 offen offset:0 nt lds
 buffer_load_dwordx4 v17, s[16:19], s54 offen offset:1024 nt lds
 buffer_load_dwordx4 v18, s[16:19], s54 offen offset:2048 nt lds
 buffer_load_dwordx4 v19, s[16:19], s54 offen offset:3072 nt lds
 s_mov_b32 m0, 0x27c00
 s_movk_i32 s70, 428
 buffer_load_dword off, s[72:75], s70 lds
 s_cmpk_ge_u32 s52, 88
 s_cbranch_scc0 L_ls100
L_lb100:
 s_waitcnt vmcnt(28)
 s_mov_b32 m0, 0x4000
 s_mov_b32 s54, 0x80380
 buffer_load_dwordx4 v20, s[20:23], s54 offen offset:0 lds
 buffer_load_dwordx4 v21, s[20:23], s54 offen offset:1024 lds
 buffer_load_dwordx4 v22, s[20:23], s54 offen offset:2048 lds
 buffer_load_dwordx4 v23, s[20:23], s54 offen offset:3072 lds
 s_waitcnt vmcnt(28)
 s_mov_b32 m0, 0x5000
 s_mov_b32 s54, 0xc0380
 buffer_load_dwordx4 v20, s[20:23], s54 offen offset:0 lds
 buffer_load_dwordx4 v21, s[20:23], s54 offen offset:1024 lds
 buffer_load_dwordx4 v22, s[20:23], s54 offen offset:2048 lds
 buffer_load_dwordx4 v23, s[20:23], s54 offen offset:3072 lds
 s_mov_b32 m0, 0x27c00
 s_movk_i32 s70, 432
 buffer_load_dword off, s[72:75], s70 lds
 s_waitcnt vmcnt(28)
 s_mov_b32 m0, 0x6000
 s_mov_b32 s54, 0x100380
 buffer_load_dwordx4 v20, s[20:23], s54 offen offset:0 lds
 buffer_load_dwordx4 v21, s[20:23], s54 offen offset:1024 lds
 buffer_load_dwordx4 v22, s[20:23], s54 offen offset:2048 lds
 buffer_load_dwordx4 v23, s[20:23], s54 offen offset:3072 lds
 s_waitcnt vmcnt(28)
 s_mov_b32 m0, 0x7000
 s_mov_b32 s54, 0x140380
 buffer_load_dwordx4 v20, s[20:23], s54 offen offset:0 lds
 buffer_load_dwordx4 v21, s[20:23], s54 offen offset:1024 lds
 buffer_load_dwordx4 v22, s[20:23], s54 offen offset:2048 lds
 buffer_load_dwordx4 v23, s[20:23], s54 offen offset:3072 lds
 s_waitcnt vmcnt(28)
 s_mov_b32 m0, 0x1a000
 s_mov_b32 s54, 0x34000
 buffer_load_dwordx4 v28, s[12:15], s54 offen offset:0 nt lds
 buffer_load_dwordx4 v29, s[12:15], s54 offen offset:1024 nt lds
 buffer_load_dwordx4 v30, s[12:15], s54 offen offset:2048 nt lds
 buffer_load_dwordx4 v31, s[12:15], s54 offen offset:3072 nt lds
 s_waitcnt vmcnt(28)
 s_mov_b32 m0, 0x1c000
 s_mov_b32 s54, 0x30000
 buffer_load_dwordx4 v16, s[16:19], s54 offen offset:0 nt lds
 buffer_load_dwordx4 v17, s[16:19], s54 offen offset:1024 nt lds
 buffer_load_dwordx4 v18, s[16:19], s54 offen offset:2048 nt lds
 buffer_load_dwordx4 v19, s[16:19], s54 offen offset:3072 nt lds
 s_waitcnt vmcnt(28)
 s_mov_b32 m0, 0x1b000
 s_mov_b32 s54, 0x34080
 buffer_load_dwordx4 v28, s[12:15], s54 offen offset:0 nt lds
 buffer_load_dwordx4 v29, s[12:15], s54 offen offset:1024 nt lds
 buffer_load_dwordx4 v30, s[12:15], s54 offen offset:2048 nt lds
 buffer_load_dwordx4 v31, s[12:15], s54 offen offset:3072 nt lds
 s_waitcnt vmcnt(28)
 s_mov_b32 m0, 0x1d000
 s_mov_b32 s54, 0x30080
 buffer_load_dwordx4 v16, s[16:19], s54 offen offset:0 nt lds
 buffer_load_dwordx4 v17, s[16:19], s54 offen offset:1024 nt lds
 buffer_load_dwordx4 v18, s[16:19], s54 offen offset:2048 nt lds
 buffer_load_dwordx4 v19, s[16:19], s54 offen offset:3072 nt lds
 s_waitcnt vmcnt(28)
 s_mov_b32 m0, 0x12000
 s_mov_b32 s54, 0x34100
 buffer_load_dwordx4 v28, s[12:15], s54 offen offset:0 nt lds
 buffer_load_dwordx4 v29, s[12:15], s54 offen offset:1024 nt lds
 buffer_load_dwordx4 v30, s[12:15], s54 offen offset:2048 nt lds
 buffer_load_dwordx4 v31, s[12:15], s54 offen offset:3072 nt lds
 s_waitcnt vmcnt(28)
 s_mov_b32 m0, 0x20000
 s_mov_b32 s54, 0x30100
 buffer_load_dwordx4 v16, s[16:19], s54 offen offset:0 nt lds
 buffer_load_dwordx4 v17, s[16:19], s54 offen offset:1024 nt lds
 buffer_load_dwordx4 v18, s[16:19], s54 offen offset:2048 nt lds
 buffer_load_dwordx4 v19, s[16:19], s54 offen offset:3072 nt lds
 s_waitcnt vmcnt(28)
 s_mov_b32 m0, 0x13000
 s_mov_b32 s54, 0x34180
 buffer_load_dwordx4 v28, s[12:15], s54 offen offset:0 nt lds
 buffer_load_dwordx4 v29, s[12:15], s54 offen offset:1024 nt lds
 buffer_load_dwordx4 v30, s[12:15], s54 offen offset:2048 nt lds
 buffer_load_dwordx4 v31, s[12:15], s54 offen offset:3072 nt lds
 s_mov_b32 m0, 0x27c00
 s_movk_i32 s70, 448
 buffer_load_dword off, s[72:75], s70 lds
 s_waitcnt vmcnt(28)
 s_mov_b32 m0, 0x21000
 s_mov_b32 s54, 0x30180
 buffer_load_dwordx4 v16, s[16:19], s54 offen offset:0 nt lds
 buffer_load_dwordx4 v17, s[16:19], s54 offen offset:1024 nt lds
 buffer_load_dwordx4 v18, s[16:19], s54 offen offset:2048 nt lds
 buffer_load_dwordx4 v19, s[16:19], s54 offen offset:3072 nt lds
 s_mov_b32 m0, 0x27c00
 s_movk_i32 s70, 452
 buffer_load_dword off, s[72:75], s70 lds
 s_cmpk_ge_u32 s52, 94
 s_cbranch_scc0 L_ls106
L_lb106:
 s_waitcnt vmcnt(28)
 s_mov_b32 m0, 0xa000
 s_mov_b32 s54, 0x180380
 buffer_load_dwordx4 v20, s[20:23], s54 offen offset:0 lds
 buffer_load_dwordx4 v21, s[20:23], s54 offen offset:1024 lds
 buffer_load_dwordx4 v22, s[20:23], s54 offen offset:2048 lds
 buffer_load_dwordx4 v23, s[20:23], s54 offen offset:3072 lds
 s_waitcnt vmcnt(28)
 s_mov_b32 m0, 0xb000
 s_mov_b32 s54, 0x1c0380
 buffer_load_dwordx4 v20, s[20:23], s54 offen offset:0 lds
 buffer_load_dwordx4 v21, s[20:23], s54 offen offset:1024 lds
 buffer_load_dwordx4 v22, s[20:23], s54 offen offset:2048 lds
 buffer_load_dwordx4 v23, s[20:23], s54 offen offset:3072 lds
 s_mov_b32 m0, 0x27c00
 s_movk_i32 s70, 456
 buffer_load_dword off, s[72:75], s70 lds
 s_waitcnt vmcnt(28)
 s_mov_b32 m0, 0x8000
 s_mov_b32 s54, 0x200380
 buffer_load_dwordx4 v20, s[20:23], s54 offen offset:0 lds
 buffer_load_dwordx4 v21, s[20:23], s54 offen offset:1024 lds
 buffer_load_dwordx4 v22, s[20:23], s54 offen offset:2048 lds
 buffer_load_dwordx4 v23, s[20:23], s54 offen offset:3072 lds
 s_waitcnt vmcnt(28)
 s_mov_b32 m0, 0x9000
 s_mov_b32 s54, 0x240380
 buffer_load_dwordx4 v20, s[20:23], s54 offen offset:0 lds
 buffer_load_dwordx4 v21, s[20:23], s54 offen offset:1024 lds
 buffer_load_dwordx4 v22, s[20:23], s54 offen offset:2048 lds
 buffer_load_dwordx4 v23, s[20:23], s54 offen offset:3072 lds
 s_waitcnt vmcnt(28)
 s_mov_b32 m0, 0x22000
 s_mov_b32 s54, 0x38000
 buffer_load_dwordx4 v28, s[12:15], s54 offen offset:0 nt lds
 buffer_load_dwordx4 v29, s[12:15], s54 offen offset:1024 nt lds
 buffer_load_dwordx4 v30, s[12:15], s54 offen offset:2048 nt lds
 buffer_load_dwordx4 v31, s[12:15], s54 offen offset:3072 nt lds
 s_waitcnt vmcnt(28)
 s_mov_b32 m0, 0x24000
 s_mov_b32 s54, 0x34000
 buffer_load_dwordx4 v16, s[16:19], s54 offen offset:0 nt lds
 buffer_load_dwordx4 v17, s[16:19], s54 offen offset:1024 nt lds
 buffer_load_dwordx4 v18, s[16:19], s54 offen offset:2048 nt lds
 buffer_load_dwordx4 v19, s[16:19], s54 offen offset:3072 nt lds
 s_waitcnt vmcnt(28)
 s_mov_b32 m0, 0x23000
 s_mov_b32 s54, 0x38080
 buffer_load_dwordx4 v28, s[12:15], s54 offen offset:0 nt lds
 buffer_load_dwordx4 v29, s[12:15], s54 offen offset:1024 nt lds
 buffer_load_dwordx4 v30, s[12:15], s54 offen offset:2048 nt lds
 buffer_load_dwordx4 v31, s[12:15], s54 offen offset:3072 nt lds
 s_waitcnt vmcnt(28)
 s_mov_b32 m0, 0x25000
 s_mov_b32 s54, 0x34080
 buffer_load_dwordx4 v16, s[16:19], s54 offen offset:0 nt lds
 buffer_load_dwordx4 v17, s[16:19], s54 offen offset:1024 nt lds
 buffer_load_dwordx4 v18, s[16:19], s54 offen offset:2048 nt lds
 buffer_load_dwordx4 v19, s[16:19], s54 offen offset:3072 nt lds
 s_waitcnt vmcnt(28)
 s_mov_b32 m0, 0xe000
 s_mov_b32 s54, 0x38100
 buffer_load_dwordx4 v28, s[12:15], s54 offen offset:0 nt lds
 buffer_load_dwordx4 v29, s[12:15], s54 offen offset:1024 nt lds
 buffer_load_dwordx4 v30, s[12:15], s54 offen offset:2048 nt lds
 buffer_load_dwordx4 v31, s[12:15], s54 offen offset:3072 nt lds
 s_waitcnt vmcnt(28)
 s_mov_b32 m0, 0x10000
 s_mov_b32 s54, 0x34100
 buffer_load_dwordx4 v16, s[16:19], s54 offen offset:0 nt lds
 buffer_load_dwordx4 v17, s[16:19], s54 offen offset:1024 nt lds
 buffer_load_dwordx4 v18, s[16:19], s54 offen offset:2048 nt lds
 buffer_load_dwordx4 v19, s[16:19], s54 offen offset:3072 nt lds
 s_waitcnt vmcnt(28)
 s_mov_b32 m0, 0xf000
 s_mov_b32 s54, 0x38180
 buffer_load_dwordx4 v28, s[12:15], s54 offen offset:0 nt lds
 buffer_load_dwordx4 v29, s[12:15], s54 offen offset:1024 nt lds
 buffer_load_dwordx4 v30, s[12:15], s54 offen offset:2048 nt lds
 buffer_load_dwordx4 v31, s[12:15], s54 offen offset:3072 nt lds
 s_mov_b32 m0, 0x27c00
 s_movk_i32 s70, 472
 buffer_load_dword off, s[72:75], s70 lds
 s_waitcnt vmcnt(28)
 s_mov_b32 m0, 0x11000
 s_mov_b32 s54, 0x34180
 buffer_load_dwordx4 v16, s[16:19], s54 offen offset:0 nt lds
 buffer_load_dwordx4 v17, s[16:19], s54 offen offset:1024 nt lds
 buffer_load_dwordx4 v18, s[16:19], s54 offen offset:2048 nt lds
 buffer_load_dwordx4 v19, s[16:19], s54 offen offset:3072 nt lds
 s_mov_b32 m0, 0x27c00
 s_movk_i32 s70, 476
 buffer_load_dword off, s[72:75], s70 lds
 s_cmpk_ge_u32 s52, 95
 s_cbranch_scc0 L_ls112
L_lb112:
 s_waitcnt vmcnt(28)
 s_mov_b32 m0, 0x0
 s_mov_b32 s54, 0x280380
 buffer_load_dwordx4 v20, s[20:23], s54 offen offset:0 lds
 buffer_load_dwordx4 v21, s[20:23], s54 offen offset:1024 lds
 buffer_load_dwordx4 v22, s[20:23], s54 offen offset:2048 lds
 buffer_load_dwordx4 v23, s[20:23], s54 offen offset:3072 lds
 s_waitcnt vmcnt(28)
 s_mov_b32 m0, 0x1000
 s_mov_b32 s54, 0x2c0380
 buffer_load_dwordx4 v20, s[20:23], s54 offen offset:0 lds
 buffer_load_dwordx4 v21, s[20:23], s54 offen offset:1024 lds
 buffer_load_dwordx4 v22, s[20:23], s54 offen offset:2048 lds
 buffer_load_dwordx4 v23, s[20:23], s54 offen offset:3072 lds
 s_cmpk_ge_u32 s52, 101
 s_cbranch_scc0 L_ls113
L_lb113:
 s_waitcnt vmcnt(28)
 s_mov_b32 m0, 0x2000
 s_mov_b32 s54, 0x300380
 buffer_load_dwordx4 v20, s[20:23], s54 offen offset:0 lds
 buffer_load_dwordx4 v21, s[20:23], s54 offen offset:1024 lds
 buffer_load_dwordx4 v22, s[20:23], s54 offen offset:2048 lds
 buffer_load_dwordx4 v23, s[20:23], s54 offen offset:3072 lds
 s_waitcnt vmcnt(28)
 s_mov_b32 m0, 0x3000
 s_mov_b32 s54, 0x340380
 buffer_load_dwordx4 v20, s[20:23], s54 offen offset:0 lds
 buffer_load_dwordx4 v21, s[20:23], s54 offen offset:1024 lds
 buffer_load_dwordx4 v22, s[20:23], s54 offen offset:2048 lds
 buffer_load_dwordx4 v23, s[20:23], s54 offen offset:3072 lds
 s_mov_b32 m0, 0x27c00
 s_movk_i32 s70, 484
 buffer_load_dword off, s[72:75], s70 lds
 s_waitcnt vmcnt(28)
 s_mov_b32 m0, 0x14000
 s_mov_b32 s54, 0x3c000
 buffer_load_dwordx4 v28, s[12:15], s54 offen offset:0 nt lds
 buffer_load_dwordx4 v29, s[12:15], s54 offen offset:1024 nt lds
 buffer_load_dwordx4 v30, s[12:15], s54 offen offset:2048 nt lds
 buffer_load_dwordx4 v31, s[12:15], s54 offen offset:3072 nt lds
 s_waitcnt vmcnt(28)
 s_mov_b32 m0, 0x16000
 s_mov_b32 s54, 0x38000
 buffer_load_dwordx4 v16, s[16:19], s54 offen offset:0 nt lds
 buffer_load_dwordx4 v17, s[16:19], s54 offen offset:1024 nt lds
 buffer_load_dwordx4 v18, s[16:19], s54 offen offset:2048 nt lds
 buffer_load_dwordx4 v19, s[16:19], s54 offen offset:3072 nt lds
 s_waitcnt vmcnt(28)
 s_mov_b32 m0, 0x15000
 s_mov_b32 s54, 0x3c080
 buffer_load_dwordx4 v28, s[12:15], s54 offen offset:0 nt lds
 buffer_load_dwordx4 v29, s[12:15], s54 offen offset:1024 nt lds
 buffer_load_dwordx4 v30, s[12:15], s54 offen offset:2048 nt lds
 buffer_load_dwordx4 v31, s[12:15], s54 offen offset:3072 nt lds
 s_waitcnt vmcnt(28)
 s_mov_b32 m0, 0x17000
 s_mov_b32 s54, 0x38080
 buffer_load_dwordx4 v16, s[16:19], s54 offen offset:0 nt lds
 buffer_load_dwordx4 v17, s[16:19], s54 offen offset:1024 nt lds
 buffer_load_dwordx4 v18, s[16:19], s54 offen offset:2048 nt lds
 buffer_load_dwordx4 v19, s[16:19], s54 offen offset:3072 nt lds
 s_waitcnt vmcnt(28)
 s_mov_b32 m0, 0x1e000
 s_mov_b32 s54, 0x3c100
 buffer_load_dwordx4 v28, s[12:15], s54 offen offset:0 nt lds
 buffer_load_dwordx4 v29, s[12:15], s54 offen offset:1024 nt lds
 buffer_load_dwordx4 v30, s[12:15], s54 offen offset:2048 nt lds
 buffer_load_dwordx4 v31, s[12:15], s54 offen offset:3072 nt lds
 s_waitcnt vmcnt(28)
 s_mov_b32 m0, 0xc000
 s_mov_b32 s54, 0x38100
 buffer_load_dwordx4 v16, s[16:19], s54 offen offset:0 nt lds
 buffer_load_dwordx4 v17, s[16:19], s54 offen offset:1024 nt lds
 buffer_load_dwordx4 v18, s[16:19], s54 offen offset:2048 nt lds
 buffer_load_dwordx4 v19, s[16:19], s54 offen offset:3072 nt lds
 s_waitcnt vmcnt(28)
 s_mov_b32 m0, 0x1f000
 s_mov_b32 s54, 0x3c180
 buffer_load_dwordx4 v28, s[12:15], s54 offen offset:0 nt lds
 buffer_load_dwordx4 v29, s[12:15], s54 offen offset:1024 nt lds
 buffer_load_dwordx4 v30, s[12:15], s54 offen offset:2048 nt lds
 buffer_load_dwordx4 v31, s[12:15], s54 offen offset:3072 nt lds
 s_mov_b32 m0, 0x27c00
 s_movk_i32 s70, 496
 buffer_load_dword off, s[72:75], s70 lds
 s_waitcnt vmcnt(28)
 s_mov_b32 m0, 0xd000
 s_mov_b32 s54, 0x38180
 buffer_load_dwordx4 v16, s[16:19], s54 offen offset:0 nt lds
 buffer_load_dwordx4 v17, s[16:19], s54 offen offset:1024 nt lds
 buffer_load_dwordx4 v18, s[16:19], s54 offen offset:2048 nt lds
 buffer_load_dwordx4 v19, s[16:19], s54 offen offset:3072 nt lds
 s_cmpk_ge_u32 s52, 103
 s_cbranch_scc0 L_ls120
L_lb120:
 s_waitcnt vmcnt(28)
 s_mov_b32 m0, 0x18000
 s_mov_b32 s54, 0x40000
 buffer_load_dwordx4 v28, s[12:15], s54 offen offset:0 nt lds
 buffer_load_dwordx4 v29, s[12:15], s54 offen offset:1024 nt lds
 buffer_load_dwordx4 v30, s[12:15], s54 offen offset:2048 nt lds
 buffer_load_dwordx4 v31, s[12:15], s54 offen offset:3072 nt lds
 s_waitcnt vmcnt(28)
 s_mov_b32 m0, 0x1a000
 s_mov_b32 s54, 0x3c000
 buffer_load_dwordx4 v16, s[16:19], s54 offen offset:0 nt lds
 buffer_load_dwordx4 v17, s[16:19], s54 offen offset:1024 nt lds
 buffer_load_dwordx4 v18, s[16:19], s54 offen offset:2048 nt lds
 buffer_load_dwordx4 v19, s[16:19], s54 offen offset:3072 nt lds
 s_waitcnt vmcnt(28)
 s_mov_b32 m0, 0x19000
 s_mov_b32 s54, 0x40080
 buffer_load_dwordx4 v28, s[12:15], s54 offen offset:0 nt lds
 buffer_load_dwordx4 v29, s[12:15], s54 offen offset:1024 nt lds
 buffer_load_dwordx4 v30, s[12:15], s54 offen offset:2048 nt lds
 buffer_load_dwordx4 v31, s[12:15], s54 offen offset:3072 nt lds
 s_mov_b32 m0, 0x27c00
 s_movk_i32 s70, 504
 buffer_load_dword off, s[72:75], s70 lds
 s_waitcnt vmcnt(28)
 s_mov_b32 m0, 0x1b000
 s_mov_b32 s54, 0x3c080
 buffer_load_dwordx4 v16, s[16:19], s54 offen offset:0 nt lds
 buffer_load_dwordx4 v17, s[16:19], s54 offen offset:1024 nt lds
 buffer_load_dwordx4 v18, s[16:19], s54 offen offset:2048 nt lds
 buffer_load_dwordx4 v19, s[16:19], s54 offen offset:3072 nt lds
 s_cmpk_ge_u32 s52, 105
 s_cbranch_scc0 L_ls121
L_lb121:
 s_waitcnt vmcnt(28)
 s_mov_b32 m0, 0x12000
 s_mov_b32 s54, 0x40100
 buffer_load_dwordx4 v28, s[12:15], s54 offen offset:0 nt lds
 buffer_load_dwordx4 v29, s[12:15], s54 offen offset:1024 nt lds
 buffer_load_dwordx4 v30, s[12:15], s54 offen offset:2048 nt lds
 buffer_load_dwordx4 v31, s[12:15], s54 offen offset:3072 nt lds
 s_waitcnt vmcnt(28)
 s_mov_b32 m0, 0x1c000
 s_mov_b32 s54, 0x3c100
 buffer_load_dwordx4 v16, s[16:19], s54 offen offset:0 nt lds
 buffer_load_dwordx4 v17, s[16:19], s54 offen offset:1024 nt lds
 buffer_load_dwordx4 v18, s[16:19], s54 offen offset:2048 nt lds
 buffer_load_dwordx4 v19, s[16:19], s54 offen offset:3072 nt lds
 s_waitcnt vmcnt(28)
 s_mov_b32 m0, 0x13000
 s_mov_b32 s54, 0x40180
 buffer_load_dwordx4 v28, s[12:15], s54 offen offset:0 nt lds
 buffer_load_dwordx4 v29, s[12:15], s54 offen offset:1024 nt lds
 buffer_load_dwordx4 v30, s[12:15], s54 offen offset:2048 nt lds
 buffer_load_dwordx4 v31, s[12:15], s54 offen offset:3072 nt lds
 s_mov_b32 m0, 0x27c00
 s_movk_i32 s70, 512
 buffer_load_dword off, s[72:75], s70 lds
 s_waitcnt vmcnt(28)
 s_mov_b32 m0, 0x1d000
 s_mov_b32 s54, 0x3c180
 buffer_load_dwordx4 v16, s[16:19], s54 offen offset:0 nt lds
 buffer_load_dwordx4 v17, s[16:19], s54 offen offset:1024 nt lds
 buffer_load_dwordx4 v18, s[16:19], s54 offen offset:2048 nt lds
 buffer_load_dwordx4 v19, s[16:19], s54 offen offset:3072 nt lds
 s_cmpk_ge_u32 s52, 109
 s_cbranch_scc0 L_ls124
L_lb124:
 s_waitcnt vmcnt(28)
 s_mov_b32 m0, 0x20000
 s_mov_b32 s54, 0x44000
 buffer_load_dwordx4 v28, s[12:15], s54 offen offset:0 nt lds
 buffer_load_dwordx4 v29, s[12:15], s54 offen offset:1024 nt lds
 buffer_load_dwordx4 v30, s[12:15], s54 offen offset:2048 nt lds
 buffer_load_dwordx4 v31, s[12:15], s54 offen offset:3072 nt lds
 s_waitcnt vmcnt(28)
 s_mov_b32 m0, 0x22000
 s_mov_b32 s54, 0x40000
 buffer_load_dwordx4 v16, s[16:19], s54 offen offset:0 nt lds
 buffer_load_dwordx4 v17, s[16:19], s54 offen offset:1024 nt lds
 buffer_load_dwordx4 v18, s[16:19], s54 offen offset:2048 nt lds
 buffer_load_dwordx4 v19, s[16:19], s54 offen offset:3072 nt lds
 s_waitcnt vmcnt(28)
 s_mov_b32 m0, 0x21000
 s_mov_b32 s54, 0x44080
 buffer_load_dwordx4 v28, s[12:15], s54 offen offset:0 nt lds
 buffer_load_dwordx4 v29, s[12:15], s54 offen offset:1024 nt lds
 buffer_load_dwordx4 v30, s[12:15], s54 offen offset:2048 nt lds
 buffer_load_dwordx4 v31, s[12:15], s54 offen offset:3072 nt lds
 s_mov_b32 m0, 0x27c00
 s_movk_i32 s70, 520
 buffer_load_dword off, s[72:75], s70 lds
 s_waitcnt vmcnt(28)
 s_mov_b32 m0, 0x23000
 s_mov_b32 s54, 0x40080
 buffer_load_dwordx4 v16, s[16:19], s54 offen offset:0 nt lds
 buffer_load_dwordx4 v17, s[16:19], s54 offen offset:1024 nt lds
 buffer_load_dwordx4 v18, s[16:19], s54 offen offset:2048 nt lds
 buffer_load_dwordx4 v19, s[16:19], s54 offen offset:3072 nt lds
 s_cmpk_ge_u32 s52, 111
 s_cbranch_scc0 L_ls125
L_lb125:
 s_waitcnt vmcnt(28)
 s_mov_b32 m0, 0xe000
 s_mov_b32 s54, 0x44100
 buffer_load_dwordx4 v28, s[12:15], s54 offen offset:0 nt lds
 buffer_load_dwordx4 v29, s[12:15], s54 offen offset:1024 nt lds
 buffer_load_dwordx4 v30, s[12:15], s54 offen offset:2048 nt lds
 buffer_load_dwordx4 v31, s[12:15], s54 offen offset:3072 nt lds
 s_waitcnt vmcnt(28)
 s_mov_b32 m0, 0x24000
 s_mov_b32 s54, 0x40100
 buffer_load_dwordx4 v16, s[16:19], s54 offen offset:0 nt lds
 buffer_load_dwordx4 v17, s[16:19], s54 offen offset:1024 nt lds
 buffer_load_dwordx4 v18, s[16:19], s54 offen offset:2048 nt lds
 buffer_load_dwordx4 v19, s[16:19], s54 offen offset:3072 nt lds
 s_waitcnt vmcnt(28)
 s_mov_b32 m0, 0xf000
 s_mov_b32 s54, 0x44180
 buffer_load_dwordx4 v28, s[12:15], s54 offen offset:0 nt lds
 buffer_load_dwordx4 v29, s[12:15], s54 offen offset:1024 nt lds
 buffer_load_dwordx4 v30, s[12:15], s54 offen offset:2048 nt lds
 buffer_load_dwordx4 v31, s[12:15], s54 offen offset:3072 nt lds
 s_mov_b32 m0, 0x27c00
 s_movk_i32 s70, 528
 buffer_load_dword off, s[72:75], s70 lds
 s_waitcnt vmcnt(28)
 s_mov_b32 m0, 0x25000
 s_mov_b32 s54, 0x40180
 buffer_load_dwordx4 v16, s[16:19], s54 offen offset:0 nt lds
 buffer_load_dwordx4 v17, s[16:19], s54 offen offset:1024 nt lds
 buffer_load_dwordx4 v18, s[16:19], s54 offen offset:2048 nt lds
 buffer_load_dwordx4 v19, s[16:19], s54 offen offset:3072 nt lds
 s_mov_b32 m0, 0x27c00
 s_movk_i32 s70, 532
 buffer_load_dword off, s[72:75], s70 lds
 s_waitcnt vmcnt(28)
 s_mov_b32 m0, 0x4000
 s_mov_b32 s54, 0x180
 buffer_load_dwordx4 v24, s[24:27], s54 offen offset:0 lds
 buffer_load_dwordx4 v25, s[24:27], s54 offen offset:1024 lds
 buffer_load_dwordx4 v26, s[24:27], s54 offen offset:2048 lds
 buffer_load_dwordx4 v27, s[24:27], s54 offen offset:3072 lds
 s_waitcnt vmcnt(28)
 s_mov_b32 m0, 0x5000
 s_mov_b32 s54, 0x7180
 buffer_load_dwordx4 v24, s[24:27], s54 offen offset:0 lds
 buffer_load_dwordx4 v25, s[24:27], s54 offen offset:1024 lds
 buffer_load_dwordx4 v26, s[24:27], s54 offen offset:2048 lds
 buffer_load_dwordx4 v27, s[24:27], s54 offen offset:3072 lds
 s_mov_b32 m0, 0x27c00
 s_movk_i32 s70, 536
 buffer_load_dword off, s[72:75], s70 lds
 s_waitcnt vmcnt(28)
 s_mov_b32 m0, 0x6000
 s_mov_b32 s54, 0xe180
 buffer_load_dwordx4 v24, s[24:27], s54 offen offset:0 lds
 buffer_load_dwordx4 v25, s[24:27], s54 offen offset:1024 lds
 buffer_load_dwordx4 v26, s[24:27], s54 offen offset:2048 lds
 buffer_load_dwordx4 v27, s[24:27], s54 offen offset:3072 lds
 s_waitcnt vmcnt(28)
 s_mov_b32 m0, 0x7000
 s_mov_b32 s54, 0x15180
 buffer_load_dwordx4 v24, s[24:27], s54 offen offset:0 lds
 buffer_load_dwordx4 v25, s[24:27], s54 offen offset:1024 lds
 buffer_load_dwordx4 v26, s[24:27], s54 offen offset:2048 lds
 buffer_load_dwordx4 v27, s[24:27], s54 offen offset:3072 lds
 s_cmpk_ge_u32 s52, 116
 s_cbranch_scc0 L_ls129
L_lb129:
 s_waitcnt vmcnt(28)
 s_mov_b32 m0, 0x10000
 s_mov_b32 s54, 0x48000
 buffer_load_dwordx4 v28, s[12:15], s54 offen offset:0 nt lds
 buffer_load_dwordx4 v29, s[12:15], s54 offen offset:1024 nt lds
 buffer_load_dwordx4 v30, s[12:15], s54 offen offset:2048 nt lds
 buffer_load_dwordx4 v31, s[12:15], s54 offen offset:3072 nt lds
 s_waitcnt vmcnt(28)
 s_mov_b32 m0, 0x14000
 s_mov_b32 s54, 0x44000
 buffer_load_dwordx4 v16, s[16:19], s54 offen offset:0 nt lds
 buffer_load_dwordx4 v17, s[16:19], s54 offen offset:1024 nt lds
 buffer_load_dwordx4 v18, s[16:19], s54 offen offset:2048 nt lds
 buffer_load_dwordx4 v19, s[16:19], s54 offen offset:3072 nt lds
 s_waitcnt vmcnt(28)
 s_mov_b32 m0, 0x11000
 s_mov_b32 s54, 0x48080
 buffer_load_dwordx4 v28, s[12:15], s54 offen offset:0 nt lds
 buffer_load_dwordx4 v29, s[12:15], s54 offen offset:1024 nt lds
 buffer_load_dwordx4 v30, s[12:15], s54 offen offset:2048 nt lds
 buffer_load_dwordx4 v31, s[12:15], s54 offen offset:3072 nt lds
 s_waitcnt vmcnt(28)
 s_mov_b32 m0, 0x15000
 s_mov_b32 s54, 0x44080
 buffer_load_dwordx4 v16, s[16:19], s54 offen offset:0 nt lds
 buffer_load_dwordx4 v17, s[16:19], s54 offen offset:1024 nt lds
 buffer_load_dwordx4 v18, s[16:19], s54 offen offset:2048 nt lds
 buffer_load_dwordx4 v19, s[16:19], s54 offen offset:3072 nt lds
 s_cmpk_ge_u32 s52, 118
 s_cbranch_scc0 L_ls130
L_lb130:
 s_waitcnt vmcnt(28)
 s_mov_b32 m0, 0x1e000
 s_mov_b32 s54, 0x48100
 buffer_load_dwordx4 v28, s[12:15], s54 offen offset:0 nt lds
 buffer_load_dwordx4 v29, s[12:15], s54 offen offset:1024 nt lds
 buffer_load_dwordx4 v30, s[12:15], s54 offen offset:2048 nt lds
 buffer_load_dwordx4 v31, s[12:15], s54 offen offset:3072 nt lds
 s_waitcnt vmcnt(28)
 s_mov_b32 m0, 0x16000
 s_mov_b32 s54, 0x44100
 buffer_load_dwordx4 v16, s[16:19], s54 offen offset:0 nt lds
 buffer_load_dwordx4 v17, s[16:19], s54 offen offset:1024 nt lds
 buffer_load_dwordx4 v18, s[16:19], s54 offen offset:2048 nt lds
 buffer_load_dwordx4 v19, s[16:19], s54 offen offset:3072 nt lds
 s_waitcnt vmcnt(28)
 s_mov_b32 m0, 0x1f000
 s_mov_b32 s54, 0x48180
 buffer_load_dwordx4 v28, s[12:15], s54 offen offset:0 nt lds
 buffer_load_dwordx4 v29, s[12:15], s54 offen offset:1024 nt lds
 buffer_load_dwordx4 v30, s[12:15], s54 offen offset:2048 nt lds
 buffer_load_dwordx4 v31, s[12:15], s54 offen offset:3072 nt lds
 s_mov_b32 m0, 0x27c00
 s_movk_i32 s70, 552
 buffer_load_dword off, s[72:75], s70 lds
 s_waitcnt vmcnt(28)
 s_mov_b32 m0, 0x17000
 s_mov_b32 s54, 0x44180
 buffer_load_dwordx4 v16, s[16:19], s54 offen offset:0 nt lds
 buffer_load_dwordx4 v17, s[16:19], s54 offen offset:1024 nt lds
 buffer_load_dwordx4 v18, s[16:19], s54 offen offset:2048 nt lds
 buffer_load_dwordx4 v19, s[16:19], s54 offen offset:3072 nt lds
 s_mov_b32 m0, 0x27c00
 s_movk_i32 s70, 556
 buffer_load_dword off, s[72:75], s70 lds
 s_cmpk_ge_u32 s52, 120
 s_cbranch_scc0 L_ls134
L_lb134:
 s_waitcnt vmcnt(28)
 s_mov_b32 m0, 0xc000
 s_mov_b32 s54, 0x4c000
 buffer_load_dwordx4 v28, s[12:15], s54 offen offset:0 nt lds
 buffer_load_dwordx4 v29, s[12:15], s54 offen offset:1024 nt lds
 buffer_load_dwordx4 v30, s[12:15], s54 offen offset:2048 nt lds
 buffer_load_dwordx4 v31, s[12:15], s54 offen offset:3072 nt lds
 s_waitcnt vmcnt(28)
 s_mov_b32 m0, 0x18000
 s_mov_b32 s54, 0x48000
 buffer_load_dwordx4 v16, s[16:19], s54 offen offset:0 nt lds
 buffer_load_dwordx4 v17, s[16:19], s54 offen offset:1024 nt lds
 buffer_load_dwordx4 v18, s[16:19], s54 offen offset:2048 nt lds
 buffer_load_dwordx4 v19, s[16:19], s54 offen offset:3072 nt lds
 s_waitcnt vmcnt(28)
 s_mov_b32 m0, 0xd000
 s_mov_b32 s54, 0x4c080
 buffer_load_dwordx4 v28, s[12:15], s54 offen offset:0 nt lds
 buffer_load_dwordx4 v29, s[12:15], s54 offen offset:1024 nt lds
 buffer_load_dwordx4 v30, s[12:15], s54 offen offset:2048 nt lds
 buffer_load_dwordx4 v31, s[12:15], s54 offen offset:3072 nt lds
 s_waitcnt vmcnt(28)
 s_mov_b32 m0, 0x19000
 s_mov_b32 s54, 0x48080
 buffer_load_dwordx4 v16, s[16:19], s54 offen offset:0 nt lds
 buffer_load_dwordx4 v17, s[16:19], s54 offen offset:1024 nt lds
 buffer_load_dwordx4 v18, s[16:19], s54 offen offset:2048 nt lds
 buffer_load_dwordx4 v19, s[16:19], s54 offen offset:3072 nt lds
 s_cmpk_ge_u32 s52, 122
 s_cbranch_scc0 L_ls135
L_lb135:
 s_waitcnt vmcnt(28)
 s_mov_b32 m0, 0x12000
 s_mov_b32 s54, 0x4c100
 buffer_load_dwordx4 v28, s[12:15], s54 offen offset:0 nt lds
 buffer_load_dwordx4 v29, s[12:15], s54 offen offset:1024 nt lds
 buffer_load_dwordx4 v30, s[12:15], s54 offen offset:2048 nt lds
 buffer_load_dwordx4 v31, s[12:15], s54 offen offset:3072 nt lds
 s_waitcnt vmcnt(28)
 s_mov_b32 m0, 0x1a000
 s_mov_b32 s54, 0x48100
 buffer_load_dwordx4 v16, s[16:19], s54 offen offset:0 nt lds
 buffer_load_dwordx4 v17, s[16:19], s54 offen offset:1024 nt lds
 buffer_load_dwordx4 v18, s[16:19], s54 offen offset:2048 nt lds
 buffer_load_dwordx4 v19, s[16:19], s54 offen offset:3072 nt lds
 s_waitcnt vmcnt(28)
 s_mov_b32 m0, 0x13000
 s_mov_b32 s54, 0x4c180
 buffer_load_dwordx4 v28, s[12:15], s54 offen offset:0 nt lds
 buffer_load_dwordx4 v29, s[12:15], s54 offen offset:1024 nt lds
 buffer_load_dwordx4 v30, s[12:15], s54 offen offset:2048 nt lds
 buffer_load_dwordx4 v31, s[12:15], s54 offen offset:3072 nt lds
 s_mov_b32 m0, 0x27c00
 s_movk_i32 s70, 568
 buffer_load_dword off, s[72:75], s70 lds
 s_waitcnt vmcnt(28)
 s_mov_b32 m0, 0x1b000
 s_mov_b32 s54, 0x48180
 buffer_load_dwordx4 v16, s[16:19], s54 offen offset:0 nt lds
 buffer_load_dwordx4 v17, s[16:19], s54 offen offset:1024 nt lds
 buffer_load_dwordx4 v18, s[16:19], s54 offen offset:2048 nt lds
 buffer_load_dwordx4 v19, s[16:19], s54 offen offset:3072 nt lds
 s_mov_b32 m0, 0x27c00
 s_movk_i32 s70, 572
 buffer_load_dword off, s[72:75], s70 lds
 s_waitcnt vmcnt(28)
 s_mov_b32 m0, 0xa000
 s_mov_b32 s54, 0x1c180
 buffer_load_dwordx4 v24, s[24:27], s54 offen offset:0 lds
 buffer_load_dwordx4 v25, s[24:27], s54 offen offset:1024 lds
 buffer_load_dwordx4 v26, s[24:27], s54 offen offset:2048 lds
 buffer_load_dwordx4 v27, s[24:27], s54 offen offset:3072 lds
 s_waitcnt vmcnt(28)
 s_mov_b32 m0, 0xb000
 s_mov_b32 s54, 0x23180
 buffer_load_dwordx4 v24, s[24:27], s54 offen offset:0 lds
 buffer_load_dwordx4 v25, s[24:27], s54 offen offset:1024 lds
 buffer_load_dwordx4 v26, s[24:27], s54 offen offset:2048 lds
 buffer_load_dwordx4 v27, s[24:27], s54 offen offset:3072 lds
 s_waitcnt vmcnt(28)
 s_mov_b32 m0, 0x8000
 s_mov_b32 s54, 0x2a180
 buffer_load_dwordx4 v24, s[24:27], s54 offen offset:0 lds
 buffer_load_dwordx4 v25, s[24:27], s54 offen offset:1024 lds
 buffer_load_dwordx4 v26, s[24:27], s54 offen offset:2048 lds
 buffer_load_dwordx4 v27, s[24:27], s54 offen offset:3072 lds
 s_waitcnt vmcnt(28)
 s_mov_b32 m0, 0x9000
 s_mov_b32 s54, 0x31180
 buffer_load_dwordx4 v24, s[24:27], s54 offen offset:0 lds
 buffer_load_dwordx4 v25, s[24:27], s54 offen offset:1024 lds
 buffer_load_dwordx4 v26, s[24:27], s54 offen offset:2048 lds
 buffer_load_dwordx4 v27, s[24:27], s54 offen offset:3072 lds
 s_mov_b32 m0, 0x27c00
 s_movk_i32 s70, 580
 buffer_load_dword off, s[72:75], s70 lds
 s_cmpk_ge_u32 s52, 124
 s_cbranch_scc0 L_ls140
L_lb140:
 s_waitcnt vmcnt(28)
 s_mov_b32 m0, 0x1c000
 s_mov_b32 s54, 0x50000
 buffer_load_dwordx4 v28, s[12:15], s54 offen offset:0 nt lds
 buffer_load_dwordx4 v29, s[12:15], s54 offen offset:1024 nt lds
 buffer_load_dwordx4 v30, s[12:15], s54 offen offset:2048 nt lds
 buffer_load_dwordx4 v31, s[12:15], s54 offen offset:3072 nt lds
 s_waitcnt vmcnt(28)
 s_mov_b32 m0, 0x20000
 s_mov_b32 s54, 0x4c000
 buffer_load_dwordx4 v16, s[16:19], s54 offen offset:0 nt lds
 buffer_load_dwordx4 v17, s[16:19], s54 offen offset:1024 nt lds
 buffer_load_dwordx4 v18, s[16:19], s54 offen offset:2048 nt lds
 buffer_load_dwordx4 v19, s[16:19], s54 offen offset:3072 nt lds
 s_waitcnt vmcnt(28)
 s_mov_b32 m0, 0x1d000
 s_mov_b32 s54, 0x50080
 buffer_load_dwordx4 v28, s[12:15], s54 offen offset:0 nt lds
 buffer_load_dwordx4 v29, s[12:15], s54 offen offset:1024 nt lds
 buffer_load_dwordx4 v30, s[12:15], s54 offen offset:2048 nt lds
 buffer_load_dwordx4 v31, s[12:15], s54 offen offset:3072 nt lds
 s_waitcnt vmcnt(28)
 s_mov_b32 m0, 0x21000
 s_mov_b32 s54, 0x4c080
 buffer_load_dwordx4 v16, s[16:19], s54 offen offset:0 nt lds
 buffer_load_dwordx4 v17, s[16:19], s54 offen offset:1024 nt lds
 buffer_load_dwordx4 v18, s[16:19], s54 offen offset:2048 nt lds
 buffer_load_dwordx4 v19, s[16:19], s54 offen offset:3072 nt lds
 s_cmpk_ge_u32 s52, 126
 s_cbranch_scc0 L_ls141
L_lb141:
 s_waitcnt vmcnt(28)
 s_mov_b32 m0, 0xe000
 s_mov_b32 s54, 0x50100
 buffer_load_dwordx4 v28, s[12:15], s54 offen offset:0 nt lds
 buffer_load_dwordx4 v29, s[12:15], s54 offen offset:1024 nt lds
 buffer_load_dwordx4 v30, s[12:15], s54 offen offset:2048 nt lds
 buffer_load_dwordx4 v31, s[12:15], s54 offen offset:3072 nt lds
 s_waitcnt vmcnt(28)
 s_mov_b32 m0, 0x22000
 s_mov_b32 s54, 0x4c100
 buffer_load_dwordx4 v16, s[16:19], s54 offen offset:0 nt lds
 buffer_load_dwordx4 v17, s[16:19], s54 offen offset:1024 nt lds
 buffer_load_dwordx4 v18, s[16:19], s54 offen offset:2048 nt lds
 buffer_load_dwordx4 v19, s[16:19], s54 offen offset:3072 nt lds
 s_waitcnt vmcnt(28)
 s_mov_b32 m0, 0xf000
 s_mov_b32 s54, 0x50180
 buffer_load_dwordx4 v28, s[12:15], s54 offen offset:0 nt lds
 buffer_load_dwordx4 v29, s[12:15], s54 offen offset:1024 nt lds
 buffer_load_dwordx4 v30, s[12:15], s54 offen offset:2048 nt lds
 buffer_load_dwordx4 v31, s[12:15], s54 offen offset:3072 nt lds
 s_mov_b32 m0, 0x27c00
 s_movk_i32 s70, 592
 buffer_load_dword off, s[72:75], s70 lds
 s_waitcnt vmcnt(28)
 s_mov_b32 m0, 0x23000
 s_mov_b32 s54, 0x4c180
 buffer_load_dwordx4 v16, s[16:19], s54 offen offset:0 nt lds
 buffer_load_dwordx4 v17, s[16:19], s54 offen offset:1024 nt lds
 buffer_load_dwordx4 v18, s[16:19], s54 offen offset:2048 nt lds
 buffer_load_dwordx4 v19, s[16:19], s54 offen offset:3072 nt lds
 s_mov_b32 m0, 0x27c00
 s_movk_i32 s70, 596
 buffer_load_dword off, s[72:75], s70 lds
 s_waitcnt vmcnt(28)
 s_mov_b32 m0, 0x0
 s_mov_b32 s54, 0x200
 buffer_load_dwordx4 v24, s[24:27], s54 offen offset:0 lds
 buffer_load_dwordx4 v25, s[24:27], s54 offen offset:1024 lds
 buffer_load_dwordx4 v26, s[24:27], s54 offen offset:2048 lds
 buffer_load_dwordx4 v27, s[24:27], s54 offen offset:3072 lds
 s_waitcnt vmcnt(28)
 s_mov_b32 m0, 0x1000
 s_mov_b32 s54, 0x7200
 buffer_load_dwordx4 v24, s[24:27], s54 offen offset:0 lds
 buffer_load_dwordx4 v25, s[24:27], s54 offen offset:1024 lds
 buffer_load_dwordx4 v26, s[24:27], s54 offen offset:2048 lds
 buffer_load_dwordx4 v27, s[24:27], s54 offen offset:3072 lds
 s_waitcnt vmcnt(28)
 s_mov_b32 m0, 0x2000
 s_mov_b32 s54, 0xe200
 buffer_load_dwordx4 v24, s[24:27], s54 offen offset:0 lds
 buffer_load_dwordx4 v25, s[24:27], s54 offen offset:1024 lds
 buffer_load_dwordx4 v26, s[24:27], s54 offen offset:2048 lds
 buffer_load_dwordx4 v27, s[24:27], s54 offen offset:3072 lds
 s_waitcnt vmcnt(28)
 s_mov_b32 m0, 0x3000
 s_mov_b32 s54, 0x15200
 buffer_load_dwordx4 v24, s[24:27], s54 offen offset:0 lds
 buffer_load_dwordx4 v25, s[24:27], s54 offen offset:1024 lds
 buffer_load_dwordx4 v26, s[24:27], s54 offen offset:2048 lds
 buffer_load_dwordx4 v27, s[24:27], s54 offen offset:3072 lds
 s_mov_b32 m0, 0x27c00
 s_movk_i32 s70, 604
 buffer_load_dword off, s[72:75], s70 lds
 s_cmpk_ge_u32 s52, 129
 s_cbranch_scc0 L_ls146
L_lb146:
 s_waitcnt vmcnt(28)
 s_mov_b32 m0, 0x24000
 s_mov_b32 s54, 0x54000
 buffer_load_dwordx4 v28, s[12:15], s54 offen offset:0 nt lds
 buffer_load_dwordx4 v29, s[12:15], s54 offen offset:1024 nt lds
 buffer_load_dwordx4 v30, s[12:15], s54 offen offset:2048 nt lds
 buffer_load_dwordx4 v31, s[12:15], s54 offen offset:3072 nt lds
 s_waitcnt vmcnt(28)
 s_mov_b32 m0, 0x10000
 s_mov_b32 s54, 0x50000
 buffer_load_dwordx4 v16, s[16:19], s54 offen offset:0 nt lds
 buffer_load_dwordx4 v17, s[16:19], s54 offen offset:1024 nt lds
 buffer_load_dwordx4 v18, s[16:19], s54 offen offset:2048 nt lds
 buffer_load_dwordx4 v19, s[16:19], s54 offen offset:3072 nt lds
 s_waitcnt vmcnt(28)
 s_mov_b32 m0, 0x25000
 s_mov_b32 s54, 0x54080
 buffer_load_dwordx4 v28, s[12:15], s54 offen offset:0 nt lds
 buffer_load_dwordx4 v29, s[12:15], s54 offen offset:1024 nt lds
 buffer_load_dwordx4 v30, s[12:15], s54 offen offset:2048 nt lds
 buffer_load_dwordx4 v31, s[12:15], s54 offen offset:3072 nt lds
 s_waitcnt vmcnt(28)
 s_mov_b32 m0, 0x11000
 s_mov_b32 s54, 0x50080
 buffer_load_dwordx4 v16, s[16:19], s54 offen offset:0 nt lds
 buffer_load_dwordx4 v17, s[16:19], s54 offen offset:1024 nt lds
 buffer_load_dwordx4 v18, s[16:19], s54 offen offset:2048 nt lds
 buffer_load_dwordx4 v19, s[16:19], s54 offen offset:3072 nt lds
 s_cmpk_ge_u32 s52, 131
 s_cbranch_scc0 L_ls147
L_lb147:
 s_waitcnt vmcnt(28)
 s_mov_b32 m0, 0x1e000
 s_mov_b32 s54, 0x54100
 buffer_load_dwordx4 v28, s[12:15], s54 offen offset:0 nt lds
 buffer_load_dwordx4 v29, s[12:15], s54 offen offset:1024 nt lds
 buffer_load_dwordx4 v30, s[12:15], s54 offen offset:2048 nt lds
 buffer_load_dwordx4 v31, s[12:15], s54 offen offset:3072 nt lds
 s_waitcnt vmcnt(28)
 s_mov_b32 m0, 0x14000
 s_mov_b32 s54, 0x50100
 buffer_load_dwordx4 v16, s[16:19], s54 offen offset:0 nt lds
 buffer_load_dwordx4 v17, s[16:19], s54 offen offset:1024 nt lds
 buffer_load_dwordx4 v18, s[16:19], s54 offen offset:2048 nt lds
 buffer_load_dwordx4 v19, s[16:19], s54 offen offset:3072 nt lds
 s_waitcnt vmcnt(28)
 s_mov_b32 m0, 0x1f000
 s_mov_b32 s54, 0x54180
 buffer_load_dwordx4 v28, s[12:15], s54 offen offset:0 nt lds
 buffer_load_dwordx4 v29, s[12:15], s54 offen offset:1024 nt lds
 buffer_load_dwordx4 v30, s[12:15], s54 offen offset:2048 nt lds
 buffer_load_dwordx4 v31, s[12:15], s54 offen offset:3072 nt lds
 s_mov_b32 m0, 0x27c00
 s_movk_i32 s70, 616
 buffer_load_dword off, s[72:75], s70 lds
 s_waitcnt vmcnt(28)
 s_mov_b32 m0, 0x15000
 s_mov_b32 s54, 0x50180
 buffer_load_dwordx4 v16, s[16:19], s54 offen offset:0 nt lds
 buffer_load_dwordx4 v17, s[16:19], s54 offen offset:1024 nt lds
 buffer_load_dwordx4 v18, s[16:19], s54 offen offset:2048 nt lds
 buffer_load_dwordx4 v19, s[16:19], s54 offen offset:3072 nt lds
 s_mov_b32 m0, 0x27c00
 s_movk_i32 s70, 620
 buffer_load_dword off, s[72:75], s70 lds
 s_waitcnt vmcnt(28)
 s_mov_b32 m0, 0x4000
 s_mov_b32 s54, 0x1c200
 buffer_load_dwordx4 v24, s[24:27], s54 offen offset:0 lds
 buffer_load_dwordx4 v25, s[24:27], s54 offen offset:1024 lds
 buffer_load_dwordx4 v26, s[24:27], s54 offen offset:2048 lds
 buffer_load_dwordx4 v27, s[24:27], s54 offen offset:3072 lds
 s_waitcnt vmcnt(28)
 s_mov_b32 m0, 0x5000
 s_mov_b32 s54, 0x23200
 buffer_load_dwordx4 v24, s[24:27], s54 offen offset:0 lds
 buffer_load_dwordx4 v25, s[24:27], s54 offen offset:1024 lds
 buffer_load_dwordx4 v26, s[24:27], s54 offen offset:2048 lds
 buffer_load_dwordx4 v27, s[24:27], s54 offen offset:3072 lds
 s_cmpk_ge_u32 s52, 132
 s_cbranch_scc0 L_ls149
L_lb149:
 s_waitcnt vmcnt(28)
 s_mov_b32 m0, 0x6000
 s_mov_b32 s54, 0x2a200
 buffer_load_dwordx4 v24, s[24:27], s54 offen offset:0 lds
 buffer_load_dwordx4 v25, s[24:27], s54 offen offset:1024 lds
 buffer_load_dwordx4 v26, s[24:27], s54 offen offset:2048 lds
 buffer_load_dwordx4 v27, s[24:27], s54 offen offset:3072 lds
 s_waitcnt vmcnt(28)
 s_mov_b32 m0, 0x7000
 s_mov_b32 s54, 0x31200
 buffer_load_dwordx4 v24, s[24:27], s54 offen offset:0 lds
 buffer_load_dwordx4 v25, s[24:27], s54 offen offset:1024 lds
 buffer_load_dwordx4 v26, s[24:27], s54 offen offset:2048 lds
 buffer_load_dwordx4 v27, s[24:27], s54 offen offset:3072 lds
 s_mov_b32 m0, 0x27c00
 s_movk_i32 s70, 628
 buffer_load_dword off, s[72:75], s70 lds
 s_cmpk_ge_u32 s52, 134
 s_cbranch_scc0 L_ls152
L_lb152:
 s_waitcnt vmcnt(28)
 s_mov_b32 m0, 0x16000
 s_mov_b32 s54, 0x58000
 buffer_load_dwordx4 v28, s[12:15], s54 offen offset:0 nt lds
 buffer_load_dwordx4 v29, s[12:15], s54 offen offset:1024 nt lds
 buffer_load_dwordx4 v30, s[12:15], s54 offen offset:2048 nt lds
 buffer_load_dwordx4 v31, s[12:15], s54 offen offset:3072 nt lds
 s_waitcnt vmcnt(28)
 s_mov_b32 m0, 0xc000
 s_mov_b32 s54, 0x54000
 buffer_load_dwordx4 v16, s[16:19], s54 offen offset:0 nt lds
 buffer_load_dwordx4 v17, s[16:19], s54 offen offset:1024 nt lds
 buffer_load_dwordx4 v18, s[16:19], s54 offen offset:2048 nt lds
 buffer_load_dwordx4 v19, s[16:19], s54 offen offset:3072 nt lds
 s_waitcnt vmcnt(28)
 s_mov_b32 m0, 0x17000
 s_mov_b32 s54, 0x58080
 buffer_load_dwordx4 v28, s[12:15], s54 offen offset:0 nt lds
 buffer_load_dwordx4 v29, s[12:15], s54 offen offset:1024 nt lds
 buffer_load_dwordx4 v30, s[12:15], s54 offen offset:2048 nt lds
 buffer_load_dwordx4 v31, s[12:15], s54 offen offset:3072 nt lds
 s_waitcnt vmcnt(28)
 s_mov_b32 m0, 0xd000
 s_mov_b32 s54, 0x54080
 buffer_load_dwordx4 v16, s[16:19], s54 offen offset:0 nt lds
 buffer_load_dwordx4 v17, s[16:19], s54 offen offset:1024 nt lds
 buffer_load_dwordx4 v18, s[16:19], s54 offen offset:2048 nt lds
 buffer_load_dwordx4 v19, s[16:19], s54 offen offset:3072 nt lds
 s_cmpk_ge_u32 s52, 136
 s_cbranch_scc0 L_ls153
L_lb153:
 s_waitcnt vmcnt(28)
 s_mov_b32 m0, 0x12000
 s_mov_b32 s54, 0x58100
 buffer_load_dwordx4 v28, s[12:15], s54 offen offset:0 nt lds
 buffer_load_dwordx4 v29, s[12:15], s54 offen offset:1024 nt lds
 buffer_load_dwordx4 v30, s[12:15], s54 offen offset:2048 nt lds
 buffer_load_dwordx4 v31, s[12:15], s54 offen offset:3072 nt lds
 s_waitcnt vmcnt(28)
 s_mov_b32 m0, 0x18000
 s_mov_b32 s54, 0x54100
 buffer_load_dwordx4 v16, s[16:19], s54 offen offset:0 nt lds
 buffer_load_dwordx4 v17, s[16:19], s54 offen offset:1024 nt lds
 buffer_load_dwordx4 v18, s[16:19], s54 offen offset:2048 nt lds
 buffer_load_dwordx4 v19, s[16:19], s54 offen offset:3072 nt lds
 s_waitcnt vmcnt(28)
 s_mov_b32 m0, 0x13000
 s_mov_b32 s54, 0x58180
 buffer_load_dwordx4 v28, s[12:15], s54 offen offset:0 nt lds
 buffer_load_dwordx4 v29, s[12:15], s54 offen offset:1024 nt lds
 buffer_load_dwordx4 v30, s[12:15], s54 offen offset:2048 nt lds
 buffer_load_dwordx4 v31, s[12:15], s54 offen offset:3072 nt lds
 s_mov_b32 m0, 0x27c00
 s_movk_i32 s70, 640
 buffer_load_dword off, s[72:75], s70 lds
 s_waitcnt vmcnt(28)
 s_mov_b32 m0, 0x19000
 s_mov_b32 s54, 0x54180
 buffer_load_dwordx4 v16, s[16:19], s54 offen offset:0 nt lds
 buffer_load_dwordx4 v17, s[16:19], s54 offen offset:1024 nt lds
 buffer_load_dwordx4 v18, s[16:19], s54 offen offset:2048 nt lds
 buffer_load_dwordx4 v19, s[16:19], s54 offen offset:3072 nt lds
 s_mov_b32 m0, 0x27c00
 s_movk_i32 s70, 644
 buffer_load_dword off, s[72:75], s70 lds
 s_cmpk_ge_u32 s52, 138
 s_cbranch_scc0 L_ls154
L_lb154:
 s_waitcnt vmcnt(28)
 s_mov_b32 m0, 0xa000
 s_mov_b32 s54, 0x280
 buffer_load_dwordx4 v24, s[24:27], s54 offen offset:0 lds
 buffer_load_dwordx4 v25, s[24:27], s54 offen offset:1024 lds
 buffer_load_dwordx4 v26, s[24:27], s54 offen offset:2048 lds
 buffer_load_dwordx4 v27, s[24:27], s54 offen offset:3072 lds
 s_waitcnt vmcnt(28)
 s_mov_b32 m0, 0xb000
 s_mov_b32 s54, 0x7280
 buffer_load_dwordx4 v24, s[24:27], s54 offen offset:0 lds
 buffer_load_dwordx4 v25, s[24:27], s54 offen offset:1024 lds
 buffer_load_dwordx4 v26, s[24:27], s54 offen offset:2048 lds
 buffer_load_dwordx4 v27, s[24:27], s54 offen offset:3072 lds
 s_waitcnt vmcnt(28)
 s_mov_b32 m0, 0x8000
 s_mov_b32 s54, 0xe280
 buffer_load_dwordx4 v24, s[24:27], s54 offen offset:0 lds
 buffer_load_dwordx4 v25, s[24:27], s54 offen offset:1024 lds
 buffer_load_dwordx4 v26, s[24:27], s54 offen offset:2048 lds
 buffer_load_dwordx4 v27, s[24:27], s54 offen offset:3072 lds
 s_waitcnt vmcnt(28)
 s_mov_b32 m0, 0x9000
 s_mov_b32 s54, 0x15280
 buffer_load_dwordx4 v24, s[24:27], s54 offen offset:0 lds
 buffer_load_dwordx4 v25, s[24:27], s54 offen offset:1024 lds
 buffer_load_dwordx4 v26, s[24:27], s54 offen offset:2048 lds
 buffer_load_dwordx4 v27, s[24:27], s54 offen offset:3072 lds
 s_mov_b32 m0, 0x27c00
 s_movk_i32 s70, 652
 buffer_load_dword off, s[72:75], s70 lds
 s_cmpk_ge_u32 s52, 140
 s_cbranch_scc0 L_ls158
L_lb158:
 s_waitcnt vmcnt(28)
 s_mov_b32 m0, 0x1a000
 s_mov_b32 s54, 0x5c000
 buffer_load_dwordx4 v28, s[12:15], s54 offen offset:0 nt lds
 buffer_load_dwordx4 v29, s[12:15], s54 offen offset:1024 nt lds
 buffer_load_dwordx4 v30, s[12:15], s54 offen offset:2048 nt lds
 buffer_load_dwordx4 v31, s[12:15], s54 offen offset:3072 nt lds
 s_waitcnt vmcnt(28)
 s_mov_b32 m0, 0x1c000
 s_mov_b32 s54, 0x58000
 buffer_load_dwordx4 v16, s[16:19], s54 offen offset:0 nt lds
 buffer_load_dwordx4 v17, s[16:19], s54 offen offset:1024 nt lds
 buffer_load_dwordx4 v18, s[16:19], s54 offen offset:2048 nt lds
 buffer_load_dwordx4 v19, s[16:19], s54 offen offset:3072 nt lds
 s_waitcnt vmcnt(28)
 s_mov_b32 m0, 0x1b000
 s_mov_b32 s54, 0x5c080
 buffer_load_dwordx4 v28, s[12:15], s54 offen offset:0 nt lds
 buffer_load_dwordx4 v29, s[12:15], s54 offen offset:1024 nt lds
 buffer_load_dwordx4 v30, s[12:15], s54 offen offset:2048 nt lds
 buffer_load_dwordx4 v31, s[12:15], s54 offen offset:3072 nt lds
 s_waitcnt vmcnt(28)
 s_mov_b32 m0, 0x1d000
 s_mov_b32 s54, 0x58080
 buffer_load_dwordx4 v16, s[16:19], s54 offen offset:0 nt lds
 buffer_load_dwordx4 v17, s[16:19], s54 offen offset:1024 nt lds
 buffer_load_dwordx4 v18, s[16:19], s54 offen offset:2048 nt lds
 buffer_load_dwordx4 v19, s[16:19], s54 offen offset:3072 nt lds
 s_cmpk_ge_u32 s52, 142
 s_cbranch_scc0 L_ls159
L_lb159:
 s_waitcnt vmcnt(28)
 s_mov_b32 m0, 0xe000
 s_mov_b32 s54, 0x5c100
 buffer_load_dwordx4 v28, s[12:15], s54 offen offset:0 nt lds
 buffer_load_dwordx4 v29, s[12:15], s54 offen offset:1024 nt lds
 buffer_load_dwordx4 v30, s[12:15], s54 offen offset:2048 nt lds
 buffer_load_dwordx4 v31, s[12:15], s54 offen offset:3072 nt lds
 s_waitcnt vmcnt(28)
 s_mov_b32 m0, 0x20000
 s_mov_b32 s54, 0x58100
 buffer_load_dwordx4 v16, s[16:19], s54 offen offset:0 nt lds
 buffer_load_dwordx4 v17, s[16:19], s54 offen offset:1024 nt lds
 buffer_load_dwordx4 v18, s[16:19], s54 offen offset:2048 nt lds
 buffer_load_dwordx4 v19, s[16:19], s54 offen offset:3072 nt lds
 s_waitcnt vmcnt(28)
 s_mov_b32 m0, 0xf000
 s_mov_b32 s54, 0x5c180
 buffer_load_dwordx4 v28, s[12:15], s54 offen offset:0 nt lds
 buffer_load_dwordx4 v29, s[12:15], s54 offen offset:1024 nt lds
 buffer_load_dwordx4 v30, s[12:15], s54 offen offset:2048 nt lds
 buffer_load_dwordx4 v31, s[12:15], s54 offen offset:3072 nt lds
 s_mov_b32 m0, 0x27c00
 s_movk_i32 s70, 664
 buffer_load_dword off, s[72:75], s70 lds
 s_waitcnt vmcnt(28)
 s_mov_b32 m0, 0x21000
 s_mov_b32 s54, 0x58180
 buffer_load_dwordx4 v16, s[16:19], s54 offen offset:0 nt lds
 buffer_load_dwordx4 v17, s[16:19], s54 offen offset:1024 nt lds
 buffer_load_dwordx4 v18, s[16:19], s54 offen offset:2048 nt lds
 buffer_load_dwordx4 v19, s[16:19], s54 offen offset:3072 nt lds
 s_mov_b32 m0, 0x27c00
 s_movk_i32 s70, 668
 buffer_load_dword off, s[72:75], s70 lds
 s_cmpk_ge_u32 s52, 144
 s_cbranch_scc0 L_ls160
L_lb160:
 s_waitcnt vmcnt(28)
 s_mov_b32 m0, 0x0
 s_mov_b32 s54, 0x1c280
 buffer_load_dwordx4 v24, s[24:27], s54 offen offset:0 lds
 buffer_load_dwordx4 v25, s[24:27], s54 offen offset:1024 lds
 buffer_load_dwordx4 v26, s[24:27], s54 offen offset:2048 lds
 buffer_load_dwordx4 v27, s[24:27], s54 offen offset:3072 lds
 s_waitcnt vmcnt(28)
 s_mov_b32 m0, 0x1000
 s_mov_b32 s54, 0x23280
 buffer_load_dwordx4 v24, s[24:27], s54 offen offset:0 lds
 buffer_load_dwordx4 v25, s[24:27], s54 offen offset:1024 lds
 buffer_load_dwordx4 v26, s[24:27], s54 offen offset:2048 lds
 buffer_load_dwordx4 v27, s[24:27], s54 offen offset:3072 lds
 s_waitcnt vmcnt(28)
 s_mov_b32 m0, 0x2000
 s_mov_b32 s54, 0x2a280
 buffer_load_dwordx4 v24, s[24:27], s54 offen offset:0 lds
 buffer_load_dwordx4 v25, s[24:27], s54 offen offset:1024 lds
 buffer_load_dwordx4 v26, s[24:27], s54 offen offset:2048 lds
 buffer_load_dwordx4 v27, s[24:27], s54 offen offset:3072 lds
 s_waitcnt vmcnt(28)
 s_mov_b32 m0, 0x3000
 s_mov_b32 s54, 0x31280
 buffer_load_dwordx4 v24, s[24:27], s54 offen offset:0 lds
 buffer_load_dwordx4 v25, s[24:27], s54 offen offset:1024 lds
 buffer_load_dwordx4 v26, s[24:27], s54 offen offset:2048 lds
 buffer_load_dwordx4 v27, s[24:27], s54 offen offset:3072 lds
 buffer_load_dword v60, v49, s[88:91], 0 offen sc1
 s_mov_b32 m0, 0x27c00
 s_movk_i32 s70, 676
 buffer_load_dword off, s[72:75], s70 lds
 s_cmpk_ge_u32 s52, 146
 s_cbranch_scc0 L_ls164
L_lb164:
 s_waitcnt vmcnt(28)
 s_mov_b32 m0, 0x22000
 s_mov_b32 s54, 0x60000
 buffer_load_dwordx4 v28, s[12:15], s54 offen offset:0 nt lds
 buffer_load_dwordx4 v29, s[12:15], s54 offen offset:1024 nt lds
 buffer_load_dwordx4 v30, s[12:15], s54 offen offset:2048 nt lds
 buffer_load_dwordx4 v31, s[12:15], s54 offen offset:3072 nt lds
 s_waitcnt vmcnt(28)
 s_mov_b32 m0, 0x24000
 s_mov_b32 s54, 0x5c000
 buffer_load_dwordx4 v16, s[16:19], s54 offen offset:0 nt lds
 buffer_load_dwordx4 v17, s[16:19], s54 offen offset:1024 nt lds
 buffer_load_dwordx4 v18, s[16:19], s54 offen offset:2048 nt lds
 buffer_load_dwordx4 v19, s[16:19], s54 offen offset:3072 nt lds
 s_waitcnt vmcnt(28)
 s_mov_b32 m0, 0x23000
 s_mov_b32 s54, 0x60080
 buffer_load_dwordx4 v28, s[12:15], s54 offen offset:0 nt lds
 buffer_load_dwordx4 v29, s[12:15], s54 offen offset:1024 nt lds
 buffer_load_dwordx4 v30, s[12:15], s54 offen offset:2048 nt lds
 buffer_load_dwordx4 v31, s[12:15], s54 offen offset:3072 nt lds
 s_waitcnt vmcnt(28)
 s_mov_b32 m0, 0x25000
 s_mov_b32 s54, 0x5c080
 buffer_load_dwordx4 v16, s[16:19], s54 offen offset:0 nt lds
 buffer_load_dwordx4 v17, s[16:19], s54 offen offset:1024 nt lds
 buffer_load_dwordx4 v18, s[16:19], s54 offen offset:2048 nt lds
 buffer_load_dwordx4 v19, s[16:19], s54 offen offset:3072 nt lds
 s_cmpk_ge_u32 s52, 148
 s_cbranch_scc0 L_ls165
L_lb165:
 s_waitcnt vmcnt(28)
 s_mov_b32 m0, 0x1e000
 s_mov_b32 s54, 0x60100
 buffer_load_dwordx4 v28, s[12:15], s54 offen offset:0 nt lds
 buffer_load_dwordx4 v29, s[12:15], s54 offen offset:1024 nt lds
 buffer_load_dwordx4 v30, s[12:15], s54 offen offset:2048 nt lds
 buffer_load_dwordx4 v31, s[12:15], s54 offen offset:3072 nt lds
 s_waitcnt vmcnt(28)
 s_mov_b32 m0, 0x10000
 s_mov_b32 s54, 0x5c100
 buffer_load_dwordx4 v16, s[16:19], s54 offen offset:0 nt lds
 buffer_load_dwordx4 v17, s[16:19], s54 offen offset:1024 nt lds
 buffer_load_dwordx4 v18, s[16:19], s54 offen offset:2048 nt lds
 buffer_load_dwordx4 v19, s[16:19], s54 offen offset:3072 nt lds
 s_waitcnt vmcnt(28)
 s_mov_b32 m0, 0x1f000
 s_mov_b32 s54, 0x60180
 buffer_load_dwordx4 v28, s[12:15], s54 offen offset:0 nt lds
 buffer_load_dwordx4 v29, s[12:15], s54 offen offset:1024 nt lds
 buffer_load_dwordx4 v30, s[12:15], s54 offen offset:2048 nt lds
 buffer_load_dwordx4 v31, s[12:15], s54 offen offset:3072 nt lds
 s_mov_b32 m0, 0x27c00
 s_movk_i32 s70, 688
 buffer_load_dword off, s[72:75], s70 lds
 s_waitcnt vmcnt(28)
 s_mov_b32 m0, 0x11000
 s_mov_b32 s54, 0x5c180
 buffer_load_dwordx4 v16, s[16:19], s54 offen offset:0 nt lds
 buffer_load_dwordx4 v17, s[16:19], s54 offen offset:1024 nt lds
 buffer_load_dwordx4 v18, s[16:19], s54 offen offset:2048 nt lds
 buffer_load_dwordx4 v19, s[16:19], s54 offen offset:3072 nt lds
 s_mov_b32 m0, 0x27c00
 s_movk_i32 s70, 692
 buffer_load_dword off, s[72:75], s70 lds
 s_cmpk_ge_u32 s52, 150
 s_cbranch_scc0 L_ls166
L_lb166:
 s_waitcnt vmcnt(28)
 s_mov_b32 m0, 0x4000
 s_mov_b32 s54, 0x300
 buffer_load_dwordx4 v24, s[24:27], s54 offen offset:0 lds
 buffer_load_dwordx4 v25, s[24:27], s54 offen offset:1024 lds
 buffer_load_dwordx4 v26, s[24:27], s54 offen offset:2048 lds
 buffer_load_dwordx4 v27, s[24:27], s54 offen offset:3072 lds
 s_waitcnt vmcnt(28)
 s_mov_b32 m0, 0x5000
 s_mov_b32 s54, 0x7300
 buffer_load_dwordx4 v24, s[24:27], s54 offen offset:0 lds
 buffer_load_dwordx4 v25, s[24:27], s54 offen offset:1024 lds
 buffer_load_dwordx4 v26, s[24:27], s54 offen offset:2048 lds
 buffer_load_dwordx4 v27, s[24:27], s54 offen offset:3072 lds
 s_waitcnt vmcnt(28)
 s_mov_b32 m0, 0x6000
 s_mov_b32 s54, 0xe300
 buffer_load_dwordx4 v24, s[24:27], s54 offen offset:0 lds
 buffer_load_dwordx4 v25, s[24:27], s54 offen offset:1024 lds
 buffer_load_dwordx4 v26, s[24:27], s54 offen offset:2048 lds
 buffer_load_dwordx4 v27, s[24:27], s54 offen offset:3072 lds
 s_waitcnt vmcnt(28)
 s_mov_b32 m0, 0x7000
 s_mov_b32 s54, 0x15300
 buffer_load_dwordx4 v24, s[24:27], s54 offen offset:0 lds
 buffer_load_dwordx4 v25, s[24:27], s54 offen offset:1024 lds
 buffer_load_dwordx4 v26, s[24:27], s54 offen offset:2048 lds
 buffer_load_dwordx4 v27, s[24:27], s54 offen offset:3072 lds
 s_branch L_clr1a
L_clra:
 s_add_u32 s57, s57, 1
 s_cmp_gt_u32 s57, 0x100000
 s_cbranch_scc1 L_exit0
 buffer_load_dword v60, v49, s[88:91], 0 offen offset:0 sc1
 s_waitcnt vmcnt(0)
L_clr1a:
 v_cmp_eq_u32 vcc, 1, v60
 s_cmp_eq_u32 vcc_lo, 1
 s_cbranch_scc0 L_clra
 s_mov_b32 m0, 0x27c00
 s_movk_i32 s70, 700
 buffer_load_dword off, s[72:75], s70 lds
 s_cmpk_ge_u32 s52, 152
 s_cbranch_scc0 L_ls170
L_lb170:
 s_waitcnt vmcnt(28)
 s_mov_b32 m0, 0x14000
 s_mov_b32 s54, 0x64000
 buffer_load_dwordx4 v28, s[12:15], s54 offen offset:0 nt lds
 buffer_load_dwordx4 v29, s[12:15], s54 offen offset:1024 nt lds
 buffer_load_dwordx4 v30, s[12:15], s54 offen offset:2048 nt lds
 buffer_load_dwordx4 v31, s[12:15], s54 offen offset:3072 nt lds
 s_waitcnt vmcnt(28)
 s_mov_b32 m0, 0x16000
 s_mov_b32 s54, 0x60000
 buffer_load_dwordx4 v16, s[16:19], s54 offen offset:0 nt lds
 buffer_load_dwordx4 v17, s[16:19], s54 offen offset:1024 nt lds
 buffer_load_dwordx4 v18, s[16:19], s54 offen offset:2048 nt lds
 buffer_load_dwordx4 v19, s[16:19], s54 offen offset:3072 nt lds
 s_waitcnt vmcnt(28)
 s_mov_b32 m0, 0x15000
 s_mov_b32 s54, 0x64080
 buffer_load_dwordx4 v28, s[12:15], s54 offen offset:0 nt lds
 buffer_load_dwordx4 v29, s[12:15], s54 offen offset:1024 nt lds
 buffer_load_dwordx4 v30, s[12:15], s54 offen offset:2048 nt lds
 buffer_load_dwordx4 v31, s[12:15], s54 offen offset:3072 nt lds
 s_waitcnt vmcnt(28)
 s_mov_b32 m0, 0x17000
 s_mov_b32 s54, 0x60080
 buffer_load_dwordx4 v16, s[16:19], s54 offen offset:0 nt lds
 buffer_load_dwordx4 v17, s[16:19], s54 offen offset:1024 nt lds
 buffer_load_dwordx4 v18, s[16:19], s54 offen offset:2048 nt lds
 buffer_load_dwordx4 v19, s[16:19], s54 offen offset:3072 nt lds
 s_cmpk_ge_u32 s52, 154
 s_cbranch_scc0 L_ls171
L_lb171:
 s_waitcnt vmcnt(28)
 s_mov_b32 m0, 0x12000
 s_mov_b32 s54, 0x64100
 buffer_load_dwordx4 v28, s[12:15], s54 offen offset:0 nt lds
 buffer_load_dwordx4 v29, s[12:15], s54 offen offset:1024 nt lds
 buffer_load_dwordx4 v30, s[12:15], s54 offen offset:2048 nt lds
 buffer_load_dwordx4 v31, s[12:15], s54 offen offset:3072 nt lds
 s_waitcnt vmcnt(28)
 s_mov_b32 m0, 0xc000
 s_mov_b32 s54, 0x60100
 buffer_load_dwordx4 v16, s[16:19], s54 offen offset:0 nt lds
 buffer_load_dwordx4 v17, s[16:19], s54 offen offset:1024 nt lds
 buffer_load_dwordx4 v18, s[16:19], s54 offen offset:2048 nt lds
 buffer_load_dwordx4 v19, s[16:19], s54 offen offset:3072 nt lds
 s_waitcnt vmcnt(28)
 s_mov_b32 m0, 0x13000
 s_mov_b32 s54, 0x64180
 buffer_load_dwordx4 v28, s[12:15], s54 offen offset:0 nt lds
 buffer_load_dwordx4 v29, s[12:15], s54 offen offset:1024 nt lds
 buffer_load_dwordx4 v30, s[12:15], s54 offen offset:2048 nt lds
 buffer_load_dwordx4 v31, s[12:15], s54 offen offset:3072 nt lds
 s_mov_b32 m0, 0x27c00
 s_movk_i32 s70, 712
 buffer_load_dword off, s[72:75], s70 lds
 s_waitcnt vmcnt(28)
 s_mov_b32 m0, 0xd000
 s_mov_b32 s54, 0x60180
 buffer_load_dwordx4 v16, s[16:19], s54 offen offset:0 nt lds
 buffer_load_dwordx4 v17, s[16:19], s54 offen offset:1024 nt lds
 buffer_load_dwordx4 v18, s[16:19], s54 offen offset:2048 nt lds
 buffer_load_dwordx4 v19, s[16:19], s54 offen offset:3072 nt lds
 s_mov_b32 m0, 0x27c00
 s_movk_i32 s70, 716
 buffer_load_dword off, s[72:75], s70 lds
 s_cmpk_ge_u32 s52, 156
 s_cbranch_scc0 L_ls172
L_lb172:
 s_waitcnt vmcnt(28)
 s_mov_b32 m0, 0xa000
 s_mov_b32 s54, 0x1c300
 buffer_load_dwordx4 v24, s[24:27], s54 offen offset:0 lds
 buffer_load_dwordx4 v25, s[24:27], s54 offen offset:1024 lds
 buffer_load_dwordx4 v26, s[24:27], s54 offen offset:2048 lds
 buffer_load_dwordx4 v27, s[24:27], s54 offen offset:3072 lds
 s_waitcnt vmcnt(28)
 s_mov_b32 m0, 0xb000
 s_mov_b32 s54, 0x23300
 buffer_load_dwordx4 v24, s[24:27], s54 offen offset:0 lds
 buffer_load_dwordx4 v25, s[24:27], s54 offen offset:1024 lds
 buffer_load_dwordx4 v26, s[24:27], s54 offen offset:2048 lds
 buffer_load_dwordx4 v27, s[24:27], s54 offen offset:3072 lds
 s_waitcnt vmcnt(28)
 s_mov_b32 m0, 0x8000
 s_mov_b32 s54, 0x2a300
 buffer_load_dwordx4 v24, s[24:27], s54 offen offset:0 lds
 buffer_load_dwordx4 v25, s[24:27], s54 offen offset:1024 lds
 buffer_load_dwordx4 v26, s[24:27], s54 offen offset:2048 lds
 buffer_load_dwordx4 v27, s[24:27], s54 offen offset:3072 lds
 s_waitcnt vmcnt(28)
 s_mov_b32 m0, 0x9000
 s_mov_b32 s54, 0x31300
 buffer_load_dwordx4 v24, s[24:27], s54 offen offset:0 lds
 buffer_load_dwordx4 v25, s[24:27], s54 offen offset:1024 lds
 buffer_load_dwordx4 v26, s[24:27], s54 offen offset:2048 lds
 buffer_load_dwordx4 v27, s[24:27], s54 offen offset:3072 lds
 s_mov_b32 m0, 0x27c00
 s_movk_i32 s70, 724
 buffer_load_dword off, s[72:75], s70 lds
 s_cmpk_ge_u32 s52, 158
 s_cbranch_scc0 L_ls176
L_lb176:
 s_waitcnt vmcnt(28)
 s_mov_b32 m0, 0x18000
 s_mov_b32 s54, 0x68000
 buffer_load_dwordx4 v28, s[12:15], s54 offen offset:0 nt lds
 buffer_load_dwordx4 v29, s[12:15], s54 offen offset:1024 nt lds
 buffer_load_dwordx4 v30, s[12:15], s54 offen offset:2048 nt lds
 buffer_load_dwordx4 v31, s[12:15], s54 offen offset:3072 nt lds
 s_waitcnt vmcnt(28)
 s_mov_b32 m0, 0x1a000
 s_mov_b32 s54, 0x64000
 buffer_load_dwordx4 v16, s[16:19], s54 offen offset:0 nt lds
 buffer_load_dwordx4 v17, s[16:19], s54 offen offset:1024 nt lds
 buffer_load_dwordx4 v18, s[16:19], s54 offen offset:2048 nt lds
 buffer_load_dwordx4 v19, s[16:19], s54 offen offset:3072 nt lds
 s_waitcnt vmcnt(28)
 s_mov_b32 m0, 0x19000
 s_mov_b32 s54, 0x68080
 buffer_load_dwordx4 v28, s[12:15], s54 offen offset:0 nt lds
 buffer_load_dwordx4 v29, s[12:15], s54 offen offset:1024 nt lds
 buffer_load_dwordx4 v30, s[12:15], s54 offen offset:2048 nt lds
 buffer_load_dwordx4 v31, s[12:15], s54 offen offset:3072 nt lds
 s_waitcnt vmcnt(28)
 s_mov_b32 m0, 0x1b000
 s_mov_b32 s54, 0x64080
 buffer_load_dwordx4 v16, s[16:19], s54 offen offset:0 nt lds
 buffer_load_dwordx4 v17, s[16:19], s54 offen offset:1024 nt lds
 buffer_load_dwordx4 v18, s[16:19], s54 offen offset:2048 nt lds
 buffer_load_dwordx4 v19, s[16:19], s54 offen offset:3072 nt lds
 s_cmpk_ge_u32 s52, 160
 s_cbranch_scc0 L_ls177
L_lb177:
 s_waitcnt vmcnt(28)
 s_mov_b32 m0, 0xe000
 s_mov_b32 s54, 0x68100
 buffer_load_dwordx4 v28, s[12:15], s54 offen offset:0 nt lds
 buffer_load_dwordx4 v29, s[12:15], s54 offen offset:1024 nt lds
 buffer_load_dwordx4 v30, s[12:15], s54 offen offset:2048 nt lds
 buffer_load_dwordx4 v31, s[12:15], s54 offen offset:3072 nt lds
 s_waitcnt vmcnt(28)
 s_mov_b32 m0, 0x1c000
 s_mov_b32 s54, 0x64100
 buffer_load_dwordx4 v16, s[16:19], s54 offen offset:0 nt lds
 buffer_load_dwordx4 v17, s[16:19], s54 offen offset:1024 nt lds
 buffer_load_dwordx4 v18, s[16:19], s54 offen offset:2048 nt lds
 buffer_load_dwordx4 v19, s[16:19], s54 offen offset:3072 nt lds
 s_waitcnt vmcnt(28)
 s_mov_b32 m0, 0xf000
 s_mov_b32 s54, 0x68180
 buffer_load_dwordx4 v28, s[12:15], s54 offen offset:0 nt lds
 buffer_load_dwordx4 v29, s[12:15], s54 offen offset:1024 nt lds
 buffer_load_dwordx4 v30, s[12:15], s54 offen offset:2048 nt lds
 buffer_load_dwordx4 v31, s[12:15], s54 offen offset:3072 nt lds
 s_mov_b32 m0, 0x27c00
 s_movk_i32 s70, 736
 buffer_load_dword off, s[72:75], s70 lds
 s_waitcnt vmcnt(28)
 s_mov_b32 m0, 0x1d000
 s_mov_b32 s54, 0x64180
 buffer_load_dwordx4 v16, s[16:19], s54 offen offset:0 nt lds
 buffer_load_dwordx4 v17, s[16:19], s54 offen offset:1024 nt lds
 buffer_load_dwordx4 v18, s[16:19], s54 offen offset:2048 nt lds
 buffer_load_dwordx4 v19, s[16:19], s54 offen offset:3072 nt lds
 s_mov_b32 m0, 0x27c00
 s_movk_i32 s70, 740
 buffer_load_dword off, s[72:75], s70 lds
 s_cmpk_ge_u32 s52, 162
 s_cbranch_scc0 L_ls178
L_lb178:
 s_waitcnt vmcnt(28)
 s_mov_b32 m0, 0x0
 s_mov_b32 s54, 0x0
 buffer_load_dwordx4 v24, s[24:27], s54 offen offset:0 lds
 buffer_load_dwordx4 v25, s[24:27], s54 offen offset:1024 lds
 buffer_load_dwordx4 v26, s[24:27], s54 offen offset:2048 lds
 buffer_load_dwordx4 v27, s[24:27], s54 offen offset:3072 lds
 s_waitcnt vmcnt(28)
 s_mov_b32 m0, 0x1000
 s_mov_b32 s54, 0x7000
 buffer_load_dwordx4 v24, s[24:27], s54 offen offset:0 lds
 buffer_load_dwordx4 v25, s[24:27], s54 offen offset:1024 lds
 buffer_load_dwordx4 v26, s[24:27], s54 offen offset:2048 lds
 buffer_load_dwordx4 v27, s[24:27], s54 offen offset:3072 lds
 s_waitcnt vmcnt(28)
 s_mov_b32 m0, 0x2000
 s_mov_b32 s54, 0xe000
 buffer_load_dwordx4 v24, s[24:27], s54 offen offset:0 lds
 buffer_load_dwordx4 v25, s[24:27], s54 offen offset:1024 lds
 buffer_load_dwordx4 v26, s[24:27], s54 offen offset:2048 lds
 buffer_load_dwordx4 v27, s[24:27], s54 offen offset:3072 lds
 s_waitcnt vmcnt(28)
 s_mov_b32 m0, 0x3000
 s_mov_b32 s54, 0x15000
 buffer_load_dwordx4 v24, s[24:27], s54 offen offset:0 lds
 buffer_load_dwordx4 v25, s[24:27], s54 offen offset:1024 lds
 buffer_load_dwordx4 v26, s[24:27], s54 offen offset:2048 lds
 buffer_load_dwordx4 v27, s[24:27], s54 offen offset:3072 lds
 s_mov_b32 m0, 0x27c00
 s_movk_i32 s70, 748
 buffer_load_dword off, s[72:75], s70 lds
 s_cmpk_ge_u32 s52, 164
 s_cbranch_scc0 L_ls182
L_lb182:
 s_waitcnt vmcnt(28)
 s_mov_b32 m0, 0x20000
 s_mov_b32 s54, 0x6c000
 buffer_load_dwordx4 v28, s[12:15], s54 offen offset:0 nt lds
 buffer_load_dwordx4 v29, s[12:15], s54 offen offset:1024 nt lds
 buffer_load_dwordx4 v30, s[12:15], s54 offen offset:2048 nt lds
 buffer_load_dwordx4 v31, s[12:15], s54 offen offset:3072 nt lds
 s_waitcnt vmcnt(28)
 s_mov_b32 m0, 0x22000
 s_mov_b32 s54, 0x68000
 buffer_load_dwordx4 v16, s[16:19], s54 offen offset:0 nt lds
 buffer_load_dwordx4 v17, s[16:19], s54 offen offset:1024 nt lds
 buffer_load_dwordx4 v18, s[16:19], s54 offen offset:2048 nt lds
 buffer_load_dwordx4 v19, s[16:19], s54 offen offset:3072 nt lds
 s_waitcnt vmcnt(28)
 s_mov_b32 m0, 0x21000
 s_mov_b32 s54, 0x6c080
 buffer_load_dwordx4 v28, s[12:15], s54 offen offset:0 nt lds
 buffer_load_dwordx4 v29, s[12:15], s54 offen offset:1024 nt lds
 buffer_load_dwordx4 v30, s[12:15], s54 offen offset:2048 nt lds
 buffer_load_dwordx4 v31, s[12:15], s54 offen offset:3072 nt lds
 s_waitcnt vmcnt(28)
 s_mov_b32 m0, 0x23000
 s_mov_b32 s54, 0x68080
 buffer_load_dwordx4 v16, s[16:19], s54 offen offset:0 nt lds
 buffer_load_dwordx4 v17, s[16:19], s54 offen offset:1024 nt lds
 buffer_load_dwordx4 v18, s[16:19], s54 offen offset:2048 nt lds
 buffer_load_dwordx4 v19, s[16:19], s54 offen offset:3072 nt lds
 s_cmpk_ge_u32 s52, 166
 s_cbranch_scc0 L_ls183
L_lb183:
 s_waitcnt vmcnt(28)
 s_mov_b32 m0, 0x1e000
 s_mov_b32 s54, 0x6c100
 buffer_load_dwordx4 v28, s[12:15], s54 offen offset:0 nt lds
 buffer_load_dwordx4 v29, s[12:15], s54 offen offset:1024 nt lds
 buffer_load_dwordx4 v30, s[12:15], s54 offen offset:2048 nt lds
 buffer_load_dwordx4 v31, s[12:15], s54 offen offset:3072 nt lds
 s_waitcnt vmcnt(28)
 s_mov_b32 m0, 0x24000
 s_mov_b32 s54, 0x68100
 buffer_load_dwordx4 v16, s[16:19], s54 offen offset:0 nt lds
 buffer_load_dwordx4 v17, s[16:19], s54 offen offset:1024 nt lds
 buffer_load_dwordx4 v18, s[16:19], s54 offen offset:2048 nt lds
 buffer_load_dwordx4 v19, s[16:19], s54 offen offset:3072 nt lds
 s_waitcnt vmcnt(28)
 s_mov_b32 m0, 0x1f000
 s_mov_b32 s54, 0x6c180
 buffer_load_dwordx4 v28, s[12:15], s54 offen offset:0 nt lds
 buffer_load_dwordx4 v29, s[12:15], s54 offen offset:1024 nt lds
 buffer_load_dwordx4 v30, s[12:15], s54 offen offset:2048 nt lds
 buffer_load_dwordx4 v31, s[12:15], s54 offen offset:3072 nt lds
 s_mov_b32 m0, 0x27c00
 s_movk_i32 s70, 760
 buffer_load_dword off, s[72:75], s70 lds
 s_waitcnt vmcnt(28)
 s_mov_b32 m0, 0x25000
 s_mov_b32 s54, 0x68180
 buffer_load_dwordx4 v16, s[16:19], s54 offen offset:0 nt lds
 buffer_load_dwordx4 v17, s[16:19], s54 offen offset:1024 nt lds
 buffer_load_dwordx4 v18, s[16:19], s54 offen offset:2048 nt lds
 buffer_load_dwordx4 v19, s[16:19], s54 offen offset:3072 nt lds
 s_mov_b32 m0, 0x27c00
 s_movk_i32 s70, 764
 buffer_load_dword off, s[72:75], s70 lds
 s_cmpk_ge_u32 s52, 168
 s_cbranch_scc0 L_ls184
L_lb184:
 s_waitcnt vmcnt(28)
 s_mov_b32 m0, 0x4000
 s_mov_b32 s54, 0x1c000
 buffer_load_dwordx4 v24, s[24:27], s54 offen offset:0 lds
 buffer_load_dwordx4 v25, s[24:27], s54 offen offset:1024 lds
 buffer_load_dwordx4 v26, s[24:27], s54 offen offset:2048 lds
 buffer_load_dwordx4 v27, s[24:27], s54 offen offset:3072 lds
 s_waitcnt vmcnt(28)
 s_mov_b32 m0, 0x5000
 s_mov_b32 s54, 0x23000
 buffer_load_dwordx4 v24, s[24:27], s54 offen offset:0 lds
 buffer_load_dwordx4 v25, s[24:27], s54 offen offset:1024 lds
 buffer_load_dwordx4 v26, s[24:27], s54 offen offset:2048 lds
 buffer_load_dwordx4 v27, s[24:27], s54 offen offset:3072 lds
 s_waitcnt vmcnt(28)
 s_mov_b32 m0, 0x6000
 s_mov_b32 s54, 0x2a000
 buffer_load_dwordx4 v24, s[24:27], s54 offen offset:0 lds
 buffer_load_dwordx4 v25, s[24:27], s54 offen offset:1024 lds
 buffer_load_dwordx4 v26, s[24:27], s54 offen offset:2048 lds
 buffer_load_dwordx4 v27, s[24:27], s54 offen offset:3072 lds
 s_waitcnt vmcnt(28)
 s_mov_b32 m0, 0x7000
 s_mov_b32 s54, 0x31000
 buffer_load_dwordx4 v24, s[24:27], s54 offen offset:0 lds
 buffer_load_dwordx4 v25, s[24:27], s54 offen offset:1024 lds
 buffer_load_dwordx4 v26, s[24:27], s54 offen offset:2048 lds
 buffer_load_dwordx4 v27, s[24:27], s54 offen offset:3072 lds
 s_mov_b32 m0, 0x27c00
 s_movk_i32 s70, 772
 buffer_load_dword off, s[72:75], s70 lds
 s_cmpk_ge_u32 s52, 170
 s_cbranch_scc0 L_ls188
L_lb188:
 s_waitcnt vmcnt(28)
 s_mov_b32 m0, 0x10000
 s_mov_b32 s54, 0x70000
 buffer_load_dwordx4 v28, s[12:15], s54 offen offset:0 nt lds
 buffer_load_dwordx4 v29, s[12:15], s54 offen offset:1024 nt lds
 buffer_load_dwordx4 v30, s[12:15], s54 offen offset:2048 nt lds
 buffer_load_dwordx4 v31, s[12:15], s54 offen offset:3072 nt lds
 s_waitcnt vmcnt(28)
 s_mov_b32 m0, 0x14000
 s_mov_b32 s54, 0x6c000
 buffer_load_dwordx4 v16, s[16:19], s54 offen offset:0 nt lds
 buffer_load_dwordx4 v17, s[16:19], s54 offen offset:1024 nt lds
 buffer_load_dwordx4 v18, s[16:19], s54 offen offset:2048 nt lds
 buffer_load_dwordx4 v19, s[16:19], s54 offen offset:3072 nt lds
 s_waitcnt vmcnt(28)
 s_mov_b32 m0, 0x11000
 s_mov_b32 s54, 0x70080
 buffer_load_dwordx4 v28, s[12:15], s54 offen offset:0 nt lds
 buffer_load_dwordx4 v29, s[12:15], s54 offen offset:1024 nt lds
 buffer_load_dwordx4 v30, s[12:15], s54 offen offset:2048 nt lds
 buffer_load_dwordx4 v31, s[12:15], s54 offen offset:3072 nt lds
 s_waitcnt vmcnt(28)
 s_mov_b32 m0, 0x15000
 s_mov_b32 s54, 0x6c080
 buffer_load_dwordx4 v16, s[16:19], s54 offen offset:0 nt lds
 buffer_load_dwordx4 v17, s[16:19], s54 offen offset:1024 nt lds
 buffer_load_dwordx4 v18, s[16:19], s54 offen offset:2048 nt lds
 buffer_load_dwordx4 v19, s[16:19], s54 offen offset:3072 nt lds
 s_cmpk_ge_u32 s52, 172
 s_cbranch_scc0 L_ls189
L_lb189:
 s_waitcnt vmcnt(28)
 s_mov_b32 m0, 0x12000
 s_mov_b32 s54, 0x70100
 buffer_load_dwordx4 v28, s[12:15], s54 offen offset:0 nt lds
 buffer_load_dwordx4 v29, s[12:15], s54 offen offset:1024 nt lds
 buffer_load_dwordx4 v30, s[12:15], s54 offen offset:2048 nt lds
 buffer_load_dwordx4 v31, s[12:15], s54 offen offset:3072 nt lds
 s_waitcnt vmcnt(28)
 s_mov_b32 m0, 0x16000
 s_mov_b32 s54, 0x6c100
 buffer_load_dwordx4 v16, s[16:19], s54 offen offset:0 nt lds
 buffer_load_dwordx4 v17, s[16:19], s54 offen offset:1024 nt lds
 buffer_load_dwordx4 v18, s[16:19], s54 offen offset:2048 nt lds
 buffer_load_dwordx4 v19, s[16:19], s54 offen offset:3072 nt lds
 s_waitcnt vmcnt(28)
 s_mov_b32 m0, 0x13000
 s_mov_b32 s54, 0x70180
 buffer_load_dwordx4 v28, s[12:15], s54 offen offset:0 nt lds
 buffer_load_dwordx4 v29, s[12:15], s54 offen offset:1024 nt lds
 buffer_load_dwordx4 v30, s[12:15], s54 offen offset:2048 nt lds
 buffer_load_dwordx4 v31, s[12:15], s54 offen offset:3072 nt lds
 s_mov_b32 m0, 0x27c00
 s_movk_i32 s70, 784
 buffer_load_dword off, s[72:75], s70 lds
 s_waitcnt vmcnt(28)
 s_mov_b32 m0, 0x17000
 s_mov_b32 s54, 0x6c180
 buffer_load_dwordx4 v16, s[16:19], s54 offen offset:0 nt lds
 buffer_load_dwordx4 v17, s[16:19], s54 offen offset:1024 nt lds
 buffer_load_dwordx4 v18, s[16:19], s54 offen offset:2048 nt lds
 buffer_load_dwordx4 v19, s[16:19], s54 offen offset:3072 nt lds
 s_mov_b32 m0, 0x27c00
 s_movk_i32 s70, 788
 buffer_load_dword off, s[72:75], s70 lds
 s_cmpk_ge_u32 s52, 174
 s_cbranch_scc0 L_ls190
L_lb190:
 s_waitcnt vmcnt(28)
 s_mov_b32 m0, 0xa000
 s_mov_b32 s54, 0x80
 buffer_load_dwordx4 v24, s[24:27], s54 offen offset:0 lds
 buffer_load_dwordx4 v25, s[24:27], s54 offen offset:1024 lds
 buffer_load_dwordx4 v26, s[24:27], s54 offen offset:2048 lds
 buffer_load_dwordx4 v27, s[24:27], s54 offen offset:3072 lds
 s_waitcnt vmcnt(28)
 s_mov_b32 m0, 0xb000
 s_mov_b32 s54, 0x7080
 buffer_load_dwordx4 v24, s[24:27], s54 offen offset:0 lds
 buffer_load_dwordx4 v25, s[24:27], s54 offen offset:1024 lds
 buffer_load_dwordx4 v26, s[24:27], s54 offen offset:2048 lds
 buffer_load_dwordx4 v27, s[24:27], s54 offen offset:3072 lds
 s_waitcnt vmcnt(32)
 s_mov_b32 m0, 0x8000
 s_mov_b32 s54, 0xe080
 buffer_load_dwordx4 v24, s[24:27], s54 offen offset:0 lds
 buffer_load_dwordx4 v25, s[24:27], s54 offen offset:1024 lds
 buffer_load_dwordx4 v26, s[24:27], s54 offen offset:2048 lds
 buffer_load_dwordx4 v27, s[24:27], s54 offen offset:3072 lds
 s_waitcnt vmcnt(32)
 s_mov_b32 m0, 0x9000
 s_mov_b32 s54, 0x15080
 buffer_load_dwordx4 v24, s[24:27], s54 offen offset:0 lds
 buffer_load_dwordx4 v25, s[24:27], s54 offen offset:1024 lds
 buffer_load_dwordx4 v26, s[24:27], s54 offen offset:2048 lds
 buffer_load_dwordx4 v27, s[24:27], s54 offen offset:3072 lds
 s_mov_b32 m0, 0x27c00
 s_movk_i32 s70, 796
 buffer_load_dword off, s[72:75], s70 lds
 s_cmpk_ge_u32 s52, 176
 s_cbranch_scc0 L_ls194
L_lb194:
 s_waitcnt vmcnt(32)
 s_mov_b32 m0, 0xc000
 s_mov_b32 s54, 0x74000
 buffer_load_dwordx4 v28, s[12:15], s54 offen offset:0 nt lds
 buffer_load_dwordx4 v29, s[12:15], s54 offen offset:1024 nt lds
 buffer_load_dwordx4 v30, s[12:15], s54 offen offset:2048 nt lds
 buffer_load_dwordx4 v31, s[12:15], s54 offen offset:3072 nt lds
 s_waitcnt vmcnt(32)
 s_mov_b32 m0, 0x18000
 s_mov_b32 s54, 0x70000
 buffer_load_dwordx4 v16, s[16:19], s54 offen offset:0 nt lds
 buffer_load_dwordx4 v17, s[16:19], s54 offen offset:1024 nt lds
 buffer_load_dwordx4 v18, s[16:19], s54 offen offset:2048 nt lds
 buffer_load_dwordx4 v19, s[16:19], s54 offen offset:3072 nt lds
 s_waitcnt vmcnt(32)
 s_mov_b32 m0, 0xd000
 s_mov_b32 s54, 0x74080
 buffer_load_dwordx4 v28, s[12:15], s54 offen offset:0 nt lds
 buffer_load_dwordx4 v29, s[12:15], s54 offen offset:1024 nt lds
 buffer_load_dwordx4 v30, s[12:15], s54 offen offset:2048 nt lds
 buffer_load_dwordx4 v31, s[12:15], s54 offen offset:3072 nt lds
 s_waitcnt vmcnt(32)
 s_mov_b32 m0, 0x19000
 s_mov_b32 s54, 0x70080
 buffer_load_dwordx4 v16, s[16:19], s54 offen offset:0 nt lds
 buffer_load_dwordx4 v17, s[16:19], s54 offen offset:1024 nt lds
 buffer_load_dwordx4 v18, s[16:19], s54 offen offset:2048 nt lds
 buffer_load_dwordx4 v19, s[16:19], s54 offen offset:3072 nt lds
 s_cmpk_ge_u32 s52, 178
 s_cbranch_scc0 L_ls195
L_lb195:
 s_waitcnt vmcnt(32)
 s_mov_b32 m0, 0xe000
 s_mov_b32 s54, 0x74100
 buffer_load_dwordx4 v28, s[12:15], s54 offen offset:0 nt lds
 buffer_load_dwordx4 v29, s[12:15], s54 offen offset:1024 nt lds
 buffer_load_dwordx4 v30, s[12:15], s54 offen offset:2048 nt lds
 buffer_load_dwordx4 v31, s[12:15], s54 offen offset:3072 nt lds
 s_waitcnt vmcnt(32)
 s_mov_b32 m0, 0x1a000
 s_mov_b32 s54, 0x70100
 buffer_load_dwordx4 v16, s[16:19], s54 offen offset:0 nt lds
 buffer_load_dwordx4 v17, s[16:19], s54 offen offset:1024 nt lds
 buffer_load_dwordx4 v18, s[16:19], s54 offen offset:2048 nt lds
 buffer_load_dwordx4 v19, s[16:19], s54 offen offset:3072 nt lds
 s_waitcnt vmcnt(32)
 s_mov_b32 m0, 0xf000
 s_mov_b32 s54, 0x74180
 buffer_load_dwordx4 v28, s[12:15], s54 offen offset:0 nt lds
 buffer_load_dwordx4 v29, s[12:15], s54 offen offset:1024 nt lds
 buffer_load_dwordx4 v30, s[12:15], s54 offen offset:2048 nt lds
 buffer_load_dwordx4 v31, s[12:15], s54 offen offset:3072 nt lds
 s_mov_b32 m0, 0x27c00
 s_movk_i32 s70, 808
 buffer_load_dword off, s[72:75], s70 lds
 s_waitcnt vmcnt(32)
 s_mov_b32 m0, 0x1b000
 s_mov_b32 s54, 0x70180
 buffer_load_dwordx4 v16, s[16:19], s54 offen offset:0 nt lds
 buffer_load_dwordx4 v17, s[16:19], s54 offen offset:1024 nt lds
 buffer_load_dwordx4 v18, s[16:19], s54 offen offset:2048 nt lds
 buffer_load_dwordx4 v19, s[16:19], s54 offen offset:3072 nt lds
 s_mov_b32 m0, 0x27c00
 s_movk_i32 s70, 812
 buffer_load_dword off, s[72:75], s70 lds
 s_cmpk_ge_u32 s52, 180
 s_cbranch_scc0 L_ls196
L_lb196:
 s_waitcnt vmcnt(32)
 s_mov_b32 m0, 0x0
 s_mov_b32 s54, 0x1c080
 buffer_load_dwordx4 v24, s[24:27], s54 offen offset:0 lds
 buffer_load_dwordx4 v25, s[24:27], s54 offen offset:1024 lds
 buffer_load_dwordx4 v26, s[24:27], s54 offen offset:2048 lds
 buffer_load_dwordx4 v27, s[24:27], s54 offen offset:3072 lds
 s_waitcnt vmcnt(32)
 s_mov_b32 m0, 0x1000
 s_mov_b32 s54, 0x23080
 buffer_load_dwordx4 v24, s[24:27], s54 offen offset:0 lds
 buffer_load_dwordx4 v25, s[24:27], s54 offen offset:1024 lds
 buffer_load_dwordx4 v26, s[24:27], s54 offen offset:2048 lds
 buffer_load_dwordx4 v27, s[24:27], s54 offen offset:3072 lds
 s_waitcnt vmcnt(32)
 s_mov_b32 m0, 0x2000
 s_mov_b32 s54, 0x2a080
 buffer_load_dwordx4 v24, s[24:27], s54 offen offset:0 lds
 buffer_load_dwordx4 v25, s[24:27], s54 offen offset:1024 lds
 buffer_load_dwordx4 v26, s[24:27], s54 offen offset:2048 lds
 buffer_load_dwordx4 v27, s[24:27], s54 offen offset:3072 lds
 s_waitcnt vmcnt(32)
 s_mov_b32 m0, 0x3000
 s_mov_b32 s54, 0x31080
 buffer_load_dwordx4 v24, s[24:27], s54 offen offset:0 lds
 buffer_load_dwordx4 v25, s[24:27], s54 offen offset:1024 lds
 buffer_load_dwordx4 v26, s[24:27], s54 offen offset:2048 lds
 buffer_load_dwordx4 v27, s[24:27], s54 offen offset:3072 lds
 s_mov_b32 m0, 0x27c00
 s_movk_i32 s70, 820
 buffer_load_dword off, s[72:75], s70 lds
 s_cmpk_ge_u32 s52, 182
 s_cbranch_scc0 L_ls200
L_lb200:
 s_waitcnt vmcnt(32)
 s_mov_b32 m0, 0x1c000
 s_mov_b32 s54, 0x78000
 buffer_load_dwordx4 v28, s[12:15], s54 offen offset:0 nt lds
 buffer_load_dwordx4 v29, s[12:15], s54 offen offset:1024 nt lds
 buffer_load_dwordx4 v30, s[12:15], s54 offen offset:2048 nt lds
 buffer_load_dwordx4 v31, s[12:15], s54 offen offset:3072 nt lds
 s_waitcnt vmcnt(32)
 s_mov_b32 m0, 0x20000
 s_mov_b32 s54, 0x74000
 buffer_load_dwordx4 v16, s[16:19], s54 offen offset:0 nt lds
 buffer_load_dwordx4 v17, s[16:19], s54 offen offset:1024 nt lds
 buffer_load_dwordx4 v18, s[16:19], s54 offen offset:2048 nt lds
 buffer_load_dwordx4 v19, s[16:19], s54 offen offset:3072 nt lds
 s_waitcnt vmcnt(32)
 s_mov_b32 m0, 0x1d000
 s_mov_b32 s54, 0x78080
 buffer_load_dwordx4 v28, s[12:15], s54 offen offset:0 nt lds
 buffer_load_dwordx4 v29, s[12:15], s54 offen offset:1024 nt lds
 buffer_load_dwordx4 v30, s[12:15], s54 offen offset:2048 nt lds
 buffer_load_dwordx4 v31, s[12:15], s54 offen offset:3072 nt lds
 s_waitcnt vmcnt(32)
 s_mov_b32 m0, 0x21000
 s_mov_b32 s54, 0x74080
 buffer_load_dwordx4 v16, s[16:19], s54 offen offset:0 nt lds
 buffer_load_dwordx4 v17, s[16:19], s54 offen offset:1024 nt lds
 buffer_load_dwordx4 v18, s[16:19], s54 offen offset:2048 nt lds
 buffer_load_dwordx4 v19, s[16:19], s54 offen offset:3072 nt lds
 s_cmpk_ge_u32 s52, 184
 s_cbranch_scc0 L_ls201
L_lb201:
 s_waitcnt vmcnt(32)
 s_mov_b32 m0, 0x1e000
 s_mov_b32 s54, 0x78100
 buffer_load_dwordx4 v28, s[12:15], s54 offen offset:0 nt lds
 buffer_load_dwordx4 v29, s[12:15], s54 offen offset:1024 nt lds
 buffer_load_dwordx4 v30, s[12:15], s54 offen offset:2048 nt lds
 buffer_load_dwordx4 v31, s[12:15], s54 offen offset:3072 nt lds
 s_waitcnt vmcnt(32)
 s_mov_b32 m0, 0x22000
 s_mov_b32 s54, 0x74100
 buffer_load_dwordx4 v16, s[16:19], s54 offen offset:0 nt lds
 buffer_load_dwordx4 v17, s[16:19], s54 offen offset:1024 nt lds
 buffer_load_dwordx4 v18, s[16:19], s54 offen offset:2048 nt lds
 buffer_load_dwordx4 v19, s[16:19], s54 offen offset:3072 nt lds
 s_waitcnt vmcnt(32)
 s_mov_b32 m0, 0x1f000
 s_mov_b32 s54, 0x78180
 buffer_load_dwordx4 v28, s[12:15], s54 offen offset:0 nt lds
 buffer_load_dwordx4 v29, s[12:15], s54 offen offset:1024 nt lds
 buffer_load_dwordx4 v30, s[12:15], s54 offen offset:2048 nt lds
 buffer_load_dwordx4 v31, s[12:15], s54 offen offset:3072 nt lds
 s_mov_b32 m0, 0x27c00
 s_movk_i32 s70, 832
 buffer_load_dword off, s[72:75], s70 lds
 s_waitcnt vmcnt(32)
 s_mov_b32 m0, 0x23000
 s_mov_b32 s54, 0x74180
 buffer_load_dwordx4 v16, s[16:19], s54 offen offset:0 nt lds
 buffer_load_dwordx4 v17, s[16:19], s54 offen offset:1024 nt lds
 buffer_load_dwordx4 v18, s[16:19], s54 offen offset:2048 nt lds
 buffer_load_dwordx4 v19, s[16:19], s54 offen offset:3072 nt lds
 s_mov_b32 m0, 0x27c00
 s_movk_i32 s70, 836
 buffer_load_dword off, s[72:75], s70 lds
 s_cmpk_ge_u32 s52, 186
 s_cbranch_scc0 L_ls202
L_lb202:
 s_waitcnt vmcnt(32)
 s_mov_b32 m0, 0x4000
 s_mov_b32 s54, 0x100
 buffer_load_dwordx4 v24, s[24:27], s54 offen offset:0 lds
 buffer_load_dwordx4 v25, s[24:27], s54 offen offset:1024 lds
 buffer_load_dwordx4 v26, s[24:27], s54 offen offset:2048 lds
 buffer_load_dwordx4 v27, s[24:27], s54 offen offset:3072 lds
 s_waitcnt vmcnt(32)
 s_mov_b32 m0, 0x5000
 s_mov_b32 s54, 0x7100
 buffer_load_dwordx4 v24, s[24:27], s54 offen offset:0 lds
 buffer_load_dwordx4 v25, s[24:27], s54 offen offset:1024 lds
 buffer_load_dwordx4 v26, s[24:27], s54 offen offset:2048 lds
 buffer_load_dwordx4 v27, s[24:27], s54 offen offset:3072 lds
 s_waitcnt vmcnt(32)
 s_mov_b32 m0, 0x6000
 s_mov_b32 s54, 0xe100
 buffer_load_dwordx4 v24, s[24:27], s54 offen offset:0 lds
 buffer_load_dwordx4 v25, s[24:27], s54 offen offset:1024 lds
 buffer_load_dwordx4 v26, s[24:27], s54 offen offset:2048 lds
 buffer_load_dwordx4 v27, s[24:27], s54 offen offset:3072 lds
 s_waitcnt vmcnt(32)
 s_mov_b32 m0, 0x7000
 s_mov_b32 s54, 0x15100
 buffer_load_dwordx4 v24, s[24:27], s54 offen offset:0 lds
 buffer_load_dwordx4 v25, s[24:27], s54 offen offset:1024 lds
 buffer_load_dwordx4 v26, s[24:27], s54 offen offset:2048 lds
 buffer_load_dwordx4 v27, s[24:27], s54 offen offset:3072 lds
 s_mov_b32 m0, 0x27c00
 s_movk_i32 s70, 844
 buffer_load_dword off, s[72:75], s70 lds
 s_cmpk_ge_u32 s52, 188
 s_cbranch_scc0 L_ls206
L_lb206:
 s_waitcnt vmcnt(32)
 s_mov_b32 m0, 0x24000
 s_mov_b32 s54, 0x7c000
 buffer_load_dwordx4 v28, s[12:15], s54 offen offset:0 nt lds
 buffer_load_dwordx4 v29, s[12:15], s54 offen offset:1024 nt lds
 buffer_load_dwordx4 v30, s[12:15], s54 offen offset:2048 nt lds
 buffer_load_dwordx4 v31, s[12:15], s54 offen offset:3072 nt lds
 s_waitcnt vmcnt(32)
 s_mov_b32 m0, 0x10000
 s_mov_b32 s54, 0x78000
 buffer_load_dwordx4 v16, s[16:19], s54 offen offset:0 nt lds
 buffer_load_dwordx4 v17, s[16:19], s54 offen offset:1024 nt lds
 buffer_load_dwordx4 v18, s[16:19], s54 offen offset:2048 nt lds
 buffer_load_dwordx4 v19, s[16:19], s54 offen offset:3072 nt lds
 s_waitcnt vmcnt(32)
 s_mov_b32 m0, 0x25000
 s_mov_b32 s54, 0x7c080
 buffer_load_dwordx4 v28, s[12:15], s54 offen offset:0 nt lds
 buffer_load_dwordx4 v29, s[12:15], s54 offen offset:1024 nt lds
 buffer_load_dwordx4 v30, s[12:15], s54 offen offset:2048 nt lds
 buffer_load_dwordx4 v31, s[12:15], s54 offen offset:3072 nt lds
 s_waitcnt vmcnt(32)
 s_mov_b32 m0, 0x11000
 s_mov_b32 s54, 0x78080
 buffer_load_dwordx4 v16, s[16:19], s54 offen offset:0 nt lds
 buffer_load_dwordx4 v17, s[16:19], s54 offen offset:1024 nt lds
 buffer_load_dwordx4 v18, s[16:19], s54 offen offset:2048 nt lds
 buffer_load_dwordx4 v19, s[16:19], s54 offen offset:3072 nt lds
 s_cmpk_ge_u32 s52, 190
 s_cbranch_scc0 L_ls207
L_lb207:
 s_waitcnt vmcnt(32)
 s_mov_b32 m0, 0x12000
 s_mov_b32 s54, 0x7c100
 buffer_load_dwordx4 v28, s[12:15], s54 offen offset:0 nt lds
 buffer_load_dwordx4 v29, s[12:15], s54 offen offset:1024 nt lds
 buffer_load_dwordx4 v30, s[12:15], s54 offen offset:2048 nt lds
 buffer_load_dwordx4 v31, s[12:15], s54 offen offset:3072 nt lds
 s_waitcnt vmcnt(32)
 s_mov_b32 m0, 0x14000
 s_mov_b32 s54, 0x78100
 buffer_load_dwordx4 v16, s[16:19], s54 offen offset:0 nt lds
 buffer_load_dwordx4 v17, s[16:19], s54 offen offset:1024 nt lds
 buffer_load_dwordx4 v18, s[16:19], s54 offen offset:2048 nt lds
 buffer_load_dwordx4 v19, s[16:19], s54 offen offset:3072 nt lds
 s_waitcnt vmcnt(32)
 s_mov_b32 m0, 0x13000
 s_mov_b32 s54, 0x7c180
 buffer_load_dwordx4 v28, s[12:15], s54 offen offset:0 nt lds
 buffer_load_dwordx4 v29, s[12:15], s54 offen offset:1024 nt lds
 buffer_load_dwordx4 v30, s[12:15], s54 offen offset:2048 nt lds
 buffer_load_dwordx4 v31, s[12:15], s54 offen offset:3072 nt lds
 s_mov_b32 m0, 0x27c00
 s_movk_i32 s70, 856
 buffer_load_dword off, s[72:75], s70 lds
 s_waitcnt vmcnt(32)
 s_mov_b32 m0, 0x15000
 s_mov_b32 s54, 0x78180
 buffer_load_dwordx4 v16, s[16:19], s54 offen offset:0 nt lds
 buffer_load_dwordx4 v17, s[16:19], s54 offen offset:1024 nt lds
 buffer_load_dwordx4 v18, s[16:19], s54 offen offset:2048 nt lds
 buffer_load_dwordx4 v19, s[16:19], s54 offen offset:3072 nt lds
 s_mov_b32 m0, 0x27c00
 s_movk_i32 s70, 860
 buffer_load_dword off, s[72:75], s70 lds
 s_cmpk_ge_u32 s52, 192
 s_cbranch_scc0 L_ls208
L_lb208:
 s_waitcnt vmcnt(32)
 s_mov_b32 m0, 0xa000
 s_mov_b32 s54, 0x1c100
 buffer_load_dwordx4 v24, s[24:27], s54 offen offset:0 lds
 buffer_load_dwordx4 v25, s[24:27], s54 offen offset:1024 lds
 buffer_load_dwordx4 v26, s[24:27], s54 offen offset:2048 lds
 buffer_load_dwordx4 v27, s[24:27], s54 offen offset:3072 lds
 s_waitcnt vmcnt(32)
 s_mov_b32 m0, 0xb000
 s_mov_b32 s54, 0x23100
 buffer_load_dwordx4 v24, s[24:27], s54 offen offset:0 lds
 buffer_load_dwordx4 v25, s[24:27], s54 offen offset:1024 lds
 buffer_load_dwordx4 v26, s[24:27], s54 offen offset:2048 lds
 buffer_load_dwordx4 v27, s[24:27], s54 offen offset:3072 lds
 s_waitcnt vmcnt(32)
 s_mov_b32 m0, 0x8000
 s_mov_b32 s54, 0x2a100
 buffer_load_dwordx4 v24, s[24:27], s54 offen offset:0 lds
 buffer_load_dwordx4 v25, s[24:27], s54 offen offset:1024 lds
 buffer_load_dwordx4 v26, s[24:27], s54 offen offset:2048 lds
 buffer_load_dwordx4 v27, s[24:27], s54 offen offset:3072 lds
 s_waitcnt vmcnt(32)
 s_mov_b32 m0, 0x9000
 s_mov_b32 s54, 0x31100
 buffer_load_dwordx4 v24, s[24:27], s54 offen offset:0 lds
 buffer_load_dwordx4 v25, s[24:27], s54 offen offset:1024 lds
 buffer_load_dwordx4 v26, s[24:27], s54 offen offset:2048 lds
 buffer_load_dwordx4 v27, s[24:27], s54 offen offset:3072 lds
 s_mov_b32 m0, 0x27c00
 s_movk_i32 s70, 868
 buffer_load_dword off, s[72:75], s70 lds
 s_waitcnt vmcnt(32)
 s_mov_b32 m0, 0x16000
 s_mov_b32 s54, 0x7c000
 buffer_load_dwordx4 v16, s[16:19], s54 offen offset:0 nt lds
 buffer_load_dwordx4 v17, s[16:19], s54 offen offset:1024 nt lds
 buffer_load_dwordx4 v18, s[16:19], s54 offen offset:2048 nt lds
 buffer_load_dwordx4 v19, s[16:19], s54 offen offset:3072 nt lds
 s_waitcnt vmcnt(32)
 s_mov_b32 m0, 0x17000
 s_mov_b32 s54, 0x7c080
 buffer_load_dwordx4 v16, s[16:19], s54 offen offset:0 nt lds
 buffer_load_dwordx4 v17, s[16:19], s54 offen offset:1024 nt lds
 buffer_load_dwordx4 v18, s[16:19], s54 offen offset:2048 nt lds
 buffer_load_dwordx4 v19, s[16:19], s54 offen offset:3072 nt lds
 s_cmpk_ge_u32 s52, 194
 s_cbranch_scc0 L_ls211
L_lb211:
 s_waitcnt vmcnt(32)
 s_mov_b32 m0, 0xc000
 s_mov_b32 s54, 0x7c100
 buffer_load_dwordx4 v16, s[16:19], s54 offen offset:0 nt lds
 buffer_load_dwordx4 v17, s[16:19], s54 offen offset:1024 nt lds
 buffer_load_dwordx4 v18, s[16:19], s54 offen offset:2048 nt lds
 buffer_load_dwordx4 v19, s[16:19], s54 offen offset:3072 nt lds
 s_waitcnt vmcnt(32)
 s_mov_b32 m0, 0xd000
 s_mov_b32 s54, 0x7c180
 buffer_load_dwordx4 v16, s[16:19], s54 offen offset:0 nt lds
 buffer_load_dwordx4 v17, s[16:19], s54 offen offset:1024 nt lds
 buffer_load_dwordx4 v18, s[16:19], s54 offen offset:2048 nt lds
 buffer_load_dwordx4 v19, s[16:19], s54 offen offset:3072 nt lds
 s_mov_b32 m0, 0x27c00
 s_movk_i32 s70, 876
 buffer_load_dword off, s[72:75], s70 lds
 s_waitcnt vmcnt(32)
 s_mov_b32 m0, 0xe000
 s_mov_b32 s54, 0x38000
 buffer_load_dwordx4 v24, s[24:27], s54 offen offset:0 lds
 buffer_load_dwordx4 v25, s[24:27], s54 offen offset:1024 lds
 buffer_load_dwordx4 v26, s[24:27], s54 offen offset:2048 lds
 buffer_load_dwordx4 v27, s[24:27], s54 offen offset:3072 lds
 s_waitcnt vmcnt(32)
 s_mov_b32 m0, 0xf000
 s_mov_b32 s54, 0x3f000
 buffer_load_dwordx4 v24, s[24:27], s54 offen offset:0 lds
 buffer_load_dwordx4 v25, s[24:27], s54 offen offset:1024 lds
 buffer_load_dwordx4 v26, s[24:27], s54 offen offset:2048 lds
 buffer_load_dwordx4 v27, s[24:27], s54 offen offset:3072 lds
 s_cmpk_ge_u32 s52, 196
 s_cbranch_scc0 L_ls213
L_lb213:
 s_waitcnt vmcnt(32)
 s_mov_b32 m0, 0x18000
 s_mov_b32 s54, 0x46000
 buffer_load_dwordx4 v24, s[24:27], s54 offen offset:0 lds
 buffer_load_dwordx4 v25, s[24:27], s54 offen offset:1024 lds
 buffer_load_dwordx4 v26, s[24:27], s54 offen offset:2048 lds
 buffer_load_dwordx4 v27, s[24:27], s54 offen offset:3072 lds
 s_waitcnt vmcnt(32)
 s_mov_b32 m0, 0x19000
 s_mov_b32 s54, 0x4d000
 buffer_load_dwordx4 v24, s[24:27], s54 offen offset:0 lds
 buffer_load_dwordx4 v25, s[24:27], s54 offen offset:1024 lds
 buffer_load_dwordx4 v26, s[24:27], s54 offen offset:2048 lds
 buffer_load_dwordx4 v27, s[24:27], s54 offen offset:3072 lds
 s_mov_b32 m0, 0x27c00
 s_movk_i32 s70, 884
 buffer_load_dword off, s[72:75], s70 lds
 s_waitcnt vmcnt(32)
 s_mov_b32 m0, 0x1a000
 s_mov_b32 s54, 0x54000
 buffer_load_dwordx4 v24, s[24:27], s54 offen offset:0 lds
 buffer_load_dwordx4 v25, s[24:27], s54 offen offset:1024 lds
 buffer_load_dwordx4 v26, s[24:27], s54 offen offset:2048 lds
 buffer_load_dwordx4 v27, s[24:27], s54 offen offset:3072 lds
 s_waitcnt vmcnt(32)
 s_mov_b32 m0, 0x1b000
 s_mov_b32 s54, 0x5b000
 buffer_load_dwordx4 v24, s[24:27], s54 offen offset:0 lds
 buffer_load_dwordx4 v25, s[24:27], s54 offen offset:1024 lds
 buffer_load_dwordx4 v26, s[24:27], s54 offen offset:2048 lds
 buffer_load_dwordx4 v27, s[24:27], s54 offen offset:3072 lds
 s_cmpk_ge_u32 s52, 198
 s_cbranch_scc0 L_ls215
L_lb215:
 s_waitcnt vmcnt(32)
 s_mov_b32 m0, 0x0
 s_mov_b32 s54, 0x62000
 buffer_load_dwordx4 v24, s[24:27], s54 offen offset:0 lds
 buffer_load_dwordx4 v25, s[24:27], s54 offen offset:1024 lds
 buffer_load_dwordx4 v26, s[24:27], s54 offen offset:2048 lds
 buffer_load_dwordx4 v27, s[24:27], s54 offen offset:3072 lds
 s_waitcnt vmcnt(32)
 s_mov_b32 m0, 0x1000
 s_mov_b32 s54, 0x69000
 buffer_load_dwordx4 v24, s[24:27], s54 offen offset:0 lds
 buffer_load_dwordx4 v25, s[24:27], s54 offen offset:1024 lds
 buffer_load_dwordx4 v26, s[24:27], s54 offen offset:2048 lds
 buffer_load_dwordx4 v27, s[24:27], s54 offen offset:3072 lds
 s_mov_b32 m0, 0x27c00
 s_movk_i32 s70, 892
 buffer_load_dword off, s[72:75], s70 lds
 s_waitcnt vmcnt(32)
 s_mov_b32 m0, 0x2000
 s_mov_b32 s54, 0x38080
 buffer_load_dwordx4 v24, s[24:27], s54 offen offset:0 lds
 buffer_load_dwordx4 v25, s[24:27], s54 offen offset:1024 lds
 buffer_load_dwordx4 v26, s[24:27], s54 offen offset:2048 lds
 buffer_load_dwordx4 v27, s[24:27], s54 offen offset:3072 lds
 s_waitcnt vmcnt(32)
 s_mov_b32 m0, 0x3000
 s_mov_b32 s54, 0x3f080
 buffer_load_dwordx4 v24, s[24:27], s54 offen offset:0 lds
 buffer_load_dwordx4 v25, s[24:27], s54 offen offset:1024 lds
 buffer_load_dwordx4 v26, s[24:27], s54 offen offset:2048 lds
 buffer_load_dwordx4 v27, s[24:27], s54 offen offset:3072 lds
 s_cmpk_ge_u32 s52, 200
 s_cbranch_scc0 L_ls217
L_lb217:
 s_waitcnt vmcnt(32)
 s_mov_b32 m0, 0x1c000
 s_mov_b32 s54, 0x46080
 buffer_load_dwordx4 v24, s[24:27], s54 offen offset:0 lds
 buffer_load_dwordx4 v25, s[24:27], s54 offen offset:1024 lds
 buffer_load_dwordx4 v26, s[24:27], s54 offen offset:2048 lds
 buffer_load_dwordx4 v27, s[24:27], s54 offen offset:3072 lds
 s_waitcnt vmcnt(32)
 s_mov_b32 m0, 0x1d000
 s_mov_b32 s54, 0x4d080
 buffer_load_dwordx4 v24, s[24:27], s54 offen offset:0 lds
 buffer_load_dwordx4 v25, s[24:27], s54 offen offset:1024 lds
 buffer_load_dwordx4 v26, s[24:27], s54 offen offset:2048 lds
 buffer_load_dwordx4 v27, s[24:27], s54 offen offset:3072 lds
 s_mov_b32 m0, 0x27c00
 s_movk_i32 s70, 900
 buffer_load_dword off, s[72:75], s70 lds
 s_waitcnt vmcnt(32)
 s_mov_b32 m0, 0x1e000
 s_mov_b32 s54, 0x54080
 buffer_load_dwordx4 v24, s[24:27], s54 offen offset:0 lds
 buffer_load_dwordx4 v25, s[24:27], s54 offen offset:1024 lds
 buffer_load_dwordx4 v26, s[24:27], s54 offen offset:2048 lds
 buffer_load_dwordx4 v27, s[24:27], s54 offen offset:3072 lds
 s_waitcnt vmcnt(32)
 s_mov_b32 m0, 0x1f000
 s_mov_b32 s54, 0x5b080
 buffer_load_dwordx4 v24, s[24:27], s54 offen offset:0 lds
 buffer_load_dwordx4 v25, s[24:27], s54 offen offset:1024 lds
 buffer_load_dwordx4 v26, s[24:27], s54 offen offset:2048 lds
 buffer_load_dwordx4 v27, s[24:27], s54 offen offset:3072 lds
 s_cmpk_ge_u32 s52, 202
 s_cbranch_scc0 L_ls219
L_lb219:
 s_waitcnt vmcnt(32)
 s_mov_b32 m0, 0x20000
 s_mov_b32 s54, 0x62080
 buffer_load_dwordx4 v24, s[24:27], s54 offen offset:0 lds
 buffer_load_dwordx4 v25, s[24:27], s54 offen offset:1024 lds
 buffer_load_dwordx4 v26, s[24:27], s54 offen offset:2048 lds
 buffer_load_dwordx4 v27, s[24:27], s54 offen offset:3072 lds
 s_waitcnt vmcnt(32)
 s_mov_b32 m0, 0x21000
 s_mov_b32 s54, 0x69080
 buffer_load_dwordx4 v24, s[24:27], s54 offen offset:0 lds
 buffer_load_dwordx4 v25, s[24:27], s54 offen offset:1024 lds
 buffer_load_dwordx4 v26, s[24:27], s54 offen offset:2048 lds
 buffer_load_dwordx4 v27, s[24:27], s54 offen offset:3072 lds
 s_mov_b32 m0, 0x27c00
 s_movk_i32 s70, 908
 buffer_load_dword off, s[72:75], s70 lds
 s_waitcnt vmcnt(32)
 s_mov_b32 m0, 0x22000
 s_mov_b32 s54, 0x38100
 buffer_load_dwordx4 v24, s[24:27], s54 offen offset:0 lds
 buffer_load_dwordx4 v25, s[24:27], s54 offen offset:1024 lds
 buffer_load_dwordx4 v26, s[24:27], s54 offen offset:2048 lds
 buffer_load_dwordx4 v27, s[24:27], s54 offen offset:3072 lds
 s_waitcnt vmcnt(32)
 s_mov_b32 m0, 0x23000
 s_mov_b32 s54, 0x3f100
 buffer_load_dwordx4 v24, s[24:27], s54 offen offset:0 lds
 buffer_load_dwordx4 v25, s[24:27], s54 offen offset:1024 lds
 buffer_load_dwordx4 v26, s[24:27], s54 offen offset:2048 lds
 buffer_load_dwordx4 v27, s[24:27], s54 offen offset:3072 lds
 s_cmpk_ge_u32 s52, 204
 s_cbranch_scc0 L_ls221
L_lb221:
 s_waitcnt vmcnt(32)
 s_mov_b32 m0, 0x4000
 s_mov_b32 s54, 0x46100
 buffer_load_dwordx4 v24, s[24:27], s54 offen offset:0 lds
 buffer_load_dwordx4 v25, s[24:27], s54 offen offset:1024 lds
 buffer_load_dwordx4 v26, s[24:27], s54 offen offset:2048 lds
 buffer_load_dwordx4 v27, s[24:27], s54 offen offset:3072 lds
 s_waitcnt vmcnt(32)
 s_mov_b32 m0, 0x5000
 s_mov_b32 s54, 0x4d100
 buffer_load_dwordx4 v24, s[24:27], s54 offen offset:0 lds
 buffer_load_dwordx4 v25, s[24:27], s54 offen offset:1024 lds
 buffer_load_dwordx4 v26, s[24:27], s54 offen offset:2048 lds
 buffer_load_dwordx4 v27, s[24:27], s54 offen offset:3072 lds
 s_mov_b32 m0, 0x27c00
 s_movk_i32 s70, 916
 buffer_load_dword off, s[72:75], s70 lds
 s_waitcnt vmcnt(32)
 s_mov_b32 m0, 0x6000
 s_mov_b32 s54, 0x54100
 buffer_load_dwordx4 v24, s[24:27], s54 offen offset:0 lds
 buffer_load_dwordx4 v25, s[24:27], s54 offen offset:1024 lds
 buffer_load_dwordx4 v26, s[24:27], s54 offen offset:2048 lds
 buffer_load_dwordx4 v27, s[24:27], s54 offen offset:3072 lds
 s_waitcnt vmcnt(32)
 s_mov_b32 m0, 0x7000
 s_mov_b32 s54, 0x5b100
 buffer_load_dwordx4 v24, s[24:27], s54 offen offset:0 lds
 buffer_load_dwordx4 v25, s[24:27], s54 offen offset:1024 lds
 buffer_load_dwordx4 v26, s[24:27], s54 offen offset:2048 lds
 buffer_load_dwordx4 v27, s[24:27], s54 offen offset:3072 lds
 s_cmpk_ge_u32 s52, 206
 s_cbranch_scc0 L_ls223
L_lb223:
 s_waitcnt vmcnt(32)
 s_mov_b32 m0, 0x24000
 s_mov_b32 s54, 0x62100
 buffer_load_dwordx4 v24, s[24:27], s54 offen offset:0 lds
 buffer_load_dwordx4 v25, s[24:27], s54 offen offset:1024 lds
 buffer_load_dwordx4 v26, s[24:27], s54 offen offset:2048 lds
 buffer_load_dwordx4 v27, s[24:27], s54 offen offset:3072 lds
 s_waitcnt vmcnt(32)
 s_mov_b32 m0, 0x25000
 s_mov_b32 s54, 0x69100
 buffer_load_dwordx4 v24, s[24:27], s54 offen offset:0 lds
 buffer_load_dwordx4 v25, s[24:27], s54 offen offset:1024 lds
 buffer_load_dwordx4 v26, s[24:27], s54 offen offset:2048 lds
 buffer_load_dwordx4 v27, s[24:27], s54 offen offset:3072 lds
 s_mov_b32 m0, 0x27c00
 s_movk_i32 s70, 924
 buffer_load_dword off, s[72:75], s70 lds
 s_waitcnt vmcnt(32)
 s_mov_b32 m0, 0x12000
 s_mov_b32 s54, 0x38180
 buffer_load_dwordx4 v24, s[24:27], s54 offen offset:0 lds
 buffer_load_dwordx4 v25, s[24:27], s54 offen offset:1024 lds
 buffer_load_dwordx4 v26, s[24:27], s54 offen offset:2048 lds
 buffer_load_dwordx4 v27, s[24:27], s54 offen offset:3072 lds
 s_waitcnt vmcnt(32)
 s_mov_b32 m0, 0x13000
 s_mov_b32 s54, 0x3f180
 buffer_load_dwordx4 v24, s[24:27], s54 offen offset:0 lds
 buffer_load_dwordx4 v25, s[24:27], s54 offen offset:1024 lds
 buffer_load_dwordx4 v26, s[24:27], s54 offen offset:2048 lds
 buffer_load_dwordx4 v27, s[24:27], s54 offen offset:3072 lds
 s_cmpk_ge_u32 s52, 208
 s_cbranch_scc0 L_ls225
L_lb225:
 s_waitcnt vmcnt(32)
 s_mov_b32 m0, 0x10000
 s_mov_b32 s54, 0x46180
 buffer_load_dwordx4 v24, s[24:27], s54 offen offset:0 lds
 buffer_load_dwordx4 v25, s[24:27], s54 offen offset:1024 lds
 buffer_load_dwordx4 v26, s[24:27], s54 offen offset:2048 lds
 buffer_load_dwordx4 v27, s[24:27], s54 offen offset:3072 lds
 s_waitcnt vmcnt(32)
 s_mov_b32 m0, 0x11000
 s_mov_b32 s54, 0x4d180
 buffer_load_dwordx4 v24, s[24:27], s54 offen offset:0 lds
 buffer_load_dwordx4 v25, s[24:27], s54 offen offset:1024 lds
 buffer_load_dwordx4 v26, s[24:27], s54 offen offset:2048 lds
 buffer_load_dwordx4 v27, s[24:27], s54 offen offset:3072 lds
 s_mov_b32 m0, 0x27c00
 s_movk_i32 s70, 932
 buffer_load_dword off, s[72:75], s70 lds
 s_waitcnt vmcnt(32)
 s_mov_b32 m0, 0x14000
 s_mov_b32 s54, 0x54180
 buffer_load_dwordx4 v24, s[24:27], s54 offen offset:0 lds
 buffer_load_dwordx4 v25, s[24:27], s54 offen offset:1024 lds
 buffer_load_dwordx4 v26, s[24:27], s54 offen offset:2048 lds
 buffer_load_dwordx4 v27, s[24:27], s54 offen offset:3072 lds
 s_waitcnt vmcnt(32)
 s_mov_b32 m0, 0x15000
 s_mov_b32 s54, 0x5b180
 buffer_load_dwordx4 v24, s[24:27], s54 offen offset:0 lds
 buffer_load_dwordx4 v25, s[24:27], s54 offen offset:1024 lds
 buffer_load_dwordx4 v26, s[24:27], s54 offen offset:2048 lds
 buffer_load_dwordx4 v27, s[24:27], s54 offen offset:3072 lds
 s_cmpk_ge_u32 s52, 210
 s_cbranch_scc0 L_ls227
L_lb227:
 s_waitcnt vmcnt(32)
 s_mov_b32 m0, 0xa000
 s_mov_b32 s54, 0x62180
 buffer_load_dwordx4 v24, s[24:27], s54 offen offset:0 lds
 buffer_load_dwordx4 v25, s[24:27], s54 offen offset:1024 lds
 buffer_load_dwordx4 v26, s[24:27], s54 offen offset:2048 lds
 buffer_load_dwordx4 v27, s[24:27], s54 offen offset:3072 lds
 s_waitcnt vmcnt(32)
 s_mov_b32 m0, 0xb000
 s_mov_b32 s54, 0x69180
 buffer_load_dwordx4 v24, s[24:27], s54 offen offset:0 lds
 buffer_load_dwordx4 v25, s[24:27], s54 offen offset:1024 lds
 buffer_load_dwordx4 v26, s[24:27], s54 offen offset:2048 lds
 buffer_load_dwordx4 v27, s[24:27], s54 offen offset:3072 lds
 s_mov_b32 m0, 0x27c00
 s_movk_i32 s70, 940
 buffer_load_dword off, s[72:75], s70 lds
 s_waitcnt vmcnt(32)
 s_mov_b32 m0, 0x8000
 s_mov_b32 s54, 0x38200
 buffer_load_dwordx4 v24, s[24:27], s54 offen offset:0 lds
 buffer_load_dwordx4 v25, s[24:27], s54 offen offset:1024 lds
 buffer_load_dwordx4 v26, s[24:27], s54 offen offset:2048 lds
 buffer_load_dwordx4 v27, s[24:27], s54 offen offset:3072 lds
 s_waitcnt vmcnt(32)
 s_mov_b32 m0, 0x9000
 s_mov_b32 s54, 0x3f200
 buffer_load_dwordx4 v24, s[24:27], s54 offen offset:0 lds
 buffer_load_dwordx4 v25, s[24:27], s54 offen offset:1024 lds
 buffer_load_dwordx4 v26, s[24:27], s54 offen offset:2048 lds
 buffer_load_dwordx4 v27, s[24:27], s54 offen offset:3072 lds
 s_cmpk_ge_u32 s52, 212
 s_cbranch_scc0 L_ls229
L_lb229:
 s_waitcnt vmcnt(32)
 s_mov_b32 m0, 0x16000
 s_mov_b32 s54, 0x46200
 buffer_load_dwordx4 v24, s[24:27], s54 offen offset:0 lds
 buffer_load_dwordx4 v25, s[24:27], s54 offen offset:1024 lds
 buffer_load_dwordx4 v26, s[24:27], s54 offen offset:2048 lds
 buffer_load_dwordx4 v27, s[24:27], s54 offen offset:3072 lds
 s_waitcnt vmcnt(32)
 s_mov_b32 m0, 0x17000
 s_mov_b32 s54, 0x4d200
 buffer_load_dwordx4 v24, s[24:27], s54 offen offset:0 lds
 buffer_load_dwordx4 v25, s[24:27], s54 offen offset:1024 lds
 buffer_load_dwordx4 v26, s[24:27], s54 offen offset:2048 lds
 buffer_load_dwordx4 v27, s[24:27], s54 offen offset:3072 lds
 s_mov_b32 m0, 0x27c00
 s_movk_i32 s70, 948
 buffer_load_dword off, s[72:75], s70 lds
 s_waitcnt vmcnt(32)
 s_mov_b32 m0, 0xc000
 s_mov_b32 s54, 0x54200
 buffer_load_dwordx4 v24, s[24:27], s54 offen offset:0 lds
 buffer_load_dwordx4 v25, s[24:27], s54 offen offset:1024 lds
 buffer_load_dwordx4 v26, s[24:27], s54 offen offset:2048 lds
 buffer_load_dwordx4 v27, s[24:27], s54 offen offset:3072 lds
 s_waitcnt vmcnt(32)
 s_mov_b32 m0, 0xd000
 s_mov_b32 s54, 0x5b200
 buffer_load_dwordx4 v24, s[24:27], s54 offen offset:0 lds
 buffer_load_dwordx4 v25, s[24:27], s54 offen offset:1024 lds
 buffer_load_dwordx4 v26, s[24:27], s54 offen offset:2048 lds
 buffer_load_dwordx4 v27, s[24:27], s54 offen offset:3072 lds
 s_cmpk_ge_u32 s52, 214
 s_cbranch_scc0 L_ls231
L_lb231:
 s_waitcnt vmcnt(32)
 s_mov_b32 m0, 0xe000
 s_mov_b32 s54, 0x62200
 buffer_load_dwordx4 v24, s[24:27], s54 offen offset:0 lds
 buffer_load_dwordx4 v25, s[24:27], s54 offen offset:1024 lds
 buffer_load_dwordx4 v26, s[24:27], s54 offen offset:2048 lds
 buffer_load_dwordx4 v27, s[24:27], s54 offen offset:3072 lds
 s_waitcnt vmcnt(32)
 s_mov_b32 m0, 0xf000
 s_mov_b32 s54, 0x69200
 buffer_load_dwordx4 v24, s[24:27], s54 offen offset:0 lds
 buffer_load_dwordx4 v25, s[24:27], s54 offen offset:1024 lds
 buffer_load_dwordx4 v26, s[24:27], s54 offen offset:2048 lds
 buffer_load_dwordx4 v27, s[24:27], s54 offen offset:3072 lds
 s_mov_b32 m0, 0x27c00
 s_movk_i32 s70, 956
 buffer_load_dword off, s[72:75], s70 lds
 s_waitcnt vmcnt(32)
 s_mov_b32 m0, 0x18000
 s_mov_b32 s54, 0x38280
 buffer_load_dwordx4 v24, s[24:27], s54 offen offset:0 lds
 buffer_load_dwordx4 v25, s[24:27], s54 offen offset:1024 lds
 buffer_load_dwordx4 v26, s[24:27], s54 offen offset:2048 lds
 buffer_load_dwordx4 v27, s[24:27], s54 offen offset:3072 lds
 s_waitcnt vmcnt(32)
 s_mov_b32 m0, 0x19000
 s_mov_b32 s54, 0x3f280
 buffer_load_dwordx4 v24, s[24:27], s54 offen offset:0 lds
 buffer_load_dwordx4 v25, s[24:27], s54 offen offset:1024 lds
 buffer_load_dwordx4 v26, s[24:27], s54 offen offset:2048 lds
 buffer_load_dwordx4 v27, s[24:27], s54 offen offset:3072 lds
 s_cmpk_ge_u32 s52, 216
 s_cbranch_scc0 L_ls233
L_lb233:
 s_waitcnt vmcnt(32)
 s_mov_b32 m0, 0x1a000
 s_mov_b32 s54, 0x46280
 buffer_load_dwordx4 v24, s[24:27], s54 offen offset:0 lds
 buffer_load_dwordx4 v25, s[24:27], s54 offen offset:1024 lds
 buffer_load_dwordx4 v26, s[24:27], s54 offen offset:2048 lds
 buffer_load_dwordx4 v27, s[24:27], s54 offen offset:3072 lds
 s_waitcnt vmcnt(32)
 s_mov_b32 m0, 0x1b000
 s_mov_b32 s54, 0x4d280
 buffer_load_dwordx4 v24, s[24:27], s54 offen offset:0 lds
 buffer_load_dwordx4 v25, s[24:27], s54 offen offset:1024 lds
 buffer_load_dwordx4 v26, s[24:27], s54 offen offset:2048 lds
 buffer_load_dwordx4 v27, s[24:27], s54 offen offset:3072 lds
 s_mov_b32 m0, 0x27c00
 s_movk_i32 s70, 964
 buffer_load_dword off, s[72:75], s70 lds
 s_waitcnt vmcnt(32)
 s_mov_b32 m0, 0x0
 s_mov_b32 s54, 0x54280
 buffer_load_dwordx4 v24, s[24:27], s54 offen offset:0 lds
 buffer_load_dwordx4 v25, s[24:27], s54 offen offset:1024 lds
 buffer_load_dwordx4 v26, s[24:27], s54 offen offset:2048 lds
 buffer_load_dwordx4 v27, s[24:27], s54 offen offset:3072 lds
 s_waitcnt vmcnt(32)
 s_mov_b32 m0, 0x1000
 s_mov_b32 s54, 0x5b280
 buffer_load_dwordx4 v24, s[24:27], s54 offen offset:0 lds
 buffer_load_dwordx4 v25, s[24:27], s54 offen offset:1024 lds
 buffer_load_dwordx4 v26, s[24:27], s54 offen offset:2048 lds
 buffer_load_dwordx4 v27, s[24:27], s54 offen offset:3072 lds
 s_cmpk_ge_u32 s52, 218
 s_cbranch_scc0 L_ls235
L_lb235:
 s_waitcnt vmcnt(32)
 s_mov_b32 m0, 0x2000
 s_mov_b32 s54, 0x62280
 buffer_load_dwordx4 v24, s[24:27], s54 offen offset:0 lds
 buffer_load_dwordx4 v25, s[24:27], s54 offen offset:1024 lds
 buffer_load_dwordx4 v26, s[24:27], s54 offen offset:2048 lds
 buffer_load_dwordx4 v27, s[24:27], s54 offen offset:3072 lds
 s_waitcnt vmcnt(32)
 s_mov_b32 m0, 0x3000
 s_mov_b32 s54, 0x69280
 buffer_load_dwordx4 v24, s[24:27], s54 offen offset:0 lds
 buffer_load_dwordx4 v25, s[24:27], s54 offen offset:1024 lds
 buffer_load_dwordx4 v26, s[24:27], s54 offen offset:2048 lds
 buffer_load_dwordx4 v27, s[24:27], s54 offen offset:3072 lds
 s_mov_b32 m0, 0x27c00
 s_movk_i32 s70, 972
 buffer_load_dword off, s[72:75], s70 lds
 s_waitcnt vmcnt(32)
 s_mov_b32 m0, 0x1c000
 s_mov_b32 s54, 0x38300
 buffer_load_dwordx4 v24, s[24:27], s54 offen offset:0 lds
 buffer_load_dwordx4 v25, s[24:27], s54 offen offset:1024 lds
 buffer_load_dwordx4 v26, s[24:27], s54 offen offset:2048 lds
 buffer_load_dwordx4 v27, s[24:27], s54 offen offset:3072 lds
 s_waitcnt vmcnt(32)
 s_mov_b32 m0, 0x1d000
 s_mov_b32 s54, 0x3f300
 buffer_load_dwordx4 v24, s[24:27], s54 offen offset:0 lds
 buffer_load_dwordx4 v25, s[24:27], s54 offen offset:1024 lds
 buffer_load_dwordx4 v26, s[24:27], s54 offen offset:2048 lds
 buffer_load_dwordx4 v27, s[24:27], s54 offen offset:3072 lds
 s_cmpk_ge_u32 s52, 220
 s_cbranch_scc0 L_ls237
L_lb237:
 s_waitcnt vmcnt(32)
 s_mov_b32 m0, 0x1e000
 s_mov_b32 s54, 0x46300
 buffer_load_dwordx4 v24, s[24:27], s54 offen offset:0 lds
 buffer_load_dwordx4 v25, s[24:27], s54 offen offset:1024 lds
 buffer_load_dwordx4 v26, s[24:27], s54 offen offset:2048 lds
 buffer_load_dwordx4 v27, s[24:27], s54 offen offset:3072 lds
 s_waitcnt vmcnt(32)
 s_mov_b32 m0, 0x1f000
 s_mov_b32 s54, 0x4d300
 buffer_load_dwordx4 v24, s[24:27], s54 offen offset:0 lds
 buffer_load_dwordx4 v25, s[24:27], s54 offen offset:1024 lds
 buffer_load_dwordx4 v26, s[24:27], s54 offen offset:2048 lds
 buffer_load_dwordx4 v27, s[24:27], s54 offen offset:3072 lds
 s_mov_b32 m0, 0x27c00
 s_movk_i32 s70, 980
 buffer_load_dword off, s[72:75], s70 lds
 s_waitcnt vmcnt(32)
 s_mov_b32 m0, 0x20000
 s_mov_b32 s54, 0x54300
 buffer_load_dwordx4 v24, s[24:27], s54 offen offset:0 lds
 buffer_load_dwordx4 v25, s[24:27], s54 offen offset:1024 lds
 buffer_load_dwordx4 v26, s[24:27], s54 offen offset:2048 lds
 buffer_load_dwordx4 v27, s[24:27], s54 offen offset:3072 lds
 s_waitcnt vmcnt(32)
 s_mov_b32 m0, 0x21000
 s_mov_b32 s54, 0x5b300
 buffer_load_dwordx4 v24, s[24:27], s54 offen offset:0 lds
 buffer_load_dwordx4 v25, s[24:27], s54 offen offset:1024 lds
 buffer_load_dwordx4 v26, s[24:27], s54 offen offset:2048 lds
 buffer_load_dwordx4 v27, s[24:27], s54 offen offset:3072 lds
 s_cmpk_ge_u32 s52, 222
 s_cbranch_scc0 L_ls239
L_lb239:
 s_waitcnt vmcnt(32)
 s_mov_b32 m0, 0x22000
 s_mov_b32 s54, 0x62300
 buffer_load_dwordx4 v24, s[24:27], s54 offen offset:0 lds
 buffer_load_dwordx4 v25, s[24:27], s54 offen offset:1024 lds
 buffer_load_dwordx4 v26, s[24:27], s54 offen offset:2048 lds
 buffer_load_dwordx4 v27, s[24:27], s54 offen offset:3072 lds
 s_waitcnt vmcnt(32)
 s_mov_b32 m0, 0x23000
 s_mov_b32 s54, 0x69300
 buffer_load_dwordx4 v24, s[24:27], s54 offen offset:0 lds
 buffer_load_dwordx4 v25, s[24:27], s54 offen offset:1024 lds
 buffer_load_dwordx4 v26, s[24:27], s54 offen offset:2048 lds
 buffer_load_dwordx4 v27, s[24:27], s54 offen offset:3072 lds
 s_mov_b32 m0, 0x27c00
 s_movk_i32 s70, 988
 buffer_load_dword off, s[72:75], s70 lds
 s_waitcnt vmcnt(0)
 s_mov_b32 s34, 0
 s_mov_b32 s35, 0
 s_branch L_ga
L_gas:
 s_sleep 4
L_ga:
 s_add_u32 s57, s57, 1
 s_cmp_gt_u32 s57, 0x100000
 s_cbranch_scc1 L_exit0
 buffer_load_dword v60, v49, s[80:83], s53 offen offset:0 sc1
 s_waitcnt vmcnt(0)
 v_cmp_eq_u32 vcc, 1, v60
 s_or_b32 s44, vcc_lo, 0
 s_lshr_b32 s46, s44, 1
 s_lshr_b32 s47, s44, 2
 s_and_b32 s44, s44, s46
 s_and_b32 s44, s44, s47
 s_and_b32 s44, s44, 0x249249
 s_andn2_b32 s44, s44, s34
 s_cbranch_scc0 L_gan1
 s_or_b32 s34, s34, s44
 s_bitcmp1_b32 s44, 0
 s_cbranch_scc0 L_gak1_0
 s_add_u32 s45, s38, 0x0
 buffer_load_dwordx4 v[64:67], v13, s[76:79], s45 offen sc1
 s_add_u32 s45, s39, 0x0
 buffer_load_dwordx4 v[96:99], v13, s[76:79], s45 offen sc1
 s_add_u32 s45, s40, 0x0
 buffer_load_dwordx4 v[128:131], v13, s[76:79], s45 offen sc1
L_gak1_0:
 s_bitcmp1_b32 s44, 3
 s_cbranch_scc0 L_gak1_1
 s_add_u32 s45, s38, 0x2a0000
 buffer_load_dwordx4 v[68:71], v13, s[76:79], s45 offen sc1
 s_add_u32 s45, s39, 0x2a0000
 buffer_load_dwordx4 v[100:103], v13, s[76:79], s45 offen sc1
 s_add_u32 s45, s40, 0x2a0000
 buffer_load_dwordx4 v[132:135], v13, s[76:79], s45 offen sc1
L_gak1_1:
 s_bitcmp1_b32 s44, 6
 s_cbranch_scc0 L_gak1_2
 s_add_u32 s45, s38, 0x540000
 buffer_load_dwordx4 v[72:75], v13, s[76:79], s45 offen sc1
 s_add_u32 s45, s39, 0x540000
 buffer_load_dwordx4 v[104:107], v13, s[76:79], s45 offen sc1
 s_add_u32 s45, s40, 0x540000
 buffer_load_dwordx4 v[136:139], v13, s[76:79], s45 offen sc1
L_gak1_2:
 s_bitcmp1_b32 s44, 9
 s_cbranch_scc0 L_gak1_3
 s_add_u32 s45, s38, 0x7e0000
 buffer_load_dwordx4 v[76:79], v13, s[76:79], s45 offen sc1
 s_add_u32 s45, s39, 0x7e0000
 buffer_load_dwordx4 v[108:111], v13, s[76:79], s45 offen sc1
 s_add_u32 s45, s40, 0x7e0000
 buffer_load_dwordx4 v[140:143], v13, s[76:79], s45 offen sc1
L_gak1_3:
 s_bitcmp1_b32 s44, 12
 s_cbranch_scc0 L_gak1_4
 s_add_u32 s45, s38, 0xa80000
 buffer_load_dwordx4 v[80:83], v13, s[76:79], s45 offen sc1
 s_add_u32 s45, s39, 0xa80000
 buffer_load_dwordx4 v[112:115], v13, s[76:79], s45 offen sc1
 s_add_u32 s45, s40, 0xa80000
 buffer_load_dwordx4 v[144:147], v13, s[76:79], s45 offen sc1
L_gak1_4:
 s_bitcmp1_b32 s44, 15
 s_cbranch_scc0 L_gak1_5
 s_add_u32 s45, s38, 0xd20000
 buffer_load_dwordx4 v[84:87], v13, s[76:79], s45 offen sc1
 s_add_u32 s45, s39, 0xd20000
 buffer_load_dwordx4 v[116:119], v13, s[76:79], s45 offen sc1
 s_add_u32 s45, s40, 0xd20000
 buffer_load_dwordx4 v[148:151], v13, s[76:79], s45 offen sc1
L_gak1_5:
 s_bitcmp1_b32 s44, 18
 s_cbranch_scc0 L_gak1_6
 s_add_u32 s45, s38, 0xfc0000
 buffer_load_dwordx4 v[88:91], v13, s[76:79], s45 offen sc1
 s_add_u32 s45, s39, 0xfc0000
 buffer_load_dwordx4 v[120:123], v13, s[76:79], s45 offen sc1
 s_add_u32 s45, s40, 0xfc0000
 buffer_load_dwordx4 v[152:155], v13, s[76:79], s45 offen sc1
L_gak1_6:
 s_bitcmp1_b32 s44, 21
 s_cbranch_scc0 L_gak1_7
 s_add_u32 s45, s38, 0x1260000
 buffer_load_dwordx4 v[92:95], v13, s[76:79], s45 offen sc1
 s_add_u32 s45, s39, 0x1260000
 buffer_load_dwordx4 v[124:127], v13, s[76:79], s45 offen sc1
 s_add_u32 s45, s40, 0x1260000
 buffer_load_dwordx4 v[156:159], v13, s[76:79], s45 offen sc1
L_gak1_7:
L_gan1:
 s_or_b32 s44, vcc_hi, 0
 s_lshr_b32 s46, s44, 1
 s_lshr_b32 s47, s44, 2
 s_and_b32 s44, s44, s46
 s_and_b32 s44, s44, s47
 s_and_b32 s44, s44, 0x249249
 s_andn2_b32 s44, s44, s35
 s_cbranch_scc0 L_gan3
 s_or_b32 s35, s35, s44
 s_bitcmp1_b32 s44, 0
 s_cbranch_scc0 L_gak3_0
 s_add_u32 s45, s38, 0x6000
 buffer_load_dwordx4 v[160:163], v13, s[76:79], s45 offen sc1
 s_add_u32 s45, s39, 0x6000
 buffer_load_dwordx4 v[192:195], v13, s[76:79], s45 offen sc1
 s_add_u32 s45, s40, 0x6000
 buffer_load_dwordx4 v[224:227], v13, s[76:79], s45 offen sc1
L_gak3_0:
 s_bitcmp1_b32 s44, 3
 s_cbranch_scc0 L_gak3_1
 s_add_u32 s45, s38, 0x2a6000
 buffer_load_dwordx4 v[164:167], v13, s[76:79], s45 offen sc1
 s_add_u32 s45, s39, 0x2a6000
 buffer_load_dwordx4 v[196:199], v13, s[76:79], s45 offen sc1
 s_add_u32 s45, s40, 0x2a6000
 buffer_load_dwordx4 v[228:231], v13, s[76:79], s45 offen sc1
L_gak3_1:
 s_bitcmp1_b32 s44, 6
 s_cbranch_scc0 L_gak3_2
 s_add_u32 s45, s38, 0x546000
 buffer_load_dwordx4 v[168:171], v13, s[76:79], s45 offen sc1
 s_add_u32 s45, s39, 0x546000
 buffer_load_dwordx4 v[200:203], v13, s[76:79], s45 offen sc1
 s_add_u32 s45, s40, 0x546000
 buffer_load_dwordx4 v[232:235], v13, s[76:79], s45 offen sc1
L_gak3_2:
 s_bitcmp1_b32 s44, 9
 s_cbranch_scc0 L_gak3_3
 s_add_u32 s45, s38, 0x7e6000
 buffer_load_dwordx4 v[172:175], v13, s[76:79], s45 offen sc1
 s_add_u32 s45, s39, 0x7e6000
 buffer_load_dwordx4 v[204:207], v13, s[76:79], s45 offen sc1
 s_add_u32 s45, s40, 0x7e6000
 buffer_load_dwordx4 v[236:239], v13, s[76:79], s45 offen sc1
L_gak3_3:
 s_bitcmp1_b32 s44, 12
 s_cbranch_scc0 L_gak3_4
 s_add_u32 s45, s38, 0xa86000
 buffer_load_dwordx4 v[176:179], v13, s[76:79], s45 offen sc1
 s_add_u32 s45, s39, 0xa86000
 buffer_load_dwordx4 v[208:211], v13, s[76:79], s45 offen sc1
 s_add_u32 s45, s40, 0xa86000
 buffer_load_dwordx4 v[240:243], v13, s[76:79], s45 offen sc1
L_gak3_4:
 s_bitcmp1_b32 s44, 15
 s_cbranch_scc0 L_gak3_5
 s_add_u32 s45, s38, 0xd26000
 buffer_load_dwordx4 v[180:183], v13, s[76:79], s45 offen sc1
 s_add_u32 s45, s39, 0xd26000
 buffer_load_dwordx4 v[212:215], v13, s[76:79], s45 offen sc1
 s_add_u32 s45, s40, 0xd26000
 buffer_load_dwordx4 v[244:247], v13, s[76:79], s45 offen sc1
L_gak3_5:
 s_bitcmp1_b32 s44, 18
 s_cbranch_scc0 L_gak3_6
 s_add_u32 s45, s38, 0xfc6000
 buffer_load_dwordx4 v[184:187], v13, s[76:79], s45 offen sc1
 s_add_u32 s45, s39, 0xfc6000
 buffer_load_dwordx4 v[216:219], v13, s[76:79], s45 offen sc1
 s_add_u32 s45, s40, 0xfc6000
 buffer_load_dwordx4 v[248:251], v13, s[76:79], s45 offen sc1
L_gak3_6:
 s_bitcmp1_b32 s44, 21
 s_cbranch_scc0 L_gak3_7
 s_add_u32 s45, s38, 0x1266000
 buffer_load_dwordx4 v[188:191], v13, s[76:79], s45 offen sc1
 s_add_u32 s45, s39, 0x1266000
 buffer_load_dwordx4 v[220:223], v13, s[76:79], s45 offen sc1
 s_add_u32 s45, s40, 0x1266000
 buffer_load_dwordx4 v[252:255], v13, s[76:79], s45 offen sc1
L_gak3_7:
L_gan3:
 s_cmp_eq_u32 s34, 0x249249
 s_cbranch_scc0 L_gas
 s_waitcnt vmcnt(0)
 v_lshlrev_b32 v16, 16, v64
 v_and_b32 v17, s56, v64
 v_lshlrev_b32 v18, 16, v65
 v_and_b32 v19, s56, v65
 v_lshlrev_b32 v20, 16, v66
 v_and_b32 v21, s56, v66
 v_lshlrev_b32 v22, 16, v67
 v_and_b32 v23, s56, v67
 v_lshlrev_b32 v24, 16, v68
 v_and_b32 v25, s56, v68
 v_add_f32 v16, v16, v24
 v_add_f32 v17, v17, v25
 v_lshlrev_b32 v24, 16, v69
 v_and_b32 v25, s56, v69
 v_add_f32 v18, v18, v24
 v_add_f32 v19, v19, v25
 v_lshlrev_b32 v24, 16, v70
 v_and_b32 v25, s56, v70
 v_add_f32 v20, v20, v24
 v_add_f32 v21, v21, v25
 v_lshlrev_b32 v24, 16, v71
 v_and_b32 v25, s56, v71
 v_add_f32 v22, v22, v24
 v_add_f32 v23, v23, v25
 v_lshlrev_b32 v24, 16, v72
 v_and_b32 v25, s56, v72
 v_add_f32 v16, v16, v24
 v_add_f32 v17, v17, v25
 v_lshlrev_b32 v24, 16, v73
 v_and_b32 v25, s56, v73
 v_add_f32 v18, v18, v24
 v_add_f32 v19, v19, v25
 v_lshlrev_b32 v24, 16, v74
 v_and_b32 v25, s56, v74
 v_add_f32 v20, v20, v24
 v_add_f32 v21, v21, v25
 v_lshlrev_b32 v24, 16, v75
 v_and_b32 v25, s56, v75
 v_add_f32 v22, v22, v24
 v_add_f32 v23, v23, v25
 v_lshlrev_b32 v24, 16, v76
 v_and_b32 v25, s56, v76
 v_add_f32 v16, v16, v24
 v_add_f32 v17, v17, v25
 v_lshlrev_b32 v24, 16, v77
 v_and_b32 v25, s56, v77
 v_add_f32 v18, v18, v24
 v_add_f32 v19, v19, v25
 v_lshlrev_b32 v24, 16, v78
 v_and_b32 v25, s56, v78
 v_add_f32 v20, v20, v24
 v_add_f32 v21, v21, v25
 v_lshlrev_b32 v24, 16, v79
 v_and_b32 v25, s56, v79
 v_add_f32 v22, v22, v24
 v_add_f32 v23, v23, v25
 v_lshlrev_b32 v24, 16, v80
 v_and_b32 v25, s56, v80
 v_add_f32 v16, v16, v24
 v_add_f32 v17, v17, v25
 v_lshlrev_b32 v24, 16, v81
 v_and_b32 v25, s56, v81
 v_add_f32 v18, v18, v24
 v_add_f32 v19, v19, v25
 v_lshlrev_b32 v24, 16, v82
 v_and_b32 v25, s56, v82
 v_add_f32 v20, v20, v24
 v_add_f32 v21, v21, v25
 v_lshlrev_b32 v24, 16, v83
 v_and_b32 v25, s56, v83
 v_add_f32 v22, v22, v24
 v_add_f32 v23, v23, v25
 v_lshlrev_b32 v24, 16, v84
 v_and_b32 v25, s56, v84
 v_add_f32 v16, v16, v24
 v_add_f32 v17, v17, v25
 v_lshlrev_b32 v24, 16, v85
 v_and_b32 v25, s56, v85
 v_add_f32 v18, v18, v24
 v_add_f32 v19, v19, v25
 v_lshlrev_b32 v24, 16, v86
 v_and_b32 v25, s56, v86
 v_add_f32 v20, v20, v24
 v_add_f32 v21, v21, v25
 v_lshlrev_b32 v24, 16, v87
 v_and_b32 v25, s56, v87
 v_add_f32 v22, v22, v24
 v_add_f32 v23, v23, v25
 v_lshlrev_b32 v24, 16, v88
 v_and_b32 v25, s56, v88
 v_add_f32 v16, v16, v24
 v_add_f32 v17, v17, v25
 v_lshlrev_b32 v24, 16, v89
 v_and_b32 v25, s56, v89
 v_add_f32 v18, v18, v24
 v_add_f32 v19, v19, v25
 v_lshlrev_b32 v24, 16, v90
 v_and_b32 v25, s56, v90
 v_add_f32 v20, v20, v24
 v_add_f32 v21, v21, v25
 v_lshlrev_b32 v24, 16, v91
 v_and_b32 v25, s56, v91
 v_add_f32 v22, v22, v24
 v_add_f32 v23, v23, v25
 v_lshlrev_b32 v24, 16, v92
 v_and_b32 v25, s56, v92
 v_add_f32 v16, v16, v24
 v_add_f32 v17, v17, v25
 v_lshlrev_b32 v24, 16, v93
 v_and_b32 v25, s56, v93
 v_add_f32 v18, v18, v24
 v_add_f32 v19, v19, v25
 v_lshlrev_b32 v24, 16, v94
 v_and_b32 v25, s56, v94
 v_add_f32 v20, v20, v24
 v_add_f32 v21, v21, v25
 v_lshlrev_b32 v24, 16, v95
 v_and_b32 v25, s56, v95
 v_add_f32 v22, v22, v24
 v_add_f32 v23, v23, v25
 v_cvt_pk_bf16_f32 v16, v16, v17
 v_cvt_pk_bf16_f32 v17, v18, v19
 buffer_store_dwordx2 v[16:17], v50, s[84:87], s41 offen offset:0
 v_cvt_pk_bf16_f32 v20, v20, v21
 v_cvt_pk_bf16_f32 v21, v22, v23
 buffer_store_dwordx2 v[20:21], v50, s[84:87], s41 offen offset:32
 v_lshlrev_b32 v26, 16, v96
 v_and_b32 v27, s56, v96
 v_lshlrev_b32 v28, 16, v97
 v_and_b32 v29, s56, v97
 v_lshlrev_b32 v30, 16, v98
 v_and_b32 v31, s56, v98
 v_lshlrev_b32 v32, 16, v99
 v_and_b32 v33, s56, v99
 v_lshlrev_b32 v34, 16, v100
 v_and_b32 v35, s56, v100
 v_add_f32 v26, v26, v34
 v_add_f32 v27, v27, v35
 v_lshlrev_b32 v34, 16, v101
 v_and_b32 v35, s56, v101
 v_add_f32 v28, v28, v34
 v_add_f32 v29, v29, v35
 v_lshlrev_b32 v34, 16, v102
 v_and_b32 v35, s56, v102
 v_add_f32 v30, v30, v34
 v_add_f32 v31, v31, v35
 v_lshlrev_b32 v34, 16, v103
 v_and_b32 v35, s56, v103
 v_add_f32 v32, v32, v34
 v_add_f32 v33, v33, v35
 v_lshlrev_b32 v34, 16, v104
 v_and_b32 v35, s56, v104
 v_add_f32 v26, v26, v34
 v_add_f32 v27, v27, v35
 v_lshlrev_b32 v34, 16, v105
 v_and_b32 v35, s56, v105
 v_add_f32 v28, v28, v34
 v_add_f32 v29, v29, v35
 v_lshlrev_b32 v34, 16, v106
 v_and_b32 v35, s56, v106
 v_add_f32 v30, v30, v34
 v_add_f32 v31, v31, v35
 v_lshlrev_b32 v34, 16, v107
 v_and_b32 v35, s56, v107
 v_add_f32 v32, v32, v34
 v_add_f32 v33, v33, v35
 v_lshlrev_b32 v34, 16, v108
 v_and_b32 v35, s56, v108
 v_add_f32 v26, v26, v34
 v_add_f32 v27, v27, v35
 v_lshlrev_b32 v34, 16, v109
 v_and_b32 v35, s56, v109
 v_add_f32 v28, v28, v34
 v_add_f32 v29, v29, v35
 v_lshlrev_b32 v34, 16, v110
 v_and_b32 v35, s56, v110
 v_add_f32 v30, v30, v34
 v_add_f32 v31, v31, v35
 v_lshlrev_b32 v34, 16, v111
 v_and_b32 v35, s56, v111
 v_add_f32 v32, v32, v34
 v_add_f32 v33, v33, v35
 v_lshlrev_b32 v34, 16, v112
 v_and_b32 v35, s56, v112
 v_add_f32 v26, v26, v34
 v_add_f32 v27, v27, v35
 v_lshlrev_b32 v34, 16, v113
 v_and_b32 v35, s56, v113
 v_add_f32 v28, v28, v34
 v_add_f32 v29, v29, v35
 v_lshlrev_b32 v34, 16, v114
 v_and_b32 v35, s56, v114
 v_add_f32 v30, v30, v34
 v_add_f32 v31, v31, v35
 v_lshlrev_b32 v34, 16, v115
 v_and_b32 v35, s56, v115
 v_add_f32 v32, v32, v34
 v_add_f32 v33, v33, v35
 v_lshlrev_b32 v34, 16, v116
 v_and_b32 v35, s56, v116
 v_add_f32 v26, v26, v34
 v_add_f32 v27, v27, v35
 v_lshlrev_b32 v34, 16, v117
 v_and_b32 v35, s56, v117
 v_add_f32 v28, v28, v34
 v_add_f32 v29, v29, v35
 v_lshlrev_b32 v34, 16, v118
 v_and_b32 v35, s56, v118
 v_add_f32 v30, v30, v34
 v_add_f32 v31, v31, v35
 v_lshlrev_b32 v34, 16, v119
 v_and_b32 v35, s56, v119
 v_add_f32 v32, v32, v34
 v_add_f32 v33, v33, v35
 v_lshlrev_b32 v34, 16, v120
 v_and_b32 v35, s56, v120
 v_add_f32 v26, v26, v34
 v_add_f32 v27, v27, v35
 v_lshlrev_b32 v34, 16, v121
 v_and_b32 v35, s56, v121
 v_add_f32 v28, v28, v34
 v_add_f32 v29, v29, v35
 v_lshlrev_b32 v34, 16, v122
 v_and_b32 v35, s56, v122
 v_add_f32 v30, v30, v34
 v_add_f32 v31, v31, v35
 v_lshlrev_b32 v34, 16, v123
 v_and_b32 v35, s56, v123
 v_add_f32 v32, v32, v34
 v_add_f32 v33, v33, v35
 v_lshlrev_b32 v34, 16, v124
 v_and_b32 v35, s56, v124
 v_add_f32 v26, v26, v34
 v_add_f32 v27, v27, v35
 v_lshlrev_b32 v34, 16, v125
 v_and_b32 v35, s56, v125
 v_add_f32 v28, v28, v34
 v_add_f32 v29, v29, v35
 v_lshlrev_b32 v34, 16, v126
 v_and_b32 v35, s56, v126
 v_add_f32 v30, v30, v34
 v_add_f32 v31, v31, v35
 v_lshlrev_b32 v34, 16, v127
 v_and_b32 v35, s56, v127
 v_add_f32 v32, v32, v34
 v_add_f32 v33, v33, v35
 v_cvt_pk_bf16_f32 v26, v26, v27
 v_cvt_pk_bf16_f32 v27, v28, v29
 buffer_store_dwordx2 v[26:27], v50, s[84:87], s42 offen offset:0
 v_cvt_pk_bf16_f32 v30, v30, v31
 v_cvt_pk_bf16_f32 v31, v32, v33
 buffer_store_dwordx2 v[30:31], v50, s[84:87], s42 offen offset:32
 v_lshlrev_b32 v16, 16, v128
 v_and_b32 v17, s56, v128
 v_lshlrev_b32 v18, 16, v129
 v_and_b32 v19, s56, v129
 v_lshlrev_b32 v20, 16, v130
 v_and_b32 v21, s56, v130
 v_lshlrev_b32 v22, 16, v131
 v_and_b32 v23, s56, v131
 v_lshlrev_b32 v24, 16, v132
 v_and_b32 v25, s56, v132
 v_add_f32 v16, v16, v24
 v_add_f32 v17, v17, v25
 v_lshlrev_b32 v24, 16, v133
 v_and_b32 v25, s56, v133
 v_add_f32 v18, v18, v24
 v_add_f32 v19, v19, v25
 v_lshlrev_b32 v24, 16, v134
 v_and_b32 v25, s56, v134
 v_add_f32 v20, v20, v24
 v_add_f32 v21, v21, v25
 v_lshlrev_b32 v24, 16, v135
 v_and_b32 v25, s56, v135
 v_add_f32 v22, v22, v24
 v_add_f32 v23, v23, v25
 v_lshlrev_b32 v24, 16, v136
 v_and_b32 v25, s56, v136
 v_add_f32 v16, v16, v24
 v_add_f32 v17, v17, v25
 v_lshlrev_b32 v24, 16, v137
 v_and_b32 v25, s56, v137
 v_add_f32 v18, v18, v24
 v_add_f32 v19, v19, v25
 v_lshlrev_b32 v24, 16, v138
 v_and_b32 v25, s56, v138
 v_add_f32 v20, v20, v24
 v_add_f32 v21, v21, v25
 v_lshlrev_b32 v24, 16, v139
 v_and_b32 v25, s56, v139
 v_add_f32 v22, v22, v24
 v_add_f32 v23, v23, v25
 v_lshlrev_b32 v24, 16, v140
 v_and_b32 v25, s56, v140
 v_add_f32 v16, v16, v24
 v_add_f32 v17, v17, v25
 v_lshlrev_b32 v24, 16, v141
 v_and_b32 v25, s56, v141
 v_add_f32 v18, v18, v24
 v_add_f32 v19, v19, v25
 v_lshlrev_b32 v24, 16, v142
 v_and_b32 v25, s56, v142
 v_add_f32 v20, v20, v24
 v_add_f32 v21, v21, v25
 v_lshlrev_b32 v24, 16, v143
 v_and_b32 v25, s56, v143
 v_add_f32 v22, v22, v24
 v_add_f32 v23, v23, v25
 v_lshlrev_b32 v24, 16, v144
 v_and_b32 v25, s56, v144
 v_add_f32 v16, v16, v24
 v_add_f32 v17, v17, v25
 v_lshlrev_b32 v24, 16, v145
 v_and_b32 v25, s56, v145
 v_add_f32 v18, v18, v24
 v_add_f32 v19, v19, v25
 v_lshlrev_b32 v24, 16, v146
 v_and_b32 v25, s56, v146
 v_add_f32 v20, v20, v24
 v_add_f32 v21, v21, v25
 v_lshlrev_b32 v24, 16, v147
 v_and_b32 v25, s56, v147
 v_add_f32 v22, v22, v24
 v_add_f32 v23, v23, v25
 v_lshlrev_b32 v24, 16, v148
 v_and_b32 v25, s56, v148
 v_add_f32 v16, v16, v24
 v_add_f32 v17, v17, v25
 v_lshlrev_b32 v24, 16, v149
 v_and_b32 v25, s56, v149
 v_add_f32 v18, v18, v24
 v_add_f32 v19, v19, v25
 v_lshlrev_b32 v24, 16, v150
 v_and_b32 v25, s56, v150
 v_add_f32 v20, v20, v24
 v_add_f32 v21, v21, v25
 v_lshlrev_b32 v24, 16, v151
 v_and_b32 v25, s56, v151
 v_add_f32 v22, v22, v24
 v_add_f32 v23, v23, v25
 v_lshlrev_b32 v24, 16, v152
 v_and_b32 v25, s56, v152
 v_add_f32 v16, v16, v24
 v_add_f32 v17, v17, v25
 v_lshlrev_b32 v24, 16, v153
 v_and_b32 v25, s56, v153
 v_add_f32 v18, v18, v24
 v_add_f32 v19, v19, v25
 v_lshlrev_b32 v24, 16, v154
 v_and_b32 v25, s56, v154
 v_add_f32 v20, v20, v24
 v_add_f32 v21, v21, v25
 v_lshlrev_b32 v24, 16, v155
 v_and_b32 v25, s56, v155
 v_add_f32 v22, v22, v24
 v_add_f32 v23, v23, v25
 v_lshlrev_b32 v24, 16, v156
 v_and_b32 v25, s56, v156
 v_add_f32 v16, v16, v24
 v_add_f32 v17, v17, v25
 v_lshlrev_b32 v24, 16, v157
 v_and_b32 v25, s56, v157
 v_add_f32 v18, v18, v24
 v_add_f32 v19, v19, v25
 v_lshlrev_b32 v24, 16, v158
 v_and_b32 v25, s56, v158
 v_add_f32 v20, v20, v24
 v_add_f32 v21, v21, v25
 v_lshlrev_b32 v24, 16, v159
 v_and_b32 v25, s56, v159
 v_add_f32 v22, v22, v24
 v_add_f32 v23, v23, v25
 v_cvt_pk_bf16_f32 v16, v16, v17
 v_cvt_pk_bf16_f32 v17, v18, v19
 buffer_store_dwordx2 v[16:17], v50, s[84:87], s43 offen offset:0
 v_cvt_pk_bf16_f32 v20, v20, v21
 v_cvt_pk_bf16_f32 v21, v22, v23
 buffer_store_dwordx2 v[20:21], v50, s[84:87], s43 offen offset:32
 s_branch L_gb
L_gbs:
 s_sleep 4
L_gb:
 s_add_u32 s57, s57, 1
 s_cmp_gt_u32 s57, 0x100000
 s_cbranch_scc1 L_exit0
 buffer_load_dword v60, v49, s[80:83], s53 offen offset:0 sc1
 s_waitcnt vmcnt(0)
 v_cmp_eq_u32 vcc, 1, v60
 s_or_b32 s44, vcc_hi, 0
 s_lshr_b32 s46, s44, 1
 s_lshr_b32 s47, s44, 2
 s_and_b32 s44, s44, s46
 s_and_b32 s44, s44, s47
 s_and_b32 s44, s44, 0x249249
 s_andn2_b32 s44, s44, s35
 s_cbranch_scc0 L_gbn3
 s_or_b32 s35, s35, s44
 s_bitcmp1_b32 s44, 0
 s_cbranch_scc0 L_gbk3_0
 s_add_u32 s45, s38, 0x6000
 buffer_load_dwordx4 v[160:163], v13, s[76:79], s45 offen sc1
 s_add_u32 s45, s39, 0x6000
 buffer_load_dwordx4 v[192:195], v13, s[76:79], s45 offen sc1
 s_add_u32 s45, s40, 0x6000
 buffer_load_dwordx4 v[224:227], v13, s[76:79], s45 offen sc1
L_gbk3_0:
 s_bitcmp1_b32 s44, 3
 s_cbranch_scc0 L_gbk3_1
 s_add_u32 s45, s38, 0x2a6000
 buffer_load_dwordx4 v[164:167], v13, s[76:79], s45 offen sc1
 s_add_u32 s45, s39, 0x2a6000
 buffer_load_dwordx4 v[196:199], v13, s[76:79], s45 offen sc1
 s_add_u32 s45, s40, 0x2a6000
 buffer_load_dwordx4 v[228:231], v13, s[76:79], s45 offen sc1
L_gbk3_1:
 s_bitcmp1_b32 s44, 6
 s_cbranch_scc0 L_gbk3_2
 s_add_u32 s45, s38, 0x546000
 buffer_load_dwordx4 v[168:171], v13, s[76:79], s45 offen sc1
 s_add_u32 s45, s39, 0x546000
 buffer_load_dwordx4 v[200:203], v13, s[76:79], s45 offen sc1
 s_add_u32 s45, s40, 0x546000
 buffer_load_dwordx4 v[232:235], v13, s[76:79], s45 offen sc1
L_gbk3_2:
 s_bitcmp1_b32 s44, 9
 s_cbranch_scc0 L_gbk3_3
 s_add_u32 s45, s38, 0x7e6000
 buffer_load_dwordx4 v[172:175], v13, s[76:79], s45 offen sc1
 s_add_u32 s45, s39, 0x7e6000
 buffer_load_dwordx4 v[204:207], v13, s[76:79], s45 offen sc1
 s_add_u32 s45, s40, 0x7e6000
 buffer_load_dwordx4 v[236:239], v13, s[76:79], s45 offen sc1
L_gbk3_3:
 s_bitcmp1_b32 s44, 12
 s_cbranch_scc0 L_gbk3_4
 s_add_u32 s45, s38, 0xa86000
 buffer_load_dwordx4 v[176:179], v13, s[76:79], s45 offen sc1
 s_add_u32 s45, s39, 0xa86000
 buffer_load_dwordx4 v[208:211], v13, s[76:79], s45 offen sc1
 s_add_u32 s45, s40, 0xa86000
 buffer_load_dwordx4 v[240:243], v13, s[76:79], s45 offen sc1
L_gbk3_4:
 s_bitcmp1_b32 s44, 15
 s_cbranch_scc0 L_gbk3_5
 s_add_u32 s45, s38, 0xd26000
 buffer_load_dwordx4 v[180:183], v13, s[76:79], s45 offen sc1
 s_add_u32 s45, s39, 0xd26000
 buffer_load_dwordx4 v[212:215], v13, s[76:79], s45 offen sc1
 s_add_u32 s45, s40, 0xd26000
 buffer_load_dwordx4 v[244:247], v13, s[76:79], s45 offen sc1
L_gbk3_5:
 s_bitcmp1_b32 s44, 18
 s_cbranch_scc0 L_gbk3_6
 s_add_u32 s45, s38, 0xfc6000
 buffer_load_dwordx4 v[184:187], v13, s[76:79], s45 offen sc1
 s_add_u32 s45, s39, 0xfc6000
 buffer_load_dwordx4 v[216:219], v13, s[76:79], s45 offen sc1
 s_add_u32 s45, s40, 0xfc6000
 buffer_load_dwordx4 v[248:251], v13, s[76:79], s45 offen sc1
L_gbk3_6:
 s_bitcmp1_b32 s44, 21
 s_cbranch_scc0 L_gbk3_7
 s_add_u32 s45, s38, 0x1266000
 buffer_load_dwordx4 v[188:191], v13, s[76:79], s45 offen sc1
 s_add_u32 s45, s39, 0x1266000
 buffer_load_dwordx4 v[220:223], v13, s[76:79], s45 offen sc1
 s_add_u32 s45, s40, 0x1266000
 buffer_load_dwordx4 v[252:255], v13, s[76:79], s45 offen sc1
L_gbk3_7:
L_gbn3:
 s_cmp_eq_u32 s35, 0x249249
 s_cbranch_scc0 L_gbs
 s_waitcnt vmcnt(0)
 v_lshlrev_b32 v26, 16, v160
 v_and_b32 v27, s56, v160
 v_lshlrev_b32 v28, 16, v161
 v_and_b32 v29, s56, v161
 v_lshlrev_b32 v30, 16, v162
 v_and_b32 v31, s56, v162
 v_lshlrev_b32 v32, 16, v163
 v_and_b32 v33, s56, v163
 v_lshlrev_b32 v34, 16, v164
 v_and_b32 v35, s56, v164
 v_add_f32 v26, v26, v34
 v_add_f32 v27, v27, v35
 v_lshlrev_b32 v34, 16, v165
 v_and_b32 v35, s56, v165
 v_add_f32 v28, v28, v34
 v_add_f32 v29, v29, v35
 v_lshlrev_b32 v34, 16, v166
 v_and_b32 v35, s56, v166
 v_add_f32 v30, v30, v34
 v_add_f32 v31, v31, v35
 v_lshlrev_b32 v34, 16, v167
 v_and_b32 v35, s56, v167
 v_add_f32 v32, v32, v34
 v_add_f32 v33, v33, v35
 v_lshlrev_b32 v34, 16, v168
 v_and_b32 v35, s56, v168
 v_add_f32 v26, v26, v34
 v_add_f32 v27, v27, v35
 v_lshlrev_b32 v34, 16, v169
 v_and_b32 v35, s56, v169
 v_add_f32 v28, v28, v34
 v_add_f32 v29, v29, v35
 v_lshlrev_b32 v34, 16, v170
 v_and_b32 v35, s56, v170
 v_add_f32 v30, v30, v34
 v_add_f32 v31, v31, v35
 v_lshlrev_b32 v34, 16, v171
 v_and_b32 v35, s56, v171
 v_add_f32 v32, v32, v34
 v_add_f32 v33, v33, v35
 v_lshlrev_b32 v34, 16, v172
 v_and_b32 v35, s56, v172
 v_add_f32 v26, v26, v34
 v_add_f32 v27, v27, v35
 v_lshlrev_b32 v34, 16, v173
 v_and_b32 v35, s56, v173
 v_add_f32 v28, v28, v34
 v_add_f32 v29, v29, v35
 v_lshlrev_b32 v34, 16, v174
 v_and_b32 v35, s56, v174
 v_add_f32 v30, v30, v34
 v_add_f32 v31, v31, v35
 v_lshlrev_b32 v34, 16, v175
 v_and_b32 v35, s56, v175
 v_add_f32 v32, v32, v34
 v_add_f32 v33, v33, v35
 v_lshlrev_b32 v34, 16, v176
 v_and_b32 v35, s56, v176
 v_add_f32 v26, v26, v34
 v_add_f32 v27, v27, v35
 v_lshlrev_b32 v34, 16, v177
 v_and_b32 v35, s56, v177
 v_add_f32 v28, v28, v34
 v_add_f32 v29, v29, v35
 v_lshlrev_b32 v34, 16, v178
 v_and_b32 v35, s56, v178
 v_add_f32 v30, v30, v34
 v_add_f32 v31, v31, v35
 v_lshlrev_b32 v34, 16, v179
 v_and_b32 v35, s56, v179
 v_add_f32 v32, v32, v34
 v_add_f32 v33, v33, v35
 v_lshlrev_b32 v34, 16, v180
 v_and_b32 v35, s56, v180
 v_add_f32 v26, v26, v34
 v_add_f32 v27, v27, v35
 v_lshlrev_b32 v34, 16, v181
 v_and_b32 v35, s56, v181
 v_add_f32 v28, v28, v34
 v_add_f32 v29, v29, v35
 v_lshlrev_b32 v34, 16, v182
 v_and_b32 v35, s56, v182
 v_add_f32 v30, v30, v34
 v_add_f32 v31, v31, v35
 v_lshlrev_b32 v34, 16, v183
 v_and_b32 v35, s56, v183
 v_add_f32 v32, v32, v34
 v_add_f32 v33, v33, v35
 v_lshlrev_b32 v34, 16, v184
 v_and_b32 v35, s56, v184
 v_add_f32 v26, v26, v34
 v_add_f32 v27, v27, v35
 v_lshlrev_b32 v34, 16, v185
 v_and_b32 v35, s56, v185
 v_add_f32 v28, v28, v34
 v_add_f32 v29, v29, v35
 v_lshlrev_b32 v34, 16, v186
 v_and_b32 v35, s56, v186
 v_add_f32 v30, v30, v34
 v_add_f32 v31, v31, v35
 v_lshlrev_b32 v34, 16, v187
 v_and_b32 v35, s56, v187
 v_add_f32 v32, v32, v34
 v_add_f32 v33, v33, v35
 v_lshlrev_b32 v34, 16, v188
 v_and_b32 v35, s56, v188
 v_add_f32 v26, v26, v34
 v_add_f32 v27, v27, v35
 v_lshlrev_b32 v34, 16, v189
 v_and_b32 v35, s56, v189
 v_add_f32 v28, v28, v34
 v_add_f32 v29, v29, v35
 v_lshlrev_b32 v34, 16, v190
 v_and_b32 v35, s56, v190
 v_add_f32 v30, v30, v34
 v_add_f32 v31, v31, v35
 v_lshlrev_b32 v34, 16, v191
 v_and_b32 v35, s56, v191
 v_add_f32 v32, v32, v34
 v_add_f32 v33, v33, v35
 v_cvt_pk_bf16_f32 v26, v26, v27
 v_cvt_pk_bf16_f32 v27, v28, v29
 buffer_store_dwordx2 v[26:27], v50, s[84:87], s41 offen offset:256
 v_cvt_pk_bf16_f32 v30, v30, v31
 v_cvt_pk_bf16_f32 v31, v32, v33
 buffer_store_dwordx2 v[30:31], v50, s[84:87], s41 offen offset:288
 v_lshlrev_b32 v16, 16, v192
 v_and_b32 v17, s56, v192
 v_lshlrev_b32 v18, 16, v193
 v_and_b32 v19, s56, v193
 v_lshlrev_b32 v20, 16, v194
 v_and_b32 v21, s56, v194
 v_lshlrev_b32 v22, 16, v195
 v_and_b32 v23, s56, v195
 v_lshlrev_b32 v24, 16, v196
 v_and_b32 v25, s56, v196
 v_add_f32 v16, v16, v24
 v_add_f32 v17, v17, v25
 v_lshlrev_b32 v24, 16, v197
 v_and_b32 v25, s56, v197
 v_add_f32 v18, v18, v24
 v_add_f32 v19, v19, v25
 v_lshlrev_b32 v24, 16, v198
 v_and_b32 v25, s56, v198
 v_add_f32 v20, v20, v24
 v_add_f32 v21, v21, v25
 v_lshlrev_b32 v24, 16, v199
 v_and_b32 v25, s56, v199
 v_add_f32 v22, v22, v24
 v_add_f32 v23, v23, v25
 v_lshlrev_b32 v24, 16, v200
 v_and_b32 v25, s56, v200
 v_add_f32 v16, v16, v24
 v_add_f32 v17, v17, v25
 v_lshlrev_b32 v24, 16, v201
 v_and_b32 v25, s56, v201
 v_add_f32 v18, v18, v24
 v_add_f32 v19, v19, v25
 v_lshlrev_b32 v24, 16, v202
 v_and_b32 v25, s56, v202
 v_add_f32 v20, v20, v24
 v_add_f32 v21, v21, v25
 v_lshlrev_b32 v24, 16, v203
 v_and_b32 v25, s56, v203
 v_add_f32 v22, v22, v24
 v_add_f32 v23, v23, v25
 v_lshlrev_b32 v24, 16, v204
 v_and_b32 v25, s56, v204
 v_add_f32 v16, v16, v24
 v_add_f32 v17, v17, v25
 v_lshlrev_b32 v24, 16, v205
 v_and_b32 v25, s56, v205
 v_add_f32 v18, v18, v24
 v_add_f32 v19, v19, v25
 v_lshlrev_b32 v24, 16, v206
 v_and_b32 v25, s56, v206
 v_add_f32 v20, v20, v24
 v_add_f32 v21, v21, v25
 v_lshlrev_b32 v24, 16, v207
 v_and_b32 v25, s56, v207
 v_add_f32 v22, v22, v24
 v_add_f32 v23, v23, v25
 v_lshlrev_b32 v24, 16, v208
 v_and_b32 v25, s56, v208
 v_add_f32 v16, v16, v24
 v_add_f32 v17, v17, v25
 v_lshlrev_b32 v24, 16, v209
 v_and_b32 v25, s56, v209
 v_add_f32 v18, v18, v24
 v_add_f32 v19, v19, v25
 v_lshlrev_b32 v24, 16, v210
 v_and_b32 v25, s56, v210
 v_add_f32 v20, v20, v24
 v_add_f32 v21, v21, v25
 v_lshlrev_b32 v24, 16, v211
 v_and_b32 v25, s56, v211
 v_add_f32 v22, v22, v24
 v_add_f32 v23, v23, v25
 v_lshlrev_b32 v24, 16, v212
 v_and_b32 v25, s56, v212
 v_add_f32 v16, v16, v24
 v_add_f32 v17, v17, v25
 v_lshlrev_b32 v24, 16, v213
 v_and_b32 v25, s56, v213
 v_add_f32 v18, v18, v24
 v_add_f32 v19, v19, v25
 v_lshlrev_b32 v24, 16, v214
 v_and_b32 v25, s56, v214
 v_add_f32 v20, v20, v24
 v_add_f32 v21, v21, v25
 v_lshlrev_b32 v24, 16, v215
 v_and_b32 v25, s56, v215
 v_add_f32 v22, v22, v24
 v_add_f32 v23, v23, v25
 v_lshlrev_b32 v24, 16, v216
 v_and_b32 v25, s56, v216
 v_add_f32 v16, v16, v24
 v_add_f32 v17, v17, v25
 v_lshlrev_b32 v24, 16, v217
 v_and_b32 v25, s56, v217
 v_add_f32 v18, v18, v24
 v_add_f32 v19, v19, v25
 v_lshlrev_b32 v24, 16, v218
 v_and_b32 v25, s56, v218
 v_add_f32 v20, v20, v24
 v_add_f32 v21, v21, v25
 v_lshlrev_b32 v24, 16, v219
 v_and_b32 v25, s56, v219
 v_add_f32 v22, v22, v24
 v_add_f32 v23, v23, v25
 v_lshlrev_b32 v24, 16, v220
 v_and_b32 v25, s56, v220
 v_add_f32 v16, v16, v24
 v_add_f32 v17, v17, v25
 v_lshlrev_b32 v24, 16, v221
 v_and_b32 v25, s56, v221
 v_add_f32 v18, v18, v24
 v_add_f32 v19, v19, v25
 v_lshlrev_b32 v24, 16, v222
 v_and_b32 v25, s56, v222
 v_add_f32 v20, v20, v24
 v_add_f32 v21, v21, v25
 v_lshlrev_b32 v24, 16, v223
 v_and_b32 v25, s56, v223
 v_add_f32 v22, v22, v24
 v_add_f32 v23, v23, v25
 v_cvt_pk_bf16_f32 v16, v16, v17
 v_cvt_pk_bf16_f32 v17, v18, v19
 buffer_store_dwordx2 v[16:17], v50, s[84:87], s42 offen offset:256
 v_cvt_pk_bf16_f32 v20, v20, v21
 v_cvt_pk_bf16_f32 v21, v22, v23
 buffer_store_dwordx2 v[20:21], v50, s[84:87], s42 offen offset:288
 v_lshlrev_b32 v26, 16, v224
 v_and_b32 v27, s56, v224
 v_lshlrev_b32 v28, 16, v225
 v_and_b32 v29, s56, v225
 v_lshlrev_b32 v30, 16, v226
 v_and_b32 v31, s56, v226
 v_lshlrev_b32 v32, 16, v227
 v_and_b32 v33, s56, v227
 v_lshlrev_b32 v34, 16, v228
 v_and_b32 v35, s56, v228
 v_add_f32 v26, v26, v34
 v_add_f32 v27, v27, v35
 v_lshlrev_b32 v34, 16, v229
 v_and_b32 v35, s56, v229
 v_add_f32 v28, v28, v34
 v_add_f32 v29, v29, v35
 v_lshlrev_b32 v34, 16, v230
 v_and_b32 v35, s56, v230
 v_add_f32 v30, v30, v34
 v_add_f32 v31, v31, v35
 v_lshlrev_b32 v34, 16, v231
 v_and_b32 v35, s56, v231
 v_add_f32 v32, v32, v34
 v_add_f32 v33, v33, v35
 v_lshlrev_b32 v34, 16, v232
 v_and_b32 v35, s56, v232
 v_add_f32 v26, v26, v34
 v_add_f32 v27, v27, v35
 v_lshlrev_b32 v34, 16, v233
 v_and_b32 v35, s56, v233
 v_add_f32 v28, v28, v34
 v_add_f32 v29, v29, v35
 v_lshlrev_b32 v34, 16, v234
 v_and_b32 v35, s56, v234
 v_add_f32 v30, v30, v34
 v_add_f32 v31, v31, v35
 v_lshlrev_b32 v34, 16, v235
 v_and_b32 v35, s56, v235
 v_add_f32 v32, v32, v34
 v_add_f32 v33, v33, v35
 v_lshlrev_b32 v34, 16, v236
 v_and_b32 v35, s56, v236
 v_add_f32 v26, v26, v34
 v_add_f32 v27, v27, v35
 v_lshlrev_b32 v34, 16, v237
 v_and_b32 v35, s56, v237
 v_add_f32 v28, v28, v34
 v_add_f32 v29, v29, v35
 v_lshlrev_b32 v34, 16, v238
 v_and_b32 v35, s56, v238
 v_add_f32 v30, v30, v34
 v_add_f32 v31, v31, v35
 v_lshlrev_b32 v34, 16, v239
 v_and_b32 v35, s56, v239
 v_add_f32 v32, v32, v34
 v_add_f32 v33, v33, v35
 v_lshlrev_b32 v34, 16, v240
 v_and_b32 v35, s56, v240
 v_add_f32 v26, v26, v34
 v_add_f32 v27, v27, v35
 v_lshlrev_b32 v34, 16, v241
 v_and_b32 v35, s56, v241
 v_add_f32 v28, v28, v34
 v_add_f32 v29, v29, v35
 v_lshlrev_b32 v34, 16, v242
 v_and_b32 v35, s56, v242
 v_add_f32 v30, v30, v34
 v_add_f32 v31, v31, v35
 v_lshlrev_b32 v34, 16, v243
 v_and_b32 v35, s56, v243
 v_add_f32 v32, v32, v34
 v_add_f32 v33, v33, v35
 v_lshlrev_b32 v34, 16, v244
 v_and_b32 v35, s56, v244
 v_add_f32 v26, v26, v34
 v_add_f32 v27, v27, v35
 v_lshlrev_b32 v34, 16, v245
 v_and_b32 v35, s56, v245
 v_add_f32 v28, v28, v34
 v_add_f32 v29, v29, v35
 v_lshlrev_b32 v34, 16, v246
 v_and_b32 v35, s56, v246
 v_add_f32 v30, v30, v34
 v_add_f32 v31, v31, v35
 v_lshlrev_b32 v34, 16, v247
 v_and_b32 v35, s56, v247
 v_add_f32 v32, v32, v34
 v_add_f32 v33, v33, v35
 v_lshlrev_b32 v34, 16, v248
 v_and_b32 v35, s56, v248
 v_add_f32 v26, v26, v34
 v_add_f32 v27, v27, v35
 v_lshlrev_b32 v34, 16, v249
 v_and_b32 v35, s56, v249
 v_add_f32 v28, v28, v34
 v_add_f32 v29, v29, v35
 v_lshlrev_b32 v34, 16, v250
 v_and_b32 v35, s56, v250
 v_add_f32 v30, v30, v34
 v_add_f32 v31, v31, v35
 v_lshlrev_b32 v34, 16, v251
 v_and_b32 v35, s56, v251
 v_add_f32 v32, v32, v34
 v_add_f32 v33, v33, v35
 v_lshlrev_b32 v34, 16, v252
 v_and_b32 v35, s56, v252
 v_add_f32 v26, v26, v34
 v_add_f32 v27, v27, v35
 v_lshlrev_b32 v34, 16, v253
 v_and_b32 v35, s56, v253
 v_add_f32 v28, v28, v34
 v_add_f32 v29, v29, v35
 v_lshlrev_b32 v34, 16, v254
 v_and_b32 v35, s56, v254
 v_add_f32 v30, v30, v34
 v_add_f32 v31, v31, v35
 v_lshlrev_b32 v34, 16, v255
 v_and_b32 v35, s56, v255
 v_add_f32 v32, v32, v34
 v_add_f32 v33, v33, v35
 v_cvt_pk_bf16_f32 v26, v26, v27
 v_cvt_pk_bf16_f32 v27, v28, v29
 buffer_store_dwordx2 v[26:27], v50, s[84:87], s43 offen offset:256
 v_cvt_pk_bf16_f32 v30, v30, v31
 v_cvt_pk_bf16_f32 v31, v32, v33
 buffer_store_dwordx2 v[30:31], v50, s[84:87], s43 offen offset:288
L_exp2:
 s_waitcnt vmcnt(0)
L_exit0:
 s_endpgm
L_lslow:
L_lspin:
 s_add_u32 s57, s57, 1
 s_cmp_gt_u32 s57, 0x100000
 s_cbranch_scc1 L_exit0
 ds_read_b32 v9, v8
 s_waitcnt lgkmcnt(0)
 v_readlane_b32 s34, v9, 0
 v_readlane_b32 s35, v9, 1
 v_readlane_b32 s36, v9, 2
 s_min_u32 s34, s34, s35
 s_min_u32 s52, s34, s36
 s_cmp_ge_u32 s52, s50
 s_cbranch_scc1 L_lspin2
 s_sleep 2
 s_branch L_lspin
L_lspin2:
 s_setpc_b64 s[48:49]
L_ls8:
 s_movk_i32 s50, 1
 s_call_b64 s[48:49], L_lslow
 s_branch L_lb8
L_ls9:
 s_movk_i32 s50, 2
 s_call_b64 s[48:49], L_lslow
 s_branch L_lb9
L_ls10:
 s_movk_i32 s50, 4
 s_call_b64 s[48:49], L_lslow
 s_branch L_lb10
L_ls12:
 s_movk_i32 s50, 6
 s_call_b64 s[48:49], L_lslow
 s_branch L_lb12
L_ls18:
 s_movk_i32 s50, 8
 s_call_b64 s[48:49], L_lslow
 s_branch L_lb18
L_ls20:
 s_movk_i32 s50, 10
 s_call_b64 s[48:49], L_lslow
 s_branch L_lb20
L_ls29:
 s_movk_i32 s50, 12
 s_call_b64 s[48:49], L_lslow
 s_branch L_lb29
L_ls43:
 s_movk_i32 s50, 14
 s_call_b64 s[48:49], L_lslow
 s_branch L_lb43
L_ls33:
 s_movk_i32 s50, 16
 s_call_b64 s[48:49], L_lslow
 s_branch L_lb33
L_ls34:
 s_movk_i32 s50, 18
 s_call_b64 s[48:49], L_lslow
 s_branch L_lb34
L_ls37:
 s_movk_i32 s50, 20
 s_call_b64 s[48:49], L_lslow
 s_branch L_lb37
L_ls38:
 s_movk_i32 s50, 22
 s_call_b64 s[48:49], L_lslow
 s_branch L_lb38
L_ls41:
 s_movk_i32 s50, 24
 s_call_b64 s[48:49], L_lslow
 s_branch L_lb41
L_ls42:
 s_movk_i32 s50, 26
 s_call_b64 s[48:49], L_lslow
 s_branch L_lb42
L_ls44:
 s_movk_i32 s50, 28
 s_call_b64 s[48:49], L_lslow
 s_branch L_lb44
L_ls49:
 s_movk_i32 s50, 30
 s_call_b64 s[48:49], L_lslow
 s_branch L_lb49
L_ls46:
 s_movk_i32 s50, 33
 s_call_b64 s[48:49], L_lslow
 s_branch L_lb46
L_ls48:
 s_movk_i32 s50, 35
 s_call_b64 s[48:49], L_lslow
 s_branch L_lb48
L_ls53:
 s_movk_i32 s50, 37
 s_call_b64 s[48:49], L_lslow
 s_branch L_lb53
L_ls54:
 s_movk_i32 s50, 39
 s_call_b64 s[48:49], L_lslow
 s_branch L_lb54
L_ls61:
 s_movk_i32 s50, 45
 s_call_b64 s[48:49], L_lslow
 s_branch L_lb61
L_ls67:
 s_movk_i32 s50, 51
 s_call_b64 s[48:49], L_lslow
 s_branch L_lb67
L_ls73:
 s_movk_i32 s50, 57
 s_call_b64 s[48:49], L_lslow
 s_branch L_lb73
L_ls75:
 s_movk_i32 s50, 63
 s_call_b64 s[48:49], L_lslow
 s_branch L_lb75
L_ls81:
 s_movk_i32 s50, 69
 s_call_b64 s[48:49], L_lslow
 s_branch L_lb81
L_ls87:
 s_movk_i32 s50, 75
 s_call_b64 s[48:49], L_lslow
 s_branch L_lb87
L_ls93:
 s_movk_i32 s50, 76
 s_call_b64 s[48:49], L_lslow
 s_branch L_lb93
L_ls94:
 s_movk_i32 s50, 82
 s_call_b64 s[48:49], L_lslow
 s_branch L_lb94
L_ls100:
 s_movk_i32 s50, 88
 s_call_b64 s[48:49], L_lslow
 s_branch L_lb100
L_ls106:
 s_movk_i32 s50, 94
 s_call_b64 s[48:49], L_lslow
 s_branch L_lb106
L_ls112:
 s_movk_i32 s50, 95
 s_call_b64 s[48:49], L_lslow
 s_branch L_lb112
L_ls113:
 s_movk_i32 s50, 101
 s_call_b64 s[48:49], L_lslow
 s_branch L_lb113
L_ls120:
 s_movk_i32 s50, 103
 s_call_b64 s[48:49], L_lslow
 s_branch L_lb120
L_ls121:
 s_movk_i32 s50, 105
 s_call_b64 s[48:49], L_lslow
 s_branch L_lb121
L_ls124:
 s_movk_i32 s50, 109
 s_call_b64 s[48:49], L_lslow
 s_branch L_lb124
L_ls125:
 s_movk_i32 s50, 111
 s_call_b64 s[48:49], L_lslow
 s_branch L_lb125
L_ls129:
 s_movk_i32 s50, 116
 s_call_b64 s[48:49], L_lslow
 s_branch L_lb129
L_ls130:
 s_movk_i32 s50, 118
 s_call_b64 s[48:49], L_lslow
 s_branch L_lb130
L_ls134:
 s_movk_i32 s50, 120
 s_call_b64 s[48:49], L_lslow
 s_branch L_lb134
L_ls135:
 s_movk_i32 s50, 122
 s_call_b64 s[48:49], L_lslow
 s_branch L_lb135
L_ls140:
 s_movk_i32 s50, 124
 s_call_b64 s[48:49], L_lslow
 s_branch L_lb140
L_ls141:
 s_movk_i32 s50, 126
 s_call_b64 s[48:49], L_lslow
 s_branch L_lb141
L_ls146:
 s_movk_i32 s50, 129
 s_call_b64 s[48:49], L_lslow
 s_branch L_lb146
L_ls147:
 s_movk_i32 s50, 131
 s_call_b64 s[48:49], L_lslow
 s_branch L_lb147
L_ls149:
 s_movk_i32 s50, 132
 s_call_b64 s[48:49], L_lslow
 s_branch L_lb149
L_ls152:
 s_movk_i32 s50, 134
 s_call_b64 s[48:49], L_lslow
 s_branch L_lb152
L_ls153:
 s_movk_i32 s50, 136
 s_call_b64 s[48:49], L_lslow
 s_branch L_lb153
L_ls154:
 s_movk_i32 s50, 138
 s_call_b64 s[48:49], L_lslow
 s_branch L_lb154
L_ls158:
 s_movk_i32 s50, 140
 s_call_b64 s[48:49], L_lslow
 s_branch L_lb158
L_ls159:
 s_movk_i32 s50, 142
 s_call_b64 s[48:49], L_lslow
 s_branch L_lb159
L_ls160:
 s_movk_i32 s50, 144
 s_call_b64 s[48:49], L_lslow
 s_branch L_lb160
L_ls164:
 s_movk_i32 s50, 146
 s_call_b64 s[48:49], L_lslow
 s_branch L_lb164
L_ls165:
 s_movk_i32 s50, 148
 s_call_b64 s[48:49], L_lslow
 s_branch L_lb165
L_ls166:
 s_movk_i32 s50, 150
 s_call_b64 s[48:49], L_lslow
 s_branch L_lb166
L_ls170:
 s_movk_i32 s50, 152
 s_call_b64 s[48:49], L_lslow
 s_branch L_lb170
L_ls171:
 s_movk_i32 s50, 154
 s_call_b64 s[48:49], L_lslow
 s_branch L_lb171
L_ls172:
 s_movk_i32 s50, 156
 s_call_b64 s[48:49], L_lslow
 s_branch L_lb172
L_ls176:
 s_movk_i32 s50, 158
 s_call_b64 s[48:49], L_lslow
 s_branch L_lb176
L_ls177:
 s_movk_i32 s50, 160
 s_call_b64 s[48:49], L_lslow
 s_branch L_lb177
L_ls178:
 s_movk_i32 s50, 162
 s_call_b64 s[48:49], L_lslow
 s_branch L_lb178
L_ls182:
 s_movk_i32 s50, 164
 s_call_b64 s[48:49], L_lslow
 s_branch L_lb182
L_ls183:
 s_movk_i32 s50, 166
 s_call_b64 s[48:49], L_lslow
 s_branch L_lb183
L_ls184:
 s_movk_i32 s50, 168
 s_call_b64 s[48:49], L_lslow
 s_branch L_lb184
L_ls188:
 s_movk_i32 s50, 170
 s_call_b64 s[48:49], L_lslow
 s_branch L_lb188
L_ls189:
 s_movk_i32 s50, 172
 s_call_b64 s[48:49], L_lslow
 s_branch L_lb189
L_ls190:
 s_movk_i32 s50, 174
 s_call_b64 s[48:49], L_lslow
 s_branch L_lb190
L_ls194:
 s_movk_i32 s50, 176
 s_call_b64 s[48:49], L_lslow
 s_branch L_lb194
L_ls195:
 s_movk_i32 s50, 178
 s_call_b64 s[48:49], L_lslow
 s_branch L_lb195
L_ls196:
 s_movk_i32 s50, 180
 s_call_b64 s[48:49], L_lslow
 s_branch L_lb196
L_ls200:
 s_movk_i32 s50, 182
 s_call_b64 s[48:49], L_lslow
 s_branch L_lb200
L_ls201:
 s_movk_i32 s50, 184
 s_call_b64 s[48:49], L_lslow
 s_branch L_lb201
L_ls202:
 s_movk_i32 s50, 186
 s_call_b64 s[48:49], L_lslow
 s_branch L_lb202
L_ls206:
 s_movk_i32 s50, 188
 s_call_b64 s[48:49], L_lslow
 s_branch L_lb206
L_ls207:
 s_movk_i32 s50, 190
 s_call_b64 s[48:49], L_lslow
 s_branch L_lb207
L_ls208:
 s_movk_i32 s50, 192
 s_call_b64 s[48:49], L_lslow
 s_branch L_lb208
L_ls211:
 s_movk_i32 s50, 194
 s_call_b64 s[48:49], L_lslow
 s_branch L_lb211
L_ls213:
 s_movk_i32 s50, 196
 s_call_b64 s[48:49], L_lslow
 s_branch L_lb213
L_ls215:
 s_movk_i32 s50, 198
 s_call_b64 s[48:49], L_lslow
 s_branch L_lb215
L_ls217:
 s_movk_i32 s50, 200
 s_call_b64 s[48:49], L_lslow
 s_branch L_lb217
L_ls219:
 s_movk_i32 s50, 202
 s_call_b64 s[48:49], L_lslow
 s_branch L_lb219
L_ls221:
 s_movk_i32 s50, 204
 s_call_b64 s[48:49], L_lslow
 s_branch L_lb221
L_ls223:
 s_movk_i32 s50, 206
 s_call_b64 s[48:49], L_lslow
 s_branch L_lb223
L_ls225:
 s_movk_i32 s50, 208
 s_call_b64 s[48:49], L_lslow
 s_branch L_lb225
L_ls227:
 s_movk_i32 s50, 210
 s_call_b64 s[48:49], L_lslow
 s_branch L_lb227
L_ls229:
 s_movk_i32 s50, 212
 s_call_b64 s[48:49], L_lslow
 s_branch L_lb229
L_ls231:
 s_movk_i32 s50, 214
 s_call_b64 s[48:49], L_lslow
 s_branch L_lb231
L_ls233:
 s_movk_i32 s50, 216
 s_call_b64 s[48:49], L_lslow
 s_branch L_lb233
L_ls235:
 s_movk_i32 s50, 218
 s_call_b64 s[48:49], L_lslow
 s_branch L_lb235
L_ls237:
 s_movk_i32 s50, 220
 s_call_b64 s[48:49], L_lslow
 s_branch L_lb237
L_ls239:
 s_movk_i32 s50, 222
 s_call_b64 s[48:49], L_lslow
 s_branch L_lb239
L_cons:
 v_lshlrev_b32 v60, 2, v0
 v_add_u32 v61, 1, v60
 v_add_u32 v62, 2, v60
 v_add_u32 v63, 3, v60
 v_lshlrev_b32 v38, 4, v0
 s_waitcnt lgkmcnt(0)
 s_lshl_b32 s34, s2, 10
 s_add_u32 s34, s34, 34603008
 s_add_u32 s72, s46, s34
 s_addc_u32 s73, s47, 0
 s_and_b32 s73, s73, 0xffff
 s_mov_b32 s74, 0x400
 s_mov_b32 s75, 0x20000
 buffer_store_dwordx4 v[60:63], v38, s[72:75], 0 offen
 s_sub_u32 s34, s4, s6
 s_lshl_b32 s34, s34, 3
 s_add_u32 s34, s34, s6
 s_mul_i32 s34, s34, 86016
 s_add_u32 s76, s46, s34
 s_addc_u32 s77, s47, 0
 s_and_b32 s77, s77, 0xffff
 s_mov_b32 s78, 0x1275000
 s_mov_b32 s79, 0x20000
 s_lshl_b32 s34, s4, 12
 s_add_u32 s34, s34, 33554432
 s_add_u32 s80, s46, s34
 s_addc_u32 s81, s47, 0
 s_and_b32 s81, s81, 0xffff
 s_mov_b32 s82, 0x1000
 s_mov_b32 s83, 0x20000
 s_lshl_b32 s53, s5, 9
 s_mul_i32 s34, s4, 86016
 s_add_u32 s84, s64, s34
 s_addc_u32 s85, s65, 0
 s_and_b32 s85, s85, 0xffff
 s_mov_b32 s86, 0x15000
 s_mov_b32 s87, 0x20000
 s_lshl_b32 s34, s4, 3
 s_add_u32 s88, s66, s34
 s_addc_u32 s89, s67, 0
 s_and_b32 s89, s89, 0xffff
 s_mov_b32 s90, 0x4
 s_mov_b32 s91, 0x20000
 s_add_u32 s34, s5, s3
 s_lshl_b32 s34, s34, 12
 v_lshl_add_u32 v20, v0, 4, s34
 v_mov_b32 v56, 0
 v_mov_b32 v57, 0
 v_mov_b32 v58, 0
 v_mov_b32 v59, 0
 buffer_store_dwordx4 v[56:59], v20, s[80:83], 0 offen offset:0 sc1
 buffer_store_dwordx4 v[56:59], v20, s[80:83], 0 offen offset:1024 sc1
 buffer_store_dwordx4 v[56:59], v20, s[80:83], 0 offen offset:2048 sc1
 buffer_store_dwordx4 v[56:59], v20, s[80:83], 0 offen offset:3072 sc1
 s_mul_i32 s44, s5, 3
 s_add_u32 s44, s44, s3
 s_lshl_b32 s42, s44, 10
 s_cmp_ge_u32 s44, 12
 s_cselect_b32 s43, 128, 0
 s_cselect_b32 s45, 12, 0
 s_sub_u32 s44, s44, s45
 s_lshr_b32 s45, s44, 2
 s_mul_i32 s45, s45, 28672
 s_add_u32 s43, s43, s45
 s_and_b32 s45, s44, 1
 s_mul_i32 s45, s45, 14336
 s_add_u32 s43, s43, s45
 s_and_b32 s45, s44, 2
 s_lshl_b32 s45, s45, 5
 s_add_u32 s43, s43, s45
 s_mul_i32 s68, s5, 3
 s_add_u32 s68, s68, s3
 s_lshl_b32 s68, s68, 2
 s_sub_u32 s34, s4, s6
 s_lshl_b32 s34, s34, 3
 s_mul_i32 s35, s5, 32
 s_add_u32 s34, s34, s35
 s_add_u32 s34, s34, s6
 s_mul_i32 s34, s34, 86016
 s_add_u32 s28, s46, s34
 s_addc_u32 s29, s47, 0
 s_and_b32 s29, s29, 0xffff
 s_mov_b32 s30, 0x15000
 s_mov_b32 s31, 0x20000
 v_lshrrev_b32 v20, 2, v0
 v_lshlrev_b32 v20, 7, v20
 v_bfe_u32 v21, v0, 3, 2
 v_lshl_add_u32 v20, v21, 5, v20
 v_and_b32 v21, 3, v0
 v_lshl_add_u32 v5, v21, 3, v20
 v_xor_b32 v6, 32, v5
 v_xor_b32 v7, 64, v5
 v_xor_b32 v8, 96, v5
 v_and_b32 v20, 15, v0
 v_lshrrev_b32 v21, 1, v20
 v_lshrrev_b32 v22, 4, v0
 v_xor_b32 v21, v21, v22
 v_lshlrev_b32 v21, 4, v21
 v_lshl_add_u32 v3, v20, 7, v21
 v_xor_b32 v4, 64, v3
 v_bfe_u32 v20, v0, 3, 2
 v_lshlrev_b32 v20, 1, v20
 v_and_b32 v21, 3, v0
 v_xor_b32 v20, v20, v21
 v_lshlrev_b32 v20, 4, v20
 v_lshrrev_b32 v21, 2, v0
 v_lshl_add_u32 v24, v21, 7, v20
 v_xor_b32 v25, 64, v24
 s_lshl_b32 s41, s3, 12
 s_add_u32 s41, s41, 65536
 v_add_u32 v16, s41, v3
 v_add_u32 v17, s41, v4
 v_add_u32 v18, 49152, v16
 v_add_u32 v19, 49152, v17
 v_mov_b32 v9, 162816
 v_add_u32 v1, s3, v0
 v_lshlrev_b32 v1, 3, v1
 s_mov_b32 s32, 0x3db8aa3b
 s_mov_b32 s56, 0xffff0000
 s_lshl_b32 s34, s3, 12
 s_add_u32 s35, s34, 12288
 s_add_u32 s36, s34, 24576
 s_add_u32 s37, s34, 36864
 s_add_u32 s38, s34, 49152
 s_add_u32 s39, s34, 61440
 s_add_u32 s40, s34, 73728
 s_waitcnt vmcnt(4)
 s_barrier
 ds_read_b32 v10, v9
 s_waitcnt lgkmcnt(0)
 v_cmp_le_u32 vcc, 2, v10
 s_cbranch_vccz L_cs0
L_cb0:
 ds_read_b128 a[0:3], v16 offset:0
 ds_read_b128 a[4:7], v16 offset:2048
 ds_read_b128 a[8:11], v17 offset:0
 ds_read_b128 a[12:15], v17 offset:2048
 ds_read_b64_tr_b16 a[224:225], v24 offset:0
 ds_read_b64_tr_b16 a[226:227], v24 offset:2048
 ds_read_b64_tr_b16 a[228:229], v24 offset:8
 ds_read_b32 v10, v9
 ds_read_b64_tr_b16 a[230:231], v24 offset:2056
 ds_read_b64_tr_b16 a[232:233], v25 offset:0
 ds_read_b64_tr_b16 a[234:235], v25 offset:2048
 ds_read_b64_tr_b16 a[236:237], v25 offset:8
 ds_read_b64_tr_b16 a[238:239], v25 offset:2056
 ds_read_b64_tr_b16 a[240:241], v24 offset:4096
 ds_read_b64_tr_b16 a[242:243], v24 offset:6144
 ds_read_b64_tr_b16 a[244:245], v24 offset:4104
 ds_read_b64_tr_b16 a[246:247], v24 offset:6152
 ds_read_b64_tr_b16 a[248:249], v25 offset:4096
 s_waitcnt lgkmcnt(5)
 ds_read_b64_tr_b16 a[250:251], v25 offset:6144
 v_mfma_f32_16x16x32_bf16 v[128:131], a[224:227], a[0:3], 0
 ds_read_b64_tr_b16 a[252:253], v25 offset:4104
 v_cmp_le_u32 vcc, 3, v10
 v_mfma_f32_16x16x32_bf16 v[136:139], a[224:227], a[4:7], 0
 ds_read_b64_tr_b16 a[254:255], v25 offset:6152
 v_mfma_f32_16x16x32_bf16 v[132:135], a[228:231], a[0:3], 0
 s_cbranch_vccz L_cs8
L_cb8:
 ds_read_b64_tr_b16 a[224:225], v24 offset:8192
 v_mfma_f32_16x16x32_bf16 v[140:143], a[228:231], a[4:7], 0
 ds_read_b64_tr_b16 a[226:227], v24 offset:10240
 v_mfma_f32_16x16x32_bf16 v[144:147], a[232:235], a[0:3], 0
 ds_read_b64_tr_b16 a[228:229], v24 offset:8200
 ds_read_b32 v10, v9
 v_mfma_f32_16x16x32_bf16 v[152:155], a[232:235], a[4:7], 0
 ds_read_b64_tr_b16 a[230:231], v24 offset:10248
 v_mfma_f32_16x16x32_bf16 v[148:151], a[236:239], a[0:3], 0
 ds_read_b64_tr_b16 a[232:233], v25 offset:8192
 s_waitcnt lgkmcnt(6)
 v_mfma_f32_16x16x32_bf16 v[156:159], a[236:239], a[4:7], 0
 ds_read_b64_tr_b16 a[234:235], v25 offset:10240
 v_mfma_f32_16x16x32_bf16 v[128:131], a[240:243], a[8:11], v[128:131]
 ds_read_b64_tr_b16 a[236:237], v25 offset:8200
 v_mfma_f32_16x16x32_bf16 v[136:139], a[240:243], a[12:15], v[136:139]
 ds_read_b64_tr_b16 a[238:239], v25 offset:10248
 v_mfma_f32_16x16x32_bf16 v[132:135], a[244:247], a[8:11], v[132:135]
 ds_read_b64_tr_b16 a[240:241], v24 offset:12288
 v_mfma_f32_16x16x32_bf16 v[140:143], a[244:247], a[12:15], v[140:143]
 ds_read_b64_tr_b16 a[242:243], v24 offset:14336
 s_movk_i32 s70, 4
 v_mfma_f32_16x16x32_bf16 v[144:147], a[248:251], a[8:11], v[144:147]
 ds_read_b64_tr_b16 a[244:245], v24 offset:12296
 v_mfma_f32_16x16x32_bf16 v[152:155], a[248:251], a[12:15], v[152:155]
 ds_read_b64_tr_b16 a[246:247], v24 offset:14344
 v_mfma_f32_16x16x32_bf16 v[148:151], a[252:255], a[8:11], v[148:151]
 ds_read_b64_tr_b16 a[248:249], v25 offset:12288
 s_waitcnt lgkmcnt(5)
 v_mfma_f32_16x16x32_bf16 v[156:159], a[252:255], a[12:15], v[156:159]
 ds_read_b64_tr_b16 a[250:251], v25 offset:14336
 buffer_load_dword off, s[72:75], s70 lds
 v_mfma_f32_16x16x32_bf16 v[160:163], a[224:227], a[0:3], 0
 ds_read_b64_tr_b16 a[252:253], v25 offset:12296
 v_cmp_le_u32 vcc, 4, v10
 v_mfma_f32_16x16x32_bf16 v[168:171], a[224:227], a[4:7], 0
 ds_read_b64_tr_b16 a[254:255], v25 offset:14344
 v_mfma_f32_16x16x32_bf16 v[164:167], a[228:231], a[0:3], 0
 s_cbranch_vccz L_cs16
L_cb16:
 ds_read_b64_tr_b16 a[224:225], v24 offset:16384
 v_mfma_f32_16x16x32_bf16 v[172:175], a[228:231], a[4:7], 0
 ds_read_b64_tr_b16 a[226:227], v24 offset:18432
 v_mfma_f32_16x16x32_bf16 v[176:179], a[232:235], a[0:3], 0
 ds_read_b64_tr_b16 a[228:229], v24 offset:16392
 ds_read_b32 v10, v9
 v_mfma_f32_16x16x32_bf16 v[184:187], a[232:235], a[4:7], 0
 ds_read_b64_tr_b16 a[230:231], v24 offset:18440
 v_mfma_f32_16x16x32_bf16 v[180:183], a[236:239], a[0:3], 0
 ds_read_b64_tr_b16 a[232:233], v25 offset:16384
 s_waitcnt lgkmcnt(6)
 v_mfma_f32_16x16x32_bf16 v[188:191], a[236:239], a[4:7], 0
 ds_read_b64_tr_b16 a[234:235], v25 offset:18432
 v_mfma_f32_16x16x32_bf16 v[160:163], a[240:243], a[8:11], v[160:163]
 ds_read_b64_tr_b16 a[236:237], v25 offset:16392
 v_mfma_f32_16x16x32_bf16 v[168:171], a[240:243], a[12:15], v[168:171]
 ds_read_b64_tr_b16 a[238:239], v25 offset:18440
 v_mfma_f32_16x16x32_bf16 v[164:167], a[244:247], a[8:11], v[164:167]
 ds_read_b64_tr_b16 a[240:241], v24 offset:20480
 v_mfma_f32_16x16x32_bf16 v[172:175], a[244:247], a[12:15], v[172:175]
 ds_read_b64_tr_b16 a[242:243], v24 offset:22528
 s_movk_i32 s70, 8
 v_mfma_f32_16x16x32_bf16 v[176:179], a[248:251], a[8:11], v[176:179]
 ds_read_b64_tr_b16 a[244:245], v24 offset:20488
 v_mfma_f32_16x16x32_bf16 v[184:187], a[248:251], a[12:15], v[184:187]
 ds_read_b64_tr_b16 a[246:247], v24 offset:22536
 v_mfma_f32_16x16x32_bf16 v[180:183], a[252:255], a[8:11], v[180:183]
 ds_read_b64_tr_b16 a[248:249], v25 offset:20480
 s_waitcnt lgkmcnt(5)
 v_mfma_f32_16x16x32_bf16 v[188:191], a[252:255], a[12:15], v[188:191]
 ds_read_b64_tr_b16 a[250:251], v25 offset:22528
 buffer_load_dword off, s[72:75], s70 lds
 v_mfma_f32_16x16x32_bf16 v[192:195], a[224:227], a[0:3], 0
 ds_read_b64_tr_b16 a[252:253], v25 offset:20488
 v_cmp_le_u32 vcc, 8, v10
 v_mfma_f32_16x16x32_bf16 v[200:203], a[224:227], a[4:7], 0
 ds_read_b64_tr_b16 a[254:255], v25 offset:22536
 v_mfma_f32_16x16x32_bf16 v[196:199], a[228:231], a[0:3], 0
 s_cbranch_vccz L_cs24
L_cb24:
 ds_read_b128 a[16:19], v16 offset:12288
 ds_read_b64_tr_b16 a[224:225], v24 offset:24576
 v_mfma_f32_16x16x32_bf16 v[204:207], a[228:231], a[4:7], 0
 ds_read_b64_tr_b16 a[226:227], v24 offset:26624
 v_mfma_f32_16x16x32_bf16 v[208:211], a[232:235], a[0:3], 0
 ds_read_b128 a[20:23], v16 offset:14336
 ds_read_b64_tr_b16 a[228:229], v24 offset:24584
 v_mfma_f32_16x16x32_bf16 v[216:219], a[232:235], a[4:7], 0
 ds_read_b64_tr_b16 a[230:231], v24 offset:26632
 v_mfma_f32_16x16x32_bf16 v[212:215], a[236:239], a[0:3], 0
 ds_read_b128 a[24:27], v17 offset:12288
 ds_read_b64_tr_b16 a[232:233], v25 offset:24576
 v_mfma_f32_16x16x32_bf16 v[220:223], a[236:239], a[4:7], 0
 ds_read_b64_tr_b16 a[234:235], v25 offset:26624
 s_waitcnt lgkmcnt(9)
 v_mfma_f32_16x16x32_bf16 v[192:195], a[240:243], a[8:11], v[192:195]
 ds_read_b128 a[28:31], v17 offset:14336
 ds_read_b64_tr_b16 a[236:237], v25 offset:24584
 v_mfma_f32_16x16x32_bf16 v[200:203], a[240:243], a[12:15], v[200:203]
 ds_read_b64_tr_b16 a[238:239], v25 offset:26632
 v_mfma_f32_16x16x32_bf16 v[196:199], a[244:247], a[8:11], v[196:199]
 ds_read_b128 a[32:35], v16 offset:24576
 ds_read_b64_tr_b16 a[240:241], v24 offset:28672
 v_mfma_f32_16x16x32_bf16 v[204:207], a[244:247], a[12:15], v[204:207]
 ds_read_b64_tr_b16 a[242:243], v24 offset:30720
 v_mfma_f32_16x16x32_bf16 v[208:211], a[248:251], a[8:11], v[208:211]
 ds_read_b128 a[36:39], v16 offset:26624
 ds_read_b64_tr_b16 a[244:245], v24 offset:28680
 v_mfma_f32_16x16x32_bf16 v[216:219], a[248:251], a[12:15], v[216:219]
 ds_read_b64_tr_b16 a[246:247], v24 offset:30728
 v_mfma_f32_16x16x32_bf16 v[212:215], a[252:255], a[8:11], v[212:215]
 ds_read_b128 a[40:43], v17 offset:24576
 ds_read_b64_tr_b16 a[248:249], v25 offset:28672
 v_mfma_f32_16x16x32_bf16 v[220:223], a[252:255], a[12:15], v[220:223]
 ds_read_b64_tr_b16 a[250:251], v25 offset:30720
 s_waitcnt lgkmcnt(9)
 v_mfma_f32_16x16x32_bf16 v[224:227], a[224:227], a[0:3], 0
 ds_read_b128 a[44:47], v17 offset:26624
 ds_read_b64_tr_b16 a[252:253], v25 offset:28680
 v_mfma_f32_16x16x32_bf16 v[232:235], a[224:227], a[4:7], 0
 ds_read_b64_tr_b16 a[254:255], v25 offset:30728
 v_mfma_f32_16x16x32_bf16 v[228:231], a[228:231], a[0:3], 0
 ds_read_b64_tr_b16 a[224:225], v24 offset:32768
 v_mfma_f32_16x16x32_bf16 v[236:239], a[228:231], a[4:7], 0
 ds_read_b64_tr_b16 a[226:227], v24 offset:34816
 v_mfma_f32_16x16x32_bf16 v[240:243], a[232:235], a[0:3], 0
 ds_read_b64_tr_b16 a[228:229], v24 offset:32776
 ds_read_b32 v10, v9
 v_mfma_f32_16x16x32_bf16 v[248:251], a[232:235], a[4:7], 0
 ds_read_b64_tr_b16 a[230:231], v24 offset:34824
 v_mfma_f32_16x16x32_bf16 v[244:247], a[236:239], a[0:3], 0
 ds_read_b64_tr_b16 a[232:233], v25 offset:32768
 s_waitcnt lgkmcnt(6)
 v_mfma_f32_16x16x32_bf16 v[252:255], a[236:239], a[4:7], 0
 ds_read_b64_tr_b16 a[234:235], v25 offset:34816
 v_mfma_f32_16x16x32_bf16 v[224:227], a[240:243], a[8:11], v[224:227]
 ds_read_b64_tr_b16 a[236:237], v25 offset:32776
 v_mfma_f32_16x16x32_bf16 v[232:235], a[240:243], a[12:15], v[232:235]
 ds_read_b64_tr_b16 a[238:239], v25 offset:34824
 v_mfma_f32_16x16x32_bf16 v[228:231], a[244:247], a[8:11], v[228:231]
 ds_read_b64_tr_b16 a[240:241], v24 offset:36864
 v_mfma_f32_16x16x32_bf16 v[236:239], a[244:247], a[12:15], v[236:239]
 ds_read_b64_tr_b16 a[242:243], v24 offset:38912
 s_movk_i32 s70, 16
 v_mfma_f32_16x16x32_bf16 v[240:243], a[248:251], a[8:11], v[240:243]
 ds_read_b64_tr_b16 a[244:245], v24 offset:36872
 v_mfma_f32_16x16x32_bf16 v[248:251], a[248:251], a[12:15], v[248:251]
 ds_read_b64_tr_b16 a[246:247], v24 offset:38920
 v_mfma_f32_16x16x32_bf16 v[244:247], a[252:255], a[8:11], v[244:247]
 ds_read_b64_tr_b16 a[248:249], v25 offset:36864
 s_waitcnt lgkmcnt(5)
 v_mfma_f32_16x16x32_bf16 v[252:255], a[252:255], a[12:15], v[252:255]
 ds_read_b64_tr_b16 a[250:251], v25 offset:38912
 buffer_load_dword off, s[72:75], s70 lds
 v_mfma_f32_16x16x32_bf16 v[128:131], a[224:227], a[16:19], v[128:131]
 ds_read_b64_tr_b16 a[252:253], v25 offset:36872
 v_cmp_le_u32 vcc, 10, v10
 v_mfma_f32_16x16x32_bf16 v[136:139], a[224:227], a[20:23], v[136:139]
 ds_read_b64_tr_b16 a[254:255], v25 offset:38920
 v_mfma_f32_16x16x32_bf16 v[132:135], a[228:231], a[16:19], v[132:135]
 s_cbranch_vccz L_cs40
L_cb40:
 ds_read_b64_tr_b16 a[224:225], v24 offset:40960
 v_mfma_f32_16x16x32_bf16 v[140:143], a[228:231], a[20:23], v[140:143]
 ds_read_b64_tr_b16 a[226:227], v24 offset:43008
 v_mfma_f32_16x16x32_bf16 v[144:147], a[232:235], a[16:19], v[144:147]
 ds_read_b64_tr_b16 a[228:229], v24 offset:40968
 v_mfma_f32_16x16x32_bf16 v[152:155], a[232:235], a[20:23], v[152:155]
 ds_read_b64_tr_b16 a[230:231], v24 offset:43016
 v_mfma_f32_16x16x32_bf16 v[148:151], a[236:239], a[16:19], v[148:151]
 ds_read_b64_tr_b16 a[232:233], v25 offset:40960
 s_waitcnt lgkmcnt(5)
 v_mfma_f32_16x16x32_bf16 v[156:159], a[236:239], a[20:23], v[156:159]
 ds_read_b64_tr_b16 a[234:235], v25 offset:43008
 v_mfma_f32_16x16x32_bf16 v[128:131], a[240:243], a[24:27], v[128:131]
 ds_read_b64_tr_b16 a[236:237], v25 offset:40968
 v_mfma_f32_16x16x32_bf16 v[136:139], a[240:243], a[28:31], v[136:139]
 ds_read_b64_tr_b16 a[238:239], v25 offset:43016
 v_mfma_f32_16x16x32_bf16 v[132:135], a[244:247], a[24:27], v[132:135]
 ds_read_b64_tr_b16 a[240:241], v24 offset:45056
 v_mfma_f32_16x16x32_bf16 v[140:143], a[244:247], a[28:31], v[140:143]
 ds_read_b64_tr_b16 a[242:243], v24 offset:47104
 v_mfma_f32_16x16x32_bf16 v[144:147], a[248:251], a[24:27], v[144:147]
 ds_read_b64_tr_b16 a[244:245], v24 offset:45064
 v_mfma_f32_16x16x32_bf16 v[152:155], a[248:251], a[28:31], v[152:155]
 ds_read_b64_tr_b16 a[246:247], v24 offset:47112
 v_mfma_f32_16x16x32_bf16 v[148:151], a[252:255], a[24:27], v[148:151]
 ds_read_b64_tr_b16 a[248:249], v25 offset:45056
 s_waitcnt lgkmcnt(5)
 v_mfma_f32_16x16x32_bf16 v[156:159], a[252:255], a[28:31], v[156:159]
 ds_read_b64_tr_b16 a[250:251], v25 offset:47104
 v_mfma_f32_16x16x32_bf16 v[160:163], a[224:227], a[16:19], v[160:163]
 ds_read_b64_tr_b16 a[252:253], v25 offset:45064
 v_mfma_f32_16x16x32_bf16 v[168:171], a[224:227], a[20:23], v[168:171]
 ds_read_b64_tr_b16 a[254:255], v25 offset:47112
 v_mfma_f32_16x16x32_bf16 v[164:167], a[228:231], a[16:19], v[164:167]
 ds_read_b64_tr_b16 a[224:225], v24 offset:49152
 v_mfma_f32_16x16x32_bf16 v[172:175], a[228:231], a[20:23], v[172:175]
 ds_read_b64_tr_b16 a[226:227], v24 offset:51200
 v_mfma_f32_16x16x32_bf16 v[176:179], a[232:235], a[16:19], v[176:179]
 ds_read_b64_tr_b16 a[228:229], v24 offset:49160
 ds_read_b32 v10, v9
 v_mfma_f32_16x16x32_bf16 v[184:187], a[232:235], a[20:23], v[184:187]
 ds_read_b64_tr_b16 a[230:231], v24 offset:51208
 v_mfma_f32_16x16x32_bf16 v[180:183], a[236:239], a[16:19], v[180:183]
 ds_read_b64_tr_b16 a[232:233], v25 offset:49152
 s_waitcnt lgkmcnt(6)
 v_mfma_f32_16x16x32_bf16 v[188:191], a[236:239], a[20:23], v[188:191]
 ds_read_b64_tr_b16 a[234:235], v25 offset:51200
 v_mfma_f32_16x16x32_bf16 v[160:163], a[240:243], a[24:27], v[160:163]
 ds_read_b64_tr_b16 a[236:237], v25 offset:49160
 v_mfma_f32_16x16x32_bf16 v[168:171], a[240:243], a[28:31], v[168:171]
 ds_read_b64_tr_b16 a[238:239], v25 offset:51208
 v_mfma_f32_16x16x32_bf16 v[164:167], a[244:247], a[24:27], v[164:167]
 ds_read_b64_tr_b16 a[240:241], v24 offset:53248
 v_mfma_f32_16x16x32_bf16 v[172:175], a[244:247], a[28:31], v[172:175]
 ds_read_b64_tr_b16 a[242:243], v24 offset:55296
 s_movk_i32 s70, 24
 v_mfma_f32_16x16x32_bf16 v[176:179], a[248:251], a[24:27], v[176:179]
 ds_read_b64_tr_b16 a[244:245], v24 offset:53256
 v_mfma_f32_16x16x32_bf16 v[184:187], a[248:251], a[28:31], v[184:187]
 ds_read_b64_tr_b16 a[246:247], v24 offset:55304
 v_mfma_f32_16x16x32_bf16 v[180:183], a[252:255], a[24:27], v[180:183]
 ds_read_b64_tr_b16 a[248:249], v25 offset:53248
 s_waitcnt lgkmcnt(5)
 v_mfma_f32_16x16x32_bf16 v[188:191], a[252:255], a[28:31], v[188:191]
 ds_read_b64_tr_b16 a[250:251], v25 offset:55296
 buffer_load_dword off, s[72:75], s70 lds
 v_mfma_f32_16x16x32_bf16 v[192:195], a[224:227], a[16:19], v[192:195]
 ds_read_b64_tr_b16 a[252:253], v25 offset:53256
 v_cmp_le_u32 vcc, 11, v10
 v_mfma_f32_16x16x32_bf16 v[200:203], a[224:227], a[20:23], v[200:203]
 ds_read_b64_tr_b16 a[254:255], v25 offset:55304
 v_mfma_f32_16x16x32_bf16 v[196:199], a[228:231], a[16:19], v[196:199]
 s_cbranch_vccz L_cs56
L_cb56:
 ds_read_b64_tr_b16 a[224:225], v24 offset:57344
 v_mfma_f32_16x16x32_bf16 v[204:207], a[228:231], a[20:23], v[204:207]
 ds_read_b64_tr_b16 a[226:227], v24 offset:59392
 v_mfma_f32_16x16x32_bf16 v[208:211], a[232:235], a[16:19], v[208:211]
 ds_read_b64_tr_b16 a[228:229], v24 offset:57352
 ds_read_b32 v10, v9
 v_mfma_f32_16x16x32_bf16 v[216:219], a[232:235], a[20:23], v[216:219]
 ds_read_b64_tr_b16 a[230:231], v24 offset:59400
 v_mfma_f32_16x16x32_bf16 v[212:215], a[236:239], a[16:19], v[212:215]
 ds_read_b64_tr_b16 a[232:233], v25 offset:57344
 s_waitcnt lgkmcnt(6)
 v_mfma_f32_16x16x32_bf16 v[220:223], a[236:239], a[20:23], v[220:223]
 ds_read_b64_tr_b16 a[234:235], v25 offset:59392
 v_mfma_f32_16x16x32_bf16 v[192:195], a[240:243], a[24:27], v[192:195]
 ds_read_b64_tr_b16 a[236:237], v25 offset:57352
 v_mfma_f32_16x16x32_bf16 v[200:203], a[240:243], a[28:31], v[200:203]
 ds_read_b64_tr_b16 a[238:239], v25 offset:59400
 v_mfma_f32_16x16x32_bf16 v[196:199], a[244:247], a[24:27], v[196:199]
 ds_read_b64_tr_b16 a[240:241], v24 offset:61440
 v_mfma_f32_16x16x32_bf16 v[204:207], a[244:247], a[28:31], v[204:207]
 ds_read_b64_tr_b16 a[242:243], v24 offset:63488
 v_mfma_f32_16x16x32_bf16 v[208:211], a[248:251], a[24:27], v[208:211]
 ds_read_b64_tr_b16 a[244:245], v24 offset:61448
 v_mfma_f32_16x16x32_bf16 v[216:219], a[248:251], a[28:31], v[216:219]
 ds_read_b64_tr_b16 a[246:247], v24 offset:63496
 v_mfma_f32_16x16x32_bf16 v[212:215], a[252:255], a[24:27], v[212:215]
 ds_read_b64_tr_b16 a[248:249], v25 offset:61440
 s_waitcnt lgkmcnt(5)
 v_mfma_f32_16x16x32_bf16 v[220:223], a[252:255], a[28:31], v[220:223]
 ds_read_b64_tr_b16 a[250:251], v25 offset:63488
 v_mfma_f32_16x16x32_bf16 v[224:227], a[224:227], a[16:19], v[224:227]
 ds_read_b64_tr_b16 a[252:253], v25 offset:61448
 v_cmp_le_u32 vcc, 17, v10
 v_mfma_f32_16x16x32_bf16 v[232:235], a[224:227], a[20:23], v[232:235]
 ds_read_b64_tr_b16 a[254:255], v25 offset:63496
 v_mfma_f32_16x16x32_bf16 v[228:231], a[228:231], a[16:19], v[228:231]
 s_cbranch_vccz L_cs64
L_cb64:
 ds_read_b128 a[48:51], v16 offset:36864
 ds_read_b128 a[52:55], v16 offset:38912
 ds_read_b64_tr_b16 a[224:225], v24 offset:0
 v_mfma_f32_16x16x32_bf16 v[236:239], a[228:231], a[20:23], v[236:239]
 ds_read_b64_tr_b16 a[226:227], v24 offset:2048
 v_mfma_f32_16x16x32_bf16 v[240:243], a[232:235], a[16:19], v[240:243]
 ds_read_b128 a[56:59], v17 offset:36864
 ds_read_b128 a[60:63], v17 offset:38912
 ds_read_b64_tr_b16 a[228:229], v24 offset:8
 v_mfma_f32_16x16x32_bf16 v[248:251], a[232:235], a[20:23], v[248:251]
 ds_read_b64_tr_b16 a[230:231], v24 offset:2056
 v_mfma_f32_16x16x32_bf16 v[244:247], a[236:239], a[16:19], v[244:247]
 ds_read_b128 a[64:67], v18 offset:0
 ds_read_b128 a[68:71], v18 offset:2048
 ds_read_b64_tr_b16 a[232:233], v25 offset:0
 v_mfma_f32_16x16x32_bf16 v[252:255], a[236:239], a[20:23], v[252:255]
 ds_read_b64_tr_b16 a[234:235], v25 offset:2048
 s_waitcnt lgkmcnt(12)
 v_mfma_f32_16x16x32_bf16 v[224:227], a[240:243], a[24:27], v[224:227]
 ds_read_b128 a[72:75], v19 offset:0
 ds_read_b128 a[76:79], v19 offset:2048
 ds_read_b64_tr_b16 a[236:237], v25 offset:8
 v_mfma_f32_16x16x32_bf16 v[232:235], a[240:243], a[28:31], v[232:235]
 ds_read_b64_tr_b16 a[238:239], v25 offset:2056
 v_mfma_f32_16x16x32_bf16 v[228:231], a[244:247], a[24:27], v[228:231]
 ds_read_b128 a[80:83], v18 offset:12288
 ds_read_b128 a[84:87], v18 offset:14336
 ds_read_b64_tr_b16 a[240:241], v24 offset:4096
 v_mfma_f32_16x16x32_bf16 v[236:239], a[244:247], a[28:31], v[236:239]
 ds_read_b64_tr_b16 a[242:243], v24 offset:6144
 s_movk_i32 s70, 32
 v_mfma_f32_16x16x32_bf16 v[240:243], a[248:251], a[24:27], v[240:243]
 ds_read_b128 a[88:91], v19 offset:12288
 ds_read_b128 a[92:95], v19 offset:14336
 ds_read_b64_tr_b16 a[244:245], v24 offset:4104
 v_mfma_f32_16x16x32_bf16 v[248:251], a[248:251], a[28:31], v[248:251]
 ds_read_b64_tr_b16 a[246:247], v24 offset:6152
 v_mfma_f32_16x16x32_bf16 v[244:247], a[252:255], a[24:27], v[244:247]
 ds_read_b128 a[96:99], v18 offset:24576
 ds_read_b128 a[100:103], v18 offset:26624
 ds_read_b64_tr_b16 a[248:249], v25 offset:4096
 v_mfma_f32_16x16x32_bf16 v[252:255], a[252:255], a[28:31], v[252:255]
 ds_read_b64_tr_b16 a[250:251], v25 offset:6144
 s_waitcnt lgkmcnt(12)
 buffer_load_dword off, s[72:75], s70 lds
 v_mfma_f32_16x16x32_bf16 v[128:131], a[224:227], a[32:35], v[128:131]
 ds_read_b128 a[104:107], v19 offset:24576
 ds_read_b128 a[108:111], v19 offset:26624
 ds_read_b64_tr_b16 a[252:253], v25 offset:4104
 v_mfma_f32_16x16x32_bf16 v[136:139], a[224:227], a[36:39], v[136:139]
 ds_read_b64_tr_b16 a[254:255], v25 offset:6152
 v_mfma_f32_16x16x32_bf16 v[132:135], a[228:231], a[32:35], v[132:135]
 ds_read_b64_tr_b16 a[224:225], v24 offset:8192
 v_mfma_f32_16x16x32_bf16 v[140:143], a[228:231], a[36:39], v[140:143]
 ds_read_b64_tr_b16 a[226:227], v24 offset:10240
 v_mfma_f32_16x16x32_bf16 v[144:147], a[232:235], a[32:35], v[144:147]
 ds_read_b64_tr_b16 a[228:229], v24 offset:8200
 ds_read_b32 v10, v9
 v_mfma_f32_16x16x32_bf16 v[152:155], a[232:235], a[36:39], v[152:155]
 ds_read_b64_tr_b16 a[230:231], v24 offset:10248
 v_mfma_f32_16x16x32_bf16 v[148:151], a[236:239], a[32:35], v[148:151]
 ds_read_b64_tr_b16 a[232:233], v25 offset:8192
 s_waitcnt lgkmcnt(6)
 v_mfma_f32_16x16x32_bf16 v[156:159], a[236:239], a[36:39], v[156:159]
 ds_read_b64_tr_b16 a[234:235], v25 offset:10240
 v_mfma_f32_16x16x32_bf16 v[128:131], a[240:243], a[40:43], v[128:131]
 ds_read_b64_tr_b16 a[236:237], v25 offset:8200
 v_mfma_f32_16x16x32_bf16 v[136:139], a[240:243], a[44:47], v[136:139]
 ds_read_b64_tr_b16 a[238:239], v25 offset:10248
 v_mfma_f32_16x16x32_bf16 v[132:135], a[244:247], a[40:43], v[132:135]
 ds_read_b64_tr_b16 a[240:241], v24 offset:12288
 v_mfma_f32_16x16x32_bf16 v[140:143], a[244:247], a[44:47], v[140:143]
 ds_read_b64_tr_b16 a[242:243], v24 offset:14336
 v_mfma_f32_16x16x32_bf16 v[144:147], a[248:251], a[40:43], v[144:147]
 ds_read_b64_tr_b16 a[244:245], v24 offset:12296
 v_mfma_f32_16x16x32_bf16 v[152:155], a[248:251], a[44:47], v[152:155]
 ds_read_b64_tr_b16 a[246:247], v24 offset:14344
 v_mfma_f32_16x16x32_bf16 v[148:151], a[252:255], a[40:43], v[148:151]
 ds_read_b64_tr_b16 a[248:249], v25 offset:12288
 s_waitcnt lgkmcnt(5)
 v_mfma_f32_16x16x32_bf16 v[156:159], a[252:255], a[44:47], v[156:159]
 ds_read_b64_tr_b16 a[250:251], v25 offset:14336
 v_mfma_f32_16x16x32_bf16 v[128:131], a[224:227], a[48:51], v[128:131]
 ds_read_b64_tr_b16 a[252:253], v25 offset:12296
 v_cmp_le_u32 vcc, 19, v10
 v_mfma_f32_16x16x32_bf16 v[136:139], a[224:227], a[52:55], v[136:139]
 ds_read_b64_tr_b16 a[254:255], v25 offset:14344
 v_mfma_f32_16x16x32_bf16 v[132:135], a[228:231], a[48:51], v[132:135]
 s_cbranch_vccz L_cs80
L_cb80:
 ds_read_b64_tr_b16 a[224:225], v24 offset:16384
 v_mfma_f32_16x16x32_bf16 v[140:143], a[228:231], a[52:55], v[140:143]
 ds_read_b64_tr_b16 a[226:227], v24 offset:18432
 v_mfma_f32_16x16x32_bf16 v[144:147], a[232:235], a[48:51], v[144:147]
 ds_read_b64_tr_b16 a[228:229], v24 offset:16392
 v_mfma_f32_16x16x32_bf16 v[152:155], a[232:235], a[52:55], v[152:155]
 ds_read_b64_tr_b16 a[230:231], v24 offset:18440
 v_mfma_f32_16x16x32_bf16 v[148:151], a[236:239], a[48:51], v[148:151]
 ds_read_b64_tr_b16 a[232:233], v25 offset:16384
 s_waitcnt lgkmcnt(5)
 v_mfma_f32_16x16x32_bf16 v[156:159], a[236:239], a[52:55], v[156:159]
 ds_read_b64_tr_b16 a[234:235], v25 offset:18432
 v_mfma_f32_16x16x32_bf16 v[128:131], a[240:243], a[56:59], v[128:131]
 ds_read_b64_tr_b16 a[236:237], v25 offset:16392
 v_mfma_f32_16x16x32_bf16 v[136:139], a[240:243], a[60:63], v[136:139]
 ds_read_b64_tr_b16 a[238:239], v25 offset:18440
 v_mfma_f32_16x16x32_bf16 v[132:135], a[244:247], a[56:59], v[132:135]
 ds_read_b64_tr_b16 a[240:241], v24 offset:20480
 v_mfma_f32_16x16x32_bf16 v[140:143], a[244:247], a[60:63], v[140:143]
 ds_read_b64_tr_b16 a[242:243], v24 offset:22528
 s_movk_i32 s70, 40
 v_mfma_f32_16x16x32_bf16 v[144:147], a[248:251], a[56:59], v[144:147]
 ds_read_b64_tr_b16 a[244:245], v24 offset:20488
 v_mfma_f32_16x16x32_bf16 v[152:155], a[248:251], a[60:63], v[152:155]
 ds_read_b64_tr_b16 a[246:247], v24 offset:22536
 v_mfma_f32_16x16x32_bf16 v[148:151], a[252:255], a[56:59], v[148:151]
 ds_read_b64_tr_b16 a[248:249], v25 offset:20480
 s_waitcnt lgkmcnt(5)
 v_mfma_f32_16x16x32_bf16 v[156:159], a[252:255], a[60:63], v[156:159]
 ds_read_b64_tr_b16 a[250:251], v25 offset:22528
 buffer_load_dword off, s[72:75], s70 lds
 v_mfma_f32_16x16x32_bf16 v[128:131], a[224:227], a[64:67], v[128:131]
 ds_read_b64_tr_b16 a[252:253], v25 offset:20488
 v_mfma_f32_16x16x32_bf16 v[136:139], a[224:227], a[68:71], v[136:139]
 ds_read_b64_tr_b16 a[254:255], v25 offset:22536
 v_mfma_f32_16x16x32_bf16 v[132:135], a[228:231], a[64:67], v[132:135]
 ds_read_b64_tr_b16 a[224:225], v24 offset:24576
 v_mfma_f32_16x16x32_bf16 v[140:143], a[228:231], a[68:71], v[140:143]
 ds_read_b64_tr_b16 a[226:227], v24 offset:26624
 v_mfma_f32_16x16x32_bf16 v[144:147], a[232:235], a[64:67], v[144:147]
 ds_read_b64_tr_b16 a[228:229], v24 offset:24584
 ds_read_b32 v10, v9
 v_mfma_f32_16x16x32_bf16 v[152:155], a[232:235], a[68:71], v[152:155]
 ds_read_b64_tr_b16 a[230:231], v24 offset:26632
 v_mfma_f32_16x16x32_bf16 v[148:151], a[236:239], a[64:67], v[148:151]
 ds_read_b64_tr_b16 a[232:233], v25 offset:24576
 s_waitcnt lgkmcnt(6)
 v_mfma_f32_16x16x32_bf16 v[156:159], a[236:239], a[68:71], v[156:159]
 ds_read_b64_tr_b16 a[234:235], v25 offset:26624
 v_mfma_f32_16x16x32_bf16 v[128:131], a[240:243], a[72:75], v[128:131]
 ds_read_b64_tr_b16 a[236:237], v25 offset:24584
 v_mfma_f32_16x16x32_bf16 v[136:139], a[240:243], a[76:79], v[136:139]
 ds_read_b64_tr_b16 a[238:239], v25 offset:26632
 v_mfma_f32_16x16x32_bf16 v[132:135], a[244:247], a[72:75], v[132:135]
 ds_read_b64_tr_b16 a[240:241], v24 offset:28672
 v_mfma_f32_16x16x32_bf16 v[140:143], a[244:247], a[76:79], v[140:143]
 ds_read_b64_tr_b16 a[242:243], v24 offset:30720
 v_mfma_f32_16x16x32_bf16 v[144:147], a[248:251], a[72:75], v[144:147]
 ds_read_b64_tr_b16 a[244:245], v24 offset:28680
 v_mfma_f32_16x16x32_bf16 v[152:155], a[248:251], a[76:79], v[152:155]
 ds_read_b64_tr_b16 a[246:247], v24 offset:30728
 v_mfma_f32_16x16x32_bf16 v[148:151], a[252:255], a[72:75], v[148:151]
 ds_read_b64_tr_b16 a[248:249], v25 offset:28672
 s_waitcnt lgkmcnt(5)
 v_mfma_f32_16x16x32_bf16 v[156:159], a[252:255], a[76:79], v[156:159]
 ds_read_b64_tr_b16 a[250:251], v25 offset:30720
 v_mfma_f32_16x16x32_bf16 v[128:131], a[224:227], a[80:83], v[128:131]
 ds_read_b64_tr_b16 a[252:253], v25 offset:28680
 v_cmp_le_u32 vcc, 21, v10
 v_mfma_f32_16x16x32_bf16 v[136:139], a[224:227], a[84:87], v[136:139]
 ds_read_b64_tr_b16 a[254:255], v25 offset:30728
 v_mfma_f32_16x16x32_bf16 v[132:135], a[228:231], a[80:83], v[132:135]
 s_cbranch_vccz L_cs96
L_cb96:
 ds_read_b64_tr_b16 a[224:225], v24 offset:32768
 v_mfma_f32_16x16x32_bf16 v[140:143], a[228:231], a[84:87], v[140:143]
 ds_read_b64_tr_b16 a[226:227], v24 offset:34816
 v_mfma_f32_16x16x32_bf16 v[144:147], a[232:235], a[80:83], v[144:147]
 ds_read_b64_tr_b16 a[228:229], v24 offset:32776
 v_mfma_f32_16x16x32_bf16 v[152:155], a[232:235], a[84:87], v[152:155]
 ds_read_b64_tr_b16 a[230:231], v24 offset:34824
 v_mfma_f32_16x16x32_bf16 v[148:151], a[236:239], a[80:83], v[148:151]
 ds_read_b64_tr_b16 a[232:233], v25 offset:32768
 s_waitcnt lgkmcnt(5)
 v_mfma_f32_16x16x32_bf16 v[156:159], a[236:239], a[84:87], v[156:159]
 ds_read_b64_tr_b16 a[234:235], v25 offset:34816
 v_mfma_f32_16x16x32_bf16 v[128:131], a[240:243], a[88:91], v[128:131]
 ds_read_b64_tr_b16 a[236:237], v25 offset:32776
 v_mfma_f32_16x16x32_bf16 v[136:139], a[240:243], a[92:95], v[136:139]
 ds_read_b64_tr_b16 a[238:239], v25 offset:34824
 v_mfma_f32_16x16x32_bf16 v[132:135], a[244:247], a[88:91], v[132:135]
 ds_read_b64_tr_b16 a[240:241], v24 offset:36864
 v_mfma_f32_16x16x32_bf16 v[140:143], a[244:247], a[92:95], v[140:143]
 ds_read_b64_tr_b16 a[242:243], v24 offset:38912
 s_movk_i32 s70, 48
 v_mfma_f32_16x16x32_bf16 v[144:147], a[248:251], a[88:91], v[144:147]
 ds_read_b64_tr_b16 a[244:245], v24 offset:36872
 v_mfma_f32_16x16x32_bf16 v[152:155], a[248:251], a[92:95], v[152:155]
 ds_read_b64_tr_b16 a[246:247], v24 offset:38920
 v_mfma_f32_16x16x32_bf16 v[148:151], a[252:255], a[88:91], v[148:151]
 ds_read_b64_tr_b16 a[248:249], v25 offset:36864
 s_waitcnt lgkmcnt(5)
 v_mfma_f32_16x16x32_bf16 v[156:159], a[252:255], a[92:95], v[156:159]
 ds_read_b64_tr_b16 a[250:251], v25 offset:38912
 buffer_load_dword off, s[72:75], s70 lds
 v_mfma_f32_16x16x32_bf16 v[128:131], a[224:227], a[96:99], v[128:131]
 ds_read_b64_tr_b16 a[252:253], v25 offset:36872
 v_mfma_f32_16x16x32_bf16 v[136:139], a[224:227], a[100:103], v[136:139]
 ds_read_b64_tr_b16 a[254:255], v25 offset:38920
 v_mfma_f32_16x16x32_bf16 v[132:135], a[228:231], a[96:99], v[132:135]
 ds_read_b64_tr_b16 a[224:225], v24 offset:40960
 v_mfma_f32_16x16x32_bf16 v[140:143], a[228:231], a[100:103], v[140:143]
 ds_read_b64_tr_b16 a[226:227], v24 offset:43008
 v_mfma_f32_16x16x32_bf16 v[144:147], a[232:235], a[96:99], v[144:147]
 ds_read_b64_tr_b16 a[228:229], v24 offset:40968
 ds_read_b32 v10, v9
 v_mfma_f32_16x16x32_bf16 v[152:155], a[232:235], a[100:103], v[152:155]
 ds_read_b64_tr_b16 a[230:231], v24 offset:43016
 v_mfma_f32_16x16x32_bf16 v[148:151], a[236:239], a[96:99], v[148:151]
 ds_read_b64_tr_b16 a[232:233], v25 offset:40960
 s_waitcnt lgkmcnt(6)
 v_mfma_f32_16x16x32_bf16 v[156:159], a[236:239], a[100:103], v[156:159]
 ds_read_b64_tr_b16 a[234:235], v25 offset:43008
 v_mfma_f32_16x16x32_bf16 v[128:131], a[240:243], a[104:107], v[128:131]
 ds_read_b64_tr_b16 a[236:237], v25 offset:40968
 s_lshl_b32 s55, s5, 3
 s_waitcnt vmcnt(6)
 v_mov_b32 v2, 1
 v_add_u32 v13, s55, v1
 buffer_store_dword v2, v13, s[88:91], 0 offen sc1
 v_mfma_f32_16x16x32_bf16 v[136:139], a[240:243], a[108:111], v[136:139]
 ds_read_b64_tr_b16 a[238:239], v25 offset:43016
 v_mfma_f32_16x16x32_bf16 v[132:135], a[244:247], a[104:107], v[132:135]
 ds_read_b64_tr_b16 a[240:241], v24 offset:45056
 v_mfma_f32_16x16x32_bf16 v[140:143], a[244:247], a[108:111], v[140:143]
 ds_read_b64_tr_b16 a[242:243], v24 offset:47104
 v_mfma_f32_16x16x32_bf16 v[144:147], a[248:251], a[104:107], v[144:147]
 ds_read_b64_tr_b16 a[244:245], v24 offset:45064
 v_mfma_f32_16x16x32_bf16 v[152:155], a[248:251], a[108:111], v[152:155]
 ds_read_b64_tr_b16 a[246:247], v24 offset:47112
 v_add_u32 v24, 0x10000, v24
 v_mfma_f32_16x16x32_bf16 v[148:151], a[252:255], a[104:107], v[148:151]
 ds_read_b64_tr_b16 a[248:249], v25 offset:45056
 s_waitcnt lgkmcnt(5)
 v_mfma_f32_16x16x32_bf16 v[156:159], a[252:255], a[108:111], v[156:159]
 ds_read_b64_tr_b16 a[250:251], v25 offset:47104
 v_mfma_f32_16x16x32_bf16 v[160:163], a[224:227], a[32:35], v[160:163]
 ds_read_b64_tr_b16 a[252:253], v25 offset:45064
 v_cmp_le_u32 vcc, 23, v10
 v_mfma_f32_16x16x32_bf16 v[168:171], a[224:227], a[36:39], v[168:171]
 ds_read_b64_tr_b16 a[254:255], v25 offset:47112
 v_add_u32 v25, 0x10000, v25
 v_mfma_f32_16x16x32_bf16 v[164:167], a[228:231], a[32:35], v[164:167]
 s_cbranch_vccz L_cs112
L_cb112:
 ds_read_b64_tr_b16 a[224:225], v24 offset:0
 v_mfma_f32_16x16x32_bf16 v[172:175], a[228:231], a[36:39], v[172:175]
 ds_read_b64_tr_b16 a[226:227], v24 offset:2048
 v_mul_f32 v128, s32, v128
 v_mfma_f32_16x16x32_bf16 v[176:179], a[232:235], a[32:35], v[176:179]
 ds_read_b64_tr_b16 a[228:229], v24 offset:8
 v_mul_f32 v129, s32, v129
 v_mfma_f32_16x16x32_bf16 v[184:187], a[232:235], a[36:39], v[184:187]
 ds_read_b64_tr_b16 a[230:231], v24 offset:2056
 v_cvt_pk_bf16_f32 v64, v128, v129
 v_mfma_f32_16x16x32_bf16 v[180:183], a[236:239], a[32:35], v[180:183]
 ds_read_b64_tr_b16 a[232:233], v25 offset:0
 s_waitcnt lgkmcnt(5)
 v_mfma_f32_16x16x32_bf16 v[188:191], a[236:239], a[36:39], v[188:191]
 ds_read_b64_tr_b16 a[234:235], v25 offset:2048
 v_mul_f32 v130, s32, v130
 v_mfma_f32_16x16x32_bf16 v[160:163], a[240:243], a[40:43], v[160:163]
 ds_read_b64_tr_b16 a[236:237], v25 offset:8
 v_mul_f32 v131, s32, v131
 v_mfma_f32_16x16x32_bf16 v[168:171], a[240:243], a[44:47], v[168:171]
 ds_read_b64_tr_b16 a[238:239], v25 offset:2056
 v_cvt_pk_bf16_f32 v65, v130, v131
 v_mfma_f32_16x16x32_bf16 v[164:167], a[244:247], a[40:43], v[164:167]
 ds_read_b64_tr_b16 a[240:241], v24 offset:4096
 v_mul_f32 v132, s32, v132
 v_mfma_f32_16x16x32_bf16 v[172:175], a[244:247], a[44:47], v[172:175]
 ds_read_b64_tr_b16 a[242:243], v24 offset:6144
 s_movk_i32 s70, 56
 v_mfma_f32_16x16x32_bf16 v[176:179], a[248:251], a[40:43], v[176:179]
 ds_read_b64_tr_b16 a[244:245], v24 offset:4104
 v_mul_f32 v133, s32, v133
 v_mfma_f32_16x16x32_bf16 v[184:187], a[248:251], a[44:47], v[184:187]
 ds_read_b64_tr_b16 a[246:247], v24 offset:6152
 v_cvt_pk_bf16_f32 v66, v132, v133
 v_mfma_f32_16x16x32_bf16 v[180:183], a[252:255], a[40:43], v[180:183]
 ds_read_b64_tr_b16 a[248:249], v25 offset:4096
 s_waitcnt lgkmcnt(5)
 v_mfma_f32_16x16x32_bf16 v[188:191], a[252:255], a[44:47], v[188:191]
 ds_read_b64_tr_b16 a[250:251], v25 offset:6144
 v_mul_f32 v134, s32, v134
 v_mfma_f32_16x16x32_bf16 v[160:163], a[224:227], a[48:51], v[160:163]
 ds_read_b64_tr_b16 a[252:253], v25 offset:4104
 buffer_load_dword off, s[72:75], s70 lds
 v_mul_f32 v135, s32, v135
 v_mfma_f32_16x16x32_bf16 v[168:171], a[224:227], a[52:55], v[168:171]
 ds_read_b64_tr_b16 a[254:255], v25 offset:6152
 v_cvt_pk_bf16_f32 v67, v134, v135
 v_mfma_f32_16x16x32_bf16 v[164:167], a[228:231], a[48:51], v[164:167]
 ds_read_b64_tr_b16 a[224:225], v24 offset:8192
 v_mul_f32 v136, s32, v136
 v_mfma_f32_16x16x32_bf16 v[172:175], a[228:231], a[52:55], v[172:175]
 ds_read_b64_tr_b16 a[226:227], v24 offset:10240
 v_mul_f32 v137, s32, v137
 v_mfma_f32_16x16x32_bf16 v[176:179], a[232:235], a[48:51], v[176:179]
 ds_read_b64_tr_b16 a[228:229], v24 offset:8200
 ds_read_b32 v10, v9
 v_mfma_f32_16x16x32_bf16 v[184:187], a[232:235], a[52:55], v[184:187]
 ds_read_b64_tr_b16 a[230:231], v24 offset:10248
 v_cvt_pk_bf16_f32 v68, v136, v137
 v_mfma_f32_16x16x32_bf16 v[180:183], a[236:239], a[48:51], v[180:183]
 ds_read_b64_tr_b16 a[232:233], v25 offset:8192
 s_waitcnt lgkmcnt(6)
 v_mfma_f32_16x16x32_bf16 v[188:191], a[236:239], a[52:55], v[188:191]
 ds_read_b64_tr_b16 a[234:235], v25 offset:10240
 v_mul_f32 v138, s32, v138
 v_mfma_f32_16x16x32_bf16 v[160:163], a[240:243], a[56:59], v[160:163]
 ds_read_b64_tr_b16 a[236:237], v25 offset:8200
 v_mul_f32 v139, s32, v139
 v_mfma_f32_16x16x32_bf16 v[168:171], a[240:243], a[60:63], v[168:171]
 ds_read_b64_tr_b16 a[238:239], v25 offset:10248
 v_cvt_pk_bf16_f32 v69, v138, v139
 v_mfma_f32_16x16x32_bf16 v[164:167], a[244:247], a[56:59], v[164:167]
 ds_read_b64_tr_b16 a[240:241], v24 offset:12288
 v_mul_f32 v140, s32, v140
 v_mfma_f32_16x16x32_bf16 v[172:175], a[244:247], a[60:63], v[172:175]
 ds_read_b64_tr_b16 a[242:243], v24 offset:14336
 v_mul_f32 v141, s32, v141
 v_mfma_f32_16x16x32_bf16 v[176:179], a[248:251], a[56:59], v[176:179]
 ds_read_b64_tr_b16 a[244:245], v24 offset:12296
 v_cvt_pk_bf16_f32 v70, v140, v141
 v_mfma_f32_16x16x32_bf16 v[184:187], a[248:251], a[60:63], v[184:187]
 ds_read_b64_tr_b16 a[246:247], v24 offset:14344
 v_mul_f32 v142, s32, v142
 v_mfma_f32_16x16x32_bf16 v[180:183], a[252:255], a[56:59], v[180:183]
 ds_read_b64_tr_b16 a[248:249], v25 offset:12288
 s_waitcnt lgkmcnt(5)
 v_mfma_f32_16x16x32_bf16 v[188:191], a[252:255], a[60:63], v[188:191]
 ds_read_b64_tr_b16 a[250:251], v25 offset:14336
 v_mul_f32 v143, s32, v143
 v_mfma_f32_16x16x32_bf16 v[160:163], a[224:227], a[64:67], v[160:163]
 ds_read_b64_tr_b16 a[252:253], v25 offset:12296
 v_cmp_le_u32 vcc, 25, v10
 v_mfma_f32_16x16x32_bf16 v[168:171], a[224:227], a[68:71], v[168:171]
 ds_read_b64_tr_b16 a[254:255], v25 offset:14344
 v_cvt_pk_bf16_f32 v71, v142, v143
 v_mfma_f32_16x16x32_bf16 v[164:167], a[228:231], a[64:67], v[164:167]
 s_cbranch_vccz L_cs128
L_cb128:
 ds_read_b64_tr_b16 a[224:225], v24 offset:16384
 v_mfma_f32_16x16x32_bf16 v[172:175], a[228:231], a[68:71], v[172:175]
 ds_read_b64_tr_b16 a[226:227], v24 offset:18432
 v_mul_f32 v144, s32, v144
 v_mfma_f32_16x16x32_bf16 v[176:179], a[232:235], a[64:67], v[176:179]
 ds_read_b64_tr_b16 a[228:229], v24 offset:16392
 v_mul_f32 v145, s32, v145
 v_mfma_f32_16x16x32_bf16 v[184:187], a[232:235], a[68:71], v[184:187]
 ds_read_b64_tr_b16 a[230:231], v24 offset:18440
 v_cvt_pk_bf16_f32 v72, v144, v145
 v_mfma_f32_16x16x32_bf16 v[180:183], a[236:239], a[64:67], v[180:183]
 ds_read_b64_tr_b16 a[232:233], v25 offset:16384
 s_waitcnt lgkmcnt(5)
 v_mfma_f32_16x16x32_bf16 v[188:191], a[236:239], a[68:71], v[188:191]
 ds_read_b64_tr_b16 a[234:235], v25 offset:18432
 v_mul_f32 v146, s32, v146
 v_mfma_f32_16x16x32_bf16 v[160:163], a[240:243], a[72:75], v[160:163]
 ds_read_b64_tr_b16 a[236:237], v25 offset:16392
 v_mul_f32 v147, s32, v147
 v_mfma_f32_16x16x32_bf16 v[168:171], a[240:243], a[76:79], v[168:171]
 ds_read_b64_tr_b16 a[238:239], v25 offset:18440
 v_cvt_pk_bf16_f32 v73, v146, v147
 v_mfma_f32_16x16x32_bf16 v[164:167], a[244:247], a[72:75], v[164:167]
 ds_read_b64_tr_b16 a[240:241], v24 offset:20480
 v_mul_f32 v148, s32, v148
 v_mfma_f32_16x16x32_bf16 v[172:175], a[244:247], a[76:79], v[172:175]
 ds_read_b64_tr_b16 a[242:243], v24 offset:22528
 s_movk_i32 s70, 64
 v_mfma_f32_16x16x32_bf16 v[176:179], a[248:251], a[72:75], v[176:179]
 ds_read_b64_tr_b16 a[244:245], v24 offset:20488
 v_mul_f32 v149, s32, v149
 v_mfma_f32_16x16x32_bf16 v[184:187], a[248:251], a[76:79], v[184:187]
 ds_read_b64_tr_b16 a[246:247], v24 offset:22536
 v_cvt_pk_bf16_f32 v74, v148, v149
 v_mfma_f32_16x16x32_bf16 v[180:183], a[252:255], a[72:75], v[180:183]
 ds_read_b64_tr_b16 a[248:249], v25 offset:20480
 s_waitcnt lgkmcnt(5)
 v_mfma_f32_16x16x32_bf16 v[188:191], a[252:255], a[76:79], v[188:191]
 ds_read_b64_tr_b16 a[250:251], v25 offset:22528
 v_mul_f32 v150, s32, v150
 v_mfma_f32_16x16x32_bf16 v[160:163], a[224:227], a[80:83], v[160:163]
 ds_read_b64_tr_b16 a[252:253], v25 offset:20488
 buffer_load_dword off, s[72:75], s70 lds
 v_mul_f32 v151, s32, v151
 v_mfma_f32_16x16x32_bf16 v[168:171], a[224:227], a[84:87], v[168:171]
 ds_read_b64_tr_b16 a[254:255], v25 offset:22536
 v_cvt_pk_bf16_f32 v75, v150, v151
 v_mfma_f32_16x16x32_bf16 v[164:167], a[228:231], a[80:83], v[164:167]
 ds_read_b64_tr_b16 a[224:225], v24 offset:24576
 v_mul_f32 v152, s32, v152
 v_mfma_f32_16x16x32_bf16 v[172:175], a[228:231], a[84:87], v[172:175]
 ds_read_b64_tr_b16 a[226:227], v24 offset:26624
 v_mul_f32 v153, s32, v153
 v_mfma_f32_16x16x32_bf16 v[176:179], a[232:235], a[80:83], v[176:179]
 ds_read_b64_tr_b16 a[228:229], v24 offset:24584
 ds_read_b32 v10, v9
 v_mfma_f32_16x16x32_bf16 v[184:187], a[232:235], a[84:87], v[184:187]
 ds_read_b64_tr_b16 a[230:231], v24 offset:26632
 v_cvt_pk_bf16_f32 v76, v152, v153
 v_mfma_f32_16x16x32_bf16 v[180:183], a[236:239], a[80:83], v[180:183]
 ds_read_b64_tr_b16 a[232:233], v25 offset:24576
 s_waitcnt lgkmcnt(6)
 v_mfma_f32_16x16x32_bf16 v[188:191], a[236:239], a[84:87], v[188:191]
 ds_read_b64_tr_b16 a[234:235], v25 offset:26624
 v_mul_f32 v154, s32, v154
 v_mfma_f32_16x16x32_bf16 v[160:163], a[240:243], a[88:91], v[160:163]
 ds_read_b64_tr_b16 a[236:237], v25 offset:24584
 v_mul_f32 v155, s32, v155
 v_mfma_f32_16x16x32_bf16 v[168:171], a[240:243], a[92:95], v[168:171]
 ds_read_b64_tr_b16 a[238:239], v25 offset:26632
 v_cvt_pk_bf16_f32 v77, v154, v155
 v_mfma_f32_16x16x32_bf16 v[164:167], a[244:247], a[88:91], v[164:167]
 ds_read_b64_tr_b16 a[240:241], v24 offset:28672
 v_mul_f32 v156, s32, v156
 v_mfma_f32_16x16x32_bf16 v[172:175], a[244:247], a[92:95], v[172:175]
 ds_read_b64_tr_b16 a[242:243], v24 offset:30720
 v_mul_f32 v157, s32, v157
 v_mfma_f32_16x16x32_bf16 v[176:179], a[248:251], a[88:91], v[176:179]
 ds_read_b64_tr_b16 a[244:245], v24 offset:28680
 v_cvt_pk_bf16_f32 v78, v156, v157
 v_mfma_f32_16x16x32_bf16 v[184:187], a[248:251], a[92:95], v[184:187]
 ds_read_b64_tr_b16 a[246:247], v24 offset:30728
 v_add_u32 v24, 0xffff0000, v24
 v_mfma_f32_16x16x32_bf16 v[180:183], a[252:255], a[88:91], v[180:183]
 ds_read_b64_tr_b16 a[248:249], v25 offset:28672
 s_waitcnt lgkmcnt(5)
 v_mfma_f32_16x16x32_bf16 v[188:191], a[252:255], a[92:95], v[188:191]
 ds_read_b64_tr_b16 a[250:251], v25 offset:30720
 v_mul_f32 v158, s32, v158
 v_mfma_f32_16x16x32_bf16 v[160:163], a[224:227], a[96:99], v[160:163]
 ds_read_b64_tr_b16 a[252:253], v25 offset:28680
 v_cmp_le_u32 vcc, 27, v10
 v_mfma_f32_16x16x32_bf16 v[168:171], a[224:227], a[100:103], v[168:171]
 ds_read_b64_tr_b16 a[254:255], v25 offset:30728
 v_add_u32 v25, 0xffff0000, v25
 v_mfma_f32_16x16x32_bf16 v[164:167], a[228:231], a[96:99], v[164:167]
 s_cbranch_vccz L_cs144
L_cb144:
 ds_read_b64_tr_b16 a[224:225], v24 offset:49152
 v_mfma_f32_16x16x32_bf16 v[172:175], a[228:231], a[100:103], v[172:175]
 ds_read_b64_tr_b16 a[226:227], v24 offset:51200
 v_mul_f32 v159, s32, v159
 v_mfma_f32_16x16x32_bf16 v[176:179], a[232:235], a[96:99], v[176:179]
 ds_read_b64_tr_b16 a[228:229], v24 offset:49160
 v_cvt_pk_bf16_f32 v79, v158, v159
 v_mfma_f32_16x16x32_bf16 v[184:187], a[232:235], a[100:103], v[184:187]
 ds_read_b64_tr_b16 a[230:231], v24 offset:51208
 v_mfma_f32_16x16x32_bf16 v[180:183], a[236:239], a[96:99], v[180:183]
 ds_read_b64_tr_b16 a[232:233], v25 offset:49152
 s_waitcnt lgkmcnt(5)
 v_mfma_f32_16x16x32_bf16 v[188:191], a[236:239], a[100:103], v[188:191]
 ds_read_b64_tr_b16 a[234:235], v25 offset:51200
 v_mfma_f32_16x16x32_bf16 v[160:163], a[240:243], a[104:107], v[160:163]
 ds_read_b64_tr_b16 a[236:237], v25 offset:49160
 v_mfma_f32_16x16x32_bf16 v[168:171], a[240:243], a[108:111], v[168:171]
 ds_read_b64_tr_b16 a[238:239], v25 offset:51208
 v_mfma_f32_16x16x32_bf16 v[164:167], a[244:247], a[104:107], v[164:167]
 ds_read_b64_tr_b16 a[240:241], v24 offset:53248
 v_mfma_f32_16x16x32_bf16 v[172:175], a[244:247], a[108:111], v[172:175]
 ds_read_b64_tr_b16 a[242:243], v24 offset:55296
 s_movk_i32 s70, 72
 v_mfma_f32_16x16x32_bf16 v[176:179], a[248:251], a[104:107], v[176:179]
 ds_read_b64_tr_b16 a[244:245], v24 offset:53256
 v_mfma_f32_16x16x32_bf16 v[184:187], a[248:251], a[108:111], v[184:187]
 ds_read_b64_tr_b16 a[246:247], v24 offset:55304
 v_mfma_f32_16x16x32_bf16 v[180:183], a[252:255], a[104:107], v[180:183]
 ds_read_b64_tr_b16 a[248:249], v25 offset:53248
 s_waitcnt lgkmcnt(5)
 v_mfma_f32_16x16x32_bf16 v[188:191], a[252:255], a[108:111], v[188:191]
 ds_read_b64_tr_b16 a[250:251], v25 offset:55296
 buffer_load_dword off, s[72:75], s70 lds
 v_mfma_f32_16x16x32_bf16 v[192:195], a[224:227], a[32:35], v[192:195]
 ds_read_b64_tr_b16 a[252:253], v25 offset:53256
 v_mfma_f32_16x16x32_bf16 v[200:203], a[224:227], a[36:39], v[200:203]
 ds_read_b64_tr_b16 a[254:255], v25 offset:55304
 v_mfma_f32_16x16x32_bf16 v[196:199], a[228:231], a[32:35], v[196:199]
 ds_read_b64_tr_b16 a[224:225], v24 offset:57344
 v_mul_f32 v160, s32, v160
 v_mfma_f32_16x16x32_bf16 v[204:207], a[228:231], a[36:39], v[204:207]
 ds_read_b64_tr_b16 a[226:227], v24 offset:59392
 v_mul_f32 v161, s32, v161
 v_mfma_f32_16x16x32_bf16 v[208:211], a[232:235], a[32:35], v[208:211]
 ds_read_b64_tr_b16 a[228:229], v24 offset:57352
 ds_read_b32 v10, v9
 v_mfma_f32_16x16x32_bf16 v[216:219], a[232:235], a[36:39], v[216:219]
 ds_read_b64_tr_b16 a[230:231], v24 offset:59400
 v_cvt_pk_bf16_f32 v80, v160, v161
 v_mfma_f32_16x16x32_bf16 v[212:215], a[236:239], a[32:35], v[212:215]
 ds_read_b64_tr_b16 a[232:233], v25 offset:57344
 s_waitcnt lgkmcnt(6)
 v_mfma_f32_16x16x32_bf16 v[220:223], a[236:239], a[36:39], v[220:223]
 ds_read_b64_tr_b16 a[234:235], v25 offset:59392
 v_mul_f32 v162, s32, v162
 v_mfma_f32_16x16x32_bf16 v[192:195], a[240:243], a[40:43], v[192:195]
 ds_read_b64_tr_b16 a[236:237], v25 offset:57352
 v_mul_f32 v163, s32, v163
 v_mfma_f32_16x16x32_bf16 v[200:203], a[240:243], a[44:47], v[200:203]
 ds_read_b64_tr_b16 a[238:239], v25 offset:59400
 v_cvt_pk_bf16_f32 v81, v162, v163
 v_mfma_f32_16x16x32_bf16 v[196:199], a[244:247], a[40:43], v[196:199]
 ds_read_b64_tr_b16 a[240:241], v24 offset:61440
 v_mul_f32 v164, s32, v164
 v_mfma_f32_16x16x32_bf16 v[204:207], a[244:247], a[44:47], v[204:207]
 ds_read_b64_tr_b16 a[242:243], v24 offset:63488
 v_mul_f32 v165, s32, v165
 v_mfma_f32_16x16x32_bf16 v[208:211], a[248:251], a[40:43], v[208:211]
 ds_read_b64_tr_b16 a[244:245], v24 offset:61448
 v_cvt_pk_bf16_f32 v82, v164, v165
 v_mfma_f32_16x16x32_bf16 v[216:219], a[248:251], a[44:47], v[216:219]
 ds_read_b64_tr_b16 a[246:247], v24 offset:63496
 v_add_u32 v24, 0x10000, v24
 v_mfma_f32_16x16x32_bf16 v[212:215], a[252:255], a[40:43], v[212:215]
 ds_read_b64_tr_b16 a[248:249], v25 offset:61440
 s_waitcnt lgkmcnt(5)
 v_mfma_f32_16x16x32_bf16 v[220:223], a[252:255], a[44:47], v[220:223]
 ds_read_b64_tr_b16 a[250:251], v25 offset:63488
 v_mul_f32 v166, s32, v166
 v_mfma_f32_16x16x32_bf16 v[192:195], a[224:227], a[48:51], v[192:195]
 ds_read_b64_tr_b16 a[252:253], v25 offset:61448
 v_cmp_le_u32 vcc, 29, v10
 v_mfma_f32_16x16x32_bf16 v[200:203], a[224:227], a[52:55], v[200:203]
 ds_read_b64_tr_b16 a[254:255], v25 offset:63496
 v_add_u32 v25, 0x10000, v25
 v_mfma_f32_16x16x32_bf16 v[196:199], a[228:231], a[48:51], v[196:199]
 s_cbranch_vccz L_cs160
L_cb160:
 ds_read_b64_tr_b16 a[224:225], v24 offset:32768
 v_mfma_f32_16x16x32_bf16 v[204:207], a[228:231], a[52:55], v[204:207]
 ds_read_b64_tr_b16 a[226:227], v24 offset:34816
 v_mul_f32 v167, s32, v167
 v_mfma_f32_16x16x32_bf16 v[208:211], a[232:235], a[48:51], v[208:211]
 ds_read_b64_tr_b16 a[228:229], v24 offset:32776
 v_cvt_pk_bf16_f32 v83, v166, v167
 v_mfma_f32_16x16x32_bf16 v[216:219], a[232:235], a[52:55], v[216:219]
 ds_read_b64_tr_b16 a[230:231], v24 offset:34824
 v_mul_f32 v168, s32, v168
 v_mfma_f32_16x16x32_bf16 v[212:215], a[236:239], a[48:51], v[212:215]
 ds_read_b64_tr_b16 a[232:233], v25 offset:32768
 s_waitcnt lgkmcnt(5)
 v_mfma_f32_16x16x32_bf16 v[220:223], a[236:239], a[52:55], v[220:223]
 ds_read_b64_tr_b16 a[234:235], v25 offset:34816
 v_mul_f32 v169, s32, v169
 v_mfma_f32_16x16x32_bf16 v[192:195], a[240:243], a[56:59], v[192:195]
 ds_read_b64_tr_b16 a[236:237], v25 offset:32776
 v_cvt_pk_bf16_f32 v84, v168, v169
 v_mfma_f32_16x16x32_bf16 v[200:203], a[240:243], a[60:63], v[200:203]
 ds_read_b64_tr_b16 a[238:239], v25 offset:34824
 v_mul_f32 v170, s32, v170
 v_mfma_f32_16x16x32_bf16 v[196:199], a[244:247], a[56:59], v[196:199]
 ds_read_b64_tr_b16 a[240:241], v24 offset:36864
 v_mul_f32 v171, s32, v171
 v_mfma_f32_16x16x32_bf16 v[204:207], a[244:247], a[60:63], v[204:207]
 ds_read_b64_tr_b16 a[242:243], v24 offset:38912
 s_movk_i32 s70, 80
 v_mfma_f32_16x16x32_bf16 v[208:211], a[248:251], a[56:59], v[208:211]
 ds_read_b64_tr_b16 a[244:245], v24 offset:36872
 v_cvt_pk_bf16_f32 v85, v170, v171
 v_mfma_f32_16x16x32_bf16 v[216:219], a[248:251], a[60:63], v[216:219]
 ds_read_b64_tr_b16 a[246:247], v24 offset:38920
 v_mul_f32 v172, s32, v172
 v_mfma_f32_16x16x32_bf16 v[212:215], a[252:255], a[56:59], v[212:215]
 ds_read_b64_tr_b16 a[248:249], v25 offset:36864
 s_waitcnt lgkmcnt(5)
 v_mfma_f32_16x16x32_bf16 v[220:223], a[252:255], a[60:63], v[220:223]
 ds_read_b64_tr_b16 a[250:251], v25 offset:38912
 v_mul_f32 v173, s32, v173
 v_mfma_f32_16x16x32_bf16 v[192:195], a[224:227], a[64:67], v[192:195]
 ds_read_b64_tr_b16 a[252:253], v25 offset:36872
 buffer_load_dword off, s[72:75], s70 lds
 v_cvt_pk_bf16_f32 v86, v172, v173
 v_mfma_f32_16x16x32_bf16 v[200:203], a[224:227], a[68:71], v[200:203]
 ds_read_b64_tr_b16 a[254:255], v25 offset:38920
 v_mul_f32 v174, s32, v174
 v_mfma_f32_16x16x32_bf16 v[196:199], a[228:231], a[64:67], v[196:199]
 ds_read_b64_tr_b16 a[224:225], v24 offset:40960
 v_mul_f32 v175, s32, v175
 v_mfma_f32_16x16x32_bf16 v[204:207], a[228:231], a[68:71], v[204:207]
 ds_read_b64_tr_b16 a[226:227], v24 offset:43008
 v_cvt_pk_bf16_f32 v87, v174, v175
 v_mfma_f32_16x16x32_bf16 v[208:211], a[232:235], a[64:67], v[208:211]
 ds_read_b64_tr_b16 a[228:229], v24 offset:40968
 ds_read_b32 v10, v9
 v_mfma_f32_16x16x32_bf16 v[216:219], a[232:235], a[68:71], v[216:219]
 ds_read_b64_tr_b16 a[230:231], v24 offset:43016
 v_mul_f32 v176, s32, v176
 v_mfma_f32_16x16x32_bf16 v[212:215], a[236:239], a[64:67], v[212:215]
 ds_read_b64_tr_b16 a[232:233], v25 offset:40960
 s_waitcnt lgkmcnt(6)
 v_mfma_f32_16x16x32_bf16 v[220:223], a[236:239], a[68:71], v[220:223]
 ds_read_b64_tr_b16 a[234:235], v25 offset:43008
 v_mul_f32 v177, s32, v177
 v_mfma_f32_16x16x32_bf16 v[192:195], a[240:243], a[72:75], v[192:195]
 ds_read_b64_tr_b16 a[236:237], v25 offset:40968
 v_cvt_pk_bf16_f32 v88, v176, v177
 v_mfma_f32_16x16x32_bf16 v[200:203], a[240:243], a[76:79], v[200:203]
 ds_read_b64_tr_b16 a[238:239], v25 offset:43016
 v_mul_f32 v178, s32, v178
 v_mfma_f32_16x16x32_bf16 v[196:199], a[244:247], a[72:75], v[196:199]
 ds_read_b64_tr_b16 a[240:241], v24 offset:45056
 v_mul_f32 v179, s32, v179
 v_mfma_f32_16x16x32_bf16 v[204:207], a[244:247], a[76:79], v[204:207]
 ds_read_b64_tr_b16 a[242:243], v24 offset:47104
 v_cvt_pk_bf16_f32 v89, v178, v179
 v_mfma_f32_16x16x32_bf16 v[208:211], a[248:251], a[72:75], v[208:211]
 ds_read_b64_tr_b16 a[244:245], v24 offset:45064
 v_mul_f32 v180, s32, v180
 v_mfma_f32_16x16x32_bf16 v[216:219], a[248:251], a[76:79], v[216:219]
 ds_read_b64_tr_b16 a[246:247], v24 offset:47112
 v_mul_f32 v181, s32, v181
 v_mfma_f32_16x16x32_bf16 v[212:215], a[252:255], a[72:75], v[212:215]
 ds_read_b64_tr_b16 a[248:249], v25 offset:45056
 s_waitcnt lgkmcnt(5)
 v_mfma_f32_16x16x32_bf16 v[220:223], a[252:255], a[76:79], v[220:223]
 ds_read_b64_tr_b16 a[250:251], v25 offset:47104
 v_cvt_pk_bf16_f32 v90, v180, v181
 v_mfma_f32_16x16x32_bf16 v[192:195], a[224:227], a[80:83], v[192:195]
 ds_read_b64_tr_b16 a[252:253], v25 offset:45064
 v_cmp_le_u32 vcc, 31, v10
 v_mfma_f32_16x16x32_bf16 v[200:203], a[224:227], a[84:87], v[200:203]
 ds_read_b64_tr_b16 a[254:255], v25 offset:47112
 v_mul_f32 v182, s32, v182
 v_mfma_f32_16x16x32_bf16 v[196:199], a[228:231], a[80:83], v[196:199]
 s_cbranch_vccz L_cs176
L_cb176:
 ds_read_b64_tr_b16 a[224:225], v24 offset:49152
 v_mfma_f32_16x16x32_bf16 v[204:207], a[228:231], a[84:87], v[204:207]
 ds_read_b64_tr_b16 a[226:227], v24 offset:51200
 v_mul_f32 v183, s32, v183
 v_mfma_f32_16x16x32_bf16 v[208:211], a[232:235], a[80:83], v[208:211]
 ds_read_b64_tr_b16 a[228:229], v24 offset:49160
 v_cvt_pk_bf16_f32 v91, v182, v183
 v_mfma_f32_16x16x32_bf16 v[216:219], a[232:235], a[84:87], v[216:219]
 ds_read_b64_tr_b16 a[230:231], v24 offset:51208
 v_mul_f32 v184, s32, v184
 v_mfma_f32_16x16x32_bf16 v[212:215], a[236:239], a[80:83], v[212:215]
 ds_read_b64_tr_b16 a[232:233], v25 offset:49152
 s_waitcnt lgkmcnt(5)
 v_mfma_f32_16x16x32_bf16 v[220:223], a[236:239], a[84:87], v[220:223]
 ds_read_b64_tr_b16 a[234:235], v25 offset:51200
 v_mul_f32 v185, s32, v185
 v_mfma_f32_16x16x32_bf16 v[192:195], a[240:243], a[88:91], v[192:195]
 ds_read_b64_tr_b16 a[236:237], v25 offset:49160
 v_cvt_pk_bf16_f32 v92, v184, v185
 v_mfma_f32_16x16x32_bf16 v[200:203], a[240:243], a[92:95], v[200:203]
 ds_read_b64_tr_b16 a[238:239], v25 offset:51208
 v_mul_f32 v186, s32, v186
 v_mfma_f32_16x16x32_bf16 v[196:199], a[244:247], a[88:91], v[196:199]
 ds_read_b64_tr_b16 a[240:241], v24 offset:53248
 v_mul_f32 v187, s32, v187
 v_mfma_f32_16x16x32_bf16 v[204:207], a[244:247], a[92:95], v[204:207]
 ds_read_b64_tr_b16 a[242:243], v24 offset:55296
 s_movk_i32 s70, 88
 v_mfma_f32_16x16x32_bf16 v[208:211], a[248:251], a[88:91], v[208:211]
 ds_read_b64_tr_b16 a[244:245], v24 offset:53256
 v_cvt_pk_bf16_f32 v93, v186, v187
 v_mfma_f32_16x16x32_bf16 v[216:219], a[248:251], a[92:95], v[216:219]
 ds_read_b64_tr_b16 a[246:247], v24 offset:55304
 v_mul_f32 v188, s32, v188
 v_mfma_f32_16x16x32_bf16 v[212:215], a[252:255], a[88:91], v[212:215]
 ds_read_b64_tr_b16 a[248:249], v25 offset:53248
 s_waitcnt lgkmcnt(5)
 v_mfma_f32_16x16x32_bf16 v[220:223], a[252:255], a[92:95], v[220:223]
 ds_read_b64_tr_b16 a[250:251], v25 offset:55296
 v_mul_f32 v189, s32, v189
 v_mfma_f32_16x16x32_bf16 v[192:195], a[224:227], a[96:99], v[192:195]
 ds_read_b64_tr_b16 a[252:253], v25 offset:53256
 buffer_load_dword off, s[72:75], s70 lds
 v_cvt_pk_bf16_f32 v94, v188, v189
 v_mfma_f32_16x16x32_bf16 v[200:203], a[224:227], a[100:103], v[200:203]
 ds_read_b64_tr_b16 a[254:255], v25 offset:55304
 v_mul_f32 v190, s32, v190
 v_mfma_f32_16x16x32_bf16 v[196:199], a[228:231], a[96:99], v[196:199]
 ds_read_b64_tr_b16 a[224:225], v24 offset:57344
 v_mul_f32 v191, s32, v191
 v_mfma_f32_16x16x32_bf16 v[204:207], a[228:231], a[100:103], v[204:207]
 ds_read_b64_tr_b16 a[226:227], v24 offset:59392
 v_cvt_pk_bf16_f32 v95, v190, v191
 v_mfma_f32_16x16x32_bf16 v[208:211], a[232:235], a[96:99], v[208:211]
 ds_read_b64_tr_b16 a[228:229], v24 offset:57352
 ds_read_b32 v10, v9
 v_mfma_f32_16x16x32_bf16 v[216:219], a[232:235], a[100:103], v[216:219]
 ds_read_b64_tr_b16 a[230:231], v24 offset:59400
 v_mfma_f32_16x16x32_bf16 v[212:215], a[236:239], a[96:99], v[212:215]
 ds_read_b64_tr_b16 a[232:233], v25 offset:57344
 s_waitcnt lgkmcnt(6)
 v_mfma_f32_16x16x32_bf16 v[220:223], a[236:239], a[100:103], v[220:223]
 ds_read_b64_tr_b16 a[234:235], v25 offset:59392
 v_mfma_f32_16x16x32_bf16 v[192:195], a[240:243], a[104:107], v[192:195]
 ds_read_b64_tr_b16 a[236:237], v25 offset:57352
 v_mfma_f32_16x16x32_bf16 v[200:203], a[240:243], a[108:111], v[200:203]
 ds_read_b64_tr_b16 a[238:239], v25 offset:59400
 v_mfma_f32_16x16x32_bf16 v[196:199], a[244:247], a[104:107], v[196:199]
 ds_read_b64_tr_b16 a[240:241], v24 offset:61440
 v_mfma_f32_16x16x32_bf16 v[204:207], a[244:247], a[108:111], v[204:207]
 ds_read_b64_tr_b16 a[242:243], v24 offset:63488
 v_mfma_f32_16x16x32_bf16 v[208:211], a[248:251], a[104:107], v[208:211]
 ds_read_b64_tr_b16 a[244:245], v24 offset:61448
 v_mfma_f32_16x16x32_bf16 v[216:219], a[248:251], a[108:111], v[216:219]
 ds_read_b64_tr_b16 a[246:247], v24 offset:63496
 v_add_u32 v24, 0x10000, v24
 v_mfma_f32_16x16x32_bf16 v[212:215], a[252:255], a[104:107], v[212:215]
 ds_read_b64_tr_b16 a[248:249], v25 offset:61440
 s_waitcnt lgkmcnt(5)
 v_mfma_f32_16x16x32_bf16 v[220:223], a[252:255], a[108:111], v[220:223]
 ds_read_b64_tr_b16 a[250:251], v25 offset:63488
 v_mfma_f32_16x16x32_bf16 v[224:227], a[224:227], a[32:35], v[224:227]
 ds_read_b64_tr_b16 a[252:253], v25 offset:61448
 v_cmp_le_u32 vcc, 33, v10
 v_mfma_f32_16x16x32_bf16 v[232:235], a[224:227], a[36:39], v[232:235]
 ds_read_b64_tr_b16 a[254:255], v25 offset:63496
 v_add_u32 v25, 0x10000, v25
 v_mfma_f32_16x16x32_bf16 v[228:231], a[228:231], a[32:35], v[228:231]
 s_cbranch_vccz L_cs192
L_cb192:
 ds_read_b64_tr_b16 a[224:225], v24 offset:0
 v_mfma_f32_16x16x32_bf16 v[236:239], a[228:231], a[36:39], v[236:239]
 ds_read_b64_tr_b16 a[226:227], v24 offset:2048
 v_mul_f32 v192, s32, v192
 v_mfma_f32_16x16x32_bf16 v[240:243], a[232:235], a[32:35], v[240:243]
 ds_read_b64_tr_b16 a[228:229], v24 offset:8
 v_mul_f32 v193, s32, v193
 v_mfma_f32_16x16x32_bf16 v[248:251], a[232:235], a[36:39], v[248:251]
 ds_read_b64_tr_b16 a[230:231], v24 offset:2056
 v_cvt_pk_bf16_f32 v96, v192, v193
 v_mfma_f32_16x16x32_bf16 v[244:247], a[236:239], a[32:35], v[244:247]
 ds_read_b64_tr_b16 a[232:233], v25 offset:0
 s_waitcnt lgkmcnt(5)
 v_mfma_f32_16x16x32_bf16 v[252:255], a[236:239], a[36:39], v[252:255]
 ds_read_b64_tr_b16 a[234:235], v25 offset:2048
 v_mul_f32 v194, s32, v194
 v_mfma_f32_16x16x32_bf16 v[224:227], a[240:243], a[40:43], v[224:227]
 ds_read_b64_tr_b16 a[236:237], v25 offset:8
 v_mul_f32 v195, s32, v195
 v_mfma_f32_16x16x32_bf16 v[232:235], a[240:243], a[44:47], v[232:235]
 ds_read_b64_tr_b16 a[238:239], v25 offset:2056
 v_cvt_pk_bf16_f32 v97, v194, v195
 v_mfma_f32_16x16x32_bf16 v[228:231], a[244:247], a[40:43], v[228:231]
 ds_read_b64_tr_b16 a[240:241], v24 offset:4096
 v_mul_f32 v196, s32, v196
 v_mfma_f32_16x16x32_bf16 v[236:239], a[244:247], a[44:47], v[236:239]
 ds_read_b64_tr_b16 a[242:243], v24 offset:6144
 s_movk_i32 s70, 96
 v_mfma_f32_16x16x32_bf16 v[240:243], a[248:251], a[40:43], v[240:243]
 ds_read_b64_tr_b16 a[244:245], v24 offset:4104
 v_mul_f32 v197, s32, v197
 v_mfma_f32_16x16x32_bf16 v[248:251], a[248:251], a[44:47], v[248:251]
 ds_read_b64_tr_b16 a[246:247], v24 offset:6152
 v_cvt_pk_bf16_f32 v98, v196, v197
 v_mfma_f32_16x16x32_bf16 v[244:247], a[252:255], a[40:43], v[244:247]
 ds_read_b64_tr_b16 a[248:249], v25 offset:4096
 s_waitcnt lgkmcnt(5)
 v_mfma_f32_16x16x32_bf16 v[252:255], a[252:255], a[44:47], v[252:255]
 ds_read_b64_tr_b16 a[250:251], v25 offset:6144
 v_mul_f32 v198, s32, v198
 v_mfma_f32_16x16x32_bf16 v[224:227], a[224:227], a[48:51], v[224:227]
 ds_read_b64_tr_b16 a[252:253], v25 offset:4104
 buffer_load_dword off, s[72:75], s70 lds
 v_mul_f32 v199, s32, v199
 v_mfma_f32_16x16x32_bf16 v[232:235], a[224:227], a[52:55], v[232:235]
 ds_read_b64_tr_b16 a[254:255], v25 offset:6152
 v_cvt_pk_bf16_f32 v99, v198, v199
 v_mfma_f32_16x16x32_bf16 v[228:231], a[228:231], a[48:51], v[228:231]
 ds_read_b64_tr_b16 a[224:225], v24 offset:8192
 v_mul_f32 v200, s32, v200
 v_mfma_f32_16x16x32_bf16 v[236:239], a[228:231], a[52:55], v[236:239]
 ds_read_b64_tr_b16 a[226:227], v24 offset:10240
 v_mul_f32 v201, s32, v201
 v_mfma_f32_16x16x32_bf16 v[240:243], a[232:235], a[48:51], v[240:243]
 ds_read_b64_tr_b16 a[228:229], v24 offset:8200
 ds_read_b32 v10, v9
 v_mfma_f32_16x16x32_bf16 v[248:251], a[232:235], a[52:55], v[248:251]
 ds_read_b64_tr_b16 a[230:231], v24 offset:10248
 v_cvt_pk_bf16_f32 v100, v200, v201
 v_mfma_f32_16x16x32_bf16 v[244:247], a[236:239], a[48:51], v[244:247]
 ds_read_b64_tr_b16 a[232:233], v25 offset:8192
 s_waitcnt lgkmcnt(6)
 v_mfma_f32_16x16x32_bf16 v[252:255], a[236:239], a[52:55], v[252:255]
 ds_read_b64_tr_b16 a[234:235], v25 offset:10240
 v_mul_f32 v202, s32, v202
 v_mfma_f32_16x16x32_bf16 v[224:227], a[240:243], a[56:59], v[224:227]
 ds_read_b64_tr_b16 a[236:237], v25 offset:8200
 v_mul_f32 v203, s32, v203
 v_mfma_f32_16x16x32_bf16 v[232:235], a[240:243], a[60:63], v[232:235]
 ds_read_b64_tr_b16 a[238:239], v25 offset:10248
 v_cvt_pk_bf16_f32 v101, v202, v203
 v_mfma_f32_16x16x32_bf16 v[228:231], a[244:247], a[56:59], v[228:231]
 ds_read_b64_tr_b16 a[240:241], v24 offset:12288
 v_mul_f32 v204, s32, v204
 v_mfma_f32_16x16x32_bf16 v[236:239], a[244:247], a[60:63], v[236:239]
 ds_read_b64_tr_b16 a[242:243], v24 offset:14336
 v_mul_f32 v205, s32, v205
 v_mfma_f32_16x16x32_bf16 v[240:243], a[248:251], a[56:59], v[240:243]
 ds_read_b64_tr_b16 a[244:245], v24 offset:12296
 v_cvt_pk_bf16_f32 v102, v204, v205
 v_mfma_f32_16x16x32_bf16 v[248:251], a[248:251], a[60:63], v[248:251]
 ds_read_b64_tr_b16 a[246:247], v24 offset:14344
 v_mul_f32 v206, s32, v206
 v_mfma_f32_16x16x32_bf16 v[244:247], a[252:255], a[56:59], v[244:247]
 ds_read_b64_tr_b16 a[248:249], v25 offset:12288
 s_waitcnt lgkmcnt(5)
 v_mfma_f32_16x16x32_bf16 v[252:255], a[252:255], a[60:63], v[252:255]
 ds_read_b64_tr_b16 a[250:251], v25 offset:14336
 v_mul_f32 v207, s32, v207
 v_mfma_f32_16x16x32_bf16 v[224:227], a[224:227], a[64:67], v[224:227]
 ds_read_b64_tr_b16 a[252:253], v25 offset:12296
 v_cmp_le_u32 vcc, 35, v10
 v_mfma_f32_16x16x32_bf16 v[232:235], a[224:227], a[68:71], v[232:235]
 ds_read_b64_tr_b16 a[254:255], v25 offset:14344
 v_cvt_pk_bf16_f32 v103, v206, v207
 v_mfma_f32_16x16x32_bf16 v[228:231], a[228:231], a[64:67], v[228:231]
 s_cbranch_vccz L_cs208
L_cb208:
 ds_read_b64_tr_b16 a[224:225], v24 offset:16384
 v_mfma_f32_16x16x32_bf16 v[236:239], a[228:231], a[68:71], v[236:239]
 ds_read_b64_tr_b16 a[226:227], v24 offset:18432
 v_mul_f32 v208, s32, v208
 v_mfma_f32_16x16x32_bf16 v[240:243], a[232:235], a[64:67], v[240:243]
 ds_read_b64_tr_b16 a[228:229], v24 offset:16392
 v_mul_f32 v209, s32, v209
 v_mfma_f32_16x16x32_bf16 v[248:251], a[232:235], a[68:71], v[248:251]
 ds_read_b64_tr_b16 a[230:231], v24 offset:18440
 v_cvt_pk_bf16_f32 v104, v208, v209
 v_mfma_f32_16x16x32_bf16 v[244:247], a[236:239], a[64:67], v[244:247]
 ds_read_b64_tr_b16 a[232:233], v25 offset:16384
 s_waitcnt lgkmcnt(5)
 v_mfma_f32_16x16x32_bf16 v[252:255], a[236:239], a[68:71], v[252:255]
 ds_read_b64_tr_b16 a[234:235], v25 offset:18432
 v_mul_f32 v210, s32, v210
 v_mfma_f32_16x16x32_bf16 v[224:227], a[240:243], a[72:75], v[224:227]
 ds_read_b64_tr_b16 a[236:237], v25 offset:16392
 v_mul_f32 v211, s32, v211
 v_mfma_f32_16x16x32_bf16 v[232:235], a[240:243], a[76:79], v[232:235]
 ds_read_b64_tr_b16 a[238:239], v25 offset:18440
 v_cvt_pk_bf16_f32 v105, v210, v211
 v_mfma_f32_16x16x32_bf16 v[228:231], a[244:247], a[72:75], v[228:231]
 ds_read_b64_tr_b16 a[240:241], v24 offset:20480
 v_mul_f32 v212, s32, v212
 v_mfma_f32_16x16x32_bf16 v[236:239], a[244:247], a[76:79], v[236:239]
 ds_read_b64_tr_b16 a[242:243], v24 offset:22528
 s_movk_i32 s70, 104
 v_mfma_f32_16x16x32_bf16 v[240:243], a[248:251], a[72:75], v[240:243]
 ds_read_b64_tr_b16 a[244:245], v24 offset:20488
 v_mul_f32 v213, s32, v213
 v_mfma_f32_16x16x32_bf16 v[248:251], a[248:251], a[76:79], v[248:251]
 ds_read_b64_tr_b16 a[246:247], v24 offset:22536
 v_add_u32 v24, 0xfffe0000, v24
 v_mfma_f32_16x16x32_bf16 v[244:247], a[252:255], a[72:75], v[244:247]
 ds_read_b64_tr_b16 a[248:249], v25 offset:20480
 s_waitcnt lgkmcnt(5)
 v_mfma_f32_16x16x32_bf16 v[252:255], a[252:255], a[76:79], v[252:255]
 ds_read_b64_tr_b16 a[250:251], v25 offset:22528
 v_cvt_pk_bf16_f32 v106, v212, v213
 v_mfma_f32_16x16x32_bf16 v[224:227], a[224:227], a[80:83], v[224:227]
 ds_read_b64_tr_b16 a[252:253], v25 offset:20488
 buffer_load_dword off, s[72:75], s70 lds
 v_mul_f32 v214, s32, v214
 v_mfma_f32_16x16x32_bf16 v[232:235], a[224:227], a[84:87], v[232:235]
 ds_read_b64_tr_b16 a[254:255], v25 offset:22536
 v_add_u32 v25, 0xfffe0000, v25
 v_mfma_f32_16x16x32_bf16 v[228:231], a[228:231], a[80:83], v[228:231]
 ds_read_b64_tr_b16 a[224:225], v24 offset:0
 v_mul_f32 v215, s32, v215
 v_mfma_f32_16x16x32_bf16 v[236:239], a[228:231], a[84:87], v[236:239]
 ds_read_b64_tr_b16 a[226:227], v24 offset:2048
 v_cvt_pk_bf16_f32 v107, v214, v215
 v_mfma_f32_16x16x32_bf16 v[240:243], a[232:235], a[80:83], v[240:243]
 ds_read_b64_tr_b16 a[228:229], v24 offset:8
 ds_read_b32 v10, v9
 v_mfma_f32_16x16x32_bf16 v[248:251], a[232:235], a[84:87], v[248:251]
 ds_read_b64_tr_b16 a[230:231], v24 offset:2056
 v_mul_f32 v216, s32, v216
 v_mfma_f32_16x16x32_bf16 v[244:247], a[236:239], a[80:83], v[244:247]
 ds_read_b64_tr_b16 a[232:233], v25 offset:0
 s_waitcnt lgkmcnt(6)
 v_mfma_f32_16x16x32_bf16 v[252:255], a[236:239], a[84:87], v[252:255]
 ds_read_b64_tr_b16 a[234:235], v25 offset:2048
 v_mul_f32 v217, s32, v217
 v_mfma_f32_16x16x32_bf16 v[224:227], a[240:243], a[88:91], v[224:227]
 ds_read_b64_tr_b16 a[236:237], v25 offset:8
 v_cvt_pk_bf16_f32 v108, v216, v217
 v_mfma_f32_16x16x32_bf16 v[232:235], a[240:243], a[92:95], v[232:235]
 ds_read_b64_tr_b16 a[238:239], v25 offset:2056
 v_mul_f32 v218, s32, v218
 v_mfma_f32_16x16x32_bf16 v[228:231], a[244:247], a[88:91], v[228:231]
 ds_read_b64_tr_b16 a[240:241], v24 offset:4096
 v_mul_f32 v219, s32, v219
 v_mfma_f32_16x16x32_bf16 v[236:239], a[244:247], a[92:95], v[236:239]
 ds_read_b64_tr_b16 a[242:243], v24 offset:6144
 v_cvt_pk_bf16_f32 v109, v218, v219
 v_mfma_f32_16x16x32_bf16 v[240:243], a[248:251], a[88:91], v[240:243]
 ds_read_b64_tr_b16 a[244:245], v24 offset:4104
 v_mul_f32 v220, s32, v220
 v_mfma_f32_16x16x32_bf16 v[248:251], a[248:251], a[92:95], v[248:251]
 ds_read_b64_tr_b16 a[246:247], v24 offset:6152
 v_mul_f32 v221, s32, v221
 v_mfma_f32_16x16x32_bf16 v[244:247], a[252:255], a[88:91], v[244:247]
 ds_read_b64_tr_b16 a[248:249], v25 offset:4096
 s_waitcnt lgkmcnt(5)
 v_mfma_f32_16x16x32_bf16 v[252:255], a[252:255], a[92:95], v[252:255]
 ds_read_b64_tr_b16 a[250:251], v25 offset:6144
 v_cvt_pk_bf16_f32 v110, v220, v221
 v_mfma_f32_16x16x32_bf16 v[224:227], a[224:227], a[96:99], v[224:227]
 ds_read_b64_tr_b16 a[252:253], v25 offset:4104
 v_cmp_le_u32 vcc, 37, v10
 v_mfma_f32_16x16x32_bf16 v[232:235], a[224:227], a[100:103], v[232:235]
 ds_read_b64_tr_b16 a[254:255], v25 offset:6152
 v_mul_f32 v222, s32, v222
 v_mfma_f32_16x16x32_bf16 v[228:231], a[228:231], a[96:99], v[228:231]
 s_cbranch_vccz L_cs224
L_cb224:
 ds_read_b128 a[224:227], v3 offset:8192
 v_mfma_f32_16x16x32_bf16 v[236:239], a[228:231], a[100:103], v[236:239]
 v_mul_f32 v223, s32, v223
 v_cvt_pk_bf16_f32 v111, v222, v223
 v_mfma_f32_16x16x32_bf16 v[240:243], a[232:235], a[96:99], v[240:243]
 ds_read_b128 a[228:231], v3 offset:10240
 v_mfma_f32_16x16x32_bf16 v[248:251], a[232:235], a[100:103], v[248:251]
 v_mfma_f32_16x16x32_bf16 v[244:247], a[236:239], a[96:99], v[244:247]
 ds_read_b128 a[232:235], v4 offset:8192
 s_waitcnt lgkmcnt(3)
 v_mfma_f32_16x16x32_bf16 v[252:255], a[236:239], a[100:103], v[252:255]
 v_mfma_f32_16x16x32_bf16 v[224:227], a[240:243], a[104:107], v[224:227]
 ds_read_b128 a[236:239], v4 offset:10240
 v_mfma_f32_16x16x32_bf16 v[232:235], a[240:243], a[108:111], v[232:235]
 v_mfma_f32_16x16x32_bf16 v[228:231], a[244:247], a[104:107], v[228:231]
 ds_read_b128 a[240:243], v3 offset:12288
 v_mfma_f32_16x16x32_bf16 v[236:239], a[244:247], a[108:111], v[236:239]
 s_movk_i32 s70, 112
 v_mfma_f32_16x16x32_bf16 v[240:243], a[248:251], a[104:107], v[240:243]
 ds_read_b128 a[244:247], v3 offset:14336
 v_mfma_f32_16x16x32_bf16 v[248:251], a[248:251], a[108:111], v[248:251]
 v_mfma_f32_16x16x32_bf16 v[244:247], a[252:255], a[104:107], v[244:247]
 ds_read_b128 a[248:251], v4 offset:12288
 s_waitcnt lgkmcnt(3)
 v_mfma_f32_16x16x32_bf16 v[252:255], a[252:255], a[108:111], v[252:255]
 buffer_load_dword off, s[72:75], s70 lds
 s_waitcnt vmcnt(8)
 v_mfma_f32_16x16x32_bf16 v[32:35], a[224:227], v[64:67], 0
 ds_read_b128 a[252:255], v4 offset:14336
 v_mfma_f32_16x16x32_bf16 v[40:43], a[224:227], v[68:71], 0
 v_mfma_f32_16x16x32_bf16 v[36:39], a[228:231], v[64:67], 0
 ds_read_b128 a[224:227], v3 offset:16384
 v_mul_f32 v224, s32, v224
 v_mul_f32 v225, s32, v225
 v_cvt_pk_bf16_f32 v112, v224, v225
 v_mul_f32 v226, s32, v226
 v_mul_f32 v227, s32, v227
 v_cvt_pk_bf16_f32 v113, v226, v227
 v_mul_f32 v228, s32, v228
 v_mul_f32 v229, s32, v229
 v_cvt_pk_bf16_f32 v114, v228, v229
 v_mul_f32 v230, s32, v230
 v_mul_f32 v231, s32, v231
 v_cvt_pk_bf16_f32 v115, v230, v231
 v_mul_f32 v232, s32, v232
 v_mul_f32 v233, s32, v233
 v_cvt_pk_bf16_f32 v116, v232, v233
 v_mul_f32 v234, s32, v234
 v_mul_f32 v235, s32, v235
 v_cvt_pk_bf16_f32 v117, v234, v235
 v_mul_f32 v236, s32, v236
 v_mul_f32 v237, s32, v237
 v_mfma_f32_16x16x32_bf16 v[44:47], a[228:231], v[68:71], 0
 v_cvt_pk_bf16_f32 v118, v236, v237
 v_mul_f32 v238, s32, v238
 v_mfma_f32_16x16x32_bf16 v[32:35], a[232:235], v[72:75], v[32:35]
 ds_read_b128 a[228:231], v3 offset:18432
 ds_read_b32 v10, v9
 v_mul_f32 v239, s32, v239
 v_mfma_f32_16x16x32_bf16 v[40:43], a[232:235], v[76:79], v[40:43]
 v_cvt_pk_bf16_f32 v119, v238, v239
 v_mul_f32 v240, s32, v240
 v_mfma_f32_16x16x32_bf16 v[36:39], a[236:239], v[72:75], v[36:39]
 ds_read_b128 a[232:235], v4 offset:16384
 s_waitcnt lgkmcnt(4)
 v_mul_f32 v241, s32, v241
 v_mfma_f32_16x16x32_bf16 v[44:47], a[236:239], v[76:79], v[44:47]
 v_cvt_pk_bf16_f32 v120, v240, v241
 v_mul_f32 v242, s32, v242
 v_mfma_f32_16x16x32_bf16 v[32:35], a[240:243], v[80:83], v[32:35]
 ds_read_b128 a[236:239], v4 offset:18432
 v_mul_f32 v243, s32, v243
 v_mfma_f32_16x16x32_bf16 v[40:43], a[240:243], v[84:87], v[40:43]
 v_cvt_pk_bf16_f32 v121, v242, v243
 v_mul_f32 v244, s32, v244
 v_mfma_f32_16x16x32_bf16 v[36:39], a[244:247], v[80:83], v[36:39]
 ds_read_b128 a[240:243], v3 offset:20480
 v_mul_f32 v245, s32, v245
 v_mfma_f32_16x16x32_bf16 v[44:47], a[244:247], v[84:87], v[44:47]
 v_cvt_pk_bf16_f32 v122, v244, v245
 v_mul_f32 v246, s32, v246
 v_mfma_f32_16x16x32_bf16 v[32:35], a[248:251], v[88:91], v[32:35]
 ds_read_b128 a[244:247], v3 offset:22528
 v_mul_f32 v247, s32, v247
 v_mfma_f32_16x16x32_bf16 v[40:43], a[248:251], v[92:95], v[40:43]
 v_cvt_pk_bf16_f32 v123, v246, v247
 v_mul_f32 v248, s32, v248
 v_mfma_f32_16x16x32_bf16 v[36:39], a[252:255], v[88:91], v[36:39]
 ds_read_b128 a[248:251], v4 offset:20480
 s_waitcnt lgkmcnt(3)
 v_mul_f32 v249, s32, v249
 v_mfma_f32_16x16x32_bf16 v[44:47], a[252:255], v[92:95], v[44:47]
 v_cvt_pk_bf16_f32 v124, v248, v249
 v_mul_f32 v250, s32, v250
 v_mfma_f32_16x16x32_bf16 v[32:35], a[224:227], v[96:99], v[32:35]
 ds_read_b128 a[252:255], v4 offset:22528
 v_cmp_le_u32 vcc, 38, v10
 v_mul_f32 v251, s32, v251
 v_mfma_f32_16x16x32_bf16 v[40:43], a[224:227], v[100:103], v[40:43]
 v_cvt_pk_bf16_f32 v125, v250, v251
 v_mul_f32 v252, s32, v252
 v_mfma_f32_16x16x32_bf16 v[36:39], a[228:231], v[96:99], v[36:39]
 s_cbranch_vccz L_cs240
L_cb240:
 ds_read_b64_tr_b16 a[224:225], v24 offset:24576
 v_mfma_f32_16x16x32_bf16 v[44:47], a[228:231], v[100:103], v[44:47]
 ds_read_b64_tr_b16 a[226:227], v24 offset:26624
 v_mul_f32 v253, s32, v253
 v_mfma_f32_16x16x32_bf16 v[32:35], a[232:235], v[104:107], v[32:35]
 ds_read_b64_tr_b16 a[228:229], v24 offset:24584
 v_cvt_pk_bf16_f32 v126, v252, v253
 v_mul_f32 v254, s32, v254
 v_mfma_f32_16x16x32_bf16 v[40:43], a[232:235], v[108:111], v[40:43]
 ds_read_b64_tr_b16 a[230:231], v24 offset:26632
 v_mul_f32 v255, s32, v255
 v_mfma_f32_16x16x32_bf16 v[36:39], a[236:239], v[104:107], v[36:39]
 ds_read_b64_tr_b16 a[232:233], v25 offset:24576
 ds_read_b32 v10, v9
 v_cvt_pk_bf16_f32 v127, v254, v255
 v_mfma_f32_16x16x32_bf16 v[44:47], a[236:239], v[108:111], v[44:47]
 ds_read_b64_tr_b16 a[234:235], v25 offset:26624
 s_waitcnt lgkmcnt(7)
 v_mfma_f32_16x16x32_bf16 v[32:35], a[240:243], v[112:115], v[32:35]
 ds_read_b64_tr_b16 a[236:237], v25 offset:24584
 v_mfma_f32_16x16x32_bf16 v[40:43], a[240:243], v[116:119], v[40:43]
 ds_read_b64_tr_b16 a[238:239], v25 offset:26632
 v_mfma_f32_16x16x32_bf16 v[36:39], a[244:247], v[112:115], v[36:39]
 ds_read_b64_tr_b16 a[240:241], v24 offset:28672
 v_mfma_f32_16x16x32_bf16 v[44:47], a[244:247], v[116:119], v[44:47]
 ds_read_b64_tr_b16 a[242:243], v24 offset:30720
 s_movk_i32 s70, 120
 v_mfma_f32_16x16x32_bf16 v[32:35], a[248:251], v[120:123], v[32:35]
 ds_read_b64_tr_b16 a[244:245], v24 offset:28680
 v_mfma_f32_16x16x32_bf16 v[40:43], a[248:251], v[124:127], v[40:43]
 ds_read_b64_tr_b16 a[246:247], v24 offset:30728
 v_mfma_f32_16x16x32_bf16 v[36:39], a[252:255], v[120:123], v[36:39]
 ds_read_b64_tr_b16 a[248:249], v25 offset:28672
 s_waitcnt lgkmcnt(5)
 v_mfma_f32_16x16x32_bf16 v[44:47], a[252:255], v[124:127], v[44:47]
 ds_read_b64_tr_b16 a[250:251], v25 offset:30720
 buffer_load_dword off, s[72:75], s70 lds
 v_mfma_f32_16x16x32_bf16 a[176:179], a[224:227], a[0:3], 0
 ds_read_b64_tr_b16 a[252:253], v25 offset:28680
 v_cmp_le_u32 vcc, 42, v10
 v_mfma_f32_16x16x32_bf16 a[184:187], a[224:227], a[4:7], 0
 ds_read_b64_tr_b16 a[254:255], v25 offset:30728
 v_mfma_f32_16x16x32_bf16 a[180:183], a[228:231], a[0:3], 0
 s_cbranch_vccz L_cs248
L_cb248:
 ds_read_b128 a[224:227], v3 offset:40960
 v_max3_f32 v11, v32, v33, v34
 v_max3_f32 v12, v40, v41, v42
 v_max3_f32 v11, v11, v35, v36
 v_max3_f32 v12, v12, v43, v44
 v_max3_f32 v11, v11, v37, v38
 v_max3_f32 v12, v12, v45, v46
 v_max_f32 v11, v11, v39
 v_max_f32 v12, v12, v47
 v_mov_b32 v16, v11
 v_mov_b32 v17, v12
  s_nop 0
 v_permlane32_swap_b32 v16, v11
 v_permlane32_swap_b32 v17, v12
 v_max_f32 v11, v16, v11
 v_max_f32 v12, v17, v12
 v_mov_b32 v16, v11
 v_mov_b32 v17, v12
  s_nop 0
 v_permlane16_swap_b32 v16, v11
 v_permlane16_swap_b32 v17, v12
 v_max_f32 v11, v16, v11
 v_max_f32 v12, v17, v12
 v_ceil_f32 v11, v11
 v_ceil_f32 v12, v12
 v_sub_f32 v16, 0, v11
 v_sub_f32 v17, 0, v11
 v_sub_f32 v18, 0, v11
 v_sub_f32 v19, 0, v11
 v_sub_f32 v20, 0, v12
 v_sub_f32 v21, 0, v12
 v_sub_f32 v22, 0, v12
 v_sub_f32 v23, 0, v12
 v_sub_f32 v32, v32, v11
 v_sub_f32 v33, v33, v11
 v_sub_f32 v34, v34, v11
 v_sub_f32 v35, v35, v11
 v_sub_f32 v36, v36, v11
 v_sub_f32 v37, v37, v11
 v_sub_f32 v38, v38, v11
 v_sub_f32 v39, v39, v11
 v_sub_f32 v40, v40, v12
 v_sub_f32 v41, v41, v12
 v_sub_f32 v42, v42, v12
 v_sub_f32 v43, v43, v12
 v_sub_f32 v44, v44, v12
 v_mfma_f32_16x16x32_bf16 a[188:191], a[228:231], a[4:7], 0
 v_sub_f32 v45, v45, v12
 v_sub_f32 v46, v46, v12
 v_mfma_f32_16x16x32_bf16 a[192:195], a[232:235], a[0:3], 0
 ds_read_b128 a[228:231], v3 offset:43008
 v_sub_f32 v47, v47, v12
 v_mfma_f32_16x16x32_bf16 a[200:203], a[232:235], a[4:7], 0
 v_exp_f32 v32, v32
 v_mfma_f32_16x16x32_bf16 a[196:199], a[236:239], a[0:3], 0
 ds_read_b128 a[232:235], v4 offset:40960
 s_waitcnt lgkmcnt(3)
 v_mov_b32 v14, 0
 v_mfma_f32_16x16x32_bf16 a[204:207], a[236:239], a[4:7], 0
 v_exp_f32 v33, v33
 v_mfma_f32_16x16x32_bf16 a[176:179], a[240:243], a[8:11], a[176:179]
 ds_read_b128 a[236:239], v4 offset:43008
 v_mov_b32 v15, 0
 v_mfma_f32_16x16x32_bf16 a[184:187], a[240:243], a[12:15], a[184:187]
 v_exp_f32 v34, v34
 v_mfma_f32_16x16x32_bf16 a[180:183], a[244:247], a[8:11], a[180:183]
 ds_read_b128 a[240:243], v3 offset:45056
 v_add_u32 v5, 0x10000, v5
 v_exp_f32 v35, v35
 v_mfma_f32_16x16x32_bf16 a[188:191], a[244:247], a[12:15], a[188:191]
 v_exp_f32 v36, v36
 v_mfma_f32_16x16x32_bf16 a[192:195], a[248:251], a[8:11], a[192:195]
 ds_read_b128 a[244:247], v3 offset:47104
 s_movk_i32 s70, 124
 v_add_u32 v3, 0x10000, v3
 v_add_u32 v6, 0x10000, v6
 v_mfma_f32_16x16x32_bf16 a[200:203], a[248:251], a[12:15], a[200:203]
 v_exp_f32 v37, v37
 v_mfma_f32_16x16x32_bf16 a[196:199], a[252:255], a[8:11], a[196:199]
 ds_read_b128 a[248:251], v4 offset:45056
 s_waitcnt lgkmcnt(3)
 v_add_u32 v7, 0x10000, v7
 v_exp_f32 v38, v38
 v_mfma_f32_16x16x32_bf16 a[204:207], a[252:255], a[12:15], a[204:207]
 buffer_load_dword off, s[72:75], s70 lds
 v_exp_f32 v39, v39
 v_mfma_f32_16x16x32_bf16 v[48:51], a[224:227], v[64:67], v[16:19]
 ds_read_b128 a[252:255], v4 offset:47104
 v_add_u32 v4, 0x10000, v4
 v_add_u32 v8, 0x10000, v8
 v_mfma_f32_16x16x32_bf16 v[56:59], a[224:227], v[68:71], v[20:23]
 v_exp_f32 v40, v40
 v_mfma_f32_16x16x32_bf16 v[52:55], a[228:231], v[64:67], v[16:19]
 ds_read_b128 a[224:227], v3 offset:8192
 v_add_f32 v14, v14, v32
 v_mfma_f32_16x16x32_bf16 v[60:63], a[228:231], v[68:71], v[20:23]
 v_exp_f32 v41, v41
 v_mfma_f32_16x16x32_bf16 v[48:51], a[232:235], v[72:75], v[48:51]
 ds_read_b128 a[228:231], v3 offset:10240
 v_add_f32 v14, v14, v33
 v_mfma_f32_16x16x32_bf16 v[56:59], a[232:235], v[76:79], v[56:59]
 v_exp_f32 v42, v42
 v_mfma_f32_16x16x32_bf16 v[52:55], a[236:239], v[72:75], v[52:55]
 ds_read_b128 a[232:235], v4 offset:8192
 s_waitcnt lgkmcnt(3)
 v_exp_f32 v43, v43
 v_mfma_f32_16x16x32_bf16 v[60:63], a[236:239], v[76:79], v[60:63]
 v_exp_f32 v44, v44
 v_mfma_f32_16x16x32_bf16 v[48:51], a[240:243], v[80:83], v[48:51]
 ds_read_b128 a[236:239], v4 offset:10240
 v_cvt_pk_bf16_f32 v32, v32, v33
 v_mfma_f32_16x16x32_bf16 v[56:59], a[240:243], v[84:87], v[56:59]
 v_exp_f32 v45, v45
 v_mfma_f32_16x16x32_bf16 v[52:55], a[244:247], v[80:83], v[52:55]
 ds_read_b128 a[240:243], v3 offset:12288
 v_add_f32 v14, v14, v34
 v_mfma_f32_16x16x32_bf16 v[60:63], a[244:247], v[84:87], v[60:63]
 v_exp_f32 v46, v46
 v_mfma_f32_16x16x32_bf16 v[48:51], a[248:251], v[88:91], v[48:51]
 ds_read_b128 a[244:247], v3 offset:14336
 v_add_f32 v14, v14, v35
 v_mfma_f32_16x16x32_bf16 v[56:59], a[248:251], v[92:95], v[56:59]
 v_exp_f32 v47, v47
 v_mfma_f32_16x16x32_bf16 v[52:55], a[252:255], v[88:91], v[52:55]
 ds_read_b128 a[248:251], v4 offset:12288
 s_waitcnt lgkmcnt(3)
 v_mfma_f32_16x16x32_bf16 v[60:63], a[252:255], v[92:95], v[60:63]
 v_cvt_pk_bf16_f32 v33, v34, v35
 v_add_f32 v14, v14, v36
 v_mfma_f32_16x16x32_bf16 v[48:51], a[224:227], v[96:99], v[48:51]
 ds_read_b128 a[252:255], v4 offset:14336
 v_add_f32 v14, v14, v37
 v_mfma_f32_16x16x32_bf16 v[56:59], a[224:227], v[100:103], v[56:59]
 v_cvt_pk_bf16_f32 v34, v36, v37
 v_add_f32 v14, v14, v38
 v_mfma_f32_16x16x32_bf16 v[52:55], a[228:231], v[96:99], v[52:55]
 ds_read_b64_tr_b16 a[224:225], v5 offset:0
 v_add_f32 v14, v14, v39
 v_mfma_f32_16x16x32_bf16 v[60:63], a[228:231], v[100:103], v[60:63]
 ds_read_b64_tr_b16 a[226:227], v5 offset:2048
 v_cvt_pk_bf16_f32 v35, v38, v39
 v_mfma_f32_16x16x32_bf16 v[48:51], a[232:235], v[104:107], v[48:51]
 ds_read_b64_tr_b16 a[228:229], v6 offset:0
 ds_read_b32 v10, v9
 v_add_f32 v15, v15, v40
 v_mfma_f32_16x16x32_bf16 v[56:59], a[232:235], v[108:111], v[56:59]
 ds_read_b64_tr_b16 a[230:231], v6 offset:2048
 v_add_f32 v15, v15, v41
 v_mfma_f32_16x16x32_bf16 v[52:55], a[236:239], v[104:107], v[52:55]
 ds_read_b64_tr_b16 a[232:233], v7 offset:0
 s_waitcnt lgkmcnt(6)
 v_cvt_pk_bf16_f32 v36, v40, v41
 v_mfma_f32_16x16x32_bf16 v[60:63], a[236:239], v[108:111], v[60:63]
 ds_read_b64_tr_b16 a[234:235], v7 offset:2048
 v_add_f32 v15, v15, v42
 v_mfma_f32_16x16x32_bf16 v[48:51], a[240:243], v[112:115], v[48:51]
 ds_read_b64_tr_b16 a[236:237], v8 offset:0
 v_add_f32 v15, v15, v43
 v_mfma_f32_16x16x32_bf16 v[56:59], a[240:243], v[116:119], v[56:59]
 ds_read_b64_tr_b16 a[238:239], v8 offset:2048
 v_cvt_pk_bf16_f32 v37, v42, v43
 v_mfma_f32_16x16x32_bf16 v[52:55], a[244:247], v[112:115], v[52:55]
 ds_read_b64_tr_b16 a[240:241], v5 offset:4096
 v_add_f32 v15, v15, v44
 v_mfma_f32_16x16x32_bf16 v[60:63], a[244:247], v[116:119], v[60:63]
 ds_read_b64_tr_b16 a[242:243], v5 offset:6144
 v_add_f32 v15, v15, v45
 v_mfma_f32_16x16x32_bf16 v[48:51], a[248:251], v[120:123], v[48:51]
 ds_read_b64_tr_b16 a[244:245], v6 offset:4096
 v_cvt_pk_bf16_f32 v38, v44, v45
 v_mfma_f32_16x16x32_bf16 v[56:59], a[248:251], v[124:127], v[56:59]
 ds_read_b64_tr_b16 a[246:247], v6 offset:6144
 v_add_f32 v15, v15, v46
 v_mfma_f32_16x16x32_bf16 v[52:55], a[252:255], v[120:123], v[52:55]
 ds_read_b64_tr_b16 a[248:249], v7 offset:4096
 v_add_f32 v15, v15, v47
 v_cvt_pk_bf16_f32 v39, v46, v47
 v_mfma_f32_16x16x32_bf16 v[60:63], a[252:255], v[124:127], v[60:63]
 ds_read_b64_tr_b16 a[250:251], v7 offset:6144
 s_waitcnt lgkmcnt(6)
 s_movk_i32 s70, 132
 v_mfma_f32_16x16x32_bf16 v[128:131], a[224:227], v[32:35], 0
 ds_read_b64_tr_b16 a[252:253], v8 offset:4096
 buffer_load_dword off, s[72:75], s70 lds
 v_cmp_le_u32 vcc, 44, v10
 v_mfma_f32_16x16x32_bf16 v[136:139], a[224:227], v[36:39], 0
 ds_read_b64_tr_b16 a[254:255], v8 offset:6144
 v_mfma_f32_16x16x32_bf16 v[132:135], a[228:231], v[32:35], 0
 s_cbranch_vccz L_cs272
L_cb272:
 ds_read_b64_tr_b16 a[224:225], v5 offset:16384
 v_mfma_f32_16x16x32_bf16 v[140:143], a[228:231], v[36:39], 0
 ds_read_b64_tr_b16 a[226:227], v5 offset:18432
 v_max3_f32 v11, v48, v49, v50
 v_mfma_f32_16x16x32_bf16 v[144:147], a[232:235], v[32:35], 0
 ds_read_b64_tr_b16 a[228:229], v6 offset:16384
 v_max3_f32 v12, v56, v57, v58
 v_mfma_f32_16x16x32_bf16 v[152:155], a[232:235], v[36:39], 0
 ds_read_b64_tr_b16 a[230:231], v6 offset:18432
 v_max3_f32 v11, v11, v51, v52
 v_mfma_f32_16x16x32_bf16 v[148:151], a[236:239], v[32:35], 0
 ds_read_b64_tr_b16 a[232:233], v7 offset:16384
 s_waitcnt lgkmcnt(5)
 v_mfma_f32_16x16x32_bf16 v[156:159], a[236:239], v[36:39], 0
 ds_read_b64_tr_b16 a[234:235], v7 offset:18432
 v_max3_f32 v12, v12, v59, v60
 v_mfma_f32_16x16x32_bf16 v[160:163], a[240:243], v[32:35], 0
 ds_read_b64_tr_b16 a[236:237], v8 offset:16384
 v_max3_f32 v11, v11, v53, v54
 v_mfma_f32_16x16x32_bf16 v[168:171], a[240:243], v[36:39], 0
 ds_read_b64_tr_b16 a[238:239], v8 offset:18432
 v_max3_f32 v12, v12, v61, v62
 v_mfma_f32_16x16x32_bf16 v[164:167], a[244:247], v[32:35], 0
 ds_read_b64_tr_b16 a[240:241], v5 offset:20480
 v_max_f32 v11, v11, v55
 v_mfma_f32_16x16x32_bf16 v[172:175], a[244:247], v[36:39], 0
 ds_read_b64_tr_b16 a[242:243], v5 offset:22528
 v_max_f32 v12, v12, v63
 v_mfma_f32_16x16x32_bf16 v[176:179], a[248:251], v[32:35], 0
 ds_read_b64_tr_b16 a[244:245], v6 offset:20480
 v_max_f32 v13, v11, v12
 v_mfma_f32_16x16x32_bf16 v[184:187], a[248:251], v[36:39], 0
 ds_read_b64_tr_b16 a[246:247], v6 offset:22528
 v_cmp_lt_f32 vcc, 0x41200000, v13
 v_mfma_f32_16x16x32_bf16 v[180:183], a[252:255], v[32:35], 0
 ds_read_b64_tr_b16 a[248:249], v7 offset:20480
 s_waitcnt lgkmcnt(5)
 s_cbranch_vccnz L_rs0_1
L_rb0_1:
 v_mfma_f32_16x16x32_bf16 v[188:191], a[252:255], v[36:39], 0
 ds_read_b64_tr_b16 a[250:251], v7 offset:22528
 v_mfma_f32_16x16x32_bf16 v[192:195], a[224:227], v[32:35], 0
 ds_read_b64_tr_b16 a[252:253], v8 offset:20480
 v_mfma_f32_16x16x32_bf16 v[200:203], a[224:227], v[36:39], 0
 ds_read_b64_tr_b16 a[254:255], v8 offset:22528
 v_mfma_f32_16x16x32_bf16 v[196:199], a[228:231], v[32:35], 0
 ds_read_b128 a[224:227], v3 offset:24576
 v_mfma_f32_16x16x32_bf16 v[204:207], a[228:231], v[36:39], 0
 v_exp_f32 v48, v48
 v_mfma_f32_16x16x32_bf16 v[208:211], a[232:235], v[32:35], 0
 ds_read_b128 a[228:231], v3 offset:26624
 ds_read_b32 v10, v9
 v_mfma_f32_16x16x32_bf16 v[216:219], a[232:235], v[36:39], 0
 v_exp_f32 v49, v49
 v_mfma_f32_16x16x32_bf16 v[212:215], a[236:239], v[32:35], 0
 ds_read_b128 a[232:235], v4 offset:24576
 s_waitcnt lgkmcnt(4)
 v_mfma_f32_16x16x32_bf16 v[220:223], a[236:239], v[36:39], 0
 v_exp_f32 v50, v50
 v_mfma_f32_16x16x32_bf16 v[224:227], a[240:243], v[32:35], 0
 ds_read_b128 a[236:239], v4 offset:26624
 v_add_f32 v14, v14, v48
 v_mfma_f32_16x16x32_bf16 v[232:235], a[240:243], v[36:39], 0
 v_exp_f32 v51, v51
 v_mfma_f32_16x16x32_bf16 v[228:231], a[244:247], v[32:35], 0
 ds_read_b128 a[240:243], v3 offset:28672
 v_add_u32 v5, 0xffff0000, v5
 v_mfma_f32_16x16x32_bf16 v[236:239], a[244:247], v[36:39], 0
 v_exp_f32 v52, v52
 v_mfma_f32_16x16x32_bf16 v[240:243], a[248:251], v[32:35], 0
 ds_read_b128 a[244:247], v3 offset:30720
 s_movk_i32 s70, 140
 v_add_u32 v3, 0xffff0000, v3
 v_add_u32 v6, 0xffff0000, v6
 v_mfma_f32_16x16x32_bf16 v[248:251], a[248:251], v[36:39], 0
 v_exp_f32 v53, v53
 v_mfma_f32_16x16x32_bf16 v[244:247], a[252:255], v[32:35], 0
 ds_read_b128 a[248:251], v4 offset:28672
 s_waitcnt lgkmcnt(3)
 v_add_u32 v7, 0xffff0000, v7
 v_exp_f32 v54, v54
 v_mfma_f32_16x16x32_bf16 v[252:255], a[252:255], v[36:39], 0
 buffer_load_dword off, s[72:75], s70 lds
 v_exp_f32 v55, v55
 v_mfma_f32_16x16x32_bf16 v[32:35], a[224:227], v[64:67], v[16:19]
 ds_read_b128 a[252:255], v4 offset:30720
 v_cmp_le_u32 vcc, 46, v10
 v_add_u32 v4, 0xffff0000, v4
 v_add_u32 v8, 0xffff0000, v8
 v_mfma_f32_16x16x32_bf16 v[40:43], a[224:227], v[68:71], v[20:23]
 v_exp_f32 v56, v56
 v_mfma_f32_16x16x32_bf16 v[36:39], a[228:231], v[64:67], v[16:19]
 s_cbranch_vccz L_cs288
L_cb288:
 ds_read_b128 a[224:227], v3 offset:57344
 v_mfma_f32_16x16x32_bf16 v[44:47], a[228:231], v[68:71], v[20:23]
 v_exp_f32 v57, v57
 v_mfma_f32_16x16x32_bf16 v[32:35], a[232:235], v[72:75], v[32:35]
 ds_read_b128 a[228:231], v3 offset:59392
 v_add_f32 v14, v14, v49
 v_mfma_f32_16x16x32_bf16 v[40:43], a[232:235], v[76:79], v[40:43]
 v_exp_f32 v58, v58
 v_mfma_f32_16x16x32_bf16 v[36:39], a[236:239], v[72:75], v[36:39]
 ds_read_b128 a[232:235], v4 offset:57344
 s_waitcnt lgkmcnt(3)
 v_exp_f32 v59, v59
 v_mfma_f32_16x16x32_bf16 v[44:47], a[236:239], v[76:79], v[44:47]
 v_exp_f32 v60, v60
 v_mfma_f32_16x16x32_bf16 v[32:35], a[240:243], v[80:83], v[32:35]
 ds_read_b128 a[236:239], v4 offset:59392
 v_cvt_pk_bf16_f32 v48, v48, v49
 v_mfma_f32_16x16x32_bf16 v[40:43], a[240:243], v[84:87], v[40:43]
 v_exp_f32 v61, v61
 v_mfma_f32_16x16x32_bf16 v[36:39], a[244:247], v[80:83], v[36:39]
 ds_read_b128 a[240:243], v3 offset:61440
 v_add_f32 v14, v14, v50
 v_mfma_f32_16x16x32_bf16 v[44:47], a[244:247], v[84:87], v[44:47]
 v_exp_f32 v62, v62
 v_mfma_f32_16x16x32_bf16 v[32:35], a[248:251], v[88:91], v[32:35]
 ds_read_b128 a[244:247], v3 offset:63488
 v_add_f32 v14, v14, v51
 v_mfma_f32_16x16x32_bf16 v[40:43], a[248:251], v[92:95], v[40:43]
 v_exp_f32 v63, v63
 v_mfma_f32_16x16x32_bf16 v[36:39], a[252:255], v[88:91], v[36:39]
 ds_read_b128 a[248:251], v4 offset:61440
 s_waitcnt lgkmcnt(3)
 v_mfma_f32_16x16x32_bf16 v[44:47], a[252:255], v[92:95], v[44:47]
 v_cvt_pk_bf16_f32 v49, v50, v51
 v_add_f32 v14, v14, v52
 v_mfma_f32_16x16x32_bf16 v[32:35], a[224:227], v[96:99], v[32:35]
 ds_read_b128 a[252:255], v4 offset:63488
 v_add_f32 v14, v14, v53
 v_mfma_f32_16x16x32_bf16 v[40:43], a[224:227], v[100:103], v[40:43]
 v_cvt_pk_bf16_f32 v50, v52, v53
 v_add_f32 v14, v14, v54
 v_mfma_f32_16x16x32_bf16 v[36:39], a[228:231], v[96:99], v[36:39]
 ds_read_b64_tr_b16 a[224:225], v5 offset:49152
 v_add_f32 v14, v14, v55
 v_mfma_f32_16x16x32_bf16 v[44:47], a[228:231], v[100:103], v[44:47]
 ds_read_b64_tr_b16 a[226:227], v5 offset:51200
 v_cvt_pk_bf16_f32 v51, v54, v55
 v_mfma_f32_16x16x32_bf16 v[32:35], a[232:235], v[104:107], v[32:35]
 ds_read_b64_tr_b16 a[228:229], v6 offset:49152
 ds_read_b32 v10, v9
 v_add_f32 v15, v15, v56
 v_mfma_f32_16x16x32_bf16 v[40:43], a[232:235], v[108:111], v[40:43]
 ds_read_b64_tr_b16 a[230:231], v6 offset:51200
 v_add_f32 v15, v15, v57
 v_mfma_f32_16x16x32_bf16 v[36:39], a[236:239], v[104:107], v[36:39]
 ds_read_b64_tr_b16 a[232:233], v7 offset:49152
 s_waitcnt lgkmcnt(6)
 v_cvt_pk_bf16_f32 v52, v56, v57
 v_mfma_f32_16x16x32_bf16 v[44:47], a[236:239], v[108:111], v[44:47]
 ds_read_b64_tr_b16 a[234:235], v7 offset:51200
 v_add_f32 v15, v15, v58
 v_mfma_f32_16x16x32_bf16 v[32:35], a[240:243], v[112:115], v[32:35]
 ds_read_b64_tr_b16 a[236:237], v8 offset:49152
 v_add_f32 v15, v15, v59
 v_mfma_f32_16x16x32_bf16 v[40:43], a[240:243], v[116:119], v[40:43]
 ds_read_b64_tr_b16 a[238:239], v8 offset:51200
 v_cvt_pk_bf16_f32 v53, v58, v59
 v_mfma_f32_16x16x32_bf16 v[36:39], a[244:247], v[112:115], v[36:39]
 ds_read_b64_tr_b16 a[240:241], v5 offset:53248
 v_add_f32 v15, v15, v60
 v_mfma_f32_16x16x32_bf16 v[44:47], a[244:247], v[116:119], v[44:47]
 ds_read_b64_tr_b16 a[242:243], v5 offset:55296
 v_add_f32 v15, v15, v61
 v_mfma_f32_16x16x32_bf16 v[32:35], a[248:251], v[120:123], v[32:35]
 ds_read_b64_tr_b16 a[244:245], v6 offset:53248
 v_cvt_pk_bf16_f32 v54, v60, v61
 v_mfma_f32_16x16x32_bf16 v[40:43], a[248:251], v[124:127], v[40:43]
 ds_read_b64_tr_b16 a[246:247], v6 offset:55296
 v_add_f32 v15, v15, v62
 v_mfma_f32_16x16x32_bf16 v[36:39], a[252:255], v[120:123], v[36:39]
 ds_read_b64_tr_b16 a[248:249], v7 offset:53248
 v_add_f32 v15, v15, v63
 v_cvt_pk_bf16_f32 v55, v62, v63
 v_mfma_f32_16x16x32_bf16 v[44:47], a[252:255], v[124:127], v[44:47]
 ds_read_b64_tr_b16 a[250:251], v7 offset:55296
 s_waitcnt lgkmcnt(6)
 s_movk_i32 s70, 148
 buffer_load_dword off, s[72:75], s70 lds
 v_mfma_f32_16x16x32_bf16 v[128:131], a[224:227], v[48:51], v[128:131]
 ds_read_b64_tr_b16 a[252:253], v8 offset:53248
 v_cmp_le_u32 vcc, 48, v10
 v_mfma_f32_16x16x32_bf16 v[136:139], a[224:227], v[52:55], v[136:139]
 ds_read_b64_tr_b16 a[254:255], v8 offset:55296
 v_add_u32 v5, 0x10000, v5
 v_mfma_f32_16x16x32_bf16 v[132:135], a[228:231], v[48:51], v[132:135]
 s_cbranch_vccz L_cs304
L_cb304:
 ds_read_b64_tr_b16 a[224:225], v5 offset:32768
 v_add_u32 v6, 0x10000, v6
 v_mfma_f32_16x16x32_bf16 v[140:143], a[228:231], v[52:55], v[140:143]
 ds_read_b64_tr_b16 a[226:227], v5 offset:34816
 v_add_u32 v7, 0x10000, v7
 v_mfma_f32_16x16x32_bf16 v[144:147], a[232:235], v[48:51], v[144:147]
 ds_read_b64_tr_b16 a[228:229], v6 offset:32768
 v_add_u32 v8, 0x10000, v8
 v_mfma_f32_16x16x32_bf16 v[152:155], a[232:235], v[52:55], v[152:155]
 ds_read_b64_tr_b16 a[230:231], v6 offset:34816
 v_max3_f32 v11, v32, v33, v34
 v_mfma_f32_16x16x32_bf16 v[148:151], a[236:239], v[48:51], v[148:151]
 ds_read_b64_tr_b16 a[232:233], v7 offset:32768
 s_waitcnt lgkmcnt(5)
 v_max3_f32 v12, v40, v41, v42
 v_mfma_f32_16x16x32_bf16 v[156:159], a[236:239], v[52:55], v[156:159]
 ds_read_b64_tr_b16 a[234:235], v7 offset:34816
 v_max3_f32 v11, v11, v35, v36
 v_mfma_f32_16x16x32_bf16 v[160:163], a[240:243], v[48:51], v[160:163]
 ds_read_b64_tr_b16 a[236:237], v8 offset:32768
 v_max3_f32 v12, v12, v43, v44
 v_mfma_f32_16x16x32_bf16 v[168:171], a[240:243], v[52:55], v[168:171]
 ds_read_b64_tr_b16 a[238:239], v8 offset:34816
 v_max3_f32 v11, v11, v37, v38
 v_mfma_f32_16x16x32_bf16 v[164:167], a[244:247], v[48:51], v[164:167]
 ds_read_b64_tr_b16 a[240:241], v5 offset:36864
 v_max3_f32 v12, v12, v45, v46
 v_mfma_f32_16x16x32_bf16 v[172:175], a[244:247], v[52:55], v[172:175]
 ds_read_b64_tr_b16 a[242:243], v5 offset:38912
 v_max_f32 v11, v11, v39
 v_mfma_f32_16x16x32_bf16 v[176:179], a[248:251], v[48:51], v[176:179]
 ds_read_b64_tr_b16 a[244:245], v6 offset:36864
 v_max_f32 v12, v12, v47
 v_mfma_f32_16x16x32_bf16 v[184:187], a[248:251], v[52:55], v[184:187]
 ds_read_b64_tr_b16 a[246:247], v6 offset:38912
 v_max_f32 v13, v11, v12
 v_cmp_lt_f32 vcc, 0x41200000, v13
 v_mfma_f32_16x16x32_bf16 v[180:183], a[252:255], v[48:51], v[180:183]
 ds_read_b64_tr_b16 a[248:249], v7 offset:36864
 s_waitcnt lgkmcnt(5)
 s_cbranch_vccnz L_rs0_2
L_rb0_2:
 v_mfma_f32_16x16x32_bf16 v[188:191], a[252:255], v[52:55], v[188:191]
 ds_read_b64_tr_b16 a[250:251], v7 offset:38912
 v_add_u32 v3, 0x10000, v3
 v_mfma_f32_16x16x32_bf16 v[192:195], a[224:227], v[48:51], v[192:195]
 ds_read_b64_tr_b16 a[252:253], v8 offset:36864
 v_add_u32 v4, 0x10000, v4
 v_mfma_f32_16x16x32_bf16 v[200:203], a[224:227], v[52:55], v[200:203]
 ds_read_b64_tr_b16 a[254:255], v8 offset:38912
 v_mfma_f32_16x16x32_bf16 v[196:199], a[228:231], v[48:51], v[196:199]
 ds_read_b128 a[224:227], v3 offset:40960
 v_mfma_f32_16x16x32_bf16 v[204:207], a[228:231], v[52:55], v[204:207]
 v_exp_f32 v32, v32
 v_mfma_f32_16x16x32_bf16 v[208:211], a[232:235], v[48:51], v[208:211]
 ds_read_b128 a[228:231], v3 offset:43008
 ds_read_b32 v10, v9
 v_mfma_f32_16x16x32_bf16 v[216:219], a[232:235], v[52:55], v[216:219]
 v_exp_f32 v33, v33
 v_mfma_f32_16x16x32_bf16 v[212:215], a[236:239], v[48:51], v[212:215]
 ds_read_b128 a[232:235], v4 offset:40960
 s_waitcnt lgkmcnt(4)
 v_mfma_f32_16x16x32_bf16 v[220:223], a[236:239], v[52:55], v[220:223]
 v_exp_f32 v34, v34
 v_mfma_f32_16x16x32_bf16 v[224:227], a[240:243], v[48:51], v[224:227]
 ds_read_b128 a[236:239], v4 offset:43008
 v_add_f32 v14, v14, v32
 v_mfma_f32_16x16x32_bf16 v[232:235], a[240:243], v[52:55], v[232:235]
 v_exp_f32 v35, v35
 v_mfma_f32_16x16x32_bf16 v[228:231], a[244:247], v[48:51], v[228:231]
 ds_read_b128 a[240:243], v3 offset:45056
 v_add_f32 v14, v14, v33
 v_mfma_f32_16x16x32_bf16 v[236:239], a[244:247], v[52:55], v[236:239]
 v_exp_f32 v36, v36
 v_mfma_f32_16x16x32_bf16 v[240:243], a[248:251], v[48:51], v[240:243]
 ds_read_b128 a[244:247], v3 offset:47104
 s_movk_i32 s70, 156
 v_mfma_f32_16x16x32_bf16 v[248:251], a[248:251], v[52:55], v[248:251]
 v_exp_f32 v37, v37
 v_mfma_f32_16x16x32_bf16 v[244:247], a[252:255], v[48:51], v[244:247]
 ds_read_b128 a[248:251], v4 offset:45056
 s_waitcnt lgkmcnt(3)
 v_mfma_f32_16x16x32_bf16 v[252:255], a[252:255], v[52:55], v[252:255]
 buffer_load_dword off, s[72:75], s70 lds
 v_exp_f32 v38, v38
 v_mfma_f32_16x16x32_bf16 v[48:51], a[224:227], v[64:67], v[16:19]
 ds_read_b128 a[252:255], v4 offset:47104
 v_cmp_le_u32 vcc, 50, v10
 v_exp_f32 v39, v39
 v_mfma_f32_16x16x32_bf16 v[56:59], a[224:227], v[68:71], v[20:23]
 v_exp_f32 v40, v40
 v_mfma_f32_16x16x32_bf16 v[52:55], a[228:231], v[64:67], v[16:19]
 s_cbranch_vccz L_cs320
L_cb320:
 ds_read_b128 a[224:227], v3 offset:57344
 v_mfma_f32_16x16x32_bf16 v[60:63], a[228:231], v[68:71], v[20:23]
 v_exp_f32 v41, v41
 v_mfma_f32_16x16x32_bf16 v[48:51], a[232:235], v[72:75], v[48:51]
 ds_read_b128 a[228:231], v3 offset:59392
 v_cvt_pk_bf16_f32 v32, v32, v33
 v_mfma_f32_16x16x32_bf16 v[56:59], a[232:235], v[76:79], v[56:59]
 v_exp_f32 v42, v42
 v_mfma_f32_16x16x32_bf16 v[52:55], a[236:239], v[72:75], v[52:55]
 ds_read_b128 a[232:235], v4 offset:57344
 s_waitcnt lgkmcnt(3)
 v_mfma_f32_16x16x32_bf16 v[60:63], a[236:239], v[76:79], v[60:63]
 v_exp_f32 v43, v43
 v_mfma_f32_16x16x32_bf16 v[48:51], a[240:243], v[80:83], v[48:51]
 ds_read_b128 a[236:239], v4 offset:59392
 v_add_f32 v14, v14, v34
 v_mfma_f32_16x16x32_bf16 v[56:59], a[240:243], v[84:87], v[56:59]
 v_exp_f32 v44, v44
 v_mfma_f32_16x16x32_bf16 v[52:55], a[244:247], v[80:83], v[52:55]
 ds_read_b128 a[240:243], v3 offset:61440
 v_add_f32 v14, v14, v35
 v_mfma_f32_16x16x32_bf16 v[60:63], a[244:247], v[84:87], v[60:63]
 v_exp_f32 v45, v45
 v_mfma_f32_16x16x32_bf16 v[48:51], a[248:251], v[88:91], v[48:51]
 ds_read_b128 a[244:247], v3 offset:63488
 v_cvt_pk_bf16_f32 v33, v34, v35
 v_mfma_f32_16x16x32_bf16 v[56:59], a[248:251], v[92:95], v[56:59]
 v_exp_f32 v46, v46
 v_mfma_f32_16x16x32_bf16 v[52:55], a[252:255], v[88:91], v[52:55]
 ds_read_b128 a[248:251], v4 offset:61440
 s_waitcnt lgkmcnt(3)
 v_exp_f32 v47, v47
 v_mfma_f32_16x16x32_bf16 v[60:63], a[252:255], v[92:95], v[60:63]
 v_add_f32 v14, v14, v36
 v_add_f32 v14, v14, v37
 v_mfma_f32_16x16x32_bf16 v[48:51], a[224:227], v[96:99], v[48:51]
 ds_read_b128 a[252:255], v4 offset:63488
 v_cvt_pk_bf16_f32 v34, v36, v37
 v_mfma_f32_16x16x32_bf16 v[56:59], a[224:227], v[100:103], v[56:59]
 v_add_f32 v14, v14, v38
 v_add_f32 v14, v14, v39
 v_mfma_f32_16x16x32_bf16 v[52:55], a[228:231], v[96:99], v[52:55]
 ds_read_b64_tr_b16 a[224:225], v5 offset:49152
 v_cvt_pk_bf16_f32 v35, v38, v39
 v_mfma_f32_16x16x32_bf16 v[60:63], a[228:231], v[100:103], v[60:63]
 ds_read_b64_tr_b16 a[226:227], v5 offset:51200
 v_add_f32 v15, v15, v40
 v_mfma_f32_16x16x32_bf16 v[48:51], a[232:235], v[104:107], v[48:51]
 ds_read_b64_tr_b16 a[228:229], v6 offset:49152
 ds_read_b32 v10, v9
 v_mfma_f32_16x16x32_bf16 v[56:59], a[232:235], v[108:111], v[56:59]
 ds_read_b64_tr_b16 a[230:231], v6 offset:51200
 v_add_f32 v15, v15, v41
 v_mfma_f32_16x16x32_bf16 v[52:55], a[236:239], v[104:107], v[52:55]
 ds_read_b64_tr_b16 a[232:233], v7 offset:49152
 s_waitcnt lgkmcnt(6)
 v_cvt_pk_bf16_f32 v36, v40, v41
 v_mfma_f32_16x16x32_bf16 v[60:63], a[236:239], v[108:111], v[60:63]
 ds_read_b64_tr_b16 a[234:235], v7 offset:51200
 v_add_f32 v15, v15, v42
 v_mfma_f32_16x16x32_bf16 v[48:51], a[240:243], v[112:115], v[48:51]
 ds_read_b64_tr_b16 a[236:237], v8 offset:49152
 v_add_f32 v15, v15, v43
 v_mfma_f32_16x16x32_bf16 v[56:59], a[240:243], v[116:119], v[56:59]
 ds_read_b64_tr_b16 a[238:239], v8 offset:51200
 v_cvt_pk_bf16_f32 v37, v42, v43
 v_mfma_f32_16x16x32_bf16 v[52:55], a[244:247], v[112:115], v[52:55]
 ds_read_b64_tr_b16 a[240:241], v5 offset:53248
 v_add_f32 v15, v15, v44
 v_mfma_f32_16x16x32_bf16 v[60:63], a[244:247], v[116:119], v[60:63]
 ds_read_b64_tr_b16 a[242:243], v5 offset:55296
 v_add_f32 v15, v15, v45
 v_mfma_f32_16x16x32_bf16 v[48:51], a[248:251], v[120:123], v[48:51]
 ds_read_b64_tr_b16 a[244:245], v6 offset:53248
 v_cvt_pk_bf16_f32 v38, v44, v45
 v_mfma_f32_16x16x32_bf16 v[56:59], a[248:251], v[124:127], v[56:59]
 ds_read_b64_tr_b16 a[246:247], v6 offset:55296
 v_add_f32 v15, v15, v46
 v_mfma_f32_16x16x32_bf16 v[52:55], a[252:255], v[120:123], v[52:55]
 ds_read_b64_tr_b16 a[248:249], v7 offset:53248
 v_add_f32 v15, v15, v47
 v_cvt_pk_bf16_f32 v39, v46, v47
 v_mfma_f32_16x16x32_bf16 v[60:63], a[252:255], v[124:127], v[60:63]
 ds_read_b64_tr_b16 a[250:251], v7 offset:55296
 s_waitcnt lgkmcnt(6)
 s_movk_i32 s70, 164
 buffer_load_dword off, s[72:75], s70 lds
 v_mfma_f32_16x16x32_bf16 v[128:131], a[224:227], v[32:35], v[128:131]
 ds_read_b64_tr_b16 a[252:253], v8 offset:53248
 v_cmp_le_u32 vcc, 51, v10
 v_mfma_f32_16x16x32_bf16 v[136:139], a[224:227], v[36:39], v[136:139]
 ds_read_b64_tr_b16 a[254:255], v8 offset:55296
 v_add_u32 v5, 0x10000, v5
 v_mfma_f32_16x16x32_bf16 v[132:135], a[228:231], v[32:35], v[132:135]
 s_cbranch_vccz L_cs336
L_cb336:
 ds_read_b64_tr_b16 a[224:225], v5 offset:0
 v_add_u32 v6, 0x10000, v6
 v_mfma_f32_16x16x32_bf16 v[140:143], a[228:231], v[36:39], v[140:143]
 ds_read_b64_tr_b16 a[226:227], v5 offset:2048
 v_add_u32 v7, 0x10000, v7
 v_mfma_f32_16x16x32_bf16 v[144:147], a[232:235], v[32:35], v[144:147]
 ds_read_b64_tr_b16 a[228:229], v6 offset:0
 v_add_u32 v8, 0x10000, v8
 v_mfma_f32_16x16x32_bf16 v[152:155], a[232:235], v[36:39], v[152:155]
 ds_read_b64_tr_b16 a[230:231], v6 offset:2048
 v_max3_f32 v11, v48, v49, v50
 v_mfma_f32_16x16x32_bf16 v[148:151], a[236:239], v[32:35], v[148:151]
 ds_read_b64_tr_b16 a[232:233], v7 offset:0
 s_waitcnt lgkmcnt(5)
 v_max3_f32 v12, v56, v57, v58
 v_mfma_f32_16x16x32_bf16 v[156:159], a[236:239], v[36:39], v[156:159]
 ds_read_b64_tr_b16 a[234:235], v7 offset:2048
 v_max3_f32 v11, v11, v51, v52
 v_mfma_f32_16x16x32_bf16 v[160:163], a[240:243], v[32:35], v[160:163]
 ds_read_b64_tr_b16 a[236:237], v8 offset:0
 v_max3_f32 v12, v12, v59, v60
 v_mfma_f32_16x16x32_bf16 v[168:171], a[240:243], v[36:39], v[168:171]
 ds_read_b64_tr_b16 a[238:239], v8 offset:2048
 v_max3_f32 v11, v11, v53, v54
 v_mfma_f32_16x16x32_bf16 v[164:167], a[244:247], v[32:35], v[164:167]
 ds_read_b64_tr_b16 a[240:241], v5 offset:4096
 v_max3_f32 v12, v12, v61, v62
 v_mfma_f32_16x16x32_bf16 v[172:175], a[244:247], v[36:39], v[172:175]
 ds_read_b64_tr_b16 a[242:243], v5 offset:6144
 v_max_f32 v11, v11, v55
 v_mfma_f32_16x16x32_bf16 v[176:179], a[248:251], v[32:35], v[176:179]
 ds_read_b64_tr_b16 a[244:245], v6 offset:4096
 v_max_f32 v12, v12, v63
 v_mfma_f32_16x16x32_bf16 v[184:187], a[248:251], v[36:39], v[184:187]
 ds_read_b64_tr_b16 a[246:247], v6 offset:6144
 v_max_f32 v13, v11, v12
 v_cmp_lt_f32 vcc, 0x41200000, v13
 v_mfma_f32_16x16x32_bf16 v[180:183], a[252:255], v[32:35], v[180:183]
 ds_read_b64_tr_b16 a[248:249], v7 offset:4096
 s_waitcnt lgkmcnt(5)
 s_cbranch_vccnz L_rs0_3
L_rb0_3:
 v_mfma_f32_16x16x32_bf16 v[188:191], a[252:255], v[36:39], v[188:191]
 ds_read_b64_tr_b16 a[250:251], v7 offset:6144
 v_mfma_f32_16x16x32_bf16 v[192:195], a[224:227], v[32:35], v[192:195]
 ds_read_b64_tr_b16 a[252:253], v8 offset:4096
 v_mfma_f32_16x16x32_bf16 v[200:203], a[224:227], v[36:39], v[200:203]
 ds_read_b64_tr_b16 a[254:255], v8 offset:6144
 v_mfma_f32_16x16x32_bf16 v[196:199], a[228:231], v[32:35], v[196:199]
 ds_read_b64_tr_b16 a[224:225], v24 offset:32768
 v_mfma_f32_16x16x32_bf16 v[204:207], a[228:231], v[36:39], v[204:207]
 ds_read_b64_tr_b16 a[226:227], v24 offset:34816
 v_mfma_f32_16x16x32_bf16 v[208:211], a[232:235], v[32:35], v[208:211]
 ds_read_b64_tr_b16 a[228:229], v24 offset:32776
 ds_read_b32 v10, v9
 v_mfma_f32_16x16x32_bf16 v[216:219], a[232:235], v[36:39], v[216:219]
 ds_read_b64_tr_b16 a[230:231], v24 offset:34824
 v_mfma_f32_16x16x32_bf16 v[212:215], a[236:239], v[32:35], v[212:215]
 ds_read_b64_tr_b16 a[232:233], v25 offset:32768
 s_waitcnt lgkmcnt(6)
 v_mfma_f32_16x16x32_bf16 v[220:223], a[236:239], v[36:39], v[220:223]
 ds_read_b64_tr_b16 a[234:235], v25 offset:34816
 v_mfma_f32_16x16x32_bf16 v[224:227], a[240:243], v[32:35], v[224:227]
 ds_read_b64_tr_b16 a[236:237], v25 offset:32776
 v_mfma_f32_16x16x32_bf16 v[232:235], a[240:243], v[36:39], v[232:235]
 ds_read_b64_tr_b16 a[238:239], v25 offset:34824
 v_mfma_f32_16x16x32_bf16 v[228:231], a[244:247], v[32:35], v[228:231]
 ds_read_b64_tr_b16 a[240:241], v24 offset:36864
 v_add_u32 v3, 0x10000, v3
 v_mfma_f32_16x16x32_bf16 v[236:239], a[244:247], v[36:39], v[236:239]
 ds_read_b64_tr_b16 a[242:243], v24 offset:38912
 s_movk_i32 s70, 172
 v_mfma_f32_16x16x32_bf16 v[240:243], a[248:251], v[32:35], v[240:243]
 ds_read_b64_tr_b16 a[244:245], v24 offset:36872
 v_mfma_f32_16x16x32_bf16 v[248:251], a[248:251], v[36:39], v[248:251]
 ds_read_b64_tr_b16 a[246:247], v24 offset:38920
 v_mfma_f32_16x16x32_bf16 v[244:247], a[252:255], v[32:35], v[244:247]
 ds_read_b64_tr_b16 a[248:249], v25 offset:36864
 s_waitcnt lgkmcnt(5)
 v_mfma_f32_16x16x32_bf16 v[252:255], a[252:255], v[36:39], v[252:255]
 ds_read_b64_tr_b16 a[250:251], v25 offset:38912
 v_add_u32 v4, 0x10000, v4
 v_mfma_f32_16x16x32_bf16 a[176:179], a[224:227], a[16:19], a[176:179]
 ds_read_b64_tr_b16 a[252:253], v25 offset:36872
 buffer_load_dword off, s[72:75], s70 lds
 v_cmp_le_u32 vcc, 52, v10
 v_mfma_f32_16x16x32_bf16 a[184:187], a[224:227], a[20:23], a[184:187]
 ds_read_b64_tr_b16 a[254:255], v25 offset:38920
 v_mfma_f32_16x16x32_bf16 a[180:183], a[228:231], a[16:19], a[180:183]
 s_cbranch_vccz L_cs352
L_cb352:
 ds_read_b64_tr_b16 a[224:225], v24 offset:0
 v_mfma_f32_16x16x32_bf16 a[188:191], a[228:231], a[20:23], a[188:191]
 ds_read_b64_tr_b16 a[226:227], v24 offset:2048
 v_mfma_f32_16x16x32_bf16 a[192:195], a[232:235], a[16:19], a[192:195]
 ds_read_b64_tr_b16 a[228:229], v24 offset:8
 ds_read_b32 v10, v9
 v_mfma_f32_16x16x32_bf16 a[200:203], a[232:235], a[20:23], a[200:203]
 ds_read_b64_tr_b16 a[230:231], v24 offset:2056
 v_mfma_f32_16x16x32_bf16 a[196:199], a[236:239], a[16:19], a[196:199]
 ds_read_b64_tr_b16 a[232:233], v25 offset:0
 s_waitcnt lgkmcnt(6)
 v_mfma_f32_16x16x32_bf16 a[204:207], a[236:239], a[20:23], a[204:207]
 ds_read_b64_tr_b16 a[234:235], v25 offset:2048
 v_mfma_f32_16x16x32_bf16 a[176:179], a[240:243], a[24:27], a[176:179]
 ds_read_b64_tr_b16 a[236:237], v25 offset:8
 v_mfma_f32_16x16x32_bf16 a[184:187], a[240:243], a[28:31], a[184:187]
 ds_read_b64_tr_b16 a[238:239], v25 offset:2056
 v_mfma_f32_16x16x32_bf16 a[180:183], a[244:247], a[24:27], a[180:183]
 ds_read_b64_tr_b16 a[240:241], v24 offset:4096
 v_mfma_f32_16x16x32_bf16 a[188:191], a[244:247], a[28:31], a[188:191]
 ds_read_b64_tr_b16 a[242:243], v24 offset:6144
 v_mfma_f32_16x16x32_bf16 a[192:195], a[248:251], a[24:27], a[192:195]
 ds_read_b64_tr_b16 a[244:245], v24 offset:4104
 v_mfma_f32_16x16x32_bf16 a[200:203], a[248:251], a[28:31], a[200:203]
 ds_read_b64_tr_b16 a[246:247], v24 offset:6152
 v_mfma_f32_16x16x32_bf16 a[196:199], a[252:255], a[24:27], a[196:199]
 ds_read_b64_tr_b16 a[248:249], v25 offset:4096
 s_waitcnt lgkmcnt(5)
 v_mfma_f32_16x16x32_bf16 a[204:207], a[252:255], a[28:31], a[204:207]
 ds_read_b64_tr_b16 a[250:251], v25 offset:6144
 v_mfma_f32_16x16x32_bf16 a[176:179], a[224:227], a[32:35], a[176:179]
 ds_read_b64_tr_b16 a[252:253], v25 offset:4104
 v_cmp_le_u32 vcc, 56, v10
 v_mfma_f32_16x16x32_bf16 a[184:187], a[224:227], a[36:39], a[184:187]
 ds_read_b64_tr_b16 a[254:255], v25 offset:6152
 v_mfma_f32_16x16x32_bf16 a[180:183], a[228:231], a[32:35], a[180:183]
 s_cbranch_vccz L_cs360
L_cb360:
 ds_read_b128 a[224:227], v3 offset:8192
 v_mfma_f32_16x16x32_bf16 a[188:191], a[228:231], a[36:39], a[188:191]
 v_exp_f32 v48, v48
 v_mfma_f32_16x16x32_bf16 a[192:195], a[232:235], a[32:35], a[192:195]
 ds_read_b128 a[228:231], v3 offset:10240
 v_add_f32 v14, v14, v48
 v_mfma_f32_16x16x32_bf16 a[200:203], a[232:235], a[36:39], a[200:203]
 v_exp_f32 v49, v49
 v_mfma_f32_16x16x32_bf16 a[196:199], a[236:239], a[32:35], a[196:199]
 ds_read_b128 a[232:235], v4 offset:8192
 s_waitcnt lgkmcnt(3)
 v_mfma_f32_16x16x32_bf16 a[204:207], a[236:239], a[36:39], a[204:207]
 v_exp_f32 v50, v50
 v_mfma_f32_16x16x32_bf16 a[176:179], a[240:243], a[40:43], a[176:179]
 ds_read_b128 a[236:239], v4 offset:10240
 v_add_f32 v14, v14, v49
 v_mfma_f32_16x16x32_bf16 a[184:187], a[240:243], a[44:47], a[184:187]
 v_exp_f32 v51, v51
 v_mfma_f32_16x16x32_bf16 a[180:183], a[244:247], a[40:43], a[180:183]
 ds_read_b128 a[240:243], v3 offset:12288
 v_cvt_pk_bf16_f32 v48, v48, v49
 v_mfma_f32_16x16x32_bf16 a[188:191], a[244:247], a[44:47], a[188:191]
 v_exp_f32 v52, v52
 v_mfma_f32_16x16x32_bf16 a[192:195], a[248:251], a[40:43], a[192:195]
 ds_read_b128 a[244:247], v3 offset:14336
 s_movk_i32 s70, 180
 v_mfma_f32_16x16x32_bf16 a[200:203], a[248:251], a[44:47], a[200:203]
 v_exp_f32 v53, v53
 v_mfma_f32_16x16x32_bf16 a[196:199], a[252:255], a[40:43], a[196:199]
 ds_read_b128 a[248:251], v4 offset:12288
 s_waitcnt lgkmcnt(3)
 v_mfma_f32_16x16x32_bf16 a[204:207], a[252:255], a[44:47], a[204:207]
 buffer_load_dword off, s[72:75], s70 lds
 v_add_u32 v3, 0xffff0000, v3
 v_mfma_f32_16x16x32_bf16 v[32:35], a[224:227], v[64:67], v[16:19]
 ds_read_b128 a[252:255], v4 offset:14336
 v_add_u32 v4, 0xffff0000, v4
 v_exp_f32 v54, v54
 v_mfma_f32_16x16x32_bf16 v[40:43], a[224:227], v[68:71], v[20:23]
 v_exp_f32 v55, v55
 v_mfma_f32_16x16x32_bf16 v[36:39], a[228:231], v[64:67], v[16:19]
 ds_read_b128 a[224:227], v3 offset:8192
 v_add_f32 v14, v14, v50
 v_mfma_f32_16x16x32_bf16 v[44:47], a[228:231], v[68:71], v[20:23]
 v_exp_f32 v56, v56
 v_mfma_f32_16x16x32_bf16 v[32:35], a[232:235], v[72:75], v[32:35]
 ds_read_b128 a[228:231], v3 offset:10240
 v_add_f32 v14, v14, v51
 v_mfma_f32_16x16x32_bf16 v[40:43], a[232:235], v[76:79], v[40:43]
 v_exp_f32 v57, v57
 v_mfma_f32_16x16x32_bf16 v[36:39], a[236:239], v[72:75], v[36:39]
 ds_read_b128 a[232:235], v4 offset:8192
 s_waitcnt lgkmcnt(3)
 v_mfma_f32_16x16x32_bf16 v[44:47], a[236:239], v[76:79], v[44:47]
 v_exp_f32 v58, v58
 v_mfma_f32_16x16x32_bf16 v[32:35], a[240:243], v[80:83], v[32:35]
 ds_read_b128 a[236:239], v4 offset:10240
 v_cvt_pk_bf16_f32 v49, v50, v51
 v_mfma_f32_16x16x32_bf16 v[40:43], a[240:243], v[84:87], v[40:43]
 v_exp_f32 v59, v59
 v_mfma_f32_16x16x32_bf16 v[36:39], a[244:247], v[80:83], v[36:39]
 ds_read_b128 a[240:243], v3 offset:12288
 v_add_f32 v14, v14, v52
 v_mfma_f32_16x16x32_bf16 v[44:47], a[244:247], v[84:87], v[44:47]
 v_exp_f32 v60, v60
 v_mfma_f32_16x16x32_bf16 v[32:35], a[248:251], v[88:91], v[32:35]
 ds_read_b128 a[244:247], v3 offset:14336
 v_add_f32 v14, v14, v53
 v_mfma_f32_16x16x32_bf16 v[40:43], a[248:251], v[92:95], v[40:43]
 v_exp_f32 v61, v61
 v_mfma_f32_16x16x32_bf16 v[36:39], a[252:255], v[88:91], v[36:39]
 ds_read_b128 a[248:251], v4 offset:12288
 s_waitcnt lgkmcnt(3)
 v_exp_f32 v62, v62
 v_mfma_f32_16x16x32_bf16 v[44:47], a[252:255], v[92:95], v[44:47]
 v_exp_f32 v63, v63
 v_mfma_f32_16x16x32_bf16 v[32:35], a[224:227], v[96:99], v[32:35]
 ds_read_b128 a[252:255], v4 offset:14336
 v_cvt_pk_bf16_f32 v50, v52, v53
 v_mfma_f32_16x16x32_bf16 v[40:43], a[224:227], v[100:103], v[40:43]
 v_add_f32 v14, v14, v54
 v_add_f32 v14, v14, v55
 v_mfma_f32_16x16x32_bf16 v[36:39], a[228:231], v[96:99], v[36:39]
 ds_read_b64_tr_b16 a[224:225], v5 offset:16384
 v_cvt_pk_bf16_f32 v51, v54, v55
 v_mfma_f32_16x16x32_bf16 v[44:47], a[228:231], v[100:103], v[44:47]
 ds_read_b64_tr_b16 a[226:227], v5 offset:18432
 v_add_f32 v15, v15, v56
 v_mfma_f32_16x16x32_bf16 v[32:35], a[232:235], v[104:107], v[32:35]
 ds_read_b64_tr_b16 a[228:229], v6 offset:16384
 ds_read_b32 v10, v9
 v_mfma_f32_16x16x32_bf16 v[40:43], a[232:235], v[108:111], v[40:43]
 ds_read_b64_tr_b16 a[230:231], v6 offset:18432
 v_add_f32 v15, v15, v57
 v_mfma_f32_16x16x32_bf16 v[36:39], a[236:239], v[104:107], v[36:39]
 ds_read_b64_tr_b16 a[232:233], v7 offset:16384
 s_waitcnt lgkmcnt(6)
 v_cvt_pk_bf16_f32 v52, v56, v57
 v_mfma_f32_16x16x32_bf16 v[44:47], a[236:239], v[108:111], v[44:47]
 ds_read_b64_tr_b16 a[234:235], v7 offset:18432
 v_add_f32 v15, v15, v58
 v_mfma_f32_16x16x32_bf16 v[32:35], a[240:243], v[112:115], v[32:35]
 ds_read_b64_tr_b16 a[236:237], v8 offset:16384
 v_add_f32 v15, v15, v59
 v_mfma_f32_16x16x32_bf16 v[40:43], a[240:243], v[116:119], v[40:43]
 ds_read_b64_tr_b16 a[238:239], v8 offset:18432
 v_cvt_pk_bf16_f32 v53, v58, v59
 v_mfma_f32_16x16x32_bf16 v[36:39], a[244:247], v[112:115], v[36:39]
 ds_read_b64_tr_b16 a[240:241], v5 offset:20480
 v_add_f32 v15, v15, v60
 v_mfma_f32_16x16x32_bf16 v[44:47], a[244:247], v[116:119], v[44:47]
 ds_read_b64_tr_b16 a[242:243], v5 offset:22528
 v_add_f32 v15, v15, v61
 v_mfma_f32_16x16x32_bf16 v[32:35], a[248:251], v[120:123], v[32:35]
 ds_read_b64_tr_b16 a[244:245], v6 offset:20480
 v_cvt_pk_bf16_f32 v54, v60, v61
 v_mfma_f32_16x16x32_bf16 v[40:43], a[248:251], v[124:127], v[40:43]
 ds_read_b64_tr_b16 a[246:247], v6 offset:22528
 v_add_f32 v15, v15, v62
 v_mfma_f32_16x16x32_bf16 v[36:39], a[252:255], v[120:123], v[36:39]
 ds_read_b64_tr_b16 a[248:249], v7 offset:20480
 v_add_f32 v15, v15, v63
 v_cvt_pk_bf16_f32 v55, v62, v63
 v_mfma_f32_16x16x32_bf16 v[44:47], a[252:255], v[124:127], v[44:47]
 ds_read_b64_tr_b16 a[250:251], v7 offset:22528
 s_waitcnt lgkmcnt(6)
 s_movk_i32 s70, 188
 buffer_load_dword off, s[72:75], s70 lds
 v_mfma_f32_16x16x32_bf16 v[128:131], a[224:227], v[48:51], v[128:131]
 ds_read_b64_tr_b16 a[252:253], v8 offset:20480
 v_cmp_le_u32 vcc, 57, v10
 v_mfma_f32_16x16x32_bf16 v[136:139], a[224:227], v[52:55], v[136:139]
 ds_read_b64_tr_b16 a[254:255], v8 offset:22528
 v_add_u32 v5, 0xffff0000, v5
 v_mfma_f32_16x16x32_bf16 v[132:135], a[228:231], v[48:51], v[132:135]
 s_cbranch_vccz L_cs384
L_cb384:
 ds_read_b64_tr_b16 a[224:225], v5 offset:0
 v_add_u32 v6, 0xffff0000, v6
 v_mfma_f32_16x16x32_bf16 v[140:143], a[228:231], v[52:55], v[140:143]
 ds_read_b64_tr_b16 a[226:227], v5 offset:2048
 v_add_u32 v7, 0xffff0000, v7
 v_mfma_f32_16x16x32_bf16 v[144:147], a[232:235], v[48:51], v[144:147]
 ds_read_b64_tr_b16 a[228:229], v6 offset:0
 v_add_u32 v8, 0xffff0000, v8
 v_mfma_f32_16x16x32_bf16 v[152:155], a[232:235], v[52:55], v[152:155]
 ds_read_b64_tr_b16 a[230:231], v6 offset:2048
 v_max3_f32 v11, v32, v33, v34
 v_mfma_f32_16x16x32_bf16 v[148:151], a[236:239], v[48:51], v[148:151]
 ds_read_b64_tr_b16 a[232:233], v7 offset:0
 s_waitcnt lgkmcnt(5)
 v_max3_f32 v12, v40, v41, v42
 v_mfma_f32_16x16x32_bf16 v[156:159], a[236:239], v[52:55], v[156:159]
 ds_read_b64_tr_b16 a[234:235], v7 offset:2048
 v_max3_f32 v11, v11, v35, v36
 v_mfma_f32_16x16x32_bf16 v[160:163], a[240:243], v[48:51], v[160:163]
 ds_read_b64_tr_b16 a[236:237], v8 offset:0
 v_max3_f32 v12, v12, v43, v44
 v_mfma_f32_16x16x32_bf16 v[168:171], a[240:243], v[52:55], v[168:171]
 ds_read_b64_tr_b16 a[238:239], v8 offset:2048
 v_max3_f32 v11, v11, v37, v38
 v_mfma_f32_16x16x32_bf16 v[164:167], a[244:247], v[48:51], v[164:167]
 ds_read_b64_tr_b16 a[240:241], v5 offset:4096
 v_max3_f32 v12, v12, v45, v46
 v_mfma_f32_16x16x32_bf16 v[172:175], a[244:247], v[52:55], v[172:175]
 ds_read_b64_tr_b16 a[242:243], v5 offset:6144
 v_max_f32 v11, v11, v39
 v_mfma_f32_16x16x32_bf16 v[176:179], a[248:251], v[48:51], v[176:179]
 ds_read_b64_tr_b16 a[244:245], v6 offset:4096
 v_max_f32 v12, v12, v47
 v_mfma_f32_16x16x32_bf16 v[184:187], a[248:251], v[52:55], v[184:187]
 ds_read_b64_tr_b16 a[246:247], v6 offset:6144
 v_max_f32 v13, v11, v12
 v_cmp_lt_f32 vcc, 0x41200000, v13
 v_mfma_f32_16x16x32_bf16 v[180:183], a[252:255], v[48:51], v[180:183]
 ds_read_b64_tr_b16 a[248:249], v7 offset:4096
 s_waitcnt lgkmcnt(5)
 s_cbranch_vccnz L_rs0_4
L_rb0_4:
 v_mfma_f32_16x16x32_bf16 v[188:191], a[252:255], v[52:55], v[188:191]
 ds_read_b64_tr_b16 a[250:251], v7 offset:6144
 v_mfma_f32_16x16x32_bf16 v[192:195], a[224:227], v[48:51], v[192:195]
 ds_read_b64_tr_b16 a[252:253], v8 offset:4096
 v_mfma_f32_16x16x32_bf16 v[200:203], a[224:227], v[52:55], v[200:203]
 ds_read_b64_tr_b16 a[254:255], v8 offset:6144
 v_mfma_f32_16x16x32_bf16 v[196:199], a[228:231], v[48:51], v[196:199]
 ds_read_b64_tr_b16 a[224:225], v24 offset:8192
 v_mfma_f32_16x16x32_bf16 v[204:207], a[228:231], v[52:55], v[204:207]
 ds_read_b64_tr_b16 a[226:227], v24 offset:10240
 v_mfma_f32_16x16x32_bf16 v[208:211], a[232:235], v[48:51], v[208:211]
 ds_read_b64_tr_b16 a[228:229], v24 offset:8200
 ds_read_b32 v10, v9
 v_mfma_f32_16x16x32_bf16 v[216:219], a[232:235], v[52:55], v[216:219]
 ds_read_b64_tr_b16 a[230:231], v24 offset:10248
 v_mfma_f32_16x16x32_bf16 v[212:215], a[236:239], v[48:51], v[212:215]
 ds_read_b64_tr_b16 a[232:233], v25 offset:8192
 s_waitcnt lgkmcnt(6)
 v_mfma_f32_16x16x32_bf16 v[220:223], a[236:239], v[52:55], v[220:223]
 ds_read_b64_tr_b16 a[234:235], v25 offset:10240
 v_mfma_f32_16x16x32_bf16 v[224:227], a[240:243], v[48:51], v[224:227]
 ds_read_b64_tr_b16 a[236:237], v25 offset:8200
 v_mfma_f32_16x16x32_bf16 v[232:235], a[240:243], v[52:55], v[232:235]
 ds_read_b64_tr_b16 a[238:239], v25 offset:10248
 v_mfma_f32_16x16x32_bf16 v[228:231], a[244:247], v[48:51], v[228:231]
 ds_read_b64_tr_b16 a[240:241], v24 offset:12288
 v_mfma_f32_16x16x32_bf16 v[236:239], a[244:247], v[52:55], v[236:239]
 ds_read_b64_tr_b16 a[242:243], v24 offset:14336
 s_movk_i32 s70, 196
 v_mfma_f32_16x16x32_bf16 v[240:243], a[248:251], v[48:51], v[240:243]
 ds_read_b64_tr_b16 a[244:245], v24 offset:12296
 v_mfma_f32_16x16x32_bf16 v[248:251], a[248:251], v[52:55], v[248:251]
 ds_read_b64_tr_b16 a[246:247], v24 offset:14344
 v_mfma_f32_16x16x32_bf16 v[244:247], a[252:255], v[48:51], v[244:247]
 ds_read_b64_tr_b16 a[248:249], v25 offset:12288
 s_waitcnt lgkmcnt(5)
 v_mfma_f32_16x16x32_bf16 v[252:255], a[252:255], v[52:55], v[252:255]
 ds_read_b64_tr_b16 a[250:251], v25 offset:14336
 buffer_load_dword off, s[72:75], s70 lds
 v_mfma_f32_16x16x32_bf16 a[176:179], a[224:227], a[48:51], a[176:179]
 ds_read_b64_tr_b16 a[252:253], v25 offset:12296
 v_cmp_le_u32 vcc, 58, v10
 v_mfma_f32_16x16x32_bf16 a[184:187], a[224:227], a[52:55], a[184:187]
 ds_read_b64_tr_b16 a[254:255], v25 offset:14344
 v_mfma_f32_16x16x32_bf16 a[180:183], a[228:231], a[48:51], a[180:183]
 s_cbranch_vccz L_cs400
L_cb400:
 ds_read_b64_tr_b16 a[224:225], v24 offset:16384
 v_mfma_f32_16x16x32_bf16 a[188:191], a[228:231], a[52:55], a[188:191]
 ds_read_b64_tr_b16 a[226:227], v24 offset:18432
 v_mfma_f32_16x16x32_bf16 a[192:195], a[232:235], a[48:51], a[192:195]
 ds_read_b64_tr_b16 a[228:229], v24 offset:16392
 ds_read_b32 v10, v9
 v_mfma_f32_16x16x32_bf16 a[200:203], a[232:235], a[52:55], a[200:203]
 ds_read_b64_tr_b16 a[230:231], v24 offset:18440
 v_mfma_f32_16x16x32_bf16 a[196:199], a[236:239], a[48:51], a[196:199]
 ds_read_b64_tr_b16 a[232:233], v25 offset:16384
 s_waitcnt lgkmcnt(6)
 v_mfma_f32_16x16x32_bf16 a[204:207], a[236:239], a[52:55], a[204:207]
 ds_read_b64_tr_b16 a[234:235], v25 offset:18432
 v_mfma_f32_16x16x32_bf16 a[176:179], a[240:243], a[56:59], a[176:179]
 ds_read_b64_tr_b16 a[236:237], v25 offset:16392
 v_mfma_f32_16x16x32_bf16 a[184:187], a[240:243], a[60:63], a[184:187]
 ds_read_b64_tr_b16 a[238:239], v25 offset:18440
 v_mfma_f32_16x16x32_bf16 a[180:183], a[244:247], a[56:59], a[180:183]
 ds_read_b64_tr_b16 a[240:241], v24 offset:20480
 v_mfma_f32_16x16x32_bf16 a[188:191], a[244:247], a[60:63], a[188:191]
 ds_read_b64_tr_b16 a[242:243], v24 offset:22528
 v_mfma_f32_16x16x32_bf16 a[192:195], a[248:251], a[56:59], a[192:195]
 ds_read_b64_tr_b16 a[244:245], v24 offset:20488
 v_mfma_f32_16x16x32_bf16 a[200:203], a[248:251], a[60:63], a[200:203]
 ds_read_b64_tr_b16 a[246:247], v24 offset:22536
 v_mfma_f32_16x16x32_bf16 a[196:199], a[252:255], a[56:59], a[196:199]
 ds_read_b64_tr_b16 a[248:249], v25 offset:20480
 s_waitcnt lgkmcnt(5)
 v_mfma_f32_16x16x32_bf16 a[204:207], a[252:255], a[60:63], a[204:207]
 ds_read_b64_tr_b16 a[250:251], v25 offset:22528
 v_mfma_f32_16x16x32_bf16 a[176:179], a[224:227], a[64:67], a[176:179]
 ds_read_b64_tr_b16 a[252:253], v25 offset:20488
 v_cmp_le_u32 vcc, 62, v10
 v_mfma_f32_16x16x32_bf16 a[184:187], a[224:227], a[68:71], a[184:187]
 ds_read_b64_tr_b16 a[254:255], v25 offset:22536
 v_mfma_f32_16x16x32_bf16 a[180:183], a[228:231], a[64:67], a[180:183]
 s_cbranch_vccz L_cs408
L_cb408:
 ds_read_b128 a[224:227], v3 offset:16384
 v_mfma_f32_16x16x32_bf16 a[188:191], a[228:231], a[68:71], a[188:191]
 v_exp_f32 v32, v32
 v_mfma_f32_16x16x32_bf16 a[192:195], a[232:235], a[64:67], a[192:195]
 ds_read_b128 a[228:231], v3 offset:18432
 v_add_f32 v14, v14, v32
 v_mfma_f32_16x16x32_bf16 a[200:203], a[232:235], a[68:71], a[200:203]
 v_exp_f32 v33, v33
 v_mfma_f32_16x16x32_bf16 a[196:199], a[236:239], a[64:67], a[196:199]
 ds_read_b128 a[232:235], v4 offset:16384
 s_waitcnt lgkmcnt(3)
 v_mfma_f32_16x16x32_bf16 a[204:207], a[236:239], a[68:71], a[204:207]
 v_exp_f32 v34, v34
 v_mfma_f32_16x16x32_bf16 a[176:179], a[240:243], a[72:75], a[176:179]
 ds_read_b128 a[236:239], v4 offset:18432
 v_add_f32 v14, v14, v33
 v_mfma_f32_16x16x32_bf16 a[184:187], a[240:243], a[76:79], a[184:187]
 v_exp_f32 v35, v35
 v_mfma_f32_16x16x32_bf16 a[180:183], a[244:247], a[72:75], a[180:183]
 ds_read_b128 a[240:243], v3 offset:20480
 v_cvt_pk_bf16_f32 v32, v32, v33
 v_mfma_f32_16x16x32_bf16 a[188:191], a[244:247], a[76:79], a[188:191]
 v_exp_f32 v36, v36
 v_mfma_f32_16x16x32_bf16 a[192:195], a[248:251], a[72:75], a[192:195]
 ds_read_b128 a[244:247], v3 offset:22528
 s_movk_i32 s70, 204
 v_mfma_f32_16x16x32_bf16 a[200:203], a[248:251], a[76:79], a[200:203]
 v_exp_f32 v37, v37
 v_mfma_f32_16x16x32_bf16 a[196:199], a[252:255], a[72:75], a[196:199]
 ds_read_b128 a[248:251], v4 offset:20480
 s_waitcnt lgkmcnt(3)
 v_mfma_f32_16x16x32_bf16 a[204:207], a[252:255], a[76:79], a[204:207]
 buffer_load_dword off, s[72:75], s70 lds
 v_add_u32 v3, 0xffff0000, v3
 v_mfma_f32_16x16x32_bf16 v[48:51], a[224:227], v[64:67], v[16:19]
 ds_read_b128 a[252:255], v4 offset:22528
 v_add_u32 v4, 0xffff0000, v4
 v_exp_f32 v38, v38
 v_mfma_f32_16x16x32_bf16 v[56:59], a[224:227], v[68:71], v[20:23]
 v_exp_f32 v39, v39
 v_mfma_f32_16x16x32_bf16 v[52:55], a[228:231], v[64:67], v[16:19]
 ds_read_b128 a[224:227], v3 offset:57344
 v_add_f32 v14, v14, v34
 v_mfma_f32_16x16x32_bf16 v[60:63], a[228:231], v[68:71], v[20:23]
 v_exp_f32 v40, v40
 v_mfma_f32_16x16x32_bf16 v[48:51], a[232:235], v[72:75], v[48:51]
 ds_read_b128 a[228:231], v3 offset:59392
 v_add_f32 v14, v14, v35
 v_mfma_f32_16x16x32_bf16 v[56:59], a[232:235], v[76:79], v[56:59]
 v_exp_f32 v41, v41
 v_mfma_f32_16x16x32_bf16 v[52:55], a[236:239], v[72:75], v[52:55]
 ds_read_b128 a[232:235], v4 offset:57344
 s_waitcnt lgkmcnt(3)
 v_mfma_f32_16x16x32_bf16 v[60:63], a[236:239], v[76:79], v[60:63]
 v_exp_f32 v42, v42
 v_mfma_f32_16x16x32_bf16 v[48:51], a[240:243], v[80:83], v[48:51]
 ds_read_b128 a[236:239], v4 offset:59392
 v_cvt_pk_bf16_f32 v33, v34, v35
 v_mfma_f32_16x16x32_bf16 v[56:59], a[240:243], v[84:87], v[56:59]
 v_exp_f32 v43, v43
 v_mfma_f32_16x16x32_bf16 v[52:55], a[244:247], v[80:83], v[52:55]
 ds_read_b128 a[240:243], v3 offset:61440
 v_add_f32 v14, v14, v36
 v_mfma_f32_16x16x32_bf16 v[60:63], a[244:247], v[84:87], v[60:63]
 v_exp_f32 v44, v44
 v_mfma_f32_16x16x32_bf16 v[48:51], a[248:251], v[88:91], v[48:51]
 ds_read_b128 a[244:247], v3 offset:63488
 v_add_f32 v14, v14, v37
 v_mfma_f32_16x16x32_bf16 v[56:59], a[248:251], v[92:95], v[56:59]
 v_exp_f32 v45, v45
 v_mfma_f32_16x16x32_bf16 v[52:55], a[252:255], v[88:91], v[52:55]
 ds_read_b128 a[248:251], v4 offset:61440
 s_waitcnt lgkmcnt(3)
 v_exp_f32 v46, v46
 v_mfma_f32_16x16x32_bf16 v[60:63], a[252:255], v[92:95], v[60:63]
 v_exp_f32 v47, v47
 v_mfma_f32_16x16x32_bf16 v[48:51], a[224:227], v[96:99], v[48:51]
 ds_read_b128 a[252:255], v4 offset:63488
 v_cvt_pk_bf16_f32 v34, v36, v37
 v_mfma_f32_16x16x32_bf16 v[56:59], a[224:227], v[100:103], v[56:59]
 v_add_f32 v14, v14, v38
 v_add_f32 v14, v14, v39
 v_mfma_f32_16x16x32_bf16 v[52:55], a[228:231], v[96:99], v[52:55]
 ds_read_b64_tr_b16 a[224:225], v5 offset:24576
 v_cvt_pk_bf16_f32 v35, v38, v39
 v_mfma_f32_16x16x32_bf16 v[60:63], a[228:231], v[100:103], v[60:63]
 ds_read_b64_tr_b16 a[226:227], v5 offset:26624
 v_add_f32 v15, v15, v40
 v_mfma_f32_16x16x32_bf16 v[48:51], a[232:235], v[104:107], v[48:51]
 ds_read_b64_tr_b16 a[228:229], v6 offset:24576
 ds_read_b32 v10, v9
 v_mfma_f32_16x16x32_bf16 v[56:59], a[232:235], v[108:111], v[56:59]
 ds_read_b64_tr_b16 a[230:231], v6 offset:26624
 v_add_f32 v15, v15, v41
 v_mfma_f32_16x16x32_bf16 v[52:55], a[236:239], v[104:107], v[52:55]
 ds_read_b64_tr_b16 a[232:233], v7 offset:24576
 s_waitcnt lgkmcnt(6)
 v_cvt_pk_bf16_f32 v36, v40, v41
 v_mfma_f32_16x16x32_bf16 v[60:63], a[236:239], v[108:111], v[60:63]
 ds_read_b64_tr_b16 a[234:235], v7 offset:26624
 v_add_f32 v15, v15, v42
 v_mfma_f32_16x16x32_bf16 v[48:51], a[240:243], v[112:115], v[48:51]
 ds_read_b64_tr_b16 a[236:237], v8 offset:24576
 v_add_f32 v15, v15, v43
 v_mfma_f32_16x16x32_bf16 v[56:59], a[240:243], v[116:119], v[56:59]
 ds_read_b64_tr_b16 a[238:239], v8 offset:26624
 v_cvt_pk_bf16_f32 v37, v42, v43
 v_mfma_f32_16x16x32_bf16 v[52:55], a[244:247], v[112:115], v[52:55]
 ds_read_b64_tr_b16 a[240:241], v5 offset:28672
 v_add_f32 v15, v15, v44
 v_mfma_f32_16x16x32_bf16 v[60:63], a[244:247], v[116:119], v[60:63]
 ds_read_b64_tr_b16 a[242:243], v5 offset:30720
 v_add_f32 v15, v15, v45
 v_mfma_f32_16x16x32_bf16 v[48:51], a[248:251], v[120:123], v[48:51]
 ds_read_b64_tr_b16 a[244:245], v6 offset:28672
 v_cvt_pk_bf16_f32 v38, v44, v45
 v_mfma_f32_16x16x32_bf16 v[56:59], a[248:251], v[124:127], v[56:59]
 ds_read_b64_tr_b16 a[246:247], v6 offset:30720
 v_add_f32 v15, v15, v46
 v_mfma_f32_16x16x32_bf16 v[52:55], a[252:255], v[120:123], v[52:55]
 ds_read_b64_tr_b16 a[248:249], v7 offset:28672
 v_add_f32 v15, v15, v47
 v_cvt_pk_bf16_f32 v39, v46, v47
 v_mfma_f32_16x16x32_bf16 v[60:63], a[252:255], v[124:127], v[60:63]
 ds_read_b64_tr_b16 a[250:251], v7 offset:30720
 s_waitcnt lgkmcnt(6)
 s_movk_i32 s70, 212
 buffer_load_dword off, s[72:75], s70 lds
 v_mfma_f32_16x16x32_bf16 v[128:131], a[224:227], v[32:35], v[128:131]
 ds_read_b64_tr_b16 a[252:253], v8 offset:28672
 v_cmp_le_u32 vcc, 63, v10
 v_mfma_f32_16x16x32_bf16 v[136:139], a[224:227], v[36:39], v[136:139]
 ds_read_b64_tr_b16 a[254:255], v8 offset:30720
 v_add_u32 v5, 0xffff0000, v5
 v_mfma_f32_16x16x32_bf16 v[132:135], a[228:231], v[32:35], v[132:135]
 s_cbranch_vccz L_cs432
L_cb432:
 ds_read_b64_tr_b16 a[224:225], v5 offset:49152
 v_add_u32 v6, 0xffff0000, v6
 v_mfma_f32_16x16x32_bf16 v[140:143], a[228:231], v[36:39], v[140:143]
 ds_read_b64_tr_b16 a[226:227], v5 offset:51200
 v_add_u32 v7, 0xffff0000, v7
 v_mfma_f32_16x16x32_bf16 v[144:147], a[232:235], v[32:35], v[144:147]
 ds_read_b64_tr_b16 a[228:229], v6 offset:49152
 v_add_u32 v8, 0xffff0000, v8
 v_mfma_f32_16x16x32_bf16 v[152:155], a[232:235], v[36:39], v[152:155]
 ds_read_b64_tr_b16 a[230:231], v6 offset:51200
 v_max3_f32 v11, v48, v49, v50
 v_mfma_f32_16x16x32_bf16 v[148:151], a[236:239], v[32:35], v[148:151]
 ds_read_b64_tr_b16 a[232:233], v7 offset:49152
 s_waitcnt lgkmcnt(5)
 v_max3_f32 v12, v56, v57, v58
 v_mfma_f32_16x16x32_bf16 v[156:159], a[236:239], v[36:39], v[156:159]
 ds_read_b64_tr_b16 a[234:235], v7 offset:51200
 v_max3_f32 v11, v11, v51, v52
 v_mfma_f32_16x16x32_bf16 v[160:163], a[240:243], v[32:35], v[160:163]
 ds_read_b64_tr_b16 a[236:237], v8 offset:49152
 v_max3_f32 v12, v12, v59, v60
 v_mfma_f32_16x16x32_bf16 v[168:171], a[240:243], v[36:39], v[168:171]
 ds_read_b64_tr_b16 a[238:239], v8 offset:51200
 v_max3_f32 v11, v11, v53, v54
 v_mfma_f32_16x16x32_bf16 v[164:167], a[244:247], v[32:35], v[164:167]
 ds_read_b64_tr_b16 a[240:241], v5 offset:53248
 v_max3_f32 v12, v12, v61, v62
 v_mfma_f32_16x16x32_bf16 v[172:175], a[244:247], v[36:39], v[172:175]
 ds_read_b64_tr_b16 a[242:243], v5 offset:55296
 v_max_f32 v11, v11, v55
 v_mfma_f32_16x16x32_bf16 v[176:179], a[248:251], v[32:35], v[176:179]
 ds_read_b64_tr_b16 a[244:245], v6 offset:53248
 v_max_f32 v12, v12, v63
 v_mfma_f32_16x16x32_bf16 v[184:187], a[248:251], v[36:39], v[184:187]
 ds_read_b64_tr_b16 a[246:247], v6 offset:55296
 v_max_f32 v13, v11, v12
 v_cmp_lt_f32 vcc, 0x41200000, v13
 v_mfma_f32_16x16x32_bf16 v[180:183], a[252:255], v[32:35], v[180:183]
 ds_read_b64_tr_b16 a[248:249], v7 offset:53248
 s_waitcnt lgkmcnt(5)
 s_cbranch_vccnz L_rs0_5
L_rb0_5:
 v_mfma_f32_16x16x32_bf16 v[188:191], a[252:255], v[36:39], v[188:191]
 ds_read_b64_tr_b16 a[250:251], v7 offset:55296
 v_mfma_f32_16x16x32_bf16 v[192:195], a[224:227], v[32:35], v[192:195]
 ds_read_b64_tr_b16 a[252:253], v8 offset:53248
 v_mfma_f32_16x16x32_bf16 v[200:203], a[224:227], v[36:39], v[200:203]
 ds_read_b64_tr_b16 a[254:255], v8 offset:55296
 v_mfma_f32_16x16x32_bf16 v[196:199], a[228:231], v[32:35], v[196:199]
 ds_read_b64_tr_b16 a[224:225], v24 offset:24576
 v_mfma_f32_16x16x32_bf16 v[204:207], a[228:231], v[36:39], v[204:207]
 ds_read_b64_tr_b16 a[226:227], v24 offset:26624
 v_mfma_f32_16x16x32_bf16 v[208:211], a[232:235], v[32:35], v[208:211]
 ds_read_b64_tr_b16 a[228:229], v24 offset:24584
 ds_read_b32 v10, v9
 v_mfma_f32_16x16x32_bf16 v[216:219], a[232:235], v[36:39], v[216:219]
 ds_read_b64_tr_b16 a[230:231], v24 offset:26632
 v_mfma_f32_16x16x32_bf16 v[212:215], a[236:239], v[32:35], v[212:215]
 ds_read_b64_tr_b16 a[232:233], v25 offset:24576
 s_waitcnt lgkmcnt(6)
 v_mfma_f32_16x16x32_bf16 v[220:223], a[236:239], v[36:39], v[220:223]
 ds_read_b64_tr_b16 a[234:235], v25 offset:26624
 v_mfma_f32_16x16x32_bf16 v[224:227], a[240:243], v[32:35], v[224:227]
 ds_read_b64_tr_b16 a[236:237], v25 offset:24584
 v_mfma_f32_16x16x32_bf16 v[232:235], a[240:243], v[36:39], v[232:235]
 ds_read_b64_tr_b16 a[238:239], v25 offset:26632
 v_mfma_f32_16x16x32_bf16 v[228:231], a[244:247], v[32:35], v[228:231]
 ds_read_b64_tr_b16 a[240:241], v24 offset:28672
 v_add_u32 v3, 0x10000, v3
 v_mfma_f32_16x16x32_bf16 v[236:239], a[244:247], v[36:39], v[236:239]
 ds_read_b64_tr_b16 a[242:243], v24 offset:30720
 s_movk_i32 s70, 220
 v_mfma_f32_16x16x32_bf16 v[240:243], a[248:251], v[32:35], v[240:243]
 ds_read_b64_tr_b16 a[244:245], v24 offset:28680
 v_mfma_f32_16x16x32_bf16 v[248:251], a[248:251], v[36:39], v[248:251]
 ds_read_b64_tr_b16 a[246:247], v24 offset:30728
 v_mfma_f32_16x16x32_bf16 v[244:247], a[252:255], v[32:35], v[244:247]
 ds_read_b64_tr_b16 a[248:249], v25 offset:28672
 s_waitcnt lgkmcnt(5)
 v_mfma_f32_16x16x32_bf16 v[252:255], a[252:255], v[36:39], v[252:255]
 ds_read_b64_tr_b16 a[250:251], v25 offset:30720
 v_add_u32 v4, 0x10000, v4
 v_mfma_f32_16x16x32_bf16 a[176:179], a[224:227], a[80:83], a[176:179]
 ds_read_b64_tr_b16 a[252:253], v25 offset:28680
 buffer_load_dword off, s[72:75], s70 lds
 v_cmp_le_u32 vcc, 64, v10
 v_mfma_f32_16x16x32_bf16 a[184:187], a[224:227], a[84:87], a[184:187]
 ds_read_b64_tr_b16 a[254:255], v25 offset:30728
 v_mfma_f32_16x16x32_bf16 a[180:183], a[228:231], a[80:83], a[180:183]
 s_cbranch_vccz L_cs448
L_cb448:
 ds_read_b64_tr_b16 a[224:225], v24 offset:40960
 v_mfma_f32_16x16x32_bf16 a[188:191], a[228:231], a[84:87], a[188:191]
 ds_read_b64_tr_b16 a[226:227], v24 offset:43008
 v_mfma_f32_16x16x32_bf16 a[192:195], a[232:235], a[80:83], a[192:195]
 ds_read_b64_tr_b16 a[228:229], v24 offset:40968
 ds_read_b32 v10, v9
 v_mfma_f32_16x16x32_bf16 a[200:203], a[232:235], a[84:87], a[200:203]
 ds_read_b64_tr_b16 a[230:231], v24 offset:43016
 v_mfma_f32_16x16x32_bf16 a[196:199], a[236:239], a[80:83], a[196:199]
 ds_read_b64_tr_b16 a[232:233], v25 offset:40960
 s_waitcnt lgkmcnt(6)
 v_mfma_f32_16x16x32_bf16 a[204:207], a[236:239], a[84:87], a[204:207]
 ds_read_b64_tr_b16 a[234:235], v25 offset:43008
 v_mfma_f32_16x16x32_bf16 a[176:179], a[240:243], a[88:91], a[176:179]
 ds_read_b64_tr_b16 a[236:237], v25 offset:40968
 v_mfma_f32_16x16x32_bf16 a[184:187], a[240:243], a[92:95], a[184:187]
 ds_read_b64_tr_b16 a[238:239], v25 offset:43016
 v_mfma_f32_16x16x32_bf16 a[180:183], a[244:247], a[88:91], a[180:183]
 ds_read_b64_tr_b16 a[240:241], v24 offset:45056
 v_mfma_f32_16x16x32_bf16 a[188:191], a[244:247], a[92:95], a[188:191]
 ds_read_b64_tr_b16 a[242:243], v24 offset:47104
 v_mfma_f32_16x16x32_bf16 a[192:195], a[248:251], a[88:91], a[192:195]
 ds_read_b64_tr_b16 a[244:245], v24 offset:45064
 v_mfma_f32_16x16x32_bf16 a[200:203], a[248:251], a[92:95], a[200:203]
 ds_read_b64_tr_b16 a[246:247], v24 offset:47112
 v_mfma_f32_16x16x32_bf16 a[196:199], a[252:255], a[88:91], a[196:199]
 ds_read_b64_tr_b16 a[248:249], v25 offset:45056
 s_waitcnt lgkmcnt(5)
 v_mfma_f32_16x16x32_bf16 a[204:207], a[252:255], a[92:95], a[204:207]
 ds_read_b64_tr_b16 a[250:251], v25 offset:47104
 v_mfma_f32_16x16x32_bf16 a[176:179], a[224:227], a[96:99], a[176:179]
 ds_read_b64_tr_b16 a[252:253], v25 offset:45064
 v_cmp_le_u32 vcc, 68, v10
 v_mfma_f32_16x16x32_bf16 a[184:187], a[224:227], a[100:103], a[184:187]
 ds_read_b64_tr_b16 a[254:255], v25 offset:47112
 v_mfma_f32_16x16x32_bf16 a[180:183], a[228:231], a[96:99], a[180:183]
 s_cbranch_vccz L_cs456
L_cb456:
 ds_read_b128 a[224:227], v3 offset:32768
 v_mfma_f32_16x16x32_bf16 a[188:191], a[228:231], a[100:103], a[188:191]
 v_exp_f32 v48, v48
 v_mfma_f32_16x16x32_bf16 a[192:195], a[232:235], a[96:99], a[192:195]
 ds_read_b128 a[228:231], v3 offset:34816
 v_add_f32 v14, v14, v48
 v_mfma_f32_16x16x32_bf16 a[200:203], a[232:235], a[100:103], a[200:203]
 v_exp_f32 v49, v49
 v_mfma_f32_16x16x32_bf16 a[196:199], a[236:239], a[96:99], a[196:199]
 ds_read_b128 a[232:235], v4 offset:32768
 s_waitcnt lgkmcnt(3)
 v_mfma_f32_16x16x32_bf16 a[204:207], a[236:239], a[100:103], a[204:207]
 v_exp_f32 v50, v50
 v_mfma_f32_16x16x32_bf16 a[176:179], a[240:243], a[104:107], a[176:179]
 ds_read_b128 a[236:239], v4 offset:34816
 v_add_f32 v14, v14, v49
 v_mfma_f32_16x16x32_bf16 a[184:187], a[240:243], a[108:111], a[184:187]
 v_exp_f32 v51, v51
 v_mfma_f32_16x16x32_bf16 a[180:183], a[244:247], a[104:107], a[180:183]
 ds_read_b128 a[240:243], v3 offset:36864
 v_add_u32 v5, 0x10000, v5
 v_mfma_f32_16x16x32_bf16 a[188:191], a[244:247], a[108:111], a[188:191]
 v_exp_f32 v52, v52
 v_mfma_f32_16x16x32_bf16 a[192:195], a[248:251], a[104:107], a[192:195]
 ds_read_b128 a[244:247], v3 offset:38912
 s_movk_i32 s70, 228
 v_mfma_f32_16x16x32_bf16 a[200:203], a[248:251], a[108:111], a[200:203]
 v_exp_f32 v53, v53
 v_mfma_f32_16x16x32_bf16 a[196:199], a[252:255], a[104:107], a[196:199]
 ds_read_b128 a[248:251], v4 offset:36864
 s_waitcnt lgkmcnt(3)
 v_add_u32 v6, 0x10000, v6
 v_mfma_f32_16x16x32_bf16 a[204:207], a[252:255], a[108:111], a[204:207]
 buffer_load_dword off, s[72:75], s70 lds
 v_add_u32 v7, 0x10000, v7
 v_exp_f32 v54, v54
 v_mfma_f32_16x16x32_bf16 v[32:35], a[224:227], v[64:67], v[16:19]
 ds_read_b128 a[252:255], v4 offset:38912
 v_add_u32 v8, 0x10000, v8
 v_mfma_f32_16x16x32_bf16 v[40:43], a[224:227], v[68:71], v[20:23]
 v_exp_f32 v55, v55
 v_mfma_f32_16x16x32_bf16 v[36:39], a[228:231], v[64:67], v[16:19]
 ds_read_b128 a[224:227], v3 offset:57344
 v_cvt_pk_bf16_f32 v48, v48, v49
 v_exp_f32 v56, v56
 v_exp_f32 v57, v57
 v_exp_f32 v58, v58
 v_exp_f32 v59, v59
 v_exp_f32 v60, v60
 v_exp_f32 v61, v61
 v_exp_f32 v62, v62
 v_exp_f32 v63, v63
 v_add_f32 v14, v14, v50
 v_add_f32 v14, v14, v51
 v_cvt_pk_bf16_f32 v49, v50, v51
 v_add_f32 v14, v14, v52
 v_add_f32 v14, v14, v53
 v_cvt_pk_bf16_f32 v50, v52, v53
 v_add_f32 v14, v14, v54
 v_add_f32 v14, v14, v55
 v_cvt_pk_bf16_f32 v51, v54, v55
 v_accvgpr_read_b32 v28, a176
 v_accvgpr_read_b32 v29, a177
 v_mul_f32 v28, s32, v28
 v_mul_f32 v29, s32, v29
 v_cvt_pk_bf16_f32 v28, v28, v29
 v_accvgpr_write_b32 a112, v28
 v_accvgpr_read_b32 v30, a178
 v_accvgpr_read_b32 v31, a179
 v_mul_f32 v30, s32, v30
 v_mul_f32 v31, s32, v31
 v_cvt_pk_bf16_f32 v30, v30, v31
 v_accvgpr_write_b32 a113, v30
 v_accvgpr_read_b32 v28, a180
 v_accvgpr_read_b32 v29, a181
 v_mul_f32 v28, s32, v28
 v_mul_f32 v29, s32, v29
 v_cvt_pk_bf16_f32 v28, v28, v29
 v_accvgpr_write_b32 a114, v28
 v_accvgpr_read_b32 v30, a182
 v_accvgpr_read_b32 v31, a183
 v_mul_f32 v30, s32, v30
 v_mul_f32 v31, s32, v31
 v_cvt_pk_bf16_f32 v30, v30, v31
 v_accvgpr_write_b32 a115, v30
 v_accvgpr_read_b32 v28, a184
 v_accvgpr_read_b32 v29, a185
 v_mul_f32 v28, s32, v28
 v_mul_f32 v29, s32, v29
 v_cvt_pk_bf16_f32 v28, v28, v29
 v_accvgpr_write_b32 a116, v28
 v_accvgpr_read_b32 v30, a186
 v_accvgpr_read_b32 v31, a187
 v_mul_f32 v30, s32, v30
 v_mul_f32 v31, s32, v31
 v_cvt_pk_bf16_f32 v30, v30, v31
 v_accvgpr_write_b32 a117, v30
 v_accvgpr_read_b32 v28, a188
 v_accvgpr_read_b32 v29, a189
 v_mul_f32 v28, s32, v28
 v_mul_f32 v29, s32, v29
 v_mfma_f32_16x16x32_bf16 v[44:47], a[228:231], v[68:71], v[20:23]
 v_add_f32 v15, v15, v56
 v_add_f32 v15, v15, v57
 v_mfma_f32_16x16x32_bf16 v[32:35], a[232:235], v[72:75], v[32:35]
 ds_read_b128 a[228:231], v3 offset:59392
 v_cvt_pk_bf16_f32 v52, v56, v57
 v_mfma_f32_16x16x32_bf16 v[40:43], a[232:235], v[76:79], v[40:43]
 v_add_f32 v15, v15, v58
 v_add_f32 v15, v15, v59
 v_mfma_f32_16x16x32_bf16 v[36:39], a[236:239], v[72:75], v[36:39]
 ds_read_b128 a[232:235], v4 offset:57344
 s_waitcnt lgkmcnt(3)
 v_cvt_pk_bf16_f32 v53, v58, v59
 v_mfma_f32_16x16x32_bf16 v[44:47], a[236:239], v[76:79], v[44:47]
 v_add_f32 v15, v15, v60
 v_add_f32 v15, v15, v61
 v_mfma_f32_16x16x32_bf16 v[32:35], a[240:243], v[80:83], v[32:35]
 ds_read_b128 a[236:239], v4 offset:59392
 v_cvt_pk_bf16_f32 v54, v60, v61
 v_mfma_f32_16x16x32_bf16 v[40:43], a[240:243], v[84:87], v[40:43]
 v_add_f32 v15, v15, v62
 v_add_f32 v15, v15, v63
 v_mfma_f32_16x16x32_bf16 v[36:39], a[244:247], v[80:83], v[36:39]
 ds_read_b128 a[240:243], v3 offset:61440
 v_cvt_pk_bf16_f32 v55, v62, v63
 v_mfma_f32_16x16x32_bf16 v[44:47], a[244:247], v[84:87], v[44:47]
 v_cvt_pk_bf16_f32 v28, v28, v29
 v_accvgpr_write_b32 a118, v28
 v_mfma_f32_16x16x32_bf16 v[32:35], a[248:251], v[88:91], v[32:35]
 ds_read_b128 a[244:247], v3 offset:63488
 v_accvgpr_read_b32 v30, a190
 v_mfma_f32_16x16x32_bf16 v[40:43], a[248:251], v[92:95], v[40:43]
 v_accvgpr_read_b32 v31, a191
 v_mul_f32 v30, s32, v30
 v_mfma_f32_16x16x32_bf16 v[36:39], a[252:255], v[88:91], v[36:39]
 ds_read_b128 a[248:251], v4 offset:61440
 s_waitcnt lgkmcnt(3)
 v_mul_f32 v31, s32, v31
 v_mfma_f32_16x16x32_bf16 v[44:47], a[252:255], v[92:95], v[44:47]
 v_cvt_pk_bf16_f32 v30, v30, v31
 v_accvgpr_write_b32 a119, v30
 v_mfma_f32_16x16x32_bf16 v[32:35], a[224:227], v[96:99], v[32:35]
 ds_read_b128 a[252:255], v4 offset:63488
 v_accvgpr_read_b32 v28, a192
 v_mfma_f32_16x16x32_bf16 v[40:43], a[224:227], v[100:103], v[40:43]
 v_accvgpr_read_b32 v29, a193
 v_mul_f32 v28, s32, v28
 v_mfma_f32_16x16x32_bf16 v[36:39], a[228:231], v[96:99], v[36:39]
 ds_read_b64_tr_b16 a[224:225], v5 offset:40960
 v_mul_f32 v29, s32, v29
 v_mfma_f32_16x16x32_bf16 v[44:47], a[228:231], v[100:103], v[44:47]
 ds_read_b64_tr_b16 a[226:227], v5 offset:43008
 v_cvt_pk_bf16_f32 v28, v28, v29
 v_mfma_f32_16x16x32_bf16 v[32:35], a[232:235], v[104:107], v[32:35]
 ds_read_b64_tr_b16 a[228:229], v6 offset:40960
 ds_read_b32 v10, v9
 v_accvgpr_write_b32 a120, v28
 v_mfma_f32_16x16x32_bf16 v[40:43], a[232:235], v[108:111], v[40:43]
 ds_read_b64_tr_b16 a[230:231], v6 offset:43008
 v_accvgpr_read_b32 v30, a194
 v_mfma_f32_16x16x32_bf16 v[36:39], a[236:239], v[104:107], v[36:39]
 ds_read_b64_tr_b16 a[232:233], v7 offset:40960
 s_waitcnt lgkmcnt(6)
 v_accvgpr_read_b32 v31, a195
 v_mfma_f32_16x16x32_bf16 v[44:47], a[236:239], v[108:111], v[44:47]
 ds_read_b64_tr_b16 a[234:235], v7 offset:43008
 v_mul_f32 v30, s32, v30
 v_mfma_f32_16x16x32_bf16 v[32:35], a[240:243], v[112:115], v[32:35]
 ds_read_b64_tr_b16 a[236:237], v8 offset:40960
 v_mul_f32 v31, s32, v31
 v_mfma_f32_16x16x32_bf16 v[40:43], a[240:243], v[116:119], v[40:43]
 ds_read_b64_tr_b16 a[238:239], v8 offset:43008
 v_cvt_pk_bf16_f32 v30, v30, v31
 v_mfma_f32_16x16x32_bf16 v[36:39], a[244:247], v[112:115], v[36:39]
 ds_read_b64_tr_b16 a[240:241], v5 offset:45056
 v_accvgpr_write_b32 a121, v30
 v_mfma_f32_16x16x32_bf16 v[44:47], a[244:247], v[116:119], v[44:47]
 ds_read_b64_tr_b16 a[242:243], v5 offset:47104
 s_movk_i32 s70, 236
 v_accvgpr_read_b32 v28, a196
 v_mfma_f32_16x16x32_bf16 v[32:35], a[248:251], v[120:123], v[32:35]
 ds_read_b64_tr_b16 a[244:245], v6 offset:45056
 v_accvgpr_read_b32 v29, a197
 v_mfma_f32_16x16x32_bf16 v[40:43], a[248:251], v[124:127], v[40:43]
 ds_read_b64_tr_b16 a[246:247], v6 offset:47104
 v_mul_f32 v28, s32, v28
 v_mfma_f32_16x16x32_bf16 v[36:39], a[252:255], v[120:123], v[36:39]
 ds_read_b64_tr_b16 a[248:249], v7 offset:45056
 s_waitcnt lgkmcnt(5)
 v_mul_f32 v29, s32, v29
 v_mfma_f32_16x16x32_bf16 v[44:47], a[252:255], v[124:127], v[44:47]
 ds_read_b64_tr_b16 a[250:251], v7 offset:47104
 buffer_load_dword off, s[72:75], s70 lds
 v_cvt_pk_bf16_f32 v28, v28, v29
 v_mfma_f32_16x16x32_bf16 v[128:131], a[224:227], v[48:51], v[128:131]
 ds_read_b64_tr_b16 a[252:253], v8 offset:45056
 v_cmp_le_u32 vcc, 69, v10
 v_accvgpr_write_b32 a122, v28
 v_mfma_f32_16x16x32_bf16 v[136:139], a[224:227], v[52:55], v[136:139]
 ds_read_b64_tr_b16 a[254:255], v8 offset:47104
 v_accvgpr_read_b32 v30, a198
 v_mfma_f32_16x16x32_bf16 v[132:135], a[228:231], v[48:51], v[132:135]
 s_cbranch_vccz L_cs480
L_cb480:
 ds_read_b64_tr_b16 a[224:225], v5 offset:49152
 v_max3_f32 v11, v32, v33, v34
 v_max3_f32 v12, v40, v41, v42
 v_max3_f32 v11, v11, v35, v36
 v_max3_f32 v12, v12, v43, v44
 v_max3_f32 v11, v11, v37, v38
 v_max3_f32 v12, v12, v45, v46
 v_max_f32 v11, v11, v39
 v_max_f32 v12, v12, v47
 v_max_f32 v13, v11, v12
 v_mfma_f32_16x16x32_bf16 v[140:143], a[228:231], v[52:55], v[140:143]
 ds_read_b64_tr_b16 a[226:227], v5 offset:51200
 v_accvgpr_read_b32 v31, a199
 v_mfma_f32_16x16x32_bf16 v[144:147], a[232:235], v[48:51], v[144:147]
 ds_read_b64_tr_b16 a[228:229], v6 offset:49152
 v_mul_f32 v30, s32, v30
 v_mfma_f32_16x16x32_bf16 v[152:155], a[232:235], v[52:55], v[152:155]
 ds_read_b64_tr_b16 a[230:231], v6 offset:51200
 v_mul_f32 v31, s32, v31
 v_mfma_f32_16x16x32_bf16 v[148:151], a[236:239], v[48:51], v[148:151]
 ds_read_b64_tr_b16 a[232:233], v7 offset:49152
 s_waitcnt lgkmcnt(5)
 v_cvt_pk_bf16_f32 v30, v30, v31
 v_mfma_f32_16x16x32_bf16 v[156:159], a[236:239], v[52:55], v[156:159]
 ds_read_b64_tr_b16 a[234:235], v7 offset:51200
 v_accvgpr_write_b32 a123, v30
 v_mfma_f32_16x16x32_bf16 v[160:163], a[240:243], v[48:51], v[160:163]
 ds_read_b64_tr_b16 a[236:237], v8 offset:49152
 v_accvgpr_read_b32 v28, a200
 v_mfma_f32_16x16x32_bf16 v[168:171], a[240:243], v[52:55], v[168:171]
 ds_read_b64_tr_b16 a[238:239], v8 offset:51200
 v_accvgpr_read_b32 v29, a201
 v_mfma_f32_16x16x32_bf16 v[164:167], a[244:247], v[48:51], v[164:167]
 ds_read_b64_tr_b16 a[240:241], v5 offset:53248
 v_mul_f32 v28, s32, v28
 v_mfma_f32_16x16x32_bf16 v[172:175], a[244:247], v[52:55], v[172:175]
 ds_read_b64_tr_b16 a[242:243], v5 offset:55296
 v_mul_f32 v29, s32, v29
 v_mfma_f32_16x16x32_bf16 v[176:179], a[248:251], v[48:51], v[176:179]
 ds_read_b64_tr_b16 a[244:245], v6 offset:53248
 v_cvt_pk_bf16_f32 v28, v28, v29
 v_mfma_f32_16x16x32_bf16 v[184:187], a[248:251], v[52:55], v[184:187]
 ds_read_b64_tr_b16 a[246:247], v6 offset:55296
 v_cmp_lt_f32 vcc, 0x41200000, v13
 v_accvgpr_write_b32 a124, v28
 v_mfma_f32_16x16x32_bf16 v[180:183], a[252:255], v[48:51], v[180:183]
 ds_read_b64_tr_b16 a[248:249], v7 offset:53248
 s_waitcnt lgkmcnt(5)
 s_cbranch_vccnz L_rs0_6
L_rb0_6:
 v_accvgpr_read_b32 v30, a202
 v_mfma_f32_16x16x32_bf16 v[188:191], a[252:255], v[52:55], v[188:191]
 ds_read_b64_tr_b16 a[250:251], v7 offset:55296
 v_accvgpr_read_b32 v31, a203
 v_mfma_f32_16x16x32_bf16 v[192:195], a[224:227], v[48:51], v[192:195]
 ds_read_b64_tr_b16 a[252:253], v8 offset:53248
 v_mul_f32 v30, s32, v30
 v_mfma_f32_16x16x32_bf16 v[200:203], a[224:227], v[52:55], v[200:203]
 ds_read_b64_tr_b16 a[254:255], v8 offset:55296
 v_mul_f32 v31, s32, v31
 v_mfma_f32_16x16x32_bf16 v[196:199], a[228:231], v[48:51], v[196:199]
 ds_read_b64_tr_b16 a[224:225], v24 offset:32768
 v_cvt_pk_bf16_f32 v30, v30, v31
 v_mfma_f32_16x16x32_bf16 v[204:207], a[228:231], v[52:55], v[204:207]
 ds_read_b64_tr_b16 a[226:227], v24 offset:34816
 v_accvgpr_write_b32 a125, v30
 v_mfma_f32_16x16x32_bf16 v[208:211], a[232:235], v[48:51], v[208:211]
 ds_read_b64_tr_b16 a[228:229], v24 offset:32776
 ds_read_b32 v10, v9
 v_accvgpr_read_b32 v28, a204
 v_mfma_f32_16x16x32_bf16 v[216:219], a[232:235], v[52:55], v[216:219]
 ds_read_b64_tr_b16 a[230:231], v24 offset:34824
 v_accvgpr_read_b32 v29, a205
 v_mfma_f32_16x16x32_bf16 v[212:215], a[236:239], v[48:51], v[212:215]
 ds_read_b64_tr_b16 a[232:233], v25 offset:32768
 s_waitcnt lgkmcnt(6)
 v_mul_f32 v28, s32, v28
 v_mfma_f32_16x16x32_bf16 v[220:223], a[236:239], v[52:55], v[220:223]
 ds_read_b64_tr_b16 a[234:235], v25 offset:34816
 v_mul_f32 v29, s32, v29
 v_mfma_f32_16x16x32_bf16 v[224:227], a[240:243], v[48:51], v[224:227]
 ds_read_b64_tr_b16 a[236:237], v25 offset:32776
 v_cvt_pk_bf16_f32 v28, v28, v29
 v_mfma_f32_16x16x32_bf16 v[232:235], a[240:243], v[52:55], v[232:235]
 ds_read_b64_tr_b16 a[238:239], v25 offset:34824
 v_accvgpr_write_b32 a126, v28
 v_mfma_f32_16x16x32_bf16 v[228:231], a[244:247], v[48:51], v[228:231]
 ds_read_b64_tr_b16 a[240:241], v24 offset:36864
 v_accvgpr_read_b32 v30, a206
 v_mfma_f32_16x16x32_bf16 v[236:239], a[244:247], v[52:55], v[236:239]
 ds_read_b64_tr_b16 a[242:243], v24 offset:38912
 v_accvgpr_read_b32 v31, a207
 v_mfma_f32_16x16x32_bf16 v[240:243], a[248:251], v[48:51], v[240:243]
 ds_read_b64_tr_b16 a[244:245], v24 offset:36872
 v_mul_f32 v30, s32, v30
 v_mfma_f32_16x16x32_bf16 v[248:251], a[248:251], v[52:55], v[248:251]
 ds_read_b64_tr_b16 a[246:247], v24 offset:38920
 v_mul_f32 v31, s32, v31
 v_mfma_f32_16x16x32_bf16 v[244:247], a[252:255], v[48:51], v[244:247]
 ds_read_b64_tr_b16 a[248:249], v25 offset:36864
 v_cvt_pk_bf16_f32 v30, v30, v31
 v_accvgpr_write_b32 a127, v30
 v_mfma_f32_16x16x32_bf16 v[252:255], a[252:255], v[52:55], v[252:255]
 ds_read_b64_tr_b16 a[250:251], v25 offset:38912
 s_waitcnt lgkmcnt(6)
 s_movk_i32 s70, 244
 v_mfma_f32_16x16x32_bf16 a[176:179], a[224:227], a[0:3], 0
 ds_read_b64_tr_b16 a[252:253], v25 offset:36872
 buffer_load_dword off, s[72:75], s70 lds
 v_cmp_le_u32 vcc, 70, v10
 v_mfma_f32_16x16x32_bf16 a[184:187], a[224:227], a[4:7], 0
 ds_read_b64_tr_b16 a[254:255], v25 offset:38920
 v_add_u32 v3, 0x10000, v3
 v_mfma_f32_16x16x32_bf16 a[180:183], a[228:231], a[0:3], 0
 s_cbranch_vccz L_cs496
L_cb496:
 ds_read_b64_tr_b16 a[224:225], v24 offset:0
 v_mfma_f32_16x16x32_bf16 a[188:191], a[228:231], a[4:7], 0
 ds_read_b64_tr_b16 a[226:227], v24 offset:2048
 v_add_u32 v4, 0x10000, v4
 v_mfma_f32_16x16x32_bf16 a[192:195], a[232:235], a[0:3], 0
 ds_read_b64_tr_b16 a[228:229], v24 offset:8
 ds_read_b32 v10, v9
 v_mfma_f32_16x16x32_bf16 a[200:203], a[232:235], a[4:7], 0
 ds_read_b64_tr_b16 a[230:231], v24 offset:2056
 v_mfma_f32_16x16x32_bf16 a[196:199], a[236:239], a[0:3], 0
 ds_read_b64_tr_b16 a[232:233], v25 offset:0
 s_waitcnt lgkmcnt(6)
 v_mfma_f32_16x16x32_bf16 a[204:207], a[236:239], a[4:7], 0
 ds_read_b64_tr_b16 a[234:235], v25 offset:2048
 v_mfma_f32_16x16x32_bf16 a[176:179], a[240:243], a[8:11], a[176:179]
 ds_read_b64_tr_b16 a[236:237], v25 offset:8
 v_mfma_f32_16x16x32_bf16 a[184:187], a[240:243], a[12:15], a[184:187]
 ds_read_b64_tr_b16 a[238:239], v25 offset:2056
 v_mfma_f32_16x16x32_bf16 a[180:183], a[244:247], a[8:11], a[180:183]
 ds_read_b64_tr_b16 a[240:241], v24 offset:4096
 v_mfma_f32_16x16x32_bf16 a[188:191], a[244:247], a[12:15], a[188:191]
 ds_read_b64_tr_b16 a[242:243], v24 offset:6144
 v_mfma_f32_16x16x32_bf16 a[192:195], a[248:251], a[8:11], a[192:195]
 ds_read_b64_tr_b16 a[244:245], v24 offset:4104
 v_mfma_f32_16x16x32_bf16 a[200:203], a[248:251], a[12:15], a[200:203]
 ds_read_b64_tr_b16 a[246:247], v24 offset:6152
 v_mfma_f32_16x16x32_bf16 a[196:199], a[252:255], a[8:11], a[196:199]
 ds_read_b64_tr_b16 a[248:249], v25 offset:4096
 s_waitcnt lgkmcnt(5)
 v_mfma_f32_16x16x32_bf16 a[204:207], a[252:255], a[12:15], a[204:207]
 ds_read_b64_tr_b16 a[250:251], v25 offset:6144
 v_mfma_f32_16x16x32_bf16 a[176:179], a[224:227], a[16:19], a[176:179]
 ds_read_b64_tr_b16 a[252:253], v25 offset:4104
 v_cmp_le_u32 vcc, 74, v10
 v_mfma_f32_16x16x32_bf16 a[184:187], a[224:227], a[20:23], a[184:187]
 ds_read_b64_tr_b16 a[254:255], v25 offset:6152
 v_mfma_f32_16x16x32_bf16 a[180:183], a[228:231], a[16:19], a[180:183]
 s_cbranch_vccz L_cs504
L_cb504:
 ds_read_b128 a[224:227], v3 offset:0
 v_mfma_f32_16x16x32_bf16 a[188:191], a[228:231], a[20:23], a[188:191]
 v_exp_f32 v32, v32
 v_mfma_f32_16x16x32_bf16 a[192:195], a[232:235], a[16:19], a[192:195]
 ds_read_b128 a[228:231], v3 offset:2048
 v_add_f32 v14, v14, v32
 v_mfma_f32_16x16x32_bf16 a[200:203], a[232:235], a[20:23], a[200:203]
 v_exp_f32 v33, v33
 v_mfma_f32_16x16x32_bf16 a[196:199], a[236:239], a[16:19], a[196:199]
 ds_read_b128 a[232:235], v4 offset:0
 s_waitcnt lgkmcnt(3)
 v_mfma_f32_16x16x32_bf16 a[204:207], a[236:239], a[20:23], a[204:207]
 v_exp_f32 v34, v34
 v_mfma_f32_16x16x32_bf16 a[176:179], a[240:243], a[24:27], a[176:179]
 ds_read_b128 a[236:239], v4 offset:2048
 v_add_f32 v14, v14, v33
 v_mfma_f32_16x16x32_bf16 a[184:187], a[240:243], a[28:31], a[184:187]
 v_exp_f32 v35, v35
 v_mfma_f32_16x16x32_bf16 a[180:183], a[244:247], a[24:27], a[180:183]
 ds_read_b128 a[240:243], v3 offset:4096
 v_add_u32 v5, 0x10000, v5
 v_mfma_f32_16x16x32_bf16 a[188:191], a[244:247], a[28:31], a[188:191]
 v_exp_f32 v36, v36
 v_mfma_f32_16x16x32_bf16 a[192:195], a[248:251], a[24:27], a[192:195]
 ds_read_b128 a[244:247], v3 offset:6144
 s_movk_i32 s70, 252
 v_mfma_f32_16x16x32_bf16 a[200:203], a[248:251], a[28:31], a[200:203]
 v_exp_f32 v37, v37
 v_mfma_f32_16x16x32_bf16 a[196:199], a[252:255], a[24:27], a[196:199]
 ds_read_b128 a[248:251], v4 offset:4096
 s_waitcnt lgkmcnt(3)
 v_add_u32 v3, 0xffff0000, v3
 v_add_u32 v6, 0x10000, v6
 v_mfma_f32_16x16x32_bf16 a[204:207], a[252:255], a[28:31], a[204:207]
 buffer_load_dword off, s[72:75], s70 lds
 v_add_u32 v7, 0x10000, v7
 v_exp_f32 v38, v38
 v_mfma_f32_16x16x32_bf16 v[48:51], a[224:227], v[64:67], v[16:19]
 ds_read_b128 a[252:255], v4 offset:6144
 v_add_u32 v4, 0xffff0000, v4
 v_add_u32 v8, 0x10000, v8
 v_mfma_f32_16x16x32_bf16 v[56:59], a[224:227], v[68:71], v[20:23]
 v_exp_f32 v39, v39
 v_mfma_f32_16x16x32_bf16 v[52:55], a[228:231], v[64:67], v[16:19]
 ds_read_b128 a[224:227], v3 offset:8192
 v_cvt_pk_bf16_f32 v32, v32, v33
 v_mfma_f32_16x16x32_bf16 v[60:63], a[228:231], v[68:71], v[20:23]
 v_exp_f32 v40, v40
 v_mfma_f32_16x16x32_bf16 v[48:51], a[232:235], v[72:75], v[48:51]
 ds_read_b128 a[228:231], v3 offset:10240
 v_add_f32 v14, v14, v34
 v_mfma_f32_16x16x32_bf16 v[56:59], a[232:235], v[76:79], v[56:59]
 v_exp_f32 v41, v41
 v_mfma_f32_16x16x32_bf16 v[52:55], a[236:239], v[72:75], v[52:55]
 ds_read_b128 a[232:235], v4 offset:8192
 s_waitcnt lgkmcnt(3)
 v_exp_f32 v42, v42
 v_mfma_f32_16x16x32_bf16 v[60:63], a[236:239], v[76:79], v[60:63]
 v_exp_f32 v43, v43
 v_mfma_f32_16x16x32_bf16 v[48:51], a[240:243], v[80:83], v[48:51]
 ds_read_b128 a[236:239], v4 offset:10240
 v_add_f32 v14, v14, v35
 v_mfma_f32_16x16x32_bf16 v[56:59], a[240:243], v[84:87], v[56:59]
 v_exp_f32 v44, v44
 v_mfma_f32_16x16x32_bf16 v[52:55], a[244:247], v[80:83], v[52:55]
 ds_read_b128 a[240:243], v3 offset:12288
 v_cvt_pk_bf16_f32 v33, v34, v35
 v_mfma_f32_16x16x32_bf16 v[60:63], a[244:247], v[84:87], v[60:63]
 v_exp_f32 v45, v45
 v_mfma_f32_16x16x32_bf16 v[48:51], a[248:251], v[88:91], v[48:51]
 ds_read_b128 a[244:247], v3 offset:14336
 v_add_f32 v14, v14, v36
 v_mfma_f32_16x16x32_bf16 v[56:59], a[248:251], v[92:95], v[56:59]
 v_exp_f32 v46, v46
 v_mfma_f32_16x16x32_bf16 v[52:55], a[252:255], v[88:91], v[52:55]
 ds_read_b128 a[248:251], v4 offset:12288
 s_waitcnt lgkmcnt(3)
 v_mfma_f32_16x16x32_bf16 v[60:63], a[252:255], v[92:95], v[60:63]
 v_exp_f32 v47, v47
 v_mfma_f32_16x16x32_bf16 v[48:51], a[224:227], v[96:99], v[48:51]
 ds_read_b128 a[252:255], v4 offset:14336
 v_add_f32 v14, v14, v37
 v_mfma_f32_16x16x32_bf16 v[56:59], a[224:227], v[100:103], v[56:59]
 v_cvt_pk_bf16_f32 v34, v36, v37
 v_add_f32 v14, v14, v38
 v_mfma_f32_16x16x32_bf16 v[52:55], a[228:231], v[96:99], v[52:55]
 ds_read_b64_tr_b16 a[224:225], v5 offset:8192
 v_add_f32 v14, v14, v39
 v_mfma_f32_16x16x32_bf16 v[60:63], a[228:231], v[100:103], v[60:63]
 ds_read_b64_tr_b16 a[226:227], v5 offset:10240
 v_cvt_pk_bf16_f32 v35, v38, v39
 v_mfma_f32_16x16x32_bf16 v[48:51], a[232:235], v[104:107], v[48:51]
 ds_read_b64_tr_b16 a[228:229], v6 offset:8192
 ds_read_b32 v10, v9
 v_add_f32 v15, v15, v40
 v_mfma_f32_16x16x32_bf16 v[56:59], a[232:235], v[108:111], v[56:59]
 ds_read_b64_tr_b16 a[230:231], v6 offset:10240
 v_add_f32 v15, v15, v41
 v_mfma_f32_16x16x32_bf16 v[52:55], a[236:239], v[104:107], v[52:55]
 ds_read_b64_tr_b16 a[232:233], v7 offset:8192
 s_waitcnt lgkmcnt(6)
 v_cvt_pk_bf16_f32 v36, v40, v41
 v_mfma_f32_16x16x32_bf16 v[60:63], a[236:239], v[108:111], v[60:63]
 ds_read_b64_tr_b16 a[234:235], v7 offset:10240
 v_add_f32 v15, v15, v42
 v_mfma_f32_16x16x32_bf16 v[48:51], a[240:243], v[112:115], v[48:51]
 ds_read_b64_tr_b16 a[236:237], v8 offset:8192
 v_add_f32 v15, v15, v43
 v_mfma_f32_16x16x32_bf16 v[56:59], a[240:243], v[116:119], v[56:59]
 ds_read_b64_tr_b16 a[238:239], v8 offset:10240
 v_cvt_pk_bf16_f32 v37, v42, v43
 v_mfma_f32_16x16x32_bf16 v[52:55], a[244:247], v[112:115], v[52:55]
 ds_read_b64_tr_b16 a[240:241], v5 offset:12288
 v_add_f32 v15, v15, v44
 v_mfma_f32_16x16x32_bf16 v[60:63], a[244:247], v[116:119], v[60:63]
 ds_read_b64_tr_b16 a[242:243], v5 offset:14336
 v_add_f32 v15, v15, v45
 v_mfma_f32_16x16x32_bf16 v[48:51], a[248:251], v[120:123], v[48:51]
 ds_read_b64_tr_b16 a[244:245], v6 offset:12288
 v_cvt_pk_bf16_f32 v38, v44, v45
 v_mfma_f32_16x16x32_bf16 v[56:59], a[248:251], v[124:127], v[56:59]
 ds_read_b64_tr_b16 a[246:247], v6 offset:14336
 v_add_f32 v15, v15, v46
 v_mfma_f32_16x16x32_bf16 v[52:55], a[252:255], v[120:123], v[52:55]
 ds_read_b64_tr_b16 a[248:249], v7 offset:12288
 v_add_f32 v15, v15, v47
 v_cvt_pk_bf16_f32 v39, v46, v47
 v_mfma_f32_16x16x32_bf16 v[60:63], a[252:255], v[124:127], v[60:63]
 ds_read_b64_tr_b16 a[250:251], v7 offset:14336
 s_waitcnt lgkmcnt(6)
 s_movk_i32 s70, 260
 v_mfma_f32_16x16x32_bf16 v[128:131], a[224:227], v[32:35], v[128:131]
 ds_read_b64_tr_b16 a[252:253], v8 offset:12288
 buffer_load_dword off, s[72:75], s70 lds
 v_cmp_le_u32 vcc, 75, v10
 v_mfma_f32_16x16x32_bf16 v[136:139], a[224:227], v[36:39], v[136:139]
 ds_read_b64_tr_b16 a[254:255], v8 offset:14336
 v_mfma_f32_16x16x32_bf16 v[132:135], a[228:231], v[32:35], v[132:135]
 s_cbranch_vccz L_cs528
L_cb528:
 ds_read_b64_tr_b16 a[224:225], v5 offset:16384
 v_mfma_f32_16x16x32_bf16 v[140:143], a[228:231], v[36:39], v[140:143]
 ds_read_b64_tr_b16 a[226:227], v5 offset:18432
 v_max3_f32 v11, v48, v49, v50
 v_mfma_f32_16x16x32_bf16 v[144:147], a[232:235], v[32:35], v[144:147]
 ds_read_b64_tr_b16 a[228:229], v6 offset:16384
 v_max3_f32 v12, v56, v57, v58
 v_mfma_f32_16x16x32_bf16 v[152:155], a[232:235], v[36:39], v[152:155]
 ds_read_b64_tr_b16 a[230:231], v6 offset:18432
 v_max3_f32 v11, v11, v51, v52
 v_mfma_f32_16x16x32_bf16 v[148:151], a[236:239], v[32:35], v[148:151]
 ds_read_b64_tr_b16 a[232:233], v7 offset:16384
 s_waitcnt lgkmcnt(5)
 v_mfma_f32_16x16x32_bf16 v[156:159], a[236:239], v[36:39], v[156:159]
 ds_read_b64_tr_b16 a[234:235], v7 offset:18432
 v_max3_f32 v12, v12, v59, v60
 v_mfma_f32_16x16x32_bf16 v[160:163], a[240:243], v[32:35], v[160:163]
 ds_read_b64_tr_b16 a[236:237], v8 offset:16384
 v_max3_f32 v11, v11, v53, v54
 v_mfma_f32_16x16x32_bf16 v[168:171], a[240:243], v[36:39], v[168:171]
 ds_read_b64_tr_b16 a[238:239], v8 offset:18432
 v_max3_f32 v12, v12, v61, v62
 v_mfma_f32_16x16x32_bf16 v[164:167], a[244:247], v[32:35], v[164:167]
 ds_read_b64_tr_b16 a[240:241], v5 offset:20480
 v_max_f32 v11, v11, v55
 v_mfma_f32_16x16x32_bf16 v[172:175], a[244:247], v[36:39], v[172:175]
 ds_read_b64_tr_b16 a[242:243], v5 offset:22528
 v_max_f32 v12, v12, v63
 v_mfma_f32_16x16x32_bf16 v[176:179], a[248:251], v[32:35], v[176:179]
 ds_read_b64_tr_b16 a[244:245], v6 offset:20480
 v_max_f32 v13, v11, v12
 v_mfma_f32_16x16x32_bf16 v[184:187], a[248:251], v[36:39], v[184:187]
 ds_read_b64_tr_b16 a[246:247], v6 offset:22528
 v_cmp_lt_f32 vcc, 0x41200000, v13
 v_mfma_f32_16x16x32_bf16 v[180:183], a[252:255], v[32:35], v[180:183]
 ds_read_b64_tr_b16 a[248:249], v7 offset:20480
 s_waitcnt lgkmcnt(5)
 s_cbranch_vccnz L_rs0_7
L_rb0_7:
 v_mfma_f32_16x16x32_bf16 v[188:191], a[252:255], v[36:39], v[188:191]
 ds_read_b64_tr_b16 a[250:251], v7 offset:22528
 v_mfma_f32_16x16x32_bf16 v[192:195], a[224:227], v[32:35], v[192:195]
 ds_read_b64_tr_b16 a[252:253], v8 offset:20480
 v_mfma_f32_16x16x32_bf16 v[200:203], a[224:227], v[36:39], v[200:203]
 ds_read_b64_tr_b16 a[254:255], v8 offset:22528
 v_mfma_f32_16x16x32_bf16 v[196:199], a[228:231], v[32:35], v[196:199]
 ds_read_b64_tr_b16 a[224:225], v24 offset:8192
 v_mfma_f32_16x16x32_bf16 v[204:207], a[228:231], v[36:39], v[204:207]
 ds_read_b64_tr_b16 a[226:227], v24 offset:10240
 v_mfma_f32_16x16x32_bf16 v[208:211], a[232:235], v[32:35], v[208:211]
 ds_read_b64_tr_b16 a[228:229], v24 offset:8200
 ds_read_b32 v10, v9
 v_mfma_f32_16x16x32_bf16 v[216:219], a[232:235], v[36:39], v[216:219]
 ds_read_b64_tr_b16 a[230:231], v24 offset:10248
 v_mfma_f32_16x16x32_bf16 v[212:215], a[236:239], v[32:35], v[212:215]
 ds_read_b64_tr_b16 a[232:233], v25 offset:8192
 s_waitcnt lgkmcnt(6)
 v_mfma_f32_16x16x32_bf16 v[220:223], a[236:239], v[36:39], v[220:223]
 ds_read_b64_tr_b16 a[234:235], v25 offset:10240
 v_mfma_f32_16x16x32_bf16 v[224:227], a[240:243], v[32:35], v[224:227]
 ds_read_b64_tr_b16 a[236:237], v25 offset:8200
 v_mfma_f32_16x16x32_bf16 v[232:235], a[240:243], v[36:39], v[232:235]
 ds_read_b64_tr_b16 a[238:239], v25 offset:10248
 v_mfma_f32_16x16x32_bf16 v[228:231], a[244:247], v[32:35], v[228:231]
 ds_read_b64_tr_b16 a[240:241], v24 offset:12288
 v_mfma_f32_16x16x32_bf16 v[236:239], a[244:247], v[36:39], v[236:239]
 ds_read_b64_tr_b16 a[242:243], v24 offset:14336
 s_movk_i32 s70, 268
 v_mfma_f32_16x16x32_bf16 v[240:243], a[248:251], v[32:35], v[240:243]
 ds_read_b64_tr_b16 a[244:245], v24 offset:12296
 v_mfma_f32_16x16x32_bf16 v[248:251], a[248:251], v[36:39], v[248:251]
 ds_read_b64_tr_b16 a[246:247], v24 offset:14344
 v_mfma_f32_16x16x32_bf16 v[244:247], a[252:255], v[32:35], v[244:247]
 ds_read_b64_tr_b16 a[248:249], v25 offset:12288
 s_waitcnt lgkmcnt(5)
 v_mfma_f32_16x16x32_bf16 v[252:255], a[252:255], v[36:39], v[252:255]
 ds_read_b64_tr_b16 a[250:251], v25 offset:14336
 buffer_load_dword off, s[72:75], s70 lds
 v_mfma_f32_16x16x32_bf16 a[176:179], a[224:227], a[32:35], a[176:179]
 ds_read_b64_tr_b16 a[252:253], v25 offset:12296
 v_cmp_le_u32 vcc, 76, v10
 v_mfma_f32_16x16x32_bf16 a[184:187], a[224:227], a[36:39], a[184:187]
 ds_read_b64_tr_b16 a[254:255], v25 offset:14344
 v_mfma_f32_16x16x32_bf16 a[180:183], a[228:231], a[32:35], a[180:183]
 s_cbranch_vccz L_cs544
L_cb544:
 ds_read_b64_tr_b16 a[224:225], v24 offset:16384
 v_mfma_f32_16x16x32_bf16 a[188:191], a[228:231], a[36:39], a[188:191]
 ds_read_b64_tr_b16 a[226:227], v24 offset:18432
 v_mfma_f32_16x16x32_bf16 a[192:195], a[232:235], a[32:35], a[192:195]
 ds_read_b64_tr_b16 a[228:229], v24 offset:16392
 ds_read_b32 v10, v9
 v_mfma_f32_16x16x32_bf16 a[200:203], a[232:235], a[36:39], a[200:203]
 ds_read_b64_tr_b16 a[230:231], v24 offset:18440
 v_mfma_f32_16x16x32_bf16 a[196:199], a[236:239], a[32:35], a[196:199]
 ds_read_b64_tr_b16 a[232:233], v25 offset:16384
 s_waitcnt lgkmcnt(6)
 v_mfma_f32_16x16x32_bf16 a[204:207], a[236:239], a[36:39], a[204:207]
 ds_read_b64_tr_b16 a[234:235], v25 offset:18432
 v_mfma_f32_16x16x32_bf16 a[176:179], a[240:243], a[40:43], a[176:179]
 ds_read_b64_tr_b16 a[236:237], v25 offset:16392
 v_mfma_f32_16x16x32_bf16 a[184:187], a[240:243], a[44:47], a[184:187]
 ds_read_b64_tr_b16 a[238:239], v25 offset:18440
 v_mfma_f32_16x16x32_bf16 a[180:183], a[244:247], a[40:43], a[180:183]
 ds_read_b64_tr_b16 a[240:241], v24 offset:20480
 v_mfma_f32_16x16x32_bf16 a[188:191], a[244:247], a[44:47], a[188:191]
 ds_read_b64_tr_b16 a[242:243], v24 offset:22528
 v_mfma_f32_16x16x32_bf16 a[192:195], a[248:251], a[40:43], a[192:195]
 ds_read_b64_tr_b16 a[244:245], v24 offset:20488
 v_mfma_f32_16x16x32_bf16 a[200:203], a[248:251], a[44:47], a[200:203]
 ds_read_b64_tr_b16 a[246:247], v24 offset:22536
 v_mfma_f32_16x16x32_bf16 a[196:199], a[252:255], a[40:43], a[196:199]
 ds_read_b64_tr_b16 a[248:249], v25 offset:20480
 s_waitcnt lgkmcnt(5)
 v_mfma_f32_16x16x32_bf16 a[204:207], a[252:255], a[44:47], a[204:207]
 ds_read_b64_tr_b16 a[250:251], v25 offset:22528
 v_mfma_f32_16x16x32_bf16 a[176:179], a[224:227], a[48:51], a[176:179]
 ds_read_b64_tr_b16 a[252:253], v25 offset:20488
 v_cmp_le_u32 vcc, 80, v10
 v_mfma_f32_16x16x32_bf16 a[184:187], a[224:227], a[52:55], a[184:187]
 ds_read_b64_tr_b16 a[254:255], v25 offset:22536
 v_mfma_f32_16x16x32_bf16 a[180:183], a[228:231], a[48:51], a[180:183]
 s_cbranch_vccz L_cs552
L_cb552:
 ds_read_b128 a[224:227], v3 offset:0
 v_mfma_f32_16x16x32_bf16 a[188:191], a[228:231], a[52:55], a[188:191]
 v_exp_f32 v48, v48
 v_mfma_f32_16x16x32_bf16 a[192:195], a[232:235], a[48:51], a[192:195]
 ds_read_b128 a[228:231], v3 offset:2048
 v_add_f32 v14, v14, v48
 v_mfma_f32_16x16x32_bf16 a[200:203], a[232:235], a[52:55], a[200:203]
 v_exp_f32 v49, v49
 v_mfma_f32_16x16x32_bf16 a[196:199], a[236:239], a[48:51], a[196:199]
 ds_read_b128 a[232:235], v4 offset:0
 s_waitcnt lgkmcnt(3)
 v_mfma_f32_16x16x32_bf16 a[204:207], a[236:239], a[52:55], a[204:207]
 v_exp_f32 v50, v50
 v_mfma_f32_16x16x32_bf16 a[176:179], a[240:243], a[56:59], a[176:179]
 ds_read_b128 a[236:239], v4 offset:2048
 v_add_f32 v14, v14, v49
 v_mfma_f32_16x16x32_bf16 a[184:187], a[240:243], a[60:63], a[184:187]
 v_exp_f32 v51, v51
 v_mfma_f32_16x16x32_bf16 a[180:183], a[244:247], a[56:59], a[180:183]
 ds_read_b128 a[240:243], v3 offset:4096
 v_add_u32 v5, 0xffff0000, v5
 v_mfma_f32_16x16x32_bf16 a[188:191], a[244:247], a[60:63], a[188:191]
 v_exp_f32 v52, v52
 v_mfma_f32_16x16x32_bf16 a[192:195], a[248:251], a[56:59], a[192:195]
 ds_read_b128 a[244:247], v3 offset:6144
 s_movk_i32 s70, 276
 v_mfma_f32_16x16x32_bf16 a[200:203], a[248:251], a[60:63], a[200:203]
 v_exp_f32 v53, v53
 v_mfma_f32_16x16x32_bf16 a[196:199], a[252:255], a[56:59], a[196:199]
 ds_read_b128 a[248:251], v4 offset:4096
 s_waitcnt lgkmcnt(3)
 v_add_u32 v3, 0xffff0000, v3
 v_add_u32 v6, 0xffff0000, v6
 v_mfma_f32_16x16x32_bf16 a[204:207], a[252:255], a[60:63], a[204:207]
 buffer_load_dword off, s[72:75], s70 lds
 v_add_u32 v7, 0xffff0000, v7
 v_exp_f32 v54, v54
 v_mfma_f32_16x16x32_bf16 v[32:35], a[224:227], v[64:67], v[16:19]
 ds_read_b128 a[252:255], v4 offset:6144
 v_add_u32 v4, 0xffff0000, v4
 v_add_u32 v8, 0xffff0000, v8
 v_mfma_f32_16x16x32_bf16 v[40:43], a[224:227], v[68:71], v[20:23]
 v_exp_f32 v55, v55
 v_mfma_f32_16x16x32_bf16 v[36:39], a[228:231], v[64:67], v[16:19]
 ds_read_b128 a[224:227], v3 offset:57344
 v_cvt_pk_bf16_f32 v48, v48, v49
 v_mfma_f32_16x16x32_bf16 v[44:47], a[228:231], v[68:71], v[20:23]
 v_exp_f32 v56, v56
 v_mfma_f32_16x16x32_bf16 v[32:35], a[232:235], v[72:75], v[32:35]
 ds_read_b128 a[228:231], v3 offset:59392
 v_add_f32 v14, v14, v50
 v_mfma_f32_16x16x32_bf16 v[40:43], a[232:235], v[76:79], v[40:43]
 v_exp_f32 v57, v57
 v_mfma_f32_16x16x32_bf16 v[36:39], a[236:239], v[72:75], v[36:39]
 ds_read_b128 a[232:235], v4 offset:57344
 s_waitcnt lgkmcnt(3)
 v_exp_f32 v58, v58
 v_mfma_f32_16x16x32_bf16 v[44:47], a[236:239], v[76:79], v[44:47]
 v_exp_f32 v59, v59
 v_mfma_f32_16x16x32_bf16 v[32:35], a[240:243], v[80:83], v[32:35]
 ds_read_b128 a[236:239], v4 offset:59392
 v_add_f32 v14, v14, v51
 v_mfma_f32_16x16x32_bf16 v[40:43], a[240:243], v[84:87], v[40:43]
 v_exp_f32 v60, v60
 v_mfma_f32_16x16x32_bf16 v[36:39], a[244:247], v[80:83], v[36:39]
 ds_read_b128 a[240:243], v3 offset:61440
 v_cvt_pk_bf16_f32 v49, v50, v51
 v_mfma_f32_16x16x32_bf16 v[44:47], a[244:247], v[84:87], v[44:47]
 v_exp_f32 v61, v61
 v_mfma_f32_16x16x32_bf16 v[32:35], a[248:251], v[88:91], v[32:35]
 ds_read_b128 a[244:247], v3 offset:63488
 v_add_f32 v14, v14, v52
 v_mfma_f32_16x16x32_bf16 v[40:43], a[248:251], v[92:95], v[40:43]
 v_exp_f32 v62, v62
 v_mfma_f32_16x16x32_bf16 v[36:39], a[252:255], v[88:91], v[36:39]
 ds_read_b128 a[248:251], v4 offset:61440
 s_waitcnt lgkmcnt(3)
 v_mfma_f32_16x16x32_bf16 v[44:47], a[252:255], v[92:95], v[44:47]
 v_exp_f32 v63, v63
 v_mfma_f32_16x16x32_bf16 v[32:35], a[224:227], v[96:99], v[32:35]
 ds_read_b128 a[252:255], v4 offset:63488
 v_add_f32 v14, v14, v53
 v_mfma_f32_16x16x32_bf16 v[40:43], a[224:227], v[100:103], v[40:43]
 v_cvt_pk_bf16_f32 v50, v52, v53
 v_add_f32 v14, v14, v54
 v_mfma_f32_16x16x32_bf16 v[36:39], a[228:231], v[96:99], v[36:39]
 ds_read_b64_tr_b16 a[224:225], v5 offset:16384
 v_add_f32 v14, v14, v55
 v_mfma_f32_16x16x32_bf16 v[44:47], a[228:231], v[100:103], v[44:47]
 ds_read_b64_tr_b16 a[226:227], v5 offset:18432
 v_cvt_pk_bf16_f32 v51, v54, v55
 v_mfma_f32_16x16x32_bf16 v[32:35], a[232:235], v[104:107], v[32:35]
 ds_read_b64_tr_b16 a[228:229], v6 offset:16384
 ds_read_b32 v10, v9
 v_add_f32 v15, v15, v56
 v_mfma_f32_16x16x32_bf16 v[40:43], a[232:235], v[108:111], v[40:43]
 ds_read_b64_tr_b16 a[230:231], v6 offset:18432
 v_add_f32 v15, v15, v57
 v_mfma_f32_16x16x32_bf16 v[36:39], a[236:239], v[104:107], v[36:39]
 ds_read_b64_tr_b16 a[232:233], v7 offset:16384
 s_waitcnt lgkmcnt(6)
 v_cvt_pk_bf16_f32 v52, v56, v57
 v_mfma_f32_16x16x32_bf16 v[44:47], a[236:239], v[108:111], v[44:47]
 ds_read_b64_tr_b16 a[234:235], v7 offset:18432
 v_add_f32 v15, v15, v58
 v_mfma_f32_16x16x32_bf16 v[32:35], a[240:243], v[112:115], v[32:35]
 ds_read_b64_tr_b16 a[236:237], v8 offset:16384
 v_add_f32 v15, v15, v59
 v_mfma_f32_16x16x32_bf16 v[40:43], a[240:243], v[116:119], v[40:43]
 ds_read_b64_tr_b16 a[238:239], v8 offset:18432
 v_cvt_pk_bf16_f32 v53, v58, v59
 v_mfma_f32_16x16x32_bf16 v[36:39], a[244:247], v[112:115], v[36:39]
 ds_read_b64_tr_b16 a[240:241], v5 offset:20480
 v_add_f32 v15, v15, v60
 v_mfma_f32_16x16x32_bf16 v[44:47], a[244:247], v[116:119], v[44:47]
 ds_read_b64_tr_b16 a[242:243], v5 offset:22528
 v_add_f32 v15, v15, v61
 v_mfma_f32_16x16x32_bf16 v[32:35], a[248:251], v[120:123], v[32:35]
 ds_read_b64_tr_b16 a[244:245], v6 offset:20480
 v_cvt_pk_bf16_f32 v54, v60, v61
 v_mfma_f32_16x16x32_bf16 v[40:43], a[248:251], v[124:127], v[40:43]
 ds_read_b64_tr_b16 a[246:247], v6 offset:22528
 v_add_f32 v15, v15, v62
 v_mfma_f32_16x16x32_bf16 v[36:39], a[252:255], v[120:123], v[36:39]
 ds_read_b64_tr_b16 a[248:249], v7 offset:20480
 v_add_f32 v15, v15, v63
 v_cvt_pk_bf16_f32 v55, v62, v63
 v_mfma_f32_16x16x32_bf16 v[44:47], a[252:255], v[124:127], v[44:47]
 ds_read_b64_tr_b16 a[250:251], v7 offset:22528
 s_waitcnt lgkmcnt(6)
 s_movk_i32 s70, 284
 v_mfma_f32_16x16x32_bf16 v[128:131], a[224:227], v[48:51], v[128:131]
 ds_read_b64_tr_b16 a[252:253], v8 offset:20480
 buffer_load_dword off, s[72:75], s70 lds
 v_cmp_le_u32 vcc, 81, v10
 v_mfma_f32_16x16x32_bf16 v[136:139], a[224:227], v[52:55], v[136:139]
 ds_read_b64_tr_b16 a[254:255], v8 offset:22528
 v_mfma_f32_16x16x32_bf16 v[132:135], a[228:231], v[48:51], v[132:135]
 s_cbranch_vccz L_cs576
L_cb576:
 ds_read_b64_tr_b16 a[224:225], v5 offset:24576
 v_mfma_f32_16x16x32_bf16 v[140:143], a[228:231], v[52:55], v[140:143]
 ds_read_b64_tr_b16 a[226:227], v5 offset:26624
 v_max3_f32 v11, v32, v33, v34
 v_mfma_f32_16x16x32_bf16 v[144:147], a[232:235], v[48:51], v[144:147]
 ds_read_b64_tr_b16 a[228:229], v6 offset:24576
 v_max3_f32 v12, v40, v41, v42
 v_mfma_f32_16x16x32_bf16 v[152:155], a[232:235], v[52:55], v[152:155]
 ds_read_b64_tr_b16 a[230:231], v6 offset:26624
 v_max3_f32 v11, v11, v35, v36
 v_mfma_f32_16x16x32_bf16 v[148:151], a[236:239], v[48:51], v[148:151]
 ds_read_b64_tr_b16 a[232:233], v7 offset:24576
 s_waitcnt lgkmcnt(5)
 v_mfma_f32_16x16x32_bf16 v[156:159], a[236:239], v[52:55], v[156:159]
 ds_read_b64_tr_b16 a[234:235], v7 offset:26624
 v_max3_f32 v12, v12, v43, v44
 v_mfma_f32_16x16x32_bf16 v[160:163], a[240:243], v[48:51], v[160:163]
 ds_read_b64_tr_b16 a[236:237], v8 offset:24576
 v_max3_f32 v11, v11, v37, v38
 v_mfma_f32_16x16x32_bf16 v[168:171], a[240:243], v[52:55], v[168:171]
 ds_read_b64_tr_b16 a[238:239], v8 offset:26624
 v_max3_f32 v12, v12, v45, v46
 v_mfma_f32_16x16x32_bf16 v[164:167], a[244:247], v[48:51], v[164:167]
 ds_read_b64_tr_b16 a[240:241], v5 offset:28672
 v_max_f32 v11, v11, v39
 v_mfma_f32_16x16x32_bf16 v[172:175], a[244:247], v[52:55], v[172:175]
 ds_read_b64_tr_b16 a[242:243], v5 offset:30720
 v_max_f32 v12, v12, v47
 v_mfma_f32_16x16x32_bf16 v[176:179], a[248:251], v[48:51], v[176:179]
 ds_read_b64_tr_b16 a[244:245], v6 offset:28672
 v_max_f32 v13, v11, v12
 v_mfma_f32_16x16x32_bf16 v[184:187], a[248:251], v[52:55], v[184:187]
 ds_read_b64_tr_b16 a[246:247], v6 offset:30720
 v_cmp_lt_f32 vcc, 0x41200000, v13
 v_mfma_f32_16x16x32_bf16 v[180:183], a[252:255], v[48:51], v[180:183]
 ds_read_b64_tr_b16 a[248:249], v7 offset:28672
 s_waitcnt lgkmcnt(5)
 s_cbranch_vccnz L_rs0_8
L_rb0_8:
 v_mfma_f32_16x16x32_bf16 v[188:191], a[252:255], v[52:55], v[188:191]
 ds_read_b64_tr_b16 a[250:251], v7 offset:30720
 v_mfma_f32_16x16x32_bf16 v[192:195], a[224:227], v[48:51], v[192:195]
 ds_read_b64_tr_b16 a[252:253], v8 offset:28672
 v_mfma_f32_16x16x32_bf16 v[200:203], a[224:227], v[52:55], v[200:203]
 ds_read_b64_tr_b16 a[254:255], v8 offset:30720
 v_mfma_f32_16x16x32_bf16 v[196:199], a[228:231], v[48:51], v[196:199]
 ds_read_b64_tr_b16 a[224:225], v24 offset:24576
 v_mfma_f32_16x16x32_bf16 v[204:207], a[228:231], v[52:55], v[204:207]
 ds_read_b64_tr_b16 a[226:227], v24 offset:26624
 v_mfma_f32_16x16x32_bf16 v[208:211], a[232:235], v[48:51], v[208:211]
 ds_read_b64_tr_b16 a[228:229], v24 offset:24584
 ds_read_b32 v10, v9
 v_mfma_f32_16x16x32_bf16 v[216:219], a[232:235], v[52:55], v[216:219]
 ds_read_b64_tr_b16 a[230:231], v24 offset:26632
 v_mfma_f32_16x16x32_bf16 v[212:215], a[236:239], v[48:51], v[212:215]
 ds_read_b64_tr_b16 a[232:233], v25 offset:24576
 s_waitcnt lgkmcnt(6)
 v_mfma_f32_16x16x32_bf16 v[220:223], a[236:239], v[52:55], v[220:223]
 ds_read_b64_tr_b16 a[234:235], v25 offset:26624
 v_mfma_f32_16x16x32_bf16 v[224:227], a[240:243], v[48:51], v[224:227]
 ds_read_b64_tr_b16 a[236:237], v25 offset:24584
 v_mfma_f32_16x16x32_bf16 v[232:235], a[240:243], v[52:55], v[232:235]
 ds_read_b64_tr_b16 a[238:239], v25 offset:26632
 v_mfma_f32_16x16x32_bf16 v[228:231], a[244:247], v[48:51], v[228:231]
 ds_read_b64_tr_b16 a[240:241], v24 offset:28672
 v_mfma_f32_16x16x32_bf16 v[236:239], a[244:247], v[52:55], v[236:239]
 ds_read_b64_tr_b16 a[242:243], v24 offset:30720
 s_movk_i32 s70, 292
 v_mfma_f32_16x16x32_bf16 v[240:243], a[248:251], v[48:51], v[240:243]
 ds_read_b64_tr_b16 a[244:245], v24 offset:28680
 v_mfma_f32_16x16x32_bf16 v[248:251], a[248:251], v[52:55], v[248:251]
 ds_read_b64_tr_b16 a[246:247], v24 offset:30728
 v_mfma_f32_16x16x32_bf16 v[244:247], a[252:255], v[48:51], v[244:247]
 ds_read_b64_tr_b16 a[248:249], v25 offset:28672
 s_waitcnt lgkmcnt(5)
 v_mfma_f32_16x16x32_bf16 v[252:255], a[252:255], v[52:55], v[252:255]
 ds_read_b64_tr_b16 a[250:251], v25 offset:30720
 buffer_load_dword off, s[72:75], s70 lds
 v_mfma_f32_16x16x32_bf16 a[176:179], a[224:227], a[64:67], a[176:179]
 ds_read_b64_tr_b16 a[252:253], v25 offset:28680
 v_cmp_le_u32 vcc, 83, v10
 v_mfma_f32_16x16x32_bf16 a[184:187], a[224:227], a[68:71], a[184:187]
 ds_read_b64_tr_b16 a[254:255], v25 offset:30728
 v_mfma_f32_16x16x32_bf16 a[180:183], a[228:231], a[64:67], a[180:183]
 s_cbranch_vccz L_cs592
L_cb592:
 ds_read_b64_tr_b16 a[224:225], v24 offset:40960
 v_mfma_f32_16x16x32_bf16 a[188:191], a[228:231], a[68:71], a[188:191]
 ds_read_b64_tr_b16 a[226:227], v24 offset:43008
 v_mfma_f32_16x16x32_bf16 a[192:195], a[232:235], a[64:67], a[192:195]
 ds_read_b64_tr_b16 a[228:229], v24 offset:40968
 v_mfma_f32_16x16x32_bf16 a[200:203], a[232:235], a[68:71], a[200:203]
 ds_read_b64_tr_b16 a[230:231], v24 offset:43016
 v_mfma_f32_16x16x32_bf16 a[196:199], a[236:239], a[64:67], a[196:199]
 ds_read_b64_tr_b16 a[232:233], v25 offset:40960
 s_waitcnt lgkmcnt(5)
 v_mfma_f32_16x16x32_bf16 a[204:207], a[236:239], a[68:71], a[204:207]
 ds_read_b64_tr_b16 a[234:235], v25 offset:43008
 v_mfma_f32_16x16x32_bf16 a[176:179], a[240:243], a[72:75], a[176:179]
 ds_read_b64_tr_b16 a[236:237], v25 offset:40968
 v_mfma_f32_16x16x32_bf16 a[184:187], a[240:243], a[76:79], a[184:187]
 ds_read_b64_tr_b16 a[238:239], v25 offset:43016
 v_mfma_f32_16x16x32_bf16 a[180:183], a[244:247], a[72:75], a[180:183]
 ds_read_b64_tr_b16 a[240:241], v24 offset:45056
 v_mfma_f32_16x16x32_bf16 a[188:191], a[244:247], a[76:79], a[188:191]
 ds_read_b64_tr_b16 a[242:243], v24 offset:47104
 v_mfma_f32_16x16x32_bf16 a[192:195], a[248:251], a[72:75], a[192:195]
 ds_read_b64_tr_b16 a[244:245], v24 offset:45064
 v_mfma_f32_16x16x32_bf16 a[200:203], a[248:251], a[76:79], a[200:203]
 ds_read_b64_tr_b16 a[246:247], v24 offset:47112
 v_mfma_f32_16x16x32_bf16 a[196:199], a[252:255], a[72:75], a[196:199]
 ds_read_b64_tr_b16 a[248:249], v25 offset:45056
 s_waitcnt lgkmcnt(5)
 v_mfma_f32_16x16x32_bf16 a[204:207], a[252:255], a[76:79], a[204:207]
 ds_read_b64_tr_b16 a[250:251], v25 offset:47104
 v_mfma_f32_16x16x32_bf16 a[176:179], a[224:227], a[80:83], a[176:179]
 ds_read_b64_tr_b16 a[252:253], v25 offset:45064
 v_mfma_f32_16x16x32_bf16 a[184:187], a[224:227], a[84:87], a[184:187]
 ds_read_b64_tr_b16 a[254:255], v25 offset:47112
 v_mfma_f32_16x16x32_bf16 a[180:183], a[228:231], a[80:83], a[180:183]
 ds_read_b64_tr_b16 a[224:225], v24 offset:32768
 v_mfma_f32_16x16x32_bf16 a[188:191], a[228:231], a[84:87], a[188:191]
 ds_read_b64_tr_b16 a[226:227], v24 offset:34816
 v_mfma_f32_16x16x32_bf16 a[192:195], a[232:235], a[80:83], a[192:195]
 ds_read_b64_tr_b16 a[228:229], v24 offset:32776
 ds_read_b32 v10, v9
 v_mfma_f32_16x16x32_bf16 a[200:203], a[232:235], a[84:87], a[200:203]
 ds_read_b64_tr_b16 a[230:231], v24 offset:34824
 v_mfma_f32_16x16x32_bf16 a[196:199], a[236:239], a[80:83], a[196:199]
 ds_read_b64_tr_b16 a[232:233], v25 offset:32768
 s_waitcnt lgkmcnt(6)
 v_mfma_f32_16x16x32_bf16 a[204:207], a[236:239], a[84:87], a[204:207]
 ds_read_b64_tr_b16 a[234:235], v25 offset:34816
 v_mfma_f32_16x16x32_bf16 a[176:179], a[240:243], a[88:91], a[176:179]
 ds_read_b64_tr_b16 a[236:237], v25 offset:32776
 v_mfma_f32_16x16x32_bf16 a[184:187], a[240:243], a[92:95], a[184:187]
 ds_read_b64_tr_b16 a[238:239], v25 offset:34824
 v_mfma_f32_16x16x32_bf16 a[180:183], a[244:247], a[88:91], a[180:183]
 ds_read_b64_tr_b16 a[240:241], v24 offset:36864
 v_mfma_f32_16x16x32_bf16 a[188:191], a[244:247], a[92:95], a[188:191]
 ds_read_b64_tr_b16 a[242:243], v24 offset:38912
 s_movk_i32 s70, 300
 v_mfma_f32_16x16x32_bf16 a[192:195], a[248:251], a[88:91], a[192:195]
 ds_read_b64_tr_b16 a[244:245], v24 offset:36872
 v_mfma_f32_16x16x32_bf16 a[200:203], a[248:251], a[92:95], a[200:203]
 ds_read_b64_tr_b16 a[246:247], v24 offset:38920
 v_mfma_f32_16x16x32_bf16 a[196:199], a[252:255], a[88:91], a[196:199]
 ds_read_b64_tr_b16 a[248:249], v25 offset:36864
 s_waitcnt lgkmcnt(5)
 v_mfma_f32_16x16x32_bf16 a[204:207], a[252:255], a[92:95], a[204:207]
 ds_read_b64_tr_b16 a[250:251], v25 offset:38912
 buffer_load_dword off, s[72:75], s70 lds
 v_mfma_f32_16x16x32_bf16 a[176:179], a[224:227], a[96:99], a[176:179]
 ds_read_b64_tr_b16 a[252:253], v25 offset:36872
 v_cmp_le_u32 vcc, 86, v10
 v_mfma_f32_16x16x32_bf16 a[184:187], a[224:227], a[100:103], a[184:187]
 ds_read_b64_tr_b16 a[254:255], v25 offset:38920
 v_mfma_f32_16x16x32_bf16 a[180:183], a[228:231], a[96:99], a[180:183]
 s_cbranch_vccz L_cs608
L_cb608:
 ds_read_b128 a[224:227], v3 offset:49152
 v_mfma_f32_16x16x32_bf16 a[188:191], a[228:231], a[100:103], a[188:191]
 v_exp_f32 v32, v32
 v_mfma_f32_16x16x32_bf16 a[192:195], a[232:235], a[96:99], a[192:195]
 ds_read_b128 a[228:231], v3 offset:51200
 v_add_f32 v14, v14, v32
 v_mfma_f32_16x16x32_bf16 a[200:203], a[232:235], a[100:103], a[200:203]
 v_exp_f32 v33, v33
 v_mfma_f32_16x16x32_bf16 a[196:199], a[236:239], a[96:99], a[196:199]
 ds_read_b128 a[232:235], v4 offset:49152
 s_waitcnt lgkmcnt(3)
 v_mfma_f32_16x16x32_bf16 a[204:207], a[236:239], a[100:103], a[204:207]
 v_exp_f32 v34, v34
 v_mfma_f32_16x16x32_bf16 a[176:179], a[240:243], a[104:107], a[176:179]
 ds_read_b128 a[236:239], v4 offset:51200
 v_add_f32 v14, v14, v33
 v_mfma_f32_16x16x32_bf16 a[184:187], a[240:243], a[108:111], a[184:187]
 v_exp_f32 v35, v35
 v_mfma_f32_16x16x32_bf16 a[180:183], a[244:247], a[104:107], a[180:183]
 ds_read_b128 a[240:243], v3 offset:53248
 v_cvt_pk_bf16_f32 v32, v32, v33
 v_mfma_f32_16x16x32_bf16 a[188:191], a[244:247], a[108:111], a[188:191]
 v_exp_f32 v36, v36
 v_mfma_f32_16x16x32_bf16 a[192:195], a[248:251], a[104:107], a[192:195]
 ds_read_b128 a[244:247], v3 offset:55296
 s_movk_i32 s70, 304
 v_mfma_f32_16x16x32_bf16 a[200:203], a[248:251], a[108:111], a[200:203]
 v_exp_f32 v37, v37
 v_mfma_f32_16x16x32_bf16 a[196:199], a[252:255], a[104:107], a[196:199]
 ds_read_b128 a[248:251], v4 offset:53248
 s_waitcnt lgkmcnt(3)
 v_mfma_f32_16x16x32_bf16 a[204:207], a[252:255], a[108:111], a[204:207]
 buffer_load_dword off, s[72:75], s70 lds
 v_add_u32 v3, 0x10000, v3
 v_mfma_f32_16x16x32_bf16 v[48:51], a[224:227], v[64:67], v[16:19]
 ds_read_b128 a[252:255], v4 offset:55296
 v_add_u32 v4, 0x10000, v4
 v_exp_f32 v38, v38
 v_mfma_f32_16x16x32_bf16 v[56:59], a[224:227], v[68:71], v[20:23]
 v_exp_f32 v39, v39
 v_mfma_f32_16x16x32_bf16 v[52:55], a[228:231], v[64:67], v[16:19]
 ds_read_b128 a[224:227], v3 offset:57344
 v_add_f32 v14, v14, v34
 v_exp_f32 v40, v40
 v_exp_f32 v41, v41
 v_exp_f32 v42, v42
 v_exp_f32 v43, v43
 v_exp_f32 v44, v44
 v_exp_f32 v45, v45
 v_exp_f32 v46, v46
 v_exp_f32 v47, v47
 v_add_f32 v14, v14, v35
 v_cvt_pk_bf16_f32 v33, v34, v35
 v_add_f32 v14, v14, v36
 v_add_f32 v14, v14, v37
 v_cvt_pk_bf16_f32 v34, v36, v37
 v_add_f32 v14, v14, v38
 v_add_f32 v14, v14, v39
 v_cvt_pk_bf16_f32 v35, v38, v39
 v_accvgpr_read_b32 v28, a176
 v_accvgpr_read_b32 v29, a177
 v_mul_f32 v28, s32, v28
 v_mul_f32 v29, s32, v29
 v_cvt_pk_bf16_f32 v28, v28, v29
 v_accvgpr_write_b32 a128, v28
 v_accvgpr_read_b32 v30, a178
 v_accvgpr_read_b32 v31, a179
 v_mul_f32 v30, s32, v30
 v_mul_f32 v31, s32, v31
 v_cvt_pk_bf16_f32 v30, v30, v31
 v_accvgpr_write_b32 a129, v30
 v_accvgpr_read_b32 v28, a180
 v_accvgpr_read_b32 v29, a181
 v_mul_f32 v28, s32, v28
 v_mul_f32 v29, s32, v29
 v_cvt_pk_bf16_f32 v28, v28, v29
 v_accvgpr_write_b32 a130, v28
 v_accvgpr_read_b32 v30, a182
 v_accvgpr_read_b32 v31, a183
 v_mul_f32 v30, s32, v30
 v_mul_f32 v31, s32, v31
 v_cvt_pk_bf16_f32 v30, v30, v31
 v_accvgpr_write_b32 a131, v30
 v_accvgpr_read_b32 v28, a184
 v_accvgpr_read_b32 v29, a185
 v_mul_f32 v28, s32, v28
 v_mul_f32 v29, s32, v29
 v_cvt_pk_bf16_f32 v28, v28, v29
 v_accvgpr_write_b32 a132, v28
 v_accvgpr_read_b32 v30, a186
 v_accvgpr_read_b32 v31, a187
 v_mul_f32 v30, s32, v30
 v_mul_f32 v31, s32, v31
 v_cvt_pk_bf16_f32 v30, v30, v31
 v_accvgpr_write_b32 a133, v30
 v_accvgpr_read_b32 v28, a188
 v_accvgpr_read_b32 v29, a189
 v_mul_f32 v28, s32, v28
 v_mul_f32 v29, s32, v29
 v_cvt_pk_bf16_f32 v28, v28, v29
 v_mfma_f32_16x16x32_bf16 v[60:63], a[228:231], v[68:71], v[20:23]
 v_add_f32 v15, v15, v40
 v_add_f32 v15, v15, v41
 v_mfma_f32_16x16x32_bf16 v[48:51], a[232:235], v[72:75], v[48:51]
 ds_read_b128 a[228:231], v3 offset:59392
 v_cvt_pk_bf16_f32 v36, v40, v41
 v_mfma_f32_16x16x32_bf16 v[56:59], a[232:235], v[76:79], v[56:59]
 v_add_f32 v15, v15, v42
 v_add_f32 v15, v15, v43
 v_mfma_f32_16x16x32_bf16 v[52:55], a[236:239], v[72:75], v[52:55]
 ds_read_b128 a[232:235], v4 offset:57344
 s_waitcnt lgkmcnt(3)
 v_cvt_pk_bf16_f32 v37, v42, v43
 v_mfma_f32_16x16x32_bf16 v[60:63], a[236:239], v[76:79], v[60:63]
 v_add_f32 v15, v15, v44
 v_add_f32 v15, v15, v45
 v_mfma_f32_16x16x32_bf16 v[48:51], a[240:243], v[80:83], v[48:51]
 ds_read_b128 a[236:239], v4 offset:59392
 v_cvt_pk_bf16_f32 v38, v44, v45
 v_mfma_f32_16x16x32_bf16 v[56:59], a[240:243], v[84:87], v[56:59]
 v_add_f32 v15, v15, v46
 v_add_f32 v15, v15, v47
 v_mfma_f32_16x16x32_bf16 v[52:55], a[244:247], v[80:83], v[52:55]
 ds_read_b128 a[240:243], v3 offset:61440
 v_cvt_pk_bf16_f32 v39, v46, v47
 v_mfma_f32_16x16x32_bf16 v[60:63], a[244:247], v[84:87], v[60:63]
 v_accvgpr_write_b32 a134, v28
 v_accvgpr_read_b32 v30, a190
 v_mfma_f32_16x16x32_bf16 v[48:51], a[248:251], v[88:91], v[48:51]
 ds_read_b128 a[244:247], v3 offset:63488
 v_accvgpr_read_b32 v31, a191
 v_mfma_f32_16x16x32_bf16 v[56:59], a[248:251], v[92:95], v[56:59]
 v_mul_f32 v30, s32, v30
 v_mul_f32 v31, s32, v31
 v_mfma_f32_16x16x32_bf16 v[52:55], a[252:255], v[88:91], v[52:55]
 ds_read_b128 a[248:251], v4 offset:61440
 s_waitcnt lgkmcnt(3)
 v_cvt_pk_bf16_f32 v30, v30, v31
 v_mfma_f32_16x16x32_bf16 v[60:63], a[252:255], v[92:95], v[60:63]
 v_accvgpr_write_b32 a135, v30
 v_accvgpr_read_b32 v28, a192
 v_mfma_f32_16x16x32_bf16 v[48:51], a[224:227], v[96:99], v[48:51]
 ds_read_b128 a[252:255], v4 offset:63488
 v_accvgpr_read_b32 v29, a193
 v_mfma_f32_16x16x32_bf16 v[56:59], a[224:227], v[100:103], v[56:59]
 v_mul_f32 v28, s32, v28
 v_mul_f32 v29, s32, v29
 v_mfma_f32_16x16x32_bf16 v[52:55], a[228:231], v[96:99], v[52:55]
 ds_read_b64_tr_b16 a[224:225], v5 offset:32768
 v_cvt_pk_bf16_f32 v28, v28, v29
 v_mfma_f32_16x16x32_bf16 v[60:63], a[228:231], v[100:103], v[60:63]
 ds_read_b64_tr_b16 a[226:227], v5 offset:34816
 v_accvgpr_write_b32 a136, v28
 v_mfma_f32_16x16x32_bf16 v[48:51], a[232:235], v[104:107], v[48:51]
 ds_read_b64_tr_b16 a[228:229], v6 offset:32768
 ds_read_b32 v10, v9
 v_accvgpr_read_b32 v30, a194
 v_mfma_f32_16x16x32_bf16 v[56:59], a[232:235], v[108:111], v[56:59]
 ds_read_b64_tr_b16 a[230:231], v6 offset:34816
 v_accvgpr_read_b32 v31, a195
 v_mfma_f32_16x16x32_bf16 v[52:55], a[236:239], v[104:107], v[52:55]
 ds_read_b64_tr_b16 a[232:233], v7 offset:32768
 s_waitcnt lgkmcnt(6)
 v_mul_f32 v30, s32, v30
 v_mfma_f32_16x16x32_bf16 v[60:63], a[236:239], v[108:111], v[60:63]
 ds_read_b64_tr_b16 a[234:235], v7 offset:34816
 v_mul_f32 v31, s32, v31
 v_mfma_f32_16x16x32_bf16 v[48:51], a[240:243], v[112:115], v[48:51]
 ds_read_b64_tr_b16 a[236:237], v8 offset:32768
 v_cvt_pk_bf16_f32 v30, v30, v31
 v_mfma_f32_16x16x32_bf16 v[56:59], a[240:243], v[116:119], v[56:59]
 ds_read_b64_tr_b16 a[238:239], v8 offset:34816
 v_accvgpr_write_b32 a137, v30
 v_mfma_f32_16x16x32_bf16 v[52:55], a[244:247], v[112:115], v[52:55]
 ds_read_b64_tr_b16 a[240:241], v5 offset:36864
 v_accvgpr_read_b32 v28, a196
 v_mfma_f32_16x16x32_bf16 v[60:63], a[244:247], v[116:119], v[60:63]
 ds_read_b64_tr_b16 a[242:243], v5 offset:38912
 s_movk_i32 s70, 312
 v_accvgpr_read_b32 v29, a197
 v_mfma_f32_16x16x32_bf16 v[48:51], a[248:251], v[120:123], v[48:51]
 ds_read_b64_tr_b16 a[244:245], v6 offset:36864
 v_mul_f32 v28, s32, v28
 v_mfma_f32_16x16x32_bf16 v[56:59], a[248:251], v[124:127], v[56:59]
 ds_read_b64_tr_b16 a[246:247], v6 offset:38912
 v_mul_f32 v29, s32, v29
 v_mfma_f32_16x16x32_bf16 v[52:55], a[252:255], v[120:123], v[52:55]
 ds_read_b64_tr_b16 a[248:249], v7 offset:36864
 s_waitcnt lgkmcnt(5)
 v_cvt_pk_bf16_f32 v28, v28, v29
 v_mfma_f32_16x16x32_bf16 v[60:63], a[252:255], v[124:127], v[60:63]
 ds_read_b64_tr_b16 a[250:251], v7 offset:38912
 buffer_load_dword off, s[72:75], s70 lds
 v_accvgpr_write_b32 a138, v28
 v_mfma_f32_16x16x32_bf16 v[128:131], a[224:227], v[32:35], v[128:131]
 ds_read_b64_tr_b16 a[252:253], v8 offset:36864
 v_cmp_le_u32 vcc, 87, v10
 v_accvgpr_read_b32 v30, a198
 v_mfma_f32_16x16x32_bf16 v[136:139], a[224:227], v[36:39], v[136:139]
 ds_read_b64_tr_b16 a[254:255], v8 offset:38912
 v_accvgpr_read_b32 v31, a199
 v_mfma_f32_16x16x32_bf16 v[132:135], a[228:231], v[32:35], v[132:135]
 s_cbranch_vccz L_cs632
L_cb632:
 ds_read_b64_tr_b16 a[224:225], v5 offset:40960
 v_max3_f32 v11, v48, v49, v50
 v_max3_f32 v12, v56, v57, v58
 v_max3_f32 v11, v11, v51, v52
 v_max3_f32 v12, v12, v59, v60
 v_max3_f32 v11, v11, v53, v54
 v_max3_f32 v12, v12, v61, v62
 v_max_f32 v11, v11, v55
 v_max_f32 v12, v12, v63
 v_max_f32 v13, v11, v12
 v_mfma_f32_16x16x32_bf16 v[140:143], a[228:231], v[36:39], v[140:143]
 ds_read_b64_tr_b16 a[226:227], v5 offset:43008
 v_mul_f32 v30, s32, v30
 v_mfma_f32_16x16x32_bf16 v[144:147], a[232:235], v[32:35], v[144:147]
 ds_read_b64_tr_b16 a[228:229], v6 offset:40960
 ds_read_b32 v10, v9
 v_mul_f32 v31, s32, v31
 v_mfma_f32_16x16x32_bf16 v[152:155], a[232:235], v[36:39], v[152:155]
 ds_read_b64_tr_b16 a[230:231], v6 offset:43008
 v_cvt_pk_bf16_f32 v30, v30, v31
 v_mfma_f32_16x16x32_bf16 v[148:151], a[236:239], v[32:35], v[148:151]
 ds_read_b64_tr_b16 a[232:233], v7 offset:40960
 s_waitcnt lgkmcnt(6)
 v_accvgpr_write_b32 a139, v30
 v_mfma_f32_16x16x32_bf16 v[156:159], a[236:239], v[36:39], v[156:159]
 ds_read_b64_tr_b16 a[234:235], v7 offset:43008
 v_accvgpr_read_b32 v28, a200
 v_mfma_f32_16x16x32_bf16 v[160:163], a[240:243], v[32:35], v[160:163]
 ds_read_b64_tr_b16 a[236:237], v8 offset:40960
 v_accvgpr_read_b32 v29, a201
 v_mfma_f32_16x16x32_bf16 v[168:171], a[240:243], v[36:39], v[168:171]
 ds_read_b64_tr_b16 a[238:239], v8 offset:43008
 v_mul_f32 v28, s32, v28
 v_mfma_f32_16x16x32_bf16 v[164:167], a[244:247], v[32:35], v[164:167]
 ds_read_b64_tr_b16 a[240:241], v5 offset:45056
 v_mul_f32 v29, s32, v29
 v_mfma_f32_16x16x32_bf16 v[172:175], a[244:247], v[36:39], v[172:175]
 ds_read_b64_tr_b16 a[242:243], v5 offset:47104
 v_cvt_pk_bf16_f32 v28, v28, v29
 v_mfma_f32_16x16x32_bf16 v[176:179], a[248:251], v[32:35], v[176:179]
 ds_read_b64_tr_b16 a[244:245], v6 offset:45056
 v_accvgpr_write_b32 a140, v28
 v_mfma_f32_16x16x32_bf16 v[184:187], a[248:251], v[36:39], v[184:187]
 ds_read_b64_tr_b16 a[246:247], v6 offset:47104
 v_cmp_lt_f32 vcc, 0x41200000, v13
 v_accvgpr_read_b32 v30, a202
 v_mfma_f32_16x16x32_bf16 v[180:183], a[252:255], v[32:35], v[180:183]
 ds_read_b64_tr_b16 a[248:249], v7 offset:45056
 s_waitcnt lgkmcnt(5)
 s_cbranch_vccnz L_rs0_9
L_rb0_9:
 v_accvgpr_read_b32 v31, a203
 v_mfma_f32_16x16x32_bf16 v[188:191], a[252:255], v[36:39], v[188:191]
 ds_read_b64_tr_b16 a[250:251], v7 offset:47104
 v_mul_f32 v30, s32, v30
 v_mfma_f32_16x16x32_bf16 v[192:195], a[224:227], v[32:35], v[192:195]
 ds_read_b64_tr_b16 a[252:253], v8 offset:45056
 v_cmp_le_u32 vcc, 89, v10
 v_mul_f32 v31, s32, v31
 v_mfma_f32_16x16x32_bf16 v[200:203], a[224:227], v[36:39], v[200:203]
 ds_read_b64_tr_b16 a[254:255], v8 offset:47104
 v_cvt_pk_bf16_f32 v30, v30, v31
 v_mfma_f32_16x16x32_bf16 v[196:199], a[228:231], v[32:35], v[196:199]
 s_cbranch_vccz L_cs640
L_cb640:
 ds_read_b64_tr_b16 a[224:225], v24 offset:0
 v_mfma_f32_16x16x32_bf16 v[204:207], a[228:231], v[36:39], v[204:207]
 ds_read_b64_tr_b16 a[226:227], v24 offset:2048
 v_accvgpr_write_b32 a141, v30
 v_mfma_f32_16x16x32_bf16 v[208:211], a[232:235], v[32:35], v[208:211]
 ds_read_b64_tr_b16 a[228:229], v24 offset:8
 v_accvgpr_read_b32 v28, a204
 v_mfma_f32_16x16x32_bf16 v[216:219], a[232:235], v[36:39], v[216:219]
 ds_read_b64_tr_b16 a[230:231], v24 offset:2056
 v_accvgpr_read_b32 v29, a205
 v_mfma_f32_16x16x32_bf16 v[212:215], a[236:239], v[32:35], v[212:215]
 ds_read_b64_tr_b16 a[232:233], v25 offset:0
 s_waitcnt lgkmcnt(5)
 v_mul_f32 v28, s32, v28
 v_mfma_f32_16x16x32_bf16 v[220:223], a[236:239], v[36:39], v[220:223]
 ds_read_b64_tr_b16 a[234:235], v25 offset:2048
 v_mul_f32 v29, s32, v29
 v_mfma_f32_16x16x32_bf16 v[224:227], a[240:243], v[32:35], v[224:227]
 ds_read_b64_tr_b16 a[236:237], v25 offset:8
 v_cvt_pk_bf16_f32 v28, v28, v29
 v_mfma_f32_16x16x32_bf16 v[232:235], a[240:243], v[36:39], v[232:235]
 ds_read_b64_tr_b16 a[238:239], v25 offset:2056
 v_accvgpr_write_b32 a142, v28
 v_mfma_f32_16x16x32_bf16 v[228:231], a[244:247], v[32:35], v[228:231]
 ds_read_b64_tr_b16 a[240:241], v24 offset:4096
 v_accvgpr_read_b32 v30, a206
 v_mfma_f32_16x16x32_bf16 v[236:239], a[244:247], v[36:39], v[236:239]
 ds_read_b64_tr_b16 a[242:243], v24 offset:6144
 v_accvgpr_read_b32 v31, a207
 v_mfma_f32_16x16x32_bf16 v[240:243], a[248:251], v[32:35], v[240:243]
 ds_read_b64_tr_b16 a[244:245], v24 offset:4104
 v_mul_f32 v30, s32, v30
 v_mfma_f32_16x16x32_bf16 v[248:251], a[248:251], v[36:39], v[248:251]
 ds_read_b64_tr_b16 a[246:247], v24 offset:6152
 v_mul_f32 v31, s32, v31
 v_mfma_f32_16x16x32_bf16 v[244:247], a[252:255], v[32:35], v[244:247]
 ds_read_b64_tr_b16 a[248:249], v25 offset:4096
 v_cvt_pk_bf16_f32 v30, v30, v31
 v_accvgpr_write_b32 a143, v30
 v_mfma_f32_16x16x32_bf16 v[252:255], a[252:255], v[36:39], v[252:255]
 ds_read_b64_tr_b16 a[250:251], v25 offset:6144
 s_waitcnt lgkmcnt(6)
 s_movk_i32 s70, 320
 v_mfma_f32_16x16x32_bf16 a[176:179], a[224:227], a[0:3], 0
 ds_read_b64_tr_b16 a[252:253], v25 offset:4104
 buffer_load_dword off, s[72:75], s70 lds
 v_mfma_f32_16x16x32_bf16 a[184:187], a[224:227], a[4:7], 0
 ds_read_b64_tr_b16 a[254:255], v25 offset:6152
 v_mfma_f32_16x16x32_bf16 a[180:183], a[228:231], a[0:3], 0
 ds_read_b64_tr_b16 a[224:225], v24 offset:8192
 v_mfma_f32_16x16x32_bf16 a[188:191], a[228:231], a[4:7], 0
 ds_read_b64_tr_b16 a[226:227], v24 offset:10240
 v_mfma_f32_16x16x32_bf16 a[192:195], a[232:235], a[0:3], 0
 ds_read_b64_tr_b16 a[228:229], v24 offset:8200
 ds_read_b32 v10, v9
 v_mfma_f32_16x16x32_bf16 a[200:203], a[232:235], a[4:7], 0
 ds_read_b64_tr_b16 a[230:231], v24 offset:10248
 v_mfma_f32_16x16x32_bf16 a[196:199], a[236:239], a[0:3], 0
 ds_read_b64_tr_b16 a[232:233], v25 offset:8192
 s_waitcnt lgkmcnt(6)
 v_mfma_f32_16x16x32_bf16 a[204:207], a[236:239], a[4:7], 0
 ds_read_b64_tr_b16 a[234:235], v25 offset:10240
 v_mfma_f32_16x16x32_bf16 a[176:179], a[240:243], a[8:11], a[176:179]
 ds_read_b64_tr_b16 a[236:237], v25 offset:8200
 v_mfma_f32_16x16x32_bf16 a[184:187], a[240:243], a[12:15], a[184:187]
 ds_read_b64_tr_b16 a[238:239], v25 offset:10248
 v_mfma_f32_16x16x32_bf16 a[180:183], a[244:247], a[8:11], a[180:183]
 ds_read_b64_tr_b16 a[240:241], v24 offset:12288
 v_mfma_f32_16x16x32_bf16 a[188:191], a[244:247], a[12:15], a[188:191]
 ds_read_b64_tr_b16 a[242:243], v24 offset:14336
 v_mfma_f32_16x16x32_bf16 a[192:195], a[248:251], a[8:11], a[192:195]
 ds_read_b64_tr_b16 a[244:245], v24 offset:12296
 v_mfma_f32_16x16x32_bf16 a[200:203], a[248:251], a[12:15], a[200:203]
 ds_read_b64_tr_b16 a[246:247], v24 offset:14344
 v_mfma_f32_16x16x32_bf16 a[196:199], a[252:255], a[8:11], a[196:199]
 ds_read_b64_tr_b16 a[248:249], v25 offset:12288
 s_waitcnt lgkmcnt(5)
 v_mfma_f32_16x16x32_bf16 a[204:207], a[252:255], a[12:15], a[204:207]
 ds_read_b64_tr_b16 a[250:251], v25 offset:14336
 v_mfma_f32_16x16x32_bf16 a[176:179], a[224:227], a[16:19], a[176:179]
 ds_read_b64_tr_b16 a[252:253], v25 offset:12296
 v_cmp_le_u32 vcc, 92, v10
 v_mfma_f32_16x16x32_bf16 a[184:187], a[224:227], a[20:23], a[184:187]
 ds_read_b64_tr_b16 a[254:255], v25 offset:14344
 v_mfma_f32_16x16x32_bf16 a[180:183], a[228:231], a[16:19], a[180:183]
 s_cbranch_vccz L_cs656
L_cb656:
 ds_read_b128 a[224:227], v3 offset:49152
 v_mfma_f32_16x16x32_bf16 a[188:191], a[228:231], a[20:23], a[188:191]
 v_exp_f32 v48, v48
 v_mfma_f32_16x16x32_bf16 a[192:195], a[232:235], a[16:19], a[192:195]
 ds_read_b128 a[228:231], v3 offset:51200
 v_add_f32 v14, v14, v48
 v_mfma_f32_16x16x32_bf16 a[200:203], a[232:235], a[20:23], a[200:203]
 v_exp_f32 v49, v49
 v_mfma_f32_16x16x32_bf16 a[196:199], a[236:239], a[16:19], a[196:199]
 ds_read_b128 a[232:235], v4 offset:49152
 s_waitcnt lgkmcnt(3)
 v_mfma_f32_16x16x32_bf16 a[204:207], a[236:239], a[20:23], a[204:207]
 v_exp_f32 v50, v50
 v_mfma_f32_16x16x32_bf16 a[176:179], a[240:243], a[24:27], a[176:179]
 ds_read_b128 a[236:239], v4 offset:51200
 v_add_f32 v14, v14, v49
 v_mfma_f32_16x16x32_bf16 a[184:187], a[240:243], a[28:31], a[184:187]
 v_exp_f32 v51, v51
 v_mfma_f32_16x16x32_bf16 a[180:183], a[244:247], a[24:27], a[180:183]
 ds_read_b128 a[240:243], v3 offset:53248
 v_add_u32 v5, 0x10000, v5
 v_mfma_f32_16x16x32_bf16 a[188:191], a[244:247], a[28:31], a[188:191]
 v_exp_f32 v52, v52
 v_mfma_f32_16x16x32_bf16 a[192:195], a[248:251], a[24:27], a[192:195]
 ds_read_b128 a[244:247], v3 offset:55296
 s_movk_i32 s70, 328
 v_mfma_f32_16x16x32_bf16 a[200:203], a[248:251], a[28:31], a[200:203]
 v_exp_f32 v53, v53
 v_mfma_f32_16x16x32_bf16 a[196:199], a[252:255], a[24:27], a[196:199]
 ds_read_b128 a[248:251], v4 offset:53248
 s_waitcnt lgkmcnt(3)
 v_add_u32 v6, 0x10000, v6
 v_mfma_f32_16x16x32_bf16 a[204:207], a[252:255], a[28:31], a[204:207]
 buffer_load_dword off, s[72:75], s70 lds
 v_add_u32 v7, 0x10000, v7
 v_exp_f32 v54, v54
 v_mfma_f32_16x16x32_bf16 v[32:35], a[224:227], v[64:67], v[16:19]
 ds_read_b128 a[252:255], v4 offset:55296
 v_add_u32 v8, 0x10000, v8
 v_mfma_f32_16x16x32_bf16 v[40:43], a[224:227], v[68:71], v[20:23]
 v_exp_f32 v55, v55
 v_mfma_f32_16x16x32_bf16 v[36:39], a[228:231], v[64:67], v[16:19]
 ds_read_b128 a[224:227], v3 offset:8192
 v_cvt_pk_bf16_f32 v48, v48, v49
 v_mfma_f32_16x16x32_bf16 v[44:47], a[228:231], v[68:71], v[20:23]
 v_exp_f32 v56, v56
 v_mfma_f32_16x16x32_bf16 v[32:35], a[232:235], v[72:75], v[32:35]
 ds_read_b128 a[228:231], v3 offset:10240
 v_add_f32 v14, v14, v50
 v_mfma_f32_16x16x32_bf16 v[40:43], a[232:235], v[76:79], v[40:43]
 v_exp_f32 v57, v57
 v_mfma_f32_16x16x32_bf16 v[36:39], a[236:239], v[72:75], v[36:39]
 ds_read_b128 a[232:235], v4 offset:8192
 s_waitcnt lgkmcnt(3)
 v_exp_f32 v58, v58
 v_mfma_f32_16x16x32_bf16 v[44:47], a[236:239], v[76:79], v[44:47]
 v_exp_f32 v59, v59
 v_mfma_f32_16x16x32_bf16 v[32:35], a[240:243], v[80:83], v[32:35]
 ds_read_b128 a[236:239], v4 offset:10240
 v_add_f32 v14, v14, v51
 v_mfma_f32_16x16x32_bf16 v[40:43], a[240:243], v[84:87], v[40:43]
 v_exp_f32 v60, v60
 v_mfma_f32_16x16x32_bf16 v[36:39], a[244:247], v[80:83], v[36:39]
 ds_read_b128 a[240:243], v3 offset:12288
 v_cvt_pk_bf16_f32 v49, v50, v51
 v_mfma_f32_16x16x32_bf16 v[44:47], a[244:247], v[84:87], v[44:47]
 v_exp_f32 v61, v61
 v_mfma_f32_16x16x32_bf16 v[32:35], a[248:251], v[88:91], v[32:35]
 ds_read_b128 a[244:247], v3 offset:14336
 v_add_f32 v14, v14, v52
 v_mfma_f32_16x16x32_bf16 v[40:43], a[248:251], v[92:95], v[40:43]
 v_exp_f32 v62, v62
 v_mfma_f32_16x16x32_bf16 v[36:39], a[252:255], v[88:91], v[36:39]
 ds_read_b128 a[248:251], v4 offset:12288
 s_waitcnt lgkmcnt(3)
 v_mfma_f32_16x16x32_bf16 v[44:47], a[252:255], v[92:95], v[44:47]
 v_exp_f32 v63, v63
 v_mfma_f32_16x16x32_bf16 v[32:35], a[224:227], v[96:99], v[32:35]
 ds_read_b128 a[252:255], v4 offset:14336
 v_add_f32 v14, v14, v53
 v_mfma_f32_16x16x32_bf16 v[40:43], a[224:227], v[100:103], v[40:43]
 v_cvt_pk_bf16_f32 v50, v52, v53
 v_add_f32 v14, v14, v54
 v_mfma_f32_16x16x32_bf16 v[36:39], a[228:231], v[96:99], v[36:39]
 ds_read_b64_tr_b16 a[224:225], v5 offset:0
 v_add_f32 v14, v14, v55
 v_mfma_f32_16x16x32_bf16 v[44:47], a[228:231], v[100:103], v[44:47]
 ds_read_b64_tr_b16 a[226:227], v5 offset:2048
 v_cvt_pk_bf16_f32 v51, v54, v55
 v_mfma_f32_16x16x32_bf16 v[32:35], a[232:235], v[104:107], v[32:35]
 ds_read_b64_tr_b16 a[228:229], v6 offset:0
 ds_read_b32 v10, v9
 v_add_f32 v15, v15, v56
 v_mfma_f32_16x16x32_bf16 v[40:43], a[232:235], v[108:111], v[40:43]
 ds_read_b64_tr_b16 a[230:231], v6 offset:2048
 v_add_f32 v15, v15, v57
 v_mfma_f32_16x16x32_bf16 v[36:39], a[236:239], v[104:107], v[36:39]
 ds_read_b64_tr_b16 a[232:233], v7 offset:0
 s_waitcnt lgkmcnt(6)
 v_cvt_pk_bf16_f32 v52, v56, v57
 v_mfma_f32_16x16x32_bf16 v[44:47], a[236:239], v[108:111], v[44:47]
 ds_read_b64_tr_b16 a[234:235], v7 offset:2048
 v_add_f32 v15, v15, v58
 v_mfma_f32_16x16x32_bf16 v[32:35], a[240:243], v[112:115], v[32:35]
 ds_read_b64_tr_b16 a[236:237], v8 offset:0
 v_add_f32 v15, v15, v59
 v_mfma_f32_16x16x32_bf16 v[40:43], a[240:243], v[116:119], v[40:43]
 ds_read_b64_tr_b16 a[238:239], v8 offset:2048
 v_cvt_pk_bf16_f32 v53, v58, v59
 v_mfma_f32_16x16x32_bf16 v[36:39], a[244:247], v[112:115], v[36:39]
 ds_read_b64_tr_b16 a[240:241], v5 offset:4096
 v_add_f32 v15, v15, v60
 v_mfma_f32_16x16x32_bf16 v[44:47], a[244:247], v[116:119], v[44:47]
 ds_read_b64_tr_b16 a[242:243], v5 offset:6144
 v_add_f32 v15, v15, v61
 v_mfma_f32_16x16x32_bf16 v[32:35], a[248:251], v[120:123], v[32:35]
 ds_read_b64_tr_b16 a[244:245], v6 offset:4096
 v_cvt_pk_bf16_f32 v54, v60, v61
 v_mfma_f32_16x16x32_bf16 v[40:43], a[248:251], v[124:127], v[40:43]
 ds_read_b64_tr_b16 a[246:247], v6 offset:6144
 v_add_f32 v15, v15, v62
 v_mfma_f32_16x16x32_bf16 v[36:39], a[252:255], v[120:123], v[36:39]
 ds_read_b64_tr_b16 a[248:249], v7 offset:4096
 v_add_f32 v15, v15, v63
 v_cvt_pk_bf16_f32 v55, v62, v63
 v_mfma_f32_16x16x32_bf16 v[44:47], a[252:255], v[124:127], v[44:47]
 ds_read_b64_tr_b16 a[250:251], v7 offset:6144
 s_waitcnt lgkmcnt(6)
 s_movk_i32 s70, 336
 v_mfma_f32_16x16x32_bf16 v[128:131], a[224:227], v[48:51], v[128:131]
 ds_read_b64_tr_b16 a[252:253], v8 offset:4096
 buffer_load_dword off, s[72:75], s70 lds
 v_cmp_le_u32 vcc, 93, v10
 v_mfma_f32_16x16x32_bf16 v[136:139], a[224:227], v[52:55], v[136:139]
 ds_read_b64_tr_b16 a[254:255], v8 offset:6144
 v_mfma_f32_16x16x32_bf16 v[132:135], a[228:231], v[48:51], v[132:135]
 s_cbranch_vccz L_cs680
L_cb680:
 ds_read_b64_tr_b16 a[224:225], v5 offset:8192
 v_mfma_f32_16x16x32_bf16 v[140:143], a[228:231], v[52:55], v[140:143]
 ds_read_b64_tr_b16 a[226:227], v5 offset:10240
 v_max3_f32 v11, v32, v33, v34
 v_mfma_f32_16x16x32_bf16 v[144:147], a[232:235], v[48:51], v[144:147]
 ds_read_b64_tr_b16 a[228:229], v6 offset:8192
 ds_read_b32 v10, v9
 v_mfma_f32_16x16x32_bf16 v[152:155], a[232:235], v[52:55], v[152:155]
 ds_read_b64_tr_b16 a[230:231], v6 offset:10240
 v_max3_f32 v12, v40, v41, v42
 v_mfma_f32_16x16x32_bf16 v[148:151], a[236:239], v[48:51], v[148:151]
 ds_read_b64_tr_b16 a[232:233], v7 offset:8192
 s_waitcnt lgkmcnt(6)
 v_mfma_f32_16x16x32_bf16 v[156:159], a[236:239], v[52:55], v[156:159]
 ds_read_b64_tr_b16 a[234:235], v7 offset:10240
 v_max3_f32 v11, v11, v35, v36
 v_mfma_f32_16x16x32_bf16 v[160:163], a[240:243], v[48:51], v[160:163]
 ds_read_b64_tr_b16 a[236:237], v8 offset:8192
 v_max3_f32 v12, v12, v43, v44
 v_mfma_f32_16x16x32_bf16 v[168:171], a[240:243], v[52:55], v[168:171]
 ds_read_b64_tr_b16 a[238:239], v8 offset:10240
 v_max3_f32 v11, v11, v37, v38
 v_mfma_f32_16x16x32_bf16 v[164:167], a[244:247], v[48:51], v[164:167]
 ds_read_b64_tr_b16 a[240:241], v5 offset:12288
 v_max3_f32 v12, v12, v45, v46
 v_mfma_f32_16x16x32_bf16 v[172:175], a[244:247], v[52:55], v[172:175]
 ds_read_b64_tr_b16 a[242:243], v5 offset:14336
 v_max_f32 v11, v11, v39
 v_mfma_f32_16x16x32_bf16 v[176:179], a[248:251], v[48:51], v[176:179]
 ds_read_b64_tr_b16 a[244:245], v6 offset:12288
 v_max_f32 v12, v12, v47
 v_mfma_f32_16x16x32_bf16 v[184:187], a[248:251], v[52:55], v[184:187]
 ds_read_b64_tr_b16 a[246:247], v6 offset:14336
 v_max_f32 v13, v11, v12
 v_cmp_lt_f32 vcc, 0x41200000, v13
 v_mfma_f32_16x16x32_bf16 v[180:183], a[252:255], v[48:51], v[180:183]
 ds_read_b64_tr_b16 a[248:249], v7 offset:12288
 s_waitcnt lgkmcnt(5)
 s_cbranch_vccnz L_rs0_10
L_rb0_10:
 v_mfma_f32_16x16x32_bf16 v[188:191], a[252:255], v[52:55], v[188:191]
 ds_read_b64_tr_b16 a[250:251], v7 offset:14336
 v_mfma_f32_16x16x32_bf16 v[192:195], a[224:227], v[48:51], v[192:195]
 ds_read_b64_tr_b16 a[252:253], v8 offset:12288
 v_cmp_le_u32 vcc, 95, v10
 v_mfma_f32_16x16x32_bf16 v[200:203], a[224:227], v[52:55], v[200:203]
 ds_read_b64_tr_b16 a[254:255], v8 offset:14336
 v_mfma_f32_16x16x32_bf16 v[196:199], a[228:231], v[48:51], v[196:199]
 s_cbranch_vccz L_cs688
L_cb688:
 ds_read_b64_tr_b16 a[224:225], v24 offset:16384
 v_mfma_f32_16x16x32_bf16 v[204:207], a[228:231], v[52:55], v[204:207]
 ds_read_b64_tr_b16 a[226:227], v24 offset:18432
 v_mfma_f32_16x16x32_bf16 v[208:211], a[232:235], v[48:51], v[208:211]
 ds_read_b64_tr_b16 a[228:229], v24 offset:16392
 v_mfma_f32_16x16x32_bf16 v[216:219], a[232:235], v[52:55], v[216:219]
 ds_read_b64_tr_b16 a[230:231], v24 offset:18440
 v_mfma_f32_16x16x32_bf16 v[212:215], a[236:239], v[48:51], v[212:215]
 ds_read_b64_tr_b16 a[232:233], v25 offset:16384
 s_waitcnt lgkmcnt(5)
 v_mfma_f32_16x16x32_bf16 v[220:223], a[236:239], v[52:55], v[220:223]
 ds_read_b64_tr_b16 a[234:235], v25 offset:18432
 v_mfma_f32_16x16x32_bf16 v[224:227], a[240:243], v[48:51], v[224:227]
 ds_read_b64_tr_b16 a[236:237], v25 offset:16392
 v_mfma_f32_16x16x32_bf16 v[232:235], a[240:243], v[52:55], v[232:235]
 ds_read_b64_tr_b16 a[238:239], v25 offset:18440
 v_mfma_f32_16x16x32_bf16 v[228:231], a[244:247], v[48:51], v[228:231]
 ds_read_b64_tr_b16 a[240:241], v24 offset:20480
 v_add_u32 v3, 0x10000, v3
 v_mfma_f32_16x16x32_bf16 v[236:239], a[244:247], v[52:55], v[236:239]
 ds_read_b64_tr_b16 a[242:243], v24 offset:22528
 s_movk_i32 s70, 344
 v_mfma_f32_16x16x32_bf16 v[240:243], a[248:251], v[48:51], v[240:243]
 ds_read_b64_tr_b16 a[244:245], v24 offset:20488
 v_mfma_f32_16x16x32_bf16 v[248:251], a[248:251], v[52:55], v[248:251]
 ds_read_b64_tr_b16 a[246:247], v24 offset:22536
 v_mfma_f32_16x16x32_bf16 v[244:247], a[252:255], v[48:51], v[244:247]
 ds_read_b64_tr_b16 a[248:249], v25 offset:20480
 s_waitcnt lgkmcnt(5)
 v_mfma_f32_16x16x32_bf16 v[252:255], a[252:255], v[52:55], v[252:255]
 ds_read_b64_tr_b16 a[250:251], v25 offset:22528
 v_add_u32 v4, 0x10000, v4
 v_mfma_f32_16x16x32_bf16 a[176:179], a[224:227], a[32:35], a[176:179]
 ds_read_b64_tr_b16 a[252:253], v25 offset:20488
 buffer_load_dword off, s[72:75], s70 lds
 v_mfma_f32_16x16x32_bf16 a[184:187], a[224:227], a[36:39], a[184:187]
 ds_read_b64_tr_b16 a[254:255], v25 offset:22536
 v_mfma_f32_16x16x32_bf16 a[180:183], a[228:231], a[32:35], a[180:183]
 ds_read_b64_tr_b16 a[224:225], v24 offset:24576
 v_mfma_f32_16x16x32_bf16 a[188:191], a[228:231], a[36:39], a[188:191]
 ds_read_b64_tr_b16 a[226:227], v24 offset:26624
 v_mfma_f32_16x16x32_bf16 a[192:195], a[232:235], a[32:35], a[192:195]
 ds_read_b64_tr_b16 a[228:229], v24 offset:24584
 ds_read_b32 v10, v9
 v_mfma_f32_16x16x32_bf16 a[200:203], a[232:235], a[36:39], a[200:203]
 ds_read_b64_tr_b16 a[230:231], v24 offset:26632
 v_mfma_f32_16x16x32_bf16 a[196:199], a[236:239], a[32:35], a[196:199]
 ds_read_b64_tr_b16 a[232:233], v25 offset:24576
 s_waitcnt lgkmcnt(6)
 v_mfma_f32_16x16x32_bf16 a[204:207], a[236:239], a[36:39], a[204:207]
 ds_read_b64_tr_b16 a[234:235], v25 offset:26624
 v_mfma_f32_16x16x32_bf16 a[176:179], a[240:243], a[40:43], a[176:179]
 ds_read_b64_tr_b16 a[236:237], v25 offset:24584
 v_mfma_f32_16x16x32_bf16 a[184:187], a[240:243], a[44:47], a[184:187]
 ds_read_b64_tr_b16 a[238:239], v25 offset:26632
 v_mfma_f32_16x16x32_bf16 a[180:183], a[244:247], a[40:43], a[180:183]
 ds_read_b64_tr_b16 a[240:241], v24 offset:28672
 v_mfma_f32_16x16x32_bf16 a[188:191], a[244:247], a[44:47], a[188:191]
 ds_read_b64_tr_b16 a[242:243], v24 offset:30720
 v_mfma_f32_16x16x32_bf16 a[192:195], a[248:251], a[40:43], a[192:195]
 ds_read_b64_tr_b16 a[244:245], v24 offset:28680
 v_mfma_f32_16x16x32_bf16 a[200:203], a[248:251], a[44:47], a[200:203]
 ds_read_b64_tr_b16 a[246:247], v24 offset:30728
 v_mfma_f32_16x16x32_bf16 a[196:199], a[252:255], a[40:43], a[196:199]
 ds_read_b64_tr_b16 a[248:249], v25 offset:28672
 s_waitcnt lgkmcnt(5)
 v_mfma_f32_16x16x32_bf16 a[204:207], a[252:255], a[44:47], a[204:207]
 ds_read_b64_tr_b16 a[250:251], v25 offset:30720
 v_mfma_f32_16x16x32_bf16 a[176:179], a[224:227], a[48:51], a[176:179]
 ds_read_b64_tr_b16 a[252:253], v25 offset:28680
 v_cmp_le_u32 vcc, 98, v10
 v_mfma_f32_16x16x32_bf16 a[184:187], a[224:227], a[52:55], a[184:187]
 ds_read_b64_tr_b16 a[254:255], v25 offset:30728
 v_mfma_f32_16x16x32_bf16 a[180:183], a[228:231], a[48:51], a[180:183]
 s_cbranch_vccz L_cs704
L_cb704:
 ds_read_b128 a[224:227], v3 offset:16384
 v_mfma_f32_16x16x32_bf16 a[188:191], a[228:231], a[52:55], a[188:191]
 v_exp_f32 v32, v32
 v_mfma_f32_16x16x32_bf16 a[192:195], a[232:235], a[48:51], a[192:195]
 ds_read_b128 a[228:231], v3 offset:18432
 v_add_f32 v14, v14, v32
 v_mfma_f32_16x16x32_bf16 a[200:203], a[232:235], a[52:55], a[200:203]
 v_exp_f32 v33, v33
 v_mfma_f32_16x16x32_bf16 a[196:199], a[236:239], a[48:51], a[196:199]
 ds_read_b128 a[232:235], v4 offset:16384
 s_waitcnt lgkmcnt(3)
 v_mfma_f32_16x16x32_bf16 a[204:207], a[236:239], a[52:55], a[204:207]
 v_exp_f32 v34, v34
 v_mfma_f32_16x16x32_bf16 a[176:179], a[240:243], a[56:59], a[176:179]
 ds_read_b128 a[236:239], v4 offset:18432
 v_add_f32 v14, v14, v33
 v_mfma_f32_16x16x32_bf16 a[184:187], a[240:243], a[60:63], a[184:187]
 v_exp_f32 v35, v35
 v_mfma_f32_16x16x32_bf16 a[180:183], a[244:247], a[56:59], a[180:183]
 ds_read_b128 a[240:243], v3 offset:20480
 v_add_u32 v5, 0xffff0000, v5
 v_mfma_f32_16x16x32_bf16 a[188:191], a[244:247], a[60:63], a[188:191]
 v_exp_f32 v36, v36
 v_mfma_f32_16x16x32_bf16 a[192:195], a[248:251], a[56:59], a[192:195]
 ds_read_b128 a[244:247], v3 offset:22528
 s_movk_i32 s70, 352
 v_mfma_f32_16x16x32_bf16 a[200:203], a[248:251], a[60:63], a[200:203]
 v_exp_f32 v37, v37
 v_mfma_f32_16x16x32_bf16 a[196:199], a[252:255], a[56:59], a[196:199]
 ds_read_b128 a[248:251], v4 offset:20480
 s_waitcnt lgkmcnt(3)
 v_add_u32 v3, 0xfffe0000, v3
 v_add_u32 v6, 0xffff0000, v6
 v_mfma_f32_16x16x32_bf16 a[204:207], a[252:255], a[60:63], a[204:207]
 buffer_load_dword off, s[72:75], s70 lds
 v_add_u32 v7, 0xffff0000, v7
 v_exp_f32 v38, v38
 v_mfma_f32_16x16x32_bf16 v[48:51], a[224:227], v[64:67], v[16:19]
 ds_read_b128 a[252:255], v4 offset:22528
 v_add_u32 v4, 0xfffe0000, v4
 v_add_u32 v8, 0xffff0000, v8
 v_mfma_f32_16x16x32_bf16 v[56:59], a[224:227], v[68:71], v[20:23]
 v_exp_f32 v39, v39
 v_mfma_f32_16x16x32_bf16 v[52:55], a[228:231], v[64:67], v[16:19]
 ds_read_b128 a[224:227], v3 offset:57344
 v_cvt_pk_bf16_f32 v32, v32, v33
 v_mfma_f32_16x16x32_bf16 v[60:63], a[228:231], v[68:71], v[20:23]
 v_exp_f32 v40, v40
 v_mfma_f32_16x16x32_bf16 v[48:51], a[232:235], v[72:75], v[48:51]
 ds_read_b128 a[228:231], v3 offset:59392
 v_add_f32 v14, v14, v34
 v_mfma_f32_16x16x32_bf16 v[56:59], a[232:235], v[76:79], v[56:59]
 v_exp_f32 v41, v41
 v_mfma_f32_16x16x32_bf16 v[52:55], a[236:239], v[72:75], v[52:55]
 ds_read_b128 a[232:235], v4 offset:57344
 s_waitcnt lgkmcnt(3)
 v_exp_f32 v42, v42
 v_mfma_f32_16x16x32_bf16 v[60:63], a[236:239], v[76:79], v[60:63]
 v_exp_f32 v43, v43
 v_mfma_f32_16x16x32_bf16 v[48:51], a[240:243], v[80:83], v[48:51]
 ds_read_b128 a[236:239], v4 offset:59392
 v_add_f32 v14, v14, v35
 v_mfma_f32_16x16x32_bf16 v[56:59], a[240:243], v[84:87], v[56:59]
 v_exp_f32 v44, v44
 v_mfma_f32_16x16x32_bf16 v[52:55], a[244:247], v[80:83], v[52:55]
 ds_read_b128 a[240:243], v3 offset:61440
 v_cvt_pk_bf16_f32 v33, v34, v35
 v_mfma_f32_16x16x32_bf16 v[60:63], a[244:247], v[84:87], v[60:63]
 v_exp_f32 v45, v45
 v_mfma_f32_16x16x32_bf16 v[48:51], a[248:251], v[88:91], v[48:51]
 ds_read_b128 a[244:247], v3 offset:63488
 v_add_f32 v14, v14, v36
 v_mfma_f32_16x16x32_bf16 v[56:59], a[248:251], v[92:95], v[56:59]
 v_exp_f32 v46, v46
 v_mfma_f32_16x16x32_bf16 v[52:55], a[252:255], v[88:91], v[52:55]
 ds_read_b128 a[248:251], v4 offset:61440
 s_waitcnt lgkmcnt(3)
 v_mfma_f32_16x16x32_bf16 v[60:63], a[252:255], v[92:95], v[60:63]
 v_exp_f32 v47, v47
 v_mfma_f32_16x16x32_bf16 v[48:51], a[224:227], v[96:99], v[48:51]
 ds_read_b128 a[252:255], v4 offset:63488
 v_add_f32 v14, v14, v37
 v_mfma_f32_16x16x32_bf16 v[56:59], a[224:227], v[100:103], v[56:59]
 v_cvt_pk_bf16_f32 v34, v36, v37
 v_add_f32 v14, v14, v38
 v_mfma_f32_16x16x32_bf16 v[52:55], a[228:231], v[96:99], v[52:55]
 ds_read_b64_tr_b16 a[224:225], v5 offset:0
 v_add_f32 v14, v14, v39
 v_mfma_f32_16x16x32_bf16 v[60:63], a[228:231], v[100:103], v[60:63]
 ds_read_b64_tr_b16 a[226:227], v5 offset:2048
 v_cvt_pk_bf16_f32 v35, v38, v39
 v_mfma_f32_16x16x32_bf16 v[48:51], a[232:235], v[104:107], v[48:51]
 ds_read_b64_tr_b16 a[228:229], v6 offset:0
 ds_read_b32 v10, v9
 v_add_f32 v15, v15, v40
 v_mfma_f32_16x16x32_bf16 v[56:59], a[232:235], v[108:111], v[56:59]
 ds_read_b64_tr_b16 a[230:231], v6 offset:2048
 v_add_f32 v15, v15, v41
 v_mfma_f32_16x16x32_bf16 v[52:55], a[236:239], v[104:107], v[52:55]
 ds_read_b64_tr_b16 a[232:233], v7 offset:0
 s_waitcnt lgkmcnt(6)
 v_cvt_pk_bf16_f32 v36, v40, v41
 v_mfma_f32_16x16x32_bf16 v[60:63], a[236:239], v[108:111], v[60:63]
 ds_read_b64_tr_b16 a[234:235], v7 offset:2048
 v_add_f32 v15, v15, v42
 v_mfma_f32_16x16x32_bf16 v[48:51], a[240:243], v[112:115], v[48:51]
 ds_read_b64_tr_b16 a[236:237], v8 offset:0
 v_add_f32 v15, v15, v43
 v_mfma_f32_16x16x32_bf16 v[56:59], a[240:243], v[116:119], v[56:59]
 ds_read_b64_tr_b16 a[238:239], v8 offset:2048
 v_cvt_pk_bf16_f32 v37, v42, v43
 v_mfma_f32_16x16x32_bf16 v[52:55], a[244:247], v[112:115], v[52:55]
 ds_read_b64_tr_b16 a[240:241], v5 offset:4096
 v_add_f32 v15, v15, v44
 v_mfma_f32_16x16x32_bf16 v[60:63], a[244:247], v[116:119], v[60:63]
 ds_read_b64_tr_b16 a[242:243], v5 offset:6144
 v_add_f32 v15, v15, v45
 v_mfma_f32_16x16x32_bf16 v[48:51], a[248:251], v[120:123], v[48:51]
 ds_read_b64_tr_b16 a[244:245], v6 offset:4096
 v_cvt_pk_bf16_f32 v38, v44, v45
 v_mfma_f32_16x16x32_bf16 v[56:59], a[248:251], v[124:127], v[56:59]
 ds_read_b64_tr_b16 a[246:247], v6 offset:6144
 v_add_f32 v15, v15, v46
 v_mfma_f32_16x16x32_bf16 v[52:55], a[252:255], v[120:123], v[52:55]
 ds_read_b64_tr_b16 a[248:249], v7 offset:4096
 v_add_f32 v15, v15, v47
 v_cvt_pk_bf16_f32 v39, v46, v47
 v_mfma_f32_16x16x32_bf16 v[60:63], a[252:255], v[124:127], v[60:63]
 ds_read_b64_tr_b16 a[250:251], v7 offset:6144
 s_waitcnt lgkmcnt(6)
 s_movk_i32 s70, 360
 v_mfma_f32_16x16x32_bf16 v[128:131], a[224:227], v[32:35], v[128:131]
 ds_read_b64_tr_b16 a[252:253], v8 offset:4096
 buffer_load_dword off, s[72:75], s70 lds
 v_cmp_le_u32 vcc, 99, v10
 v_mfma_f32_16x16x32_bf16 v[136:139], a[224:227], v[36:39], v[136:139]
 ds_read_b64_tr_b16 a[254:255], v8 offset:6144
 v_mfma_f32_16x16x32_bf16 v[132:135], a[228:231], v[32:35], v[132:135]
 s_cbranch_vccz L_cs728
L_cb728:
 ds_read_b64_tr_b16 a[224:225], v5 offset:16384
 v_mfma_f32_16x16x32_bf16 v[140:143], a[228:231], v[36:39], v[140:143]
 ds_read_b64_tr_b16 a[226:227], v5 offset:18432
 v_max3_f32 v11, v48, v49, v50
 v_mfma_f32_16x16x32_bf16 v[144:147], a[232:235], v[32:35], v[144:147]
 ds_read_b64_tr_b16 a[228:229], v6 offset:16384
 ds_read_b32 v10, v9
 v_mfma_f32_16x16x32_bf16 v[152:155], a[232:235], v[36:39], v[152:155]
 ds_read_b64_tr_b16 a[230:231], v6 offset:18432
 v_max3_f32 v12, v56, v57, v58
 v_mfma_f32_16x16x32_bf16 v[148:151], a[236:239], v[32:35], v[148:151]
 ds_read_b64_tr_b16 a[232:233], v7 offset:16384
 s_waitcnt lgkmcnt(6)
 v_mfma_f32_16x16x32_bf16 v[156:159], a[236:239], v[36:39], v[156:159]
 ds_read_b64_tr_b16 a[234:235], v7 offset:18432
 v_max3_f32 v11, v11, v51, v52
 v_mfma_f32_16x16x32_bf16 v[160:163], a[240:243], v[32:35], v[160:163]
 ds_read_b64_tr_b16 a[236:237], v8 offset:16384
 v_max3_f32 v12, v12, v59, v60
 v_mfma_f32_16x16x32_bf16 v[168:171], a[240:243], v[36:39], v[168:171]
 ds_read_b64_tr_b16 a[238:239], v8 offset:18432
 v_max3_f32 v11, v11, v53, v54
 v_mfma_f32_16x16x32_bf16 v[164:167], a[244:247], v[32:35], v[164:167]
 ds_read_b64_tr_b16 a[240:241], v5 offset:20480
 v_max3_f32 v12, v12, v61, v62
 v_mfma_f32_16x16x32_bf16 v[172:175], a[244:247], v[36:39], v[172:175]
 ds_read_b64_tr_b16 a[242:243], v5 offset:22528
 v_max_f32 v11, v11, v55
 v_mfma_f32_16x16x32_bf16 v[176:179], a[248:251], v[32:35], v[176:179]
 ds_read_b64_tr_b16 a[244:245], v6 offset:20480
 v_max_f32 v12, v12, v63
 v_mfma_f32_16x16x32_bf16 v[184:187], a[248:251], v[36:39], v[184:187]
 ds_read_b64_tr_b16 a[246:247], v6 offset:22528
 v_max_f32 v13, v11, v12
 v_cmp_lt_f32 vcc, 0x41200000, v13
 v_mfma_f32_16x16x32_bf16 v[180:183], a[252:255], v[32:35], v[180:183]
 ds_read_b64_tr_b16 a[248:249], v7 offset:20480
 s_waitcnt lgkmcnt(5)
 s_cbranch_vccnz L_rs0_11
L_rb0_11:
 v_mfma_f32_16x16x32_bf16 v[188:191], a[252:255], v[36:39], v[188:191]
 ds_read_b64_tr_b16 a[250:251], v7 offset:22528
 v_mfma_f32_16x16x32_bf16 v[192:195], a[224:227], v[32:35], v[192:195]
 ds_read_b64_tr_b16 a[252:253], v8 offset:20480
 v_cmp_le_u32 vcc, 101, v10
 v_mfma_f32_16x16x32_bf16 v[200:203], a[224:227], v[36:39], v[200:203]
 ds_read_b64_tr_b16 a[254:255], v8 offset:22528
 v_mfma_f32_16x16x32_bf16 v[196:199], a[228:231], v[32:35], v[196:199]
 s_cbranch_vccz L_cs736
L_cb736:
 ds_read_b64_tr_b16 a[224:225], v24 offset:40960
 v_mfma_f32_16x16x32_bf16 v[204:207], a[228:231], v[36:39], v[204:207]
 ds_read_b64_tr_b16 a[226:227], v24 offset:43008
 v_mfma_f32_16x16x32_bf16 v[208:211], a[232:235], v[32:35], v[208:211]
 ds_read_b64_tr_b16 a[228:229], v24 offset:40968
 v_mfma_f32_16x16x32_bf16 v[216:219], a[232:235], v[36:39], v[216:219]
 ds_read_b64_tr_b16 a[230:231], v24 offset:43016
 v_mfma_f32_16x16x32_bf16 v[212:215], a[236:239], v[32:35], v[212:215]
 ds_read_b64_tr_b16 a[232:233], v25 offset:40960
 s_waitcnt lgkmcnt(5)
 v_mfma_f32_16x16x32_bf16 v[220:223], a[236:239], v[36:39], v[220:223]
 ds_read_b64_tr_b16 a[234:235], v25 offset:43008
 v_mfma_f32_16x16x32_bf16 v[224:227], a[240:243], v[32:35], v[224:227]
 ds_read_b64_tr_b16 a[236:237], v25 offset:40968
 v_mfma_f32_16x16x32_bf16 v[232:235], a[240:243], v[36:39], v[232:235]
 ds_read_b64_tr_b16 a[238:239], v25 offset:43016
 v_mfma_f32_16x16x32_bf16 v[228:231], a[244:247], v[32:35], v[228:231]
 ds_read_b64_tr_b16 a[240:241], v24 offset:45056
 v_mfma_f32_16x16x32_bf16 v[236:239], a[244:247], v[36:39], v[236:239]
 ds_read_b64_tr_b16 a[242:243], v24 offset:47104
 s_movk_i32 s70, 368
 v_mfma_f32_16x16x32_bf16 v[240:243], a[248:251], v[32:35], v[240:243]
 ds_read_b64_tr_b16 a[244:245], v24 offset:45064
 v_mfma_f32_16x16x32_bf16 v[248:251], a[248:251], v[36:39], v[248:251]
 ds_read_b64_tr_b16 a[246:247], v24 offset:47112
 v_mfma_f32_16x16x32_bf16 v[244:247], a[252:255], v[32:35], v[244:247]
 ds_read_b64_tr_b16 a[248:249], v25 offset:45056
 s_waitcnt lgkmcnt(5)
 v_mfma_f32_16x16x32_bf16 v[252:255], a[252:255], v[36:39], v[252:255]
 ds_read_b64_tr_b16 a[250:251], v25 offset:47104
 buffer_load_dword off, s[72:75], s70 lds
 v_mfma_f32_16x16x32_bf16 a[176:179], a[224:227], a[64:67], a[176:179]
 ds_read_b64_tr_b16 a[252:253], v25 offset:45064
 v_mfma_f32_16x16x32_bf16 a[184:187], a[224:227], a[68:71], a[184:187]
 ds_read_b64_tr_b16 a[254:255], v25 offset:47112
 v_mfma_f32_16x16x32_bf16 a[180:183], a[228:231], a[64:67], a[180:183]
 ds_read_b64_tr_b16 a[224:225], v24 offset:32768
 v_mfma_f32_16x16x32_bf16 a[188:191], a[228:231], a[68:71], a[188:191]
 ds_read_b64_tr_b16 a[226:227], v24 offset:34816
 v_mfma_f32_16x16x32_bf16 a[192:195], a[232:235], a[64:67], a[192:195]
 ds_read_b64_tr_b16 a[228:229], v24 offset:32776
 ds_read_b32 v10, v9
 v_mfma_f32_16x16x32_bf16 a[200:203], a[232:235], a[68:71], a[200:203]
 ds_read_b64_tr_b16 a[230:231], v24 offset:34824
 v_mfma_f32_16x16x32_bf16 a[196:199], a[236:239], a[64:67], a[196:199]
 ds_read_b64_tr_b16 a[232:233], v25 offset:32768
 s_waitcnt lgkmcnt(6)
 v_mfma_f32_16x16x32_bf16 a[204:207], a[236:239], a[68:71], a[204:207]
 ds_read_b64_tr_b16 a[234:235], v25 offset:34816
 v_mfma_f32_16x16x32_bf16 a[176:179], a[240:243], a[72:75], a[176:179]
 ds_read_b64_tr_b16 a[236:237], v25 offset:32776
 v_mfma_f32_16x16x32_bf16 a[184:187], a[240:243], a[76:79], a[184:187]
 ds_read_b64_tr_b16 a[238:239], v25 offset:34824
 v_mfma_f32_16x16x32_bf16 a[180:183], a[244:247], a[72:75], a[180:183]
 ds_read_b64_tr_b16 a[240:241], v24 offset:36864
 v_add_u32 v3, 0x10000, v3
 v_mfma_f32_16x16x32_bf16 a[188:191], a[244:247], a[76:79], a[188:191]
 ds_read_b64_tr_b16 a[242:243], v24 offset:38912
 v_mfma_f32_16x16x32_bf16 a[192:195], a[248:251], a[72:75], a[192:195]
 ds_read_b64_tr_b16 a[244:245], v24 offset:36872
 v_mfma_f32_16x16x32_bf16 a[200:203], a[248:251], a[76:79], a[200:203]
 ds_read_b64_tr_b16 a[246:247], v24 offset:38920
 v_mfma_f32_16x16x32_bf16 a[196:199], a[252:255], a[72:75], a[196:199]
 ds_read_b64_tr_b16 a[248:249], v25 offset:36864
 s_waitcnt lgkmcnt(5)
 v_mfma_f32_16x16x32_bf16 a[204:207], a[252:255], a[76:79], a[204:207]
 ds_read_b64_tr_b16 a[250:251], v25 offset:38912
 v_add_u32 v4, 0x10000, v4
 v_mfma_f32_16x16x32_bf16 a[176:179], a[224:227], a[80:83], a[176:179]
 ds_read_b64_tr_b16 a[252:253], v25 offset:36872
 v_cmp_le_u32 vcc, 102, v10
 v_mfma_f32_16x16x32_bf16 a[184:187], a[224:227], a[84:87], a[184:187]
 ds_read_b64_tr_b16 a[254:255], v25 offset:38920
 v_mfma_f32_16x16x32_bf16 a[180:183], a[228:231], a[80:83], a[180:183]
 s_cbranch_vccz L_cs752
L_cb752:
 ds_read_b64_tr_b16 a[224:225], v24 offset:0
 v_mfma_f32_16x16x32_bf16 a[188:191], a[228:231], a[84:87], a[188:191]
 ds_read_b64_tr_b16 a[226:227], v24 offset:2048
 v_mfma_f32_16x16x32_bf16 a[192:195], a[232:235], a[80:83], a[192:195]
 ds_read_b64_tr_b16 a[228:229], v24 offset:8
 ds_read_b32 v10, v9
 v_mfma_f32_16x16x32_bf16 a[200:203], a[232:235], a[84:87], a[200:203]
 ds_read_b64_tr_b16 a[230:231], v24 offset:2056
 v_mfma_f32_16x16x32_bf16 a[196:199], a[236:239], a[80:83], a[196:199]
 ds_read_b64_tr_b16 a[232:233], v25 offset:0
 s_waitcnt lgkmcnt(6)
 v_mfma_f32_16x16x32_bf16 a[204:207], a[236:239], a[84:87], a[204:207]
 ds_read_b64_tr_b16 a[234:235], v25 offset:2048
 v_mfma_f32_16x16x32_bf16 a[176:179], a[240:243], a[88:91], a[176:179]
 ds_read_b64_tr_b16 a[236:237], v25 offset:8
 v_mfma_f32_16x16x32_bf16 a[184:187], a[240:243], a[92:95], a[184:187]
 ds_read_b64_tr_b16 a[238:239], v25 offset:2056
 v_mfma_f32_16x16x32_bf16 a[180:183], a[244:247], a[88:91], a[180:183]
 ds_read_b64_tr_b16 a[240:241], v24 offset:4096
 v_mfma_f32_16x16x32_bf16 a[188:191], a[244:247], a[92:95], a[188:191]
 ds_read_b64_tr_b16 a[242:243], v24 offset:6144
 s_movk_i32 s70, 376
 v_mfma_f32_16x16x32_bf16 a[192:195], a[248:251], a[88:91], a[192:195]
 ds_read_b64_tr_b16 a[244:245], v24 offset:4104
 v_mfma_f32_16x16x32_bf16 a[200:203], a[248:251], a[92:95], a[200:203]
 ds_read_b64_tr_b16 a[246:247], v24 offset:6152
 v_mfma_f32_16x16x32_bf16 a[196:199], a[252:255], a[88:91], a[196:199]
 ds_read_b64_tr_b16 a[248:249], v25 offset:4096
 s_waitcnt lgkmcnt(5)
 v_mfma_f32_16x16x32_bf16 a[204:207], a[252:255], a[92:95], a[204:207]
 ds_read_b64_tr_b16 a[250:251], v25 offset:6144
 buffer_load_dword off, s[72:75], s70 lds
 v_mfma_f32_16x16x32_bf16 a[176:179], a[224:227], a[96:99], a[176:179]
 ds_read_b64_tr_b16 a[252:253], v25 offset:4104
 v_cmp_le_u32 vcc, 106, v10
 v_mfma_f32_16x16x32_bf16 a[184:187], a[224:227], a[100:103], a[184:187]
 ds_read_b64_tr_b16 a[254:255], v25 offset:6152
 v_mfma_f32_16x16x32_bf16 a[180:183], a[228:231], a[96:99], a[180:183]
 s_cbranch_vccz L_cs760
L_cb760:
 ds_read_b128 a[224:227], v3 offset:24576
 v_mfma_f32_16x16x32_bf16 a[188:191], a[228:231], a[100:103], a[188:191]
 v_exp_f32 v48, v48
 v_mfma_f32_16x16x32_bf16 a[192:195], a[232:235], a[96:99], a[192:195]
 ds_read_b128 a[228:231], v3 offset:26624
 v_add_f32 v14, v14, v48
 v_mfma_f32_16x16x32_bf16 a[200:203], a[232:235], a[100:103], a[200:203]
 v_exp_f32 v49, v49
 v_mfma_f32_16x16x32_bf16 a[196:199], a[236:239], a[96:99], a[196:199]
 ds_read_b128 a[232:235], v4 offset:24576
 s_waitcnt lgkmcnt(3)
 v_mfma_f32_16x16x32_bf16 a[204:207], a[236:239], a[100:103], a[204:207]
 v_exp_f32 v50, v50
 v_mfma_f32_16x16x32_bf16 a[176:179], a[240:243], a[104:107], a[176:179]
 ds_read_b128 a[236:239], v4 offset:26624
 v_add_f32 v14, v14, v49
 v_mfma_f32_16x16x32_bf16 a[184:187], a[240:243], a[108:111], a[184:187]
 v_exp_f32 v51, v51
 v_mfma_f32_16x16x32_bf16 a[180:183], a[244:247], a[104:107], a[180:183]
 ds_read_b128 a[240:243], v3 offset:28672
 v_add_u32 v5, 0xffff0000, v5
 v_mfma_f32_16x16x32_bf16 a[188:191], a[244:247], a[108:111], a[188:191]
 v_exp_f32 v52, v52
 v_mfma_f32_16x16x32_bf16 a[192:195], a[248:251], a[104:107], a[192:195]
 ds_read_b128 a[244:247], v3 offset:30720
 s_movk_i32 s70, 380
 v_mfma_f32_16x16x32_bf16 a[200:203], a[248:251], a[108:111], a[200:203]
 v_exp_f32 v53, v53
 v_mfma_f32_16x16x32_bf16 a[196:199], a[252:255], a[104:107], a[196:199]
 ds_read_b128 a[248:251], v4 offset:28672
 s_waitcnt lgkmcnt(3)
 v_add_u32 v6, 0xffff0000, v6
 v_mfma_f32_16x16x32_bf16 a[204:207], a[252:255], a[108:111], a[204:207]
 buffer_load_dword off, s[72:75], s70 lds
 v_add_u32 v7, 0xffff0000, v7
 v_exp_f32 v54, v54
 v_mfma_f32_16x16x32_bf16 v[32:35], a[224:227], v[64:67], v[16:19]
 ds_read_b128 a[252:255], v4 offset:30720
 v_add_u32 v8, 0xffff0000, v8
 v_mfma_f32_16x16x32_bf16 v[40:43], a[224:227], v[68:71], v[20:23]
 v_exp_f32 v55, v55
 v_mfma_f32_16x16x32_bf16 v[36:39], a[228:231], v[64:67], v[16:19]
 ds_read_b128 a[224:227], v3 offset:57344
 v_cvt_pk_bf16_f32 v48, v48, v49
 v_exp_f32 v56, v56
 v_exp_f32 v57, v57
 v_exp_f32 v58, v58
 v_exp_f32 v59, v59
 v_exp_f32 v60, v60
 v_exp_f32 v61, v61
 v_exp_f32 v62, v62
 v_exp_f32 v63, v63
 v_add_f32 v14, v14, v50
 v_add_f32 v14, v14, v51
 v_cvt_pk_bf16_f32 v49, v50, v51
 v_add_f32 v14, v14, v52
 v_add_f32 v14, v14, v53
 v_cvt_pk_bf16_f32 v50, v52, v53
 v_add_f32 v14, v14, v54
 v_add_f32 v14, v14, v55
 v_cvt_pk_bf16_f32 v51, v54, v55
 v_accvgpr_read_b32 v28, a176
 v_accvgpr_read_b32 v29, a177
 v_mul_f32 v28, s32, v28
 v_mul_f32 v29, s32, v29
 v_cvt_pk_bf16_f32 v28, v28, v29
 v_accvgpr_write_b32 a144, v28
 v_accvgpr_read_b32 v30, a178
 v_accvgpr_read_b32 v31, a179
 v_mul_f32 v30, s32, v30
 v_mul_f32 v31, s32, v31
 v_cvt_pk_bf16_f32 v30, v30, v31
 v_accvgpr_write_b32 a145, v30
 v_accvgpr_read_b32 v28, a180
 v_accvgpr_read_b32 v29, a181
 v_mul_f32 v28, s32, v28
 v_mul_f32 v29, s32, v29
 v_cvt_pk_bf16_f32 v28, v28, v29
 v_accvgpr_write_b32 a146, v28
 v_accvgpr_read_b32 v30, a182
 v_accvgpr_read_b32 v31, a183
 v_mul_f32 v30, s32, v30
 v_mul_f32 v31, s32, v31
 v_cvt_pk_bf16_f32 v30, v30, v31
 v_accvgpr_write_b32 a147, v30
 v_accvgpr_read_b32 v28, a184
 v_accvgpr_read_b32 v29, a185
 v_mul_f32 v28, s32, v28
 v_mul_f32 v29, s32, v29
 v_cvt_pk_bf16_f32 v28, v28, v29
 v_accvgpr_write_b32 a148, v28
 v_accvgpr_read_b32 v30, a186
 v_accvgpr_read_b32 v31, a187
 v_mul_f32 v30, s32, v30
 v_mul_f32 v31, s32, v31
 v_cvt_pk_bf16_f32 v30, v30, v31
 v_accvgpr_write_b32 a149, v30
 v_accvgpr_read_b32 v28, a188
 v_accvgpr_read_b32 v29, a189
 v_mul_f32 v28, s32, v28
 v_mul_f32 v29, s32, v29
 v_mfma_f32_16x16x32_bf16 v[44:47], a[228:231], v[68:71], v[20:23]
 v_add_f32 v15, v15, v56
 v_add_f32 v15, v15, v57
 v_mfma_f32_16x16x32_bf16 v[32:35], a[232:235], v[72:75], v[32:35]
 ds_read_b128 a[228:231], v3 offset:59392
 v_cvt_pk_bf16_f32 v52, v56, v57
 v_mfma_f32_16x16x32_bf16 v[40:43], a[232:235], v[76:79], v[40:43]
 v_add_f32 v15, v15, v58
 v_add_f32 v15, v15, v59
 v_mfma_f32_16x16x32_bf16 v[36:39], a[236:239], v[72:75], v[36:39]
 ds_read_b128 a[232:235], v4 offset:57344
 s_waitcnt lgkmcnt(3)
 v_cvt_pk_bf16_f32 v53, v58, v59
 v_mfma_f32_16x16x32_bf16 v[44:47], a[236:239], v[76:79], v[44:47]
 v_add_f32 v15, v15, v60
 v_add_f32 v15, v15, v61
 v_mfma_f32_16x16x32_bf16 v[32:35], a[240:243], v[80:83], v[32:35]
 ds_read_b128 a[236:239], v4 offset:59392
 v_cvt_pk_bf16_f32 v54, v60, v61
 v_mfma_f32_16x16x32_bf16 v[40:43], a[240:243], v[84:87], v[40:43]
 v_add_f32 v15, v15, v62
 v_add_f32 v15, v15, v63
 v_mfma_f32_16x16x32_bf16 v[36:39], a[244:247], v[80:83], v[36:39]
 ds_read_b128 a[240:243], v3 offset:61440
 v_cvt_pk_bf16_f32 v55, v62, v63
 v_mfma_f32_16x16x32_bf16 v[44:47], a[244:247], v[84:87], v[44:47]
 v_cvt_pk_bf16_f32 v28, v28, v29
 v_accvgpr_write_b32 a150, v28
 v_mfma_f32_16x16x32_bf16 v[32:35], a[248:251], v[88:91], v[32:35]
 ds_read_b128 a[244:247], v3 offset:63488
 v_accvgpr_read_b32 v30, a190
 v_mfma_f32_16x16x32_bf16 v[40:43], a[248:251], v[92:95], v[40:43]
 v_accvgpr_read_b32 v31, a191
 v_mul_f32 v30, s32, v30
 v_mfma_f32_16x16x32_bf16 v[36:39], a[252:255], v[88:91], v[36:39]
 ds_read_b128 a[248:251], v4 offset:61440
 s_waitcnt lgkmcnt(3)
 v_mul_f32 v31, s32, v31
 v_mfma_f32_16x16x32_bf16 v[44:47], a[252:255], v[92:95], v[44:47]
 v_cvt_pk_bf16_f32 v30, v30, v31
 v_accvgpr_write_b32 a151, v30
 v_mfma_f32_16x16x32_bf16 v[32:35], a[224:227], v[96:99], v[32:35]
 ds_read_b128 a[252:255], v4 offset:63488
 v_accvgpr_read_b32 v28, a192
 v_mfma_f32_16x16x32_bf16 v[40:43], a[224:227], v[100:103], v[40:43]
 v_accvgpr_read_b32 v29, a193
 v_mul_f32 v28, s32, v28
 v_mfma_f32_16x16x32_bf16 v[36:39], a[228:231], v[96:99], v[36:39]
 ds_read_b64_tr_b16 a[224:225], v5 offset:49152
 v_mul_f32 v29, s32, v29
 v_mfma_f32_16x16x32_bf16 v[44:47], a[228:231], v[100:103], v[44:47]
 ds_read_b64_tr_b16 a[226:227], v5 offset:51200
 v_cvt_pk_bf16_f32 v28, v28, v29
 v_mfma_f32_16x16x32_bf16 v[32:35], a[232:235], v[104:107], v[32:35]
 ds_read_b64_tr_b16 a[228:229], v6 offset:49152
 ds_read_b32 v10, v9
 v_accvgpr_write_b32 a152, v28
 v_mfma_f32_16x16x32_bf16 v[40:43], a[232:235], v[108:111], v[40:43]
 ds_read_b64_tr_b16 a[230:231], v6 offset:51200
 v_accvgpr_read_b32 v30, a194
 v_mfma_f32_16x16x32_bf16 v[36:39], a[236:239], v[104:107], v[36:39]
 ds_read_b64_tr_b16 a[232:233], v7 offset:49152
 s_waitcnt lgkmcnt(6)
 v_accvgpr_read_b32 v31, a195
 v_mfma_f32_16x16x32_bf16 v[44:47], a[236:239], v[108:111], v[44:47]
 ds_read_b64_tr_b16 a[234:235], v7 offset:51200
 v_mul_f32 v30, s32, v30
 v_mfma_f32_16x16x32_bf16 v[32:35], a[240:243], v[112:115], v[32:35]
 ds_read_b64_tr_b16 a[236:237], v8 offset:49152
 v_mul_f32 v31, s32, v31
 v_mfma_f32_16x16x32_bf16 v[40:43], a[240:243], v[116:119], v[40:43]
 ds_read_b64_tr_b16 a[238:239], v8 offset:51200
 v_cvt_pk_bf16_f32 v30, v30, v31
 v_mfma_f32_16x16x32_bf16 v[36:39], a[244:247], v[112:115], v[36:39]
 ds_read_b64_tr_b16 a[240:241], v5 offset:53248
 v_accvgpr_write_b32 a153, v30
 v_mfma_f32_16x16x32_bf16 v[44:47], a[244:247], v[116:119], v[44:47]
 ds_read_b64_tr_b16 a[242:243], v5 offset:55296
 s_movk_i32 s70, 388
 v_add_u32 v5, 0x10000, v5
 v_accvgpr_read_b32 v28, a196
 v_mfma_f32_16x16x32_bf16 v[32:35], a[248:251], v[120:123], v[32:35]
 ds_read_b64_tr_b16 a[244:245], v6 offset:53248
 v_accvgpr_read_b32 v29, a197
 v_mfma_f32_16x16x32_bf16 v[40:43], a[248:251], v[124:127], v[40:43]
 ds_read_b64_tr_b16 a[246:247], v6 offset:55296
 v_add_u32 v6, 0x10000, v6
 v_mul_f32 v28, s32, v28
 v_mfma_f32_16x16x32_bf16 v[36:39], a[252:255], v[120:123], v[36:39]
 ds_read_b64_tr_b16 a[248:249], v7 offset:53248
 s_waitcnt lgkmcnt(5)
 v_mul_f32 v29, s32, v29
 v_mfma_f32_16x16x32_bf16 v[44:47], a[252:255], v[124:127], v[44:47]
 ds_read_b64_tr_b16 a[250:251], v7 offset:55296
 buffer_load_dword off, s[72:75], s70 lds
 v_add_u32 v7, 0x10000, v7
 v_cvt_pk_bf16_f32 v28, v28, v29
 v_mfma_f32_16x16x32_bf16 v[128:131], a[224:227], v[48:51], v[128:131]
 ds_read_b64_tr_b16 a[252:253], v8 offset:53248
 v_cmp_le_u32 vcc, 107, v10
 v_accvgpr_write_b32 a154, v28
 v_mfma_f32_16x16x32_bf16 v[136:139], a[224:227], v[52:55], v[136:139]
 ds_read_b64_tr_b16 a[254:255], v8 offset:55296
 v_add_u32 v8, 0x10000, v8
 v_accvgpr_read_b32 v30, a198
 v_mfma_f32_16x16x32_bf16 v[132:135], a[228:231], v[48:51], v[132:135]
 s_cbranch_vccz L_cs784
L_cb784:
 ds_read_b64_tr_b16 a[224:225], v5 offset:32768
 v_max3_f32 v11, v32, v33, v34
 v_max3_f32 v12, v40, v41, v42
 v_max3_f32 v11, v11, v35, v36
 v_max3_f32 v12, v12, v43, v44
 v_max3_f32 v11, v11, v37, v38
 v_max3_f32 v12, v12, v45, v46
 v_max_f32 v11, v11, v39
 v_max_f32 v12, v12, v47
 v_max_f32 v13, v11, v12
 v_mfma_f32_16x16x32_bf16 v[140:143], a[228:231], v[52:55], v[140:143]
 ds_read_b64_tr_b16 a[226:227], v5 offset:34816
 v_accvgpr_read_b32 v31, a199
 v_mfma_f32_16x16x32_bf16 v[144:147], a[232:235], v[48:51], v[144:147]
 ds_read_b64_tr_b16 a[228:229], v6 offset:32768
 v_mul_f32 v30, s32, v30
 v_mfma_f32_16x16x32_bf16 v[152:155], a[232:235], v[52:55], v[152:155]
 ds_read_b64_tr_b16 a[230:231], v6 offset:34816
 v_mul_f32 v31, s32, v31
 v_mfma_f32_16x16x32_bf16 v[148:151], a[236:239], v[48:51], v[148:151]
 ds_read_b64_tr_b16 a[232:233], v7 offset:32768
 s_waitcnt lgkmcnt(5)
 v_cvt_pk_bf16_f32 v30, v30, v31
 v_mfma_f32_16x16x32_bf16 v[156:159], a[236:239], v[52:55], v[156:159]
 ds_read_b64_tr_b16 a[234:235], v7 offset:34816
 v_accvgpr_write_b32 a155, v30
 v_mfma_f32_16x16x32_bf16 v[160:163], a[240:243], v[48:51], v[160:163]
 ds_read_b64_tr_b16 a[236:237], v8 offset:32768
 v_accvgpr_read_b32 v28, a200
 v_mfma_f32_16x16x32_bf16 v[168:171], a[240:243], v[52:55], v[168:171]
 ds_read_b64_tr_b16 a[238:239], v8 offset:34816
 v_accvgpr_read_b32 v29, a201
 v_mfma_f32_16x16x32_bf16 v[164:167], a[244:247], v[48:51], v[164:167]
 ds_read_b64_tr_b16 a[240:241], v5 offset:36864
 v_mul_f32 v28, s32, v28
 v_mfma_f32_16x16x32_bf16 v[172:175], a[244:247], v[52:55], v[172:175]
 ds_read_b64_tr_b16 a[242:243], v5 offset:38912
 v_mul_f32 v29, s32, v29
 v_mfma_f32_16x16x32_bf16 v[176:179], a[248:251], v[48:51], v[176:179]
 ds_read_b64_tr_b16 a[244:245], v6 offset:36864
 v_cvt_pk_bf16_f32 v28, v28, v29
 v_mfma_f32_16x16x32_bf16 v[184:187], a[248:251], v[52:55], v[184:187]
 ds_read_b64_tr_b16 a[246:247], v6 offset:38912
 v_cmp_lt_f32 vcc, 0x41200000, v13
 v_accvgpr_write_b32 a156, v28
 v_mfma_f32_16x16x32_bf16 v[180:183], a[252:255], v[48:51], v[180:183]
 ds_read_b64_tr_b16 a[248:249], v7 offset:36864
 s_waitcnt lgkmcnt(5)
 s_cbranch_vccnz L_rs0_12
L_rb0_12:
 v_accvgpr_read_b32 v30, a202
 v_mfma_f32_16x16x32_bf16 v[188:191], a[252:255], v[52:55], v[188:191]
 ds_read_b64_tr_b16 a[250:251], v7 offset:38912
 v_accvgpr_read_b32 v31, a203
 v_mfma_f32_16x16x32_bf16 v[192:195], a[224:227], v[48:51], v[192:195]
 ds_read_b64_tr_b16 a[252:253], v8 offset:36864
 v_mul_f32 v30, s32, v30
 v_mfma_f32_16x16x32_bf16 v[200:203], a[224:227], v[52:55], v[200:203]
 ds_read_b64_tr_b16 a[254:255], v8 offset:38912
 v_mul_f32 v31, s32, v31
 v_mfma_f32_16x16x32_bf16 v[196:199], a[228:231], v[48:51], v[196:199]
 ds_read_b64_tr_b16 a[224:225], v24 offset:8192
 v_cvt_pk_bf16_f32 v30, v30, v31
 v_mfma_f32_16x16x32_bf16 v[204:207], a[228:231], v[52:55], v[204:207]
 ds_read_b64_tr_b16 a[226:227], v24 offset:10240
 v_accvgpr_write_b32 a157, v30
 v_mfma_f32_16x16x32_bf16 v[208:211], a[232:235], v[48:51], v[208:211]
 ds_read_b64_tr_b16 a[228:229], v24 offset:8200
 ds_read_b32 v10, v9
 v_accvgpr_read_b32 v28, a204
 v_mfma_f32_16x16x32_bf16 v[216:219], a[232:235], v[52:55], v[216:219]
 ds_read_b64_tr_b16 a[230:231], v24 offset:10248
 v_accvgpr_read_b32 v29, a205
 v_mfma_f32_16x16x32_bf16 v[212:215], a[236:239], v[48:51], v[212:215]
 ds_read_b64_tr_b16 a[232:233], v25 offset:8192
 s_waitcnt lgkmcnt(6)
 v_mul_f32 v28, s32, v28
 v_mfma_f32_16x16x32_bf16 v[220:223], a[236:239], v[52:55], v[220:223]
 ds_read_b64_tr_b16 a[234:235], v25 offset:10240
 v_mul_f32 v29, s32, v29
 v_mfma_f32_16x16x32_bf16 v[224:227], a[240:243], v[48:51], v[224:227]
 ds_read_b64_tr_b16 a[236:237], v25 offset:8200
 v_cvt_pk_bf16_f32 v28, v28, v29
 v_mfma_f32_16x16x32_bf16 v[232:235], a[240:243], v[52:55], v[232:235]
 ds_read_b64_tr_b16 a[238:239], v25 offset:10248
 v_accvgpr_write_b32 a158, v28
 v_mfma_f32_16x16x32_bf16 v[228:231], a[244:247], v[48:51], v[228:231]
 ds_read_b64_tr_b16 a[240:241], v24 offset:12288
 v_accvgpr_read_b32 v30, a206
 v_mfma_f32_16x16x32_bf16 v[236:239], a[244:247], v[52:55], v[236:239]
 ds_read_b64_tr_b16 a[242:243], v24 offset:14336
 v_accvgpr_read_b32 v31, a207
 v_mfma_f32_16x16x32_bf16 v[240:243], a[248:251], v[48:51], v[240:243]
 ds_read_b64_tr_b16 a[244:245], v24 offset:12296
 v_mul_f32 v30, s32, v30
 v_mfma_f32_16x16x32_bf16 v[248:251], a[248:251], v[52:55], v[248:251]
 ds_read_b64_tr_b16 a[246:247], v24 offset:14344
 v_mul_f32 v31, s32, v31
 v_mfma_f32_16x16x32_bf16 v[244:247], a[252:255], v[48:51], v[244:247]
 ds_read_b64_tr_b16 a[248:249], v25 offset:12288
 v_cvt_pk_bf16_f32 v30, v30, v31
 v_accvgpr_write_b32 a159, v30
 v_mfma_f32_16x16x32_bf16 v[252:255], a[252:255], v[52:55], v[252:255]
 ds_read_b64_tr_b16 a[250:251], v25 offset:14336
 s_waitcnt lgkmcnt(6)
 s_movk_i32 s70, 396
 v_mfma_f32_16x16x32_bf16 a[176:179], a[224:227], a[0:3], 0
 ds_read_b64_tr_b16 a[252:253], v25 offset:12296
 buffer_load_dword off, s[72:75], s70 lds
 v_cmp_le_u32 vcc, 108, v10
 v_mfma_f32_16x16x32_bf16 a[184:187], a[224:227], a[4:7], 0
 ds_read_b64_tr_b16 a[254:255], v25 offset:14344
 v_mfma_f32_16x16x32_bf16 a[180:183], a[228:231], a[0:3], 0
 s_cbranch_vccz L_cs800
L_cb800:
 ds_read_b64_tr_b16 a[224:225], v24 offset:16384
 v_mfma_f32_16x16x32_bf16 a[188:191], a[228:231], a[4:7], 0
 ds_read_b64_tr_b16 a[226:227], v24 offset:18432
 v_mfma_f32_16x16x32_bf16 a[192:195], a[232:235], a[0:3], 0
 ds_read_b64_tr_b16 a[228:229], v24 offset:16392
 ds_read_b32 v10, v9
 v_mfma_f32_16x16x32_bf16 a[200:203], a[232:235], a[4:7], 0
 ds_read_b64_tr_b16 a[230:231], v24 offset:18440
 v_mfma_f32_16x16x32_bf16 a[196:199], a[236:239], a[0:3], 0
 ds_read_b64_tr_b16 a[232:233], v25 offset:16384
 s_waitcnt lgkmcnt(6)
 v_mfma_f32_16x16x32_bf16 a[204:207], a[236:239], a[4:7], 0
 ds_read_b64_tr_b16 a[234:235], v25 offset:18432
 v_mfma_f32_16x16x32_bf16 a[176:179], a[240:243], a[8:11], a[176:179]
 ds_read_b64_tr_b16 a[236:237], v25 offset:16392
 v_mfma_f32_16x16x32_bf16 a[184:187], a[240:243], a[12:15], a[184:187]
 ds_read_b64_tr_b16 a[238:239], v25 offset:18440
 v_mfma_f32_16x16x32_bf16 a[180:183], a[244:247], a[8:11], a[180:183]
 ds_read_b64_tr_b16 a[240:241], v24 offset:20480
 v_mfma_f32_16x16x32_bf16 a[188:191], a[244:247], a[12:15], a[188:191]
 ds_read_b64_tr_b16 a[242:243], v24 offset:22528
 v_mfma_f32_16x16x32_bf16 a[192:195], a[248:251], a[8:11], a[192:195]
 ds_read_b64_tr_b16 a[244:245], v24 offset:20488
 v_mfma_f32_16x16x32_bf16 a[200:203], a[248:251], a[12:15], a[200:203]
 ds_read_b64_tr_b16 a[246:247], v24 offset:22536
 v_mfma_f32_16x16x32_bf16 a[196:199], a[252:255], a[8:11], a[196:199]
 ds_read_b64_tr_b16 a[248:249], v25 offset:20480
 s_waitcnt lgkmcnt(5)
 v_mfma_f32_16x16x32_bf16 a[204:207], a[252:255], a[12:15], a[204:207]
 ds_read_b64_tr_b16 a[250:251], v25 offset:22528
 v_mfma_f32_16x16x32_bf16 a[176:179], a[224:227], a[16:19], a[176:179]
 ds_read_b64_tr_b16 a[252:253], v25 offset:20488
 v_cmp_le_u32 vcc, 112, v10
 v_mfma_f32_16x16x32_bf16 a[184:187], a[224:227], a[20:23], a[184:187]
 ds_read_b64_tr_b16 a[254:255], v25 offset:22536
 v_mfma_f32_16x16x32_bf16 a[180:183], a[228:231], a[16:19], a[180:183]
 s_cbranch_vccz L_cs808
L_cb808:
 ds_read_b128 a[224:227], v3 offset:40960
 v_mfma_f32_16x16x32_bf16 a[188:191], a[228:231], a[20:23], a[188:191]
 v_exp_f32 v32, v32
 v_mfma_f32_16x16x32_bf16 a[192:195], a[232:235], a[16:19], a[192:195]
 ds_read_b128 a[228:231], v3 offset:43008
 v_add_f32 v14, v14, v32
 v_mfma_f32_16x16x32_bf16 a[200:203], a[232:235], a[20:23], a[200:203]
 v_exp_f32 v33, v33
 v_mfma_f32_16x16x32_bf16 a[196:199], a[236:239], a[16:19], a[196:199]
 ds_read_b128 a[232:235], v4 offset:40960
 s_waitcnt lgkmcnt(3)
 v_mfma_f32_16x16x32_bf16 a[204:207], a[236:239], a[20:23], a[204:207]
 v_exp_f32 v34, v34
 v_mfma_f32_16x16x32_bf16 a[176:179], a[240:243], a[24:27], a[176:179]
 ds_read_b128 a[236:239], v4 offset:43008
 v_add_f32 v14, v14, v33
 v_mfma_f32_16x16x32_bf16 a[184:187], a[240:243], a[28:31], a[184:187]
 v_exp_f32 v35, v35
 v_mfma_f32_16x16x32_bf16 a[180:183], a[244:247], a[24:27], a[180:183]
 ds_read_b128 a[240:243], v3 offset:45056
 v_cvt_pk_bf16_f32 v32, v32, v33
 v_mfma_f32_16x16x32_bf16 a[188:191], a[244:247], a[28:31], a[188:191]
 v_exp_f32 v36, v36
 v_mfma_f32_16x16x32_bf16 a[192:195], a[248:251], a[24:27], a[192:195]
 ds_read_b128 a[244:247], v3 offset:47104
 s_movk_i32 s70, 404
 v_mfma_f32_16x16x32_bf16 a[200:203], a[248:251], a[28:31], a[200:203]
 v_exp_f32 v37, v37
 v_mfma_f32_16x16x32_bf16 a[196:199], a[252:255], a[24:27], a[196:199]
 ds_read_b128 a[248:251], v4 offset:45056
 s_waitcnt lgkmcnt(3)
 v_mfma_f32_16x16x32_bf16 a[204:207], a[252:255], a[28:31], a[204:207]
 buffer_load_dword off, s[72:75], s70 lds
 v_mfma_f32_16x16x32_bf16 v[48:51], a[224:227], v[64:67], v[16:19]
 ds_read_b128 a[252:255], v4 offset:47104
 v_add_f32 v14, v14, v34
 v_mfma_f32_16x16x32_bf16 v[56:59], a[224:227], v[68:71], v[20:23]
 v_exp_f32 v38, v38
 v_mfma_f32_16x16x32_bf16 v[52:55], a[228:231], v[64:67], v[16:19]
 ds_read_b128 a[224:227], v3 offset:8192
 v_add_f32 v14, v14, v35
 v_mfma_f32_16x16x32_bf16 v[60:63], a[228:231], v[68:71], v[20:23]
 v_exp_f32 v39, v39
 v_mfma_f32_16x16x32_bf16 v[48:51], a[232:235], v[72:75], v[48:51]
 ds_read_b128 a[228:231], v3 offset:10240
 v_cvt_pk_bf16_f32 v33, v34, v35
 v_mfma_f32_16x16x32_bf16 v[56:59], a[232:235], v[76:79], v[56:59]
 v_exp_f32 v40, v40
 v_mfma_f32_16x16x32_bf16 v[52:55], a[236:239], v[72:75], v[52:55]
 ds_read_b128 a[232:235], v4 offset:8192
 s_waitcnt lgkmcnt(3)
 v_exp_f32 v41, v41
 v_mfma_f32_16x16x32_bf16 v[60:63], a[236:239], v[76:79], v[60:63]
 v_exp_f32 v42, v42
 v_mfma_f32_16x16x32_bf16 v[48:51], a[240:243], v[80:83], v[48:51]
 ds_read_b128 a[236:239], v4 offset:10240
 v_add_f32 v14, v14, v36
 v_mfma_f32_16x16x32_bf16 v[56:59], a[240:243], v[84:87], v[56:59]
 v_exp_f32 v43, v43
 v_mfma_f32_16x16x32_bf16 v[52:55], a[244:247], v[80:83], v[52:55]
 ds_read_b128 a[240:243], v3 offset:12288
 v_add_f32 v14, v14, v37
 v_mfma_f32_16x16x32_bf16 v[60:63], a[244:247], v[84:87], v[60:63]
 v_exp_f32 v44, v44
 v_mfma_f32_16x16x32_bf16 v[48:51], a[248:251], v[88:91], v[48:51]
 ds_read_b128 a[244:247], v3 offset:14336
 v_cvt_pk_bf16_f32 v34, v36, v37
 v_mfma_f32_16x16x32_bf16 v[56:59], a[248:251], v[92:95], v[56:59]
 v_exp_f32 v45, v45
 v_mfma_f32_16x16x32_bf16 v[52:55], a[252:255], v[88:91], v[52:55]
 ds_read_b128 a[248:251], v4 offset:12288
 s_waitcnt lgkmcnt(3)
 v_mfma_f32_16x16x32_bf16 v[60:63], a[252:255], v[92:95], v[60:63]
 v_exp_f32 v46, v46
 v_mfma_f32_16x16x32_bf16 v[48:51], a[224:227], v[96:99], v[48:51]
 ds_read_b128 a[252:255], v4 offset:14336
 v_add_f32 v14, v14, v38
 v_mfma_f32_16x16x32_bf16 v[56:59], a[224:227], v[100:103], v[56:59]
 v_exp_f32 v47, v47
 v_mfma_f32_16x16x32_bf16 v[52:55], a[228:231], v[96:99], v[52:55]
 ds_read_b64_tr_b16 a[224:225], v5 offset:49152
 v_add_f32 v14, v14, v39
 v_mfma_f32_16x16x32_bf16 v[60:63], a[228:231], v[100:103], v[60:63]
 ds_read_b64_tr_b16 a[226:227], v5 offset:51200
 v_cvt_pk_bf16_f32 v35, v38, v39
 v_mfma_f32_16x16x32_bf16 v[48:51], a[232:235], v[104:107], v[48:51]
 ds_read_b64_tr_b16 a[228:229], v6 offset:49152
 ds_read_b32 v10, v9
 v_add_f32 v15, v15, v40
 v_mfma_f32_16x16x32_bf16 v[56:59], a[232:235], v[108:111], v[56:59]
 ds_read_b64_tr_b16 a[230:231], v6 offset:51200
 v_add_f32 v15, v15, v41
 v_mfma_f32_16x16x32_bf16 v[52:55], a[236:239], v[104:107], v[52:55]
 ds_read_b64_tr_b16 a[232:233], v7 offset:49152
 s_waitcnt lgkmcnt(6)
 v_cvt_pk_bf16_f32 v36, v40, v41
 v_mfma_f32_16x16x32_bf16 v[60:63], a[236:239], v[108:111], v[60:63]
 ds_read_b64_tr_b16 a[234:235], v7 offset:51200
 v_add_f32 v15, v15, v42
 v_mfma_f32_16x16x32_bf16 v[48:51], a[240:243], v[112:115], v[48:51]
 ds_read_b64_tr_b16 a[236:237], v8 offset:49152
 v_add_f32 v15, v15, v43
 v_mfma_f32_16x16x32_bf16 v[56:59], a[240:243], v[116:119], v[56:59]
 ds_read_b64_tr_b16 a[238:239], v8 offset:51200
 v_cvt_pk_bf16_f32 v37, v42, v43
 v_mfma_f32_16x16x32_bf16 v[52:55], a[244:247], v[112:115], v[52:55]
 ds_read_b64_tr_b16 a[240:241], v5 offset:53248
 v_add_f32 v15, v15, v44
 v_mfma_f32_16x16x32_bf16 v[60:63], a[244:247], v[116:119], v[60:63]
 ds_read_b64_tr_b16 a[242:243], v5 offset:55296
 v_add_f32 v15, v15, v45
 v_mfma_f32_16x16x32_bf16 v[48:51], a[248:251], v[120:123], v[48:51]
 ds_read_b64_tr_b16 a[244:245], v6 offset:53248
 v_cvt_pk_bf16_f32 v38, v44, v45
 v_mfma_f32_16x16x32_bf16 v[56:59], a[248:251], v[124:127], v[56:59]
 ds_read_b64_tr_b16 a[246:247], v6 offset:55296
 v_add_f32 v15, v15, v46
 v_mfma_f32_16x16x32_bf16 v[52:55], a[252:255], v[120:123], v[52:55]
 ds_read_b64_tr_b16 a[248:249], v7 offset:53248
 v_add_f32 v15, v15, v47
 v_cvt_pk_bf16_f32 v39, v46, v47
 v_mfma_f32_16x16x32_bf16 v[60:63], a[252:255], v[124:127], v[60:63]
 ds_read_b64_tr_b16 a[250:251], v7 offset:55296
 s_waitcnt lgkmcnt(6)
 s_movk_i32 s70, 412
 buffer_load_dword off, s[72:75], s70 lds
 v_mfma_f32_16x16x32_bf16 v[128:131], a[224:227], v[32:35], v[128:131]
 ds_read_b64_tr_b16 a[252:253], v8 offset:53248
 v_cmp_le_u32 vcc, 113, v10
 v_mfma_f32_16x16x32_bf16 v[136:139], a[224:227], v[36:39], v[136:139]
 ds_read_b64_tr_b16 a[254:255], v8 offset:55296
 v_add_u32 v5, 0x10000, v5
 v_mfma_f32_16x16x32_bf16 v[132:135], a[228:231], v[32:35], v[132:135]
 s_cbranch_vccz L_cs832
L_cb832:
 ds_read_b64_tr_b16 a[224:225], v5 offset:0
 v_add_u32 v6, 0x10000, v6
 v_mfma_f32_16x16x32_bf16 v[140:143], a[228:231], v[36:39], v[140:143]
 ds_read_b64_tr_b16 a[226:227], v5 offset:2048
 v_add_u32 v7, 0x10000, v7
 v_mfma_f32_16x16x32_bf16 v[144:147], a[232:235], v[32:35], v[144:147]
 ds_read_b64_tr_b16 a[228:229], v6 offset:0
 v_add_u32 v8, 0x10000, v8
 v_mfma_f32_16x16x32_bf16 v[152:155], a[232:235], v[36:39], v[152:155]
 ds_read_b64_tr_b16 a[230:231], v6 offset:2048
 v_max3_f32 v11, v48, v49, v50
 v_mfma_f32_16x16x32_bf16 v[148:151], a[236:239], v[32:35], v[148:151]
 ds_read_b64_tr_b16 a[232:233], v7 offset:0
 s_waitcnt lgkmcnt(5)
 v_max3_f32 v12, v56, v57, v58
 v_mfma_f32_16x16x32_bf16 v[156:159], a[236:239], v[36:39], v[156:159]
 ds_read_b64_tr_b16 a[234:235], v7 offset:2048
 v_max3_f32 v11, v11, v51, v52
 v_mfma_f32_16x16x32_bf16 v[160:163], a[240:243], v[32:35], v[160:163]
 ds_read_b64_tr_b16 a[236:237], v8 offset:0
 v_max3_f32 v12, v12, v59, v60
 v_mfma_f32_16x16x32_bf16 v[168:171], a[240:243], v[36:39], v[168:171]
 ds_read_b64_tr_b16 a[238:239], v8 offset:2048
 v_max3_f32 v11, v11, v53, v54
 v_mfma_f32_16x16x32_bf16 v[164:167], a[244:247], v[32:35], v[164:167]
 ds_read_b64_tr_b16 a[240:241], v5 offset:4096
 v_max3_f32 v12, v12, v61, v62
 v_mfma_f32_16x16x32_bf16 v[172:175], a[244:247], v[36:39], v[172:175]
 ds_read_b64_tr_b16 a[242:243], v5 offset:6144
 v_max_f32 v11, v11, v55
 v_mfma_f32_16x16x32_bf16 v[176:179], a[248:251], v[32:35], v[176:179]
 ds_read_b64_tr_b16 a[244:245], v6 offset:4096
 v_max_f32 v12, v12, v63
 v_mfma_f32_16x16x32_bf16 v[184:187], a[248:251], v[36:39], v[184:187]
 ds_read_b64_tr_b16 a[246:247], v6 offset:6144
 v_max_f32 v13, v11, v12
 v_cmp_lt_f32 vcc, 0x41200000, v13
 v_mfma_f32_16x16x32_bf16 v[180:183], a[252:255], v[32:35], v[180:183]
 ds_read_b64_tr_b16 a[248:249], v7 offset:4096
 s_waitcnt lgkmcnt(5)
 s_cbranch_vccnz L_rs0_13
L_rb0_13:
 v_mfma_f32_16x16x32_bf16 v[188:191], a[252:255], v[36:39], v[188:191]
 ds_read_b64_tr_b16 a[250:251], v7 offset:6144
 v_mfma_f32_16x16x32_bf16 v[192:195], a[224:227], v[32:35], v[192:195]
 ds_read_b64_tr_b16 a[252:253], v8 offset:4096
 v_mfma_f32_16x16x32_bf16 v[200:203], a[224:227], v[36:39], v[200:203]
 ds_read_b64_tr_b16 a[254:255], v8 offset:6144
 v_mfma_f32_16x16x32_bf16 v[196:199], a[228:231], v[32:35], v[196:199]
 ds_read_b64_tr_b16 a[224:225], v24 offset:24576
 v_mfma_f32_16x16x32_bf16 v[204:207], a[228:231], v[36:39], v[204:207]
 ds_read_b64_tr_b16 a[226:227], v24 offset:26624
 v_mfma_f32_16x16x32_bf16 v[208:211], a[232:235], v[32:35], v[208:211]
 ds_read_b64_tr_b16 a[228:229], v24 offset:24584
 ds_read_b32 v10, v9
 v_mfma_f32_16x16x32_bf16 v[216:219], a[232:235], v[36:39], v[216:219]
 ds_read_b64_tr_b16 a[230:231], v24 offset:26632
 v_mfma_f32_16x16x32_bf16 v[212:215], a[236:239], v[32:35], v[212:215]
 ds_read_b64_tr_b16 a[232:233], v25 offset:24576
 s_waitcnt lgkmcnt(6)
 v_mfma_f32_16x16x32_bf16 v[220:223], a[236:239], v[36:39], v[220:223]
 ds_read_b64_tr_b16 a[234:235], v25 offset:26624
 v_mfma_f32_16x16x32_bf16 v[224:227], a[240:243], v[32:35], v[224:227]
 ds_read_b64_tr_b16 a[236:237], v25 offset:24584
 v_mfma_f32_16x16x32_bf16 v[232:235], a[240:243], v[36:39], v[232:235]
 ds_read_b64_tr_b16 a[238:239], v25 offset:26632
 v_mfma_f32_16x16x32_bf16 v[228:231], a[244:247], v[32:35], v[228:231]
 ds_read_b64_tr_b16 a[240:241], v24 offset:28672
 v_add_u32 v3, 0x10000, v3
 v_mfma_f32_16x16x32_bf16 v[236:239], a[244:247], v[36:39], v[236:239]
 ds_read_b64_tr_b16 a[242:243], v24 offset:30720
 s_movk_i32 s70, 420
 v_mfma_f32_16x16x32_bf16 v[240:243], a[248:251], v[32:35], v[240:243]
 ds_read_b64_tr_b16 a[244:245], v24 offset:28680
 v_mfma_f32_16x16x32_bf16 v[248:251], a[248:251], v[36:39], v[248:251]
 ds_read_b64_tr_b16 a[246:247], v24 offset:30728
 v_mfma_f32_16x16x32_bf16 v[244:247], a[252:255], v[32:35], v[244:247]
 ds_read_b64_tr_b16 a[248:249], v25 offset:28672
 s_waitcnt lgkmcnt(5)
 v_mfma_f32_16x16x32_bf16 v[252:255], a[252:255], v[36:39], v[252:255]
 ds_read_b64_tr_b16 a[250:251], v25 offset:30720
 v_add_u32 v4, 0x10000, v4
 v_mfma_f32_16x16x32_bf16 a[176:179], a[224:227], a[32:35], a[176:179]
 ds_read_b64_tr_b16 a[252:253], v25 offset:28680
 buffer_load_dword off, s[72:75], s70 lds
 v_cmp_le_u32 vcc, 114, v10
 v_mfma_f32_16x16x32_bf16 a[184:187], a[224:227], a[36:39], a[184:187]
 ds_read_b64_tr_b16 a[254:255], v25 offset:30728
 v_mfma_f32_16x16x32_bf16 a[180:183], a[228:231], a[32:35], a[180:183]
 s_cbranch_vccz L_cs848
L_cb848:
 ds_read_b64_tr_b16 a[224:225], v24 offset:40960
 v_mfma_f32_16x16x32_bf16 a[188:191], a[228:231], a[36:39], a[188:191]
 ds_read_b64_tr_b16 a[226:227], v24 offset:43008
 v_mfma_f32_16x16x32_bf16 a[192:195], a[232:235], a[32:35], a[192:195]
 ds_read_b64_tr_b16 a[228:229], v24 offset:40968
 ds_read_b32 v10, v9
 v_mfma_f32_16x16x32_bf16 a[200:203], a[232:235], a[36:39], a[200:203]
 ds_read_b64_tr_b16 a[230:231], v24 offset:43016
 v_mfma_f32_16x16x32_bf16 a[196:199], a[236:239], a[32:35], a[196:199]
 ds_read_b64_tr_b16 a[232:233], v25 offset:40960
 s_waitcnt lgkmcnt(6)
 v_mfma_f32_16x16x32_bf16 a[204:207], a[236:239], a[36:39], a[204:207]
 ds_read_b64_tr_b16 a[234:235], v25 offset:43008
 v_mfma_f32_16x16x32_bf16 a[176:179], a[240:243], a[40:43], a[176:179]
 ds_read_b64_tr_b16 a[236:237], v25 offset:40968
 v_mfma_f32_16x16x32_bf16 a[184:187], a[240:243], a[44:47], a[184:187]
 ds_read_b64_tr_b16 a[238:239], v25 offset:43016
 v_mfma_f32_16x16x32_bf16 a[180:183], a[244:247], a[40:43], a[180:183]
 ds_read_b64_tr_b16 a[240:241], v24 offset:45056
 v_mfma_f32_16x16x32_bf16 a[188:191], a[244:247], a[44:47], a[188:191]
 ds_read_b64_tr_b16 a[242:243], v24 offset:47104
 v_mfma_f32_16x16x32_bf16 a[192:195], a[248:251], a[40:43], a[192:195]
 ds_read_b64_tr_b16 a[244:245], v24 offset:45064
 v_mfma_f32_16x16x32_bf16 a[200:203], a[248:251], a[44:47], a[200:203]
 ds_read_b64_tr_b16 a[246:247], v24 offset:47112
 v_mfma_f32_16x16x32_bf16 a[196:199], a[252:255], a[40:43], a[196:199]
 ds_read_b64_tr_b16 a[248:249], v25 offset:45056
 s_waitcnt lgkmcnt(5)
 v_mfma_f32_16x16x32_bf16 a[204:207], a[252:255], a[44:47], a[204:207]
 ds_read_b64_tr_b16 a[250:251], v25 offset:47104
 v_mfma_f32_16x16x32_bf16 a[176:179], a[224:227], a[48:51], a[176:179]
 ds_read_b64_tr_b16 a[252:253], v25 offset:45064
 v_cmp_le_u32 vcc, 118, v10
 v_mfma_f32_16x16x32_bf16 a[184:187], a[224:227], a[52:55], a[184:187]
 ds_read_b64_tr_b16 a[254:255], v25 offset:47112
 v_mfma_f32_16x16x32_bf16 a[180:183], a[228:231], a[48:51], a[180:183]
 s_cbranch_vccz L_cs856
L_cb856:
 ds_read_b128 a[224:227], v3 offset:8192
 v_mfma_f32_16x16x32_bf16 a[188:191], a[228:231], a[52:55], a[188:191]
 v_exp_f32 v48, v48
 v_mfma_f32_16x16x32_bf16 a[192:195], a[232:235], a[48:51], a[192:195]
 ds_read_b128 a[228:231], v3 offset:10240
 v_add_f32 v14, v14, v48
 v_mfma_f32_16x16x32_bf16 a[200:203], a[232:235], a[52:55], a[200:203]
 v_exp_f32 v49, v49
 v_mfma_f32_16x16x32_bf16 a[196:199], a[236:239], a[48:51], a[196:199]
 ds_read_b128 a[232:235], v4 offset:8192
 s_waitcnt lgkmcnt(3)
 v_mfma_f32_16x16x32_bf16 a[204:207], a[236:239], a[52:55], a[204:207]
 v_exp_f32 v50, v50
 v_mfma_f32_16x16x32_bf16 a[176:179], a[240:243], a[56:59], a[176:179]
 ds_read_b128 a[236:239], v4 offset:10240
 v_add_f32 v14, v14, v49
 v_mfma_f32_16x16x32_bf16 a[184:187], a[240:243], a[60:63], a[184:187]
 v_exp_f32 v51, v51
 v_mfma_f32_16x16x32_bf16 a[180:183], a[244:247], a[56:59], a[180:183]
 ds_read_b128 a[240:243], v3 offset:12288
 v_cvt_pk_bf16_f32 v48, v48, v49
 v_mfma_f32_16x16x32_bf16 a[188:191], a[244:247], a[60:63], a[188:191]
 v_exp_f32 v52, v52
 v_mfma_f32_16x16x32_bf16 a[192:195], a[248:251], a[56:59], a[192:195]
 ds_read_b128 a[244:247], v3 offset:14336
 s_movk_i32 s70, 428
 v_mfma_f32_16x16x32_bf16 a[200:203], a[248:251], a[60:63], a[200:203]
 v_exp_f32 v53, v53
 v_mfma_f32_16x16x32_bf16 a[196:199], a[252:255], a[56:59], a[196:199]
 ds_read_b128 a[248:251], v4 offset:12288
 s_waitcnt lgkmcnt(3)
 v_mfma_f32_16x16x32_bf16 a[204:207], a[252:255], a[60:63], a[204:207]
 buffer_load_dword off, s[72:75], s70 lds
 v_add_u32 v3, 0xfffe0000, v3
 v_mfma_f32_16x16x32_bf16 v[32:35], a[224:227], v[64:67], v[16:19]
 ds_read_b128 a[252:255], v4 offset:14336
 v_add_u32 v4, 0xfffe0000, v4
 v_exp_f32 v54, v54
 v_mfma_f32_16x16x32_bf16 v[40:43], a[224:227], v[68:71], v[20:23]
 v_exp_f32 v55, v55
 v_mfma_f32_16x16x32_bf16 v[36:39], a[228:231], v[64:67], v[16:19]
 ds_read_b128 a[224:227], v3 offset:57344
 v_add_f32 v14, v14, v50
 v_mfma_f32_16x16x32_bf16 v[44:47], a[228:231], v[68:71], v[20:23]
 v_exp_f32 v56, v56
 v_mfma_f32_16x16x32_bf16 v[32:35], a[232:235], v[72:75], v[32:35]
 ds_read_b128 a[228:231], v3 offset:59392
 v_add_f32 v14, v14, v51
 v_mfma_f32_16x16x32_bf16 v[40:43], a[232:235], v[76:79], v[40:43]
 v_exp_f32 v57, v57
 v_mfma_f32_16x16x32_bf16 v[36:39], a[236:239], v[72:75], v[36:39]
 ds_read_b128 a[232:235], v4 offset:57344
 s_waitcnt lgkmcnt(3)
 v_mfma_f32_16x16x32_bf16 v[44:47], a[236:239], v[76:79], v[44:47]
 v_exp_f32 v58, v58
 v_mfma_f32_16x16x32_bf16 v[32:35], a[240:243], v[80:83], v[32:35]
 ds_read_b128 a[236:239], v4 offset:59392
 v_cvt_pk_bf16_f32 v49, v50, v51
 v_mfma_f32_16x16x32_bf16 v[40:43], a[240:243], v[84:87], v[40:43]
 v_exp_f32 v59, v59
 v_mfma_f32_16x16x32_bf16 v[36:39], a[244:247], v[80:83], v[36:39]
 ds_read_b128 a[240:243], v3 offset:61440
 v_add_f32 v14, v14, v52
 v_mfma_f32_16x16x32_bf16 v[44:47], a[244:247], v[84:87], v[44:47]
 v_exp_f32 v60, v60
 v_mfma_f32_16x16x32_bf16 v[32:35], a[248:251], v[88:91], v[32:35]
 ds_read_b128 a[244:247], v3 offset:63488
 v_add_f32 v14, v14, v53
 v_mfma_f32_16x16x32_bf16 v[40:43], a[248:251], v[92:95], v[40:43]
 v_exp_f32 v61, v61
 v_mfma_f32_16x16x32_bf16 v[36:39], a[252:255], v[88:91], v[36:39]
 ds_read_b128 a[248:251], v4 offset:61440
 s_waitcnt lgkmcnt(3)
 v_exp_f32 v62, v62
 v_mfma_f32_16x16x32_bf16 v[44:47], a[252:255], v[92:95], v[44:47]
 v_exp_f32 v63, v63
 v_mfma_f32_16x16x32_bf16 v[32:35], a[224:227], v[96:99], v[32:35]
 ds_read_b128 a[252:255], v4 offset:63488
 v_cvt_pk_bf16_f32 v50, v52, v53
 v_mfma_f32_16x16x32_bf16 v[40:43], a[224:227], v[100:103], v[40:43]
 v_add_f32 v14, v14, v54
 v_add_f32 v14, v14, v55
 v_mfma_f32_16x16x32_bf16 v[36:39], a[228:231], v[96:99], v[36:39]
 ds_read_b64_tr_b16 a[224:225], v5 offset:16384
 v_cvt_pk_bf16_f32 v51, v54, v55
 v_mfma_f32_16x16x32_bf16 v[44:47], a[228:231], v[100:103], v[44:47]
 ds_read_b64_tr_b16 a[226:227], v5 offset:18432
 v_add_f32 v15, v15, v56
 v_mfma_f32_16x16x32_bf16 v[32:35], a[232:235], v[104:107], v[32:35]
 ds_read_b64_tr_b16 a[228:229], v6 offset:16384
 ds_read_b32 v10, v9
 v_mfma_f32_16x16x32_bf16 v[40:43], a[232:235], v[108:111], v[40:43]
 ds_read_b64_tr_b16 a[230:231], v6 offset:18432
 v_add_f32 v15, v15, v57
 v_mfma_f32_16x16x32_bf16 v[36:39], a[236:239], v[104:107], v[36:39]
 ds_read_b64_tr_b16 a[232:233], v7 offset:16384
 s_waitcnt lgkmcnt(6)
 v_cvt_pk_bf16_f32 v52, v56, v57
 v_mfma_f32_16x16x32_bf16 v[44:47], a[236:239], v[108:111], v[44:47]
 ds_read_b64_tr_b16 a[234:235], v7 offset:18432
 v_add_f32 v15, v15, v58
 v_mfma_f32_16x16x32_bf16 v[32:35], a[240:243], v[112:115], v[32:35]
 ds_read_b64_tr_b16 a[236:237], v8 offset:16384
 v_add_f32 v15, v15, v59
 v_mfma_f32_16x16x32_bf16 v[40:43], a[240:243], v[116:119], v[40:43]
 ds_read_b64_tr_b16 a[238:239], v8 offset:18432
 v_cvt_pk_bf16_f32 v53, v58, v59
 v_mfma_f32_16x16x32_bf16 v[36:39], a[244:247], v[112:115], v[36:39]
 ds_read_b64_tr_b16 a[240:241], v5 offset:20480
 v_add_f32 v15, v15, v60
 v_mfma_f32_16x16x32_bf16 v[44:47], a[244:247], v[116:119], v[44:47]
 ds_read_b64_tr_b16 a[242:243], v5 offset:22528
 v_add_f32 v15, v15, v61
 v_mfma_f32_16x16x32_bf16 v[32:35], a[248:251], v[120:123], v[32:35]
 ds_read_b64_tr_b16 a[244:245], v6 offset:20480
 v_cvt_pk_bf16_f32 v54, v60, v61
 v_mfma_f32_16x16x32_bf16 v[40:43], a[248:251], v[124:127], v[40:43]
 ds_read_b64_tr_b16 a[246:247], v6 offset:22528
 v_add_f32 v15, v15, v62
 v_mfma_f32_16x16x32_bf16 v[36:39], a[252:255], v[120:123], v[36:39]
 ds_read_b64_tr_b16 a[248:249], v7 offset:20480
 v_add_f32 v15, v15, v63
 v_cvt_pk_bf16_f32 v55, v62, v63
 v_mfma_f32_16x16x32_bf16 v[44:47], a[252:255], v[124:127], v[44:47]
 ds_read_b64_tr_b16 a[250:251], v7 offset:22528
 s_waitcnt lgkmcnt(6)
 s_movk_i32 s70, 436
 buffer_load_dword off, s[72:75], s70 lds
 v_mfma_f32_16x16x32_bf16 v[128:131], a[224:227], v[48:51], v[128:131]
 ds_read_b64_tr_b16 a[252:253], v8 offset:20480
 v_cmp_le_u32 vcc, 119, v10
 v_mfma_f32_16x16x32_bf16 v[136:139], a[224:227], v[52:55], v[136:139]
 ds_read_b64_tr_b16 a[254:255], v8 offset:22528
 v_add_u32 v5, 0xffff0000, v5
 v_mfma_f32_16x16x32_bf16 v[132:135], a[228:231], v[48:51], v[132:135]
 s_cbranch_vccz L_cs880
L_cb880:
 ds_read_b64_tr_b16 a[224:225], v5 offset:0
 v_add_u32 v6, 0xffff0000, v6
 v_mfma_f32_16x16x32_bf16 v[140:143], a[228:231], v[52:55], v[140:143]
 ds_read_b64_tr_b16 a[226:227], v5 offset:2048
 v_add_u32 v7, 0xffff0000, v7
 v_mfma_f32_16x16x32_bf16 v[144:147], a[232:235], v[48:51], v[144:147]
 ds_read_b64_tr_b16 a[228:229], v6 offset:0
 v_add_u32 v8, 0xffff0000, v8
 v_mfma_f32_16x16x32_bf16 v[152:155], a[232:235], v[52:55], v[152:155]
 ds_read_b64_tr_b16 a[230:231], v6 offset:2048
 v_max3_f32 v11, v32, v33, v34
 v_mfma_f32_16x16x32_bf16 v[148:151], a[236:239], v[48:51], v[148:151]
 ds_read_b64_tr_b16 a[232:233], v7 offset:0
 s_waitcnt lgkmcnt(5)
 v_max3_f32 v12, v40, v41, v42
 v_mfma_f32_16x16x32_bf16 v[156:159], a[236:239], v[52:55], v[156:159]
 ds_read_b64_tr_b16 a[234:235], v7 offset:2048
 v_max3_f32 v11, v11, v35, v36
 v_mfma_f32_16x16x32_bf16 v[160:163], a[240:243], v[48:51], v[160:163]
 ds_read_b64_tr_b16 a[236:237], v8 offset:0
 v_max3_f32 v12, v12, v43, v44
 v_mfma_f32_16x16x32_bf16 v[168:171], a[240:243], v[52:55], v[168:171]
 ds_read_b64_tr_b16 a[238:239], v8 offset:2048
 v_max3_f32 v11, v11, v37, v38
 v_mfma_f32_16x16x32_bf16 v[164:167], a[244:247], v[48:51], v[164:167]
 ds_read_b64_tr_b16 a[240:241], v5 offset:4096
 v_max3_f32 v12, v12, v45, v46
 v_mfma_f32_16x16x32_bf16 v[172:175], a[244:247], v[52:55], v[172:175]
 ds_read_b64_tr_b16 a[242:243], v5 offset:6144
 v_max_f32 v11, v11, v39
 v_mfma_f32_16x16x32_bf16 v[176:179], a[248:251], v[48:51], v[176:179]
 ds_read_b64_tr_b16 a[244:245], v6 offset:4096
 v_max_f32 v12, v12, v47
 v_mfma_f32_16x16x32_bf16 v[184:187], a[248:251], v[52:55], v[184:187]
 ds_read_b64_tr_b16 a[246:247], v6 offset:6144
 v_max_f32 v13, v11, v12
 v_cmp_lt_f32 vcc, 0x41200000, v13
 v_mfma_f32_16x16x32_bf16 v[180:183], a[252:255], v[48:51], v[180:183]
 ds_read_b64_tr_b16 a[248:249], v7 offset:4096
 s_waitcnt lgkmcnt(5)
 s_cbranch_vccnz L_rs0_14
L_rb0_14:
 v_mfma_f32_16x16x32_bf16 v[188:191], a[252:255], v[52:55], v[188:191]
 ds_read_b64_tr_b16 a[250:251], v7 offset:6144
 v_mfma_f32_16x16x32_bf16 v[192:195], a[224:227], v[48:51], v[192:195]
 ds_read_b64_tr_b16 a[252:253], v8 offset:4096
 v_mfma_f32_16x16x32_bf16 v[200:203], a[224:227], v[52:55], v[200:203]
 ds_read_b64_tr_b16 a[254:255], v8 offset:6144
 v_mfma_f32_16x16x32_bf16 v[196:199], a[228:231], v[48:51], v[196:199]
 ds_read_b64_tr_b16 a[224:225], v24 offset:32768
 v_mfma_f32_16x16x32_bf16 v[204:207], a[228:231], v[52:55], v[204:207]
 ds_read_b64_tr_b16 a[226:227], v24 offset:34816
 v_mfma_f32_16x16x32_bf16 v[208:211], a[232:235], v[48:51], v[208:211]
 ds_read_b64_tr_b16 a[228:229], v24 offset:32776
 ds_read_b32 v10, v9
 v_mfma_f32_16x16x32_bf16 v[216:219], a[232:235], v[52:55], v[216:219]
 ds_read_b64_tr_b16 a[230:231], v24 offset:34824
 v_mfma_f32_16x16x32_bf16 v[212:215], a[236:239], v[48:51], v[212:215]
 ds_read_b64_tr_b16 a[232:233], v25 offset:32768
 s_waitcnt lgkmcnt(6)
 v_mfma_f32_16x16x32_bf16 v[220:223], a[236:239], v[52:55], v[220:223]
 ds_read_b64_tr_b16 a[234:235], v25 offset:34816
 v_mfma_f32_16x16x32_bf16 v[224:227], a[240:243], v[48:51], v[224:227]
 ds_read_b64_tr_b16 a[236:237], v25 offset:32776
 v_mfma_f32_16x16x32_bf16 v[232:235], a[240:243], v[52:55], v[232:235]
 ds_read_b64_tr_b16 a[238:239], v25 offset:34824
 v_mfma_f32_16x16x32_bf16 v[228:231], a[244:247], v[48:51], v[228:231]
 ds_read_b64_tr_b16 a[240:241], v24 offset:36864
 v_mfma_f32_16x16x32_bf16 v[236:239], a[244:247], v[52:55], v[236:239]
 ds_read_b64_tr_b16 a[242:243], v24 offset:38912
 s_movk_i32 s70, 444
 v_mfma_f32_16x16x32_bf16 v[240:243], a[248:251], v[48:51], v[240:243]
 ds_read_b64_tr_b16 a[244:245], v24 offset:36872
 v_mfma_f32_16x16x32_bf16 v[248:251], a[248:251], v[52:55], v[248:251]
 ds_read_b64_tr_b16 a[246:247], v24 offset:38920
 v_mfma_f32_16x16x32_bf16 v[244:247], a[252:255], v[48:51], v[244:247]
 ds_read_b64_tr_b16 a[248:249], v25 offset:36864
 s_waitcnt lgkmcnt(5)
 v_mfma_f32_16x16x32_bf16 v[252:255], a[252:255], v[52:55], v[252:255]
 ds_read_b64_tr_b16 a[250:251], v25 offset:38912
 buffer_load_dword off, s[72:75], s70 lds
 v_mfma_f32_16x16x32_bf16 a[176:179], a[224:227], a[64:67], a[176:179]
 ds_read_b64_tr_b16 a[252:253], v25 offset:36872
 v_cmp_le_u32 vcc, 121, v10
 v_mfma_f32_16x16x32_bf16 a[184:187], a[224:227], a[68:71], a[184:187]
 ds_read_b64_tr_b16 a[254:255], v25 offset:38920
 v_mfma_f32_16x16x32_bf16 a[180:183], a[228:231], a[64:67], a[180:183]
 s_cbranch_vccz L_cs896
L_cb896:
 ds_read_b64_tr_b16 a[224:225], v24 offset:0
 v_mfma_f32_16x16x32_bf16 a[188:191], a[228:231], a[68:71], a[188:191]
 ds_read_b64_tr_b16 a[226:227], v24 offset:2048
 v_mfma_f32_16x16x32_bf16 a[192:195], a[232:235], a[64:67], a[192:195]
 ds_read_b64_tr_b16 a[228:229], v24 offset:8
 v_mfma_f32_16x16x32_bf16 a[200:203], a[232:235], a[68:71], a[200:203]
 ds_read_b64_tr_b16 a[230:231], v24 offset:2056
 v_mfma_f32_16x16x32_bf16 a[196:199], a[236:239], a[64:67], a[196:199]
 ds_read_b64_tr_b16 a[232:233], v25 offset:0
 s_waitcnt lgkmcnt(5)
 v_mfma_f32_16x16x32_bf16 a[204:207], a[236:239], a[68:71], a[204:207]
 ds_read_b64_tr_b16 a[234:235], v25 offset:2048
 v_mfma_f32_16x16x32_bf16 a[176:179], a[240:243], a[72:75], a[176:179]
 ds_read_b64_tr_b16 a[236:237], v25 offset:8
 v_mfma_f32_16x16x32_bf16 a[184:187], a[240:243], a[76:79], a[184:187]
 ds_read_b64_tr_b16 a[238:239], v25 offset:2056
 v_mfma_f32_16x16x32_bf16 a[180:183], a[244:247], a[72:75], a[180:183]
 ds_read_b64_tr_b16 a[240:241], v24 offset:4096
 v_add_u32 v3, 0x10000, v3
 v_mfma_f32_16x16x32_bf16 a[188:191], a[244:247], a[76:79], a[188:191]
 ds_read_b64_tr_b16 a[242:243], v24 offset:6144
 v_mfma_f32_16x16x32_bf16 a[192:195], a[248:251], a[72:75], a[192:195]
 ds_read_b64_tr_b16 a[244:245], v24 offset:4104
 v_mfma_f32_16x16x32_bf16 a[200:203], a[248:251], a[76:79], a[200:203]
 ds_read_b64_tr_b16 a[246:247], v24 offset:6152
 v_mfma_f32_16x16x32_bf16 a[196:199], a[252:255], a[72:75], a[196:199]
 ds_read_b64_tr_b16 a[248:249], v25 offset:4096
 s_waitcnt lgkmcnt(5)
 v_mfma_f32_16x16x32_bf16 a[204:207], a[252:255], a[76:79], a[204:207]
 ds_read_b64_tr_b16 a[250:251], v25 offset:6144
 v_add_u32 v4, 0x10000, v4
 v_mfma_f32_16x16x32_bf16 a[176:179], a[224:227], a[80:83], a[176:179]
 ds_read_b64_tr_b16 a[252:253], v25 offset:4104
 v_mfma_f32_16x16x32_bf16 a[184:187], a[224:227], a[84:87], a[184:187]
 ds_read_b64_tr_b16 a[254:255], v25 offset:6152
 v_mfma_f32_16x16x32_bf16 a[180:183], a[228:231], a[80:83], a[180:183]
 ds_read_b64_tr_b16 a[224:225], v24 offset:8192
 v_mfma_f32_16x16x32_bf16 a[188:191], a[228:231], a[84:87], a[188:191]
 ds_read_b64_tr_b16 a[226:227], v24 offset:10240
 v_mfma_f32_16x16x32_bf16 a[192:195], a[232:235], a[80:83], a[192:195]
 ds_read_b64_tr_b16 a[228:229], v24 offset:8200
 ds_read_b32 v10, v9
 v_mfma_f32_16x16x32_bf16 a[200:203], a[232:235], a[84:87], a[200:203]
 ds_read_b64_tr_b16 a[230:231], v24 offset:10248
 v_mfma_f32_16x16x32_bf16 a[196:199], a[236:239], a[80:83], a[196:199]
 ds_read_b64_tr_b16 a[232:233], v25 offset:8192
 s_waitcnt lgkmcnt(6)
 v_mfma_f32_16x16x32_bf16 a[204:207], a[236:239], a[84:87], a[204:207]
 ds_read_b64_tr_b16 a[234:235], v25 offset:10240
 v_mfma_f32_16x16x32_bf16 a[176:179], a[240:243], a[88:91], a[176:179]
 ds_read_b64_tr_b16 a[236:237], v25 offset:8200
 v_mfma_f32_16x16x32_bf16 a[184:187], a[240:243], a[92:95], a[184:187]
 ds_read_b64_tr_b16 a[238:239], v25 offset:10248
 v_mfma_f32_16x16x32_bf16 a[180:183], a[244:247], a[88:91], a[180:183]
 ds_read_b64_tr_b16 a[240:241], v24 offset:12288
 v_mfma_f32_16x16x32_bf16 a[188:191], a[244:247], a[92:95], a[188:191]
 ds_read_b64_tr_b16 a[242:243], v24 offset:14336
 s_movk_i32 s70, 452
 v_mfma_f32_16x16x32_bf16 a[192:195], a[248:251], a[88:91], a[192:195]
 ds_read_b64_tr_b16 a[244:245], v24 offset:12296
 v_mfma_f32_16x16x32_bf16 a[200:203], a[248:251], a[92:95], a[200:203]
 ds_read_b64_tr_b16 a[246:247], v24 offset:14344
 v_mfma_f32_16x16x32_bf16 a[196:199], a[252:255], a[88:91], a[196:199]
 ds_read_b64_tr_b16 a[248:249], v25 offset:12288
 s_waitcnt lgkmcnt(5)
 v_mfma_f32_16x16x32_bf16 a[204:207], a[252:255], a[92:95], a[204:207]
 ds_read_b64_tr_b16 a[250:251], v25 offset:14336
 buffer_load_dword off, s[72:75], s70 lds
 v_mfma_f32_16x16x32_bf16 a[176:179], a[224:227], a[96:99], a[176:179]
 ds_read_b64_tr_b16 a[252:253], v25 offset:12296
 v_cmp_le_u32 vcc, 124, v10
 v_mfma_f32_16x16x32_bf16 a[184:187], a[224:227], a[100:103], a[184:187]
 ds_read_b64_tr_b16 a[254:255], v25 offset:14344
 v_mfma_f32_16x16x32_bf16 a[180:183], a[228:231], a[96:99], a[180:183]
 s_cbranch_vccz L_cs912
L_cb912:
 ds_read_b128 a[224:227], v3 offset:16384
 v_mfma_f32_16x16x32_bf16 a[188:191], a[228:231], a[100:103], a[188:191]
 v_exp_f32 v32, v32
 v_mfma_f32_16x16x32_bf16 a[192:195], a[232:235], a[96:99], a[192:195]
 ds_read_b128 a[228:231], v3 offset:18432
 v_add_f32 v14, v14, v32
 v_mfma_f32_16x16x32_bf16 a[200:203], a[232:235], a[100:103], a[200:203]
 v_exp_f32 v33, v33
 v_mfma_f32_16x16x32_bf16 a[196:199], a[236:239], a[96:99], a[196:199]
 ds_read_b128 a[232:235], v4 offset:16384
 s_waitcnt lgkmcnt(3)
 v_mfma_f32_16x16x32_bf16 a[204:207], a[236:239], a[100:103], a[204:207]
 v_exp_f32 v34, v34
 v_mfma_f32_16x16x32_bf16 a[176:179], a[240:243], a[104:107], a[176:179]
 ds_read_b128 a[236:239], v4 offset:18432
 v_add_f32 v14, v14, v33
 v_mfma_f32_16x16x32_bf16 a[184:187], a[240:243], a[108:111], a[184:187]
 v_exp_f32 v35, v35
 v_mfma_f32_16x16x32_bf16 a[180:183], a[244:247], a[104:107], a[180:183]
 ds_read_b128 a[240:243], v3 offset:20480
 v_cvt_pk_bf16_f32 v32, v32, v33
 v_mfma_f32_16x16x32_bf16 a[188:191], a[244:247], a[108:111], a[188:191]
 v_exp_f32 v36, v36
 v_mfma_f32_16x16x32_bf16 a[192:195], a[248:251], a[104:107], a[192:195]
 ds_read_b128 a[244:247], v3 offset:22528
 s_movk_i32 s70, 456
 v_mfma_f32_16x16x32_bf16 a[200:203], a[248:251], a[108:111], a[200:203]
 v_exp_f32 v37, v37
 v_mfma_f32_16x16x32_bf16 a[196:199], a[252:255], a[104:107], a[196:199]
 ds_read_b128 a[248:251], v4 offset:20480
 s_waitcnt lgkmcnt(3)
 v_mfma_f32_16x16x32_bf16 a[204:207], a[252:255], a[108:111], a[204:207]
 buffer_load_dword off, s[72:75], s70 lds
 v_mfma_f32_16x16x32_bf16 v[48:51], a[224:227], v[64:67], v[16:19]
 ds_read_b128 a[252:255], v4 offset:22528
 v_add_f32 v14, v14, v34
 v_mfma_f32_16x16x32_bf16 v[56:59], a[224:227], v[68:71], v[20:23]
 v_exp_f32 v38, v38
 v_mfma_f32_16x16x32_bf16 v[52:55], a[228:231], v[64:67], v[16:19]
 ds_read_b128 a[224:227], v3 offset:57344
 v_add_f32 v14, v14, v35
 v_exp_f32 v39, v39
 v_exp_f32 v40, v40
 v_exp_f32 v41, v41
 v_exp_f32 v42, v42
 v_exp_f32 v43, v43
 v_exp_f32 v44, v44
 v_exp_f32 v45, v45
 v_exp_f32 v46, v46
 v_exp_f32 v47, v47
 v_cvt_pk_bf16_f32 v33, v34, v35
 v_add_f32 v14, v14, v36
 v_add_f32 v14, v14, v37
 v_cvt_pk_bf16_f32 v34, v36, v37
 v_add_f32 v14, v14, v38
 v_accvgpr_read_b32 v28, a176
 v_accvgpr_read_b32 v29, a177
 v_mul_f32 v28, s32, v28
 v_mul_f32 v29, s32, v29
 v_cvt_pk_bf16_f32 v28, v28, v29
 v_mfma_f32_16x16x32_bf16 v[60:63], a[228:231], v[68:71], v[20:23]
 v_add_f32 v14, v14, v39
 v_cvt_pk_bf16_f32 v35, v38, v39
 v_mfma_f32_16x16x32_bf16 v[48:51], a[232:235], v[72:75], v[48:51]
 ds_read_b128 a[228:231], v3 offset:59392
 v_add_f32 v15, v15, v40
 v_mfma_f32_16x16x32_bf16 v[56:59], a[232:235], v[76:79], v[56:59]
 v_add_f32 v15, v15, v41
 v_cvt_pk_bf16_f32 v36, v40, v41
 v_mfma_f32_16x16x32_bf16 v[52:55], a[236:239], v[72:75], v[52:55]
 ds_read_b128 a[232:235], v4 offset:57344
 s_waitcnt lgkmcnt(3)
 v_add_f32 v15, v15, v42
 v_mfma_f32_16x16x32_bf16 v[60:63], a[236:239], v[76:79], v[60:63]
 v_add_f32 v15, v15, v43
 v_cvt_pk_bf16_f32 v37, v42, v43
 v_mfma_f32_16x16x32_bf16 v[48:51], a[240:243], v[80:83], v[48:51]
 ds_read_b128 a[236:239], v4 offset:59392
 v_add_f32 v15, v15, v44
 v_mfma_f32_16x16x32_bf16 v[56:59], a[240:243], v[84:87], v[56:59]
 v_add_f32 v15, v15, v45
 v_cvt_pk_bf16_f32 v38, v44, v45
 v_mfma_f32_16x16x32_bf16 v[52:55], a[244:247], v[80:83], v[52:55]
 ds_read_b128 a[240:243], v3 offset:61440
 v_add_f32 v15, v15, v46
 v_mfma_f32_16x16x32_bf16 v[60:63], a[244:247], v[84:87], v[60:63]
 v_add_f32 v15, v15, v47
 v_cvt_pk_bf16_f32 v39, v46, v47
 v_mfma_f32_16x16x32_bf16 v[48:51], a[248:251], v[88:91], v[48:51]
 ds_read_b128 a[244:247], v3 offset:63488
 v_accvgpr_write_b32 a160, v28
 v_mfma_f32_16x16x32_bf16 v[56:59], a[248:251], v[92:95], v[56:59]
 v_accvgpr_read_b32 v30, a178
 v_accvgpr_read_b32 v31, a179
 v_mfma_f32_16x16x32_bf16 v[52:55], a[252:255], v[88:91], v[52:55]
 ds_read_b128 a[248:251], v4 offset:61440
 s_waitcnt lgkmcnt(3)
 v_mul_f32 v30, s32, v30
 v_mfma_f32_16x16x32_bf16 v[60:63], a[252:255], v[92:95], v[60:63]
 v_mul_f32 v31, s32, v31
 v_cvt_pk_bf16_f32 v30, v30, v31
 v_mfma_f32_16x16x32_bf16 v[48:51], a[224:227], v[96:99], v[48:51]
 ds_read_b128 a[252:255], v4 offset:63488
 v_accvgpr_write_b32 a161, v30
 v_mfma_f32_16x16x32_bf16 v[56:59], a[224:227], v[100:103], v[56:59]
 v_accvgpr_read_b32 v28, a180
 v_accvgpr_read_b32 v29, a181
 v_mfma_f32_16x16x32_bf16 v[52:55], a[228:231], v[96:99], v[52:55]
 ds_read_b64_tr_b16 a[224:225], v5 offset:24576
 v_mul_f32 v28, s32, v28
 v_mfma_f32_16x16x32_bf16 v[60:63], a[228:231], v[100:103], v[60:63]
 ds_read_b64_tr_b16 a[226:227], v5 offset:26624
 v_mul_f32 v29, s32, v29
 v_mfma_f32_16x16x32_bf16 v[48:51], a[232:235], v[104:107], v[48:51]
 ds_read_b64_tr_b16 a[228:229], v6 offset:24576
 ds_read_b32 v10, v9
 v_cvt_pk_bf16_f32 v28, v28, v29
 v_mfma_f32_16x16x32_bf16 v[56:59], a[232:235], v[108:111], v[56:59]
 ds_read_b64_tr_b16 a[230:231], v6 offset:26624
 v_accvgpr_write_b32 a162, v28
 v_mfma_f32_16x16x32_bf16 v[52:55], a[236:239], v[104:107], v[52:55]
 ds_read_b64_tr_b16 a[232:233], v7 offset:24576
 s_waitcnt lgkmcnt(6)
 v_accvgpr_read_b32 v30, a182
 v_mfma_f32_16x16x32_bf16 v[60:63], a[236:239], v[108:111], v[60:63]
 ds_read_b64_tr_b16 a[234:235], v7 offset:26624
 v_accvgpr_read_b32 v31, a183
 v_mfma_f32_16x16x32_bf16 v[48:51], a[240:243], v[112:115], v[48:51]
 ds_read_b64_tr_b16 a[236:237], v8 offset:24576
 v_mul_f32 v30, s32, v30
 v_mfma_f32_16x16x32_bf16 v[56:59], a[240:243], v[116:119], v[56:59]
 ds_read_b64_tr_b16 a[238:239], v8 offset:26624
 v_mul_f32 v31, s32, v31
 v_mfma_f32_16x16x32_bf16 v[52:55], a[244:247], v[112:115], v[52:55]
 ds_read_b64_tr_b16 a[240:241], v5 offset:28672
 v_cvt_pk_bf16_f32 v30, v30, v31
 v_mfma_f32_16x16x32_bf16 v[60:63], a[244:247], v[116:119], v[60:63]
 ds_read_b64_tr_b16 a[242:243], v5 offset:30720
 s_movk_i32 s70, 464
 v_add_u32 v5, 0xffff0000, v5
 v_accvgpr_write_b32 a163, v30
 v_mfma_f32_16x16x32_bf16 v[48:51], a[248:251], v[120:123], v[48:51]
 ds_read_b64_tr_b16 a[244:245], v6 offset:28672
 v_accvgpr_read_b32 v28, a184
 v_mfma_f32_16x16x32_bf16 v[56:59], a[248:251], v[124:127], v[56:59]
 ds_read_b64_tr_b16 a[246:247], v6 offset:30720
 v_add_u32 v6, 0xffff0000, v6
 v_accvgpr_read_b32 v29, a185
 v_mfma_f32_16x16x32_bf16 v[52:55], a[252:255], v[120:123], v[52:55]
 ds_read_b64_tr_b16 a[248:249], v7 offset:28672
 s_waitcnt lgkmcnt(5)
 v_mul_f32 v28, s32, v28
 v_mfma_f32_16x16x32_bf16 v[60:63], a[252:255], v[124:127], v[60:63]
 ds_read_b64_tr_b16 a[250:251], v7 offset:30720
 buffer_load_dword off, s[72:75], s70 lds
 v_add_u32 v7, 0xffff0000, v7
 v_mul_f32 v29, s32, v29
 v_mfma_f32_16x16x32_bf16 v[128:131], a[224:227], v[32:35], v[128:131]
 ds_read_b64_tr_b16 a[252:253], v8 offset:28672
 v_cmp_le_u32 vcc, 126, v10
 v_cvt_pk_bf16_f32 v28, v28, v29
 v_mfma_f32_16x16x32_bf16 v[136:139], a[224:227], v[36:39], v[136:139]
 ds_read_b64_tr_b16 a[254:255], v8 offset:30720
 v_add_u32 v8, 0xffff0000, v8
 v_accvgpr_write_b32 a164, v28
 v_mfma_f32_16x16x32_bf16 v[132:135], a[228:231], v[32:35], v[132:135]
 s_cbranch_vccz L_cs936
L_cb936:
 ds_read_b64_tr_b16 a[224:225], v5 offset:49152
 v_max3_f32 v11, v48, v49, v50
 v_max3_f32 v12, v56, v57, v58
 v_max3_f32 v11, v11, v51, v52
 v_max3_f32 v12, v12, v59, v60
 v_max3_f32 v11, v11, v53, v54
 v_max3_f32 v12, v12, v61, v62
 v_max_f32 v11, v11, v55
 v_max_f32 v12, v12, v63
 v_max_f32 v13, v11, v12
 v_mfma_f32_16x16x32_bf16 v[140:143], a[228:231], v[36:39], v[140:143]
 ds_read_b64_tr_b16 a[226:227], v5 offset:51200
 v_accvgpr_read_b32 v30, a186
 v_mfma_f32_16x16x32_bf16 v[144:147], a[232:235], v[32:35], v[144:147]
 ds_read_b64_tr_b16 a[228:229], v6 offset:49152
 v_accvgpr_read_b32 v31, a187
 v_mfma_f32_16x16x32_bf16 v[152:155], a[232:235], v[36:39], v[152:155]
 ds_read_b64_tr_b16 a[230:231], v6 offset:51200
 v_mul_f32 v30, s32, v30
 v_mfma_f32_16x16x32_bf16 v[148:151], a[236:239], v[32:35], v[148:151]
 ds_read_b64_tr_b16 a[232:233], v7 offset:49152
 s_waitcnt lgkmcnt(5)
 v_mul_f32 v31, s32, v31
 v_mfma_f32_16x16x32_bf16 v[156:159], a[236:239], v[36:39], v[156:159]
 ds_read_b64_tr_b16 a[234:235], v7 offset:51200
 v_cvt_pk_bf16_f32 v30, v30, v31
 v_mfma_f32_16x16x32_bf16 v[160:163], a[240:243], v[32:35], v[160:163]
 ds_read_b64_tr_b16 a[236:237], v8 offset:49152
 v_accvgpr_write_b32 a165, v30
 v_mfma_f32_16x16x32_bf16 v[168:171], a[240:243], v[36:39], v[168:171]
 ds_read_b64_tr_b16 a[238:239], v8 offset:51200
 v_accvgpr_read_b32 v28, a188
 v_mfma_f32_16x16x32_bf16 v[164:167], a[244:247], v[32:35], v[164:167]
 ds_read_b64_tr_b16 a[240:241], v5 offset:53248
 v_accvgpr_read_b32 v29, a189
 v_mfma_f32_16x16x32_bf16 v[172:175], a[244:247], v[36:39], v[172:175]
 ds_read_b64_tr_b16 a[242:243], v5 offset:55296
 v_mul_f32 v28, s32, v28
 v_mfma_f32_16x16x32_bf16 v[176:179], a[248:251], v[32:35], v[176:179]
 ds_read_b64_tr_b16 a[244:245], v6 offset:53248
 v_mul_f32 v29, s32, v29
 v_mfma_f32_16x16x32_bf16 v[184:187], a[248:251], v[36:39], v[184:187]
 ds_read_b64_tr_b16 a[246:247], v6 offset:55296
 v_cmp_lt_f32 vcc, 0x41200000, v13
 v_cvt_pk_bf16_f32 v28, v28, v29
 v_mfma_f32_16x16x32_bf16 v[180:183], a[252:255], v[32:35], v[180:183]
 ds_read_b64_tr_b16 a[248:249], v7 offset:53248
 s_waitcnt lgkmcnt(5)
 s_cbranch_vccnz L_rs0_15
L_rb0_15:
 v_accvgpr_write_b32 a166, v28
 v_accvgpr_read_b32 v30, a190
 v_accvgpr_read_b32 v31, a191
 v_mul_f32 v30, s32, v30
 v_mul_f32 v31, s32, v31
 v_cvt_pk_bf16_f32 v30, v30, v31
 v_accvgpr_write_b32 a167, v30
 v_accvgpr_read_b32 v28, a192
 v_accvgpr_read_b32 v29, a193
 v_mul_f32 v28, s32, v28
 v_mul_f32 v29, s32, v29
 v_cvt_pk_bf16_f32 v28, v28, v29
 v_accvgpr_write_b32 a168, v28
 v_accvgpr_read_b32 v30, a194
 v_accvgpr_read_b32 v31, a195
 v_mul_f32 v30, s32, v30
 v_mul_f32 v31, s32, v31
 v_cvt_pk_bf16_f32 v30, v30, v31
 v_accvgpr_write_b32 a169, v30
 v_accvgpr_read_b32 v28, a196
 v_accvgpr_read_b32 v29, a197
 v_mul_f32 v28, s32, v28
 v_mul_f32 v29, s32, v29
 v_cvt_pk_bf16_f32 v28, v28, v29
 v_accvgpr_write_b32 a170, v28
 v_accvgpr_read_b32 v30, a198
 v_accvgpr_read_b32 v31, a199
 v_mul_f32 v30, s32, v30
 v_mul_f32 v31, s32, v31
 v_cvt_pk_bf16_f32 v30, v30, v31
 v_accvgpr_write_b32 a171, v30
 v_accvgpr_read_b32 v28, a200
 v_accvgpr_read_b32 v29, a201
 v_mul_f32 v28, s32, v28
 v_mul_f32 v29, s32, v29
 v_cvt_pk_bf16_f32 v28, v28, v29
 v_accvgpr_write_b32 a172, v28
 v_accvgpr_read_b32 v30, a202
 v_accvgpr_read_b32 v31, a203
 v_mul_f32 v30, s32, v30
 v_mul_f32 v31, s32, v31
 v_cvt_pk_bf16_f32 v30, v30, v31
 v_accvgpr_write_b32 a173, v30
 v_accvgpr_read_b32 v28, a204
 v_accvgpr_read_b32 v29, a205
 v_mul_f32 v28, s32, v28
 v_mul_f32 v29, s32, v29
 v_mfma_f32_16x16x32_bf16 v[188:191], a[252:255], v[36:39], v[188:191]
 ds_read_b64_tr_b16 a[250:251], v7 offset:55296
 v_cvt_pk_bf16_f32 v28, v28, v29
 v_mfma_f32_16x16x32_bf16 v[192:195], a[224:227], v[32:35], v[192:195]
 ds_read_b64_tr_b16 a[252:253], v8 offset:53248
 v_accvgpr_write_b32 a174, v28
 v_mfma_f32_16x16x32_bf16 v[200:203], a[224:227], v[36:39], v[200:203]
 ds_read_b64_tr_b16 a[254:255], v8 offset:55296
 v_accvgpr_read_b32 v30, a206
 v_mfma_f32_16x16x32_bf16 v[196:199], a[228:231], v[32:35], v[196:199]
 ds_read_b128 a[224:227], v3 offset:32768
 v_accvgpr_read_b32 v31, a207
 v_mfma_f32_16x16x32_bf16 v[204:207], a[228:231], v[36:39], v[204:207]
 v_exp_f32 v48, v48
 v_mfma_f32_16x16x32_bf16 v[208:211], a[232:235], v[32:35], v[208:211]
 ds_read_b128 a[228:231], v3 offset:34816
 ds_read_b32 v10, v9
 v_mul_f32 v30, s32, v30
 v_mfma_f32_16x16x32_bf16 v[216:219], a[232:235], v[36:39], v[216:219]
 v_exp_f32 v49, v49
 v_mfma_f32_16x16x32_bf16 v[212:215], a[236:239], v[32:35], v[212:215]
 ds_read_b128 a[232:235], v4 offset:32768
 s_waitcnt lgkmcnt(4)
 v_mul_f32 v31, s32, v31
 v_mfma_f32_16x16x32_bf16 v[220:223], a[236:239], v[36:39], v[220:223]
 v_exp_f32 v50, v50
 v_mfma_f32_16x16x32_bf16 v[224:227], a[240:243], v[32:35], v[224:227]
 ds_read_b128 a[236:239], v4 offset:34816
 v_cvt_pk_bf16_f32 v30, v30, v31
 v_mfma_f32_16x16x32_bf16 v[232:235], a[240:243], v[36:39], v[232:235]
 v_exp_f32 v51, v51
 v_mfma_f32_16x16x32_bf16 v[228:231], a[244:247], v[32:35], v[228:231]
 ds_read_b128 a[240:243], v3 offset:36864
 v_add_u32 v5, 0x10000, v5
 v_accvgpr_write_b32 a175, v30
 v_mfma_f32_16x16x32_bf16 v[236:239], a[244:247], v[36:39], v[236:239]
 s_movk_i32 s70, 472
 v_exp_f32 v52, v52
 v_mfma_f32_16x16x32_bf16 v[240:243], a[248:251], v[32:35], v[240:243]
 ds_read_b128 a[244:247], v3 offset:38912
 v_add_u32 v6, 0x10000, v6
 v_exp_f32 v53, v53
 v_mfma_f32_16x16x32_bf16 v[248:251], a[248:251], v[36:39], v[248:251]
 v_exp_f32 v54, v54
 v_mfma_f32_16x16x32_bf16 v[244:247], a[252:255], v[32:35], v[244:247]
 ds_read_b128 a[248:251], v4 offset:36864
 s_waitcnt lgkmcnt(3)
 v_add_u32 v7, 0x10000, v7
 v_mfma_f32_16x16x32_bf16 v[252:255], a[252:255], v[36:39], v[252:255]
 buffer_load_dword off, s[72:75], s70 lds
 v_exp_f32 v55, v55
 v_mfma_f32_16x16x32_bf16 v[32:35], a[224:227], a[112:115], 0
 ds_read_b128 a[252:255], v4 offset:38912
 v_cmp_le_u32 vcc, 128, v10
 v_add_u32 v8, 0x10000, v8
 v_exp_f32 v56, v56
 v_mfma_f32_16x16x32_bf16 v[40:43], a[224:227], a[116:119], 0
 v_exp_f32 v57, v57
 v_mfma_f32_16x16x32_bf16 v[36:39], a[228:231], a[112:115], 0
 s_cbranch_vccz L_cs952
L_cb952:
 ds_read_b128 a[224:227], v3 offset:8192
 v_mfma_f32_16x16x32_bf16 v[44:47], a[228:231], a[116:119], 0
 v_exp_f32 v58, v58
 v_mfma_f32_16x16x32_bf16 v[32:35], a[232:235], a[120:123], v[32:35]
 ds_read_b128 a[228:231], v3 offset:10240
 v_add_f32 v14, v14, v48
 v_mfma_f32_16x16x32_bf16 v[40:43], a[232:235], a[124:127], v[40:43]
 v_exp_f32 v59, v59
 v_mfma_f32_16x16x32_bf16 v[36:39], a[236:239], a[120:123], v[36:39]
 ds_read_b128 a[232:235], v4 offset:8192
 s_waitcnt lgkmcnt(3)
 v_mfma_f32_16x16x32_bf16 v[44:47], a[236:239], a[124:127], v[44:47]
 v_exp_f32 v60, v60
 v_mfma_f32_16x16x32_bf16 v[32:35], a[240:243], a[128:131], v[32:35]
 ds_read_b128 a[236:239], v4 offset:10240
 v_add_f32 v14, v14, v49
 v_mfma_f32_16x16x32_bf16 v[40:43], a[240:243], a[132:135], v[40:43]
 v_exp_f32 v61, v61
 v_mfma_f32_16x16x32_bf16 v[36:39], a[244:247], a[128:131], v[36:39]
 ds_read_b128 a[240:243], v3 offset:12288
 v_cvt_pk_bf16_f32 v48, v48, v49
 v_mfma_f32_16x16x32_bf16 v[44:47], a[244:247], a[132:135], v[44:47]
 v_exp_f32 v62, v62
 v_mfma_f32_16x16x32_bf16 v[32:35], a[248:251], a[136:139], v[32:35]
 ds_read_b128 a[244:247], v3 offset:14336
 v_add_f32 v14, v14, v50
 v_mfma_f32_16x16x32_bf16 v[40:43], a[248:251], a[140:143], v[40:43]
 v_exp_f32 v63, v63
 v_mfma_f32_16x16x32_bf16 v[36:39], a[252:255], a[136:139], v[36:39]
 ds_read_b128 a[248:251], v4 offset:12288
 s_waitcnt lgkmcnt(3)
 v_add_f32 v14, v14, v51
 v_mfma_f32_16x16x32_bf16 v[44:47], a[252:255], a[140:143], v[44:47]
 v_cvt_pk_bf16_f32 v49, v50, v51
 v_add_f32 v14, v14, v52
 v_mfma_f32_16x16x32_bf16 v[32:35], a[224:227], a[144:147], v[32:35]
 ds_read_b128 a[252:255], v4 offset:14336
 v_add_f32 v14, v14, v53
 v_cvt_pk_bf16_f32 v50, v52, v53
 v_add_f32 v14, v14, v54
 v_add_f32 v14, v14, v55
 v_cvt_pk_bf16_f32 v51, v54, v55
 v_add_f32 v15, v15, v56
 v_add_f32 v15, v15, v57
 v_cvt_pk_bf16_f32 v52, v56, v57
 v_add_f32 v15, v15, v58
 v_add_f32 v15, v15, v59
 v_cvt_pk_bf16_f32 v53, v58, v59
 v_add_f32 v15, v15, v60
 v_mfma_f32_16x16x32_bf16 v[40:43], a[224:227], a[148:151], v[40:43]
 v_add_f32 v15, v15, v61
 v_cvt_pk_bf16_f32 v54, v60, v61
 v_mfma_f32_16x16x32_bf16 v[36:39], a[228:231], a[144:147], v[36:39]
 ds_read_b64_tr_b16 a[224:225], v5 offset:40960
 v_add_f32 v15, v15, v62
 v_mfma_f32_16x16x32_bf16 v[44:47], a[228:231], a[148:151], v[44:47]
 ds_read_b64_tr_b16 a[226:227], v5 offset:43008
 v_add_f32 v15, v15, v63
 v_mfma_f32_16x16x32_bf16 v[32:35], a[232:235], a[152:155], v[32:35]
 ds_read_b64_tr_b16 a[228:229], v6 offset:40960
 ds_read_b32 v10, v9
 v_cvt_pk_bf16_f32 v55, v62, v63
 v_mfma_f32_16x16x32_bf16 v[40:43], a[232:235], a[156:159], v[40:43]
 ds_read_b64_tr_b16 a[230:231], v6 offset:43008
 v_mov_b32 v1, v14
 v_mfma_f32_16x16x32_bf16 v[36:39], a[236:239], a[152:155], v[36:39]
 ds_read_b64_tr_b16 a[232:233], v7 offset:40960
 s_waitcnt lgkmcnt(6)
 v_mov_b32 v2, v15
 v_mfma_f32_16x16x32_bf16 v[44:47], a[236:239], a[156:159], v[44:47]
 ds_read_b64_tr_b16 a[234:235], v7 offset:43008
 v_and_b32 v24, 0xffff, v5
 v_permlane32_swap_b32 v1, v14
 v_mfma_f32_16x16x32_bf16 v[32:35], a[240:243], a[160:163], v[32:35]
 ds_read_b64_tr_b16 a[236:237], v8 offset:40960
 v_and_b32 v25, 0xffff, v6
 v_mfma_f32_16x16x32_bf16 v[40:43], a[240:243], a[164:167], v[40:43]
 ds_read_b64_tr_b16 a[238:239], v8 offset:43008
 v_and_b32 v26, 0xffff, v7
 v_permlane32_swap_b32 v2, v15
 v_mfma_f32_16x16x32_bf16 v[36:39], a[244:247], a[160:163], v[36:39]
 ds_read_b64_tr_b16 a[240:241], v5 offset:45056
 v_add_f32 v14, v1, v14
 v_mfma_f32_16x16x32_bf16 v[44:47], a[244:247], a[164:167], v[44:47]
 ds_read_b64_tr_b16 a[242:243], v5 offset:47104
 s_movk_i32 s70, 480
 v_mfma_f32_16x16x32_bf16 v[32:35], a[248:251], a[168:171], v[32:35]
 ds_read_b64_tr_b16 a[244:245], v6 offset:45056
 v_add_f32 v15, v2, v15
 v_mfma_f32_16x16x32_bf16 v[40:43], a[248:251], a[172:175], v[40:43]
 ds_read_b64_tr_b16 a[246:247], v6 offset:47104
 v_mov_b32 v1, v14
 v_mfma_f32_16x16x32_bf16 v[36:39], a[252:255], a[168:171], v[36:39]
 ds_read_b64_tr_b16 a[248:249], v7 offset:45056
 s_waitcnt lgkmcnt(5)
 v_mov_b32 v2, v15
 v_mfma_f32_16x16x32_bf16 v[44:47], a[252:255], a[172:175], v[44:47]
 ds_read_b64_tr_b16 a[250:251], v7 offset:47104
 buffer_load_dword off, s[72:75], s70 lds
 v_add_u32 v3, 0x10000, v3
 v_permlane16_swap_b32 v1, v14
 v_mfma_f32_16x16x32_bf16 v[128:131], a[224:227], v[48:51], v[128:131]
 ds_read_b64_tr_b16 a[252:253], v8 offset:45056
 v_cmp_le_u32 vcc, 130, v10
 v_mfma_f32_16x16x32_bf16 v[136:139], a[224:227], v[52:55], v[136:139]
 ds_read_b64_tr_b16 a[254:255], v8 offset:47104
 v_add_u32 v4, 0x10000, v4
 v_permlane16_swap_b32 v2, v15
 v_mfma_f32_16x16x32_bf16 v[132:135], a[228:231], v[48:51], v[132:135]
 s_cbranch_vccz L_cs968
L_cb968:
 ds_read_b64_tr_b16 a[224:225], v5 offset:49152
 v_add_f32 v14, v1, v14
 v_add_f32 v15, v2, v15
 v_rcp_f32 v1, v14
 v_rcp_f32 v2, v15
 v_max3_f32 v11, v32, v33, v34
 v_max3_f32 v12, v40, v41, v42
 v_max3_f32 v11, v11, v35, v36
 v_max3_f32 v12, v12, v43, v44
 v_max3_f32 v11, v11, v37, v38
 v_max3_f32 v12, v12, v45, v46
 v_max_f32 v11, v11, v39
 v_max_f32 v12, v12, v47
 v_mov_b32 v16, v11
 v_mov_b32 v17, v12
  s_nop 0
 v_permlane32_swap_b32 v16, v11
 v_permlane32_swap_b32 v17, v12
 v_max_f32 v11, v16, v11
 v_max_f32 v12, v17, v12
 v_mov_b32 v16, v11
 v_mov_b32 v17, v12
  s_nop 0
 v_permlane16_swap_b32 v16, v11
 v_permlane16_swap_b32 v17, v12
 v_max_f32 v11, v16, v11
 v_max_f32 v12, v17, v12
 v_ceil_f32 v11, v11
 v_ceil_f32 v12, v12
 v_sub_f32 v16, 0, v11
 v_sub_f32 v17, 0, v11
 v_sub_f32 v18, 0, v11
 v_sub_f32 v19, 0, v11
 v_sub_f32 v20, 0, v12
 v_sub_f32 v21, 0, v12
 v_mfma_f32_16x16x32_bf16 v[140:143], a[228:231], v[52:55], v[140:143]
 ds_read_b64_tr_b16 a[226:227], v5 offset:51200
 v_sub_f32 v22, 0, v12
 v_mfma_f32_16x16x32_bf16 v[144:147], a[232:235], v[48:51], v[144:147]
 ds_read_b64_tr_b16 a[228:229], v6 offset:49152
 v_sub_f32 v23, 0, v12
 v_mfma_f32_16x16x32_bf16 v[152:155], a[232:235], v[52:55], v[152:155]
 ds_read_b64_tr_b16 a[230:231], v6 offset:51200
 v_sub_f32 v32, v32, v11
 v_mfma_f32_16x16x32_bf16 v[148:151], a[236:239], v[48:51], v[148:151]
 ds_read_b64_tr_b16 a[232:233], v7 offset:49152
 s_waitcnt lgkmcnt(5)
 v_sub_f32 v33, v33, v11
 v_sub_f32 v34, v34, v11
 v_sub_f32 v35, v35, v11
 v_sub_f32 v36, v36, v11
 v_sub_f32 v37, v37, v11
 v_sub_f32 v38, v38, v11
 v_sub_f32 v39, v39, v11
 v_sub_f32 v40, v40, v12
 v_sub_f32 v41, v41, v12
 v_sub_f32 v42, v42, v12
 v_sub_f32 v43, v43, v12
 v_sub_f32 v44, v44, v12
 v_sub_f32 v45, v45, v12
 v_sub_f32 v46, v46, v12
 v_sub_f32 v47, v47, v12
 v_mov_b32 v14, 0
 v_mov_b32 v15, 0
 v_exp_f32 v32, v32
 v_exp_f32 v33, v33
 v_exp_f32 v34, v34
 v_exp_f32 v35, v35
 v_mfma_f32_16x16x32_bf16 v[156:159], a[236:239], v[52:55], v[156:159]
 ds_read_b64_tr_b16 a[234:235], v7 offset:51200
 v_add_f32 v14, v14, v32
 v_mfma_f32_16x16x32_bf16 v[160:163], a[240:243], v[48:51], v[160:163]
 ds_read_b64_tr_b16 a[236:237], v8 offset:49152
 v_add_f32 v14, v14, v33
 v_mfma_f32_16x16x32_bf16 v[168:171], a[240:243], v[52:55], v[168:171]
 ds_read_b64_tr_b16 a[238:239], v8 offset:51200
 v_cvt_pk_bf16_f32 v32, v32, v33
 v_mfma_f32_16x16x32_bf16 v[164:167], a[244:247], v[48:51], v[164:167]
 ds_read_b64_tr_b16 a[240:241], v5 offset:53248
 v_add_f32 v14, v14, v34
 v_exp_f32 v36, v36
 v_exp_f32 v37, v37
 v_exp_f32 v38, v38
 v_exp_f32 v39, v39
 v_exp_f32 v40, v40
 v_exp_f32 v41, v41
 v_exp_f32 v42, v42
 v_exp_f32 v43, v43
 v_exp_f32 v44, v44
 v_exp_f32 v45, v45
 v_exp_f32 v46, v46
 v_mfma_f32_16x16x32_bf16 v[172:175], a[244:247], v[52:55], v[172:175]
 ds_read_b64_tr_b16 a[242:243], v5 offset:55296
 v_add_f32 v14, v14, v35
 v_mfma_f32_16x16x32_bf16 v[176:179], a[248:251], v[48:51], v[176:179]
 ds_read_b64_tr_b16 a[244:245], v6 offset:53248
 v_cvt_pk_bf16_f32 v33, v34, v35
 v_mfma_f32_16x16x32_bf16 v[184:187], a[248:251], v[52:55], v[184:187]
 ds_read_b64_tr_b16 a[246:247], v6 offset:55296
 v_add_f32 v14, v14, v36
 v_mfma_f32_16x16x32_bf16 v[180:183], a[252:255], v[48:51], v[180:183]
 ds_read_b64_tr_b16 a[248:249], v7 offset:53248
 s_waitcnt lgkmcnt(5)
 v_exp_f32 v47, v47
 v_add_f32 v14, v14, v37
 v_cvt_pk_bf16_f32 v34, v36, v37
 v_add_f32 v14, v14, v38
 v_add_f32 v14, v14, v39
 v_cvt_pk_bf16_f32 v35, v38, v39
 v_add_f32 v15, v15, v40
 v_add_f32 v15, v15, v41
 v_cvt_pk_bf16_f32 v36, v40, v41
 v_add_f32 v15, v15, v42
 v_add_f32 v15, v15, v43
 v_cvt_pk_bf16_f32 v37, v42, v43
 v_add_f32 v15, v15, v44
 v_add_f32 v15, v15, v45
 v_cvt_pk_bf16_f32 v38, v44, v45
 v_add_f32 v15, v15, v46
 v_mul_f32 v128, v128, v1
 v_mul_f32 v129, v129, v1
 v_cvt_pk_bf16_f32 v64, v128, v129
 v_mfma_f32_16x16x32_bf16 v[188:191], a[252:255], v[52:55], v[188:191]
 ds_read_b64_tr_b16 a[250:251], v7 offset:55296
 v_add_f32 v15, v15, v47
 v_mfma_f32_16x16x32_bf16 v[192:195], a[224:227], v[48:51], v[192:195]
 ds_read_b64_tr_b16 a[252:253], v8 offset:53248
 v_cvt_pk_bf16_f32 v39, v46, v47
 v_mfma_f32_16x16x32_bf16 v[200:203], a[224:227], v[52:55], v[200:203]
 ds_read_b64_tr_b16 a[254:255], v8 offset:55296
 v_mul_f32 v130, v130, v1
 v_mfma_f32_16x16x32_bf16 v[196:199], a[228:231], v[48:51], v[196:199]
 ds_read_b128 a[224:227], v3 offset:0
 v_mul_f32 v131, v131, v1
 v_cvt_pk_bf16_f32 v65, v130, v131
 v_mul_f32 v132, v132, v1
 v_mul_f32 v133, v133, v1
 v_cvt_pk_bf16_f32 v66, v132, v133
 v_mul_f32 v134, v134, v1
 v_mul_f32 v135, v135, v1
 v_cvt_pk_bf16_f32 v67, v134, v135
 v_mul_f32 v136, v136, v2
 v_mul_f32 v137, v137, v2
 v_cvt_pk_bf16_f32 v68, v136, v137
 v_mul_f32 v138, v138, v2
 v_mul_f32 v139, v139, v2
 v_cvt_pk_bf16_f32 v69, v138, v139
 v_mul_f32 v140, v140, v2
 v_mul_f32 v141, v141, v2
 v_cvt_pk_bf16_f32 v70, v140, v141
 v_mul_f32 v142, v142, v2
 v_mul_f32 v143, v143, v2
 v_cvt_pk_bf16_f32 v71, v142, v143
 v_mul_f32 v144, v144, v1
 v_mfma_f32_16x16x32_bf16 v[204:207], a[228:231], v[52:55], v[204:207]
 v_mul_f32 v145, v145, v1
 v_cvt_pk_bf16_f32 v72, v144, v145
 v_mfma_f32_16x16x32_bf16 v[208:211], a[232:235], v[48:51], v[208:211]
 ds_read_b128 a[228:231], v3 offset:2048
 ds_read_b32 v10, v9
 v_mul_f32 v146, v146, v1
 v_mfma_f32_16x16x32_bf16 v[216:219], a[232:235], v[52:55], v[216:219]
 v_mul_f32 v147, v147, v1
 v_cvt_pk_bf16_f32 v73, v146, v147
 v_mfma_f32_16x16x32_bf16 v[212:215], a[236:239], v[48:51], v[212:215]
 ds_read_b128 a[232:235], v4 offset:0
 s_waitcnt lgkmcnt(4)
 v_mul_f32 v148, v148, v1
 v_mul_f32 v149, v149, v1
 v_cvt_pk_bf16_f32 v74, v148, v149
 v_mul_f32 v150, v150, v1
 v_mul_f32 v151, v151, v1
 v_cvt_pk_bf16_f32 v75, v150, v151
 v_mul_f32 v152, v152, v2
 v_mul_f32 v153, v153, v2
 v_cvt_pk_bf16_f32 v76, v152, v153
 v_mul_f32 v154, v154, v2
 v_mul_f32 v155, v155, v2
 v_cvt_pk_bf16_f32 v77, v154, v155
 v_mul_f32 v156, v156, v2
 v_mul_f32 v157, v157, v2
 v_cvt_pk_bf16_f32 v78, v156, v157
 v_mul_f32 v158, v158, v2
 v_mul_f32 v159, v159, v2
 v_cvt_pk_bf16_f32 v79, v158, v159
 v_mul_f32 v160, v160, v1
 v_mul_f32 v161, v161, v1
 v_cvt_pk_bf16_f32 v80, v160, v161
 v_mul_f32 v162, v162, v1
 v_mul_f32 v163, v163, v1
 v_mfma_f32_16x16x32_bf16 v[220:223], a[236:239], v[52:55], v[220:223]
 v_cvt_pk_bf16_f32 v81, v162, v163
 v_mul_f32 v164, v164, v1
 v_mfma_f32_16x16x32_bf16 v[224:227], a[240:243], v[48:51], v[224:227]
 ds_read_b128 a[236:239], v4 offset:2048
 v_mul_f32 v165, v165, v1
 v_mfma_f32_16x16x32_bf16 v[232:235], a[240:243], v[52:55], v[232:235]
 v_cvt_pk_bf16_f32 v82, v164, v165
 v_mul_f32 v166, v166, v1
 v_mfma_f32_16x16x32_bf16 v[228:231], a[244:247], v[48:51], v[228:231]
 ds_read_b128 a[240:243], v3 offset:4096
 v_add_u32 v5, 0x10000, v5
 v_mul_f32 v167, v167, v1
 v_cvt_pk_bf16_f32 v83, v166, v167
 v_mul_f32 v168, v168, v2
 v_mul_f32 v169, v169, v2
 v_cvt_pk_bf16_f32 v84, v168, v169
 v_mul_f32 v170, v170, v2
 v_mul_f32 v171, v171, v2
 v_cvt_pk_bf16_f32 v85, v170, v171
 v_mul_f32 v172, v172, v2
 v_mul_f32 v173, v173, v2
 v_cvt_pk_bf16_f32 v86, v172, v173
 v_mul_f32 v174, v174, v2
 v_mul_f32 v175, v175, v2
 v_cvt_pk_bf16_f32 v87, v174, v175
 v_mul_f32 v176, v176, v1
 v_mul_f32 v177, v177, v1
 v_cvt_pk_bf16_f32 v88, v176, v177
 v_mul_f32 v178, v178, v1
 v_mul_f32 v179, v179, v1
 v_cvt_pk_bf16_f32 v89, v178, v179
 v_mul_f32 v180, v180, v1
 v_mul_f32 v181, v181, v1
 v_cvt_pk_bf16_f32 v90, v180, v181
 v_mul_f32 v182, v182, v1
 v_mul_f32 v183, v183, v1
 v_mfma_f32_16x16x32_bf16 v[236:239], a[244:247], v[52:55], v[236:239]
 s_movk_i32 s70, 488
 v_cvt_pk_bf16_f32 v91, v182, v183
 v_mul_f32 v184, v184, v2
 v_mfma_f32_16x16x32_bf16 v[240:243], a[248:251], v[48:51], v[240:243]
 ds_read_b128 a[244:247], v3 offset:6144
 v_add_u32 v3, 0xfffe0000, v3
 v_add_u32 v6, 0x10000, v6
 v_mul_f32 v185, v185, v2
 v_mfma_f32_16x16x32_bf16 v[248:251], a[248:251], v[52:55], v[248:251]
 v_cvt_pk_bf16_f32 v92, v184, v185
 v_mul_f32 v186, v186, v2
 v_mfma_f32_16x16x32_bf16 v[244:247], a[252:255], v[48:51], v[244:247]
 ds_read_b128 a[248:251], v4 offset:4096
 s_waitcnt lgkmcnt(3)
 v_add_u32 v7, 0x10000, v7
 v_mul_f32 v187, v187, v2
 v_cvt_pk_bf16_f32 v93, v186, v187
 v_mul_f32 v188, v188, v2
 v_mul_f32 v189, v189, v2
 v_cvt_pk_bf16_f32 v94, v188, v189
 v_mul_f32 v190, v190, v2
 v_mul_f32 v191, v191, v2
 v_cvt_pk_bf16_f32 v95, v190, v191
 v_mul_f32 v192, v192, v1
 v_mul_f32 v193, v193, v1
 v_cvt_pk_bf16_f32 v96, v192, v193
 v_mul_f32 v194, v194, v1
 v_mul_f32 v195, v195, v1
 v_cvt_pk_bf16_f32 v97, v194, v195
 v_mul_f32 v196, v196, v1
 v_mul_f32 v197, v197, v1
 v_cvt_pk_bf16_f32 v98, v196, v197
 v_mul_f32 v198, v198, v1
 v_mul_f32 v199, v199, v1
 v_cvt_pk_bf16_f32 v99, v198, v199
 v_mul_f32 v200, v200, v2
 v_mul_f32 v201, v201, v2
 v_cvt_pk_bf16_f32 v100, v200, v201
 v_mul_f32 v202, v202, v2
 v_mul_f32 v203, v203, v2
 v_mfma_f32_16x16x32_bf16 v[252:255], a[252:255], v[52:55], v[252:255]
 buffer_load_dword off, s[72:75], s70 lds
 v_cvt_pk_bf16_f32 v101, v202, v203
 v_mul_f32 v204, v204, v2
 v_mfma_f32_16x16x32_bf16 v[48:51], a[224:227], a[112:115], v[16:19]
 ds_read_b128 a[252:255], v4 offset:6144
 v_cmp_le_u32 vcc, 132, v10
 v_add_u32 v4, 0xfffe0000, v4
 v_add_u32 v8, 0x10000, v8
 v_mul_f32 v205, v205, v2
 v_mfma_f32_16x16x32_bf16 v[56:59], a[224:227], a[116:119], v[20:23]
 v_cvt_pk_bf16_f32 v102, v204, v205
 v_mul_f32 v206, v206, v2
 v_mfma_f32_16x16x32_bf16 v[52:55], a[228:231], a[112:115], v[16:19]
 s_cbranch_vccz L_cs984
L_cb984:
 ds_read_b128 a[224:227], v3 offset:57344
 v_mul_f32 v207, v207, v2
 v_cvt_pk_bf16_f32 v103, v206, v207
 v_mul_f32 v208, v208, v1
 v_mul_f32 v209, v209, v1
 v_cvt_pk_bf16_f32 v104, v208, v209
 v_mul_f32 v210, v210, v1
 v_mul_f32 v211, v211, v1
 v_cvt_pk_bf16_f32 v105, v210, v211
 v_mul_f32 v212, v212, v1
 v_mul_f32 v213, v213, v1
 v_cvt_pk_bf16_f32 v106, v212, v213
 v_mul_f32 v214, v214, v1
 v_mul_f32 v215, v215, v1
 v_cvt_pk_bf16_f32 v107, v214, v215
 v_mul_f32 v216, v216, v2
 v_mul_f32 v217, v217, v2
 v_cvt_pk_bf16_f32 v108, v216, v217
 v_mul_f32 v218, v218, v2
 v_mul_f32 v219, v219, v2
 v_cvt_pk_bf16_f32 v109, v218, v219
 v_mul_f32 v220, v220, v2
 v_mul_f32 v221, v221, v2
 v_cvt_pk_bf16_f32 v110, v220, v221
 v_mul_f32 v222, v222, v2
 v_mfma_f32_16x16x32_bf16 v[60:63], a[228:231], a[116:119], v[20:23]
 v_mul_f32 v223, v223, v2
 v_cvt_pk_bf16_f32 v111, v222, v223
 v_mfma_f32_16x16x32_bf16 v[48:51], a[232:235], a[120:123], v[48:51]
 ds_read_b128 a[228:231], v3 offset:59392
 v_mul_f32 v224, v224, v1
 v_mfma_f32_16x16x32_bf16 v[56:59], a[232:235], a[124:127], v[56:59]
 v_mul_f32 v225, v225, v1
 v_cvt_pk_bf16_f32 v112, v224, v225
 v_mfma_f32_16x16x32_bf16 v[52:55], a[236:239], a[120:123], v[52:55]
 ds_read_b128 a[232:235], v4 offset:57344
 s_waitcnt lgkmcnt(3)
 v_mul_f32 v226, v226, v1
 v_mfma_f32_16x16x32_bf16 v[60:63], a[236:239], a[124:127], v[60:63]
 v_mul_f32 v227, v227, v1
 v_cvt_pk_bf16_f32 v113, v226, v227
 v_mfma_f32_16x16x32_bf16 v[48:51], a[240:243], a[128:131], v[48:51]
 ds_read_b128 a[236:239], v4 offset:59392
 v_mul_f32 v228, v228, v1
 v_mfma_f32_16x16x32_bf16 v[56:59], a[240:243], a[132:135], v[56:59]
 v_mul_f32 v229, v229, v1
 v_cvt_pk_bf16_f32 v114, v228, v229
 v_mfma_f32_16x16x32_bf16 v[52:55], a[244:247], a[128:131], v[52:55]
 ds_read_b128 a[240:243], v3 offset:61440
 v_mul_f32 v230, v230, v1
 v_mfma_f32_16x16x32_bf16 v[60:63], a[244:247], a[132:135], v[60:63]
 v_mul_f32 v231, v231, v1
 v_cvt_pk_bf16_f32 v115, v230, v231
 v_mfma_f32_16x16x32_bf16 v[48:51], a[248:251], a[136:139], v[48:51]
 ds_read_b128 a[244:247], v3 offset:63488
 v_mul_f32 v232, v232, v2
 v_mfma_f32_16x16x32_bf16 v[56:59], a[248:251], a[140:143], v[56:59]
 v_mul_f32 v233, v233, v2
 v_cvt_pk_bf16_f32 v116, v232, v233
 v_mfma_f32_16x16x32_bf16 v[52:55], a[252:255], a[136:139], v[52:55]
 ds_read_b128 a[248:251], v4 offset:61440
 s_waitcnt lgkmcnt(3)
 v_mul_f32 v234, v234, v2
 v_mfma_f32_16x16x32_bf16 v[60:63], a[252:255], a[140:143], v[60:63]
 v_mul_f32 v235, v235, v2
 v_cvt_pk_bf16_f32 v117, v234, v235
 v_mfma_f32_16x16x32_bf16 v[48:51], a[224:227], a[144:147], v[48:51]
 ds_read_b128 a[252:255], v4 offset:63488
 v_mul_f32 v236, v236, v2
 v_mfma_f32_16x16x32_bf16 v[56:59], a[224:227], a[148:151], v[56:59]
 v_mul_f32 v237, v237, v2
 v_cvt_pk_bf16_f32 v118, v236, v237
 v_mfma_f32_16x16x32_bf16 v[52:55], a[228:231], a[144:147], v[52:55]
 ds_read_b64_tr_b16 a[224:225], v5 offset:8192
 v_mul_f32 v238, v238, v2
 v_mfma_f32_16x16x32_bf16 v[60:63], a[228:231], a[148:151], v[60:63]
 ds_read_b64_tr_b16 a[226:227], v5 offset:10240
 v_mul_f32 v239, v239, v2
 v_mfma_f32_16x16x32_bf16 v[48:51], a[232:235], a[152:155], v[48:51]
 ds_read_b64_tr_b16 a[228:229], v6 offset:8192
 ds_read_b32 v10, v9
 v_cvt_pk_bf16_f32 v119, v238, v239
 v_mfma_f32_16x16x32_bf16 v[56:59], a[232:235], a[156:159], v[56:59]
 ds_read_b64_tr_b16 a[230:231], v6 offset:10240
 v_mul_f32 v240, v240, v1
 v_mfma_f32_16x16x32_bf16 v[52:55], a[236:239], a[152:155], v[52:55]
 ds_read_b64_tr_b16 a[232:233], v7 offset:8192
 s_waitcnt lgkmcnt(6)
 v_mul_f32 v241, v241, v1
 v_mfma_f32_16x16x32_bf16 v[60:63], a[236:239], a[156:159], v[60:63]
 ds_read_b64_tr_b16 a[234:235], v7 offset:10240
 v_cvt_pk_bf16_f32 v120, v240, v241
 v_mfma_f32_16x16x32_bf16 v[48:51], a[240:243], a[160:163], v[48:51]
 ds_read_b64_tr_b16 a[236:237], v8 offset:8192
 v_mul_f32 v242, v242, v1
 v_mfma_f32_16x16x32_bf16 v[56:59], a[240:243], a[164:167], v[56:59]
 ds_read_b64_tr_b16 a[238:239], v8 offset:10240
 v_mul_f32 v243, v243, v1
 v_mfma_f32_16x16x32_bf16 v[52:55], a[244:247], a[160:163], v[52:55]
 ds_read_b64_tr_b16 a[240:241], v5 offset:12288
 v_cvt_pk_bf16_f32 v121, v242, v243
 v_mfma_f32_16x16x32_bf16 v[60:63], a[244:247], a[164:167], v[60:63]
 ds_read_b64_tr_b16 a[242:243], v5 offset:14336
 s_movk_i32 s70, 496
 v_mul_f32 v244, v244, v1
 v_mfma_f32_16x16x32_bf16 v[48:51], a[248:251], a[168:171], v[48:51]
 ds_read_b64_tr_b16 a[244:245], v6 offset:12288
 v_mul_f32 v245, v245, v1
 v_mfma_f32_16x16x32_bf16 v[56:59], a[248:251], a[172:175], v[56:59]
 ds_read_b64_tr_b16 a[246:247], v6 offset:14336
 v_cvt_pk_bf16_f32 v122, v244, v245
 v_mfma_f32_16x16x32_bf16 v[52:55], a[252:255], a[168:171], v[52:55]
 ds_read_b64_tr_b16 a[248:249], v7 offset:12288
 s_waitcnt lgkmcnt(5)
 v_mul_f32 v246, v246, v1
 v_mfma_f32_16x16x32_bf16 v[60:63], a[252:255], a[172:175], v[60:63]
 ds_read_b64_tr_b16 a[250:251], v7 offset:14336
 buffer_load_dword off, s[72:75], s70 lds
 v_mul_f32 v247, v247, v1
 v_mfma_f32_16x16x32_bf16 v[128:131], a[224:227], v[32:35], 0
 ds_read_b64_tr_b16 a[252:253], v8 offset:12288
 v_cmp_le_u32 vcc, 133, v10
 v_cvt_pk_bf16_f32 v123, v246, v247
 v_mfma_f32_16x16x32_bf16 v[136:139], a[224:227], v[36:39], 0
 ds_read_b64_tr_b16 a[254:255], v8 offset:14336
 v_mul_f32 v248, v248, v2
 v_mfma_f32_16x16x32_bf16 v[132:135], a[228:231], v[32:35], 0
 s_cbranch_vccz L_cs1000
L_cb1000:
 ds_read_b64_tr_b16 a[224:225], v5 offset:16384
 v_max3_f32 v11, v48, v49, v50
 v_max3_f32 v12, v56, v57, v58
 v_max3_f32 v11, v11, v51, v52
 v_max3_f32 v12, v12, v59, v60
 v_max3_f32 v11, v11, v53, v54
 v_max3_f32 v12, v12, v61, v62
 v_max_f32 v11, v11, v55
 v_max_f32 v12, v12, v63
 v_max_f32 v13, v11, v12
 v_mfma_f32_16x16x32_bf16 v[140:143], a[228:231], v[36:39], 0
 ds_read_b64_tr_b16 a[226:227], v5 offset:18432
 v_mul_f32 v249, v249, v2
 v_mfma_f32_16x16x32_bf16 v[144:147], a[232:235], v[32:35], 0
 ds_read_b64_tr_b16 a[228:229], v6 offset:16384
 ds_read_b32 v10, v9
 v_cvt_pk_bf16_f32 v124, v248, v249
 v_mfma_f32_16x16x32_bf16 v[152:155], a[232:235], v[36:39], 0
 ds_read_b64_tr_b16 a[230:231], v6 offset:18432
 v_mul_f32 v250, v250, v2
 v_mfma_f32_16x16x32_bf16 v[148:151], a[236:239], v[32:35], 0
 ds_read_b64_tr_b16 a[232:233], v7 offset:16384
 s_waitcnt lgkmcnt(6)
 v_mul_f32 v251, v251, v2
 v_mfma_f32_16x16x32_bf16 v[156:159], a[236:239], v[36:39], 0
 ds_read_b64_tr_b16 a[234:235], v7 offset:18432
 v_cvt_pk_bf16_f32 v125, v250, v251
 v_mfma_f32_16x16x32_bf16 v[160:163], a[240:243], v[32:35], 0
 ds_read_b64_tr_b16 a[236:237], v8 offset:16384
 v_mul_f32 v252, v252, v2
 v_mfma_f32_16x16x32_bf16 v[168:171], a[240:243], v[36:39], 0
 ds_read_b64_tr_b16 a[238:239], v8 offset:18432
 v_mul_f32 v253, v253, v2
 v_mfma_f32_16x16x32_bf16 v[164:167], a[244:247], v[32:35], 0
 ds_read_b64_tr_b16 a[240:241], v5 offset:20480
 v_cvt_pk_bf16_f32 v126, v252, v253
 v_mfma_f32_16x16x32_bf16 v[172:175], a[244:247], v[36:39], 0
 ds_read_b64_tr_b16 a[242:243], v5 offset:22528
 v_mul_f32 v254, v254, v2
 v_mfma_f32_16x16x32_bf16 v[176:179], a[248:251], v[32:35], 0
 ds_read_b64_tr_b16 a[244:245], v6 offset:20480
 v_mul_f32 v255, v255, v2
 v_mfma_f32_16x16x32_bf16 v[184:187], a[248:251], v[36:39], 0
 ds_read_b64_tr_b16 a[246:247], v6 offset:22528
 v_cmp_lt_f32 vcc, 0x41200000, v13
 v_cvt_pk_bf16_f32 v127, v254, v255
 v_mfma_f32_16x16x32_bf16 v[180:183], a[252:255], v[32:35], 0
 ds_read_b64_tr_b16 a[248:249], v7 offset:20480
 s_waitcnt lgkmcnt(5)
 s_cbranch_vccnz L_rs1_1
L_rb1_1:
 v_mfma_f32_16x16x32_bf16 v[188:191], a[252:255], v[36:39], 0
 ds_read_b64_tr_b16 a[250:251], v7 offset:22528
 v_and_b32 v27, 0xffff, v8
 v_mfma_f32_16x16x32_bf16 v[192:195], a[224:227], v[32:35], 0
 ds_read_b64_tr_b16 a[252:253], v8 offset:20480
 v_cmp_le_u32 vcc, 134, v10
 v_mfma_f32_16x16x32_bf16 v[200:203], a[224:227], v[36:39], 0
 ds_read_b64_tr_b16 a[254:255], v8 offset:22528
 v_add_u32 v3, 0x10000, v3
 v_mfma_f32_16x16x32_bf16 v[196:199], a[228:231], v[32:35], 0
 s_cbranch_vccz L_cs1008
L_cb1008:
 ds_read_b64_tr_b16 a[224:225], v24 offset:16384
 v_mfma_f32_16x16x32_bf16 v[204:207], a[228:231], v[36:39], 0
 ds_read_b64_tr_b16 a[226:227], v24 offset:18432
 v_add_u32 v4, 0x10000, v4
 v_mfma_f32_16x16x32_bf16 v[208:211], a[232:235], v[32:35], 0
 ds_read_b64_tr_b16 a[228:229], v25 offset:16384
 ds_read_b32 v10, v9
 v_mfma_f32_16x16x32_bf16 v[216:219], a[232:235], v[36:39], 0
 ds_read_b64_tr_b16 a[230:231], v25 offset:18432
 v_mfma_f32_16x16x32_bf16 v[212:215], a[236:239], v[32:35], 0
 ds_read_b64_tr_b16 a[232:233], v26 offset:16384
 s_waitcnt lgkmcnt(6)
 v_mfma_f32_16x16x32_bf16 v[220:223], a[236:239], v[36:39], 0
 ds_read_b64_tr_b16 a[234:235], v26 offset:18432
 v_mfma_f32_16x16x32_bf16 v[224:227], a[240:243], v[32:35], 0
 ds_read_b64_tr_b16 a[236:237], v27 offset:16384
 v_mfma_f32_16x16x32_bf16 v[232:235], a[240:243], v[36:39], 0
 ds_read_b64_tr_b16 a[238:239], v27 offset:18432
 v_mfma_f32_16x16x32_bf16 v[228:231], a[244:247], v[32:35], 0
 ds_read_b64_tr_b16 a[240:241], v24 offset:20480
 v_mfma_f32_16x16x32_bf16 v[236:239], a[244:247], v[36:39], 0
 ds_read_b64_tr_b16 a[242:243], v24 offset:22528
 s_movk_i32 s70, 504
 v_mfma_f32_16x16x32_bf16 v[240:243], a[248:251], v[32:35], 0
 ds_read_b64_tr_b16 a[244:245], v25 offset:20480
 v_mfma_f32_16x16x32_bf16 v[248:251], a[248:251], v[36:39], 0
 ds_read_b64_tr_b16 a[246:247], v25 offset:22528
 v_mfma_f32_16x16x32_bf16 v[244:247], a[252:255], v[32:35], 0
 ds_read_b64_tr_b16 a[248:249], v26 offset:20480
 s_waitcnt lgkmcnt(5)
 v_mfma_f32_16x16x32_bf16 v[252:255], a[252:255], v[36:39], 0
 ds_read_b64_tr_b16 a[250:251], v26 offset:22528
 buffer_load_dword off, s[72:75], s70 lds
 v_mfma_f32_16x16x32_bf16 a[64:67], a[224:227], v[64:67], 0
 ds_read_b64_tr_b16 a[252:253], v27 offset:20480
 v_cmp_le_u32 vcc, 138, v10
 v_mfma_f32_16x16x32_bf16 a[72:75], a[224:227], v[68:71], 0
 ds_read_b64_tr_b16 a[254:255], v27 offset:22528
 v_mfma_f32_16x16x32_bf16 a[68:71], a[228:231], v[64:67], 0
 s_cbranch_vccz L_cs1016
L_cb1016:
 ds_read_b128 a[224:227], v3 offset:0
 v_mfma_f32_16x16x32_bf16 a[76:79], a[228:231], v[68:71], 0
 v_exp_f32 v48, v48
 v_mfma_f32_16x16x32_bf16 a[80:83], a[232:235], v[64:67], 0
 ds_read_b128 a[228:231], v3 offset:2048
 v_add_f32 v14, v14, v48
 v_mfma_f32_16x16x32_bf16 a[88:91], a[232:235], v[68:71], 0
 v_exp_f32 v49, v49
 v_mfma_f32_16x16x32_bf16 a[84:87], a[236:239], v[64:67], 0
 ds_read_b128 a[232:235], v4 offset:0
 s_waitcnt lgkmcnt(3)
 v_mfma_f32_16x16x32_bf16 a[92:95], a[236:239], v[68:71], 0
 v_exp_f32 v50, v50
 v_mfma_f32_16x16x32_bf16 a[64:67], a[240:243], v[72:75], a[64:67]
 ds_read_b128 a[236:239], v4 offset:2048
 v_add_f32 v14, v14, v49
 v_mfma_f32_16x16x32_bf16 a[72:75], a[240:243], v[76:79], a[72:75]
 v_exp_f32 v51, v51
 v_mfma_f32_16x16x32_bf16 a[68:71], a[244:247], v[72:75], a[68:71]
 ds_read_b128 a[240:243], v3 offset:4096
 v_add_u32 v5, 0xffff0000, v5
 v_mfma_f32_16x16x32_bf16 a[76:79], a[244:247], v[76:79], a[76:79]
 v_exp_f32 v52, v52
 v_mfma_f32_16x16x32_bf16 a[80:83], a[248:251], v[72:75], a[80:83]
 ds_read_b128 a[244:247], v3 offset:6144
 s_movk_i32 s70, 508
 v_mfma_f32_16x16x32_bf16 a[88:91], a[248:251], v[76:79], a[88:91]
 v_exp_f32 v53, v53
 v_mfma_f32_16x16x32_bf16 a[84:87], a[252:255], v[72:75], a[84:87]
 ds_read_b128 a[248:251], v4 offset:4096
 s_waitcnt lgkmcnt(3)
 v_add_u32 v6, 0xffff0000, v6
 v_mfma_f32_16x16x32_bf16 a[92:95], a[252:255], v[76:79], a[92:95]
 buffer_load_dword off, s[72:75], s70 lds
 v_add_u32 v7, 0xffff0000, v7
 v_exp_f32 v54, v54
 v_mfma_f32_16x16x32_bf16 v[32:35], a[224:227], a[112:115], v[16:19]
 ds_read_b128 a[252:255], v4 offset:6144
 v_add_u32 v8, 0xffff0000, v8
 v_mfma_f32_16x16x32_bf16 v[40:43], a[224:227], a[116:119], v[20:23]
 v_exp_f32 v55, v55
 v_mfma_f32_16x16x32_bf16 v[36:39], a[228:231], a[112:115], v[16:19]
 ds_read_b128 a[224:227], v3 offset:57344
 v_cvt_pk_bf16_f32 v48, v48, v49
 v_mfma_f32_16x16x32_bf16 v[44:47], a[228:231], a[116:119], v[20:23]
 v_exp_f32 v56, v56
 v_mfma_f32_16x16x32_bf16 v[32:35], a[232:235], a[120:123], v[32:35]
 ds_read_b128 a[228:231], v3 offset:59392
 v_add_f32 v14, v14, v50
 v_mfma_f32_16x16x32_bf16 v[40:43], a[232:235], a[124:127], v[40:43]
 v_exp_f32 v57, v57
 v_mfma_f32_16x16x32_bf16 v[36:39], a[236:239], a[120:123], v[36:39]
 ds_read_b128 a[232:235], v4 offset:57344
 s_waitcnt lgkmcnt(3)
 v_exp_f32 v58, v58
 v_mfma_f32_16x16x32_bf16 v[44:47], a[236:239], a[124:127], v[44:47]
 v_exp_f32 v59, v59
 v_mfma_f32_16x16x32_bf16 v[32:35], a[240:243], a[128:131], v[32:35]
 ds_read_b128 a[236:239], v4 offset:59392
 v_add_f32 v14, v14, v51
 v_mfma_f32_16x16x32_bf16 v[40:43], a[240:243], a[132:135], v[40:43]
 v_exp_f32 v60, v60
 v_mfma_f32_16x16x32_bf16 v[36:39], a[244:247], a[128:131], v[36:39]
 ds_read_b128 a[240:243], v3 offset:61440
 v_cvt_pk_bf16_f32 v49, v50, v51
 v_mfma_f32_16x16x32_bf16 v[44:47], a[244:247], a[132:135], v[44:47]
 v_exp_f32 v61, v61
 v_mfma_f32_16x16x32_bf16 v[32:35], a[248:251], a[136:139], v[32:35]
 ds_read_b128 a[244:247], v3 offset:63488
 v_add_f32 v14, v14, v52
 v_mfma_f32_16x16x32_bf16 v[40:43], a[248:251], a[140:143], v[40:43]
 v_exp_f32 v62, v62
 v_mfma_f32_16x16x32_bf16 v[36:39], a[252:255], a[136:139], v[36:39]
 ds_read_b128 a[248:251], v4 offset:61440
 s_waitcnt lgkmcnt(3)
 v_mfma_f32_16x16x32_bf16 v[44:47], a[252:255], a[140:143], v[44:47]
 v_exp_f32 v63, v63
 v_mfma_f32_16x16x32_bf16 v[32:35], a[224:227], a[144:147], v[32:35]
 ds_read_b128 a[252:255], v4 offset:63488
 v_add_f32 v14, v14, v53
 v_mfma_f32_16x16x32_bf16 v[40:43], a[224:227], a[148:151], v[40:43]
 v_cvt_pk_bf16_f32 v50, v52, v53
 v_add_f32 v14, v14, v54
 v_mfma_f32_16x16x32_bf16 v[36:39], a[228:231], a[144:147], v[36:39]
 ds_read_b64_tr_b16 a[224:225], v5 offset:16384
 v_add_f32 v14, v14, v55
 v_mfma_f32_16x16x32_bf16 v[44:47], a[228:231], a[148:151], v[44:47]
 ds_read_b64_tr_b16 a[226:227], v5 offset:18432
 v_cvt_pk_bf16_f32 v51, v54, v55
 v_mfma_f32_16x16x32_bf16 v[32:35], a[232:235], a[152:155], v[32:35]
 ds_read_b64_tr_b16 a[228:229], v6 offset:16384
 ds_read_b32 v10, v9
 v_add_f32 v15, v15, v56
 v_mfma_f32_16x16x32_bf16 v[40:43], a[232:235], a[156:159], v[40:43]
 ds_read_b64_tr_b16 a[230:231], v6 offset:18432
 v_add_f32 v15, v15, v57
 v_mfma_f32_16x16x32_bf16 v[36:39], a[236:239], a[152:155], v[36:39]
 ds_read_b64_tr_b16 a[232:233], v7 offset:16384
 s_waitcnt lgkmcnt(6)
 v_cvt_pk_bf16_f32 v52, v56, v57
 v_mfma_f32_16x16x32_bf16 v[44:47], a[236:239], a[156:159], v[44:47]
 ds_read_b64_tr_b16 a[234:235], v7 offset:18432
 v_add_f32 v15, v15, v58
 v_mfma_f32_16x16x32_bf16 v[32:35], a[240:243], a[160:163], v[32:35]
 ds_read_b64_tr_b16 a[236:237], v8 offset:16384
 v_add_f32 v15, v15, v59
 v_mfma_f32_16x16x32_bf16 v[40:43], a[240:243], a[164:167], v[40:43]
 ds_read_b64_tr_b16 a[238:239], v8 offset:18432
 v_cvt_pk_bf16_f32 v53, v58, v59
 v_mfma_f32_16x16x32_bf16 v[36:39], a[244:247], a[160:163], v[36:39]
 ds_read_b64_tr_b16 a[240:241], v5 offset:20480
 v_add_f32 v15, v15, v60
 v_mfma_f32_16x16x32_bf16 v[44:47], a[244:247], a[164:167], v[44:47]
 ds_read_b64_tr_b16 a[242:243], v5 offset:22528
 v_add_f32 v15, v15, v61
 v_mfma_f32_16x16x32_bf16 v[32:35], a[248:251], a[168:171], v[32:35]
 ds_read_b64_tr_b16 a[244:245], v6 offset:20480
 v_cvt_pk_bf16_f32 v54, v60, v61
 v_mfma_f32_16x16x32_bf16 v[40:43], a[248:251], a[172:175], v[40:43]
 ds_read_b64_tr_b16 a[246:247], v6 offset:22528
 v_add_f32 v15, v15, v62
 v_mfma_f32_16x16x32_bf16 v[36:39], a[252:255], a[168:171], v[36:39]
 ds_read_b64_tr_b16 a[248:249], v7 offset:20480
 v_add_f32 v15, v15, v63
 v_cvt_pk_bf16_f32 v55, v62, v63
 v_mfma_f32_16x16x32_bf16 v[44:47], a[252:255], a[172:175], v[44:47]
 ds_read_b64_tr_b16 a[250:251], v7 offset:22528
 s_waitcnt lgkmcnt(6)
 s_movk_i32 s70, 516
 v_mfma_f32_16x16x32_bf16 v[128:131], a[224:227], v[48:51], v[128:131]
 ds_read_b64_tr_b16 a[252:253], v8 offset:20480
 buffer_load_dword off, s[72:75], s70 lds
 v_cmp_le_u32 vcc, 139, v10
 v_mfma_f32_16x16x32_bf16 v[136:139], a[224:227], v[52:55], v[136:139]
 ds_read_b64_tr_b16 a[254:255], v8 offset:22528
 v_mfma_f32_16x16x32_bf16 v[132:135], a[228:231], v[48:51], v[132:135]
 s_cbranch_vccz L_cs1040
L_cb1040:
 ds_read_b64_tr_b16 a[224:225], v5 offset:24576
 v_mfma_f32_16x16x32_bf16 v[140:143], a[228:231], v[52:55], v[140:143]
 ds_read_b64_tr_b16 a[226:227], v5 offset:26624
 v_max3_f32 v11, v32, v33, v34
 v_mfma_f32_16x16x32_bf16 v[144:147], a[232:235], v[48:51], v[144:147]
 ds_read_b64_tr_b16 a[228:229], v6 offset:24576
 v_max3_f32 v12, v40, v41, v42
 v_mfma_f32_16x16x32_bf16 v[152:155], a[232:235], v[52:55], v[152:155]
 ds_read_b64_tr_b16 a[230:231], v6 offset:26624
 v_max3_f32 v11, v11, v35, v36
 v_mfma_f32_16x16x32_bf16 v[148:151], a[236:239], v[48:51], v[148:151]
 ds_read_b64_tr_b16 a[232:233], v7 offset:24576
 s_waitcnt lgkmcnt(5)
 v_mfma_f32_16x16x32_bf16 v[156:159], a[236:239], v[52:55], v[156:159]
 ds_read_b64_tr_b16 a[234:235], v7 offset:26624
 v_max3_f32 v12, v12, v43, v44
 v_mfma_f32_16x16x32_bf16 v[160:163], a[240:243], v[48:51], v[160:163]
 ds_read_b64_tr_b16 a[236:237], v8 offset:24576
 v_max3_f32 v11, v11, v37, v38
 v_mfma_f32_16x16x32_bf16 v[168:171], a[240:243], v[52:55], v[168:171]
 ds_read_b64_tr_b16 a[238:239], v8 offset:26624
 v_max3_f32 v12, v12, v45, v46
 v_mfma_f32_16x16x32_bf16 v[164:167], a[244:247], v[48:51], v[164:167]
 ds_read_b64_tr_b16 a[240:241], v5 offset:28672
 v_max_f32 v11, v11, v39
 v_mfma_f32_16x16x32_bf16 v[172:175], a[244:247], v[52:55], v[172:175]
 ds_read_b64_tr_b16 a[242:243], v5 offset:30720
 v_max_f32 v12, v12, v47
 v_mfma_f32_16x16x32_bf16 v[176:179], a[248:251], v[48:51], v[176:179]
 ds_read_b64_tr_b16 a[244:245], v6 offset:28672
 v_max_f32 v13, v11, v12
 v_mfma_f32_16x16x32_bf16 v[184:187], a[248:251], v[52:55], v[184:187]
 ds_read_b64_tr_b16 a[246:247], v6 offset:30720
 v_cmp_lt_f32 vcc, 0x41200000, v13
 v_mfma_f32_16x16x32_bf16 v[180:183], a[252:255], v[48:51], v[180:183]
 ds_read_b64_tr_b16 a[248:249], v7 offset:28672
 s_waitcnt lgkmcnt(5)
 s_cbranch_vccnz L_rs1_2
L_rb1_2:
 v_mfma_f32_16x16x32_bf16 v[188:191], a[252:255], v[52:55], v[188:191]
 ds_read_b64_tr_b16 a[250:251], v7 offset:30720
 v_add_u32 v3, 0xffff0000, v3
 v_mfma_f32_16x16x32_bf16 v[192:195], a[224:227], v[48:51], v[192:195]
 ds_read_b64_tr_b16 a[252:253], v8 offset:28672
 v_add_u32 v4, 0xffff0000, v4
 v_mfma_f32_16x16x32_bf16 v[200:203], a[224:227], v[52:55], v[200:203]
 ds_read_b64_tr_b16 a[254:255], v8 offset:30720
 v_mfma_f32_16x16x32_bf16 v[196:199], a[228:231], v[48:51], v[196:199]
 ds_read_b64_tr_b16 a[224:225], v24 offset:24576
 v_mfma_f32_16x16x32_bf16 v[204:207], a[228:231], v[52:55], v[204:207]
 ds_read_b64_tr_b16 a[226:227], v24 offset:26624
 v_mfma_f32_16x16x32_bf16 v[208:211], a[232:235], v[48:51], v[208:211]
 ds_read_b64_tr_b16 a[228:229], v25 offset:24576
 ds_read_b32 v10, v9
 v_mfma_f32_16x16x32_bf16 v[216:219], a[232:235], v[52:55], v[216:219]
 ds_read_b64_tr_b16 a[230:231], v25 offset:26624
 v_mfma_f32_16x16x32_bf16 v[212:215], a[236:239], v[48:51], v[212:215]
 ds_read_b64_tr_b16 a[232:233], v26 offset:24576
 s_waitcnt lgkmcnt(6)
 v_mfma_f32_16x16x32_bf16 v[220:223], a[236:239], v[52:55], v[220:223]
 ds_read_b64_tr_b16 a[234:235], v26 offset:26624
 v_mfma_f32_16x16x32_bf16 v[224:227], a[240:243], v[48:51], v[224:227]
 ds_read_b64_tr_b16 a[236:237], v27 offset:24576
 v_mfma_f32_16x16x32_bf16 v[232:235], a[240:243], v[52:55], v[232:235]
 ds_read_b64_tr_b16 a[238:239], v27 offset:26624
 v_mfma_f32_16x16x32_bf16 v[228:231], a[244:247], v[48:51], v[228:231]
 ds_read_b64_tr_b16 a[240:241], v24 offset:28672
 v_mfma_f32_16x16x32_bf16 v[236:239], a[244:247], v[52:55], v[236:239]
 ds_read_b64_tr_b16 a[242:243], v24 offset:30720
 s_movk_i32 s70, 524
 v_mfma_f32_16x16x32_bf16 v[240:243], a[248:251], v[48:51], v[240:243]
 ds_read_b64_tr_b16 a[244:245], v25 offset:28672
 v_mfma_f32_16x16x32_bf16 v[248:251], a[248:251], v[52:55], v[248:251]
 ds_read_b64_tr_b16 a[246:247], v25 offset:30720
 v_mfma_f32_16x16x32_bf16 v[244:247], a[252:255], v[48:51], v[244:247]
 ds_read_b64_tr_b16 a[248:249], v26 offset:28672
 s_waitcnt lgkmcnt(5)
 v_mfma_f32_16x16x32_bf16 v[252:255], a[252:255], v[52:55], v[252:255]
 ds_read_b64_tr_b16 a[250:251], v26 offset:30720
 buffer_load_dword off, s[72:75], s70 lds
 v_mfma_f32_16x16x32_bf16 a[64:67], a[224:227], v[80:83], a[64:67]
 ds_read_b64_tr_b16 a[252:253], v27 offset:28672
 v_cmp_le_u32 vcc, 142, v10
 v_mfma_f32_16x16x32_bf16 a[72:75], a[224:227], v[84:87], a[72:75]
 ds_read_b64_tr_b16 a[254:255], v27 offset:30720
 v_mfma_f32_16x16x32_bf16 a[68:71], a[228:231], v[80:83], a[68:71]
 s_cbranch_vccz L_cs1056
L_cb1056:
 ds_read_b128 a[224:227], v3 offset:49152
 v_mfma_f32_16x16x32_bf16 a[76:79], a[228:231], v[84:87], a[76:79]
 v_exp_f32 v32, v32
 v_mfma_f32_16x16x32_bf16 a[80:83], a[232:235], v[80:83], a[80:83]
 ds_read_b128 a[228:231], v3 offset:51200
 v_add_f32 v14, v14, v32
 v_mfma_f32_16x16x32_bf16 a[88:91], a[232:235], v[84:87], a[88:91]
 v_exp_f32 v33, v33
 v_mfma_f32_16x16x32_bf16 a[84:87], a[236:239], v[80:83], a[84:87]
 ds_read_b128 a[232:235], v4 offset:49152
 s_waitcnt lgkmcnt(3)
 v_mfma_f32_16x16x32_bf16 a[92:95], a[236:239], v[84:87], a[92:95]
 v_exp_f32 v34, v34
 v_mfma_f32_16x16x32_bf16 a[64:67], a[240:243], v[88:91], a[64:67]
 ds_read_b128 a[236:239], v4 offset:51200
 v_add_f32 v14, v14, v33
 v_mfma_f32_16x16x32_bf16 a[72:75], a[240:243], v[92:95], a[72:75]
 v_exp_f32 v35, v35
 v_mfma_f32_16x16x32_bf16 a[68:71], a[244:247], v[88:91], a[68:71]
 ds_read_b128 a[240:243], v3 offset:53248
 v_cvt_pk_bf16_f32 v32, v32, v33
 v_mfma_f32_16x16x32_bf16 a[76:79], a[244:247], v[92:95], a[76:79]
 v_exp_f32 v36, v36
 v_mfma_f32_16x16x32_bf16 a[80:83], a[248:251], v[88:91], a[80:83]
 ds_read_b128 a[244:247], v3 offset:55296
 s_movk_i32 s70, 528
 v_mfma_f32_16x16x32_bf16 a[88:91], a[248:251], v[92:95], a[88:91]
 v_exp_f32 v37, v37
 v_mfma_f32_16x16x32_bf16 a[84:87], a[252:255], v[88:91], a[84:87]
 ds_read_b128 a[248:251], v4 offset:53248
 s_waitcnt lgkmcnt(3)
 v_mfma_f32_16x16x32_bf16 a[92:95], a[252:255], v[92:95], a[92:95]
 buffer_load_dword off, s[72:75], s70 lds
 v_add_u32 v3, 0x10000, v3
 v_mfma_f32_16x16x32_bf16 v[48:51], a[224:227], a[112:115], v[16:19]
 ds_read_b128 a[252:255], v4 offset:55296
 v_add_u32 v4, 0x10000, v4
 v_exp_f32 v38, v38
 v_mfma_f32_16x16x32_bf16 v[56:59], a[224:227], a[116:119], v[20:23]
 v_exp_f32 v39, v39
 v_mfma_f32_16x16x32_bf16 v[52:55], a[228:231], a[112:115], v[16:19]
 ds_read_b128 a[224:227], v3 offset:8192
 v_add_f32 v14, v14, v34
 v_mfma_f32_16x16x32_bf16 v[60:63], a[228:231], a[116:119], v[20:23]
 v_exp_f32 v40, v40
 v_mfma_f32_16x16x32_bf16 v[48:51], a[232:235], a[120:123], v[48:51]
 ds_read_b128 a[228:231], v3 offset:10240
 v_add_f32 v14, v14, v35
 v_mfma_f32_16x16x32_bf16 v[56:59], a[232:235], a[124:127], v[56:59]
 v_exp_f32 v41, v41
 v_mfma_f32_16x16x32_bf16 v[52:55], a[236:239], a[120:123], v[52:55]
 ds_read_b128 a[232:235], v4 offset:8192
 s_waitcnt lgkmcnt(3)
 v_mfma_f32_16x16x32_bf16 v[60:63], a[236:239], a[124:127], v[60:63]
 v_exp_f32 v42, v42
 v_mfma_f32_16x16x32_bf16 v[48:51], a[240:243], a[128:131], v[48:51]
 ds_read_b128 a[236:239], v4 offset:10240
 v_cvt_pk_bf16_f32 v33, v34, v35
 v_mfma_f32_16x16x32_bf16 v[56:59], a[240:243], a[132:135], v[56:59]
 v_exp_f32 v43, v43
 v_mfma_f32_16x16x32_bf16 v[52:55], a[244:247], a[128:131], v[52:55]
 ds_read_b128 a[240:243], v3 offset:12288
 v_add_f32 v14, v14, v36
 v_mfma_f32_16x16x32_bf16 v[60:63], a[244:247], a[132:135], v[60:63]
 v_exp_f32 v44, v44
 v_mfma_f32_16x16x32_bf16 v[48:51], a[248:251], a[136:139], v[48:51]
 ds_read_b128 a[244:247], v3 offset:14336
 v_add_f32 v14, v14, v37
 v_mfma_f32_16x16x32_bf16 v[56:59], a[248:251], a[140:143], v[56:59]
 v_exp_f32 v45, v45
 v_mfma_f32_16x16x32_bf16 v[52:55], a[252:255], a[136:139], v[52:55]
 ds_read_b128 a[248:251], v4 offset:12288
 s_waitcnt lgkmcnt(3)
 v_exp_f32 v46, v46
 v_mfma_f32_16x16x32_bf16 v[60:63], a[252:255], a[140:143], v[60:63]
 v_exp_f32 v47, v47
 v_mfma_f32_16x16x32_bf16 v[48:51], a[224:227], a[144:147], v[48:51]
 ds_read_b128 a[252:255], v4 offset:14336
 v_cvt_pk_bf16_f32 v34, v36, v37
 v_mfma_f32_16x16x32_bf16 v[56:59], a[224:227], a[148:151], v[56:59]
 v_add_f32 v14, v14, v38
 v_add_f32 v14, v14, v39
 v_mfma_f32_16x16x32_bf16 v[52:55], a[228:231], a[144:147], v[52:55]
 ds_read_b64_tr_b16 a[224:225], v5 offset:32768
 v_cvt_pk_bf16_f32 v35, v38, v39
 v_mfma_f32_16x16x32_bf16 v[60:63], a[228:231], a[148:151], v[60:63]
 ds_read_b64_tr_b16 a[226:227], v5 offset:34816
 v_add_f32 v15, v15, v40
 v_mfma_f32_16x16x32_bf16 v[48:51], a[232:235], a[152:155], v[48:51]
 ds_read_b64_tr_b16 a[228:229], v6 offset:32768
 ds_read_b32 v10, v9
 v_mfma_f32_16x16x32_bf16 v[56:59], a[232:235], a[156:159], v[56:59]
 ds_read_b64_tr_b16 a[230:231], v6 offset:34816
 v_add_f32 v15, v15, v41
 v_mfma_f32_16x16x32_bf16 v[52:55], a[236:239], a[152:155], v[52:55]
 ds_read_b64_tr_b16 a[232:233], v7 offset:32768
 s_waitcnt lgkmcnt(6)
 v_cvt_pk_bf16_f32 v36, v40, v41
 v_mfma_f32_16x16x32_bf16 v[60:63], a[236:239], a[156:159], v[60:63]
 ds_read_b64_tr_b16 a[234:235], v7 offset:34816
 v_add_f32 v15, v15, v42
 v_mfma_f32_16x16x32_bf16 v[48:51], a[240:243], a[160:163], v[48:51]
 ds_read_b64_tr_b16 a[236:237], v8 offset:32768
 v_add_f32 v15, v15, v43
 v_mfma_f32_16x16x32_bf16 v[56:59], a[240:243], a[164:167], v[56:59]
 ds_read_b64_tr_b16 a[238:239], v8 offset:34816
 v_cvt_pk_bf16_f32 v37, v42, v43
 v_mfma_f32_16x16x32_bf16 v[52:55], a[244:247], a[160:163], v[52:55]
 ds_read_b64_tr_b16 a[240:241], v5 offset:36864
 v_add_f32 v15, v15, v44
 v_mfma_f32_16x16x32_bf16 v[60:63], a[244:247], a[164:167], v[60:63]
 ds_read_b64_tr_b16 a[242:243], v5 offset:38912
 v_add_f32 v15, v15, v45
 v_mfma_f32_16x16x32_bf16 v[48:51], a[248:251], a[168:171], v[48:51]
 ds_read_b64_tr_b16 a[244:245], v6 offset:36864
 v_cvt_pk_bf16_f32 v38, v44, v45
 v_mfma_f32_16x16x32_bf16 v[56:59], a[248:251], a[172:175], v[56:59]
 ds_read_b64_tr_b16 a[246:247], v6 offset:38912
 v_add_f32 v15, v15, v46
 v_mfma_f32_16x16x32_bf16 v[52:55], a[252:255], a[168:171], v[52:55]
 ds_read_b64_tr_b16 a[248:249], v7 offset:36864
 v_add_f32 v15, v15, v47
 v_cvt_pk_bf16_f32 v39, v46, v47
 v_mfma_f32_16x16x32_bf16 v[60:63], a[252:255], a[172:175], v[60:63]
 ds_read_b64_tr_b16 a[250:251], v7 offset:38912
 s_waitcnt lgkmcnt(6)
 s_movk_i32 s70, 536
 v_mfma_f32_16x16x32_bf16 v[128:131], a[224:227], v[32:35], v[128:131]
 ds_read_b64_tr_b16 a[252:253], v8 offset:36864
 buffer_load_dword off, s[72:75], s70 lds
 v_cmp_le_u32 vcc, 143, v10
 v_mfma_f32_16x16x32_bf16 v[136:139], a[224:227], v[36:39], v[136:139]
 ds_read_b64_tr_b16 a[254:255], v8 offset:38912
 v_mfma_f32_16x16x32_bf16 v[132:135], a[228:231], v[32:35], v[132:135]
 s_cbranch_vccz L_cs1080
L_cb1080:
 ds_read_b64_tr_b16 a[224:225], v5 offset:40960
 v_mfma_f32_16x16x32_bf16 v[140:143], a[228:231], v[36:39], v[140:143]
 ds_read_b64_tr_b16 a[226:227], v5 offset:43008
 v_max3_f32 v11, v48, v49, v50
 v_mfma_f32_16x16x32_bf16 v[144:147], a[232:235], v[32:35], v[144:147]
 ds_read_b64_tr_b16 a[228:229], v6 offset:40960
 ds_read_b32 v10, v9
 v_mfma_f32_16x16x32_bf16 v[152:155], a[232:235], v[36:39], v[152:155]
 ds_read_b64_tr_b16 a[230:231], v6 offset:43008
 v_max3_f32 v12, v56, v57, v58
 v_mfma_f32_16x16x32_bf16 v[148:151], a[236:239], v[32:35], v[148:151]
 ds_read_b64_tr_b16 a[232:233], v7 offset:40960
 s_waitcnt lgkmcnt(6)
 v_mfma_f32_16x16x32_bf16 v[156:159], a[236:239], v[36:39], v[156:159]
 ds_read_b64_tr_b16 a[234:235], v7 offset:43008
 v_max3_f32 v11, v11, v51, v52
 v_mfma_f32_16x16x32_bf16 v[160:163], a[240:243], v[32:35], v[160:163]
 ds_read_b64_tr_b16 a[236:237], v8 offset:40960
 v_max3_f32 v12, v12, v59, v60
 v_mfma_f32_16x16x32_bf16 v[168:171], a[240:243], v[36:39], v[168:171]
 ds_read_b64_tr_b16 a[238:239], v8 offset:43008
 v_max3_f32 v11, v11, v53, v54
 v_mfma_f32_16x16x32_bf16 v[164:167], a[244:247], v[32:35], v[164:167]
 ds_read_b64_tr_b16 a[240:241], v5 offset:45056
 v_max3_f32 v12, v12, v61, v62
 v_mfma_f32_16x16x32_bf16 v[172:175], a[244:247], v[36:39], v[172:175]
 ds_read_b64_tr_b16 a[242:243], v5 offset:47104
 v_max_f32 v11, v11, v55
 v_mfma_f32_16x16x32_bf16 v[176:179], a[248:251], v[32:35], v[176:179]
 ds_read_b64_tr_b16 a[244:245], v6 offset:45056
 v_max_f32 v12, v12, v63
 v_mfma_f32_16x16x32_bf16 v[184:187], a[248:251], v[36:39], v[184:187]
 ds_read_b64_tr_b16 a[246:247], v6 offset:47104
 v_max_f32 v13, v11, v12
 v_cmp_lt_f32 vcc, 0x41200000, v13
 v_mfma_f32_16x16x32_bf16 v[180:183], a[252:255], v[32:35], v[180:183]
 ds_read_b64_tr_b16 a[248:249], v7 offset:45056
 s_waitcnt lgkmcnt(5)
 s_cbranch_vccnz L_rs1_3
L_rb1_3:
 v_mfma_f32_16x16x32_bf16 v[188:191], a[252:255], v[36:39], v[188:191]
 ds_read_b64_tr_b16 a[250:251], v7 offset:47104
 v_mfma_f32_16x16x32_bf16 v[192:195], a[224:227], v[32:35], v[192:195]
 ds_read_b64_tr_b16 a[252:253], v8 offset:45056
 v_cmp_le_u32 vcc, 145, v10
 v_mfma_f32_16x16x32_bf16 v[200:203], a[224:227], v[36:39], v[200:203]
 ds_read_b64_tr_b16 a[254:255], v8 offset:47104
 v_mfma_f32_16x16x32_bf16 v[196:199], a[228:231], v[32:35], v[196:199]
 s_cbranch_vccz L_cs1088
L_cb1088:
 ds_read_b64_tr_b16 a[224:225], v24 offset:40960
 v_mfma_f32_16x16x32_bf16 v[204:207], a[228:231], v[36:39], v[204:207]
 ds_read_b64_tr_b16 a[226:227], v24 offset:43008
 v_mfma_f32_16x16x32_bf16 v[208:211], a[232:235], v[32:35], v[208:211]
 ds_read_b64_tr_b16 a[228:229], v25 offset:40960
 v_mfma_f32_16x16x32_bf16 v[216:219], a[232:235], v[36:39], v[216:219]
 ds_read_b64_tr_b16 a[230:231], v25 offset:43008
 v_mfma_f32_16x16x32_bf16 v[212:215], a[236:239], v[32:35], v[212:215]
 ds_read_b64_tr_b16 a[232:233], v26 offset:40960
 s_waitcnt lgkmcnt(5)
 v_mfma_f32_16x16x32_bf16 v[220:223], a[236:239], v[36:39], v[220:223]
 ds_read_b64_tr_b16 a[234:235], v26 offset:43008
 v_mfma_f32_16x16x32_bf16 v[224:227], a[240:243], v[32:35], v[224:227]
 ds_read_b64_tr_b16 a[236:237], v27 offset:40960
 v_mfma_f32_16x16x32_bf16 v[232:235], a[240:243], v[36:39], v[232:235]
 ds_read_b64_tr_b16 a[238:239], v27 offset:43008
 v_mfma_f32_16x16x32_bf16 v[228:231], a[244:247], v[32:35], v[228:231]
 ds_read_b64_tr_b16 a[240:241], v24 offset:45056
 v_mfma_f32_16x16x32_bf16 v[236:239], a[244:247], v[36:39], v[236:239]
 ds_read_b64_tr_b16 a[242:243], v24 offset:47104
 s_movk_i32 s70, 544
 v_mfma_f32_16x16x32_bf16 v[240:243], a[248:251], v[32:35], v[240:243]
 ds_read_b64_tr_b16 a[244:245], v25 offset:45056
 v_mfma_f32_16x16x32_bf16 v[248:251], a[248:251], v[36:39], v[248:251]
 ds_read_b64_tr_b16 a[246:247], v25 offset:47104
 v_mfma_f32_16x16x32_bf16 v[244:247], a[252:255], v[32:35], v[244:247]
 ds_read_b64_tr_b16 a[248:249], v26 offset:45056
 s_waitcnt lgkmcnt(5)
 v_mfma_f32_16x16x32_bf16 v[252:255], a[252:255], v[36:39], v[252:255]
 ds_read_b64_tr_b16 a[250:251], v26 offset:47104
 buffer_load_dword off, s[72:75], s70 lds
 v_mfma_f32_16x16x32_bf16 a[64:67], a[224:227], v[96:99], a[64:67]
 ds_read_b64_tr_b16 a[252:253], v27 offset:45056
 v_mfma_f32_16x16x32_bf16 a[72:75], a[224:227], v[100:103], a[72:75]
 ds_read_b64_tr_b16 a[254:255], v27 offset:47104
 v_mfma_f32_16x16x32_bf16 a[68:71], a[228:231], v[96:99], a[68:71]
 ds_read_b64_tr_b16 a[224:225], v24 offset:32768
 v_mfma_f32_16x16x32_bf16 a[76:79], a[228:231], v[100:103], a[76:79]
 ds_read_b64_tr_b16 a[226:227], v24 offset:34816
 v_mfma_f32_16x16x32_bf16 a[80:83], a[232:235], v[96:99], a[80:83]
 ds_read_b64_tr_b16 a[228:229], v25 offset:32768
 ds_read_b32 v10, v9
 v_mfma_f32_16x16x32_bf16 a[88:91], a[232:235], v[100:103], a[88:91]
 ds_read_b64_tr_b16 a[230:231], v25 offset:34816
 v_mfma_f32_16x16x32_bf16 a[84:87], a[236:239], v[96:99], a[84:87]
 ds_read_b64_tr_b16 a[232:233], v26 offset:32768
 s_waitcnt lgkmcnt(6)
 v_mfma_f32_16x16x32_bf16 a[92:95], a[236:239], v[100:103], a[92:95]
 ds_read_b64_tr_b16 a[234:235], v26 offset:34816
 v_mfma_f32_16x16x32_bf16 a[64:67], a[240:243], v[104:107], a[64:67]
 ds_read_b64_tr_b16 a[236:237], v27 offset:32768
 v_mfma_f32_16x16x32_bf16 a[72:75], a[240:243], v[108:111], a[72:75]
 ds_read_b64_tr_b16 a[238:239], v27 offset:34816
 v_mfma_f32_16x16x32_bf16 a[68:71], a[244:247], v[104:107], a[68:71]
 ds_read_b64_tr_b16 a[240:241], v24 offset:36864
 v_mfma_f32_16x16x32_bf16 a[76:79], a[244:247], v[108:111], a[76:79]
 ds_read_b64_tr_b16 a[242:243], v24 offset:38912
 v_mfma_f32_16x16x32_bf16 a[80:83], a[248:251], v[104:107], a[80:83]
 ds_read_b64_tr_b16 a[244:245], v25 offset:36864
 v_mfma_f32_16x16x32_bf16 a[88:91], a[248:251], v[108:111], a[88:91]
 ds_read_b64_tr_b16 a[246:247], v25 offset:38912
 v_mfma_f32_16x16x32_bf16 a[84:87], a[252:255], v[104:107], a[84:87]
 ds_read_b64_tr_b16 a[248:249], v26 offset:36864
 s_waitcnt lgkmcnt(5)
 v_mfma_f32_16x16x32_bf16 a[92:95], a[252:255], v[108:111], a[92:95]
 ds_read_b64_tr_b16 a[250:251], v26 offset:38912
 v_mfma_f32_16x16x32_bf16 a[64:67], a[224:227], v[112:115], a[64:67]
 ds_read_b64_tr_b16 a[252:253], v27 offset:36864
 v_cmp_le_u32 vcc, 148, v10
 v_mfma_f32_16x16x32_bf16 a[72:75], a[224:227], v[116:119], a[72:75]
 ds_read_b64_tr_b16 a[254:255], v27 offset:38912
 v_mfma_f32_16x16x32_bf16 a[68:71], a[228:231], v[112:115], a[68:71]
 s_cbranch_vccz L_cs1104
L_cb1104:
 ds_read_b128 a[224:227], v3 offset:49152
 v_mfma_f32_16x16x32_bf16 a[76:79], a[228:231], v[116:119], a[76:79]
 v_exp_f32 v48, v48
 v_mfma_f32_16x16x32_bf16 a[80:83], a[232:235], v[112:115], a[80:83]
 ds_read_b128 a[228:231], v3 offset:51200
 v_add_f32 v14, v14, v48
 v_mfma_f32_16x16x32_bf16 a[88:91], a[232:235], v[116:119], a[88:91]
 v_exp_f32 v49, v49
 v_mfma_f32_16x16x32_bf16 a[84:87], a[236:239], v[112:115], a[84:87]
 ds_read_b128 a[232:235], v4 offset:49152
 s_waitcnt lgkmcnt(3)
 v_mfma_f32_16x16x32_bf16 a[92:95], a[236:239], v[116:119], a[92:95]
 v_exp_f32 v50, v50
 v_mfma_f32_16x16x32_bf16 a[64:67], a[240:243], v[120:123], a[64:67]
 ds_read_b128 a[236:239], v4 offset:51200
 v_add_f32 v14, v14, v49
 v_mfma_f32_16x16x32_bf16 a[72:75], a[240:243], v[124:127], a[72:75]
 v_exp_f32 v51, v51
 v_mfma_f32_16x16x32_bf16 a[68:71], a[244:247], v[120:123], a[68:71]
 ds_read_b128 a[240:243], v3 offset:53248
 v_add_u32 v5, 0x10000, v5
 v_mfma_f32_16x16x32_bf16 a[76:79], a[244:247], v[124:127], a[76:79]
 v_exp_f32 v52, v52
 v_mfma_f32_16x16x32_bf16 a[80:83], a[248:251], v[120:123], a[80:83]
 ds_read_b128 a[244:247], v3 offset:55296
 s_movk_i32 s70, 552
 v_mfma_f32_16x16x32_bf16 a[88:91], a[248:251], v[124:127], a[88:91]
 v_exp_f32 v53, v53
 v_mfma_f32_16x16x32_bf16 a[84:87], a[252:255], v[120:123], a[84:87]
 ds_read_b128 a[248:251], v4 offset:53248
 s_waitcnt lgkmcnt(3)
 v_add_u32 v3, 0xffff0000, v3
 v_add_u32 v6, 0x10000, v6
 v_mfma_f32_16x16x32_bf16 a[92:95], a[252:255], v[124:127], a[92:95]
 buffer_load_dword off, s[72:75], s70 lds
 v_add_u32 v7, 0x10000, v7
 v_exp_f32 v54, v54
 v_mfma_f32_16x16x32_bf16 v[32:35], a[224:227], a[112:115], v[16:19]
 ds_read_b128 a[252:255], v4 offset:55296
 v_add_u32 v4, 0xffff0000, v4
 v_add_u32 v8, 0x10000, v8
 v_mfma_f32_16x16x32_bf16 v[40:43], a[224:227], a[116:119], v[20:23]
 v_exp_f32 v55, v55
 v_mfma_f32_16x16x32_bf16 v[36:39], a[228:231], a[112:115], v[16:19]
 ds_read_b128 a[224:227], v3 offset:57344
 v_cvt_pk_bf16_f32 v48, v48, v49
 v_mfma_f32_16x16x32_bf16 v[44:47], a[228:231], a[116:119], v[20:23]
 v_exp_f32 v56, v56
 v_mfma_f32_16x16x32_bf16 v[32:35], a[232:235], a[120:123], v[32:35]
 ds_read_b128 a[228:231], v3 offset:59392
 v_add_f32 v14, v14, v50
 v_mfma_f32_16x16x32_bf16 v[40:43], a[232:235], a[124:127], v[40:43]
 v_exp_f32 v57, v57
 v_mfma_f32_16x16x32_bf16 v[36:39], a[236:239], a[120:123], v[36:39]
 ds_read_b128 a[232:235], v4 offset:57344
 s_waitcnt lgkmcnt(3)
 v_exp_f32 v58, v58
 v_mfma_f32_16x16x32_bf16 v[44:47], a[236:239], a[124:127], v[44:47]
 v_exp_f32 v59, v59
 v_mfma_f32_16x16x32_bf16 v[32:35], a[240:243], a[128:131], v[32:35]
 ds_read_b128 a[236:239], v4 offset:59392
 v_add_f32 v14, v14, v51
 v_mfma_f32_16x16x32_bf16 v[40:43], a[240:243], a[132:135], v[40:43]
 v_exp_f32 v60, v60
 v_mfma_f32_16x16x32_bf16 v[36:39], a[244:247], a[128:131], v[36:39]
 ds_read_b128 a[240:243], v3 offset:61440
 v_cvt_pk_bf16_f32 v49, v50, v51
 v_mfma_f32_16x16x32_bf16 v[44:47], a[244:247], a[132:135], v[44:47]
 v_exp_f32 v61, v61
 v_mfma_f32_16x16x32_bf16 v[32:35], a[248:251], a[136:139], v[32:35]
 ds_read_b128 a[244:247], v3 offset:63488
 v_add_f32 v14, v14, v52
 v_mfma_f32_16x16x32_bf16 v[40:43], a[248:251], a[140:143], v[40:43]
 v_exp_f32 v62, v62
 v_mfma_f32_16x16x32_bf16 v[36:39], a[252:255], a[136:139], v[36:39]
 ds_read_b128 a[248:251], v4 offset:61440
 s_waitcnt lgkmcnt(3)
 v_mfma_f32_16x16x32_bf16 v[44:47], a[252:255], a[140:143], v[44:47]
 v_exp_f32 v63, v63
 v_mfma_f32_16x16x32_bf16 v[32:35], a[224:227], a[144:147], v[32:35]
 ds_read_b128 a[252:255], v4 offset:63488
 v_add_f32 v14, v14, v53
 v_mfma_f32_16x16x32_bf16 v[40:43], a[224:227], a[148:151], v[40:43]
 v_cvt_pk_bf16_f32 v50, v52, v53
 v_add_f32 v14, v14, v54
 v_mfma_f32_16x16x32_bf16 v[36:39], a[228:231], a[144:147], v[36:39]
 ds_read_b64_tr_b16 a[224:225], v5 offset:0
 v_add_f32 v14, v14, v55
 v_mfma_f32_16x16x32_bf16 v[44:47], a[228:231], a[148:151], v[44:47]
 ds_read_b64_tr_b16 a[226:227], v5 offset:2048
 v_cvt_pk_bf16_f32 v51, v54, v55
 v_mfma_f32_16x16x32_bf16 v[32:35], a[232:235], a[152:155], v[32:35]
 ds_read_b64_tr_b16 a[228:229], v6 offset:0
 ds_read_b32 v10, v9
 v_add_f32 v15, v15, v56
 v_mfma_f32_16x16x32_bf16 v[40:43], a[232:235], a[156:159], v[40:43]
 ds_read_b64_tr_b16 a[230:231], v6 offset:2048
 v_add_f32 v15, v15, v57
 v_mfma_f32_16x16x32_bf16 v[36:39], a[236:239], a[152:155], v[36:39]
 ds_read_b64_tr_b16 a[232:233], v7 offset:0
 s_waitcnt lgkmcnt(6)
 v_cvt_pk_bf16_f32 v52, v56, v57
 v_mfma_f32_16x16x32_bf16 v[44:47], a[236:239], a[156:159], v[44:47]
 ds_read_b64_tr_b16 a[234:235], v7 offset:2048
 v_add_f32 v15, v15, v58
 v_mfma_f32_16x16x32_bf16 v[32:35], a[240:243], a[160:163], v[32:35]
 ds_read_b64_tr_b16 a[236:237], v8 offset:0
 v_add_f32 v15, v15, v59
 v_mfma_f32_16x16x32_bf16 v[40:43], a[240:243], a[164:167], v[40:43]
 ds_read_b64_tr_b16 a[238:239], v8 offset:2048
 v_cvt_pk_bf16_f32 v53, v58, v59
 v_mfma_f32_16x16x32_bf16 v[36:39], a[244:247], a[160:163], v[36:39]
 ds_read_b64_tr_b16 a[240:241], v5 offset:4096
 v_add_f32 v15, v15, v60
 v_mfma_f32_16x16x32_bf16 v[44:47], a[244:247], a[164:167], v[44:47]
 ds_read_b64_tr_b16 a[242:243], v5 offset:6144
 v_add_f32 v15, v15, v61
 v_mfma_f32_16x16x32_bf16 v[32:35], a[248:251], a[168:171], v[32:35]
 ds_read_b64_tr_b16 a[244:245], v6 offset:4096
 v_cvt_pk_bf16_f32 v54, v60, v61
 v_mfma_f32_16x16x32_bf16 v[40:43], a[248:251], a[172:175], v[40:43]
 ds_read_b64_tr_b16 a[246:247], v6 offset:6144
 v_add_f32 v15, v15, v62
 v_mfma_f32_16x16x32_bf16 v[36:39], a[252:255], a[168:171], v[36:39]
 ds_read_b64_tr_b16 a[248:249], v7 offset:4096
 v_add_f32 v15, v15, v63
 v_cvt_pk_bf16_f32 v55, v62, v63
 v_mfma_f32_16x16x32_bf16 v[44:47], a[252:255], a[172:175], v[44:47]
 ds_read_b64_tr_b16 a[250:251], v7 offset:6144
 s_waitcnt lgkmcnt(6)
 s_movk_i32 s70, 560
 v_mfma_f32_16x16x32_bf16 v[128:131], a[224:227], v[48:51], v[128:131]
 ds_read_b64_tr_b16 a[252:253], v8 offset:4096
 buffer_load_dword off, s[72:75], s70 lds
 v_cmp_le_u32 vcc, 149, v10
 v_mfma_f32_16x16x32_bf16 v[136:139], a[224:227], v[52:55], v[136:139]
 ds_read_b64_tr_b16 a[254:255], v8 offset:6144
 v_accvgpr_read_b32 v28, a64
 v_mfma_f32_16x16x32_bf16 v[132:135], a[228:231], v[48:51], v[132:135]
 s_cbranch_vccz L_cs1128
L_cb1128:
 ds_read_b64_tr_b16 a[224:225], v5 offset:8192
 v_mfma_f32_16x16x32_bf16 v[140:143], a[228:231], v[52:55], v[140:143]
 ds_read_b64_tr_b16 a[226:227], v5 offset:10240
 v_max3_f32 v11, v32, v33, v34
 v_mfma_f32_16x16x32_bf16 v[144:147], a[232:235], v[48:51], v[144:147]
 ds_read_b64_tr_b16 a[228:229], v6 offset:8192
 ds_read_b32 v10, v9
 v_mfma_f32_16x16x32_bf16 v[152:155], a[232:235], v[52:55], v[152:155]
 ds_read_b64_tr_b16 a[230:231], v6 offset:10240
 v_max3_f32 v12, v40, v41, v42
 v_mfma_f32_16x16x32_bf16 v[148:151], a[236:239], v[48:51], v[148:151]
 ds_read_b64_tr_b16 a[232:233], v7 offset:8192
 s_waitcnt lgkmcnt(6)
 v_mfma_f32_16x16x32_bf16 v[156:159], a[236:239], v[52:55], v[156:159]
 ds_read_b64_tr_b16 a[234:235], v7 offset:10240
 v_max3_f32 v11, v11, v35, v36
 v_mfma_f32_16x16x32_bf16 v[160:163], a[240:243], v[48:51], v[160:163]
 ds_read_b64_tr_b16 a[236:237], v8 offset:8192
 v_max3_f32 v12, v12, v43, v44
 v_mfma_f32_16x16x32_bf16 v[168:171], a[240:243], v[52:55], v[168:171]
 ds_read_b64_tr_b16 a[238:239], v8 offset:10240
 v_max3_f32 v11, v11, v37, v38
 v_mfma_f32_16x16x32_bf16 v[164:167], a[244:247], v[48:51], v[164:167]
 ds_read_b64_tr_b16 a[240:241], v5 offset:12288
 v_max3_f32 v12, v12, v45, v46
 v_mfma_f32_16x16x32_bf16 v[172:175], a[244:247], v[52:55], v[172:175]
 ds_read_b64_tr_b16 a[242:243], v5 offset:14336
 v_max_f32 v11, v11, v39
 v_mfma_f32_16x16x32_bf16 v[176:179], a[248:251], v[48:51], v[176:179]
 ds_read_b64_tr_b16 a[244:245], v6 offset:12288
 v_max_f32 v12, v12, v47
 v_mfma_f32_16x16x32_bf16 v[184:187], a[248:251], v[52:55], v[184:187]
 ds_read_b64_tr_b16 a[246:247], v6 offset:14336
 v_max_f32 v13, v11, v12
 v_cmp_lt_f32 vcc, 0x41200000, v13
 v_mfma_f32_16x16x32_bf16 v[180:183], a[252:255], v[48:51], v[180:183]
 ds_read_b64_tr_b16 a[248:249], v7 offset:12288
 s_waitcnt lgkmcnt(5)
 s_cbranch_vccnz L_rs1_4
L_rb1_4:
 v_mfma_f32_16x16x32_bf16 v[188:191], a[252:255], v[52:55], v[188:191]
 ds_read_b64_tr_b16 a[250:251], v7 offset:14336
 v_accvgpr_read_b32 v29, a65
 v_mfma_f32_16x16x32_bf16 v[192:195], a[224:227], v[48:51], v[192:195]
 ds_read_b64_tr_b16 a[252:253], v8 offset:12288
 v_cmp_le_u32 vcc, 151, v10
 v_mfma_f32_16x16x32_bf16 v[200:203], a[224:227], v[52:55], v[200:203]
 ds_read_b64_tr_b16 a[254:255], v8 offset:14336
 v_cvt_pk_bf16_f32 v28, v28, v29
 v_mfma_f32_16x16x32_bf16 v[196:199], a[228:231], v[48:51], v[196:199]
 s_cbranch_vccz L_cs1136
L_cb1136:
 ds_read_b64_tr_b16 a[224:225], v24 offset:0
 v_mfma_f32_16x16x32_bf16 v[204:207], a[228:231], v[52:55], v[204:207]
 ds_read_b64_tr_b16 a[226:227], v24 offset:2048
 v_accvgpr_write_b32 a0, v28
 v_mfma_f32_16x16x32_bf16 v[208:211], a[232:235], v[48:51], v[208:211]
 ds_read_b64_tr_b16 a[228:229], v25 offset:0
 v_accvgpr_read_b32 v30, a66
 v_mfma_f32_16x16x32_bf16 v[216:219], a[232:235], v[52:55], v[216:219]
 ds_read_b64_tr_b16 a[230:231], v25 offset:2048
 v_accvgpr_read_b32 v31, a67
 v_mfma_f32_16x16x32_bf16 v[212:215], a[236:239], v[48:51], v[212:215]
 ds_read_b64_tr_b16 a[232:233], v26 offset:0
 s_waitcnt lgkmcnt(5)
 v_mfma_f32_16x16x32_bf16 v[220:223], a[236:239], v[52:55], v[220:223]
 ds_read_b64_tr_b16 a[234:235], v26 offset:2048
 v_cvt_pk_bf16_f32 v30, v30, v31
 v_mfma_f32_16x16x32_bf16 v[224:227], a[240:243], v[48:51], v[224:227]
 ds_read_b64_tr_b16 a[236:237], v27 offset:0
 v_accvgpr_write_b32 a1, v30
 v_mfma_f32_16x16x32_bf16 v[232:235], a[240:243], v[52:55], v[232:235]
 ds_read_b64_tr_b16 a[238:239], v27 offset:2048
 v_accvgpr_read_b32 v28, a68
 v_mfma_f32_16x16x32_bf16 v[228:231], a[244:247], v[48:51], v[228:231]
 ds_read_b64_tr_b16 a[240:241], v24 offset:4096
 v_add_u32 v3, 0x20000, v3
 v_mfma_f32_16x16x32_bf16 v[236:239], a[244:247], v[52:55], v[236:239]
 ds_read_b64_tr_b16 a[242:243], v24 offset:6144
 s_movk_i32 s70, 568
 v_mfma_f32_16x16x32_bf16 v[240:243], a[248:251], v[48:51], v[240:243]
 ds_read_b64_tr_b16 a[244:245], v25 offset:4096
 v_accvgpr_read_b32 v29, a69
 v_mfma_f32_16x16x32_bf16 v[248:251], a[248:251], v[52:55], v[248:251]
 ds_read_b64_tr_b16 a[246:247], v25 offset:6144
 v_cvt_pk_bf16_f32 v28, v28, v29
 v_mfma_f32_16x16x32_bf16 v[244:247], a[252:255], v[48:51], v[244:247]
 ds_read_b64_tr_b16 a[248:249], v26 offset:4096
 s_waitcnt lgkmcnt(5)
 v_mfma_f32_16x16x32_bf16 v[252:255], a[252:255], v[52:55], v[252:255]
 ds_read_b64_tr_b16 a[250:251], v26 offset:6144
 v_add_u32 v4, 0x20000, v4
 v_mfma_f32_16x16x32_bf16 a[176:179], a[224:227], v[64:67], 0
 ds_read_b64_tr_b16 a[252:253], v27 offset:4096
 buffer_load_dword off, s[72:75], s70 lds
 v_accvgpr_write_b32 a2, v28
 v_mfma_f32_16x16x32_bf16 a[184:187], a[224:227], v[68:71], 0
 ds_read_b64_tr_b16 a[254:255], v27 offset:6144
 v_accvgpr_read_b32 v30, a70
 v_mfma_f32_16x16x32_bf16 a[180:183], a[228:231], v[64:67], 0
 ds_read_b64_tr_b16 a[224:225], v24 offset:8192
 v_accvgpr_read_b32 v31, a71
 v_mfma_f32_16x16x32_bf16 a[188:191], a[228:231], v[68:71], 0
 ds_read_b64_tr_b16 a[226:227], v24 offset:10240
 v_cvt_pk_bf16_f32 v30, v30, v31
 v_mfma_f32_16x16x32_bf16 a[192:195], a[232:235], v[64:67], 0
 ds_read_b64_tr_b16 a[228:229], v25 offset:8192
 ds_read_b32 v10, v9
 v_mfma_f32_16x16x32_bf16 a[200:203], a[232:235], v[68:71], 0
 ds_read_b64_tr_b16 a[230:231], v25 offset:10240
 v_accvgpr_write_b32 a3, v30
 v_mfma_f32_16x16x32_bf16 a[196:199], a[236:239], v[64:67], 0
 ds_read_b64_tr_b16 a[232:233], v26 offset:8192
 s_waitcnt lgkmcnt(6)
 v_mfma_f32_16x16x32_bf16 a[204:207], a[236:239], v[68:71], 0
 ds_read_b64_tr_b16 a[234:235], v26 offset:10240
 v_accvgpr_read_b32 v28, a72
 v_mfma_f32_16x16x32_bf16 a[176:179], a[240:243], v[72:75], a[176:179]
 ds_read_b64_tr_b16 a[236:237], v27 offset:8192
 v_accvgpr_read_b32 v29, a73
 v_mfma_f32_16x16x32_bf16 a[184:187], a[240:243], v[76:79], a[184:187]
 ds_read_b64_tr_b16 a[238:239], v27 offset:10240
 v_cvt_pk_bf16_f32 v28, v28, v29
 v_mfma_f32_16x16x32_bf16 a[180:183], a[244:247], v[72:75], a[180:183]
 ds_read_b64_tr_b16 a[240:241], v24 offset:12288
 v_accvgpr_write_b32 a4, v28
 v_mfma_f32_16x16x32_bf16 a[188:191], a[244:247], v[76:79], a[188:191]
 ds_read_b64_tr_b16 a[242:243], v24 offset:14336
 v_accvgpr_read_b32 v30, a74
 v_mfma_f32_16x16x32_bf16 a[192:195], a[248:251], v[72:75], a[192:195]
 ds_read_b64_tr_b16 a[244:245], v25 offset:12288
 v_accvgpr_read_b32 v31, a75
 v_mfma_f32_16x16x32_bf16 a[200:203], a[248:251], v[76:79], a[200:203]
 ds_read_b64_tr_b16 a[246:247], v25 offset:14336
 v_cvt_pk_bf16_f32 v30, v30, v31
 v_mfma_f32_16x16x32_bf16 a[196:199], a[252:255], v[72:75], a[196:199]
 ds_read_b64_tr_b16 a[248:249], v26 offset:12288
 s_waitcnt lgkmcnt(5)
 v_mfma_f32_16x16x32_bf16 a[204:207], a[252:255], v[76:79], a[204:207]
 ds_read_b64_tr_b16 a[250:251], v26 offset:14336
 v_accvgpr_write_b32 a5, v30
 v_mfma_f32_16x16x32_bf16 a[176:179], a[224:227], v[80:83], a[176:179]
 ds_read_b64_tr_b16 a[252:253], v27 offset:12288
 v_cmp_le_u32 vcc, 154, v10
 v_mfma_f32_16x16x32_bf16 a[184:187], a[224:227], v[84:87], a[184:187]
 ds_read_b64_tr_b16 a[254:255], v27 offset:14336
 v_accvgpr_read_b32 v28, a76
 v_mfma_f32_16x16x32_bf16 a[180:183], a[228:231], v[80:83], a[180:183]
 s_cbranch_vccz L_cs1152
L_cb1152:
 ds_read_b128 a[224:227], v3 offset:16384
 v_mfma_f32_16x16x32_bf16 a[188:191], a[228:231], v[84:87], a[188:191]
 v_exp_f32 v32, v32
 v_mfma_f32_16x16x32_bf16 a[192:195], a[232:235], v[80:83], a[192:195]
 ds_read_b128 a[228:231], v3 offset:18432
 v_add_f32 v14, v14, v32
 v_mfma_f32_16x16x32_bf16 a[200:203], a[232:235], v[84:87], a[200:203]
 v_exp_f32 v33, v33
 v_mfma_f32_16x16x32_bf16 a[196:199], a[236:239], v[80:83], a[196:199]
 ds_read_b128 a[232:235], v4 offset:16384
 s_waitcnt lgkmcnt(3)
 v_mfma_f32_16x16x32_bf16 a[204:207], a[236:239], v[84:87], a[204:207]
 v_exp_f32 v34, v34
 v_mfma_f32_16x16x32_bf16 a[176:179], a[240:243], v[88:91], a[176:179]
 ds_read_b128 a[236:239], v4 offset:18432
 v_add_f32 v14, v14, v33
 v_mfma_f32_16x16x32_bf16 a[184:187], a[240:243], v[92:95], a[184:187]
 v_exp_f32 v35, v35
 v_mfma_f32_16x16x32_bf16 a[180:183], a[244:247], v[88:91], a[180:183]
 ds_read_b128 a[240:243], v3 offset:20480
 v_add_u32 v5, 0xffff0000, v5
 v_mfma_f32_16x16x32_bf16 a[188:191], a[244:247], v[92:95], a[188:191]
 v_exp_f32 v36, v36
 v_mfma_f32_16x16x32_bf16 a[192:195], a[248:251], v[88:91], a[192:195]
 ds_read_b128 a[244:247], v3 offset:22528
 s_movk_i32 s70, 576
 v_mfma_f32_16x16x32_bf16 a[200:203], a[248:251], v[92:95], a[200:203]
 v_exp_f32 v37, v37
 v_mfma_f32_16x16x32_bf16 a[196:199], a[252:255], v[88:91], a[196:199]
 ds_read_b128 a[248:251], v4 offset:20480
 s_waitcnt lgkmcnt(3)
 v_add_u32 v3, 0xffff0000, v3
 v_add_u32 v6, 0xffff0000, v6
 v_mfma_f32_16x16x32_bf16 a[204:207], a[252:255], v[92:95], a[204:207]
 buffer_load_dword off, s[72:75], s70 lds
 v_add_u32 v7, 0xffff0000, v7
 v_exp_f32 v38, v38
 v_mfma_f32_16x16x32_bf16 v[48:51], a[224:227], a[112:115], v[16:19]
 ds_read_b128 a[252:255], v4 offset:22528
 v_add_u32 v4, 0xffff0000, v4
 v_add_u32 v8, 0xffff0000, v8
 v_mfma_f32_16x16x32_bf16 v[56:59], a[224:227], a[116:119], v[20:23]
 v_exp_f32 v39, v39
 v_mfma_f32_16x16x32_bf16 v[52:55], a[228:231], a[112:115], v[16:19]
 ds_read_b128 a[224:227], v3 offset:57344
 v_cvt_pk_bf16_f32 v32, v32, v33
 v_mfma_f32_16x16x32_bf16 v[60:63], a[228:231], a[116:119], v[20:23]
 v_exp_f32 v40, v40
 v_mfma_f32_16x16x32_bf16 v[48:51], a[232:235], a[120:123], v[48:51]
 ds_read_b128 a[228:231], v3 offset:59392
 v_add_f32 v14, v14, v34
 v_mfma_f32_16x16x32_bf16 v[56:59], a[232:235], a[124:127], v[56:59]
 v_exp_f32 v41, v41
 v_mfma_f32_16x16x32_bf16 v[52:55], a[236:239], a[120:123], v[52:55]
 ds_read_b128 a[232:235], v4 offset:57344
 s_waitcnt lgkmcnt(3)
 v_exp_f32 v42, v42
 v_mfma_f32_16x16x32_bf16 v[60:63], a[236:239], a[124:127], v[60:63]
 v_exp_f32 v43, v43
 v_mfma_f32_16x16x32_bf16 v[48:51], a[240:243], a[128:131], v[48:51]
 ds_read_b128 a[236:239], v4 offset:59392
 v_add_f32 v14, v14, v35
 v_mfma_f32_16x16x32_bf16 v[56:59], a[240:243], a[132:135], v[56:59]
 v_exp_f32 v44, v44
 v_mfma_f32_16x16x32_bf16 v[52:55], a[244:247], a[128:131], v[52:55]
 ds_read_b128 a[240:243], v3 offset:61440
 v_cvt_pk_bf16_f32 v33, v34, v35
 v_mfma_f32_16x16x32_bf16 v[60:63], a[244:247], a[132:135], v[60:63]
 v_exp_f32 v45, v45
 v_mfma_f32_16x16x32_bf16 v[48:51], a[248:251], a[136:139], v[48:51]
 ds_read_b128 a[244:247], v3 offset:63488
 v_add_f32 v14, v14, v36
 v_mfma_f32_16x16x32_bf16 v[56:59], a[248:251], a[140:143], v[56:59]
 v_exp_f32 v46, v46
 v_mfma_f32_16x16x32_bf16 v[52:55], a[252:255], a[136:139], v[52:55]
 ds_read_b128 a[248:251], v4 offset:61440
 s_waitcnt lgkmcnt(3)
 v_mfma_f32_16x16x32_bf16 v[60:63], a[252:255], a[140:143], v[60:63]
 v_exp_f32 v47, v47
 v_mfma_f32_16x16x32_bf16 v[48:51], a[224:227], a[144:147], v[48:51]
 ds_read_b128 a[252:255], v4 offset:63488
 v_add_f32 v14, v14, v37
 v_mfma_f32_16x16x32_bf16 v[56:59], a[224:227], a[148:151], v[56:59]
 v_cvt_pk_bf16_f32 v34, v36, v37
 v_add_f32 v14, v14, v38
 v_mfma_f32_16x16x32_bf16 v[52:55], a[228:231], a[144:147], v[52:55]
 ds_read_b64_tr_b16 a[224:225], v5 offset:0
 v_add_f32 v14, v14, v39
 v_mfma_f32_16x16x32_bf16 v[60:63], a[228:231], a[148:151], v[60:63]
 ds_read_b64_tr_b16 a[226:227], v5 offset:2048
 v_cvt_pk_bf16_f32 v35, v38, v39
 v_mfma_f32_16x16x32_bf16 v[48:51], a[232:235], a[152:155], v[48:51]
 ds_read_b64_tr_b16 a[228:229], v6 offset:0
 ds_read_b32 v10, v9
 v_add_f32 v15, v15, v40
 v_mfma_f32_16x16x32_bf16 v[56:59], a[232:235], a[156:159], v[56:59]
 ds_read_b64_tr_b16 a[230:231], v6 offset:2048
 v_add_f32 v15, v15, v41
 v_mfma_f32_16x16x32_bf16 v[52:55], a[236:239], a[152:155], v[52:55]
 ds_read_b64_tr_b16 a[232:233], v7 offset:0
 s_waitcnt lgkmcnt(6)
 v_cvt_pk_bf16_f32 v36, v40, v41
 v_mfma_f32_16x16x32_bf16 v[60:63], a[236:239], a[156:159], v[60:63]
 ds_read_b64_tr_b16 a[234:235], v7 offset:2048
 v_add_f32 v15, v15, v42
 v_mfma_f32_16x16x32_bf16 v[48:51], a[240:243], a[160:163], v[48:51]
 ds_read_b64_tr_b16 a[236:237], v8 offset:0
 v_add_f32 v15, v15, v43
 v_mfma_f32_16x16x32_bf16 v[56:59], a[240:243], a[164:167], v[56:59]
 ds_read_b64_tr_b16 a[238:239], v8 offset:2048
 v_cvt_pk_bf16_f32 v37, v42, v43
 v_mfma_f32_16x16x32_bf16 v[52:55], a[244:247], a[160:163], v[52:55]
 ds_read_b64_tr_b16 a[240:241], v5 offset:4096
 v_add_f32 v15, v15, v44
 v_mfma_f32_16x16x32_bf16 v[60:63], a[244:247], a[164:167], v[60:63]
 ds_read_b64_tr_b16 a[242:243], v5 offset:6144
 v_add_f32 v15, v15, v45
 v_mfma_f32_16x16x32_bf16 v[48:51], a[248:251], a[168:171], v[48:51]
 ds_read_b64_tr_b16 a[244:245], v6 offset:4096
 v_cvt_pk_bf16_f32 v38, v44, v45
 v_mfma_f32_16x16x32_bf16 v[56:59], a[248:251], a[172:175], v[56:59]
 ds_read_b64_tr_b16 a[246:247], v6 offset:6144
 v_add_f32 v15, v15, v46
 v_mfma_f32_16x16x32_bf16 v[52:55], a[252:255], a[168:171], v[52:55]
 ds_read_b64_tr_b16 a[248:249], v7 offset:4096
 v_add_f32 v15, v15, v47
 v_cvt_pk_bf16_f32 v39, v46, v47
 v_mfma_f32_16x16x32_bf16 v[60:63], a[252:255], a[172:175], v[60:63]
 ds_read_b64_tr_b16 a[250:251], v7 offset:6144
 s_waitcnt lgkmcnt(6)
 s_movk_i32 s70, 584
 v_mfma_f32_16x16x32_bf16 v[128:131], a[224:227], v[32:35], v[128:131]
 ds_read_b64_tr_b16 a[252:253], v8 offset:4096
 buffer_load_dword off, s[72:75], s70 lds
 v_cmp_le_u32 vcc, 155, v10
 v_mfma_f32_16x16x32_bf16 v[136:139], a[224:227], v[36:39], v[136:139]
 ds_read_b64_tr_b16 a[254:255], v8 offset:6144
 v_accvgpr_read_b32 v29, a77
 v_mfma_f32_16x16x32_bf16 v[132:135], a[228:231], v[32:35], v[132:135]
 s_cbranch_vccz L_cs1176
L_cb1176:
 ds_read_b64_tr_b16 a[224:225], v5 offset:16384
 v_mfma_f32_16x16x32_bf16 v[140:143], a[228:231], v[36:39], v[140:143]
 ds_read_b64_tr_b16 a[226:227], v5 offset:18432
 v_max3_f32 v11, v48, v49, v50
 v_mfma_f32_16x16x32_bf16 v[144:147], a[232:235], v[32:35], v[144:147]
 ds_read_b64_tr_b16 a[228:229], v6 offset:16384
 ds_read_b32 v10, v9
 v_mfma_f32_16x16x32_bf16 v[152:155], a[232:235], v[36:39], v[152:155]
 ds_read_b64_tr_b16 a[230:231], v6 offset:18432
 v_max3_f32 v12, v56, v57, v58
 v_mfma_f32_16x16x32_bf16 v[148:151], a[236:239], v[32:35], v[148:151]
 ds_read_b64_tr_b16 a[232:233], v7 offset:16384
 s_waitcnt lgkmcnt(6)
 v_mfma_f32_16x16x32_bf16 v[156:159], a[236:239], v[36:39], v[156:159]
 ds_read_b64_tr_b16 a[234:235], v7 offset:18432
 v_max3_f32 v11, v11, v51, v52
 v_mfma_f32_16x16x32_bf16 v[160:163], a[240:243], v[32:35], v[160:163]
 ds_read_b64_tr_b16 a[236:237], v8 offset:16384
 v_max3_f32 v12, v12, v59, v60
 v_mfma_f32_16x16x32_bf16 v[168:171], a[240:243], v[36:39], v[168:171]
 ds_read_b64_tr_b16 a[238:239], v8 offset:18432
 v_max3_f32 v11, v11, v53, v54
 v_mfma_f32_16x16x32_bf16 v[164:167], a[244:247], v[32:35], v[164:167]
 ds_read_b64_tr_b16 a[240:241], v5 offset:20480
 v_max3_f32 v12, v12, v61, v62
 v_mfma_f32_16x16x32_bf16 v[172:175], a[244:247], v[36:39], v[172:175]
 ds_read_b64_tr_b16 a[242:243], v5 offset:22528
 v_max_f32 v11, v11, v55
 v_mfma_f32_16x16x32_bf16 v[176:179], a[248:251], v[32:35], v[176:179]
 ds_read_b64_tr_b16 a[244:245], v6 offset:20480
 v_max_f32 v12, v12, v63
 v_mfma_f32_16x16x32_bf16 v[184:187], a[248:251], v[36:39], v[184:187]
 ds_read_b64_tr_b16 a[246:247], v6 offset:22528
 v_max_f32 v13, v11, v12
 v_cmp_lt_f32 vcc, 0x41200000, v13
 v_mfma_f32_16x16x32_bf16 v[180:183], a[252:255], v[32:35], v[180:183]
 ds_read_b64_tr_b16 a[248:249], v7 offset:20480
 s_waitcnt lgkmcnt(5)
 s_cbranch_vccnz L_rs1_5
L_rb1_5:
 v_mfma_f32_16x16x32_bf16 v[188:191], a[252:255], v[36:39], v[188:191]
 ds_read_b64_tr_b16 a[250:251], v7 offset:22528
 v_cvt_pk_bf16_f32 v28, v28, v29
 v_mfma_f32_16x16x32_bf16 v[192:195], a[224:227], v[32:35], v[192:195]
 ds_read_b64_tr_b16 a[252:253], v8 offset:20480
 v_cmp_le_u32 vcc, 157, v10
 v_mfma_f32_16x16x32_bf16 v[200:203], a[224:227], v[36:39], v[200:203]
 ds_read_b64_tr_b16 a[254:255], v8 offset:22528
 v_accvgpr_write_b32 a6, v28
 v_mfma_f32_16x16x32_bf16 v[196:199], a[228:231], v[32:35], v[196:199]
 s_cbranch_vccz L_cs1184
L_cb1184:
 ds_read_b64_tr_b16 a[224:225], v24 offset:16384
 v_mfma_f32_16x16x32_bf16 v[204:207], a[228:231], v[36:39], v[204:207]
 ds_read_b64_tr_b16 a[226:227], v24 offset:18432
 v_accvgpr_read_b32 v30, a78
 v_mfma_f32_16x16x32_bf16 v[208:211], a[232:235], v[32:35], v[208:211]
 ds_read_b64_tr_b16 a[228:229], v25 offset:16384
 v_accvgpr_read_b32 v31, a79
 v_mfma_f32_16x16x32_bf16 v[216:219], a[232:235], v[36:39], v[216:219]
 ds_read_b64_tr_b16 a[230:231], v25 offset:18432
 v_cvt_pk_bf16_f32 v30, v30, v31
 v_mfma_f32_16x16x32_bf16 v[212:215], a[236:239], v[32:35], v[212:215]
 ds_read_b64_tr_b16 a[232:233], v26 offset:16384
 s_waitcnt lgkmcnt(5)
 v_mfma_f32_16x16x32_bf16 v[220:223], a[236:239], v[36:39], v[220:223]
 ds_read_b64_tr_b16 a[234:235], v26 offset:18432
 v_accvgpr_write_b32 a7, v30
 v_mfma_f32_16x16x32_bf16 v[224:227], a[240:243], v[32:35], v[224:227]
 ds_read_b64_tr_b16 a[236:237], v27 offset:16384
 v_accvgpr_read_b32 v28, a80
 v_mfma_f32_16x16x32_bf16 v[232:235], a[240:243], v[36:39], v[232:235]
 ds_read_b64_tr_b16 a[238:239], v27 offset:18432
 v_accvgpr_read_b32 v29, a81
 v_mfma_f32_16x16x32_bf16 v[228:231], a[244:247], v[32:35], v[228:231]
 ds_read_b64_tr_b16 a[240:241], v24 offset:20480
 v_cvt_pk_bf16_f32 v28, v28, v29
 v_mfma_f32_16x16x32_bf16 v[236:239], a[244:247], v[36:39], v[236:239]
 ds_read_b64_tr_b16 a[242:243], v24 offset:22528
 s_movk_i32 s70, 592
 v_mfma_f32_16x16x32_bf16 v[240:243], a[248:251], v[32:35], v[240:243]
 ds_read_b64_tr_b16 a[244:245], v25 offset:20480
 v_accvgpr_write_b32 a8, v28
 v_mfma_f32_16x16x32_bf16 v[248:251], a[248:251], v[36:39], v[248:251]
 ds_read_b64_tr_b16 a[246:247], v25 offset:22528
 v_accvgpr_read_b32 v30, a82
 v_mfma_f32_16x16x32_bf16 v[244:247], a[252:255], v[32:35], v[244:247]
 ds_read_b64_tr_b16 a[248:249], v26 offset:20480
 s_waitcnt lgkmcnt(5)
 v_mfma_f32_16x16x32_bf16 v[252:255], a[252:255], v[36:39], v[252:255]
 ds_read_b64_tr_b16 a[250:251], v26 offset:22528
 v_accvgpr_read_b32 v31, a83
 v_mfma_f32_16x16x32_bf16 a[176:179], a[224:227], v[96:99], a[176:179]
 ds_read_b64_tr_b16 a[252:253], v27 offset:20480
 buffer_load_dword off, s[72:75], s70 lds
 v_cvt_pk_bf16_f32 v30, v30, v31
 v_mfma_f32_16x16x32_bf16 a[184:187], a[224:227], v[100:103], a[184:187]
 ds_read_b64_tr_b16 a[254:255], v27 offset:22528
 v_accvgpr_write_b32 a9, v30
 v_mfma_f32_16x16x32_bf16 a[180:183], a[228:231], v[96:99], a[180:183]
 ds_read_b64_tr_b16 a[224:225], v24 offset:24576
 v_accvgpr_read_b32 v28, a84
 v_mfma_f32_16x16x32_bf16 a[188:191], a[228:231], v[100:103], a[188:191]
 ds_read_b64_tr_b16 a[226:227], v24 offset:26624
 v_accvgpr_read_b32 v29, a85
 v_mfma_f32_16x16x32_bf16 a[192:195], a[232:235], v[96:99], a[192:195]
 ds_read_b64_tr_b16 a[228:229], v25 offset:24576
 ds_read_b32 v10, v9
 v_mfma_f32_16x16x32_bf16 a[200:203], a[232:235], v[100:103], a[200:203]
 ds_read_b64_tr_b16 a[230:231], v25 offset:26624
 v_cvt_pk_bf16_f32 v28, v28, v29
 v_mfma_f32_16x16x32_bf16 a[196:199], a[236:239], v[96:99], a[196:199]
 ds_read_b64_tr_b16 a[232:233], v26 offset:24576
 s_waitcnt lgkmcnt(6)
 v_mfma_f32_16x16x32_bf16 a[204:207], a[236:239], v[100:103], a[204:207]
 ds_read_b64_tr_b16 a[234:235], v26 offset:26624
 v_accvgpr_write_b32 a10, v28
 v_mfma_f32_16x16x32_bf16 a[176:179], a[240:243], v[104:107], a[176:179]
 ds_read_b64_tr_b16 a[236:237], v27 offset:24576
 v_accvgpr_read_b32 v30, a86
 v_mfma_f32_16x16x32_bf16 a[184:187], a[240:243], v[108:111], a[184:187]
 ds_read_b64_tr_b16 a[238:239], v27 offset:26624
 v_accvgpr_read_b32 v31, a87
 v_mfma_f32_16x16x32_bf16 a[180:183], a[244:247], v[104:107], a[180:183]
 ds_read_b64_tr_b16 a[240:241], v24 offset:28672
 v_cvt_pk_bf16_f32 v30, v30, v31
 v_mfma_f32_16x16x32_bf16 a[188:191], a[244:247], v[108:111], a[188:191]
 ds_read_b64_tr_b16 a[242:243], v24 offset:30720
 v_accvgpr_write_b32 a11, v30
 v_mfma_f32_16x16x32_bf16 a[192:195], a[248:251], v[104:107], a[192:195]
 ds_read_b64_tr_b16 a[244:245], v25 offset:28672
 v_accvgpr_read_b32 v28, a88
 v_mfma_f32_16x16x32_bf16 a[200:203], a[248:251], v[108:111], a[200:203]
 ds_read_b64_tr_b16 a[246:247], v25 offset:30720
 v_accvgpr_read_b32 v29, a89
 v_mfma_f32_16x16x32_bf16 a[196:199], a[252:255], v[104:107], a[196:199]
 ds_read_b64_tr_b16 a[248:249], v26 offset:28672
 s_waitcnt lgkmcnt(5)
 v_mfma_f32_16x16x32_bf16 a[204:207], a[252:255], v[108:111], a[204:207]
 ds_read_b64_tr_b16 a[250:251], v26 offset:30720
 v_cvt_pk_bf16_f32 v28, v28, v29
 v_mfma_f32_16x16x32_bf16 a[176:179], a[224:227], v[112:115], a[176:179]
 ds_read_b64_tr_b16 a[252:253], v27 offset:28672
 v_cmp_le_u32 vcc, 160, v10
 v_mfma_f32_16x16x32_bf16 a[184:187], a[224:227], v[116:119], a[184:187]
 ds_read_b64_tr_b16 a[254:255], v27 offset:30720
 v_accvgpr_write_b32 a12, v28
 v_mfma_f32_16x16x32_bf16 a[180:183], a[228:231], v[112:115], a[180:183]
 s_cbranch_vccz L_cs1200
L_cb1200:
 ds_read_b128 a[224:227], v3 offset:24576
 v_mfma_f32_16x16x32_bf16 a[188:191], a[228:231], v[116:119], a[188:191]
 v_exp_f32 v48, v48
 v_mfma_f32_16x16x32_bf16 a[192:195], a[232:235], v[112:115], a[192:195]
 ds_read_b128 a[228:231], v3 offset:26624
 v_add_f32 v14, v14, v48
 v_mfma_f32_16x16x32_bf16 a[200:203], a[232:235], v[116:119], a[200:203]
 v_exp_f32 v49, v49
 v_mfma_f32_16x16x32_bf16 a[196:199], a[236:239], v[112:115], a[196:199]
 ds_read_b128 a[232:235], v4 offset:24576
 s_waitcnt lgkmcnt(3)
 v_mfma_f32_16x16x32_bf16 a[204:207], a[236:239], v[116:119], a[204:207]
 v_exp_f32 v50, v50
 v_mfma_f32_16x16x32_bf16 a[176:179], a[240:243], v[120:123], a[176:179]
 ds_read_b128 a[236:239], v4 offset:26624
 v_add_f32 v14, v14, v49
 v_mfma_f32_16x16x32_bf16 a[184:187], a[240:243], v[124:127], a[184:187]
 v_exp_f32 v51, v51
 v_mfma_f32_16x16x32_bf16 a[180:183], a[244:247], v[120:123], a[180:183]
 ds_read_b128 a[240:243], v3 offset:28672
 v_add_u32 v5, 0xffff0000, v5
 v_mfma_f32_16x16x32_bf16 a[188:191], a[244:247], v[124:127], a[188:191]
 v_exp_f32 v52, v52
 v_mfma_f32_16x16x32_bf16 a[192:195], a[248:251], v[120:123], a[192:195]
 ds_read_b128 a[244:247], v3 offset:30720
 s_movk_i32 s70, 600
 v_mfma_f32_16x16x32_bf16 a[200:203], a[248:251], v[124:127], a[200:203]
 v_exp_f32 v53, v53
 v_mfma_f32_16x16x32_bf16 a[196:199], a[252:255], v[120:123], a[196:199]
 ds_read_b128 a[248:251], v4 offset:28672
 s_waitcnt lgkmcnt(3)
 v_add_u32 v6, 0xffff0000, v6
 v_mfma_f32_16x16x32_bf16 a[204:207], a[252:255], v[124:127], a[204:207]
 buffer_load_dword off, s[72:75], s70 lds
 v_add_u32 v7, 0xffff0000, v7
 v_exp_f32 v54, v54
 v_mfma_f32_16x16x32_bf16 v[32:35], a[224:227], a[112:115], v[16:19]
 ds_read_b128 a[252:255], v4 offset:30720
 v_add_u32 v8, 0xffff0000, v8
 v_mfma_f32_16x16x32_bf16 v[40:43], a[224:227], a[116:119], v[20:23]
 v_exp_f32 v55, v55
 v_mfma_f32_16x16x32_bf16 v[36:39], a[228:231], a[112:115], v[16:19]
 ds_read_b128 a[224:227], v3 offset:8192
 v_cvt_pk_bf16_f32 v48, v48, v49
 v_mfma_f32_16x16x32_bf16 v[44:47], a[228:231], a[116:119], v[20:23]
 v_exp_f32 v56, v56
 v_mfma_f32_16x16x32_bf16 v[32:35], a[232:235], a[120:123], v[32:35]
 ds_read_b128 a[228:231], v3 offset:10240
 v_add_f32 v14, v14, v50
 v_mfma_f32_16x16x32_bf16 v[40:43], a[232:235], a[124:127], v[40:43]
 v_exp_f32 v57, v57
 v_mfma_f32_16x16x32_bf16 v[36:39], a[236:239], a[120:123], v[36:39]
 ds_read_b128 a[232:235], v4 offset:8192
 s_waitcnt lgkmcnt(3)
 v_exp_f32 v58, v58
 v_mfma_f32_16x16x32_bf16 v[44:47], a[236:239], a[124:127], v[44:47]
 v_exp_f32 v59, v59
 v_mfma_f32_16x16x32_bf16 v[32:35], a[240:243], a[128:131], v[32:35]
 ds_read_b128 a[236:239], v4 offset:10240
 v_add_f32 v14, v14, v51
 v_mfma_f32_16x16x32_bf16 v[40:43], a[240:243], a[132:135], v[40:43]
 v_exp_f32 v60, v60
 v_mfma_f32_16x16x32_bf16 v[36:39], a[244:247], a[128:131], v[36:39]
 ds_read_b128 a[240:243], v3 offset:12288
 v_cvt_pk_bf16_f32 v49, v50, v51
 v_mfma_f32_16x16x32_bf16 v[44:47], a[244:247], a[132:135], v[44:47]
 v_exp_f32 v61, v61
 v_mfma_f32_16x16x32_bf16 v[32:35], a[248:251], a[136:139], v[32:35]
 ds_read_b128 a[244:247], v3 offset:14336
 v_add_f32 v14, v14, v52
 v_mfma_f32_16x16x32_bf16 v[40:43], a[248:251], a[140:143], v[40:43]
 v_exp_f32 v62, v62
 v_mfma_f32_16x16x32_bf16 v[36:39], a[252:255], a[136:139], v[36:39]
 ds_read_b128 a[248:251], v4 offset:12288
 s_waitcnt lgkmcnt(3)
 v_mfma_f32_16x16x32_bf16 v[44:47], a[252:255], a[140:143], v[44:47]
 v_exp_f32 v63, v63
 v_mfma_f32_16x16x32_bf16 v[32:35], a[224:227], a[144:147], v[32:35]
 ds_read_b128 a[252:255], v4 offset:14336
 v_add_f32 v14, v14, v53
 v_mfma_f32_16x16x32_bf16 v[40:43], a[224:227], a[148:151], v[40:43]
 v_cvt_pk_bf16_f32 v50, v52, v53
 v_add_f32 v14, v14, v54
 v_mfma_f32_16x16x32_bf16 v[36:39], a[228:231], a[144:147], v[36:39]
 ds_read_b64_tr_b16 a[224:225], v5 offset:49152
 v_add_f32 v14, v14, v55
 v_mfma_f32_16x16x32_bf16 v[44:47], a[228:231], a[148:151], v[44:47]
 ds_read_b64_tr_b16 a[226:227], v5 offset:51200
 v_cvt_pk_bf16_f32 v51, v54, v55
 v_mfma_f32_16x16x32_bf16 v[32:35], a[232:235], a[152:155], v[32:35]
 ds_read_b64_tr_b16 a[228:229], v6 offset:49152
 ds_read_b32 v10, v9
 v_add_f32 v15, v15, v56
 v_mfma_f32_16x16x32_bf16 v[40:43], a[232:235], a[156:159], v[40:43]
 ds_read_b64_tr_b16 a[230:231], v6 offset:51200
 v_add_f32 v15, v15, v57
 v_mfma_f32_16x16x32_bf16 v[36:39], a[236:239], a[152:155], v[36:39]
 ds_read_b64_tr_b16 a[232:233], v7 offset:49152
 s_waitcnt lgkmcnt(6)
 v_cvt_pk_bf16_f32 v52, v56, v57
 v_mfma_f32_16x16x32_bf16 v[44:47], a[236:239], a[156:159], v[44:47]
 ds_read_b64_tr_b16 a[234:235], v7 offset:51200
 v_add_f32 v15, v15, v58
 v_mfma_f32_16x16x32_bf16 v[32:35], a[240:243], a[160:163], v[32:35]
 ds_read_b64_tr_b16 a[236:237], v8 offset:49152
 v_add_f32 v15, v15, v59
 v_mfma_f32_16x16x32_bf16 v[40:43], a[240:243], a[164:167], v[40:43]
 ds_read_b64_tr_b16 a[238:239], v8 offset:51200
 v_cvt_pk_bf16_f32 v53, v58, v59
 v_mfma_f32_16x16x32_bf16 v[36:39], a[244:247], a[160:163], v[36:39]
 ds_read_b64_tr_b16 a[240:241], v5 offset:53248
 v_add_f32 v15, v15, v60
 v_mfma_f32_16x16x32_bf16 v[44:47], a[244:247], a[164:167], v[44:47]
 ds_read_b64_tr_b16 a[242:243], v5 offset:55296
 v_add_f32 v15, v15, v61
 v_mfma_f32_16x16x32_bf16 v[32:35], a[248:251], a[168:171], v[32:35]
 ds_read_b64_tr_b16 a[244:245], v6 offset:53248
 v_cvt_pk_bf16_f32 v54, v60, v61
 v_mfma_f32_16x16x32_bf16 v[40:43], a[248:251], a[172:175], v[40:43]
 ds_read_b64_tr_b16 a[246:247], v6 offset:55296
 v_add_f32 v15, v15, v62
 v_mfma_f32_16x16x32_bf16 v[36:39], a[252:255], a[168:171], v[36:39]
 ds_read_b64_tr_b16 a[248:249], v7 offset:53248
 v_add_f32 v15, v15, v63
 v_cvt_pk_bf16_f32 v55, v62, v63
 v_mfma_f32_16x16x32_bf16 v[44:47], a[252:255], a[172:175], v[44:47]
 ds_read_b64_tr_b16 a[250:251], v7 offset:55296
 s_waitcnt lgkmcnt(6)
 s_movk_i32 s70, 608
 buffer_load_dword off, s[72:75], s70 lds
 v_mfma_f32_16x16x32_bf16 v[128:131], a[224:227], v[48:51], v[128:131]
 ds_read_b64_tr_b16 a[252:253], v8 offset:53248
 v_cmp_le_u32 vcc, 161, v10
 v_mfma_f32_16x16x32_bf16 v[136:139], a[224:227], v[52:55], v[136:139]
 ds_read_b64_tr_b16 a[254:255], v8 offset:55296
 v_add_u32 v5, 0x10000, v5
 v_mfma_f32_16x16x32_bf16 v[132:135], a[228:231], v[48:51], v[132:135]
 s_cbranch_vccz L_cs1224
L_cb1224:
 ds_read_b64_tr_b16 a[224:225], v5 offset:32768
 v_add_u32 v6, 0x10000, v6
 v_mfma_f32_16x16x32_bf16 v[140:143], a[228:231], v[52:55], v[140:143]
 ds_read_b64_tr_b16 a[226:227], v5 offset:34816
 v_add_u32 v7, 0x10000, v7
 v_mfma_f32_16x16x32_bf16 v[144:147], a[232:235], v[48:51], v[144:147]
 ds_read_b64_tr_b16 a[228:229], v6 offset:32768
 ds_read_b32 v10, v9
 v_add_u32 v8, 0x10000, v8
 v_mfma_f32_16x16x32_bf16 v[152:155], a[232:235], v[52:55], v[152:155]
 ds_read_b64_tr_b16 a[230:231], v6 offset:34816
 v_max3_f32 v11, v32, v33, v34
 v_mfma_f32_16x16x32_bf16 v[148:151], a[236:239], v[48:51], v[148:151]
 ds_read_b64_tr_b16 a[232:233], v7 offset:32768
 s_waitcnt lgkmcnt(6)
 v_max3_f32 v12, v40, v41, v42
 v_mfma_f32_16x16x32_bf16 v[156:159], a[236:239], v[52:55], v[156:159]
 ds_read_b64_tr_b16 a[234:235], v7 offset:34816
 v_max3_f32 v11, v11, v35, v36
 v_mfma_f32_16x16x32_bf16 v[160:163], a[240:243], v[48:51], v[160:163]
 ds_read_b64_tr_b16 a[236:237], v8 offset:32768
 v_max3_f32 v12, v12, v43, v44
 v_mfma_f32_16x16x32_bf16 v[168:171], a[240:243], v[52:55], v[168:171]
 ds_read_b64_tr_b16 a[238:239], v8 offset:34816
 v_max3_f32 v11, v11, v37, v38
 v_mfma_f32_16x16x32_bf16 v[164:167], a[244:247], v[48:51], v[164:167]
 ds_read_b64_tr_b16 a[240:241], v5 offset:36864
 v_max3_f32 v12, v12, v45, v46
 v_mfma_f32_16x16x32_bf16 v[172:175], a[244:247], v[52:55], v[172:175]
 ds_read_b64_tr_b16 a[242:243], v5 offset:38912
 v_max_f32 v11, v11, v39
 v_mfma_f32_16x16x32_bf16 v[176:179], a[248:251], v[48:51], v[176:179]
 ds_read_b64_tr_b16 a[244:245], v6 offset:36864
 v_max_f32 v12, v12, v47
 v_mfma_f32_16x16x32_bf16 v[184:187], a[248:251], v[52:55], v[184:187]
 ds_read_b64_tr_b16 a[246:247], v6 offset:38912
 v_max_f32 v13, v11, v12
 v_cmp_lt_f32 vcc, 0x41200000, v13
 v_mfma_f32_16x16x32_bf16 v[180:183], a[252:255], v[48:51], v[180:183]
 ds_read_b64_tr_b16 a[248:249], v7 offset:36864
 s_waitcnt lgkmcnt(5)
 s_cbranch_vccnz L_rs1_6
L_rb1_6:
 v_mfma_f32_16x16x32_bf16 v[188:191], a[252:255], v[52:55], v[188:191]
 ds_read_b64_tr_b16 a[250:251], v7 offset:38912
 v_accvgpr_read_b32 v30, a90
 v_mfma_f32_16x16x32_bf16 v[192:195], a[224:227], v[48:51], v[192:195]
 ds_read_b64_tr_b16 a[252:253], v8 offset:36864
 v_cmp_le_u32 vcc, 163, v10
 v_mfma_f32_16x16x32_bf16 v[200:203], a[224:227], v[52:55], v[200:203]
 ds_read_b64_tr_b16 a[254:255], v8 offset:38912
 v_accvgpr_read_b32 v31, a91
 v_mfma_f32_16x16x32_bf16 v[196:199], a[228:231], v[48:51], v[196:199]
 s_cbranch_vccz L_cs1232
L_cb1232:
 ds_read_b64_tr_b16 a[224:225], v24 offset:40960
 v_mfma_f32_16x16x32_bf16 v[204:207], a[228:231], v[52:55], v[204:207]
 ds_read_b64_tr_b16 a[226:227], v24 offset:43008
 v_cvt_pk_bf16_f32 v30, v30, v31
 v_mfma_f32_16x16x32_bf16 v[208:211], a[232:235], v[48:51], v[208:211]
 ds_read_b64_tr_b16 a[228:229], v25 offset:40960
 v_accvgpr_write_b32 a13, v30
 v_mfma_f32_16x16x32_bf16 v[216:219], a[232:235], v[52:55], v[216:219]
 ds_read_b64_tr_b16 a[230:231], v25 offset:43008
 v_accvgpr_read_b32 v28, a92
 v_mfma_f32_16x16x32_bf16 v[212:215], a[236:239], v[48:51], v[212:215]
 ds_read_b64_tr_b16 a[232:233], v26 offset:40960
 s_waitcnt lgkmcnt(5)
 v_mfma_f32_16x16x32_bf16 v[220:223], a[236:239], v[52:55], v[220:223]
 ds_read_b64_tr_b16 a[234:235], v26 offset:43008
 v_accvgpr_read_b32 v29, a93
 v_mfma_f32_16x16x32_bf16 v[224:227], a[240:243], v[48:51], v[224:227]
 ds_read_b64_tr_b16 a[236:237], v27 offset:40960
 v_cvt_pk_bf16_f32 v28, v28, v29
 v_mfma_f32_16x16x32_bf16 v[232:235], a[240:243], v[52:55], v[232:235]
 ds_read_b64_tr_b16 a[238:239], v27 offset:43008
 v_accvgpr_write_b32 a14, v28
 v_mfma_f32_16x16x32_bf16 v[228:231], a[244:247], v[48:51], v[228:231]
 ds_read_b64_tr_b16 a[240:241], v24 offset:45056
 v_accvgpr_read_b32 v30, a94
 v_mfma_f32_16x16x32_bf16 v[236:239], a[244:247], v[52:55], v[236:239]
 ds_read_b64_tr_b16 a[242:243], v24 offset:47104
 s_movk_i32 s70, 616
 v_mfma_f32_16x16x32_bf16 v[240:243], a[248:251], v[48:51], v[240:243]
 ds_read_b64_tr_b16 a[244:245], v25 offset:45056
 v_accvgpr_read_b32 v31, a95
 v_mfma_f32_16x16x32_bf16 v[248:251], a[248:251], v[52:55], v[248:251]
 ds_read_b64_tr_b16 a[246:247], v25 offset:47104
 v_cvt_pk_bf16_f32 v30, v30, v31
 v_mfma_f32_16x16x32_bf16 v[244:247], a[252:255], v[48:51], v[244:247]
 ds_read_b64_tr_b16 a[248:249], v26 offset:45056
 s_waitcnt lgkmcnt(5)
 v_mfma_f32_16x16x32_bf16 v[252:255], a[252:255], v[52:55], v[252:255]
 ds_read_b64_tr_b16 a[250:251], v26 offset:47104
 v_accvgpr_write_b32 a15, v30
 v_mfma_f32_16x16x32_bf16 a[96:99], a[224:227], v[64:67], 0
 ds_read_b64_tr_b16 a[252:253], v27 offset:45056
 buffer_load_dword off, s[72:75], s70 lds
 v_accvgpr_read_b32 v28, a176
 v_mfma_f32_16x16x32_bf16 a[104:107], a[224:227], v[68:71], 0
 ds_read_b64_tr_b16 a[254:255], v27 offset:47104
 v_accvgpr_read_b32 v29, a177
 v_mfma_f32_16x16x32_bf16 a[100:103], a[228:231], v[64:67], 0
 ds_read_b64_tr_b16 a[224:225], v24 offset:32768
 v_cvt_pk_bf16_f32 v28, v28, v29
 v_mfma_f32_16x16x32_bf16 a[108:111], a[228:231], v[68:71], 0
 ds_read_b64_tr_b16 a[226:227], v24 offset:34816
 v_accvgpr_write_b32 a16, v28
 v_mfma_f32_16x16x32_bf16 a[208:211], a[232:235], v[64:67], 0
 ds_read_b64_tr_b16 a[228:229], v25 offset:32768
 ds_read_b32 v10, v9
 v_mfma_f32_16x16x32_bf16 a[216:219], a[232:235], v[68:71], 0
 ds_read_b64_tr_b16 a[230:231], v25 offset:34816
 v_accvgpr_read_b32 v30, a178
 v_mfma_f32_16x16x32_bf16 a[212:215], a[236:239], v[64:67], 0
 ds_read_b64_tr_b16 a[232:233], v26 offset:32768
 s_waitcnt lgkmcnt(6)
 v_mfma_f32_16x16x32_bf16 a[220:223], a[236:239], v[68:71], 0
 ds_read_b64_tr_b16 a[234:235], v26 offset:34816
 v_accvgpr_read_b32 v31, a179
 v_mfma_f32_16x16x32_bf16 a[96:99], a[240:243], v[72:75], a[96:99]
 ds_read_b64_tr_b16 a[236:237], v27 offset:32768
 v_cvt_pk_bf16_f32 v30, v30, v31
 v_mfma_f32_16x16x32_bf16 a[104:107], a[240:243], v[76:79], a[104:107]
 ds_read_b64_tr_b16 a[238:239], v27 offset:34816
 v_accvgpr_write_b32 a17, v30
 v_mfma_f32_16x16x32_bf16 a[100:103], a[244:247], v[72:75], a[100:103]
 ds_read_b64_tr_b16 a[240:241], v24 offset:36864
 v_accvgpr_read_b32 v28, a180
 v_mfma_f32_16x16x32_bf16 a[108:111], a[244:247], v[76:79], a[108:111]
 ds_read_b64_tr_b16 a[242:243], v24 offset:38912
 v_accvgpr_read_b32 v29, a181
 v_mfma_f32_16x16x32_bf16 a[208:211], a[248:251], v[72:75], a[208:211]
 ds_read_b64_tr_b16 a[244:245], v25 offset:36864
 v_cvt_pk_bf16_f32 v28, v28, v29
 v_mfma_f32_16x16x32_bf16 a[216:219], a[248:251], v[76:79], a[216:219]
 ds_read_b64_tr_b16 a[246:247], v25 offset:38912
 v_accvgpr_write_b32 a18, v28
 v_mfma_f32_16x16x32_bf16 a[212:215], a[252:255], v[72:75], a[212:215]
 ds_read_b64_tr_b16 a[248:249], v26 offset:36864
 s_waitcnt lgkmcnt(5)
 v_mfma_f32_16x16x32_bf16 a[220:223], a[252:255], v[76:79], a[220:223]
 ds_read_b64_tr_b16 a[250:251], v26 offset:38912
 v_accvgpr_read_b32 v30, a182
 v_mfma_f32_16x16x32_bf16 a[96:99], a[224:227], v[80:83], a[96:99]
 ds_read_b64_tr_b16 a[252:253], v27 offset:36864
 v_cmp_le_u32 vcc, 166, v10
 v_mfma_f32_16x16x32_bf16 a[104:107], a[224:227], v[84:87], a[104:107]
 ds_read_b64_tr_b16 a[254:255], v27 offset:38912
 v_accvgpr_read_b32 v31, a183
 v_mfma_f32_16x16x32_bf16 a[100:103], a[228:231], v[80:83], a[100:103]
 s_cbranch_vccz L_cs1248
L_cb1248:
 ds_read_b128 a[224:227], v3 offset:40960
 v_mfma_f32_16x16x32_bf16 a[108:111], a[228:231], v[84:87], a[108:111]
 v_exp_f32 v32, v32
 v_mfma_f32_16x16x32_bf16 a[208:211], a[232:235], v[80:83], a[208:211]
 ds_read_b128 a[228:231], v3 offset:43008
 v_add_f32 v14, v14, v32
 v_mfma_f32_16x16x32_bf16 a[216:219], a[232:235], v[84:87], a[216:219]
 v_exp_f32 v33, v33
 v_mfma_f32_16x16x32_bf16 a[212:215], a[236:239], v[80:83], a[212:215]
 ds_read_b128 a[232:235], v4 offset:40960
 s_waitcnt lgkmcnt(3)
 v_mfma_f32_16x16x32_bf16 a[220:223], a[236:239], v[84:87], a[220:223]
 v_exp_f32 v34, v34
 v_mfma_f32_16x16x32_bf16 a[96:99], a[240:243], v[88:91], a[96:99]
 ds_read_b128 a[236:239], v4 offset:43008
 v_add_f32 v14, v14, v33
 v_mfma_f32_16x16x32_bf16 a[104:107], a[240:243], v[92:95], a[104:107]
 v_exp_f32 v35, v35
 v_mfma_f32_16x16x32_bf16 a[100:103], a[244:247], v[88:91], a[100:103]
 ds_read_b128 a[240:243], v3 offset:45056
 v_cvt_pk_bf16_f32 v32, v32, v33
 v_mfma_f32_16x16x32_bf16 a[108:111], a[244:247], v[92:95], a[108:111]
 v_exp_f32 v36, v36
 v_mfma_f32_16x16x32_bf16 a[208:211], a[248:251], v[88:91], a[208:211]
 ds_read_b128 a[244:247], v3 offset:47104
 s_movk_i32 s70, 624
 v_mfma_f32_16x16x32_bf16 a[216:219], a[248:251], v[92:95], a[216:219]
 v_exp_f32 v37, v37
 v_mfma_f32_16x16x32_bf16 a[212:215], a[252:255], v[88:91], a[212:215]
 ds_read_b128 a[248:251], v4 offset:45056
 s_waitcnt lgkmcnt(3)
 v_mfma_f32_16x16x32_bf16 a[220:223], a[252:255], v[92:95], a[220:223]
 buffer_load_dword off, s[72:75], s70 lds
 v_add_u32 v3, 0xffff0000, v3
 v_mfma_f32_16x16x32_bf16 v[48:51], a[224:227], a[112:115], v[16:19]
 ds_read_b128 a[252:255], v4 offset:47104
 v_add_u32 v4, 0xffff0000, v4
 v_exp_f32 v38, v38
 v_mfma_f32_16x16x32_bf16 v[56:59], a[224:227], a[116:119], v[20:23]
 v_exp_f32 v39, v39
 v_mfma_f32_16x16x32_bf16 v[52:55], a[228:231], a[112:115], v[16:19]
 ds_read_b128 a[224:227], v3 offset:57344
 v_add_f32 v14, v14, v34
 v_mfma_f32_16x16x32_bf16 v[60:63], a[228:231], a[116:119], v[20:23]
 v_exp_f32 v40, v40
 v_mfma_f32_16x16x32_bf16 v[48:51], a[232:235], a[120:123], v[48:51]
 ds_read_b128 a[228:231], v3 offset:59392
 v_add_f32 v14, v14, v35
 v_mfma_f32_16x16x32_bf16 v[56:59], a[232:235], a[124:127], v[56:59]
 v_exp_f32 v41, v41
 v_mfma_f32_16x16x32_bf16 v[52:55], a[236:239], a[120:123], v[52:55]
 ds_read_b128 a[232:235], v4 offset:57344
 s_waitcnt lgkmcnt(3)
 v_mfma_f32_16x16x32_bf16 v[60:63], a[236:239], a[124:127], v[60:63]
 v_exp_f32 v42, v42
 v_mfma_f32_16x16x32_bf16 v[48:51], a[240:243], a[128:131], v[48:51]
 ds_read_b128 a[236:239], v4 offset:59392
 v_cvt_pk_bf16_f32 v33, v34, v35
 v_mfma_f32_16x16x32_bf16 v[56:59], a[240:243], a[132:135], v[56:59]
 v_exp_f32 v43, v43
 v_mfma_f32_16x16x32_bf16 v[52:55], a[244:247], a[128:131], v[52:55]
 ds_read_b128 a[240:243], v3 offset:61440
 v_add_f32 v14, v14, v36
 v_mfma_f32_16x16x32_bf16 v[60:63], a[244:247], a[132:135], v[60:63]
 v_exp_f32 v44, v44
 v_mfma_f32_16x16x32_bf16 v[48:51], a[248:251], a[136:139], v[48:51]
 ds_read_b128 a[244:247], v3 offset:63488
 v_add_f32 v14, v14, v37
 v_mfma_f32_16x16x32_bf16 v[56:59], a[248:251], a[140:143], v[56:59]
 v_exp_f32 v45, v45
 v_mfma_f32_16x16x32_bf16 v[52:55], a[252:255], a[136:139], v[52:55]
 ds_read_b128 a[248:251], v4 offset:61440
 s_waitcnt lgkmcnt(3)
 v_exp_f32 v46, v46
 v_mfma_f32_16x16x32_bf16 v[60:63], a[252:255], a[140:143], v[60:63]
 v_exp_f32 v47, v47
 v_mfma_f32_16x16x32_bf16 v[48:51], a[224:227], a[144:147], v[48:51]
 ds_read_b128 a[252:255], v4 offset:63488
 v_cvt_pk_bf16_f32 v34, v36, v37
 v_mfma_f32_16x16x32_bf16 v[56:59], a[224:227], a[148:151], v[56:59]
 v_add_f32 v14, v14, v38
 v_add_f32 v14, v14, v39
 v_mfma_f32_16x16x32_bf16 v[52:55], a[228:231], a[144:147], v[52:55]
 ds_read_b64_tr_b16 a[224:225], v5 offset:49152
 v_cvt_pk_bf16_f32 v35, v38, v39
 v_mfma_f32_16x16x32_bf16 v[60:63], a[228:231], a[148:151], v[60:63]
 ds_read_b64_tr_b16 a[226:227], v5 offset:51200
 v_add_f32 v15, v15, v40
 v_mfma_f32_16x16x32_bf16 v[48:51], a[232:235], a[152:155], v[48:51]
 ds_read_b64_tr_b16 a[228:229], v6 offset:49152
 ds_read_b32 v10, v9
 v_mfma_f32_16x16x32_bf16 v[56:59], a[232:235], a[156:159], v[56:59]
 ds_read_b64_tr_b16 a[230:231], v6 offset:51200
 v_add_f32 v15, v15, v41
 v_mfma_f32_16x16x32_bf16 v[52:55], a[236:239], a[152:155], v[52:55]
 ds_read_b64_tr_b16 a[232:233], v7 offset:49152
 s_waitcnt lgkmcnt(6)
 v_cvt_pk_bf16_f32 v36, v40, v41
 v_mfma_f32_16x16x32_bf16 v[60:63], a[236:239], a[156:159], v[60:63]
 ds_read_b64_tr_b16 a[234:235], v7 offset:51200
 v_add_f32 v15, v15, v42
 v_mfma_f32_16x16x32_bf16 v[48:51], a[240:243], a[160:163], v[48:51]
 ds_read_b64_tr_b16 a[236:237], v8 offset:49152
 v_add_f32 v15, v15, v43
 v_mfma_f32_16x16x32_bf16 v[56:59], a[240:243], a[164:167], v[56:59]
 ds_read_b64_tr_b16 a[238:239], v8 offset:51200
 v_cvt_pk_bf16_f32 v37, v42, v43
 v_mfma_f32_16x16x32_bf16 v[52:55], a[244:247], a[160:163], v[52:55]
 ds_read_b64_tr_b16 a[240:241], v5 offset:53248
 v_add_f32 v15, v15, v44
 v_mfma_f32_16x16x32_bf16 v[60:63], a[244:247], a[164:167], v[60:63]
 ds_read_b64_tr_b16 a[242:243], v5 offset:55296
 v_add_f32 v15, v15, v45
 v_mfma_f32_16x16x32_bf16 v[48:51], a[248:251], a[168:171], v[48:51]
 ds_read_b64_tr_b16 a[244:245], v6 offset:53248
 v_cvt_pk_bf16_f32 v38, v44, v45
 v_mfma_f32_16x16x32_bf16 v[56:59], a[248:251], a[172:175], v[56:59]
 ds_read_b64_tr_b16 a[246:247], v6 offset:55296
 v_add_f32 v15, v15, v46
 v_mfma_f32_16x16x32_bf16 v[52:55], a[252:255], a[168:171], v[52:55]
 ds_read_b64_tr_b16 a[248:249], v7 offset:53248
 v_add_f32 v15, v15, v47
 v_cvt_pk_bf16_f32 v39, v46, v47
 v_mfma_f32_16x16x32_bf16 v[60:63], a[252:255], a[172:175], v[60:63]
 ds_read_b64_tr_b16 a[250:251], v7 offset:55296
 s_waitcnt lgkmcnt(6)
 s_movk_i32 s70, 632
 buffer_load_dword off, s[72:75], s70 lds
 v_mfma_f32_16x16x32_bf16 v[128:131], a[224:227], v[32:35], v[128:131]
 ds_read_b64_tr_b16 a[252:253], v8 offset:53248
 v_cmp_le_u32 vcc, 167, v10
 v_mfma_f32_16x16x32_bf16 v[136:139], a[224:227], v[36:39], v[136:139]
 ds_read_b64_tr_b16 a[254:255], v8 offset:55296
 v_add_u32 v5, 0x10000, v5
 v_mfma_f32_16x16x32_bf16 v[132:135], a[228:231], v[32:35], v[132:135]
 s_cbranch_vccz L_cs1272
L_cb1272:
 ds_read_b64_tr_b16 a[224:225], v5 offset:0
 v_add_u32 v6, 0x10000, v6
 v_mfma_f32_16x16x32_bf16 v[140:143], a[228:231], v[36:39], v[140:143]
 ds_read_b64_tr_b16 a[226:227], v5 offset:2048
 v_add_u32 v7, 0x10000, v7
 v_mfma_f32_16x16x32_bf16 v[144:147], a[232:235], v[32:35], v[144:147]
 ds_read_b64_tr_b16 a[228:229], v6 offset:0
 ds_read_b32 v10, v9
 v_add_u32 v8, 0x10000, v8
 v_mfma_f32_16x16x32_bf16 v[152:155], a[232:235], v[36:39], v[152:155]
 ds_read_b64_tr_b16 a[230:231], v6 offset:2048
 v_max3_f32 v11, v48, v49, v50
 v_mfma_f32_16x16x32_bf16 v[148:151], a[236:239], v[32:35], v[148:151]
 ds_read_b64_tr_b16 a[232:233], v7 offset:0
 s_waitcnt lgkmcnt(6)
 v_max3_f32 v12, v56, v57, v58
 v_mfma_f32_16x16x32_bf16 v[156:159], a[236:239], v[36:39], v[156:159]
 ds_read_b64_tr_b16 a[234:235], v7 offset:2048
 v_max3_f32 v11, v11, v51, v52
 v_mfma_f32_16x16x32_bf16 v[160:163], a[240:243], v[32:35], v[160:163]
 ds_read_b64_tr_b16 a[236:237], v8 offset:0
 v_max3_f32 v12, v12, v59, v60
 v_mfma_f32_16x16x32_bf16 v[168:171], a[240:243], v[36:39], v[168:171]
 ds_read_b64_tr_b16 a[238:239], v8 offset:2048
 v_max3_f32 v11, v11, v53, v54
 v_mfma_f32_16x16x32_bf16 v[164:167], a[244:247], v[32:35], v[164:167]
 ds_read_b64_tr_b16 a[240:241], v5 offset:4096
 v_max3_f32 v12, v12, v61, v62
 v_mfma_f32_16x16x32_bf16 v[172:175], a[244:247], v[36:39], v[172:175]
 ds_read_b64_tr_b16 a[242:243], v5 offset:6144
 v_max_f32 v11, v11, v55
 v_mfma_f32_16x16x32_bf16 v[176:179], a[248:251], v[32:35], v[176:179]
 ds_read_b64_tr_b16 a[244:245], v6 offset:4096
 v_max_f32 v12, v12, v63
 v_mfma_f32_16x16x32_bf16 v[184:187], a[248:251], v[36:39], v[184:187]
 ds_read_b64_tr_b16 a[246:247], v6 offset:6144
 v_max_f32 v13, v11, v12
 v_cmp_lt_f32 vcc, 0x41200000, v13
 v_mfma_f32_16x16x32_bf16 v[180:183], a[252:255], v[32:35], v[180:183]
 ds_read_b64_tr_b16 a[248:249], v7 offset:4096
 s_waitcnt lgkmcnt(5)
 s_cbranch_vccnz L_rs1_7
L_rb1_7:
 v_mfma_f32_16x16x32_bf16 v[188:191], a[252:255], v[36:39], v[188:191]
 ds_read_b64_tr_b16 a[250:251], v7 offset:6144
 v_cvt_pk_bf16_f32 v30, v30, v31
 v_mfma_f32_16x16x32_bf16 v[192:195], a[224:227], v[32:35], v[192:195]
 ds_read_b64_tr_b16 a[252:253], v8 offset:4096
 v_cmp_le_u32 vcc, 169, v10
 v_mfma_f32_16x16x32_bf16 v[200:203], a[224:227], v[36:39], v[200:203]
 ds_read_b64_tr_b16 a[254:255], v8 offset:6144
 v_accvgpr_write_b32 a19, v30
 v_mfma_f32_16x16x32_bf16 v[196:199], a[228:231], v[32:35], v[196:199]
 s_cbranch_vccz L_cs1280
L_cb1280:
 ds_read_b64_tr_b16 a[224:225], v24 offset:0
 v_mfma_f32_16x16x32_bf16 v[204:207], a[228:231], v[36:39], v[204:207]
 ds_read_b64_tr_b16 a[226:227], v24 offset:2048
 v_accvgpr_read_b32 v28, a184
 v_mfma_f32_16x16x32_bf16 v[208:211], a[232:235], v[32:35], v[208:211]
 ds_read_b64_tr_b16 a[228:229], v25 offset:0
 v_accvgpr_read_b32 v29, a185
 v_mfma_f32_16x16x32_bf16 v[216:219], a[232:235], v[36:39], v[216:219]
 ds_read_b64_tr_b16 a[230:231], v25 offset:2048
 v_cvt_pk_bf16_f32 v28, v28, v29
 v_mfma_f32_16x16x32_bf16 v[212:215], a[236:239], v[32:35], v[212:215]
 ds_read_b64_tr_b16 a[232:233], v26 offset:0
 s_waitcnt lgkmcnt(5)
 v_mfma_f32_16x16x32_bf16 v[220:223], a[236:239], v[36:39], v[220:223]
 ds_read_b64_tr_b16 a[234:235], v26 offset:2048
 v_accvgpr_write_b32 a20, v28
 v_mfma_f32_16x16x32_bf16 v[224:227], a[240:243], v[32:35], v[224:227]
 ds_read_b64_tr_b16 a[236:237], v27 offset:0
 v_accvgpr_read_b32 v30, a186
 v_mfma_f32_16x16x32_bf16 v[232:235], a[240:243], v[36:39], v[232:235]
 ds_read_b64_tr_b16 a[238:239], v27 offset:2048
 v_accvgpr_read_b32 v31, a187
 v_mfma_f32_16x16x32_bf16 v[228:231], a[244:247], v[32:35], v[228:231]
 ds_read_b64_tr_b16 a[240:241], v24 offset:4096
 v_add_u32 v3, 0x20000, v3
 v_mfma_f32_16x16x32_bf16 v[236:239], a[244:247], v[36:39], v[236:239]
 ds_read_b64_tr_b16 a[242:243], v24 offset:6144
 s_movk_i32 s70, 640
 v_mfma_f32_16x16x32_bf16 v[240:243], a[248:251], v[32:35], v[240:243]
 ds_read_b64_tr_b16 a[244:245], v25 offset:4096
 v_cvt_pk_bf16_f32 v30, v30, v31
 v_mfma_f32_16x16x32_bf16 v[248:251], a[248:251], v[36:39], v[248:251]
 ds_read_b64_tr_b16 a[246:247], v25 offset:6144
 v_accvgpr_write_b32 a21, v30
 v_mfma_f32_16x16x32_bf16 v[244:247], a[252:255], v[32:35], v[244:247]
 ds_read_b64_tr_b16 a[248:249], v26 offset:4096
 s_waitcnt lgkmcnt(5)
 v_mfma_f32_16x16x32_bf16 v[252:255], a[252:255], v[36:39], v[252:255]
 ds_read_b64_tr_b16 a[250:251], v26 offset:6144
 v_add_u32 v4, 0x20000, v4
 v_mfma_f32_16x16x32_bf16 a[96:99], a[224:227], v[96:99], a[96:99]
 ds_read_b64_tr_b16 a[252:253], v27 offset:4096
 buffer_load_dword off, s[72:75], s70 lds
 v_accvgpr_read_b32 v28, a188
 v_mfma_f32_16x16x32_bf16 a[104:107], a[224:227], v[100:103], a[104:107]
 ds_read_b64_tr_b16 a[254:255], v27 offset:6144
 v_accvgpr_read_b32 v29, a189
 v_mfma_f32_16x16x32_bf16 a[100:103], a[228:231], v[96:99], a[100:103]
 ds_read_b64_tr_b16 a[224:225], v24 offset:8192
 v_cvt_pk_bf16_f32 v28, v28, v29
 v_mfma_f32_16x16x32_bf16 a[108:111], a[228:231], v[100:103], a[108:111]
 ds_read_b64_tr_b16 a[226:227], v24 offset:10240
 v_accvgpr_write_b32 a22, v28
 v_mfma_f32_16x16x32_bf16 a[208:211], a[232:235], v[96:99], a[208:211]
 ds_read_b64_tr_b16 a[228:229], v25 offset:8192
 ds_read_b32 v10, v9
 v_mfma_f32_16x16x32_bf16 a[216:219], a[232:235], v[100:103], a[216:219]
 ds_read_b64_tr_b16 a[230:231], v25 offset:10240
 v_accvgpr_read_b32 v30, a190
 v_mfma_f32_16x16x32_bf16 a[212:215], a[236:239], v[96:99], a[212:215]
 ds_read_b64_tr_b16 a[232:233], v26 offset:8192
 s_waitcnt lgkmcnt(6)
 v_mfma_f32_16x16x32_bf16 a[220:223], a[236:239], v[100:103], a[220:223]
 ds_read_b64_tr_b16 a[234:235], v26 offset:10240
 v_accvgpr_read_b32 v31, a191
 v_mfma_f32_16x16x32_bf16 a[96:99], a[240:243], v[104:107], a[96:99]
 ds_read_b64_tr_b16 a[236:237], v27 offset:8192
 v_cvt_pk_bf16_f32 v30, v30, v31
 v_mfma_f32_16x16x32_bf16 a[104:107], a[240:243], v[108:111], a[104:107]
 ds_read_b64_tr_b16 a[238:239], v27 offset:10240
 v_accvgpr_write_b32 a23, v30
 v_mfma_f32_16x16x32_bf16 a[100:103], a[244:247], v[104:107], a[100:103]
 ds_read_b64_tr_b16 a[240:241], v24 offset:12288
 v_accvgpr_read_b32 v28, a192
 v_mfma_f32_16x16x32_bf16 a[108:111], a[244:247], v[108:111], a[108:111]
 ds_read_b64_tr_b16 a[242:243], v24 offset:14336
 v_accvgpr_read_b32 v29, a193
 v_mfma_f32_16x16x32_bf16 a[208:211], a[248:251], v[104:107], a[208:211]
 ds_read_b64_tr_b16 a[244:245], v25 offset:12288
 v_cvt_pk_bf16_f32 v28, v28, v29
 v_mfma_f32_16x16x32_bf16 a[216:219], a[248:251], v[108:111], a[216:219]
 ds_read_b64_tr_b16 a[246:247], v25 offset:14336
 v_accvgpr_write_b32 a24, v28
 v_mfma_f32_16x16x32_bf16 a[212:215], a[252:255], v[104:107], a[212:215]
 ds_read_b64_tr_b16 a[248:249], v26 offset:12288
 s_waitcnt lgkmcnt(5)
 v_mfma_f32_16x16x32_bf16 a[220:223], a[252:255], v[108:111], a[220:223]
 ds_read_b64_tr_b16 a[250:251], v26 offset:14336
 v_accvgpr_read_b32 v30, a194
 v_mfma_f32_16x16x32_bf16 a[96:99], a[224:227], v[112:115], a[96:99]
 ds_read_b64_tr_b16 a[252:253], v27 offset:12288
 v_cmp_le_u32 vcc, 172, v10
 v_mfma_f32_16x16x32_bf16 a[104:107], a[224:227], v[116:119], a[104:107]
 ds_read_b64_tr_b16 a[254:255], v27 offset:14336
 v_accvgpr_read_b32 v31, a195
 v_mfma_f32_16x16x32_bf16 a[100:103], a[228:231], v[112:115], a[100:103]
 s_cbranch_vccz L_cs1296
L_cb1296:
 ds_read_b128 a[224:227], v3 offset:8192
 v_mfma_f32_16x16x32_bf16 a[108:111], a[228:231], v[116:119], a[108:111]
 v_exp_f32 v48, v48
 v_mfma_f32_16x16x32_bf16 a[208:211], a[232:235], v[112:115], a[208:211]
 ds_read_b128 a[228:231], v3 offset:10240
 v_add_f32 v14, v14, v48
 v_mfma_f32_16x16x32_bf16 a[216:219], a[232:235], v[116:119], a[216:219]
 v_exp_f32 v49, v49
 v_mfma_f32_16x16x32_bf16 a[212:215], a[236:239], v[112:115], a[212:215]
 ds_read_b128 a[232:235], v4 offset:8192
 s_waitcnt lgkmcnt(3)
 v_mfma_f32_16x16x32_bf16 a[220:223], a[236:239], v[116:119], a[220:223]
 v_exp_f32 v50, v50
 v_mfma_f32_16x16x32_bf16 a[96:99], a[240:243], v[120:123], a[96:99]
 ds_read_b128 a[236:239], v4 offset:10240
 v_add_f32 v14, v14, v49
 v_mfma_f32_16x16x32_bf16 a[104:107], a[240:243], v[124:127], a[104:107]
 v_exp_f32 v51, v51
 v_mfma_f32_16x16x32_bf16 a[100:103], a[244:247], v[120:123], a[100:103]
 ds_read_b128 a[240:243], v3 offset:12288
 v_cvt_pk_bf16_f32 v48, v48, v49
 v_mfma_f32_16x16x32_bf16 a[108:111], a[244:247], v[124:127], a[108:111]
 v_exp_f32 v52, v52
 v_mfma_f32_16x16x32_bf16 a[208:211], a[248:251], v[120:123], a[208:211]
 ds_read_b128 a[244:247], v3 offset:14336
 s_movk_i32 s70, 648
 v_mfma_f32_16x16x32_bf16 a[216:219], a[248:251], v[124:127], a[216:219]
 v_exp_f32 v53, v53
 v_mfma_f32_16x16x32_bf16 a[212:215], a[252:255], v[120:123], a[212:215]
 ds_read_b128 a[248:251], v4 offset:12288
 s_waitcnt lgkmcnt(3)
 v_mfma_f32_16x16x32_bf16 a[220:223], a[252:255], v[124:127], a[220:223]
 buffer_load_dword off, s[72:75], s70 lds
 v_add_u32 v3, 0xffff0000, v3
 v_mfma_f32_16x16x32_bf16 v[32:35], a[224:227], a[112:115], v[16:19]
 ds_read_b128 a[252:255], v4 offset:14336
 v_add_u32 v4, 0xffff0000, v4
 v_exp_f32 v54, v54
 v_mfma_f32_16x16x32_bf16 v[40:43], a[224:227], a[116:119], v[20:23]
 v_exp_f32 v55, v55
 v_mfma_f32_16x16x32_bf16 v[36:39], a[228:231], a[112:115], v[16:19]
 ds_read_b128 a[224:227], v3 offset:57344
 v_add_f32 v14, v14, v50
 v_mfma_f32_16x16x32_bf16 v[44:47], a[228:231], a[116:119], v[20:23]
 v_exp_f32 v56, v56
 v_mfma_f32_16x16x32_bf16 v[32:35], a[232:235], a[120:123], v[32:35]
 ds_read_b128 a[228:231], v3 offset:59392
 v_add_f32 v14, v14, v51
 v_mfma_f32_16x16x32_bf16 v[40:43], a[232:235], a[124:127], v[40:43]
 v_exp_f32 v57, v57
 v_mfma_f32_16x16x32_bf16 v[36:39], a[236:239], a[120:123], v[36:39]
 ds_read_b128 a[232:235], v4 offset:57344
 s_waitcnt lgkmcnt(3)
 v_mfma_f32_16x16x32_bf16 v[44:47], a[236:239], a[124:127], v[44:47]
 v_exp_f32 v58, v58
 v_mfma_f32_16x16x32_bf16 v[32:35], a[240:243], a[128:131], v[32:35]
 ds_read_b128 a[236:239], v4 offset:59392
 v_cvt_pk_bf16_f32 v49, v50, v51
 v_mfma_f32_16x16x32_bf16 v[40:43], a[240:243], a[132:135], v[40:43]
 v_exp_f32 v59, v59
 v_mfma_f32_16x16x32_bf16 v[36:39], a[244:247], a[128:131], v[36:39]
 ds_read_b128 a[240:243], v3 offset:61440
 v_add_f32 v14, v14, v52
 v_mfma_f32_16x16x32_bf16 v[44:47], a[244:247], a[132:135], v[44:47]
 v_exp_f32 v60, v60
 v_mfma_f32_16x16x32_bf16 v[32:35], a[248:251], a[136:139], v[32:35]
 ds_read_b128 a[244:247], v3 offset:63488
 v_add_f32 v14, v14, v53
 v_mfma_f32_16x16x32_bf16 v[40:43], a[248:251], a[140:143], v[40:43]
 v_exp_f32 v61, v61
 v_mfma_f32_16x16x32_bf16 v[36:39], a[252:255], a[136:139], v[36:39]
 ds_read_b128 a[248:251], v4 offset:61440
 s_waitcnt lgkmcnt(3)
 v_exp_f32 v62, v62
 v_mfma_f32_16x16x32_bf16 v[44:47], a[252:255], a[140:143], v[44:47]
 v_exp_f32 v63, v63
 v_mfma_f32_16x16x32_bf16 v[32:35], a[224:227], a[144:147], v[32:35]
 ds_read_b128 a[252:255], v4 offset:63488
 v_cvt_pk_bf16_f32 v50, v52, v53
 v_mfma_f32_16x16x32_bf16 v[40:43], a[224:227], a[148:151], v[40:43]
 v_add_f32 v14, v14, v54
 v_add_f32 v14, v14, v55
 v_mfma_f32_16x16x32_bf16 v[36:39], a[228:231], a[144:147], v[36:39]
 ds_read_b64_tr_b16 a[224:225], v5 offset:16384
 v_cvt_pk_bf16_f32 v51, v54, v55
 v_mfma_f32_16x16x32_bf16 v[44:47], a[228:231], a[148:151], v[44:47]
 ds_read_b64_tr_b16 a[226:227], v5 offset:18432
 v_add_f32 v15, v15, v56
 v_mfma_f32_16x16x32_bf16 v[32:35], a[232:235], a[152:155], v[32:35]
 ds_read_b64_tr_b16 a[228:229], v6 offset:16384
 ds_read_b32 v10, v9
 v_mfma_f32_16x16x32_bf16 v[40:43], a[232:235], a[156:159], v[40:43]
 ds_read_b64_tr_b16 a[230:231], v6 offset:18432
 v_add_f32 v15, v15, v57
 v_mfma_f32_16x16x32_bf16 v[36:39], a[236:239], a[152:155], v[36:39]
 ds_read_b64_tr_b16 a[232:233], v7 offset:16384
 s_waitcnt lgkmcnt(6)
 v_cvt_pk_bf16_f32 v52, v56, v57
 v_mfma_f32_16x16x32_bf16 v[44:47], a[236:239], a[156:159], v[44:47]
 ds_read_b64_tr_b16 a[234:235], v7 offset:18432
 v_add_f32 v15, v15, v58
 v_mfma_f32_16x16x32_bf16 v[32:35], a[240:243], a[160:163], v[32:35]
 ds_read_b64_tr_b16 a[236:237], v8 offset:16384
 v_add_f32 v15, v15, v59
 v_mfma_f32_16x16x32_bf16 v[40:43], a[240:243], a[164:167], v[40:43]
 ds_read_b64_tr_b16 a[238:239], v8 offset:18432
 v_cvt_pk_bf16_f32 v53, v58, v59
 v_mfma_f32_16x16x32_bf16 v[36:39], a[244:247], a[160:163], v[36:39]
 ds_read_b64_tr_b16 a[240:241], v5 offset:20480
 v_add_f32 v15, v15, v60
 v_mfma_f32_16x16x32_bf16 v[44:47], a[244:247], a[164:167], v[44:47]
 ds_read_b64_tr_b16 a[242:243], v5 offset:22528
 v_add_f32 v15, v15, v61
 v_mfma_f32_16x16x32_bf16 v[32:35], a[248:251], a[168:171], v[32:35]
 ds_read_b64_tr_b16 a[244:245], v6 offset:20480
 v_cvt_pk_bf16_f32 v54, v60, v61
 v_mfma_f32_16x16x32_bf16 v[40:43], a[248:251], a[172:175], v[40:43]
 ds_read_b64_tr_b16 a[246:247], v6 offset:22528
 v_add_f32 v15, v15, v62
 v_mfma_f32_16x16x32_bf16 v[36:39], a[252:255], a[168:171], v[36:39]
 ds_read_b64_tr_b16 a[248:249], v7 offset:20480
 v_add_f32 v15, v15, v63
 v_cvt_pk_bf16_f32 v55, v62, v63
 v_mfma_f32_16x16x32_bf16 v[44:47], a[252:255], a[172:175], v[44:47]
 ds_read_b64_tr_b16 a[250:251], v7 offset:22528
 s_waitcnt lgkmcnt(6)
 s_movk_i32 s70, 656
 buffer_load_dword off, s[72:75], s70 lds
 v_mfma_f32_16x16x32_bf16 v[128:131], a[224:227], v[48:51], v[128:131]
 ds_read_b64_tr_b16 a[252:253], v8 offset:20480
 v_cmp_le_u32 vcc, 173, v10
 v_mfma_f32_16x16x32_bf16 v[136:139], a[224:227], v[52:55], v[136:139]
 ds_read_b64_tr_b16 a[254:255], v8 offset:22528
 v_add_u32 v5, 0xffff0000, v5
 v_mfma_f32_16x16x32_bf16 v[132:135], a[228:231], v[48:51], v[132:135]
 s_cbranch_vccz L_cs1320
L_cb1320:
 ds_read_b64_tr_b16 a[224:225], v5 offset:0
 v_add_u32 v6, 0xffff0000, v6
 v_mfma_f32_16x16x32_bf16 v[140:143], a[228:231], v[52:55], v[140:143]
 ds_read_b64_tr_b16 a[226:227], v5 offset:2048
 v_add_u32 v7, 0xffff0000, v7
 v_mfma_f32_16x16x32_bf16 v[144:147], a[232:235], v[48:51], v[144:147]
 ds_read_b64_tr_b16 a[228:229], v6 offset:0
 ds_read_b32 v10, v9
 v_add_u32 v8, 0xffff0000, v8
 v_mfma_f32_16x16x32_bf16 v[152:155], a[232:235], v[52:55], v[152:155]
 ds_read_b64_tr_b16 a[230:231], v6 offset:2048
 v_max3_f32 v11, v32, v33, v34
 v_mfma_f32_16x16x32_bf16 v[148:151], a[236:239], v[48:51], v[148:151]
 ds_read_b64_tr_b16 a[232:233], v7 offset:0
 s_waitcnt lgkmcnt(6)
 v_max3_f32 v12, v40, v41, v42
 v_mfma_f32_16x16x32_bf16 v[156:159], a[236:239], v[52:55], v[156:159]
 ds_read_b64_tr_b16 a[234:235], v7 offset:2048
 v_max3_f32 v11, v11, v35, v36
 v_mfma_f32_16x16x32_bf16 v[160:163], a[240:243], v[48:51], v[160:163]
 ds_read_b64_tr_b16 a[236:237], v8 offset:0
 v_max3_f32 v12, v12, v43, v44
 v_mfma_f32_16x16x32_bf16 v[168:171], a[240:243], v[52:55], v[168:171]
 ds_read_b64_tr_b16 a[238:239], v8 offset:2048
 v_max3_f32 v11, v11, v37, v38
 v_mfma_f32_16x16x32_bf16 v[164:167], a[244:247], v[48:51], v[164:167]
 ds_read_b64_tr_b16 a[240:241], v5 offset:4096
 v_max3_f32 v12, v12, v45, v46
 v_mfma_f32_16x16x32_bf16 v[172:175], a[244:247], v[52:55], v[172:175]
 ds_read_b64_tr_b16 a[242:243], v5 offset:6144
 v_max_f32 v11, v11, v39
 v_mfma_f32_16x16x32_bf16 v[176:179], a[248:251], v[48:51], v[176:179]
 ds_read_b64_tr_b16 a[244:245], v6 offset:4096
 v_max_f32 v12, v12, v47
 v_mfma_f32_16x16x32_bf16 v[184:187], a[248:251], v[52:55], v[184:187]
 ds_read_b64_tr_b16 a[246:247], v6 offset:6144
 v_max_f32 v13, v11, v12
 v_cmp_lt_f32 vcc, 0x41200000, v13
 v_mfma_f32_16x16x32_bf16 v[180:183], a[252:255], v[48:51], v[180:183]
 ds_read_b64_tr_b16 a[248:249], v7 offset:4096
 s_waitcnt lgkmcnt(5)
 s_cbranch_vccnz L_rs1_8
L_rb1_8:
 v_mfma_f32_16x16x32_bf16 v[188:191], a[252:255], v[52:55], v[188:191]
 ds_read_b64_tr_b16 a[250:251], v7 offset:6144
 v_cvt_pk_bf16_f32 v30, v30, v31
 v_mfma_f32_16x16x32_bf16 v[192:195], a[224:227], v[48:51], v[192:195]
 ds_read_b64_tr_b16 a[252:253], v8 offset:4096
 v_cmp_le_u32 vcc, 175, v10
 v_mfma_f32_16x16x32_bf16 v[200:203], a[224:227], v[52:55], v[200:203]
 ds_read_b64_tr_b16 a[254:255], v8 offset:6144
 v_accvgpr_write_b32 a25, v30
 v_mfma_f32_16x16x32_bf16 v[196:199], a[228:231], v[48:51], v[196:199]
 s_cbranch_vccz L_cs1328
L_cb1328:
 ds_read_b64_tr_b16 a[224:225], v24 offset:16384
 v_mfma_f32_16x16x32_bf16 v[204:207], a[228:231], v[52:55], v[204:207]
 ds_read_b64_tr_b16 a[226:227], v24 offset:18432
 v_accvgpr_read_b32 v28, a196
 v_mfma_f32_16x16x32_bf16 v[208:211], a[232:235], v[48:51], v[208:211]
 ds_read_b64_tr_b16 a[228:229], v25 offset:16384
 v_accvgpr_read_b32 v29, a197
 v_mfma_f32_16x16x32_bf16 v[216:219], a[232:235], v[52:55], v[216:219]
 ds_read_b64_tr_b16 a[230:231], v25 offset:18432
 v_cvt_pk_bf16_f32 v28, v28, v29
 v_mfma_f32_16x16x32_bf16 v[212:215], a[236:239], v[48:51], v[212:215]
 ds_read_b64_tr_b16 a[232:233], v26 offset:16384
 s_waitcnt lgkmcnt(5)
 v_mfma_f32_16x16x32_bf16 v[220:223], a[236:239], v[52:55], v[220:223]
 ds_read_b64_tr_b16 a[234:235], v26 offset:18432
 v_accvgpr_write_b32 a26, v28
 v_mfma_f32_16x16x32_bf16 v[224:227], a[240:243], v[48:51], v[224:227]
 ds_read_b64_tr_b16 a[236:237], v27 offset:16384
 v_accvgpr_read_b32 v30, a198
 v_mfma_f32_16x16x32_bf16 v[232:235], a[240:243], v[52:55], v[232:235]
 ds_read_b64_tr_b16 a[238:239], v27 offset:18432
 v_accvgpr_read_b32 v31, a199
 v_mfma_f32_16x16x32_bf16 v[228:231], a[244:247], v[48:51], v[228:231]
 ds_read_b64_tr_b16 a[240:241], v24 offset:20480
 v_cvt_pk_bf16_f32 v30, v30, v31
 v_mfma_f32_16x16x32_bf16 v[236:239], a[244:247], v[52:55], v[236:239]
 ds_read_b64_tr_b16 a[242:243], v24 offset:22528
 s_movk_i32 s70, 664
 v_mfma_f32_16x16x32_bf16 v[240:243], a[248:251], v[48:51], v[240:243]
 ds_read_b64_tr_b16 a[244:245], v25 offset:20480
 v_accvgpr_write_b32 a27, v30
 v_mfma_f32_16x16x32_bf16 v[248:251], a[248:251], v[52:55], v[248:251]
 ds_read_b64_tr_b16 a[246:247], v25 offset:22528
 v_accvgpr_read_b32 v28, a200
 v_mfma_f32_16x16x32_bf16 v[244:247], a[252:255], v[48:51], v[244:247]
 ds_read_b64_tr_b16 a[248:249], v26 offset:20480
 s_waitcnt lgkmcnt(5)
 v_mfma_f32_16x16x32_bf16 v[252:255], a[252:255], v[52:55], v[252:255]
 ds_read_b64_tr_b16 a[250:251], v26 offset:22528
 v_accvgpr_read_b32 v29, a201
 v_mfma_f32_16x16x32_bf16 a[64:67], a[224:227], v[64:67], 0
 ds_read_b64_tr_b16 a[252:253], v27 offset:20480
 buffer_load_dword off, s[72:75], s70 lds
 v_cvt_pk_bf16_f32 v28, v28, v29
 v_mfma_f32_16x16x32_bf16 a[72:75], a[224:227], v[68:71], 0
 ds_read_b64_tr_b16 a[254:255], v27 offset:22528
 v_accvgpr_write_b32 a28, v28
 v_mfma_f32_16x16x32_bf16 a[68:71], a[228:231], v[64:67], 0
 ds_read_b64_tr_b16 a[224:225], v24 offset:24576
 v_accvgpr_read_b32 v30, a202
 v_mfma_f32_16x16x32_bf16 a[76:79], a[228:231], v[68:71], 0
 ds_read_b64_tr_b16 a[226:227], v24 offset:26624
 v_accvgpr_read_b32 v31, a203
 v_mfma_f32_16x16x32_bf16 a[80:83], a[232:235], v[64:67], 0
 ds_read_b64_tr_b16 a[228:229], v25 offset:24576
 ds_read_b32 v10, v9
 v_mfma_f32_16x16x32_bf16 a[88:91], a[232:235], v[68:71], 0
 ds_read_b64_tr_b16 a[230:231], v25 offset:26624
 v_cvt_pk_bf16_f32 v30, v30, v31
 v_mfma_f32_16x16x32_bf16 a[84:87], a[236:239], v[64:67], 0
 ds_read_b64_tr_b16 a[232:233], v26 offset:24576
 s_waitcnt lgkmcnt(6)
 v_mfma_f32_16x16x32_bf16 a[92:95], a[236:239], v[68:71], 0
 ds_read_b64_tr_b16 a[234:235], v26 offset:26624
 v_accvgpr_write_b32 a29, v30
 v_mfma_f32_16x16x32_bf16 a[64:67], a[240:243], v[72:75], a[64:67]
 ds_read_b64_tr_b16 a[236:237], v27 offset:24576
 v_accvgpr_read_b32 v28, a204
 v_mfma_f32_16x16x32_bf16 a[72:75], a[240:243], v[76:79], a[72:75]
 ds_read_b64_tr_b16 a[238:239], v27 offset:26624
 v_accvgpr_read_b32 v29, a205
 v_mfma_f32_16x16x32_bf16 a[68:71], a[244:247], v[72:75], a[68:71]
 ds_read_b64_tr_b16 a[240:241], v24 offset:28672
 v_cvt_pk_bf16_f32 v28, v28, v29
 v_mfma_f32_16x16x32_bf16 a[76:79], a[244:247], v[76:79], a[76:79]
 ds_read_b64_tr_b16 a[242:243], v24 offset:30720
 v_accvgpr_write_b32 a30, v28
 v_mfma_f32_16x16x32_bf16 a[80:83], a[248:251], v[72:75], a[80:83]
 ds_read_b64_tr_b16 a[244:245], v25 offset:28672
 v_accvgpr_read_b32 v30, a206
 v_mfma_f32_16x16x32_bf16 a[88:91], a[248:251], v[76:79], a[88:91]
 ds_read_b64_tr_b16 a[246:247], v25 offset:30720
 v_accvgpr_read_b32 v31, a207
 v_mfma_f32_16x16x32_bf16 a[84:87], a[252:255], v[72:75], a[84:87]
 ds_read_b64_tr_b16 a[248:249], v26 offset:28672
 s_waitcnt lgkmcnt(5)
 v_mfma_f32_16x16x32_bf16 a[92:95], a[252:255], v[76:79], a[92:95]
 ds_read_b64_tr_b16 a[250:251], v26 offset:30720
 v_cvt_pk_bf16_f32 v30, v30, v31
 v_mfma_f32_16x16x32_bf16 a[64:67], a[224:227], v[80:83], a[64:67]
 ds_read_b64_tr_b16 a[252:253], v27 offset:28672
 v_cmp_le_u32 vcc, 178, v10
 v_mfma_f32_16x16x32_bf16 a[72:75], a[224:227], v[84:87], a[72:75]
 ds_read_b64_tr_b16 a[254:255], v27 offset:30720
 v_accvgpr_write_b32 a31, v30
 v_mfma_f32_16x16x32_bf16 a[68:71], a[228:231], v[80:83], a[68:71]
 s_cbranch_vccz L_cs1344
L_cb1344:
 ds_read_b128 a[224:227], v3 offset:16384
 v_mfma_f32_16x16x32_bf16 a[76:79], a[228:231], v[84:87], a[76:79]
 v_exp_f32 v32, v32
 v_mfma_f32_16x16x32_bf16 a[80:83], a[232:235], v[80:83], a[80:83]
 ds_read_b128 a[228:231], v3 offset:18432
 v_add_f32 v14, v14, v32
 v_mfma_f32_16x16x32_bf16 a[88:91], a[232:235], v[84:87], a[88:91]
 v_exp_f32 v33, v33
 v_mfma_f32_16x16x32_bf16 a[84:87], a[236:239], v[80:83], a[84:87]
 ds_read_b128 a[232:235], v4 offset:16384
 s_waitcnt lgkmcnt(3)
 v_mfma_f32_16x16x32_bf16 a[92:95], a[236:239], v[84:87], a[92:95]
 v_exp_f32 v34, v34
 v_mfma_f32_16x16x32_bf16 a[64:67], a[240:243], v[88:91], a[64:67]
 ds_read_b128 a[236:239], v4 offset:18432
 v_add_f32 v14, v14, v33
 v_mfma_f32_16x16x32_bf16 a[72:75], a[240:243], v[92:95], a[72:75]
 v_exp_f32 v35, v35
 v_mfma_f32_16x16x32_bf16 a[68:71], a[244:247], v[88:91], a[68:71]
 ds_read_b128 a[240:243], v3 offset:20480
 v_cvt_pk_bf16_f32 v32, v32, v33
 v_mfma_f32_16x16x32_bf16 a[76:79], a[244:247], v[92:95], a[76:79]
 v_exp_f32 v36, v36
 v_mfma_f32_16x16x32_bf16 a[80:83], a[248:251], v[88:91], a[80:83]
 ds_read_b128 a[244:247], v3 offset:22528
 s_movk_i32 s70, 672
 v_mfma_f32_16x16x32_bf16 a[88:91], a[248:251], v[92:95], a[88:91]
 v_exp_f32 v37, v37
 v_mfma_f32_16x16x32_bf16 a[84:87], a[252:255], v[88:91], a[84:87]
 ds_read_b128 a[248:251], v4 offset:20480
 s_waitcnt lgkmcnt(3)
 v_mfma_f32_16x16x32_bf16 a[92:95], a[252:255], v[92:95], a[92:95]
 buffer_load_dword off, s[72:75], s70 lds
 v_mfma_f32_16x16x32_bf16 v[48:51], a[224:227], a[112:115], v[16:19]
 ds_read_b128 a[252:255], v4 offset:22528
 v_add_f32 v14, v14, v34
 v_mfma_f32_16x16x32_bf16 v[56:59], a[224:227], a[116:119], v[20:23]
 v_exp_f32 v38, v38
 v_mfma_f32_16x16x32_bf16 v[52:55], a[228:231], a[112:115], v[16:19]
 ds_read_b128 a[224:227], v3 offset:8192
 v_add_f32 v14, v14, v35
 v_mfma_f32_16x16x32_bf16 v[60:63], a[228:231], a[116:119], v[20:23]
 v_exp_f32 v39, v39
 v_mfma_f32_16x16x32_bf16 v[48:51], a[232:235], a[120:123], v[48:51]
 ds_read_b128 a[228:231], v3 offset:10240
 v_cvt_pk_bf16_f32 v33, v34, v35
 v_mfma_f32_16x16x32_bf16 v[56:59], a[232:235], a[124:127], v[56:59]
 v_exp_f32 v40, v40
 v_mfma_f32_16x16x32_bf16 v[52:55], a[236:239], a[120:123], v[52:55]
 ds_read_b128 a[232:235], v4 offset:8192
 s_waitcnt lgkmcnt(3)
 v_exp_f32 v41, v41
 v_mfma_f32_16x16x32_bf16 v[60:63], a[236:239], a[124:127], v[60:63]
 v_exp_f32 v42, v42
 v_mfma_f32_16x16x32_bf16 v[48:51], a[240:243], a[128:131], v[48:51]
 ds_read_b128 a[236:239], v4 offset:10240
 v_add_f32 v14, v14, v36
 v_mfma_f32_16x16x32_bf16 v[56:59], a[240:243], a[132:135], v[56:59]
 v_exp_f32 v43, v43
 v_mfma_f32_16x16x32_bf16 v[52:55], a[244:247], a[128:131], v[52:55]
 ds_read_b128 a[240:243], v3 offset:12288
 v_add_f32 v14, v14, v37
 v_mfma_f32_16x16x32_bf16 v[60:63], a[244:247], a[132:135], v[60:63]
 v_exp_f32 v44, v44
 v_mfma_f32_16x16x32_bf16 v[48:51], a[248:251], a[136:139], v[48:51]
 ds_read_b128 a[244:247], v3 offset:14336
 v_cvt_pk_bf16_f32 v34, v36, v37
 v_mfma_f32_16x16x32_bf16 v[56:59], a[248:251], a[140:143], v[56:59]
 v_exp_f32 v45, v45
 v_mfma_f32_16x16x32_bf16 v[52:55], a[252:255], a[136:139], v[52:55]
 ds_read_b128 a[248:251], v4 offset:12288
 s_waitcnt lgkmcnt(3)
 v_mfma_f32_16x16x32_bf16 v[60:63], a[252:255], a[140:143], v[60:63]
 v_exp_f32 v46, v46
 v_mfma_f32_16x16x32_bf16 v[48:51], a[224:227], a[144:147], v[48:51]
 ds_read_b128 a[252:255], v4 offset:14336
 v_add_f32 v14, v14, v38
 v_mfma_f32_16x16x32_bf16 v[56:59], a[224:227], a[148:151], v[56:59]
 v_exp_f32 v47, v47
 v_mfma_f32_16x16x32_bf16 v[52:55], a[228:231], a[144:147], v[52:55]
 ds_read_b64_tr_b16 a[224:225], v5 offset:24576
 v_add_f32 v14, v14, v39
 v_mfma_f32_16x16x32_bf16 v[60:63], a[228:231], a[148:151], v[60:63]
 ds_read_b64_tr_b16 a[226:227], v5 offset:26624
 v_cvt_pk_bf16_f32 v35, v38, v39
 v_mfma_f32_16x16x32_bf16 v[48:51], a[232:235], a[152:155], v[48:51]
 ds_read_b64_tr_b16 a[228:229], v6 offset:24576
 ds_read_b32 v10, v9
 v_add_f32 v15, v15, v40
 v_mfma_f32_16x16x32_bf16 v[56:59], a[232:235], a[156:159], v[56:59]
 ds_read_b64_tr_b16 a[230:231], v6 offset:26624
 v_add_f32 v15, v15, v41
 v_mfma_f32_16x16x32_bf16 v[52:55], a[236:239], a[152:155], v[52:55]
 ds_read_b64_tr_b16 a[232:233], v7 offset:24576
 s_waitcnt lgkmcnt(6)
 v_cvt_pk_bf16_f32 v36, v40, v41
 v_mfma_f32_16x16x32_bf16 v[60:63], a[236:239], a[156:159], v[60:63]
 ds_read_b64_tr_b16 a[234:235], v7 offset:26624
 v_add_f32 v15, v15, v42
 v_mfma_f32_16x16x32_bf16 v[48:51], a[240:243], a[160:163], v[48:51]
 ds_read_b64_tr_b16 a[236:237], v8 offset:24576
 v_add_f32 v15, v15, v43
 v_mfma_f32_16x16x32_bf16 v[56:59], a[240:243], a[164:167], v[56:59]
 ds_read_b64_tr_b16 a[238:239], v8 offset:26624
 v_cvt_pk_bf16_f32 v37, v42, v43
 v_mfma_f32_16x16x32_bf16 v[52:55], a[244:247], a[160:163], v[52:55]
 ds_read_b64_tr_b16 a[240:241], v5 offset:28672
 v_add_f32 v15, v15, v44
 v_mfma_f32_16x16x32_bf16 v[60:63], a[244:247], a[164:167], v[60:63]
 ds_read_b64_tr_b16 a[242:243], v5 offset:30720
 v_add_f32 v15, v15, v45
 v_mfma_f32_16x16x32_bf16 v[48:51], a[248:251], a[168:171], v[48:51]
 ds_read_b64_tr_b16 a[244:245], v6 offset:28672
 v_cvt_pk_bf16_f32 v38, v44, v45
 v_mfma_f32_16x16x32_bf16 v[56:59], a[248:251], a[172:175], v[56:59]
 ds_read_b64_tr_b16 a[246:247], v6 offset:30720
 v_add_f32 v15, v15, v46
 v_mfma_f32_16x16x32_bf16 v[52:55], a[252:255], a[168:171], v[52:55]
 ds_read_b64_tr_b16 a[248:249], v7 offset:28672
 v_add_f32 v15, v15, v47
 v_cvt_pk_bf16_f32 v39, v46, v47
 v_mfma_f32_16x16x32_bf16 v[60:63], a[252:255], a[172:175], v[60:63]
 ds_read_b64_tr_b16 a[250:251], v7 offset:30720
 s_waitcnt lgkmcnt(6)
 s_movk_i32 s70, 680
 buffer_load_dword off, s[72:75], s70 lds
 v_mfma_f32_16x16x32_bf16 v[128:131], a[224:227], v[32:35], v[128:131]
 ds_read_b64_tr_b16 a[252:253], v8 offset:28672
 v_cmp_le_u32 vcc, 179, v10
 v_mfma_f32_16x16x32_bf16 v[136:139], a[224:227], v[36:39], v[136:139]
 ds_read_b64_tr_b16 a[254:255], v8 offset:30720
 v_add_u32 v5, 0xffff0000, v5
 v_mfma_f32_16x16x32_bf16 v[132:135], a[228:231], v[32:35], v[132:135]
 s_cbranch_vccz L_cs1368
L_cb1368:
 ds_read_b64_tr_b16 a[224:225], v5 offset:49152
 v_add_u32 v6, 0xffff0000, v6
 v_mfma_f32_16x16x32_bf16 v[140:143], a[228:231], v[36:39], v[140:143]
 ds_read_b64_tr_b16 a[226:227], v5 offset:51200
 v_add_u32 v7, 0xffff0000, v7
 v_mfma_f32_16x16x32_bf16 v[144:147], a[232:235], v[32:35], v[144:147]
 ds_read_b64_tr_b16 a[228:229], v6 offset:49152
 ds_read_b32 v10, v9
 v_add_u32 v8, 0xffff0000, v8
 v_mfma_f32_16x16x32_bf16 v[152:155], a[232:235], v[36:39], v[152:155]
 ds_read_b64_tr_b16 a[230:231], v6 offset:51200
 v_max3_f32 v11, v48, v49, v50
 v_mfma_f32_16x16x32_bf16 v[148:151], a[236:239], v[32:35], v[148:151]
 ds_read_b64_tr_b16 a[232:233], v7 offset:49152
 s_waitcnt lgkmcnt(6)
 v_max3_f32 v12, v56, v57, v58
 v_mfma_f32_16x16x32_bf16 v[156:159], a[236:239], v[36:39], v[156:159]
 ds_read_b64_tr_b16 a[234:235], v7 offset:51200
 v_max3_f32 v11, v11, v51, v52
 v_mfma_f32_16x16x32_bf16 v[160:163], a[240:243], v[32:35], v[160:163]
 ds_read_b64_tr_b16 a[236:237], v8 offset:49152
 v_max3_f32 v12, v12, v59, v60
 v_mfma_f32_16x16x32_bf16 v[168:171], a[240:243], v[36:39], v[168:171]
 ds_read_b64_tr_b16 a[238:239], v8 offset:51200
 v_max3_f32 v11, v11, v53, v54
 v_mfma_f32_16x16x32_bf16 v[164:167], a[244:247], v[32:35], v[164:167]
 ds_read_b64_tr_b16 a[240:241], v5 offset:53248
 v_max3_f32 v12, v12, v61, v62
 v_mfma_f32_16x16x32_bf16 v[172:175], a[244:247], v[36:39], v[172:175]
 ds_read_b64_tr_b16 a[242:243], v5 offset:55296
 v_max_f32 v11, v11, v55
 v_mfma_f32_16x16x32_bf16 v[176:179], a[248:251], v[32:35], v[176:179]
 ds_read_b64_tr_b16 a[244:245], v6 offset:53248
 v_max_f32 v12, v12, v63
 v_mfma_f32_16x16x32_bf16 v[184:187], a[248:251], v[36:39], v[184:187]
 ds_read_b64_tr_b16 a[246:247], v6 offset:55296
 v_max_f32 v13, v11, v12
 v_cmp_lt_f32 vcc, 0x41200000, v13
 v_mfma_f32_16x16x32_bf16 v[180:183], a[252:255], v[32:35], v[180:183]
 ds_read_b64_tr_b16 a[248:249], v7 offset:53248
 s_waitcnt lgkmcnt(5)
 s_cbranch_vccnz L_rs1_9
L_rb1_9:
 v_mfma_f32_16x16x32_bf16 v[188:191], a[252:255], v[36:39], v[188:191]
 ds_read_b64_tr_b16 a[250:251], v7 offset:55296
 v_accvgpr_read_b32 v28, a96
 v_mfma_f32_16x16x32_bf16 v[192:195], a[224:227], v[32:35], v[192:195]
 ds_read_b64_tr_b16 a[252:253], v8 offset:53248
 v_cmp_le_u32 vcc, 181, v10
 v_mfma_f32_16x16x32_bf16 v[200:203], a[224:227], v[36:39], v[200:203]
 ds_read_b64_tr_b16 a[254:255], v8 offset:55296
 v_accvgpr_read_b32 v29, a97
 v_mfma_f32_16x16x32_bf16 v[196:199], a[228:231], v[32:35], v[196:199]
 s_cbranch_vccz L_cs1376
L_cb1376:
 ds_read_b64_tr_b16 a[224:225], v24 offset:40960
 v_mfma_f32_16x16x32_bf16 v[204:207], a[228:231], v[36:39], v[204:207]
 ds_read_b64_tr_b16 a[226:227], v24 offset:43008
 v_cvt_pk_bf16_f32 v28, v28, v29
 v_mfma_f32_16x16x32_bf16 v[208:211], a[232:235], v[32:35], v[208:211]
 ds_read_b64_tr_b16 a[228:229], v25 offset:40960
 v_accvgpr_write_b32 a32, v28
 v_mfma_f32_16x16x32_bf16 v[216:219], a[232:235], v[36:39], v[216:219]
 ds_read_b64_tr_b16 a[230:231], v25 offset:43008
 v_accvgpr_read_b32 v30, a98
 v_mfma_f32_16x16x32_bf16 v[212:215], a[236:239], v[32:35], v[212:215]
 ds_read_b64_tr_b16 a[232:233], v26 offset:40960
 s_waitcnt lgkmcnt(5)
 v_mfma_f32_16x16x32_bf16 v[220:223], a[236:239], v[36:39], v[220:223]
 ds_read_b64_tr_b16 a[234:235], v26 offset:43008
 v_accvgpr_read_b32 v31, a99
 v_mfma_f32_16x16x32_bf16 v[224:227], a[240:243], v[32:35], v[224:227]
 ds_read_b64_tr_b16 a[236:237], v27 offset:40960
 v_cvt_pk_bf16_f32 v30, v30, v31
 v_mfma_f32_16x16x32_bf16 v[232:235], a[240:243], v[36:39], v[232:235]
 ds_read_b64_tr_b16 a[238:239], v27 offset:43008
 v_accvgpr_write_b32 a33, v30
 v_mfma_f32_16x16x32_bf16 v[228:231], a[244:247], v[32:35], v[228:231]
 ds_read_b64_tr_b16 a[240:241], v24 offset:45056
 v_accvgpr_read_b32 v28, a100
 v_mfma_f32_16x16x32_bf16 v[236:239], a[244:247], v[36:39], v[236:239]
 ds_read_b64_tr_b16 a[242:243], v24 offset:47104
 s_movk_i32 s70, 688
 v_mfma_f32_16x16x32_bf16 v[240:243], a[248:251], v[32:35], v[240:243]
 ds_read_b64_tr_b16 a[244:245], v25 offset:45056
 v_accvgpr_read_b32 v29, a101
 v_mfma_f32_16x16x32_bf16 v[248:251], a[248:251], v[36:39], v[248:251]
 ds_read_b64_tr_b16 a[246:247], v25 offset:47104
 v_cvt_pk_bf16_f32 v28, v28, v29
 v_mfma_f32_16x16x32_bf16 v[244:247], a[252:255], v[32:35], v[244:247]
 ds_read_b64_tr_b16 a[248:249], v26 offset:45056
 s_waitcnt lgkmcnt(5)
 v_mfma_f32_16x16x32_bf16 v[252:255], a[252:255], v[36:39], v[252:255]
 ds_read_b64_tr_b16 a[250:251], v26 offset:47104
 v_accvgpr_write_b32 a34, v28
 v_mfma_f32_16x16x32_bf16 a[64:67], a[224:227], v[96:99], a[64:67]
 ds_read_b64_tr_b16 a[252:253], v27 offset:45056
 buffer_load_dword off, s[72:75], s70 lds
 v_accvgpr_read_b32 v30, a102
 v_mfma_f32_16x16x32_bf16 a[72:75], a[224:227], v[100:103], a[72:75]
 ds_read_b64_tr_b16 a[254:255], v27 offset:47104
 v_accvgpr_read_b32 v31, a103
 v_mfma_f32_16x16x32_bf16 a[68:71], a[228:231], v[96:99], a[68:71]
 ds_read_b64_tr_b16 a[224:225], v24 offset:32768
 v_cvt_pk_bf16_f32 v30, v30, v31
 v_mfma_f32_16x16x32_bf16 a[76:79], a[228:231], v[100:103], a[76:79]
 ds_read_b64_tr_b16 a[226:227], v24 offset:34816
 v_accvgpr_write_b32 a35, v30
 v_mfma_f32_16x16x32_bf16 a[80:83], a[232:235], v[96:99], a[80:83]
 ds_read_b64_tr_b16 a[228:229], v25 offset:32768
 ds_read_b32 v10, v9
 v_mfma_f32_16x16x32_bf16 a[88:91], a[232:235], v[100:103], a[88:91]
 ds_read_b64_tr_b16 a[230:231], v25 offset:34816
 v_accvgpr_read_b32 v28, a104
 v_mfma_f32_16x16x32_bf16 a[84:87], a[236:239], v[96:99], a[84:87]
 ds_read_b64_tr_b16 a[232:233], v26 offset:32768
 s_waitcnt lgkmcnt(6)
 v_mfma_f32_16x16x32_bf16 a[92:95], a[236:239], v[100:103], a[92:95]
 ds_read_b64_tr_b16 a[234:235], v26 offset:34816
 v_accvgpr_read_b32 v29, a105
 v_mfma_f32_16x16x32_bf16 a[64:67], a[240:243], v[104:107], a[64:67]
 ds_read_b64_tr_b16 a[236:237], v27 offset:32768
 v_cvt_pk_bf16_f32 v28, v28, v29
 v_mfma_f32_16x16x32_bf16 a[72:75], a[240:243], v[108:111], a[72:75]
 ds_read_b64_tr_b16 a[238:239], v27 offset:34816
 v_accvgpr_write_b32 a36, v28
 v_mfma_f32_16x16x32_bf16 a[68:71], a[244:247], v[104:107], a[68:71]
 ds_read_b64_tr_b16 a[240:241], v24 offset:36864
 v_accvgpr_read_b32 v30, a106
 v_mfma_f32_16x16x32_bf16 a[76:79], a[244:247], v[108:111], a[76:79]
 ds_read_b64_tr_b16 a[242:243], v24 offset:38912
 v_accvgpr_read_b32 v31, a107
 v_mfma_f32_16x16x32_bf16 a[80:83], a[248:251], v[104:107], a[80:83]
 ds_read_b64_tr_b16 a[244:245], v25 offset:36864
 v_cvt_pk_bf16_f32 v30, v30, v31
 v_mfma_f32_16x16x32_bf16 a[88:91], a[248:251], v[108:111], a[88:91]
 ds_read_b64_tr_b16 a[246:247], v25 offset:38912
 v_accvgpr_write_b32 a37, v30
 v_mfma_f32_16x16x32_bf16 a[84:87], a[252:255], v[104:107], a[84:87]
 ds_read_b64_tr_b16 a[248:249], v26 offset:36864
 s_waitcnt lgkmcnt(5)
 v_mfma_f32_16x16x32_bf16 a[92:95], a[252:255], v[108:111], a[92:95]
 ds_read_b64_tr_b16 a[250:251], v26 offset:38912
 v_accvgpr_read_b32 v28, a108
 v_mfma_f32_16x16x32_bf16 a[64:67], a[224:227], v[112:115], a[64:67]
 ds_read_b64_tr_b16 a[252:253], v27 offset:36864
 v_cmp_le_u32 vcc, 184, v10
 v_mfma_f32_16x16x32_bf16 a[72:75], a[224:227], v[116:119], a[72:75]
 ds_read_b64_tr_b16 a[254:255], v27 offset:38912
 v_accvgpr_read_b32 v29, a109
 v_mfma_f32_16x16x32_bf16 a[68:71], a[228:231], v[112:115], a[68:71]
 s_cbranch_vccz L_cs1392
L_cb1392:
 ds_read_b128 a[224:227], v3 offset:32768
 v_mfma_f32_16x16x32_bf16 a[76:79], a[228:231], v[116:119], a[76:79]
 v_exp_f32 v48, v48
 v_mfma_f32_16x16x32_bf16 a[80:83], a[232:235], v[112:115], a[80:83]
 ds_read_b128 a[228:231], v3 offset:34816
 v_add_f32 v14, v14, v48
 v_mfma_f32_16x16x32_bf16 a[88:91], a[232:235], v[116:119], a[88:91]
 v_exp_f32 v49, v49
 v_mfma_f32_16x16x32_bf16 a[84:87], a[236:239], v[112:115], a[84:87]
 ds_read_b128 a[232:235], v4 offset:32768
 s_waitcnt lgkmcnt(3)
 v_mfma_f32_16x16x32_bf16 a[92:95], a[236:239], v[116:119], a[92:95]
 v_exp_f32 v50, v50
 v_mfma_f32_16x16x32_bf16 a[64:67], a[240:243], v[120:123], a[64:67]
 ds_read_b128 a[236:239], v4 offset:34816
 v_add_f32 v14, v14, v49
 v_mfma_f32_16x16x32_bf16 a[72:75], a[240:243], v[124:127], a[72:75]
 v_exp_f32 v51, v51
 v_mfma_f32_16x16x32_bf16 a[68:71], a[244:247], v[120:123], a[68:71]
 ds_read_b128 a[240:243], v3 offset:36864
 v_add_u32 v5, 0x10000, v5
 v_mfma_f32_16x16x32_bf16 a[76:79], a[244:247], v[124:127], a[76:79]
 v_exp_f32 v52, v52
 v_mfma_f32_16x16x32_bf16 a[80:83], a[248:251], v[120:123], a[80:83]
 ds_read_b128 a[244:247], v3 offset:38912
 s_movk_i32 s70, 696
 v_mfma_f32_16x16x32_bf16 a[88:91], a[248:251], v[124:127], a[88:91]
 v_exp_f32 v53, v53
 v_mfma_f32_16x16x32_bf16 a[84:87], a[252:255], v[120:123], a[84:87]
 ds_read_b128 a[248:251], v4 offset:36864
 s_waitcnt lgkmcnt(3)
 v_add_u32 v3, 0xffff0000, v3
 v_add_u32 v6, 0x10000, v6
 v_mfma_f32_16x16x32_bf16 a[92:95], a[252:255], v[124:127], a[92:95]
 buffer_load_dword off, s[72:75], s70 lds
 v_add_u32 v7, 0x10000, v7
 v_exp_f32 v54, v54
 v_mfma_f32_16x16x32_bf16 v[32:35], a[224:227], a[112:115], v[16:19]
 ds_read_b128 a[252:255], v4 offset:38912
 v_add_u32 v4, 0xffff0000, v4
 v_add_u32 v8, 0x10000, v8
 v_mfma_f32_16x16x32_bf16 v[40:43], a[224:227], a[116:119], v[20:23]
 v_exp_f32 v55, v55
 v_mfma_f32_16x16x32_bf16 v[36:39], a[228:231], a[112:115], v[16:19]
 ds_read_b128 a[224:227], v3 offset:57344
 v_cvt_pk_bf16_f32 v48, v48, v49
 v_mfma_f32_16x16x32_bf16 v[44:47], a[228:231], a[116:119], v[20:23]
 v_exp_f32 v56, v56
 v_mfma_f32_16x16x32_bf16 v[32:35], a[232:235], a[120:123], v[32:35]
 ds_read_b128 a[228:231], v3 offset:59392
 v_add_f32 v14, v14, v50
 v_mfma_f32_16x16x32_bf16 v[40:43], a[232:235], a[124:127], v[40:43]
 v_exp_f32 v57, v57
 v_mfma_f32_16x16x32_bf16 v[36:39], a[236:239], a[120:123], v[36:39]
 ds_read_b128 a[232:235], v4 offset:57344
 s_waitcnt lgkmcnt(3)
 v_exp_f32 v58, v58
 v_mfma_f32_16x16x32_bf16 v[44:47], a[236:239], a[124:127], v[44:47]
 v_exp_f32 v59, v59
 v_mfma_f32_16x16x32_bf16 v[32:35], a[240:243], a[128:131], v[32:35]
 ds_read_b128 a[236:239], v4 offset:59392
 v_add_f32 v14, v14, v51
 v_mfma_f32_16x16x32_bf16 v[40:43], a[240:243], a[132:135], v[40:43]
 v_exp_f32 v60, v60
 v_mfma_f32_16x16x32_bf16 v[36:39], a[244:247], a[128:131], v[36:39]
 ds_read_b128 a[240:243], v3 offset:61440
 v_cvt_pk_bf16_f32 v49, v50, v51
 v_mfma_f32_16x16x32_bf16 v[44:47], a[244:247], a[132:135], v[44:47]
 v_exp_f32 v61, v61
 v_mfma_f32_16x16x32_bf16 v[32:35], a[248:251], a[136:139], v[32:35]
 ds_read_b128 a[244:247], v3 offset:63488
 v_add_f32 v14, v14, v52
 v_mfma_f32_16x16x32_bf16 v[40:43], a[248:251], a[140:143], v[40:43]
 v_exp_f32 v62, v62
 v_mfma_f32_16x16x32_bf16 v[36:39], a[252:255], a[136:139], v[36:39]
 ds_read_b128 a[248:251], v4 offset:61440
 s_waitcnt lgkmcnt(3)
 v_mfma_f32_16x16x32_bf16 v[44:47], a[252:255], a[140:143], v[44:47]
 v_exp_f32 v63, v63
 v_mfma_f32_16x16x32_bf16 v[32:35], a[224:227], a[144:147], v[32:35]
 ds_read_b128 a[252:255], v4 offset:63488
 v_add_f32 v14, v14, v53
 v_mfma_f32_16x16x32_bf16 v[40:43], a[224:227], a[148:151], v[40:43]
 v_cvt_pk_bf16_f32 v50, v52, v53
 v_add_f32 v14, v14, v54
 v_mfma_f32_16x16x32_bf16 v[36:39], a[228:231], a[144:147], v[36:39]
 ds_read_b64_tr_b16 a[224:225], v5 offset:40960
 v_add_f32 v14, v14, v55
 v_mfma_f32_16x16x32_bf16 v[44:47], a[228:231], a[148:151], v[44:47]
 ds_read_b64_tr_b16 a[226:227], v5 offset:43008
 v_cvt_pk_bf16_f32 v51, v54, v55
 v_mfma_f32_16x16x32_bf16 v[32:35], a[232:235], a[152:155], v[32:35]
 ds_read_b64_tr_b16 a[228:229], v6 offset:40960
 ds_read_b32 v10, v9
 v_add_f32 v15, v15, v56
 v_mfma_f32_16x16x32_bf16 v[40:43], a[232:235], a[156:159], v[40:43]
 ds_read_b64_tr_b16 a[230:231], v6 offset:43008
 v_add_f32 v15, v15, v57
 v_mfma_f32_16x16x32_bf16 v[36:39], a[236:239], a[152:155], v[36:39]
 ds_read_b64_tr_b16 a[232:233], v7 offset:40960
 s_waitcnt lgkmcnt(6)
 v_cvt_pk_bf16_f32 v52, v56, v57
 v_mfma_f32_16x16x32_bf16 v[44:47], a[236:239], a[156:159], v[44:47]
 ds_read_b64_tr_b16 a[234:235], v7 offset:43008
 v_add_f32 v15, v15, v58
 v_mfma_f32_16x16x32_bf16 v[32:35], a[240:243], a[160:163], v[32:35]
 ds_read_b64_tr_b16 a[236:237], v8 offset:40960
 v_add_f32 v15, v15, v59
 v_mfma_f32_16x16x32_bf16 v[40:43], a[240:243], a[164:167], v[40:43]
 ds_read_b64_tr_b16 a[238:239], v8 offset:43008
 v_cvt_pk_bf16_f32 v53, v58, v59
 v_mfma_f32_16x16x32_bf16 v[36:39], a[244:247], a[160:163], v[36:39]
 ds_read_b64_tr_b16 a[240:241], v5 offset:45056
 v_add_f32 v15, v15, v60
 v_mfma_f32_16x16x32_bf16 v[44:47], a[244:247], a[164:167], v[44:47]
 ds_read_b64_tr_b16 a[242:243], v5 offset:47104
 v_add_f32 v15, v15, v61
 v_mfma_f32_16x16x32_bf16 v[32:35], a[248:251], a[168:171], v[32:35]
 ds_read_b64_tr_b16 a[244:245], v6 offset:45056
 v_cvt_pk_bf16_f32 v54, v60, v61
 v_mfma_f32_16x16x32_bf16 v[40:43], a[248:251], a[172:175], v[40:43]
 ds_read_b64_tr_b16 a[246:247], v6 offset:47104
 v_add_f32 v15, v15, v62
 v_mfma_f32_16x16x32_bf16 v[36:39], a[252:255], a[168:171], v[36:39]
 ds_read_b64_tr_b16 a[248:249], v7 offset:45056
 v_add_f32 v15, v15, v63
 v_cvt_pk_bf16_f32 v55, v62, v63
 v_mfma_f32_16x16x32_bf16 v[44:47], a[252:255], a[172:175], v[44:47]
 ds_read_b64_tr_b16 a[250:251], v7 offset:47104
 s_waitcnt lgkmcnt(6)
 s_movk_i32 s70, 704
 v_mfma_f32_16x16x32_bf16 v[128:131], a[224:227], v[48:51], v[128:131]
 ds_read_b64_tr_b16 a[252:253], v8 offset:45056
 buffer_load_dword off, s[72:75], s70 lds
 v_cmp_le_u32 vcc, 185, v10
 v_mfma_f32_16x16x32_bf16 v[136:139], a[224:227], v[52:55], v[136:139]
 ds_read_b64_tr_b16 a[254:255], v8 offset:47104
 v_cvt_pk_bf16_f32 v28, v28, v29
 v_mfma_f32_16x16x32_bf16 v[132:135], a[228:231], v[48:51], v[132:135]
 s_cbranch_vccz L_cs1416
L_cb1416:
 ds_read_b64_tr_b16 a[224:225], v5 offset:49152
 v_mfma_f32_16x16x32_bf16 v[140:143], a[228:231], v[52:55], v[140:143]
 ds_read_b64_tr_b16 a[226:227], v5 offset:51200
 v_max3_f32 v11, v32, v33, v34
 v_mfma_f32_16x16x32_bf16 v[144:147], a[232:235], v[48:51], v[144:147]
 ds_read_b64_tr_b16 a[228:229], v6 offset:49152
 ds_read_b32 v10, v9
 v_mfma_f32_16x16x32_bf16 v[152:155], a[232:235], v[52:55], v[152:155]
 ds_read_b64_tr_b16 a[230:231], v6 offset:51200
 v_max3_f32 v12, v40, v41, v42
 v_mfma_f32_16x16x32_bf16 v[148:151], a[236:239], v[48:51], v[148:151]
 ds_read_b64_tr_b16 a[232:233], v7 offset:49152
 s_waitcnt lgkmcnt(6)
 v_mfma_f32_16x16x32_bf16 v[156:159], a[236:239], v[52:55], v[156:159]
 ds_read_b64_tr_b16 a[234:235], v7 offset:51200
 v_max3_f32 v11, v11, v35, v36
 v_mfma_f32_16x16x32_bf16 v[160:163], a[240:243], v[48:51], v[160:163]
 ds_read_b64_tr_b16 a[236:237], v8 offset:49152
 v_max3_f32 v12, v12, v43, v44
 v_mfma_f32_16x16x32_bf16 v[168:171], a[240:243], v[52:55], v[168:171]
 ds_read_b64_tr_b16 a[238:239], v8 offset:51200
 v_max3_f32 v11, v11, v37, v38
 v_mfma_f32_16x16x32_bf16 v[164:167], a[244:247], v[48:51], v[164:167]
 ds_read_b64_tr_b16 a[240:241], v5 offset:53248
 v_max3_f32 v12, v12, v45, v46
 v_mfma_f32_16x16x32_bf16 v[172:175], a[244:247], v[52:55], v[172:175]
 ds_read_b64_tr_b16 a[242:243], v5 offset:55296
 v_max_f32 v11, v11, v39
 v_mfma_f32_16x16x32_bf16 v[176:179], a[248:251], v[48:51], v[176:179]
 ds_read_b64_tr_b16 a[244:245], v6 offset:53248
 v_max_f32 v12, v12, v47
 v_mfma_f32_16x16x32_bf16 v[184:187], a[248:251], v[52:55], v[184:187]
 ds_read_b64_tr_b16 a[246:247], v6 offset:55296
 v_max_f32 v13, v11, v12
 v_cmp_lt_f32 vcc, 0x41200000, v13
 v_mfma_f32_16x16x32_bf16 v[180:183], a[252:255], v[48:51], v[180:183]
 ds_read_b64_tr_b16 a[248:249], v7 offset:53248
 s_waitcnt lgkmcnt(5)
 s_cbranch_vccnz L_rs1_10
L_rb1_10:
 v_mfma_f32_16x16x32_bf16 v[188:191], a[252:255], v[52:55], v[188:191]
 ds_read_b64_tr_b16 a[250:251], v7 offset:55296
 v_accvgpr_write_b32 a38, v28
 v_mfma_f32_16x16x32_bf16 v[192:195], a[224:227], v[48:51], v[192:195]
 ds_read_b64_tr_b16 a[252:253], v8 offset:53248
 v_cmp_le_u32 vcc, 187, v10
 v_mfma_f32_16x16x32_bf16 v[200:203], a[224:227], v[52:55], v[200:203]
 ds_read_b64_tr_b16 a[254:255], v8 offset:55296
 v_accvgpr_read_b32 v30, a110
 v_mfma_f32_16x16x32_bf16 v[196:199], a[228:231], v[48:51], v[196:199]
 s_cbranch_vccz L_cs1424
L_cb1424:
 ds_read_b64_tr_b16 a[224:225], v24 offset:0
 v_mfma_f32_16x16x32_bf16 v[204:207], a[228:231], v[52:55], v[204:207]
 ds_read_b64_tr_b16 a[226:227], v24 offset:2048
 v_accvgpr_read_b32 v31, a111
 v_mfma_f32_16x16x32_bf16 v[208:211], a[232:235], v[48:51], v[208:211]
 ds_read_b64_tr_b16 a[228:229], v25 offset:0
 v_cvt_pk_bf16_f32 v30, v30, v31
 v_mfma_f32_16x16x32_bf16 v[216:219], a[232:235], v[52:55], v[216:219]
 ds_read_b64_tr_b16 a[230:231], v25 offset:2048
 v_accvgpr_write_b32 a39, v30
 v_mfma_f32_16x16x32_bf16 v[212:215], a[236:239], v[48:51], v[212:215]
 ds_read_b64_tr_b16 a[232:233], v26 offset:0
 s_waitcnt lgkmcnt(5)
 v_mfma_f32_16x16x32_bf16 v[220:223], a[236:239], v[52:55], v[220:223]
 ds_read_b64_tr_b16 a[234:235], v26 offset:2048
 v_accvgpr_read_b32 v28, a208
 v_mfma_f32_16x16x32_bf16 v[224:227], a[240:243], v[48:51], v[224:227]
 ds_read_b64_tr_b16 a[236:237], v27 offset:0
 v_accvgpr_read_b32 v29, a209
 v_mfma_f32_16x16x32_bf16 v[232:235], a[240:243], v[52:55], v[232:235]
 ds_read_b64_tr_b16 a[238:239], v27 offset:2048
 v_cvt_pk_bf16_f32 v28, v28, v29
 v_mfma_f32_16x16x32_bf16 v[228:231], a[244:247], v[48:51], v[228:231]
 ds_read_b64_tr_b16 a[240:241], v24 offset:4096
 v_add_u32 v3, 0x20000, v3
 v_mfma_f32_16x16x32_bf16 v[236:239], a[244:247], v[52:55], v[236:239]
 ds_read_b64_tr_b16 a[242:243], v24 offset:6144
 s_movk_i32 s70, 712
 v_mfma_f32_16x16x32_bf16 v[240:243], a[248:251], v[48:51], v[240:243]
 ds_read_b64_tr_b16 a[244:245], v25 offset:4096
 v_accvgpr_write_b32 a40, v28
 v_mfma_f32_16x16x32_bf16 v[248:251], a[248:251], v[52:55], v[248:251]
 ds_read_b64_tr_b16 a[246:247], v25 offset:6144
 v_accvgpr_read_b32 v30, a210
 v_mfma_f32_16x16x32_bf16 v[244:247], a[252:255], v[48:51], v[244:247]
 ds_read_b64_tr_b16 a[248:249], v26 offset:4096
 s_waitcnt lgkmcnt(5)
 v_mfma_f32_16x16x32_bf16 v[252:255], a[252:255], v[52:55], v[252:255]
 ds_read_b64_tr_b16 a[250:251], v26 offset:6144
 v_add_u32 v4, 0x20000, v4
 v_mfma_f32_16x16x32_bf16 a[176:179], a[224:227], v[64:67], 0
 ds_read_b64_tr_b16 a[252:253], v27 offset:4096
 buffer_load_dword off, s[72:75], s70 lds
 v_accvgpr_read_b32 v31, a211
 v_mfma_f32_16x16x32_bf16 a[184:187], a[224:227], v[68:71], 0
 ds_read_b64_tr_b16 a[254:255], v27 offset:6144
 v_cvt_pk_bf16_f32 v30, v30, v31
 v_mfma_f32_16x16x32_bf16 a[180:183], a[228:231], v[64:67], 0
 ds_read_b64_tr_b16 a[224:225], v24 offset:8192
 v_accvgpr_write_b32 a41, v30
 v_mfma_f32_16x16x32_bf16 a[188:191], a[228:231], v[68:71], 0
 ds_read_b64_tr_b16 a[226:227], v24 offset:10240
 v_accvgpr_read_b32 v28, a212
 v_mfma_f32_16x16x32_bf16 a[192:195], a[232:235], v[64:67], 0
 ds_read_b64_tr_b16 a[228:229], v25 offset:8192
 ds_read_b32 v10, v9
 v_mfma_f32_16x16x32_bf16 a[200:203], a[232:235], v[68:71], 0
 ds_read_b64_tr_b16 a[230:231], v25 offset:10240
 v_accvgpr_read_b32 v29, a213
 v_mfma_f32_16x16x32_bf16 a[196:199], a[236:239], v[64:67], 0
 ds_read_b64_tr_b16 a[232:233], v26 offset:8192
 s_waitcnt lgkmcnt(6)
 v_mfma_f32_16x16x32_bf16 a[204:207], a[236:239], v[68:71], 0
 ds_read_b64_tr_b16 a[234:235], v26 offset:10240
 v_cvt_pk_bf16_f32 v28, v28, v29
 v_mfma_f32_16x16x32_bf16 a[176:179], a[240:243], v[72:75], a[176:179]
 ds_read_b64_tr_b16 a[236:237], v27 offset:8192
 v_accvgpr_write_b32 a42, v28
 v_mfma_f32_16x16x32_bf16 a[184:187], a[240:243], v[76:79], a[184:187]
 ds_read_b64_tr_b16 a[238:239], v27 offset:10240
 v_accvgpr_read_b32 v30, a214
 v_mfma_f32_16x16x32_bf16 a[180:183], a[244:247], v[72:75], a[180:183]
 ds_read_b64_tr_b16 a[240:241], v24 offset:12288
 v_accvgpr_read_b32 v31, a215
 v_mfma_f32_16x16x32_bf16 a[188:191], a[244:247], v[76:79], a[188:191]
 ds_read_b64_tr_b16 a[242:243], v24 offset:14336
 v_cvt_pk_bf16_f32 v30, v30, v31
 v_mfma_f32_16x16x32_bf16 a[192:195], a[248:251], v[72:75], a[192:195]
 ds_read_b64_tr_b16 a[244:245], v25 offset:12288
 v_accvgpr_write_b32 a43, v30
 v_mfma_f32_16x16x32_bf16 a[200:203], a[248:251], v[76:79], a[200:203]
 ds_read_b64_tr_b16 a[246:247], v25 offset:14336
 v_accvgpr_read_b32 v28, a216
 v_mfma_f32_16x16x32_bf16 a[196:199], a[252:255], v[72:75], a[196:199]
 ds_read_b64_tr_b16 a[248:249], v26 offset:12288
 s_waitcnt lgkmcnt(5)
 v_mfma_f32_16x16x32_bf16 a[204:207], a[252:255], v[76:79], a[204:207]
 ds_read_b64_tr_b16 a[250:251], v26 offset:14336
 v_accvgpr_read_b32 v29, a217
 v_mfma_f32_16x16x32_bf16 a[176:179], a[224:227], v[80:83], a[176:179]
 ds_read_b64_tr_b16 a[252:253], v27 offset:12288
 v_cmp_le_u32 vcc, 190, v10
 v_mfma_f32_16x16x32_bf16 a[184:187], a[224:227], v[84:87], a[184:187]
 ds_read_b64_tr_b16 a[254:255], v27 offset:14336
 v_cvt_pk_bf16_f32 v28, v28, v29
 v_mfma_f32_16x16x32_bf16 a[180:183], a[228:231], v[80:83], a[180:183]
 s_cbranch_vccz L_cs1440
L_cb1440:
 ds_read_b128 a[224:227], v3 offset:0
 v_mfma_f32_16x16x32_bf16 a[188:191], a[228:231], v[84:87], a[188:191]
 v_exp_f32 v32, v32
 v_mfma_f32_16x16x32_bf16 a[192:195], a[232:235], v[80:83], a[192:195]
 ds_read_b128 a[228:231], v3 offset:2048
 v_add_f32 v14, v14, v32
 v_mfma_f32_16x16x32_bf16 a[200:203], a[232:235], v[84:87], a[200:203]
 v_exp_f32 v33, v33
 v_mfma_f32_16x16x32_bf16 a[196:199], a[236:239], v[80:83], a[196:199]
 ds_read_b128 a[232:235], v4 offset:0
 s_waitcnt lgkmcnt(3)
 v_mfma_f32_16x16x32_bf16 a[204:207], a[236:239], v[84:87], a[204:207]
 v_exp_f32 v34, v34
 v_mfma_f32_16x16x32_bf16 a[176:179], a[240:243], v[88:91], a[176:179]
 ds_read_b128 a[236:239], v4 offset:2048
 v_add_f32 v14, v14, v33
 v_mfma_f32_16x16x32_bf16 a[184:187], a[240:243], v[92:95], a[184:187]
 v_exp_f32 v35, v35
 v_mfma_f32_16x16x32_bf16 a[180:183], a[244:247], v[88:91], a[180:183]
 ds_read_b128 a[240:243], v3 offset:4096
 v_add_u32 v5, 0x10000, v5
 v_mfma_f32_16x16x32_bf16 a[188:191], a[244:247], v[92:95], a[188:191]
 v_exp_f32 v36, v36
 v_mfma_f32_16x16x32_bf16 a[192:195], a[248:251], v[88:91], a[192:195]
 ds_read_b128 a[244:247], v3 offset:6144
 s_movk_i32 s70, 720
 v_mfma_f32_16x16x32_bf16 a[200:203], a[248:251], v[92:95], a[200:203]
 v_exp_f32 v37, v37
 v_mfma_f32_16x16x32_bf16 a[196:199], a[252:255], v[88:91], a[196:199]
 ds_read_b128 a[248:251], v4 offset:4096
 s_waitcnt lgkmcnt(3)
 v_add_u32 v3, 0xffff0000, v3
 v_add_u32 v6, 0x10000, v6
 v_mfma_f32_16x16x32_bf16 a[204:207], a[252:255], v[92:95], a[204:207]
 buffer_load_dword off, s[72:75], s70 lds
 v_add_u32 v7, 0x10000, v7
 v_exp_f32 v38, v38
 v_mfma_f32_16x16x32_bf16 v[48:51], a[224:227], a[112:115], v[16:19]
 ds_read_b128 a[252:255], v4 offset:6144
 v_add_u32 v4, 0xffff0000, v4
 v_add_u32 v8, 0x10000, v8
 v_mfma_f32_16x16x32_bf16 v[56:59], a[224:227], a[116:119], v[20:23]
 v_exp_f32 v39, v39
 v_mfma_f32_16x16x32_bf16 v[52:55], a[228:231], a[112:115], v[16:19]
 ds_read_b128 a[224:227], v3 offset:57344
 v_cvt_pk_bf16_f32 v32, v32, v33
 v_mfma_f32_16x16x32_bf16 v[60:63], a[228:231], a[116:119], v[20:23]
 v_exp_f32 v40, v40
 v_mfma_f32_16x16x32_bf16 v[48:51], a[232:235], a[120:123], v[48:51]
 ds_read_b128 a[228:231], v3 offset:59392
 v_add_f32 v14, v14, v34
 v_mfma_f32_16x16x32_bf16 v[56:59], a[232:235], a[124:127], v[56:59]
 v_exp_f32 v41, v41
 v_mfma_f32_16x16x32_bf16 v[52:55], a[236:239], a[120:123], v[52:55]
 ds_read_b128 a[232:235], v4 offset:57344
 s_waitcnt lgkmcnt(3)
 v_exp_f32 v42, v42
 v_mfma_f32_16x16x32_bf16 v[60:63], a[236:239], a[124:127], v[60:63]
 v_exp_f32 v43, v43
 v_mfma_f32_16x16x32_bf16 v[48:51], a[240:243], a[128:131], v[48:51]
 ds_read_b128 a[236:239], v4 offset:59392
 v_add_f32 v14, v14, v35
 v_mfma_f32_16x16x32_bf16 v[56:59], a[240:243], a[132:135], v[56:59]
 v_exp_f32 v44, v44
 v_mfma_f32_16x16x32_bf16 v[52:55], a[244:247], a[128:131], v[52:55]
 ds_read_b128 a[240:243], v3 offset:61440
 v_cvt_pk_bf16_f32 v33, v34, v35
 v_mfma_f32_16x16x32_bf16 v[60:63], a[244:247], a[132:135], v[60:63]
 v_exp_f32 v45, v45
 v_mfma_f32_16x16x32_bf16 v[48:51], a[248:251], a[136:139], v[48:51]
 ds_read_b128 a[244:247], v3 offset:63488
 v_add_f32 v14, v14, v36
 v_mfma_f32_16x16x32_bf16 v[56:59], a[248:251], a[140:143], v[56:59]
 v_exp_f32 v46, v46
 v_mfma_f32_16x16x32_bf16 v[52:55], a[252:255], a[136:139], v[52:55]
 ds_read_b128 a[248:251], v4 offset:61440
 s_waitcnt lgkmcnt(3)
 v_mfma_f32_16x16x32_bf16 v[60:63], a[252:255], a[140:143], v[60:63]
 v_exp_f32 v47, v47
 v_mfma_f32_16x16x32_bf16 v[48:51], a[224:227], a[144:147], v[48:51]
 ds_read_b128 a[252:255], v4 offset:63488
 v_add_f32 v14, v14, v37
 v_mfma_f32_16x16x32_bf16 v[56:59], a[224:227], a[148:151], v[56:59]
 v_cvt_pk_bf16_f32 v34, v36, v37
 v_add_f32 v14, v14, v38
 v_mfma_f32_16x16x32_bf16 v[52:55], a[228:231], a[144:147], v[52:55]
 ds_read_b64_tr_b16 a[224:225], v5 offset:8192
 v_add_f32 v14, v14, v39
 v_mfma_f32_16x16x32_bf16 v[60:63], a[228:231], a[148:151], v[60:63]
 ds_read_b64_tr_b16 a[226:227], v5 offset:10240
 v_cvt_pk_bf16_f32 v35, v38, v39
 v_mfma_f32_16x16x32_bf16 v[48:51], a[232:235], a[152:155], v[48:51]
 ds_read_b64_tr_b16 a[228:229], v6 offset:8192
 ds_read_b32 v10, v9
 v_add_f32 v15, v15, v40
 v_mfma_f32_16x16x32_bf16 v[56:59], a[232:235], a[156:159], v[56:59]
 ds_read_b64_tr_b16 a[230:231], v6 offset:10240
 v_add_f32 v15, v15, v41
 v_mfma_f32_16x16x32_bf16 v[52:55], a[236:239], a[152:155], v[52:55]
 ds_read_b64_tr_b16 a[232:233], v7 offset:8192
 s_waitcnt lgkmcnt(6)
 v_cvt_pk_bf16_f32 v36, v40, v41
 v_mfma_f32_16x16x32_bf16 v[60:63], a[236:239], a[156:159], v[60:63]
 ds_read_b64_tr_b16 a[234:235], v7 offset:10240
 v_add_f32 v15, v15, v42
 v_mfma_f32_16x16x32_bf16 v[48:51], a[240:243], a[160:163], v[48:51]
 ds_read_b64_tr_b16 a[236:237], v8 offset:8192
 v_add_f32 v15, v15, v43
 v_mfma_f32_16x16x32_bf16 v[56:59], a[240:243], a[164:167], v[56:59]
 ds_read_b64_tr_b16 a[238:239], v8 offset:10240
 v_cvt_pk_bf16_f32 v37, v42, v43
 v_mfma_f32_16x16x32_bf16 v[52:55], a[244:247], a[160:163], v[52:55]
 ds_read_b64_tr_b16 a[240:241], v5 offset:12288
 v_add_f32 v15, v15, v44
 v_mfma_f32_16x16x32_bf16 v[60:63], a[244:247], a[164:167], v[60:63]
 ds_read_b64_tr_b16 a[242:243], v5 offset:14336
 v_add_f32 v15, v15, v45
 v_mfma_f32_16x16x32_bf16 v[48:51], a[248:251], a[168:171], v[48:51]
 ds_read_b64_tr_b16 a[244:245], v6 offset:12288
 v_cvt_pk_bf16_f32 v38, v44, v45
 v_mfma_f32_16x16x32_bf16 v[56:59], a[248:251], a[172:175], v[56:59]
 ds_read_b64_tr_b16 a[246:247], v6 offset:14336
 v_add_f32 v15, v15, v46
 v_mfma_f32_16x16x32_bf16 v[52:55], a[252:255], a[168:171], v[52:55]
 ds_read_b64_tr_b16 a[248:249], v7 offset:12288
 v_add_f32 v15, v15, v47
 v_cvt_pk_bf16_f32 v39, v46, v47
 v_mfma_f32_16x16x32_bf16 v[60:63], a[252:255], a[172:175], v[60:63]
 ds_read_b64_tr_b16 a[250:251], v7 offset:14336
 s_waitcnt lgkmcnt(6)
 s_movk_i32 s70, 728
 v_mfma_f32_16x16x32_bf16 v[128:131], a[224:227], v[32:35], v[128:131]
 ds_read_b64_tr_b16 a[252:253], v8 offset:12288
 buffer_load_dword off, s[72:75], s70 lds
 v_cmp_le_u32 vcc, 191, v10
 v_mfma_f32_16x16x32_bf16 v[136:139], a[224:227], v[36:39], v[136:139]
 ds_read_b64_tr_b16 a[254:255], v8 offset:14336
 v_accvgpr_write_b32 a44, v28
 v_mfma_f32_16x16x32_bf16 v[132:135], a[228:231], v[32:35], v[132:135]
 s_cbranch_vccz L_cs1464
L_cb1464:
 ds_read_b64_tr_b16 a[224:225], v5 offset:16384
 v_mfma_f32_16x16x32_bf16 v[140:143], a[228:231], v[36:39], v[140:143]
 ds_read_b64_tr_b16 a[226:227], v5 offset:18432
 v_max3_f32 v11, v48, v49, v50
 v_mfma_f32_16x16x32_bf16 v[144:147], a[232:235], v[32:35], v[144:147]
 ds_read_b64_tr_b16 a[228:229], v6 offset:16384
 ds_read_b32 v10, v9
 v_mfma_f32_16x16x32_bf16 v[152:155], a[232:235], v[36:39], v[152:155]
 ds_read_b64_tr_b16 a[230:231], v6 offset:18432
 v_max3_f32 v12, v56, v57, v58
 v_mfma_f32_16x16x32_bf16 v[148:151], a[236:239], v[32:35], v[148:151]
 ds_read_b64_tr_b16 a[232:233], v7 offset:16384
 s_waitcnt lgkmcnt(6)
 v_mfma_f32_16x16x32_bf16 v[156:159], a[236:239], v[36:39], v[156:159]
 ds_read_b64_tr_b16 a[234:235], v7 offset:18432
 v_max3_f32 v11, v11, v51, v52
 v_mfma_f32_16x16x32_bf16 v[160:163], a[240:243], v[32:35], v[160:163]
 ds_read_b64_tr_b16 a[236:237], v8 offset:16384
 v_max3_f32 v12, v12, v59, v60
 v_mfma_f32_16x16x32_bf16 v[168:171], a[240:243], v[36:39], v[168:171]
 ds_read_b64_tr_b16 a[238:239], v8 offset:18432
 v_max3_f32 v11, v11, v53, v54
 v_mfma_f32_16x16x32_bf16 v[164:167], a[244:247], v[32:35], v[164:167]
 ds_read_b64_tr_b16 a[240:241], v5 offset:20480
 v_max3_f32 v12, v12, v61, v62
 v_mfma_f32_16x16x32_bf16 v[172:175], a[244:247], v[36:39], v[172:175]
 ds_read_b64_tr_b16 a[242:243], v5 offset:22528
 v_max_f32 v11, v11, v55
 v_mfma_f32_16x16x32_bf16 v[176:179], a[248:251], v[32:35], v[176:179]
 ds_read_b64_tr_b16 a[244:245], v6 offset:20480
 v_max_f32 v12, v12, v63
 v_mfma_f32_16x16x32_bf16 v[184:187], a[248:251], v[36:39], v[184:187]
 ds_read_b64_tr_b16 a[246:247], v6 offset:22528
 v_max_f32 v13, v11, v12
 v_cmp_lt_f32 vcc, 0x41200000, v13
 v_mfma_f32_16x16x32_bf16 v[180:183], a[252:255], v[32:35], v[180:183]
 ds_read_b64_tr_b16 a[248:249], v7 offset:20480
 s_waitcnt lgkmcnt(5)
 s_cbranch_vccnz L_rs1_11
L_rb1_11:
 v_mfma_f32_16x16x32_bf16 v[188:191], a[252:255], v[36:39], v[188:191]
 ds_read_b64_tr_b16 a[250:251], v7 offset:22528
 v_accvgpr_read_b32 v30, a218
 v_mfma_f32_16x16x32_bf16 v[192:195], a[224:227], v[32:35], v[192:195]
 ds_read_b64_tr_b16 a[252:253], v8 offset:20480
 v_cmp_le_u32 vcc, 193, v10
 v_mfma_f32_16x16x32_bf16 v[200:203], a[224:227], v[36:39], v[200:203]
 ds_read_b64_tr_b16 a[254:255], v8 offset:22528
 v_accvgpr_read_b32 v31, a219
 v_mfma_f32_16x16x32_bf16 v[196:199], a[228:231], v[32:35], v[196:199]
 s_cbranch_vccz L_cs1472
L_cb1472:
 ds_read_b64_tr_b16 a[224:225], v24 offset:16384
 v_mfma_f32_16x16x32_bf16 v[204:207], a[228:231], v[36:39], v[204:207]
 ds_read_b64_tr_b16 a[226:227], v24 offset:18432
 v_cvt_pk_bf16_f32 v30, v30, v31
 v_mfma_f32_16x16x32_bf16 v[208:211], a[232:235], v[32:35], v[208:211]
 ds_read_b64_tr_b16 a[228:229], v25 offset:16384
 v_accvgpr_write_b32 a45, v30
 v_mfma_f32_16x16x32_bf16 v[216:219], a[232:235], v[36:39], v[216:219]
 ds_read_b64_tr_b16 a[230:231], v25 offset:18432
 v_accvgpr_read_b32 v28, a220
 v_mfma_f32_16x16x32_bf16 v[212:215], a[236:239], v[32:35], v[212:215]
 ds_read_b64_tr_b16 a[232:233], v26 offset:16384
 s_waitcnt lgkmcnt(5)
 v_mfma_f32_16x16x32_bf16 v[220:223], a[236:239], v[36:39], v[220:223]
 ds_read_b64_tr_b16 a[234:235], v26 offset:18432
 v_accvgpr_read_b32 v29, a221
 v_mfma_f32_16x16x32_bf16 v[224:227], a[240:243], v[32:35], v[224:227]
 ds_read_b64_tr_b16 a[236:237], v27 offset:16384
 v_cvt_pk_bf16_f32 v28, v28, v29
 v_mfma_f32_16x16x32_bf16 v[232:235], a[240:243], v[36:39], v[232:235]
 ds_read_b64_tr_b16 a[238:239], v27 offset:18432
 v_accvgpr_write_b32 a46, v28
 v_mfma_f32_16x16x32_bf16 v[228:231], a[244:247], v[32:35], v[228:231]
 ds_read_b64_tr_b16 a[240:241], v24 offset:20480
 v_accvgpr_read_b32 v30, a222
 v_mfma_f32_16x16x32_bf16 v[236:239], a[244:247], v[36:39], v[236:239]
 ds_read_b64_tr_b16 a[242:243], v24 offset:22528
 s_movk_i32 s70, 736
 v_mfma_f32_16x16x32_bf16 v[240:243], a[248:251], v[32:35], v[240:243]
 ds_read_b64_tr_b16 a[244:245], v25 offset:20480
 v_accvgpr_read_b32 v31, a223
 v_mfma_f32_16x16x32_bf16 v[248:251], a[248:251], v[36:39], v[248:251]
 ds_read_b64_tr_b16 a[246:247], v25 offset:22528
 v_cvt_pk_bf16_f32 v30, v30, v31
 v_mfma_f32_16x16x32_bf16 v[244:247], a[252:255], v[32:35], v[244:247]
 ds_read_b64_tr_b16 a[248:249], v26 offset:20480
 s_waitcnt lgkmcnt(5)
 v_mfma_f32_16x16x32_bf16 v[252:255], a[252:255], v[36:39], v[252:255]
 ds_read_b64_tr_b16 a[250:251], v26 offset:22528
 v_accvgpr_write_b32 a47, v30
 v_mfma_f32_16x16x32_bf16 a[176:179], a[224:227], v[96:99], a[176:179]
 ds_read_b64_tr_b16 a[252:253], v27 offset:20480
 buffer_load_dword off, s[72:75], s70 lds
 v_accvgpr_read_b32 v28, a64
 v_mfma_f32_16x16x32_bf16 a[184:187], a[224:227], v[100:103], a[184:187]
 ds_read_b64_tr_b16 a[254:255], v27 offset:22528
 v_accvgpr_read_b32 v29, a65
 v_mfma_f32_16x16x32_bf16 a[180:183], a[228:231], v[96:99], a[180:183]
 ds_read_b64_tr_b16 a[224:225], v24 offset:24576
 v_cvt_pk_bf16_f32 v28, v28, v29
 v_mfma_f32_16x16x32_bf16 a[188:191], a[228:231], v[100:103], a[188:191]
 ds_read_b64_tr_b16 a[226:227], v24 offset:26624
 v_accvgpr_write_b32 a48, v28
 v_mfma_f32_16x16x32_bf16 a[192:195], a[232:235], v[96:99], a[192:195]
 ds_read_b64_tr_b16 a[228:229], v25 offset:24576
 ds_read_b32 v10, v9
 v_mfma_f32_16x16x32_bf16 a[200:203], a[232:235], v[100:103], a[200:203]
 ds_read_b64_tr_b16 a[230:231], v25 offset:26624
 v_accvgpr_read_b32 v30, a66
 v_mfma_f32_16x16x32_bf16 a[196:199], a[236:239], v[96:99], a[196:199]
 ds_read_b64_tr_b16 a[232:233], v26 offset:24576
 s_waitcnt lgkmcnt(6)
 v_mfma_f32_16x16x32_bf16 a[204:207], a[236:239], v[100:103], a[204:207]
 ds_read_b64_tr_b16 a[234:235], v26 offset:26624
 v_accvgpr_read_b32 v31, a67
 v_mfma_f32_16x16x32_bf16 a[176:179], a[240:243], v[104:107], a[176:179]
 ds_read_b64_tr_b16 a[236:237], v27 offset:24576
 v_cvt_pk_bf16_f32 v30, v30, v31
 v_mfma_f32_16x16x32_bf16 a[184:187], a[240:243], v[108:111], a[184:187]
 ds_read_b64_tr_b16 a[238:239], v27 offset:26624
 v_accvgpr_write_b32 a49, v30
 v_mfma_f32_16x16x32_bf16 a[180:183], a[244:247], v[104:107], a[180:183]
 ds_read_b64_tr_b16 a[240:241], v24 offset:28672
 v_accvgpr_read_b32 v28, a68
 v_mfma_f32_16x16x32_bf16 a[188:191], a[244:247], v[108:111], a[188:191]
 ds_read_b64_tr_b16 a[242:243], v24 offset:30720
 v_accvgpr_read_b32 v29, a69
 v_mfma_f32_16x16x32_bf16 a[192:195], a[248:251], v[104:107], a[192:195]
 ds_read_b64_tr_b16 a[244:245], v25 offset:28672
 v_cvt_pk_bf16_f32 v28, v28, v29
 v_mfma_f32_16x16x32_bf16 a[200:203], a[248:251], v[108:111], a[200:203]
 ds_read_b64_tr_b16 a[246:247], v25 offset:30720
 v_accvgpr_write_b32 a50, v28
 v_mfma_f32_16x16x32_bf16 a[196:199], a[252:255], v[104:107], a[196:199]
 ds_read_b64_tr_b16 a[248:249], v26 offset:28672
 s_waitcnt lgkmcnt(5)
 v_mfma_f32_16x16x32_bf16 a[204:207], a[252:255], v[108:111], a[204:207]
 ds_read_b64_tr_b16 a[250:251], v26 offset:30720
 v_accvgpr_read_b32 v30, a70
 v_mfma_f32_16x16x32_bf16 a[176:179], a[224:227], v[112:115], a[176:179]
 ds_read_b64_tr_b16 a[252:253], v27 offset:28672
 v_cmp_le_u32 vcc, 196, v10
 v_mfma_f32_16x16x32_bf16 a[184:187], a[224:227], v[116:119], a[184:187]
 ds_read_b64_tr_b16 a[254:255], v27 offset:30720
 v_accvgpr_read_b32 v31, a71
 v_mfma_f32_16x16x32_bf16 a[180:183], a[228:231], v[112:115], a[180:183]
 s_cbranch_vccz L_cs1488
L_cb1488:
 ds_read_b128 a[224:227], v3 offset:0
 v_mfma_f32_16x16x32_bf16 a[188:191], a[228:231], v[116:119], a[188:191]
 v_exp_f32 v48, v48
 v_mfma_f32_16x16x32_bf16 a[192:195], a[232:235], v[112:115], a[192:195]
 ds_read_b128 a[228:231], v3 offset:2048
 v_add_f32 v14, v14, v48
 v_mfma_f32_16x16x32_bf16 a[200:203], a[232:235], v[116:119], a[200:203]
 v_exp_f32 v49, v49
 v_mfma_f32_16x16x32_bf16 a[196:199], a[236:239], v[112:115], a[196:199]
 ds_read_b128 a[232:235], v4 offset:0
 s_waitcnt lgkmcnt(3)
 v_mfma_f32_16x16x32_bf16 a[204:207], a[236:239], v[116:119], a[204:207]
 v_exp_f32 v50, v50
 v_mfma_f32_16x16x32_bf16 a[176:179], a[240:243], v[120:123], a[176:179]
 ds_read_b128 a[236:239], v4 offset:2048
 v_add_f32 v14, v14, v49
 v_mfma_f32_16x16x32_bf16 a[184:187], a[240:243], v[124:127], a[184:187]
 v_exp_f32 v51, v51
 v_mfma_f32_16x16x32_bf16 a[180:183], a[244:247], v[120:123], a[180:183]
 ds_read_b128 a[240:243], v3 offset:4096
 v_add_u32 v5, 0xffff0000, v5
 v_mfma_f32_16x16x32_bf16 a[188:191], a[244:247], v[124:127], a[188:191]
 v_exp_f32 v52, v52
 v_mfma_f32_16x16x32_bf16 a[192:195], a[248:251], v[120:123], a[192:195]
 ds_read_b128 a[244:247], v3 offset:6144
 s_movk_i32 s70, 744
 v_mfma_f32_16x16x32_bf16 a[200:203], a[248:251], v[124:127], a[200:203]
 v_exp_f32 v53, v53
 v_mfma_f32_16x16x32_bf16 a[196:199], a[252:255], v[120:123], a[196:199]
 ds_read_b128 a[248:251], v4 offset:4096
 s_waitcnt lgkmcnt(3)
 v_add_u32 v6, 0xffff0000, v6
 v_mfma_f32_16x16x32_bf16 a[204:207], a[252:255], v[124:127], a[204:207]
 buffer_load_dword off, s[72:75], s70 lds
 v_add_u32 v7, 0xffff0000, v7
 v_exp_f32 v54, v54
 v_mfma_f32_16x16x32_bf16 v[32:35], a[224:227], a[112:115], v[16:19]
 ds_read_b128 a[252:255], v4 offset:6144
 v_add_u32 v8, 0xffff0000, v8
 v_mfma_f32_16x16x32_bf16 v[40:43], a[224:227], a[116:119], v[20:23]
 v_exp_f32 v55, v55
 v_mfma_f32_16x16x32_bf16 v[36:39], a[228:231], a[112:115], v[16:19]
 ds_read_b128 a[224:227], v3 offset:8192
 v_cvt_pk_bf16_f32 v48, v48, v49
 v_mfma_f32_16x16x32_bf16 v[44:47], a[228:231], a[116:119], v[20:23]
 v_exp_f32 v56, v56
 v_mfma_f32_16x16x32_bf16 v[32:35], a[232:235], a[120:123], v[32:35]
 ds_read_b128 a[228:231], v3 offset:10240
 v_add_f32 v14, v14, v50
 v_mfma_f32_16x16x32_bf16 v[40:43], a[232:235], a[124:127], v[40:43]
 v_exp_f32 v57, v57
 v_mfma_f32_16x16x32_bf16 v[36:39], a[236:239], a[120:123], v[36:39]
 ds_read_b128 a[232:235], v4 offset:8192
 s_waitcnt lgkmcnt(3)
 v_exp_f32 v58, v58
 v_mfma_f32_16x16x32_bf16 v[44:47], a[236:239], a[124:127], v[44:47]
 v_exp_f32 v59, v59
 v_mfma_f32_16x16x32_bf16 v[32:35], a[240:243], a[128:131], v[32:35]
 ds_read_b128 a[236:239], v4 offset:10240
 v_add_f32 v14, v14, v51
 v_mfma_f32_16x16x32_bf16 v[40:43], a[240:243], a[132:135], v[40:43]
 v_exp_f32 v60, v60
 v_mfma_f32_16x16x32_bf16 v[36:39], a[244:247], a[128:131], v[36:39]
 ds_read_b128 a[240:243], v3 offset:12288
 v_cvt_pk_bf16_f32 v49, v50, v51
 v_mfma_f32_16x16x32_bf16 v[44:47], a[244:247], a[132:135], v[44:47]
 v_exp_f32 v61, v61
 v_mfma_f32_16x16x32_bf16 v[32:35], a[248:251], a[136:139], v[32:35]
 ds_read_b128 a[244:247], v3 offset:14336
 v_add_f32 v14, v14, v52
 v_mfma_f32_16x16x32_bf16 v[40:43], a[248:251], a[140:143], v[40:43]
 v_exp_f32 v62, v62
 v_mfma_f32_16x16x32_bf16 v[36:39], a[252:255], a[136:139], v[36:39]
 ds_read_b128 a[248:251], v4 offset:12288
 s_waitcnt lgkmcnt(3)
 v_mfma_f32_16x16x32_bf16 v[44:47], a[252:255], a[140:143], v[44:47]
 v_exp_f32 v63, v63
 v_mfma_f32_16x16x32_bf16 v[32:35], a[224:227], a[144:147], v[32:35]
 ds_read_b128 a[252:255], v4 offset:14336
 v_add_f32 v14, v14, v53
 v_mfma_f32_16x16x32_bf16 v[40:43], a[224:227], a[148:151], v[40:43]
 v_cvt_pk_bf16_f32 v50, v52, v53
 v_add_f32 v14, v14, v54
 v_mfma_f32_16x16x32_bf16 v[36:39], a[228:231], a[144:147], v[36:39]
 ds_read_b64_tr_b16 a[224:225], v5 offset:16384
 v_add_f32 v14, v14, v55
 v_mfma_f32_16x16x32_bf16 v[44:47], a[228:231], a[148:151], v[44:47]
 ds_read_b64_tr_b16 a[226:227], v5 offset:18432
 v_cvt_pk_bf16_f32 v51, v54, v55
 v_mfma_f32_16x16x32_bf16 v[32:35], a[232:235], a[152:155], v[32:35]
 ds_read_b64_tr_b16 a[228:229], v6 offset:16384
 ds_read_b32 v10, v9
 v_add_f32 v15, v15, v56
 v_mfma_f32_16x16x32_bf16 v[40:43], a[232:235], a[156:159], v[40:43]
 ds_read_b64_tr_b16 a[230:231], v6 offset:18432
 v_add_f32 v15, v15, v57
 v_mfma_f32_16x16x32_bf16 v[36:39], a[236:239], a[152:155], v[36:39]
 ds_read_b64_tr_b16 a[232:233], v7 offset:16384
 s_waitcnt lgkmcnt(6)
 v_cvt_pk_bf16_f32 v52, v56, v57
 v_mfma_f32_16x16x32_bf16 v[44:47], a[236:239], a[156:159], v[44:47]
 ds_read_b64_tr_b16 a[234:235], v7 offset:18432
 v_add_f32 v15, v15, v58
 v_mfma_f32_16x16x32_bf16 v[32:35], a[240:243], a[160:163], v[32:35]
 ds_read_b64_tr_b16 a[236:237], v8 offset:16384
 v_add_f32 v15, v15, v59
 v_mfma_f32_16x16x32_bf16 v[40:43], a[240:243], a[164:167], v[40:43]
 ds_read_b64_tr_b16 a[238:239], v8 offset:18432
 v_cvt_pk_bf16_f32 v53, v58, v59
 v_mfma_f32_16x16x32_bf16 v[36:39], a[244:247], a[160:163], v[36:39]
 ds_read_b64_tr_b16 a[240:241], v5 offset:20480
 v_add_f32 v15, v15, v60
 v_mfma_f32_16x16x32_bf16 v[44:47], a[244:247], a[164:167], v[44:47]
 ds_read_b64_tr_b16 a[242:243], v5 offset:22528
 v_add_f32 v15, v15, v61
 v_mfma_f32_16x16x32_bf16 v[32:35], a[248:251], a[168:171], v[32:35]
 ds_read_b64_tr_b16 a[244:245], v6 offset:20480
 v_cvt_pk_bf16_f32 v54, v60, v61
 v_mfma_f32_16x16x32_bf16 v[40:43], a[248:251], a[172:175], v[40:43]
 ds_read_b64_tr_b16 a[246:247], v6 offset:22528
 v_add_f32 v15, v15, v62
 v_mfma_f32_16x16x32_bf16 v[36:39], a[252:255], a[168:171], v[36:39]
 ds_read_b64_tr_b16 a[248:249], v7 offset:20480
 v_add_f32 v15, v15, v63
 v_cvt_pk_bf16_f32 v55, v62, v63
 v_mfma_f32_16x16x32_bf16 v[44:47], a[252:255], a[172:175], v[44:47]
 ds_read_b64_tr_b16 a[250:251], v7 offset:22528
 s_waitcnt lgkmcnt(6)
 s_movk_i32 s70, 752
 v_mfma_f32_16x16x32_bf16 v[128:131], a[224:227], v[48:51], v[128:131]
 ds_read_b64_tr_b16 a[252:253], v8 offset:20480
 buffer_load_dword off, s[72:75], s70 lds
 v_cmp_le_u32 vcc, 197, v10
 v_mfma_f32_16x16x32_bf16 v[136:139], a[224:227], v[52:55], v[136:139]
 ds_read_b64_tr_b16 a[254:255], v8 offset:22528
 v_cvt_pk_bf16_f32 v30, v30, v31
 v_mfma_f32_16x16x32_bf16 v[132:135], a[228:231], v[48:51], v[132:135]
 s_cbranch_vccz L_cs1512
L_cb1512:
 ds_read_b64_tr_b16 a[224:225], v5 offset:24576
 v_mfma_f32_16x16x32_bf16 v[140:143], a[228:231], v[52:55], v[140:143]
 ds_read_b64_tr_b16 a[226:227], v5 offset:26624
 v_max3_f32 v11, v32, v33, v34
 v_mfma_f32_16x16x32_bf16 v[144:147], a[232:235], v[48:51], v[144:147]
 ds_read_b64_tr_b16 a[228:229], v6 offset:24576
 ds_read_b32 v10, v9
 v_mfma_f32_16x16x32_bf16 v[152:155], a[232:235], v[52:55], v[152:155]
 ds_read_b64_tr_b16 a[230:231], v6 offset:26624
 v_max3_f32 v12, v40, v41, v42
 v_mfma_f32_16x16x32_bf16 v[148:151], a[236:239], v[48:51], v[148:151]
 ds_read_b64_tr_b16 a[232:233], v7 offset:24576
 s_waitcnt lgkmcnt(6)
 v_mfma_f32_16x16x32_bf16 v[156:159], a[236:239], v[52:55], v[156:159]
 ds_read_b64_tr_b16 a[234:235], v7 offset:26624
 v_max3_f32 v11, v11, v35, v36
 v_mfma_f32_16x16x32_bf16 v[160:163], a[240:243], v[48:51], v[160:163]
 ds_read_b64_tr_b16 a[236:237], v8 offset:24576
 v_max3_f32 v12, v12, v43, v44
 v_mfma_f32_16x16x32_bf16 v[168:171], a[240:243], v[52:55], v[168:171]
 ds_read_b64_tr_b16 a[238:239], v8 offset:26624
 v_max3_f32 v11, v11, v37, v38
 v_mfma_f32_16x16x32_bf16 v[164:167], a[244:247], v[48:51], v[164:167]
 ds_read_b64_tr_b16 a[240:241], v5 offset:28672
 v_max3_f32 v12, v12, v45, v46
 v_mfma_f32_16x16x32_bf16 v[172:175], a[244:247], v[52:55], v[172:175]
 ds_read_b64_tr_b16 a[242:243], v5 offset:30720
 v_max_f32 v11, v11, v39
 v_mfma_f32_16x16x32_bf16 v[176:179], a[248:251], v[48:51], v[176:179]
 ds_read_b64_tr_b16 a[244:245], v6 offset:28672
 v_max_f32 v12, v12, v47
 v_mfma_f32_16x16x32_bf16 v[184:187], a[248:251], v[52:55], v[184:187]
 ds_read_b64_tr_b16 a[246:247], v6 offset:30720
 v_max_f32 v13, v11, v12
 v_cmp_lt_f32 vcc, 0x41200000, v13
 v_mfma_f32_16x16x32_bf16 v[180:183], a[252:255], v[48:51], v[180:183]
 ds_read_b64_tr_b16 a[248:249], v7 offset:28672
 s_waitcnt lgkmcnt(5)
 s_cbranch_vccnz L_rs1_12
L_rb1_12:
 v_mfma_f32_16x16x32_bf16 v[188:191], a[252:255], v[52:55], v[188:191]
 ds_read_b64_tr_b16 a[250:251], v7 offset:30720
 v_accvgpr_write_b32 a51, v30
 v_mfma_f32_16x16x32_bf16 v[192:195], a[224:227], v[48:51], v[192:195]
 ds_read_b64_tr_b16 a[252:253], v8 offset:28672
 v_cmp_le_u32 vcc, 199, v10
 v_mfma_f32_16x16x32_bf16 v[200:203], a[224:227], v[52:55], v[200:203]
 ds_read_b64_tr_b16 a[254:255], v8 offset:30720
 v_accvgpr_read_b32 v28, a72
 v_mfma_f32_16x16x32_bf16 v[196:199], a[228:231], v[48:51], v[196:199]
 s_cbranch_vccz L_cs1520
L_cb1520:
 ds_read_b64_tr_b16 a[224:225], v24 offset:40960
 v_mfma_f32_16x16x32_bf16 v[204:207], a[228:231], v[52:55], v[204:207]
 ds_read_b64_tr_b16 a[226:227], v24 offset:43008
 v_accvgpr_read_b32 v29, a73
 v_mfma_f32_16x16x32_bf16 v[208:211], a[232:235], v[48:51], v[208:211]
 ds_read_b64_tr_b16 a[228:229], v25 offset:40960
 v_cvt_pk_bf16_f32 v28, v28, v29
 v_mfma_f32_16x16x32_bf16 v[216:219], a[232:235], v[52:55], v[216:219]
 ds_read_b64_tr_b16 a[230:231], v25 offset:43008
 v_accvgpr_write_b32 a52, v28
 v_mfma_f32_16x16x32_bf16 v[212:215], a[236:239], v[48:51], v[212:215]
 ds_read_b64_tr_b16 a[232:233], v26 offset:40960
 s_waitcnt lgkmcnt(5)
 v_mfma_f32_16x16x32_bf16 v[220:223], a[236:239], v[52:55], v[220:223]
 ds_read_b64_tr_b16 a[234:235], v26 offset:43008
 v_accvgpr_read_b32 v30, a74
 v_mfma_f32_16x16x32_bf16 v[224:227], a[240:243], v[48:51], v[224:227]
 ds_read_b64_tr_b16 a[236:237], v27 offset:40960
 v_accvgpr_read_b32 v31, a75
 v_mfma_f32_16x16x32_bf16 v[232:235], a[240:243], v[52:55], v[232:235]
 ds_read_b64_tr_b16 a[238:239], v27 offset:43008
 v_cvt_pk_bf16_f32 v30, v30, v31
 v_mfma_f32_16x16x32_bf16 v[228:231], a[244:247], v[48:51], v[228:231]
 ds_read_b64_tr_b16 a[240:241], v24 offset:45056
 v_add_u32 v3, 0xffff0000, v3
 v_mfma_f32_16x16x32_bf16 v[236:239], a[244:247], v[52:55], v[236:239]
 ds_read_b64_tr_b16 a[242:243], v24 offset:47104
 s_movk_i32 s70, 760
 v_mfma_f32_16x16x32_bf16 v[240:243], a[248:251], v[48:51], v[240:243]
 ds_read_b64_tr_b16 a[244:245], v25 offset:45056
 v_accvgpr_write_b32 a53, v30
 v_mfma_f32_16x16x32_bf16 v[248:251], a[248:251], v[52:55], v[248:251]
 ds_read_b64_tr_b16 a[246:247], v25 offset:47104
 v_accvgpr_read_b32 v28, a76
 v_mfma_f32_16x16x32_bf16 v[244:247], a[252:255], v[48:51], v[244:247]
 ds_read_b64_tr_b16 a[248:249], v26 offset:45056
 s_waitcnt lgkmcnt(5)
 v_mfma_f32_16x16x32_bf16 v[252:255], a[252:255], v[52:55], v[252:255]
 ds_read_b64_tr_b16 a[250:251], v26 offset:47104
 v_add_u32 v4, 0xffff0000, v4
 v_mfma_f32_16x16x32_bf16 a[96:99], a[224:227], v[64:67], 0
 ds_read_b64_tr_b16 a[252:253], v27 offset:45056
 buffer_load_dword off, s[72:75], s70 lds
 v_accvgpr_read_b32 v29, a77
 v_mfma_f32_16x16x32_bf16 a[104:107], a[224:227], v[68:71], 0
 ds_read_b64_tr_b16 a[254:255], v27 offset:47104
 v_cvt_pk_bf16_f32 v28, v28, v29
 v_mfma_f32_16x16x32_bf16 a[100:103], a[228:231], v[64:67], 0
 ds_read_b64_tr_b16 a[224:225], v24 offset:32768
 v_accvgpr_write_b32 a54, v28
 v_mfma_f32_16x16x32_bf16 a[108:111], a[228:231], v[68:71], 0
 ds_read_b64_tr_b16 a[226:227], v24 offset:34816
 v_accvgpr_read_b32 v30, a78
 v_mfma_f32_16x16x32_bf16 a[208:211], a[232:235], v[64:67], 0
 ds_read_b64_tr_b16 a[228:229], v25 offset:32768
 ds_read_b32 v10, v9
 v_mfma_f32_16x16x32_bf16 a[216:219], a[232:235], v[68:71], 0
 ds_read_b64_tr_b16 a[230:231], v25 offset:34816
 v_accvgpr_read_b32 v31, a79
 v_mfma_f32_16x16x32_bf16 a[212:215], a[236:239], v[64:67], 0
 ds_read_b64_tr_b16 a[232:233], v26 offset:32768
 s_waitcnt lgkmcnt(6)
 v_mfma_f32_16x16x32_bf16 a[220:223], a[236:239], v[68:71], 0
 ds_read_b64_tr_b16 a[234:235], v26 offset:34816
 v_cvt_pk_bf16_f32 v30, v30, v31
 v_mfma_f32_16x16x32_bf16 a[96:99], a[240:243], v[72:75], a[96:99]
 ds_read_b64_tr_b16 a[236:237], v27 offset:32768
 v_accvgpr_write_b32 a55, v30
 v_mfma_f32_16x16x32_bf16 a[104:107], a[240:243], v[76:79], a[104:107]
 ds_read_b64_tr_b16 a[238:239], v27 offset:34816
 v_accvgpr_read_b32 v28, a80
 v_mfma_f32_16x16x32_bf16 a[100:103], a[244:247], v[72:75], a[100:103]
 ds_read_b64_tr_b16 a[240:241], v24 offset:36864
 v_accvgpr_read_b32 v29, a81
 v_mfma_f32_16x16x32_bf16 a[108:111], a[244:247], v[76:79], a[108:111]
 ds_read_b64_tr_b16 a[242:243], v24 offset:38912
 v_cvt_pk_bf16_f32 v28, v28, v29
 v_mfma_f32_16x16x32_bf16 a[208:211], a[248:251], v[72:75], a[208:211]
 ds_read_b64_tr_b16 a[244:245], v25 offset:36864
 v_accvgpr_write_b32 a56, v28
 v_mfma_f32_16x16x32_bf16 a[216:219], a[248:251], v[76:79], a[216:219]
 ds_read_b64_tr_b16 a[246:247], v25 offset:38912
 v_accvgpr_read_b32 v30, a82
 v_mfma_f32_16x16x32_bf16 a[212:215], a[252:255], v[72:75], a[212:215]
 ds_read_b64_tr_b16 a[248:249], v26 offset:36864
 s_waitcnt lgkmcnt(5)
 v_mfma_f32_16x16x32_bf16 a[220:223], a[252:255], v[76:79], a[220:223]
 ds_read_b64_tr_b16 a[250:251], v26 offset:38912
 v_accvgpr_read_b32 v31, a83
 v_mfma_f32_16x16x32_bf16 a[96:99], a[224:227], v[80:83], a[96:99]
 ds_read_b64_tr_b16 a[252:253], v27 offset:36864
 v_cmp_le_u32 vcc, 202, v10
 v_mfma_f32_16x16x32_bf16 a[104:107], a[224:227], v[84:87], a[104:107]
 ds_read_b64_tr_b16 a[254:255], v27 offset:38912
 v_cvt_pk_bf16_f32 v30, v30, v31
 v_mfma_f32_16x16x32_bf16 a[100:103], a[228:231], v[80:83], a[100:103]
 s_cbranch_vccz L_cs1536
L_cb1536:
 ds_read_b128 a[224:227], v3 offset:49152
 v_mfma_f32_16x16x32_bf16 a[108:111], a[228:231], v[84:87], a[108:111]
 v_exp_f32 v32, v32
 v_mfma_f32_16x16x32_bf16 a[208:211], a[232:235], v[80:83], a[208:211]
 ds_read_b128 a[228:231], v3 offset:51200
 v_add_f32 v14, v14, v32
 v_mfma_f32_16x16x32_bf16 a[216:219], a[232:235], v[84:87], a[216:219]
 v_exp_f32 v33, v33
 v_mfma_f32_16x16x32_bf16 a[212:215], a[236:239], v[80:83], a[212:215]
 ds_read_b128 a[232:235], v4 offset:49152
 s_waitcnt lgkmcnt(3)
 v_mfma_f32_16x16x32_bf16 a[220:223], a[236:239], v[84:87], a[220:223]
 v_exp_f32 v34, v34
 v_mfma_f32_16x16x32_bf16 a[96:99], a[240:243], v[88:91], a[96:99]
 ds_read_b128 a[236:239], v4 offset:51200
 v_add_f32 v14, v14, v33
 v_mfma_f32_16x16x32_bf16 a[104:107], a[240:243], v[92:95], a[104:107]
 v_exp_f32 v35, v35
 v_mfma_f32_16x16x32_bf16 a[100:103], a[244:247], v[88:91], a[100:103]
 ds_read_b128 a[240:243], v3 offset:53248
 v_cvt_pk_bf16_f32 v32, v32, v33
 v_mfma_f32_16x16x32_bf16 a[108:111], a[244:247], v[92:95], a[108:111]
 v_exp_f32 v36, v36
 v_mfma_f32_16x16x32_bf16 a[208:211], a[248:251], v[88:91], a[208:211]
 ds_read_b128 a[244:247], v3 offset:55296
 s_movk_i32 s70, 768
 v_mfma_f32_16x16x32_bf16 a[216:219], a[248:251], v[92:95], a[216:219]
 v_exp_f32 v37, v37
 v_mfma_f32_16x16x32_bf16 a[212:215], a[252:255], v[88:91], a[212:215]
 ds_read_b128 a[248:251], v4 offset:53248
 s_waitcnt lgkmcnt(3)
 v_mfma_f32_16x16x32_bf16 a[220:223], a[252:255], v[92:95], a[220:223]
 buffer_load_dword off, s[72:75], s70 lds
 v_mfma_f32_16x16x32_bf16 v[48:51], a[224:227], a[112:115], v[16:19]
 ds_read_b128 a[252:255], v4 offset:55296
 v_add_f32 v14, v14, v34
 v_mfma_f32_16x16x32_bf16 v[56:59], a[224:227], a[116:119], v[20:23]
 v_exp_f32 v38, v38
 v_mfma_f32_16x16x32_bf16 v[52:55], a[228:231], a[112:115], v[16:19]
 ds_read_b128 a[224:227], v3 offset:57344
 v_add_f32 v14, v14, v35
 v_mfma_f32_16x16x32_bf16 v[60:63], a[228:231], a[116:119], v[20:23]
 v_exp_f32 v39, v39
 v_mfma_f32_16x16x32_bf16 v[48:51], a[232:235], a[120:123], v[48:51]
 ds_read_b128 a[228:231], v3 offset:59392
 v_cvt_pk_bf16_f32 v33, v34, v35
 v_mfma_f32_16x16x32_bf16 v[56:59], a[232:235], a[124:127], v[56:59]
 v_exp_f32 v40, v40
 v_mfma_f32_16x16x32_bf16 v[52:55], a[236:239], a[120:123], v[52:55]
 ds_read_b128 a[232:235], v4 offset:57344
 s_waitcnt lgkmcnt(3)
 v_exp_f32 v41, v41
 v_mfma_f32_16x16x32_bf16 v[60:63], a[236:239], a[124:127], v[60:63]
 v_exp_f32 v42, v42
 v_mfma_f32_16x16x32_bf16 v[48:51], a[240:243], a[128:131], v[48:51]
 ds_read_b128 a[236:239], v4 offset:59392
 v_add_f32 v14, v14, v36
 v_mfma_f32_16x16x32_bf16 v[56:59], a[240:243], a[132:135], v[56:59]
 v_exp_f32 v43, v43
 v_mfma_f32_16x16x32_bf16 v[52:55], a[244:247], a[128:131], v[52:55]
 ds_read_b128 a[240:243], v3 offset:61440
 v_add_f32 v14, v14, v37
 v_mfma_f32_16x16x32_bf16 v[60:63], a[244:247], a[132:135], v[60:63]
 v_exp_f32 v44, v44
 v_mfma_f32_16x16x32_bf16 v[48:51], a[248:251], a[136:139], v[48:51]
 ds_read_b128 a[244:247], v3 offset:63488
 v_cvt_pk_bf16_f32 v34, v36, v37
 v_mfma_f32_16x16x32_bf16 v[56:59], a[248:251], a[140:143], v[56:59]
 v_exp_f32 v45, v45
 v_mfma_f32_16x16x32_bf16 v[52:55], a[252:255], a[136:139], v[52:55]
 ds_read_b128 a[248:251], v4 offset:61440
 s_waitcnt lgkmcnt(3)
 v_mfma_f32_16x16x32_bf16 v[60:63], a[252:255], a[140:143], v[60:63]
 v_exp_f32 v46, v46
 v_mfma_f32_16x16x32_bf16 v[48:51], a[224:227], a[144:147], v[48:51]
 ds_read_b128 a[252:255], v4 offset:63488
 v_add_f32 v14, v14, v38
 v_mfma_f32_16x16x32_bf16 v[56:59], a[224:227], a[148:151], v[56:59]
 v_exp_f32 v47, v47
 v_mfma_f32_16x16x32_bf16 v[52:55], a[228:231], a[144:147], v[52:55]
 ds_read_b64_tr_b16 a[224:225], v5 offset:32768
 v_add_f32 v14, v14, v39
 v_mfma_f32_16x16x32_bf16 v[60:63], a[228:231], a[148:151], v[60:63]
 ds_read_b64_tr_b16 a[226:227], v5 offset:34816
 v_cvt_pk_bf16_f32 v35, v38, v39
 v_mfma_f32_16x16x32_bf16 v[48:51], a[232:235], a[152:155], v[48:51]
 ds_read_b64_tr_b16 a[228:229], v6 offset:32768
 ds_read_b32 v10, v9
 v_add_f32 v15, v15, v40
 v_mfma_f32_16x16x32_bf16 v[56:59], a[232:235], a[156:159], v[56:59]
 ds_read_b64_tr_b16 a[230:231], v6 offset:34816
 v_add_f32 v15, v15, v41
 v_mfma_f32_16x16x32_bf16 v[52:55], a[236:239], a[152:155], v[52:55]
 ds_read_b64_tr_b16 a[232:233], v7 offset:32768
 s_waitcnt lgkmcnt(6)
 v_cvt_pk_bf16_f32 v36, v40, v41
 v_mfma_f32_16x16x32_bf16 v[60:63], a[236:239], a[156:159], v[60:63]
 ds_read_b64_tr_b16 a[234:235], v7 offset:34816
 v_add_f32 v15, v15, v42
 v_mfma_f32_16x16x32_bf16 v[48:51], a[240:243], a[160:163], v[48:51]
 ds_read_b64_tr_b16 a[236:237], v8 offset:32768
 v_add_f32 v15, v15, v43
 v_mfma_f32_16x16x32_bf16 v[56:59], a[240:243], a[164:167], v[56:59]
 ds_read_b64_tr_b16 a[238:239], v8 offset:34816
 v_cvt_pk_bf16_f32 v37, v42, v43
 v_mfma_f32_16x16x32_bf16 v[52:55], a[244:247], a[160:163], v[52:55]
 ds_read_b64_tr_b16 a[240:241], v5 offset:36864
 v_add_f32 v15, v15, v44
 v_mfma_f32_16x16x32_bf16 v[60:63], a[244:247], a[164:167], v[60:63]
 ds_read_b64_tr_b16 a[242:243], v5 offset:38912
 v_add_f32 v15, v15, v45
 v_mfma_f32_16x16x32_bf16 v[48:51], a[248:251], a[168:171], v[48:51]
 ds_read_b64_tr_b16 a[244:245], v6 offset:36864
 v_cvt_pk_bf16_f32 v38, v44, v45
 v_mfma_f32_16x16x32_bf16 v[56:59], a[248:251], a[172:175], v[56:59]
 ds_read_b64_tr_b16 a[246:247], v6 offset:38912
 v_add_f32 v15, v15, v46
 v_mfma_f32_16x16x32_bf16 v[52:55], a[252:255], a[168:171], v[52:55]
 ds_read_b64_tr_b16 a[248:249], v7 offset:36864
 v_add_f32 v15, v15, v47
 v_cvt_pk_bf16_f32 v39, v46, v47
 v_mfma_f32_16x16x32_bf16 v[60:63], a[252:255], a[172:175], v[60:63]
 ds_read_b64_tr_b16 a[250:251], v7 offset:38912
 s_waitcnt lgkmcnt(6)
 s_movk_i32 s70, 776
 v_mfma_f32_16x16x32_bf16 v[128:131], a[224:227], v[32:35], v[128:131]
 ds_read_b64_tr_b16 a[252:253], v8 offset:36864
 buffer_load_dword off, s[72:75], s70 lds
 v_cmp_le_u32 vcc, 203, v10
 v_mfma_f32_16x16x32_bf16 v[136:139], a[224:227], v[36:39], v[136:139]
 ds_read_b64_tr_b16 a[254:255], v8 offset:38912
 v_accvgpr_write_b32 a57, v30
 v_mfma_f32_16x16x32_bf16 v[132:135], a[228:231], v[32:35], v[132:135]
 s_cbranch_vccz L_cs1560
L_cb1560:
 ds_read_b64_tr_b16 a[224:225], v5 offset:40960
 v_mfma_f32_16x16x32_bf16 v[140:143], a[228:231], v[36:39], v[140:143]
 ds_read_b64_tr_b16 a[226:227], v5 offset:43008
 v_max3_f32 v11, v48, v49, v50
 v_mfma_f32_16x16x32_bf16 v[144:147], a[232:235], v[32:35], v[144:147]
 ds_read_b64_tr_b16 a[228:229], v6 offset:40960
 ds_read_b32 v10, v9
 v_mfma_f32_16x16x32_bf16 v[152:155], a[232:235], v[36:39], v[152:155]
 ds_read_b64_tr_b16 a[230:231], v6 offset:43008
 v_max3_f32 v12, v56, v57, v58
 v_mfma_f32_16x16x32_bf16 v[148:151], a[236:239], v[32:35], v[148:151]
 ds_read_b64_tr_b16 a[232:233], v7 offset:40960
 s_waitcnt lgkmcnt(6)
 v_mfma_f32_16x16x32_bf16 v[156:159], a[236:239], v[36:39], v[156:159]
 ds_read_b64_tr_b16 a[234:235], v7 offset:43008
 v_max3_f32 v11, v11, v51, v52
 v_mfma_f32_16x16x32_bf16 v[160:163], a[240:243], v[32:35], v[160:163]
 ds_read_b64_tr_b16 a[236:237], v8 offset:40960
 v_max3_f32 v12, v12, v59, v60
 v_mfma_f32_16x16x32_bf16 v[168:171], a[240:243], v[36:39], v[168:171]
 ds_read_b64_tr_b16 a[238:239], v8 offset:43008
 v_max3_f32 v11, v11, v53, v54
 v_mfma_f32_16x16x32_bf16 v[164:167], a[244:247], v[32:35], v[164:167]
 ds_read_b64_tr_b16 a[240:241], v5 offset:45056
 v_max3_f32 v12, v12, v61, v62
 v_mfma_f32_16x16x32_bf16 v[172:175], a[244:247], v[36:39], v[172:175]
 ds_read_b64_tr_b16 a[242:243], v5 offset:47104
 v_max_f32 v11, v11, v55
 v_mfma_f32_16x16x32_bf16 v[176:179], a[248:251], v[32:35], v[176:179]
 ds_read_b64_tr_b16 a[244:245], v6 offset:45056
 v_max_f32 v12, v12, v63
 v_mfma_f32_16x16x32_bf16 v[184:187], a[248:251], v[36:39], v[184:187]
 ds_read_b64_tr_b16 a[246:247], v6 offset:47104
 v_max_f32 v13, v11, v12
 v_cmp_lt_f32 vcc, 0x41200000, v13
 v_mfma_f32_16x16x32_bf16 v[180:183], a[252:255], v[32:35], v[180:183]
 ds_read_b64_tr_b16 a[248:249], v7 offset:45056
 s_waitcnt lgkmcnt(5)
 s_cbranch_vccnz L_rs1_13
L_rb1_13:
 v_mfma_f32_16x16x32_bf16 v[188:191], a[252:255], v[36:39], v[188:191]
 ds_read_b64_tr_b16 a[250:251], v7 offset:47104
 v_accvgpr_read_b32 v28, a84
 v_mfma_f32_16x16x32_bf16 v[192:195], a[224:227], v[32:35], v[192:195]
 ds_read_b64_tr_b16 a[252:253], v8 offset:45056
 v_cmp_le_u32 vcc, 205, v10
 v_mfma_f32_16x16x32_bf16 v[200:203], a[224:227], v[36:39], v[200:203]
 ds_read_b64_tr_b16 a[254:255], v8 offset:47104
 v_accvgpr_read_b32 v29, a85
 v_mfma_f32_16x16x32_bf16 v[196:199], a[228:231], v[32:35], v[196:199]
 s_cbranch_vccz L_cs1568
L_cb1568:
 ds_read_b64_tr_b16 a[224:225], v24 offset:0
 v_mfma_f32_16x16x32_bf16 v[204:207], a[228:231], v[36:39], v[204:207]
 ds_read_b64_tr_b16 a[226:227], v24 offset:2048
 v_cvt_pk_bf16_f32 v28, v28, v29
 v_mfma_f32_16x16x32_bf16 v[208:211], a[232:235], v[32:35], v[208:211]
 ds_read_b64_tr_b16 a[228:229], v25 offset:0
 v_accvgpr_write_b32 a58, v28
 v_mfma_f32_16x16x32_bf16 v[216:219], a[232:235], v[36:39], v[216:219]
 ds_read_b64_tr_b16 a[230:231], v25 offset:2048
 v_accvgpr_read_b32 v30, a86
 v_mfma_f32_16x16x32_bf16 v[212:215], a[236:239], v[32:35], v[212:215]
 ds_read_b64_tr_b16 a[232:233], v26 offset:0
 s_waitcnt lgkmcnt(5)
 v_mfma_f32_16x16x32_bf16 v[220:223], a[236:239], v[36:39], v[220:223]
 ds_read_b64_tr_b16 a[234:235], v26 offset:2048
 v_accvgpr_read_b32 v31, a87
 v_mfma_f32_16x16x32_bf16 v[224:227], a[240:243], v[32:35], v[224:227]
 ds_read_b64_tr_b16 a[236:237], v27 offset:0
 v_cvt_pk_bf16_f32 v30, v30, v31
 v_mfma_f32_16x16x32_bf16 v[232:235], a[240:243], v[36:39], v[232:235]
 ds_read_b64_tr_b16 a[238:239], v27 offset:2048
 v_accvgpr_write_b32 a59, v30
 v_mfma_f32_16x16x32_bf16 v[228:231], a[244:247], v[32:35], v[228:231]
 ds_read_b64_tr_b16 a[240:241], v24 offset:4096
 v_add_u32 v3, 0x10000, v3
 v_mfma_f32_16x16x32_bf16 v[236:239], a[244:247], v[36:39], v[236:239]
 ds_read_b64_tr_b16 a[242:243], v24 offset:6144
 s_movk_i32 s70, 784
 v_mfma_f32_16x16x32_bf16 v[240:243], a[248:251], v[32:35], v[240:243]
 ds_read_b64_tr_b16 a[244:245], v25 offset:4096
 v_accvgpr_read_b32 v28, a88
 v_mfma_f32_16x16x32_bf16 v[248:251], a[248:251], v[36:39], v[248:251]
 ds_read_b64_tr_b16 a[246:247], v25 offset:6144
 v_accvgpr_read_b32 v29, a89
 v_mfma_f32_16x16x32_bf16 v[244:247], a[252:255], v[32:35], v[244:247]
 ds_read_b64_tr_b16 a[248:249], v26 offset:4096
 s_waitcnt lgkmcnt(5)
 v_mfma_f32_16x16x32_bf16 v[252:255], a[252:255], v[36:39], v[252:255]
 ds_read_b64_tr_b16 a[250:251], v26 offset:6144
 v_add_u32 v4, 0x10000, v4
 v_mfma_f32_16x16x32_bf16 a[96:99], a[224:227], v[96:99], a[96:99]
 ds_read_b64_tr_b16 a[252:253], v27 offset:4096
 buffer_load_dword off, s[72:75], s70 lds
 v_cvt_pk_bf16_f32 v28, v28, v29
 v_mfma_f32_16x16x32_bf16 a[104:107], a[224:227], v[100:103], a[104:107]
 ds_read_b64_tr_b16 a[254:255], v27 offset:6144
 v_accvgpr_write_b32 a60, v28
 v_mfma_f32_16x16x32_bf16 a[100:103], a[228:231], v[96:99], a[100:103]
 ds_read_b64_tr_b16 a[224:225], v24 offset:8192
 v_accvgpr_read_b32 v30, a90
 v_mfma_f32_16x16x32_bf16 a[108:111], a[228:231], v[100:103], a[108:111]
 ds_read_b64_tr_b16 a[226:227], v24 offset:10240
 v_accvgpr_read_b32 v31, a91
 v_mfma_f32_16x16x32_bf16 a[208:211], a[232:235], v[96:99], a[208:211]
 ds_read_b64_tr_b16 a[228:229], v25 offset:8192
 ds_read_b32 v10, v9
 v_mfma_f32_16x16x32_bf16 a[216:219], a[232:235], v[100:103], a[216:219]
 ds_read_b64_tr_b16 a[230:231], v25 offset:10240
 v_cvt_pk_bf16_f32 v30, v30, v31
 v_mfma_f32_16x16x32_bf16 a[212:215], a[236:239], v[96:99], a[212:215]
 ds_read_b64_tr_b16 a[232:233], v26 offset:8192
 s_waitcnt lgkmcnt(6)
 v_mfma_f32_16x16x32_bf16 a[220:223], a[236:239], v[100:103], a[220:223]
 ds_read_b64_tr_b16 a[234:235], v26 offset:10240
 v_accvgpr_write_b32 a61, v30
 v_mfma_f32_16x16x32_bf16 a[96:99], a[240:243], v[104:107], a[96:99]
 ds_read_b64_tr_b16 a[236:237], v27 offset:8192
 v_accvgpr_read_b32 v28, a92
 v_mfma_f32_16x16x32_bf16 a[104:107], a[240:243], v[108:111], a[104:107]
 ds_read_b64_tr_b16 a[238:239], v27 offset:10240
 v_accvgpr_read_b32 v29, a93
 v_mfma_f32_16x16x32_bf16 a[100:103], a[244:247], v[104:107], a[100:103]
 ds_read_b64_tr_b16 a[240:241], v24 offset:12288
 v_cvt_pk_bf16_f32 v28, v28, v29
 v_mfma_f32_16x16x32_bf16 a[108:111], a[244:247], v[108:111], a[108:111]
 ds_read_b64_tr_b16 a[242:243], v24 offset:14336
 v_accvgpr_write_b32 a62, v28
 v_mfma_f32_16x16x32_bf16 a[208:211], a[248:251], v[104:107], a[208:211]
 ds_read_b64_tr_b16 a[244:245], v25 offset:12288
 v_accvgpr_read_b32 v30, a94
 v_mfma_f32_16x16x32_bf16 a[216:219], a[248:251], v[108:111], a[216:219]
 ds_read_b64_tr_b16 a[246:247], v25 offset:14336
 v_accvgpr_read_b32 v31, a95
 v_mfma_f32_16x16x32_bf16 a[212:215], a[252:255], v[104:107], a[212:215]
 ds_read_b64_tr_b16 a[248:249], v26 offset:12288
 s_waitcnt lgkmcnt(5)
 v_mfma_f32_16x16x32_bf16 a[220:223], a[252:255], v[108:111], a[220:223]
 ds_read_b64_tr_b16 a[250:251], v26 offset:14336
 v_cvt_pk_bf16_f32 v30, v30, v31
 v_mfma_f32_16x16x32_bf16 a[96:99], a[224:227], v[112:115], a[96:99]
 ds_read_b64_tr_b16 a[252:253], v27 offset:12288
 v_cmp_le_u32 vcc, 208, v10
 v_mfma_f32_16x16x32_bf16 a[104:107], a[224:227], v[116:119], a[104:107]
 ds_read_b64_tr_b16 a[254:255], v27 offset:14336
 v_accvgpr_write_b32 a63, v30
 v_mfma_f32_16x16x32_bf16 a[100:103], a[228:231], v[112:115], a[100:103]
 s_cbranch_vccz L_cs1584
L_cb1584:
 ds_read_b128 a[224:227], v3 offset:49152
 v_mfma_f32_16x16x32_bf16 a[108:111], a[228:231], v[116:119], a[108:111]
 v_exp_f32 v48, v48
 v_mfma_f32_16x16x32_bf16 a[208:211], a[232:235], v[112:115], a[208:211]
 ds_read_b128 a[228:231], v3 offset:51200
 v_add_f32 v14, v14, v48
 v_mfma_f32_16x16x32_bf16 a[216:219], a[232:235], v[116:119], a[216:219]
 v_exp_f32 v49, v49
 v_mfma_f32_16x16x32_bf16 a[212:215], a[236:239], v[112:115], a[212:215]
 ds_read_b128 a[232:235], v4 offset:49152
 s_waitcnt lgkmcnt(3)
 v_mfma_f32_16x16x32_bf16 a[220:223], a[236:239], v[116:119], a[220:223]
 v_exp_f32 v50, v50
 v_mfma_f32_16x16x32_bf16 a[96:99], a[240:243], v[120:123], a[96:99]
 ds_read_b128 a[236:239], v4 offset:51200
 v_add_f32 v14, v14, v49
 v_mfma_f32_16x16x32_bf16 a[104:107], a[240:243], v[124:127], a[104:107]
 v_exp_f32 v51, v51
 v_mfma_f32_16x16x32_bf16 a[100:103], a[244:247], v[120:123], a[100:103]
 ds_read_b128 a[240:243], v3 offset:53248
 v_add_u32 v5, 0x10000, v5
 v_mfma_f32_16x16x32_bf16 a[108:111], a[244:247], v[124:127], a[108:111]
 v_exp_f32 v52, v52
 v_mfma_f32_16x16x32_bf16 a[208:211], a[248:251], v[120:123], a[208:211]
 ds_read_b128 a[244:247], v3 offset:55296
 s_movk_i32 s70, 792
 v_mfma_f32_16x16x32_bf16 a[216:219], a[248:251], v[124:127], a[216:219]
 v_exp_f32 v53, v53
 v_mfma_f32_16x16x32_bf16 a[212:215], a[252:255], v[120:123], a[212:215]
 ds_read_b128 a[248:251], v4 offset:53248
 s_waitcnt lgkmcnt(3)
 v_add_u32 v6, 0x10000, v6
 v_mfma_f32_16x16x32_bf16 a[220:223], a[252:255], v[124:127], a[220:223]
 buffer_load_dword off, s[72:75], s70 lds
 v_add_u32 v7, 0x10000, v7
 v_exp_f32 v54, v54
 v_mfma_f32_16x16x32_bf16 v[32:35], a[224:227], a[112:115], v[16:19]
 ds_read_b128 a[252:255], v4 offset:55296
 v_add_u32 v8, 0x10000, v8
 v_mfma_f32_16x16x32_bf16 v[40:43], a[224:227], a[116:119], v[20:23]
 v_exp_f32 v55, v55
 v_mfma_f32_16x16x32_bf16 v[36:39], a[228:231], a[112:115], v[16:19]
 ds_read_b128 a[224:227], v3 offset:57344
 v_cvt_pk_bf16_f32 v48, v48, v49
 v_mfma_f32_16x16x32_bf16 v[44:47], a[228:231], a[116:119], v[20:23]
 v_exp_f32 v56, v56
 v_mfma_f32_16x16x32_bf16 v[32:35], a[232:235], a[120:123], v[32:35]
 ds_read_b128 a[228:231], v3 offset:59392
 v_add_f32 v14, v14, v50
 v_mfma_f32_16x16x32_bf16 v[40:43], a[232:235], a[124:127], v[40:43]
 v_exp_f32 v57, v57
 v_mfma_f32_16x16x32_bf16 v[36:39], a[236:239], a[120:123], v[36:39]
 ds_read_b128 a[232:235], v4 offset:57344
 s_waitcnt lgkmcnt(3)
 v_exp_f32 v58, v58
 v_mfma_f32_16x16x32_bf16 v[44:47], a[236:239], a[124:127], v[44:47]
 v_exp_f32 v59, v59
 v_mfma_f32_16x16x32_bf16 v[32:35], a[240:243], a[128:131], v[32:35]
 ds_read_b128 a[236:239], v4 offset:59392
 v_add_f32 v14, v14, v51
 v_mfma_f32_16x16x32_bf16 v[40:43], a[240:243], a[132:135], v[40:43]
 v_exp_f32 v60, v60
 v_mfma_f32_16x16x32_bf16 v[36:39], a[244:247], a[128:131], v[36:39]
 ds_read_b128 a[240:243], v3 offset:61440
 v_cvt_pk_bf16_f32 v49, v50, v51
 v_mfma_f32_16x16x32_bf16 v[44:47], a[244:247], a[132:135], v[44:47]
 v_exp_f32 v61, v61
 v_mfma_f32_16x16x32_bf16 v[32:35], a[248:251], a[136:139], v[32:35]
 ds_read_b128 a[244:247], v3 offset:63488
 v_add_f32 v14, v14, v52
 v_mfma_f32_16x16x32_bf16 v[40:43], a[248:251], a[140:143], v[40:43]
 v_exp_f32 v62, v62
 v_mfma_f32_16x16x32_bf16 v[36:39], a[252:255], a[136:139], v[36:39]
 ds_read_b128 a[248:251], v4 offset:61440
 s_waitcnt lgkmcnt(3)
 v_mfma_f32_16x16x32_bf16 v[44:47], a[252:255], a[140:143], v[44:47]
 v_exp_f32 v63, v63
 v_mfma_f32_16x16x32_bf16 v[32:35], a[224:227], a[144:147], v[32:35]
 ds_read_b128 a[252:255], v4 offset:63488
 v_add_f32 v14, v14, v53
 v_mfma_f32_16x16x32_bf16 v[40:43], a[224:227], a[148:151], v[40:43]
 v_cvt_pk_bf16_f32 v50, v52, v53
 v_add_f32 v14, v14, v54
 v_mfma_f32_16x16x32_bf16 v[36:39], a[228:231], a[144:147], v[36:39]
 ds_read_b64_tr_b16 a[224:225], v5 offset:0
 v_add_f32 v14, v14, v55
 v_mfma_f32_16x16x32_bf16 v[44:47], a[228:231], a[148:151], v[44:47]
 ds_read_b64_tr_b16 a[226:227], v5 offset:2048
 v_cvt_pk_bf16_f32 v51, v54, v55
 v_mfma_f32_16x16x32_bf16 v[32:35], a[232:235], a[152:155], v[32:35]
 ds_read_b64_tr_b16 a[228:229], v6 offset:0
 ds_read_b32 v10, v9
 v_add_f32 v15, v15, v56
 v_mfma_f32_16x16x32_bf16 v[40:43], a[232:235], a[156:159], v[40:43]
 ds_read_b64_tr_b16 a[230:231], v6 offset:2048
 v_add_f32 v15, v15, v57
 v_mfma_f32_16x16x32_bf16 v[36:39], a[236:239], a[152:155], v[36:39]
 ds_read_b64_tr_b16 a[232:233], v7 offset:0
 s_waitcnt lgkmcnt(6)
 v_cvt_pk_bf16_f32 v52, v56, v57
 v_mfma_f32_16x16x32_bf16 v[44:47], a[236:239], a[156:159], v[44:47]
 ds_read_b64_tr_b16 a[234:235], v7 offset:2048
 v_add_f32 v15, v15, v58
 v_mfma_f32_16x16x32_bf16 v[32:35], a[240:243], a[160:163], v[32:35]
 ds_read_b64_tr_b16 a[236:237], v8 offset:0
 v_add_f32 v15, v15, v59
 v_mfma_f32_16x16x32_bf16 v[40:43], a[240:243], a[164:167], v[40:43]
 ds_read_b64_tr_b16 a[238:239], v8 offset:2048
 v_cvt_pk_bf16_f32 v53, v58, v59
 v_mfma_f32_16x16x32_bf16 v[36:39], a[244:247], a[160:163], v[36:39]
 ds_read_b64_tr_b16 a[240:241], v5 offset:4096
 v_add_f32 v15, v15, v60
 v_mfma_f32_16x16x32_bf16 v[44:47], a[244:247], a[164:167], v[44:47]
 ds_read_b64_tr_b16 a[242:243], v5 offset:6144
 v_add_f32 v15, v15, v61
 v_mfma_f32_16x16x32_bf16 v[32:35], a[248:251], a[168:171], v[32:35]
 ds_read_b64_tr_b16 a[244:245], v6 offset:4096
 v_cvt_pk_bf16_f32 v54, v60, v61
 v_mfma_f32_16x16x32_bf16 v[40:43], a[248:251], a[172:175], v[40:43]
 ds_read_b64_tr_b16 a[246:247], v6 offset:6144
 v_add_f32 v15, v15, v62
 v_mfma_f32_16x16x32_bf16 v[36:39], a[252:255], a[168:171], v[36:39]
 ds_read_b64_tr_b16 a[248:249], v7 offset:4096
 v_add_f32 v15, v15, v63
 v_cvt_pk_bf16_f32 v55, v62, v63
 v_mfma_f32_16x16x32_bf16 v[44:47], a[252:255], a[172:175], v[44:47]
 ds_read_b64_tr_b16 a[250:251], v7 offset:6144
 s_waitcnt lgkmcnt(6)
 s_movk_i32 s70, 800
 v_mfma_f32_16x16x32_bf16 v[128:131], a[224:227], v[48:51], v[128:131]
 ds_read_b64_tr_b16 a[252:253], v8 offset:4096
 buffer_load_dword off, s[72:75], s70 lds
 v_cmp_le_u32 vcc, 209, v10
 v_mfma_f32_16x16x32_bf16 v[136:139], a[224:227], v[52:55], v[136:139]
 ds_read_b64_tr_b16 a[254:255], v8 offset:6144
 v_mfma_f32_16x16x32_bf16 v[132:135], a[228:231], v[48:51], v[132:135]
 s_cbranch_vccz L_cs1608
L_cb1608:
 ds_read_b64_tr_b16 a[224:225], v5 offset:8192
 v_mfma_f32_16x16x32_bf16 v[140:143], a[228:231], v[52:55], v[140:143]
 ds_read_b64_tr_b16 a[226:227], v5 offset:10240
 v_max3_f32 v11, v32, v33, v34
 v_mfma_f32_16x16x32_bf16 v[144:147], a[232:235], v[48:51], v[144:147]
 ds_read_b64_tr_b16 a[228:229], v6 offset:8192
 ds_read_b32 v10, v9
 v_mfma_f32_16x16x32_bf16 v[152:155], a[232:235], v[52:55], v[152:155]
 ds_read_b64_tr_b16 a[230:231], v6 offset:10240
 v_max3_f32 v12, v40, v41, v42
 v_mfma_f32_16x16x32_bf16 v[148:151], a[236:239], v[48:51], v[148:151]
 ds_read_b64_tr_b16 a[232:233], v7 offset:8192
 s_waitcnt lgkmcnt(6)
 v_mfma_f32_16x16x32_bf16 v[156:159], a[236:239], v[52:55], v[156:159]
 ds_read_b64_tr_b16 a[234:235], v7 offset:10240
 v_max3_f32 v11, v11, v35, v36
 v_mfma_f32_16x16x32_bf16 v[160:163], a[240:243], v[48:51], v[160:163]
 ds_read_b64_tr_b16 a[236:237], v8 offset:8192
 v_max3_f32 v12, v12, v43, v44
 v_mfma_f32_16x16x32_bf16 v[168:171], a[240:243], v[52:55], v[168:171]
 ds_read_b64_tr_b16 a[238:239], v8 offset:10240
 v_max3_f32 v11, v11, v37, v38
 v_mfma_f32_16x16x32_bf16 v[164:167], a[244:247], v[48:51], v[164:167]
 ds_read_b64_tr_b16 a[240:241], v5 offset:12288
 v_max3_f32 v12, v12, v45, v46
 v_mfma_f32_16x16x32_bf16 v[172:175], a[244:247], v[52:55], v[172:175]
 ds_read_b64_tr_b16 a[242:243], v5 offset:14336
 v_max_f32 v11, v11, v39
 v_mfma_f32_16x16x32_bf16 v[176:179], a[248:251], v[48:51], v[176:179]
 ds_read_b64_tr_b16 a[244:245], v6 offset:12288
 v_max_f32 v12, v12, v47
 v_mfma_f32_16x16x32_bf16 v[184:187], a[248:251], v[52:55], v[184:187]
 ds_read_b64_tr_b16 a[246:247], v6 offset:14336
 v_max_f32 v13, v11, v12
 v_cmp_lt_f32 vcc, 0x41200000, v13
 v_mfma_f32_16x16x32_bf16 v[180:183], a[252:255], v[48:51], v[180:183]
 ds_read_b64_tr_b16 a[248:249], v7 offset:12288
 s_waitcnt lgkmcnt(5)
 s_cbranch_vccnz L_rs1_14
L_rb1_14:
 v_mfma_f32_16x16x32_bf16 v[188:191], a[252:255], v[52:55], v[188:191]
 ds_read_b64_tr_b16 a[250:251], v7 offset:14336
 v_mfma_f32_16x16x32_bf16 v[192:195], a[224:227], v[48:51], v[192:195]
 ds_read_b64_tr_b16 a[252:253], v8 offset:12288
 v_cmp_le_u32 vcc, 211, v10
 v_mfma_f32_16x16x32_bf16 v[200:203], a[224:227], v[52:55], v[200:203]
 ds_read_b64_tr_b16 a[254:255], v8 offset:14336
 v_mfma_f32_16x16x32_bf16 v[196:199], a[228:231], v[48:51], v[196:199]
 s_cbranch_vccz L_cs1616
L_cb1616:
 ds_read_b64_tr_b16 a[224:225], v24 offset:16384
 v_mfma_f32_16x16x32_bf16 v[204:207], a[228:231], v[52:55], v[204:207]
 ds_read_b64_tr_b16 a[226:227], v24 offset:18432
 v_mfma_f32_16x16x32_bf16 v[208:211], a[232:235], v[48:51], v[208:211]
 ds_read_b64_tr_b16 a[228:229], v25 offset:16384
 v_mfma_f32_16x16x32_bf16 v[216:219], a[232:235], v[52:55], v[216:219]
 ds_read_b64_tr_b16 a[230:231], v25 offset:18432
 v_mfma_f32_16x16x32_bf16 v[212:215], a[236:239], v[48:51], v[212:215]
 ds_read_b64_tr_b16 a[232:233], v26 offset:16384
 s_waitcnt lgkmcnt(5)
 v_mfma_f32_16x16x32_bf16 v[220:223], a[236:239], v[52:55], v[220:223]
 ds_read_b64_tr_b16 a[234:235], v26 offset:18432
 v_mfma_f32_16x16x32_bf16 v[224:227], a[240:243], v[48:51], v[224:227]
 ds_read_b64_tr_b16 a[236:237], v27 offset:16384
 v_mfma_f32_16x16x32_bf16 v[232:235], a[240:243], v[52:55], v[232:235]
 ds_read_b64_tr_b16 a[238:239], v27 offset:18432
 v_mfma_f32_16x16x32_bf16 v[228:231], a[244:247], v[48:51], v[228:231]
 ds_read_b64_tr_b16 a[240:241], v24 offset:20480
 v_add_u32 v3, 0x10000, v3
 v_mfma_f32_16x16x32_bf16 v[236:239], a[244:247], v[52:55], v[236:239]
 ds_read_b64_tr_b16 a[242:243], v24 offset:22528
 s_movk_i32 s70, 808
 v_mfma_f32_16x16x32_bf16 v[240:243], a[248:251], v[48:51], v[240:243]
 ds_read_b64_tr_b16 a[244:245], v25 offset:20480
 v_mfma_f32_16x16x32_bf16 v[248:251], a[248:251], v[52:55], v[248:251]
 ds_read_b64_tr_b16 a[246:247], v25 offset:22528
 v_mfma_f32_16x16x32_bf16 v[244:247], a[252:255], v[48:51], v[244:247]
 ds_read_b64_tr_b16 a[248:249], v26 offset:20480
 s_waitcnt lgkmcnt(5)
 v_mfma_f32_16x16x32_bf16 v[252:255], a[252:255], v[52:55], v[252:255]
 ds_read_b64_tr_b16 a[250:251], v26 offset:22528
 v_add_u32 v4, 0x10000, v4
 v_mfma_f32_16x16x32_bf16 a[64:67], a[224:227], v[64:67], 0
 ds_read_b64_tr_b16 a[252:253], v27 offset:20480
 buffer_load_dword off, s[72:75], s70 lds
 v_mfma_f32_16x16x32_bf16 a[72:75], a[224:227], v[68:71], 0
 ds_read_b64_tr_b16 a[254:255], v27 offset:22528
 v_mfma_f32_16x16x32_bf16 a[68:71], a[228:231], v[64:67], 0
 ds_read_b64_tr_b16 a[224:225], v24 offset:24576
 v_mfma_f32_16x16x32_bf16 a[76:79], a[228:231], v[68:71], 0
 ds_read_b64_tr_b16 a[226:227], v24 offset:26624
 v_mfma_f32_16x16x32_bf16 a[80:83], a[232:235], v[64:67], 0
 ds_read_b64_tr_b16 a[228:229], v25 offset:24576
 ds_read_b32 v10, v9
 v_mfma_f32_16x16x32_bf16 a[88:91], a[232:235], v[68:71], 0
 ds_read_b64_tr_b16 a[230:231], v25 offset:26624
 v_mfma_f32_16x16x32_bf16 a[84:87], a[236:239], v[64:67], 0
 ds_read_b64_tr_b16 a[232:233], v26 offset:24576
 s_waitcnt lgkmcnt(6)
 v_mfma_f32_16x16x32_bf16 a[92:95], a[236:239], v[68:71], 0
 ds_read_b64_tr_b16 a[234:235], v26 offset:26624
 v_mfma_f32_16x16x32_bf16 a[64:67], a[240:243], v[72:75], a[64:67]
 ds_read_b64_tr_b16 a[236:237], v27 offset:24576
 v_mfma_f32_16x16x32_bf16 a[72:75], a[240:243], v[76:79], a[72:75]
 ds_read_b64_tr_b16 a[238:239], v27 offset:26624
 v_mfma_f32_16x16x32_bf16 a[68:71], a[244:247], v[72:75], a[68:71]
 ds_read_b64_tr_b16 a[240:241], v24 offset:28672
 v_mfma_f32_16x16x32_bf16 a[76:79], a[244:247], v[76:79], a[76:79]
 ds_read_b64_tr_b16 a[242:243], v24 offset:30720
 v_mfma_f32_16x16x32_bf16 a[80:83], a[248:251], v[72:75], a[80:83]
 ds_read_b64_tr_b16 a[244:245], v25 offset:28672
 v_mfma_f32_16x16x32_bf16 a[88:91], a[248:251], v[76:79], a[88:91]
 ds_read_b64_tr_b16 a[246:247], v25 offset:30720
 v_mfma_f32_16x16x32_bf16 a[84:87], a[252:255], v[72:75], a[84:87]
 ds_read_b64_tr_b16 a[248:249], v26 offset:28672
 s_waitcnt lgkmcnt(5)
 v_mfma_f32_16x16x32_bf16 a[92:95], a[252:255], v[76:79], a[92:95]
 ds_read_b64_tr_b16 a[250:251], v26 offset:30720
 v_mfma_f32_16x16x32_bf16 a[64:67], a[224:227], v[80:83], a[64:67]
 ds_read_b64_tr_b16 a[252:253], v27 offset:28672
 v_cmp_le_u32 vcc, 214, v10
 v_mfma_f32_16x16x32_bf16 a[72:75], a[224:227], v[84:87], a[72:75]
 ds_read_b64_tr_b16 a[254:255], v27 offset:30720
 v_mfma_f32_16x16x32_bf16 a[68:71], a[228:231], v[80:83], a[68:71]
 s_cbranch_vccz L_cs1632
L_cb1632:
 ds_read_b128 a[224:227], v3 offset:16384
 v_mfma_f32_16x16x32_bf16 a[76:79], a[228:231], v[84:87], a[76:79]
 v_exp_f32 v32, v32
 v_mfma_f32_16x16x32_bf16 a[80:83], a[232:235], v[80:83], a[80:83]
 ds_read_b128 a[228:231], v3 offset:18432
 v_add_f32 v14, v14, v32
 v_mfma_f32_16x16x32_bf16 a[88:91], a[232:235], v[84:87], a[88:91]
 v_exp_f32 v33, v33
 v_mfma_f32_16x16x32_bf16 a[84:87], a[236:239], v[80:83], a[84:87]
 ds_read_b128 a[232:235], v4 offset:16384
 s_waitcnt lgkmcnt(3)
 v_mfma_f32_16x16x32_bf16 a[92:95], a[236:239], v[84:87], a[92:95]
 v_exp_f32 v34, v34
 v_mfma_f32_16x16x32_bf16 a[64:67], a[240:243], v[88:91], a[64:67]
 ds_read_b128 a[236:239], v4 offset:18432
 v_add_f32 v14, v14, v33
 v_mfma_f32_16x16x32_bf16 a[72:75], a[240:243], v[92:95], a[72:75]
 v_exp_f32 v35, v35
 v_mfma_f32_16x16x32_bf16 a[68:71], a[244:247], v[88:91], a[68:71]
 ds_read_b128 a[240:243], v3 offset:20480
 v_add_u32 v5, 0xffff0000, v5
 v_mfma_f32_16x16x32_bf16 a[76:79], a[244:247], v[92:95], a[76:79]
 v_exp_f32 v36, v36
 v_mfma_f32_16x16x32_bf16 a[80:83], a[248:251], v[88:91], a[80:83]
 ds_read_b128 a[244:247], v3 offset:22528
 s_movk_i32 s70, 816
 v_mfma_f32_16x16x32_bf16 a[88:91], a[248:251], v[92:95], a[88:91]
 v_exp_f32 v37, v37
 v_mfma_f32_16x16x32_bf16 a[84:87], a[252:255], v[88:91], a[84:87]
 ds_read_b128 a[248:251], v4 offset:20480
 s_waitcnt lgkmcnt(3)
 v_add_u32 v3, 0xffff0000, v3
 v_add_u32 v6, 0xffff0000, v6
 v_mfma_f32_16x16x32_bf16 a[92:95], a[252:255], v[92:95], a[92:95]
 buffer_load_dword off, s[72:75], s70 lds
 v_add_u32 v7, 0xffff0000, v7
 v_exp_f32 v38, v38
 v_mfma_f32_16x16x32_bf16 v[48:51], a[224:227], a[112:115], v[16:19]
 ds_read_b128 a[252:255], v4 offset:22528
 v_add_u32 v4, 0xffff0000, v4
 v_add_u32 v8, 0xffff0000, v8
 v_mfma_f32_16x16x32_bf16 v[56:59], a[224:227], a[116:119], v[20:23]
 v_exp_f32 v39, v39
 v_mfma_f32_16x16x32_bf16 v[52:55], a[228:231], a[112:115], v[16:19]
 ds_read_b128 a[224:227], v3 offset:8192
 v_cvt_pk_bf16_f32 v32, v32, v33
 v_mfma_f32_16x16x32_bf16 v[60:63], a[228:231], a[116:119], v[20:23]
 v_exp_f32 v40, v40
 v_mfma_f32_16x16x32_bf16 v[48:51], a[232:235], a[120:123], v[48:51]
 ds_read_b128 a[228:231], v3 offset:10240
 v_add_f32 v14, v14, v34
 v_mfma_f32_16x16x32_bf16 v[56:59], a[232:235], a[124:127], v[56:59]
 v_exp_f32 v41, v41
 v_mfma_f32_16x16x32_bf16 v[52:55], a[236:239], a[120:123], v[52:55]
 ds_read_b128 a[232:235], v4 offset:8192
 s_waitcnt lgkmcnt(3)
 v_exp_f32 v42, v42
 v_mfma_f32_16x16x32_bf16 v[60:63], a[236:239], a[124:127], v[60:63]
 v_exp_f32 v43, v43
 v_mfma_f32_16x16x32_bf16 v[48:51], a[240:243], a[128:131], v[48:51]
 ds_read_b128 a[236:239], v4 offset:10240
 v_add_f32 v14, v14, v35
 v_mfma_f32_16x16x32_bf16 v[56:59], a[240:243], a[132:135], v[56:59]
 v_exp_f32 v44, v44
 v_mfma_f32_16x16x32_bf16 v[52:55], a[244:247], a[128:131], v[52:55]
 ds_read_b128 a[240:243], v3 offset:12288
 v_cvt_pk_bf16_f32 v33, v34, v35
 v_mfma_f32_16x16x32_bf16 v[60:63], a[244:247], a[132:135], v[60:63]
 v_exp_f32 v45, v45
 v_mfma_f32_16x16x32_bf16 v[48:51], a[248:251], a[136:139], v[48:51]
 ds_read_b128 a[244:247], v3 offset:14336
 v_add_f32 v14, v14, v36
 v_mfma_f32_16x16x32_bf16 v[56:59], a[248:251], a[140:143], v[56:59]
 v_exp_f32 v46, v46
 v_mfma_f32_16x16x32_bf16 v[52:55], a[252:255], a[136:139], v[52:55]
 ds_read_b128 a[248:251], v4 offset:12288
 s_waitcnt lgkmcnt(3)
 v_mfma_f32_16x16x32_bf16 v[60:63], a[252:255], a[140:143], v[60:63]
 v_exp_f32 v47, v47
 v_mfma_f32_16x16x32_bf16 v[48:51], a[224:227], a[144:147], v[48:51]
 ds_read_b128 a[252:255], v4 offset:14336
 v_add_f32 v14, v14, v37
 v_mfma_f32_16x16x32_bf16 v[56:59], a[224:227], a[148:151], v[56:59]
 v_cvt_pk_bf16_f32 v34, v36, v37
 v_add_f32 v14, v14, v38
 v_mfma_f32_16x16x32_bf16 v[52:55], a[228:231], a[144:147], v[52:55]
 ds_read_b64_tr_b16 a[224:225], v5 offset:0
 v_add_f32 v14, v14, v39
 v_mfma_f32_16x16x32_bf16 v[60:63], a[228:231], a[148:151], v[60:63]
 ds_read_b64_tr_b16 a[226:227], v5 offset:2048
 v_cvt_pk_bf16_f32 v35, v38, v39
 v_mfma_f32_16x16x32_bf16 v[48:51], a[232:235], a[152:155], v[48:51]
 ds_read_b64_tr_b16 a[228:229], v6 offset:0
 ds_read_b32 v10, v9
 v_add_f32 v15, v15, v40
 v_mfma_f32_16x16x32_bf16 v[56:59], a[232:235], a[156:159], v[56:59]
 ds_read_b64_tr_b16 a[230:231], v6 offset:2048
 v_add_f32 v15, v15, v41
 v_mfma_f32_16x16x32_bf16 v[52:55], a[236:239], a[152:155], v[52:55]
 ds_read_b64_tr_b16 a[232:233], v7 offset:0
 s_waitcnt lgkmcnt(6)
 v_cvt_pk_bf16_f32 v36, v40, v41
 v_mfma_f32_16x16x32_bf16 v[60:63], a[236:239], a[156:159], v[60:63]
 ds_read_b64_tr_b16 a[234:235], v7 offset:2048
 v_add_f32 v15, v15, v42
 v_mfma_f32_16x16x32_bf16 v[48:51], a[240:243], a[160:163], v[48:51]
 ds_read_b64_tr_b16 a[236:237], v8 offset:0
 v_add_f32 v15, v15, v43
 v_mfma_f32_16x16x32_bf16 v[56:59], a[240:243], a[164:167], v[56:59]
 ds_read_b64_tr_b16 a[238:239], v8 offset:2048
 v_cvt_pk_bf16_f32 v37, v42, v43
 v_mfma_f32_16x16x32_bf16 v[52:55], a[244:247], a[160:163], v[52:55]
 ds_read_b64_tr_b16 a[240:241], v5 offset:4096
 v_add_f32 v15, v15, v44
 v_mfma_f32_16x16x32_bf16 v[60:63], a[244:247], a[164:167], v[60:63]
 ds_read_b64_tr_b16 a[242:243], v5 offset:6144
 v_add_f32 v15, v15, v45
 v_mfma_f32_16x16x32_bf16 v[48:51], a[248:251], a[168:171], v[48:51]
 ds_read_b64_tr_b16 a[244:245], v6 offset:4096
 v_cvt_pk_bf16_f32 v38, v44, v45
 v_mfma_f32_16x16x32_bf16 v[56:59], a[248:251], a[172:175], v[56:59]
 ds_read_b64_tr_b16 a[246:247], v6 offset:6144
 v_add_f32 v15, v15, v46
 v_mfma_f32_16x16x32_bf16 v[52:55], a[252:255], a[168:171], v[52:55]
 ds_read_b64_tr_b16 a[248:249], v7 offset:4096
 v_add_f32 v15, v15, v47
 v_cvt_pk_bf16_f32 v39, v46, v47
 v_mfma_f32_16x16x32_bf16 v[60:63], a[252:255], a[172:175], v[60:63]
 ds_read_b64_tr_b16 a[250:251], v7 offset:6144
 s_waitcnt lgkmcnt(6)
 s_movk_i32 s70, 824
 v_mfma_f32_16x16x32_bf16 v[128:131], a[224:227], v[32:35], v[128:131]
 ds_read_b64_tr_b16 a[252:253], v8 offset:4096
 buffer_load_dword off, s[72:75], s70 lds
 v_cmp_le_u32 vcc, 215, v10
 v_mfma_f32_16x16x32_bf16 v[136:139], a[224:227], v[36:39], v[136:139]
 ds_read_b64_tr_b16 a[254:255], v8 offset:6144
 v_mfma_f32_16x16x32_bf16 v[132:135], a[228:231], v[32:35], v[132:135]
 s_cbranch_vccz L_cs1656
L_cb1656:
 ds_read_b64_tr_b16 a[224:225], v5 offset:16384
 v_mfma_f32_16x16x32_bf16 v[140:143], a[228:231], v[36:39], v[140:143]
 ds_read_b64_tr_b16 a[226:227], v5 offset:18432
 v_max3_f32 v11, v48, v49, v50
 v_mfma_f32_16x16x32_bf16 v[144:147], a[232:235], v[32:35], v[144:147]
 ds_read_b64_tr_b16 a[228:229], v6 offset:16384
 ds_read_b32 v10, v9
 v_mfma_f32_16x16x32_bf16 v[152:155], a[232:235], v[36:39], v[152:155]
 ds_read_b64_tr_b16 a[230:231], v6 offset:18432
 v_max3_f32 v12, v56, v57, v58
 v_mfma_f32_16x16x32_bf16 v[148:151], a[236:239], v[32:35], v[148:151]
 ds_read_b64_tr_b16 a[232:233], v7 offset:16384
 s_waitcnt lgkmcnt(6)
 v_mfma_f32_16x16x32_bf16 v[156:159], a[236:239], v[36:39], v[156:159]
 ds_read_b64_tr_b16 a[234:235], v7 offset:18432
 v_max3_f32 v11, v11, v51, v52
 v_mfma_f32_16x16x32_bf16 v[160:163], a[240:243], v[32:35], v[160:163]
 ds_read_b64_tr_b16 a[236:237], v8 offset:16384
 v_max3_f32 v12, v12, v59, v60
 v_mfma_f32_16x16x32_bf16 v[168:171], a[240:243], v[36:39], v[168:171]
 ds_read_b64_tr_b16 a[238:239], v8 offset:18432
 v_max3_f32 v11, v11, v53, v54
 v_mfma_f32_16x16x32_bf16 v[164:167], a[244:247], v[32:35], v[164:167]
 ds_read_b64_tr_b16 a[240:241], v5 offset:20480
 v_max3_f32 v12, v12, v61, v62
 v_mfma_f32_16x16x32_bf16 v[172:175], a[244:247], v[36:39], v[172:175]
 ds_read_b64_tr_b16 a[242:243], v5 offset:22528
 v_max_f32 v11, v11, v55
 v_mfma_f32_16x16x32_bf16 v[176:179], a[248:251], v[32:35], v[176:179]
 ds_read_b64_tr_b16 a[244:245], v6 offset:20480
 v_max_f32 v12, v12, v63
 v_mfma_f32_16x16x32_bf16 v[184:187], a[248:251], v[36:39], v[184:187]
 ds_read_b64_tr_b16 a[246:247], v6 offset:22528
 v_max_f32 v13, v11, v12
 v_cmp_lt_f32 vcc, 0x41200000, v13
 v_mfma_f32_16x16x32_bf16 v[180:183], a[252:255], v[32:35], v[180:183]
 ds_read_b64_tr_b16 a[248:249], v7 offset:20480
 s_waitcnt lgkmcnt(5)
 s_cbranch_vccnz L_rs1_15
L_rb1_15:
 v_exp_f32 v48, v48
 v_exp_f32 v49, v49
 v_exp_f32 v50, v50
 v_exp_f32 v51, v51
 v_exp_f32 v52, v52
 v_mfma_f32_16x16x32_bf16 v[188:191], a[252:255], v[36:39], v[188:191]
 ds_read_b64_tr_b16 a[250:251], v7 offset:22528
 v_add_f32 v14, v14, v48
 v_mfma_f32_16x16x32_bf16 v[192:195], a[224:227], v[32:35], v[192:195]
 ds_read_b64_tr_b16 a[252:253], v8 offset:20480
 v_cmp_le_u32 vcc, 217, v10
 v_mfma_f32_16x16x32_bf16 v[200:203], a[224:227], v[36:39], v[200:203]
 ds_read_b64_tr_b16 a[254:255], v8 offset:22528
 v_add_f32 v14, v14, v49
 v_mfma_f32_16x16x32_bf16 v[196:199], a[228:231], v[32:35], v[196:199]
 s_cbranch_vccz L_cs1664
L_cb1664:
 ds_read_b64_tr_b16 a[224:225], v24 offset:40960
 v_mfma_f32_16x16x32_bf16 v[204:207], a[228:231], v[36:39], v[204:207]
 ds_read_b64_tr_b16 a[226:227], v24 offset:43008
 v_cvt_pk_bf16_f32 v48, v48, v49
 v_mfma_f32_16x16x32_bf16 v[208:211], a[232:235], v[32:35], v[208:211]
 ds_read_b64_tr_b16 a[228:229], v25 offset:40960
 v_add_f32 v14, v14, v50
 v_mfma_f32_16x16x32_bf16 v[216:219], a[232:235], v[36:39], v[216:219]
 ds_read_b64_tr_b16 a[230:231], v25 offset:43008
 v_add_f32 v14, v14, v51
 v_mfma_f32_16x16x32_bf16 v[212:215], a[236:239], v[32:35], v[212:215]
 ds_read_b64_tr_b16 a[232:233], v26 offset:40960
 s_waitcnt lgkmcnt(5)
 v_exp_f32 v53, v53
 v_mfma_f32_16x16x32_bf16 v[220:223], a[236:239], v[36:39], v[220:223]
 ds_read_b64_tr_b16 a[234:235], v26 offset:43008
 v_cvt_pk_bf16_f32 v49, v50, v51
 v_mfma_f32_16x16x32_bf16 v[224:227], a[240:243], v[32:35], v[224:227]
 ds_read_b64_tr_b16 a[236:237], v27 offset:40960
 v_add_f32 v14, v14, v52
 v_mfma_f32_16x16x32_bf16 v[232:235], a[240:243], v[36:39], v[232:235]
 ds_read_b64_tr_b16 a[238:239], v27 offset:43008
 v_add_f32 v14, v14, v53
 v_mfma_f32_16x16x32_bf16 v[228:231], a[244:247], v[32:35], v[228:231]
 ds_read_b64_tr_b16 a[240:241], v24 offset:45056
 v_cvt_pk_bf16_f32 v50, v52, v53
 v_mfma_f32_16x16x32_bf16 v[236:239], a[244:247], v[36:39], v[236:239]
 ds_read_b64_tr_b16 a[242:243], v24 offset:47104
 s_movk_i32 s70, 832
 v_mfma_f32_16x16x32_bf16 v[240:243], a[248:251], v[32:35], v[240:243]
 ds_read_b64_tr_b16 a[244:245], v25 offset:45056
 v_mbcnt_lo_u32_b32 v3, -1, 0
 v_exp_f32 v54, v54
 v_mfma_f32_16x16x32_bf16 v[248:251], a[248:251], v[36:39], v[248:251]
 ds_read_b64_tr_b16 a[246:247], v25 offset:47104
 v_add_f32 v14, v14, v54
 v_mfma_f32_16x16x32_bf16 v[244:247], a[252:255], v[32:35], v[244:247]
 ds_read_b64_tr_b16 a[248:249], v26 offset:45056
 s_waitcnt lgkmcnt(5)
 v_mfma_f32_16x16x32_bf16 v[252:255], a[252:255], v[36:39], v[252:255]
 ds_read_b64_tr_b16 a[250:251], v26 offset:47104
 buffer_load_dword off, s[72:75], s70 lds
 v_mbcnt_hi_u32_b32 v3, -1, v3
 v_exp_f32 v55, v55
 v_mfma_f32_16x16x32_bf16 a[64:67], a[224:227], v[96:99], a[64:67]
 ds_read_b64_tr_b16 a[252:253], v27 offset:45056
 v_add_f32 v14, v14, v55
 v_mfma_f32_16x16x32_bf16 a[72:75], a[224:227], v[100:103], a[72:75]
 ds_read_b64_tr_b16 a[254:255], v27 offset:47104
 v_cvt_pk_bf16_f32 v51, v54, v55
 v_mfma_f32_16x16x32_bf16 a[68:71], a[228:231], v[96:99], a[68:71]
 ds_read_b64_tr_b16 a[224:225], v24 offset:32768
 v_bfe_u32 v16, v3, 2, 2
 v_mfma_f32_16x16x32_bf16 a[76:79], a[228:231], v[100:103], a[76:79]
 ds_read_b64_tr_b16 a[226:227], v24 offset:34816
 v_lshrrev_b32 v17, 4, v3
 v_exp_f32 v56, v56
 v_mfma_f32_16x16x32_bf16 a[80:83], a[232:235], v[96:99], a[80:83]
 ds_read_b64_tr_b16 a[228:229], v25 offset:32768
 ds_read_b32 v10, v9
 v_mfma_f32_16x16x32_bf16 a[88:91], a[232:235], v[100:103], a[88:91]
 ds_read_b64_tr_b16 a[230:231], v25 offset:34816
 v_add_f32 v15, v15, v56
 v_mfma_f32_16x16x32_bf16 a[84:87], a[236:239], v[96:99], a[84:87]
 ds_read_b64_tr_b16 a[232:233], v26 offset:32768
 s_waitcnt lgkmcnt(6)
 v_exp_f32 v57, v57
 v_mfma_f32_16x16x32_bf16 a[92:95], a[236:239], v[100:103], a[92:95]
 ds_read_b64_tr_b16 a[234:235], v26 offset:34816
 v_add_f32 v15, v15, v57
 v_mfma_f32_16x16x32_bf16 a[64:67], a[240:243], v[104:107], a[64:67]
 ds_read_b64_tr_b16 a[236:237], v27 offset:32768
 v_cvt_pk_bf16_f32 v52, v56, v57
 v_mfma_f32_16x16x32_bf16 a[72:75], a[240:243], v[108:111], a[72:75]
 ds_read_b64_tr_b16 a[238:239], v27 offset:34816
 v_xor_b32 v16, v16, v17
 v_mfma_f32_16x16x32_bf16 a[68:71], a[244:247], v[104:107], a[68:71]
 ds_read_b64_tr_b16 a[240:241], v24 offset:36864
 v_min_u32 v16, 1, v16
 v_exp_f32 v58, v58
 v_mfma_f32_16x16x32_bf16 a[76:79], a[244:247], v[108:111], a[76:79]
 ds_read_b64_tr_b16 a[242:243], v24 offset:38912
 v_add_f32 v15, v15, v58
 v_mfma_f32_16x16x32_bf16 a[80:83], a[248:251], v[104:107], a[80:83]
 ds_read_b64_tr_b16 a[244:245], v25 offset:36864
 v_add_u32 v16, -1, v16
 v_mfma_f32_16x16x32_bf16 a[88:91], a[248:251], v[108:111], a[88:91]
 ds_read_b64_tr_b16 a[246:247], v25 offset:38912
 v_and_b32 v16, 0x3f80, v16
 v_exp_f32 v59, v59
 v_mfma_f32_16x16x32_bf16 a[84:87], a[252:255], v[104:107], a[84:87]
 ds_read_b64_tr_b16 a[248:249], v26 offset:36864
 s_waitcnt lgkmcnt(5)
 v_mfma_f32_16x16x32_bf16 a[92:95], a[252:255], v[108:111], a[92:95]
 ds_read_b64_tr_b16 a[250:251], v26 offset:38912
 v_add_f32 v15, v15, v59
 v_mfma_f32_16x16x32_bf16 a[64:67], a[224:227], v[112:115], a[64:67]
 ds_read_b64_tr_b16 a[252:253], v27 offset:36864
 v_cmp_le_u32 vcc, 219, v10
 v_exp_f32 v60, v60
 v_exp_f32 v61, v61
 v_exp_f32 v62, v62
 v_exp_f32 v63, v63
 v_cvt_pk_bf16_f32 v53, v58, v59
 v_mfma_f32_16x16x32_bf16 a[72:75], a[224:227], v[116:119], a[72:75]
 ds_read_b64_tr_b16 a[254:255], v27 offset:38912
 v_add_f32 v15, v15, v60
 v_add_f32 v15, v15, v61
 v_cvt_pk_bf16_f32 v54, v60, v61
 v_mfma_f32_16x16x32_bf16 a[68:71], a[228:231], v[112:115], a[68:71]
 s_cbranch_vccz L_cs1680
L_cb1680:
 ds_read_b64_tr_b16 a[224:225], v5 offset:24576
 v_mfma_f32_16x16x32_bf16 a[76:79], a[228:231], v[116:119], a[76:79]
 ds_read_b64_tr_b16 a[226:227], v5 offset:26624
 v_add_f32 v15, v15, v62
 v_mfma_f32_16x16x32_bf16 a[80:83], a[232:235], v[112:115], a[80:83]
 ds_read_b64_tr_b16 a[228:229], v6 offset:24576
 v_add_f32 v15, v15, v63
 v_mfma_f32_16x16x32_bf16 a[88:91], a[232:235], v[116:119], a[88:91]
 ds_read_b64_tr_b16 a[230:231], v6 offset:26624
 v_cvt_pk_bf16_f32 v55, v62, v63
 v_mfma_f32_16x16x32_bf16 a[84:87], a[236:239], v[112:115], a[84:87]
 ds_read_b64_tr_b16 a[232:233], v7 offset:24576
 s_waitcnt lgkmcnt(5)
 v_mov_b32 v1, v14
 v_mfma_f32_16x16x32_bf16 a[92:95], a[236:239], v[116:119], a[92:95]
 ds_read_b64_tr_b16 a[234:235], v7 offset:26624
 v_mov_b32 v2, v15
 v_mfma_f32_16x16x32_bf16 a[64:67], a[240:243], v[120:123], a[64:67]
 ds_read_b64_tr_b16 a[236:237], v8 offset:24576
 v_and_b32 v17, 1, v3
 v_permlane32_swap_b32 v1, v14
 v_mfma_f32_16x16x32_bf16 a[72:75], a[240:243], v[124:127], a[72:75]
 ds_read_b64_tr_b16 a[238:239], v8 offset:26624
 v_lshlrev_b32 v17, 4, v17
 v_mfma_f32_16x16x32_bf16 a[68:71], a[244:247], v[120:123], a[68:71]
 ds_read_b64_tr_b16 a[240:241], v5 offset:28672
 v_lshlrev_b32 v16, v17, v16
 v_permlane32_swap_b32 v2, v15
 v_mfma_f32_16x16x32_bf16 a[76:79], a[244:247], v[124:127], a[76:79]
 ds_read_b64_tr_b16 a[242:243], v5 offset:30720
 s_movk_i32 s70, 840
 v_add_u32 v5, 0xffff0000, v5
 v_mfma_f32_16x16x32_bf16 a[80:83], a[248:251], v[120:123], a[80:83]
 ds_read_b64_tr_b16 a[244:245], v6 offset:28672
 v_add_f32 v14, v1, v14
 v_mfma_f32_16x16x32_bf16 a[88:91], a[248:251], v[124:127], a[88:91]
 ds_read_b64_tr_b16 a[246:247], v6 offset:30720
 v_add_u32 v6, 0xffff0000, v6
 v_add_f32 v15, v2, v15
 v_mfma_f32_16x16x32_bf16 a[84:87], a[252:255], v[120:123], a[84:87]
 ds_read_b64_tr_b16 a[248:249], v7 offset:28672
 s_waitcnt lgkmcnt(5)
 v_mov_b32 v1, v14
 v_mfma_f32_16x16x32_bf16 a[92:95], a[252:255], v[124:127], a[92:95]
 ds_read_b64_tr_b16 a[250:251], v7 offset:30720
 buffer_load_dword off, s[72:75], s70 lds
 v_add_u32 v7, 0xffff0000, v7
 v_mov_b32 v2, v15
 v_mfma_f32_16x16x32_bf16 v[128:131], a[224:227], v[48:51], v[128:131]
 ds_read_b64_tr_b16 a[252:253], v8 offset:28672
 v_bfe_i32 v17, v3, 1, 1
 v_permlane16_swap_b32 v1, v14
 v_mfma_f32_16x16x32_bf16 v[136:139], a[224:227], v[52:55], v[136:139]
 ds_read_b64_tr_b16 a[254:255], v8 offset:30720
 v_add_u32 v8, 0xffff0000, v8
 v_mfma_f32_16x16x32_bf16 v[132:135], a[228:231], v[48:51], v[132:135]
 ds_read_b64_tr_b16 a[224:225], v5 offset:49152
 v_and_b32 v19, v16, v17
 v_permlane16_swap_b32 v2, v15
 v_mfma_f32_16x16x32_bf16 v[140:143], a[228:231], v[52:55], v[140:143]
 ds_read_b64_tr_b16 a[226:227], v5 offset:51200
 v_add_f32 v14, v1, v14
 v_mfma_f32_16x16x32_bf16 v[144:147], a[232:235], v[48:51], v[144:147]
 ds_read_b64_tr_b16 a[228:229], v6 offset:49152
 ds_read_b32 v10, v9
 v_mfma_f32_16x16x32_bf16 v[152:155], a[232:235], v[52:55], v[152:155]
 ds_read_b64_tr_b16 a[230:231], v6 offset:51200
 v_add_f32 v15, v2, v15
 v_mfma_f32_16x16x32_bf16 v[148:151], a[236:239], v[48:51], v[148:151]
 ds_read_b64_tr_b16 a[232:233], v7 offset:49152
 s_waitcnt lgkmcnt(6)
 v_rcp_f32 v1, v14
 v_rcp_f32 v2, v15
 v_mfma_f32_16x16x32_bf16 v[156:159], a[236:239], v[52:55], v[156:159]
 ds_read_b64_tr_b16 a[234:235], v7 offset:51200
 v_mul_f32 v128, v128, v1
 v_mfma_f32_16x16x32_bf16 v[160:163], a[240:243], v[48:51], v[160:163]
 ds_read_b64_tr_b16 a[236:237], v8 offset:49152
 v_mul_f32 v129, v129, v1
 v_mfma_f32_16x16x32_bf16 v[168:171], a[240:243], v[52:55], v[168:171]
 ds_read_b64_tr_b16 a[238:239], v8 offset:51200
 v_cvt_pk_bf16_f32 v64, v128, v129
 v_mfma_f32_16x16x32_bf16 v[164:167], a[244:247], v[48:51], v[164:167]
 ds_read_b64_tr_b16 a[240:241], v5 offset:53248
 v_mul_f32 v130, v130, v1
 v_mul_f32 v131, v131, v1
 v_cvt_pk_bf16_f32 v65, v130, v131
 v_mul_f32 v132, v132, v1
 v_mul_f32 v133, v133, v1
 v_cvt_pk_bf16_f32 v66, v132, v133
 v_mul_f32 v134, v134, v1
 v_mul_f32 v135, v135, v1
 v_cvt_pk_bf16_f32 v67, v134, v135
 v_mul_f32 v136, v136, v2
 v_mul_f32 v137, v137, v2
 v_cvt_pk_bf16_f32 v68, v136, v137
 v_mul_f32 v138, v138, v2
 v_mul_f32 v139, v139, v2
 v_cvt_pk_bf16_f32 v69, v138, v139
 v_mul_f32 v140, v140, v2
 v_mul_f32 v141, v141, v2
 v_mfma_f32_16x16x32_bf16 v[172:175], a[244:247], v[52:55], v[172:175]
 ds_read_b64_tr_b16 a[242:243], v5 offset:55296
 v_cvt_pk_bf16_f32 v70, v140, v141
 v_mfma_f32_16x16x32_bf16 v[176:179], a[248:251], v[48:51], v[176:179]
 ds_read_b64_tr_b16 a[244:245], v6 offset:53248
 v_mul_f32 v142, v142, v2
 v_mfma_f32_16x16x32_bf16 v[184:187], a[248:251], v[52:55], v[184:187]
 ds_read_b64_tr_b16 a[246:247], v6 offset:55296
 v_mul_f32 v143, v143, v2
 v_mfma_f32_16x16x32_bf16 v[180:183], a[252:255], v[48:51], v[180:183]
 ds_read_b64_tr_b16 a[248:249], v7 offset:53248
 s_waitcnt lgkmcnt(5)
 v_cvt_pk_bf16_f32 v71, v142, v143
 v_mul_f32 v144, v144, v1
 v_mul_f32 v145, v145, v1
 v_cvt_pk_bf16_f32 v72, v144, v145
 v_mul_f32 v146, v146, v1
 v_mul_f32 v147, v147, v1
 v_cvt_pk_bf16_f32 v73, v146, v147
 v_mul_f32 v148, v148, v1
 v_mul_f32 v149, v149, v1
 v_cvt_pk_bf16_f32 v74, v148, v149
 v_mul_f32 v150, v150, v1
 v_mul_f32 v151, v151, v1
 v_cvt_pk_bf16_f32 v75, v150, v151
 v_mul_f32 v152, v152, v2
 v_mul_f32 v153, v153, v2
 v_cvt_pk_bf16_f32 v76, v152, v153
 v_mul_f32 v154, v154, v2
 v_mfma_f32_16x16x32_bf16 v[188:191], a[252:255], v[52:55], v[188:191]
 ds_read_b64_tr_b16 a[250:251], v7 offset:55296
 v_mul_f32 v155, v155, v2
 v_mfma_f32_16x16x32_bf16 v[192:195], a[224:227], v[48:51], v[192:195]
 ds_read_b64_tr_b16 a[252:253], v8 offset:53248
 v_cmp_le_u32 vcc, 221, v10
 v_cvt_pk_bf16_f32 v77, v154, v155
 v_mfma_f32_16x16x32_bf16 v[200:203], a[224:227], v[52:55], v[200:203]
 ds_read_b64_tr_b16 a[254:255], v8 offset:55296
 v_mul_f32 v156, v156, v2
 v_mfma_f32_16x16x32_bf16 v[196:199], a[228:231], v[48:51], v[196:199]
 s_cbranch_vccz L_cs1696
L_cb1696:
 ds_read_b64_tr_b16 a[224:225], v24 offset:57344
 v_mul_f32 v157, v157, v2
 v_cvt_pk_bf16_f32 v78, v156, v157
 v_mul_f32 v158, v158, v2
 v_mul_f32 v159, v159, v2
 v_cvt_pk_bf16_f32 v79, v158, v159
 v_mul_f32 v160, v160, v1
 v_mul_f32 v161, v161, v1
 v_cvt_pk_bf16_f32 v80, v160, v161
 v_mul_f32 v162, v162, v1
 v_mul_f32 v163, v163, v1
 v_cvt_pk_bf16_f32 v81, v162, v163
 v_mul_f32 v164, v164, v1
 v_mul_f32 v165, v165, v1
 v_cvt_pk_bf16_f32 v82, v164, v165
 v_mul_f32 v166, v166, v1
 v_mul_f32 v167, v167, v1
 v_cvt_pk_bf16_f32 v83, v166, v167
 v_mfma_f32_16x16x32_bf16 v[204:207], a[228:231], v[52:55], v[204:207]
 ds_read_b64_tr_b16 a[226:227], v24 offset:59392
 v_mul_f32 v168, v168, v2
 v_mfma_f32_16x16x32_bf16 v[208:211], a[232:235], v[48:51], v[208:211]
 ds_read_b64_tr_b16 a[228:229], v25 offset:57344
 v_mul_f32 v169, v169, v2
 v_mfma_f32_16x16x32_bf16 v[216:219], a[232:235], v[52:55], v[216:219]
 ds_read_b64_tr_b16 a[230:231], v25 offset:59392
 v_cvt_pk_bf16_f32 v84, v168, v169
 v_mfma_f32_16x16x32_bf16 v[212:215], a[236:239], v[48:51], v[212:215]
 ds_read_b64_tr_b16 a[232:233], v26 offset:57344
 s_waitcnt lgkmcnt(5)
 v_mul_f32 v170, v170, v2
 v_mul_f32 v171, v171, v2
 v_cvt_pk_bf16_f32 v85, v170, v171
 v_mul_f32 v172, v172, v2
 v_mul_f32 v173, v173, v2
 v_cvt_pk_bf16_f32 v86, v172, v173
 v_mul_f32 v174, v174, v2
 v_mul_f32 v175, v175, v2
 v_cvt_pk_bf16_f32 v87, v174, v175
 v_mul_f32 v176, v176, v1
 v_mul_f32 v177, v177, v1
 v_cvt_pk_bf16_f32 v88, v176, v177
 v_mul_f32 v178, v178, v1
 v_mul_f32 v179, v179, v1
 v_cvt_pk_bf16_f32 v89, v178, v179
 v_mul_f32 v180, v180, v1
 v_mul_f32 v181, v181, v1
 v_mfma_f32_16x16x32_bf16 v[220:223], a[236:239], v[52:55], v[220:223]
 ds_read_b64_tr_b16 a[234:235], v26 offset:59392
 v_cvt_pk_bf16_f32 v90, v180, v181
 v_mfma_f32_16x16x32_bf16 v[224:227], a[240:243], v[48:51], v[224:227]
 ds_read_b64_tr_b16 a[236:237], v27 offset:57344
 v_mul_f32 v182, v182, v1
 v_mfma_f32_16x16x32_bf16 v[232:235], a[240:243], v[52:55], v[232:235]
 ds_read_b64_tr_b16 a[238:239], v27 offset:59392
 v_mul_f32 v183, v183, v1
 v_mfma_f32_16x16x32_bf16 v[228:231], a[244:247], v[48:51], v[228:231]
 ds_read_b64_tr_b16 a[240:241], v24 offset:61440
 v_cvt_pk_bf16_f32 v91, v182, v183
 v_mul_f32 v184, v184, v2
 v_mul_f32 v185, v185, v2
 v_cvt_pk_bf16_f32 v92, v184, v185
 v_mul_f32 v186, v186, v2
 v_mul_f32 v187, v187, v2
 v_cvt_pk_bf16_f32 v93, v186, v187
 v_mul_f32 v188, v188, v2
 v_mul_f32 v189, v189, v2
 v_cvt_pk_bf16_f32 v94, v188, v189
 v_mul_f32 v190, v190, v2
 v_mul_f32 v191, v191, v2
 v_cvt_pk_bf16_f32 v95, v190, v191
 v_mul_f32 v192, v192, v1
 v_mul_f32 v193, v193, v1
 v_cvt_pk_bf16_f32 v96, v192, v193
 v_mul_f32 v194, v194, v1
 v_mul_f32 v195, v195, v1
 v_cvt_pk_bf16_f32 v97, v194, v195
 v_mul_f32 v196, v196, v1
 v_mul_f32 v197, v197, v1
 v_cvt_pk_bf16_f32 v98, v196, v197
 v_mfma_f32_16x16x32_bf16 v[236:239], a[244:247], v[52:55], v[236:239]
 ds_read_b64_tr_b16 a[242:243], v24 offset:63488
 s_movk_i32 s70, 848
 v_add_u32 v24, 0x10000, v24
 v_mul_f32 v198, v198, v1
 v_mfma_f32_16x16x32_bf16 v[240:243], a[248:251], v[48:51], v[240:243]
 ds_read_b64_tr_b16 a[244:245], v25 offset:61440
 v_mul_f32 v199, v199, v1
 v_mfma_f32_16x16x32_bf16 v[248:251], a[248:251], v[52:55], v[248:251]
 ds_read_b64_tr_b16 a[246:247], v25 offset:63488
 v_add_u32 v25, 0x10000, v25
 v_cvt_pk_bf16_f32 v99, v198, v199
 v_mfma_f32_16x16x32_bf16 v[244:247], a[252:255], v[48:51], v[244:247]
 ds_read_b64_tr_b16 a[248:249], v26 offset:61440
 s_waitcnt lgkmcnt(5)
 v_mul_f32 v200, v200, v2
 v_mul_f32 v201, v201, v2
 v_cvt_pk_bf16_f32 v100, v200, v201
 v_mul_f32 v202, v202, v2
 v_mul_f32 v203, v203, v2
 v_cvt_pk_bf16_f32 v101, v202, v203
 v_mul_f32 v204, v204, v2
 v_mul_f32 v205, v205, v2
 v_cvt_pk_bf16_f32 v102, v204, v205
 v_mul_f32 v206, v206, v2
 v_mul_f32 v207, v207, v2
 v_cvt_pk_bf16_f32 v103, v206, v207
 v_mul_f32 v208, v208, v1
 v_mul_f32 v209, v209, v1
 v_cvt_pk_bf16_f32 v104, v208, v209
 v_mul_f32 v210, v210, v1
 v_mul_f32 v211, v211, v1
 v_mfma_f32_16x16x32_bf16 v[252:255], a[252:255], v[52:55], v[252:255]
 ds_read_b64_tr_b16 a[250:251], v26 offset:63488
 buffer_load_dword off, s[72:75], s70 lds
 v_add_u32 v26, 0x10000, v26
 v_cvt_pk_bf16_f32 v105, v210, v211
 v_mfma_f32_16x16x32_bf16 a[176:179], a[224:227], v[64:67], a[176:179]
 ds_read_b64_tr_b16 a[252:253], v27 offset:61440
 v_mul_f32 v212, v212, v1
 v_mfma_f32_16x16x32_bf16 a[184:187], a[224:227], v[68:71], a[184:187]
 ds_read_b64_tr_b16 a[254:255], v27 offset:63488
 v_add_u32 v27, 0x10000, v27
 v_mul_f32 v213, v213, v1
 v_mfma_f32_16x16x32_bf16 a[180:183], a[228:231], v[64:67], a[180:183]
 ds_read_b64_tr_b16 a[224:225], v24 offset:32768
 v_cvt_pk_bf16_f32 v106, v212, v213
 v_mul_f32 v214, v214, v1
 v_mul_f32 v215, v215, v1
 v_cvt_pk_bf16_f32 v107, v214, v215
 v_mul_f32 v216, v216, v2
 v_mul_f32 v217, v217, v2
 v_cvt_pk_bf16_f32 v108, v216, v217
 v_mul_f32 v218, v218, v2
 v_mul_f32 v219, v219, v2
 v_cvt_pk_bf16_f32 v109, v218, v219
 v_mul_f32 v220, v220, v2
 v_mul_f32 v221, v221, v2
 v_cvt_pk_bf16_f32 v110, v220, v221
 v_mul_f32 v222, v222, v2
 v_mul_f32 v223, v223, v2
 v_cvt_pk_bf16_f32 v111, v222, v223
 v_xor_b32 v18, v16, v19
 v_mov_b32 v16, 0
 v_mov_b32 v17, 0
 v_mov_b32 v20, 0
 v_mov_b32 v21, 0
 v_mul_f32 v224, v224, v1
 v_mfma_f32_16x16x32_bf16 a[188:191], a[228:231], v[68:71], a[188:191]
 ds_read_b64_tr_b16 a[226:227], v24 offset:34816
 v_mul_f32 v225, v225, v1
 v_mfma_f32_16x16x32_bf16 a[192:195], a[232:235], v[64:67], a[192:195]
 ds_read_b64_tr_b16 a[228:229], v25 offset:32768
 ds_read_b32 v10, v9
 v_cvt_pk_bf16_f32 v112, v224, v225
 v_mfma_f32_16x16x32_bf16 a[200:203], a[232:235], v[68:71], a[200:203]
 ds_read_b64_tr_b16 a[230:231], v25 offset:34816
 v_mul_f32 v226, v226, v1
 v_mfma_f32_16x16x32_bf16 a[196:199], a[236:239], v[64:67], a[196:199]
 ds_read_b64_tr_b16 a[232:233], v26 offset:32768
 s_waitcnt lgkmcnt(6)
 v_mul_f32 v227, v227, v1
 v_mfma_f32_16x16x32_bf16 a[204:207], a[236:239], v[68:71], a[204:207]
 ds_read_b64_tr_b16 a[234:235], v26 offset:34816
 v_cvt_pk_bf16_f32 v113, v226, v227
 v_mfma_f32_16x16x32_bf16 a[176:179], a[240:243], v[72:75], a[176:179]
 ds_read_b64_tr_b16 a[236:237], v27 offset:32768
 v_mul_f32 v228, v228, v1
 v_mfma_f32_16x16x32_bf16 a[184:187], a[240:243], v[76:79], a[184:187]
 ds_read_b64_tr_b16 a[238:239], v27 offset:34816
 v_mul_f32 v229, v229, v1
 v_mfma_f32_16x16x32_bf16 a[180:183], a[244:247], v[72:75], a[180:183]
 ds_read_b64_tr_b16 a[240:241], v24 offset:36864
 v_cvt_pk_bf16_f32 v114, v228, v229
 v_mfma_f32_16x16x32_bf16 a[188:191], a[244:247], v[76:79], a[188:191]
 ds_read_b64_tr_b16 a[242:243], v24 offset:38912
 v_mul_f32 v230, v230, v1
 v_mfma_f32_16x16x32_bf16 a[192:195], a[248:251], v[72:75], a[192:195]
 ds_read_b64_tr_b16 a[244:245], v25 offset:36864
 v_mul_f32 v231, v231, v1
 v_mfma_f32_16x16x32_bf16 a[200:203], a[248:251], v[76:79], a[200:203]
 ds_read_b64_tr_b16 a[246:247], v25 offset:38912
 v_cvt_pk_bf16_f32 v115, v230, v231
 v_mfma_f32_16x16x32_bf16 a[196:199], a[252:255], v[72:75], a[196:199]
 ds_read_b64_tr_b16 a[248:249], v26 offset:36864
 s_waitcnt lgkmcnt(5)
 v_mul_f32 v232, v232, v2
 v_mfma_f32_16x16x32_bf16 a[204:207], a[252:255], v[76:79], a[204:207]
 ds_read_b64_tr_b16 a[250:251], v26 offset:38912
 v_mul_f32 v233, v233, v2
 v_mfma_f32_16x16x32_bf16 a[176:179], a[224:227], v[80:83], a[176:179]
 ds_read_b64_tr_b16 a[252:253], v27 offset:36864
 v_cmp_le_u32 vcc, 223, v10
 v_cvt_pk_bf16_f32 v116, v232, v233
 v_mfma_f32_16x16x32_bf16 a[184:187], a[224:227], v[84:87], a[184:187]
 ds_read_b64_tr_b16 a[254:255], v27 offset:38912
 v_mul_f32 v234, v234, v2
 v_mfma_f32_16x16x32_bf16 a[180:183], a[228:231], v[80:83], a[180:183]
 s_cbranch_vccz L_cs1712
L_cb1712:
 ds_read_b64_tr_b16 a[224:225], v24 offset:40960
 v_mfma_f32_16x16x32_bf16 a[188:191], a[228:231], v[84:87], a[188:191]
 ds_read_b64_tr_b16 a[226:227], v24 offset:43008
 v_mul_f32 v235, v235, v2
 v_mfma_f32_16x16x32_bf16 a[192:195], a[232:235], v[80:83], a[192:195]
 ds_read_b64_tr_b16 a[228:229], v25 offset:40960
 v_cvt_pk_bf16_f32 v117, v234, v235
 v_mfma_f32_16x16x32_bf16 a[200:203], a[232:235], v[84:87], a[200:203]
 ds_read_b64_tr_b16 a[230:231], v25 offset:43008
 v_mul_f32 v236, v236, v2
 v_mfma_f32_16x16x32_bf16 a[196:199], a[236:239], v[80:83], a[196:199]
 ds_read_b64_tr_b16 a[232:233], v26 offset:40960
 s_waitcnt lgkmcnt(5)
 v_mul_f32 v237, v237, v2
 v_mfma_f32_16x16x32_bf16 a[204:207], a[236:239], v[84:87], a[204:207]
 ds_read_b64_tr_b16 a[234:235], v26 offset:43008
 v_cvt_pk_bf16_f32 v118, v236, v237
 v_mfma_f32_16x16x32_bf16 a[176:179], a[240:243], v[88:91], a[176:179]
 ds_read_b64_tr_b16 a[236:237], v27 offset:40960
 v_mul_f32 v238, v238, v2
 v_mul_f32 v239, v239, v2
 v_cvt_pk_bf16_f32 v119, v238, v239
 v_mul_f32 v240, v240, v1
 v_mfma_f32_16x16x32_bf16 a[184:187], a[240:243], v[92:95], a[184:187]
 ds_read_b64_tr_b16 a[238:239], v27 offset:43008
 v_mul_f32 v241, v241, v1
 v_mfma_f32_16x16x32_bf16 a[180:183], a[244:247], v[88:91], a[180:183]
 ds_read_b64_tr_b16 a[240:241], v24 offset:45056
 v_cvt_pk_bf16_f32 v120, v240, v241
 v_mfma_f32_16x16x32_bf16 a[188:191], a[244:247], v[92:95], a[188:191]
 ds_read_b64_tr_b16 a[242:243], v24 offset:47104
 s_movk_i32 s70, 856
 v_add_u32 v24, 0xffff0000, v24
 v_mul_f32 v242, v242, v1
 v_mfma_f32_16x16x32_bf16 a[192:195], a[248:251], v[88:91], a[192:195]
 ds_read_b64_tr_b16 a[244:245], v25 offset:45056
 v_mul_f32 v243, v243, v1
 v_mfma_f32_16x16x32_bf16 a[200:203], a[248:251], v[92:95], a[200:203]
 ds_read_b64_tr_b16 a[246:247], v25 offset:47104
 v_add_u32 v25, 0xffff0000, v25
 v_cvt_pk_bf16_f32 v121, v242, v243
 v_mfma_f32_16x16x32_bf16 a[196:199], a[252:255], v[88:91], a[196:199]
 ds_read_b64_tr_b16 a[248:249], v26 offset:45056
 s_waitcnt lgkmcnt(5)
 v_mul_f32 v244, v244, v1
 v_mfma_f32_16x16x32_bf16 a[204:207], a[252:255], v[92:95], a[204:207]
 ds_read_b64_tr_b16 a[250:251], v26 offset:47104
 buffer_load_dword off, s[72:75], s70 lds
 v_add_u32 v26, 0xffff0000, v26
 v_mul_f32 v245, v245, v1
 v_mfma_f32_16x16x32_bf16 a[176:179], a[224:227], v[96:99], a[176:179]
 ds_read_b64_tr_b16 a[252:253], v27 offset:45056
 v_cvt_pk_bf16_f32 v122, v244, v245
 v_mfma_f32_16x16x32_bf16 a[184:187], a[224:227], v[100:103], a[184:187]
 ds_read_b64_tr_b16 a[254:255], v27 offset:47104
 v_add_u32 v27, 0xffff0000, v27
 v_mul_f32 v246, v246, v1
 v_mfma_f32_16x16x32_bf16 a[180:183], a[228:231], v[96:99], a[180:183]
 ds_read_b64_tr_b16 a[224:225], v24 offset:0
 v_mul_f32 v247, v247, v1
 v_mfma_f32_16x16x32_bf16 a[188:191], a[228:231], v[100:103], a[188:191]
 ds_read_b64_tr_b16 a[226:227], v24 offset:2048
 v_cvt_pk_bf16_f32 v123, v246, v247
 v_mfma_f32_16x16x32_bf16 a[192:195], a[232:235], v[96:99], a[192:195]
 ds_read_b64_tr_b16 a[228:229], v25 offset:0
 ds_read_b32 v10, v9
 v_mul_f32 v248, v248, v2
 v_mfma_f32_16x16x32_bf16 a[200:203], a[232:235], v[100:103], a[200:203]
 ds_read_b64_tr_b16 a[230:231], v25 offset:2048
 v_mul_f32 v249, v249, v2
 v_mfma_f32_16x16x32_bf16 a[196:199], a[236:239], v[96:99], a[196:199]
 ds_read_b64_tr_b16 a[232:233], v24 offset:4096
 s_waitcnt lgkmcnt(6)
 v_cvt_pk_bf16_f32 v124, v248, v249
 v_mfma_f32_16x16x32_bf16 a[204:207], a[236:239], v[100:103], a[204:207]
 ds_read_b64_tr_b16 a[234:235], v24 offset:6144
 v_mul_f32 v250, v250, v2
 v_mfma_f32_16x16x32_bf16 a[176:179], a[240:243], v[104:107], a[176:179]
 ds_read_b64_tr_b16 a[236:237], v25 offset:4096
 v_mul_f32 v251, v251, v2
 v_mfma_f32_16x16x32_bf16 a[184:187], a[240:243], v[108:111], a[184:187]
 ds_read_b64_tr_b16 a[238:239], v25 offset:6144
 v_cvt_pk_bf16_f32 v125, v250, v251
 v_mfma_f32_16x16x32_bf16 a[180:183], a[244:247], v[104:107], a[180:183]
 ds_read_b64_tr_b16 a[240:241], v26 offset:0
 v_mul_f32 v252, v252, v2
 v_mfma_f32_16x16x32_bf16 a[188:191], a[244:247], v[108:111], a[188:191]
 ds_read_b64_tr_b16 a[242:243], v26 offset:2048
 v_mul_f32 v253, v253, v2
 v_mfma_f32_16x16x32_bf16 a[192:195], a[248:251], v[104:107], a[192:195]
 ds_read_b64_tr_b16 a[244:245], v27 offset:0
 v_cvt_pk_bf16_f32 v126, v252, v253
 v_mfma_f32_16x16x32_bf16 a[200:203], a[248:251], v[108:111], a[200:203]
 ds_read_b64_tr_b16 a[246:247], v27 offset:2048
 v_mul_f32 v254, v254, v2
 v_mfma_f32_16x16x32_bf16 a[196:199], a[252:255], v[104:107], a[196:199]
 ds_read_b64_tr_b16 a[248:249], v26 offset:4096
 s_waitcnt lgkmcnt(5)
 v_mul_f32 v255, v255, v2
 v_mfma_f32_16x16x32_bf16 a[204:207], a[252:255], v[108:111], a[204:207]
 ds_read_b64_tr_b16 a[250:251], v26 offset:6144
 v_cvt_pk_bf16_f32 v127, v254, v255
 v_mfma_f32_16x16x32_bf16 a[176:179], a[224:227], v[112:115], a[176:179]
 ds_read_b64_tr_b16 a[252:253], v27 offset:4096
 v_cmp_le_u32 vcc, 225, v10
 v_lshlrev_b32 v12, 9, v3
 v_mfma_f32_16x16x32_bf16 a[184:187], a[224:227], v[116:119], a[184:187]
 ds_read_b64_tr_b16 a[254:255], v27 offset:6144
 v_mov_b32 v11, 1
 v_mfma_f32_16x16x32_bf16 a[180:183], a[228:231], v[112:115], a[180:183]
 s_cbranch_vccz L_cs1728
L_cb1728:
 ds_read_b64_tr_b16 a[224:225], v24 offset:8192
 v_mfma_f32_16x16x32_bf16 a[188:191], a[228:231], v[116:119], a[188:191]
 ds_read_b64_tr_b16 a[226:227], v24 offset:10240
 v_lshlrev_b32 v3, 4, v3
 v_mfma_f32_16x16x32_bf16 a[176:179], a[232:235], v[120:123], a[176:179]
 ds_read_b64_tr_b16 a[228:229], v25 offset:8192
 v_mfma_f32_16x16x32_bf16 a[184:187], a[232:235], v[124:127], a[184:187]
 ds_read_b64_tr_b16 a[230:231], v25 offset:10240
 v_mfma_f32_16x16x32_bf16 a[180:183], a[236:239], v[120:123], a[180:183]
 ds_read_b64_tr_b16 a[232:233], v26 offset:8192
 s_waitcnt lgkmcnt(5)
 v_mfma_f32_16x16x32_bf16 a[188:191], a[236:239], v[124:127], a[188:191]
 ds_read_b64_tr_b16 a[234:235], v26 offset:10240
 v_mfma_f32_16x16x32_bf16 a[192:195], a[240:243], v[112:115], a[192:195]
 ds_read_b64_tr_b16 a[236:237], v27 offset:8192
 v_mfma_f32_16x16x32_bf16 a[200:203], a[240:243], v[116:119], a[200:203]
 ds_read_b64_tr_b16 a[238:239], v27 offset:10240
 v_mfma_f32_16x16x32_bf16 a[196:199], a[244:247], v[112:115], a[196:199]
 ds_read_b64_tr_b16 a[240:241], v24 offset:12288
 v_accvgpr_read_b32 v32, a176
 v_accvgpr_read_b32 v33, a177
 v_cvt_pk_bf16_f32 v32, v32, v33
 v_accvgpr_read_b32 v34, a178
 v_accvgpr_read_b32 v35, a179
 v_mfma_f32_16x16x32_bf16 a[204:207], a[244:247], v[116:119], a[204:207]
 ds_read_b64_tr_b16 a[242:243], v24 offset:14336
 s_movk_i32 s70, 864
 v_add_u32 v24, 0x10000, v24
 v_cvt_pk_bf16_f32 v33, v34, v35
 v_mfma_f32_16x16x32_bf16 a[192:195], a[248:251], v[120:123], a[192:195]
 ds_read_b64_tr_b16 a[244:245], v25 offset:12288
 v_accvgpr_read_b32 v36, a180
 v_mfma_f32_16x16x32_bf16 a[200:203], a[248:251], v[124:127], a[200:203]
 ds_read_b64_tr_b16 a[246:247], v25 offset:14336
 v_add_u32 v25, 0x10000, v25
 v_accvgpr_read_b32 v37, a181
 v_mfma_f32_16x16x32_bf16 a[196:199], a[252:255], v[120:123], a[196:199]
 ds_read_b64_tr_b16 a[248:249], v26 offset:12288
 s_waitcnt lgkmcnt(5)
 v_cvt_pk_bf16_f32 v34, v36, v37
 v_mfma_f32_16x16x32_bf16 a[204:207], a[252:255], v[124:127], a[204:207]
 ds_read_b64_tr_b16 a[250:251], v26 offset:14336
 buffer_load_dword off, s[72:75], s70 lds
 v_add_u32 v26, 0x10000, v26
 v_accvgpr_read_b32 v38, a182
 v_mfma_f32_16x16x32_bf16 a[96:99], a[224:227], v[64:67], a[96:99]
 ds_read_b64_tr_b16 a[252:253], v27 offset:12288
 v_accvgpr_read_b32 v39, a183
 v_mfma_f32_16x16x32_bf16 a[104:107], a[224:227], v[68:71], a[104:107]
 ds_read_b64_tr_b16 a[254:255], v27 offset:14336
 v_add_u32 v27, 0x10000, v27
 v_cvt_pk_bf16_f32 v35, v38, v39
 v_mfma_f32_16x16x32_bf16 a[100:103], a[228:231], v[64:67], a[100:103]
 ds_read_b64_tr_b16 a[224:225], v24 offset:49152
 buffer_store_dwordx4 v[32:35], v3, s[28:31], s34 offen offset:0 sc1
 v_accvgpr_read_b32 v40, a184
 v_accvgpr_read_b32 v41, a185
 v_cvt_pk_bf16_f32 v36, v40, v41
 v_accvgpr_read_b32 v42, a186
 v_accvgpr_read_b32 v43, a187
 v_cvt_pk_bf16_f32 v37, v42, v43
 v_accvgpr_read_b32 v44, a188
 v_accvgpr_read_b32 v45, a189
 v_cvt_pk_bf16_f32 v38, v44, v45
 v_accvgpr_read_b32 v46, a190
 v_accvgpr_read_b32 v47, a191
 v_cvt_pk_bf16_f32 v39, v46, v47
 buffer_store_dwordx4 v[36:39], v3, s[28:31], s34 offen offset:1024 sc1
 v_accvgpr_read_b32 v48, a192
 v_accvgpr_read_b32 v49, a193
 v_cvt_pk_bf16_f32 v48, v48, v49
 v_accvgpr_read_b32 v50, a194
 v_accvgpr_read_b32 v51, a195
 v_cvt_pk_bf16_f32 v49, v50, v51
 v_mfma_f32_16x16x32_bf16 a[108:111], a[228:231], v[68:71], a[108:111]
 ds_read_b64_tr_b16 a[226:227], v24 offset:51200
 v_accvgpr_read_b32 v52, a196
 v_mfma_f32_16x16x32_bf16 a[208:211], a[232:235], v[64:67], a[208:211]
 ds_read_b64_tr_b16 a[228:229], v25 offset:49152
 ds_read_b32 v10, v9
 v_accvgpr_read_b32 v53, a197
 v_mfma_f32_16x16x32_bf16 a[216:219], a[232:235], v[68:71], a[216:219]
 ds_read_b64_tr_b16 a[230:231], v25 offset:51200
 v_cvt_pk_bf16_f32 v50, v52, v53
 v_mfma_f32_16x16x32_bf16 a[212:215], a[236:239], v[64:67], a[212:215]
 ds_read_b64_tr_b16 a[232:233], v26 offset:49152
 s_waitcnt lgkmcnt(6)
 v_accvgpr_read_b32 v54, a198
 v_mfma_f32_16x16x32_bf16 a[220:223], a[236:239], v[68:71], a[220:223]
 ds_read_b64_tr_b16 a[234:235], v26 offset:51200
 v_accvgpr_read_b32 v55, a199
 v_mfma_f32_16x16x32_bf16 a[96:99], a[240:243], v[72:75], a[96:99]
 ds_read_b64_tr_b16 a[236:237], v27 offset:49152
 v_cvt_pk_bf16_f32 v51, v54, v55
 v_mfma_f32_16x16x32_bf16 a[104:107], a[240:243], v[76:79], a[104:107]
 ds_read_b64_tr_b16 a[238:239], v27 offset:51200
 buffer_store_dwordx4 v[48:51], v3, s[28:31], s34 offen offset:2048 sc1
 v_mfma_f32_16x16x32_bf16 a[100:103], a[244:247], v[72:75], a[100:103]
 ds_read_b64_tr_b16 a[240:241], v24 offset:53248
 v_accvgpr_read_b32 v56, a200
 v_mfma_f32_16x16x32_bf16 a[108:111], a[244:247], v[76:79], a[108:111]
 ds_read_b64_tr_b16 a[242:243], v24 offset:55296
 v_accvgpr_read_b32 v57, a201
 v_mfma_f32_16x16x32_bf16 a[208:211], a[248:251], v[72:75], a[208:211]
 ds_read_b64_tr_b16 a[244:245], v25 offset:53248
 v_cvt_pk_bf16_f32 v52, v56, v57
 v_mfma_f32_16x16x32_bf16 a[216:219], a[248:251], v[76:79], a[216:219]
 ds_read_b64_tr_b16 a[246:247], v25 offset:55296
 v_accvgpr_read_b32 v58, a202
 v_mfma_f32_16x16x32_bf16 a[212:215], a[252:255], v[72:75], a[212:215]
 ds_read_b64_tr_b16 a[248:249], v26 offset:53248
 s_waitcnt lgkmcnt(5)
 v_mfma_f32_16x16x32_bf16 a[220:223], a[252:255], v[76:79], a[220:223]
 ds_read_b64_tr_b16 a[250:251], v26 offset:55296
 v_accvgpr_read_b32 v59, a203
 v_mfma_f32_16x16x32_bf16 a[96:99], a[224:227], v[80:83], a[96:99]
 ds_read_b64_tr_b16 a[252:253], v27 offset:53248
 v_cmp_le_u32 vcc, 227, v10
 v_cvt_pk_bf16_f32 v53, v58, v59
 v_mfma_f32_16x16x32_bf16 a[104:107], a[224:227], v[84:87], a[104:107]
 ds_read_b64_tr_b16 a[254:255], v27 offset:55296
 v_accvgpr_read_b32 v60, a204
 v_mfma_f32_16x16x32_bf16 a[100:103], a[228:231], v[80:83], a[100:103]
 s_cbranch_vccz L_cs1744
L_cb1744:
 ds_read_b64_tr_b16 a[224:225], v24 offset:57344
 v_mfma_f32_16x16x32_bf16 a[108:111], a[228:231], v[84:87], a[108:111]
 ds_read_b64_tr_b16 a[226:227], v24 offset:59392
 v_accvgpr_read_b32 v61, a205
 v_mfma_f32_16x16x32_bf16 a[208:211], a[232:235], v[80:83], a[208:211]
 ds_read_b64_tr_b16 a[228:229], v25 offset:57344
 v_cvt_pk_bf16_f32 v54, v60, v61
 v_mfma_f32_16x16x32_bf16 a[216:219], a[232:235], v[84:87], a[216:219]
 ds_read_b64_tr_b16 a[230:231], v25 offset:59392
 v_accvgpr_read_b32 v62, a206
 v_mfma_f32_16x16x32_bf16 a[212:215], a[236:239], v[80:83], a[212:215]
 ds_read_b64_tr_b16 a[232:233], v26 offset:57344
 s_waitcnt lgkmcnt(5)
 v_accvgpr_read_b32 v63, a207
 v_mfma_f32_16x16x32_bf16 a[220:223], a[236:239], v[84:87], a[220:223]
 ds_read_b64_tr_b16 a[234:235], v26 offset:59392
 v_cvt_pk_bf16_f32 v55, v62, v63
 v_mfma_f32_16x16x32_bf16 a[96:99], a[240:243], v[88:91], a[96:99]
 ds_read_b64_tr_b16 a[236:237], v27 offset:57344
 buffer_store_dwordx4 v[52:55], v3, s[28:31], s34 offen offset:3072 sc1
 v_mfma_f32_16x16x32_bf16 a[104:107], a[240:243], v[92:95], a[104:107]
 ds_read_b64_tr_b16 a[238:239], v27 offset:59392
 v_mfma_f32_16x16x32_bf16 a[100:103], a[244:247], v[88:91], a[100:103]
 ds_read_b64_tr_b16 a[240:241], v24 offset:61440
 v_mfma_f32_16x16x32_bf16 a[108:111], a[244:247], v[92:95], a[108:111]
 ds_read_b64_tr_b16 a[242:243], v24 offset:63488
 s_movk_i32 s70, 872
 v_mfma_f32_16x16x32_bf16 a[208:211], a[248:251], v[88:91], a[208:211]
 ds_read_b64_tr_b16 a[244:245], v25 offset:61440
 v_add_u32 v24, 0x10000, v24
 v_mfma_f32_16x16x32_bf16 a[216:219], a[248:251], v[92:95], a[216:219]
 ds_read_b64_tr_b16 a[246:247], v25 offset:63488
 v_add_u32 v25, 0x10000, v25
 v_mfma_f32_16x16x32_bf16 a[212:215], a[252:255], v[88:91], a[212:215]
 ds_read_b64_tr_b16 a[248:249], v26 offset:61440
 s_waitcnt lgkmcnt(5)
 v_mfma_f32_16x16x32_bf16 a[220:223], a[252:255], v[92:95], a[220:223]
 ds_read_b64_tr_b16 a[250:251], v26 offset:63488
 v_add_u32 v26, 0x10000, v26
 v_mfma_f32_16x16x32_bf16 a[96:99], a[224:227], v[96:99], a[96:99]
 ds_read_b64_tr_b16 a[252:253], v27 offset:61440
 buffer_load_dword off, s[72:75], s70 lds
 v_mfma_f32_16x16x32_bf16 a[104:107], a[224:227], v[100:103], a[104:107]
 ds_read_b64_tr_b16 a[254:255], v27 offset:63488
 v_add_u32 v27, 0x10000, v27
 v_mfma_f32_16x16x32_bf16 a[100:103], a[228:231], v[96:99], a[100:103]
 ds_read_b64_tr_b16 a[224:225], v24 offset:0
 v_mfma_f32_16x16x32_bf16 a[108:111], a[228:231], v[100:103], a[108:111]
 ds_read_b64_tr_b16 a[226:227], v24 offset:2048
 v_mfma_f32_16x16x32_bf16 a[208:211], a[232:235], v[96:99], a[208:211]
 ds_read_b64_tr_b16 a[228:229], v25 offset:0
 ds_read_b32 v10, v9
 v_mfma_f32_16x16x32_bf16 a[216:219], a[232:235], v[100:103], a[216:219]
 ds_read_b64_tr_b16 a[230:231], v25 offset:2048
 v_mfma_f32_16x16x32_bf16 a[212:215], a[236:239], v[96:99], a[212:215]
 ds_read_b64_tr_b16 a[232:233], v24 offset:4096
 s_waitcnt lgkmcnt(6)
 v_mfma_f32_16x16x32_bf16 a[220:223], a[236:239], v[100:103], a[220:223]
 ds_read_b64_tr_b16 a[234:235], v24 offset:6144
 v_mfma_f32_16x16x32_bf16 a[96:99], a[240:243], v[104:107], a[96:99]
 ds_read_b64_tr_b16 a[236:237], v25 offset:4096
 v_mfma_f32_16x16x32_bf16 a[104:107], a[240:243], v[108:111], a[104:107]
 ds_read_b64_tr_b16 a[238:239], v25 offset:6144
 v_mfma_f32_16x16x32_bf16 a[100:103], a[244:247], v[104:107], a[100:103]
 ds_read_b64_tr_b16 a[240:241], v26 offset:0
 v_mfma_f32_16x16x32_bf16 a[108:111], a[244:247], v[108:111], a[108:111]
 ds_read_b64_tr_b16 a[242:243], v26 offset:2048
 v_mfma_f32_16x16x32_bf16 a[208:211], a[248:251], v[104:107], a[208:211]
 ds_read_b64_tr_b16 a[244:245], v27 offset:0
 v_mfma_f32_16x16x32_bf16 a[216:219], a[248:251], v[108:111], a[216:219]
 ds_read_b64_tr_b16 a[246:247], v27 offset:2048
 v_mfma_f32_16x16x32_bf16 a[212:215], a[252:255], v[104:107], a[212:215]
 ds_read_b64_tr_b16 a[248:249], v26 offset:4096
 s_waitcnt lgkmcnt(5)
 v_mfma_f32_16x16x32_bf16 a[220:223], a[252:255], v[108:111], a[220:223]
 ds_read_b64_tr_b16 a[250:251], v26 offset:6144
 v_mfma_f32_16x16x32_bf16 a[96:99], a[224:227], v[112:115], a[96:99]
 ds_read_b64_tr_b16 a[252:253], v27 offset:4096
 v_cmp_le_u32 vcc, 229, v10
 v_mfma_f32_16x16x32_bf16 a[104:107], a[224:227], v[116:119], a[104:107]
 ds_read_b64_tr_b16 a[254:255], v27 offset:6144
 v_mfma_f32_16x16x32_bf16 a[100:103], a[228:231], v[112:115], a[100:103]
 s_cbranch_vccz L_cs1760
L_cb1760:
 ds_read_b64_tr_b16 a[224:225], v24 offset:8192
 v_mfma_f32_16x16x32_bf16 a[108:111], a[228:231], v[116:119], a[108:111]
 ds_read_b64_tr_b16 a[226:227], v24 offset:10240
 v_mfma_f32_16x16x32_bf16 a[96:99], a[232:235], v[120:123], a[96:99]
 ds_read_b64_tr_b16 a[228:229], v25 offset:8192
 v_mfma_f32_16x16x32_bf16 a[104:107], a[232:235], v[124:127], a[104:107]
 ds_read_b64_tr_b16 a[230:231], v25 offset:10240
 v_mfma_f32_16x16x32_bf16 a[100:103], a[236:239], v[120:123], a[100:103]
 ds_read_b64_tr_b16 a[232:233], v26 offset:8192
 s_waitcnt lgkmcnt(5)
 v_mfma_f32_16x16x32_bf16 a[108:111], a[236:239], v[124:127], a[108:111]
 ds_read_b64_tr_b16 a[234:235], v26 offset:10240
 v_mfma_f32_16x16x32_bf16 a[208:211], a[240:243], v[112:115], a[208:211]
 ds_read_b64_tr_b16 a[236:237], v27 offset:8192
 v_mfma_f32_16x16x32_bf16 a[216:219], a[240:243], v[116:119], a[216:219]
 ds_read_b64_tr_b16 a[238:239], v27 offset:10240
 v_mfma_f32_16x16x32_bf16 a[212:215], a[244:247], v[112:115], a[212:215]
 ds_read_b64_tr_b16 a[240:241], v24 offset:12288
 v_accvgpr_read_b32 v32, a96
 v_accvgpr_read_b32 v33, a97
 v_cvt_pk_bf16_f32 v32, v32, v33
 v_accvgpr_read_b32 v34, a98
 v_accvgpr_read_b32 v35, a99
 v_mfma_f32_16x16x32_bf16 a[220:223], a[244:247], v[116:119], a[220:223]
 ds_read_b64_tr_b16 a[242:243], v24 offset:14336
 s_movk_i32 s70, 880
 v_add_u32 v24, 0xfffe0000, v24
 v_cvt_pk_bf16_f32 v33, v34, v35
 v_mfma_f32_16x16x32_bf16 a[208:211], a[248:251], v[120:123], a[208:211]
 ds_read_b64_tr_b16 a[244:245], v25 offset:12288
 v_accvgpr_read_b32 v36, a100
 v_mfma_f32_16x16x32_bf16 a[216:219], a[248:251], v[124:127], a[216:219]
 ds_read_b64_tr_b16 a[246:247], v25 offset:14336
 v_add_u32 v25, 0xfffe0000, v25
 v_accvgpr_read_b32 v37, a101
 v_mfma_f32_16x16x32_bf16 a[212:215], a[252:255], v[120:123], a[212:215]
 ds_read_b64_tr_b16 a[248:249], v26 offset:12288
 s_waitcnt lgkmcnt(5)
 v_cvt_pk_bf16_f32 v34, v36, v37
 v_mfma_f32_16x16x32_bf16 a[220:223], a[252:255], v[124:127], a[220:223]
 ds_read_b64_tr_b16 a[250:251], v26 offset:14336
 buffer_load_dword off, s[72:75], s70 lds
 v_add_u32 v26, 0xfffe0000, v26
 v_accvgpr_read_b32 v38, a102
 v_mfma_f32_16x16x32_bf16 a[64:67], a[224:227], v[64:67], a[64:67]
 ds_read_b64_tr_b16 a[252:253], v27 offset:12288
 v_accvgpr_read_b32 v39, a103
 v_mfma_f32_16x16x32_bf16 a[72:75], a[224:227], v[68:71], a[72:75]
 ds_read_b64_tr_b16 a[254:255], v27 offset:14336
 v_add_u32 v27, 0xfffe0000, v27
 v_cvt_pk_bf16_f32 v35, v38, v39
 v_mfma_f32_16x16x32_bf16 a[68:71], a[228:231], v[64:67], a[68:71]
 ds_read_b64_tr_b16 a[224:225], v24 offset:16384
 buffer_store_dwordx4 v[32:35], v3, s[28:31], s35 offen offset:0 sc1
 v_accvgpr_read_b32 v40, a104
 v_accvgpr_read_b32 v41, a105
 v_cvt_pk_bf16_f32 v36, v40, v41
 v_accvgpr_read_b32 v42, a106
 v_accvgpr_read_b32 v43, a107
 v_cvt_pk_bf16_f32 v37, v42, v43
 v_accvgpr_read_b32 v44, a108
 v_accvgpr_read_b32 v45, a109
 v_cvt_pk_bf16_f32 v38, v44, v45
 v_accvgpr_read_b32 v46, a110
 v_accvgpr_read_b32 v47, a111
 v_cvt_pk_bf16_f32 v39, v46, v47
 buffer_store_dwordx4 v[36:39], v3, s[28:31], s35 offen offset:1024 sc1
 v_accvgpr_read_b32 v48, a208
 v_accvgpr_read_b32 v49, a209
 v_cvt_pk_bf16_f32 v48, v48, v49
 v_accvgpr_read_b32 v50, a210
 v_accvgpr_read_b32 v51, a211
 v_cvt_pk_bf16_f32 v49, v50, v51
 v_mfma_f32_16x16x32_bf16 a[76:79], a[228:231], v[68:71], a[76:79]
 ds_read_b64_tr_b16 a[226:227], v24 offset:18432
 v_accvgpr_read_b32 v52, a212
 v_mfma_f32_16x16x32_bf16 a[80:83], a[232:235], v[64:67], a[80:83]
 ds_read_b64_tr_b16 a[228:229], v25 offset:16384
 ds_read_b32 v10, v9
 v_accvgpr_read_b32 v53, a213
 v_mfma_f32_16x16x32_bf16 a[88:91], a[232:235], v[68:71], a[88:91]
 ds_read_b64_tr_b16 a[230:231], v25 offset:18432
 v_cvt_pk_bf16_f32 v50, v52, v53
 v_mfma_f32_16x16x32_bf16 a[84:87], a[236:239], v[64:67], a[84:87]
 ds_read_b64_tr_b16 a[232:233], v26 offset:16384
 s_waitcnt lgkmcnt(6)
 v_accvgpr_read_b32 v54, a214
 v_mfma_f32_16x16x32_bf16 a[92:95], a[236:239], v[68:71], a[92:95]
 ds_read_b64_tr_b16 a[234:235], v26 offset:18432
 v_accvgpr_read_b32 v55, a215
 v_mfma_f32_16x16x32_bf16 a[64:67], a[240:243], v[72:75], a[64:67]
 ds_read_b64_tr_b16 a[236:237], v27 offset:16384
 v_cvt_pk_bf16_f32 v51, v54, v55
 v_mfma_f32_16x16x32_bf16 a[72:75], a[240:243], v[76:79], a[72:75]
 ds_read_b64_tr_b16 a[238:239], v27 offset:18432
 buffer_store_dwordx4 v[48:51], v3, s[28:31], s35 offen offset:2048 sc1
 v_mfma_f32_16x16x32_bf16 a[68:71], a[244:247], v[72:75], a[68:71]
 ds_read_b64_tr_b16 a[240:241], v24 offset:20480
 v_accvgpr_read_b32 v56, a216
 v_mfma_f32_16x16x32_bf16 a[76:79], a[244:247], v[76:79], a[76:79]
 ds_read_b64_tr_b16 a[242:243], v24 offset:22528
 v_accvgpr_read_b32 v57, a217
 v_mfma_f32_16x16x32_bf16 a[80:83], a[248:251], v[72:75], a[80:83]
 ds_read_b64_tr_b16 a[244:245], v25 offset:20480
 v_cvt_pk_bf16_f32 v52, v56, v57
 v_mfma_f32_16x16x32_bf16 a[88:91], a[248:251], v[76:79], a[88:91]
 ds_read_b64_tr_b16 a[246:247], v25 offset:22528
 v_accvgpr_read_b32 v58, a218
 v_mfma_f32_16x16x32_bf16 a[84:87], a[252:255], v[72:75], a[84:87]
 ds_read_b64_tr_b16 a[248:249], v26 offset:20480
 s_waitcnt lgkmcnt(5)
 v_mfma_f32_16x16x32_bf16 a[92:95], a[252:255], v[76:79], a[92:95]
 ds_read_b64_tr_b16 a[250:251], v26 offset:22528
 v_accvgpr_read_b32 v59, a219
 v_mfma_f32_16x16x32_bf16 a[64:67], a[224:227], v[80:83], a[64:67]
 ds_read_b64_tr_b16 a[252:253], v27 offset:20480
 v_cmp_le_u32 vcc, 231, v10
 v_cvt_pk_bf16_f32 v53, v58, v59
 v_mfma_f32_16x16x32_bf16 a[72:75], a[224:227], v[84:87], a[72:75]
 ds_read_b64_tr_b16 a[254:255], v27 offset:22528
 v_accvgpr_read_b32 v60, a220
 v_mfma_f32_16x16x32_bf16 a[68:71], a[228:231], v[80:83], a[68:71]
 s_cbranch_vccz L_cs1776
L_cb1776:
 ds_read_b64_tr_b16 a[224:225], v24 offset:24576
 v_mfma_f32_16x16x32_bf16 a[76:79], a[228:231], v[84:87], a[76:79]
 ds_read_b64_tr_b16 a[226:227], v24 offset:26624
 v_accvgpr_read_b32 v61, a221
 v_mfma_f32_16x16x32_bf16 a[80:83], a[232:235], v[80:83], a[80:83]
 ds_read_b64_tr_b16 a[228:229], v25 offset:24576
 v_cvt_pk_bf16_f32 v54, v60, v61
 v_mfma_f32_16x16x32_bf16 a[88:91], a[232:235], v[84:87], a[88:91]
 ds_read_b64_tr_b16 a[230:231], v25 offset:26624
 v_accvgpr_read_b32 v62, a222
 v_mfma_f32_16x16x32_bf16 a[84:87], a[236:239], v[80:83], a[84:87]
 ds_read_b64_tr_b16 a[232:233], v26 offset:24576
 s_waitcnt lgkmcnt(5)
 v_accvgpr_read_b32 v63, a223
 v_mfma_f32_16x16x32_bf16 a[92:95], a[236:239], v[84:87], a[92:95]
 ds_read_b64_tr_b16 a[234:235], v26 offset:26624
 v_cvt_pk_bf16_f32 v55, v62, v63
 v_mfma_f32_16x16x32_bf16 a[64:67], a[240:243], v[88:91], a[64:67]
 ds_read_b64_tr_b16 a[236:237], v27 offset:24576
 buffer_store_dwordx4 v[52:55], v3, s[28:31], s35 offen offset:3072 sc1
 v_mfma_f32_16x16x32_bf16 a[72:75], a[240:243], v[92:95], a[72:75]
 ds_read_b64_tr_b16 a[238:239], v27 offset:26624
 v_mfma_f32_16x16x32_bf16 a[68:71], a[244:247], v[88:91], a[68:71]
 ds_read_b64_tr_b16 a[240:241], v24 offset:28672
 v_mfma_f32_16x16x32_bf16 a[76:79], a[244:247], v[92:95], a[76:79]
 ds_read_b64_tr_b16 a[242:243], v24 offset:30720
 s_movk_i32 s70, 888
 v_mfma_f32_16x16x32_bf16 a[80:83], a[248:251], v[88:91], a[80:83]
 ds_read_b64_tr_b16 a[244:245], v25 offset:28672
 v_add_u32 v24, 0x20000, v24
 v_mfma_f32_16x16x32_bf16 a[88:91], a[248:251], v[92:95], a[88:91]
 ds_read_b64_tr_b16 a[246:247], v25 offset:30720
 v_add_u32 v25, 0x20000, v25
 v_mfma_f32_16x16x32_bf16 a[84:87], a[252:255], v[88:91], a[84:87]
 ds_read_b64_tr_b16 a[248:249], v26 offset:28672
 s_waitcnt lgkmcnt(5)
 v_mfma_f32_16x16x32_bf16 a[92:95], a[252:255], v[92:95], a[92:95]
 ds_read_b64_tr_b16 a[250:251], v26 offset:30720
 v_add_u32 v26, 0x20000, v26
 v_mfma_f32_16x16x32_bf16 a[64:67], a[224:227], v[96:99], a[64:67]
 ds_read_b64_tr_b16 a[252:253], v27 offset:28672
 buffer_load_dword off, s[72:75], s70 lds
 v_mfma_f32_16x16x32_bf16 a[72:75], a[224:227], v[100:103], a[72:75]
 ds_read_b64_tr_b16 a[254:255], v27 offset:30720
 v_add_u32 v27, 0x20000, v27
 v_mfma_f32_16x16x32_bf16 a[68:71], a[228:231], v[96:99], a[68:71]
 ds_read_b64_tr_b16 a[224:225], v24 offset:16384
 v_mfma_f32_16x16x32_bf16 a[76:79], a[228:231], v[100:103], a[76:79]
 ds_read_b64_tr_b16 a[226:227], v24 offset:18432
 v_mfma_f32_16x16x32_bf16 a[80:83], a[232:235], v[96:99], a[80:83]
 ds_read_b64_tr_b16 a[228:229], v25 offset:16384
 v_mfma_f32_16x16x32_bf16 a[88:91], a[232:235], v[100:103], a[88:91]
 ds_read_b64_tr_b16 a[230:231], v25 offset:18432
 v_mfma_f32_16x16x32_bf16 a[84:87], a[236:239], v[96:99], a[84:87]
 ds_read_b64_tr_b16 a[232:233], v24 offset:20480
 s_waitcnt lgkmcnt(5)
 v_mfma_f32_16x16x32_bf16 a[92:95], a[236:239], v[100:103], a[92:95]
 ds_read_b64_tr_b16 a[234:235], v24 offset:22528
 v_add_u32 v24, 0xffff0000, v24
 v_mfma_f32_16x16x32_bf16 a[64:67], a[240:243], v[104:107], a[64:67]
 ds_read_b64_tr_b16 a[236:237], v25 offset:20480
 v_mfma_f32_16x16x32_bf16 a[72:75], a[240:243], v[108:111], a[72:75]
 ds_read_b64_tr_b16 a[238:239], v25 offset:22528
 v_add_u32 v25, 0xffff0000, v25
 v_mfma_f32_16x16x32_bf16 a[68:71], a[244:247], v[104:107], a[68:71]
 ds_read_b64_tr_b16 a[240:241], v26 offset:16384
 v_mfma_f32_16x16x32_bf16 a[76:79], a[244:247], v[108:111], a[76:79]
 ds_read_b64_tr_b16 a[242:243], v26 offset:18432
 v_mfma_f32_16x16x32_bf16 a[80:83], a[248:251], v[104:107], a[80:83]
 ds_read_b64_tr_b16 a[244:245], v27 offset:16384
 ds_read_b32 v10, v9
 v_mfma_f32_16x16x32_bf16 a[88:91], a[248:251], v[108:111], a[88:91]
 ds_read_b64_tr_b16 a[246:247], v27 offset:18432
 v_mfma_f32_16x16x32_bf16 a[84:87], a[252:255], v[104:107], a[84:87]
 ds_read_b64_tr_b16 a[248:249], v26 offset:20480
 s_waitcnt lgkmcnt(6)
 v_mfma_f32_16x16x32_bf16 a[92:95], a[252:255], v[108:111], a[92:95]
 ds_read_b64_tr_b16 a[250:251], v26 offset:22528
 v_add_u32 v26, 0xffff0000, v26
 v_mfma_f32_16x16x32_bf16 a[64:67], a[224:227], v[112:115], a[64:67]
 ds_read_b64_tr_b16 a[252:253], v27 offset:20480
 v_mfma_f32_16x16x32_bf16 a[72:75], a[224:227], v[116:119], a[72:75]
 ds_read_b64_tr_b16 a[254:255], v27 offset:22528
 v_add_u32 v27, 0xffff0000, v27
 v_mfma_f32_16x16x32_bf16 a[68:71], a[228:231], v[112:115], a[68:71]
 v_mfma_f32_16x16x32_bf16 a[76:79], a[228:231], v[116:119], a[76:79]
 v_mfma_f32_16x16x32_bf16 a[64:67], a[232:235], v[120:123], a[64:67]
 v_mfma_f32_16x16x32_bf16 a[72:75], a[232:235], v[124:127], a[72:75]
 v_mfma_f32_16x16x32_bf16 a[68:71], a[236:239], v[120:123], a[68:71]
 s_waitcnt lgkmcnt(0)
 v_mfma_f32_16x16x32_bf16 a[76:79], a[236:239], v[124:127], a[76:79]
 v_mfma_f32_16x16x32_bf16 a[80:83], a[240:243], v[112:115], a[80:83]
 v_cmp_le_u32 vcc, 233, v10
 v_mfma_f32_16x16x32_bf16 a[88:91], a[240:243], v[116:119], a[88:91]
 v_mfma_f32_16x16x32_bf16 a[84:87], a[244:247], v[112:115], a[84:87]
 s_cbranch_vccz L_cs1796
L_cb1796:
 ds_read_b64_tr_b16 a[240:241], v24 offset:8192
 v_accvgpr_read_b32 v32, a64
 v_accvgpr_read_b32 v33, a65
 v_cvt_pk_bf16_f32 v32, v32, v33
 v_accvgpr_read_b32 v34, a66
 v_accvgpr_read_b32 v35, a67
 v_mfma_f32_16x16x32_bf16 a[92:95], a[244:247], v[116:119], a[92:95]
 ds_read_b64_tr_b16 a[242:243], v24 offset:10240
 v_cvt_pk_bf16_f32 v33, v34, v35
 v_mfma_f32_16x16x32_bf16 a[80:83], a[248:251], v[120:123], a[80:83]
 ds_read_b64_tr_b16 a[244:245], v25 offset:8192
 v_accvgpr_read_b32 v36, a68
 v_mfma_f32_16x16x32_bf16 a[88:91], a[248:251], v[124:127], a[88:91]
 ds_read_b64_tr_b16 a[246:247], v25 offset:10240
 v_accvgpr_read_b32 v37, a69
 v_mfma_f32_16x16x32_bf16 a[84:87], a[252:255], v[120:123], a[84:87]
 ds_read_b64_tr_b16 a[248:249], v26 offset:8192
 v_cvt_pk_bf16_f32 v34, v36, v37
 v_mfma_f32_16x16x32_bf16 a[92:95], a[252:255], v[124:127], a[92:95]
 ds_read_b64_tr_b16 a[250:251], v26 offset:10240
 v_accvgpr_read_b32 v38, a70
 v_mfma_f32_16x16x32_bf16 v[128:131], v[18:21], a[0:3], 0
 ds_read_b64_tr_b16 a[252:253], v27 offset:8192
 v_accvgpr_read_b32 v39, a71
 v_mfma_f32_16x16x32_bf16 v[136:139], v[18:21], a[4:7], 0
 ds_read_b64_tr_b16 a[254:255], v27 offset:10240
 v_cvt_pk_bf16_f32 v35, v38, v39
 v_mfma_f32_16x16x32_bf16 v[132:135], v[16:19], a[0:3], 0
 ds_read_b64_tr_b16 a[224:225], v24 offset:12288
 buffer_store_dwordx4 v[32:35], v3, s[28:31], s36 offen offset:0 sc1
 v_accvgpr_read_b32 v40, a72
 v_accvgpr_read_b32 v41, a73
 v_cvt_pk_bf16_f32 v36, v40, v41
 v_accvgpr_read_b32 v42, a74
 v_accvgpr_read_b32 v43, a75
 v_cvt_pk_bf16_f32 v37, v42, v43
 v_accvgpr_read_b32 v44, a76
 v_accvgpr_read_b32 v45, a77
 v_cvt_pk_bf16_f32 v38, v44, v45
 v_accvgpr_read_b32 v46, a78
 v_accvgpr_read_b32 v47, a79
 v_cvt_pk_bf16_f32 v39, v46, v47
 buffer_store_dwordx4 v[36:39], v3, s[28:31], s36 offen offset:1024 sc1
 v_accvgpr_read_b32 v48, a80
 v_accvgpr_read_b32 v49, a81
 v_cvt_pk_bf16_f32 v48, v48, v49
 v_accvgpr_read_b32 v50, a82
 v_accvgpr_read_b32 v51, a83
 v_mfma_f32_16x16x32_bf16 v[140:143], v[16:19], a[4:7], 0
 ds_read_b64_tr_b16 a[226:227], v24 offset:14336
 v_cvt_pk_bf16_f32 v49, v50, v51
 v_mfma_f32_16x16x32_bf16 v[144:147], v[18:21], a[8:11], 0
 ds_read_b64_tr_b16 a[228:229], v25 offset:12288
 v_accvgpr_read_b32 v52, a84
 v_mfma_f32_16x16x32_bf16 v[152:155], v[18:21], a[12:15], 0
 ds_read_b64_tr_b16 a[230:231], v25 offset:14336
 v_accvgpr_read_b32 v53, a85
 v_mfma_f32_16x16x32_bf16 v[148:151], v[16:19], a[8:11], 0
 ds_read_b64_tr_b16 a[232:233], v26 offset:12288
 s_waitcnt lgkmcnt(5)
 v_cvt_pk_bf16_f32 v50, v52, v53
 v_mfma_f32_16x16x32_bf16 v[156:159], v[16:19], a[12:15], 0
 ds_read_b64_tr_b16 a[234:235], v26 offset:14336
 v_accvgpr_read_b32 v54, a86
 v_mfma_f32_16x16x32_bf16 v[128:131], a[240:243], v[64:67], v[128:131]
 ds_read_b64_tr_b16 a[236:237], v27 offset:12288
 v_accvgpr_read_b32 v55, a87
 v_mfma_f32_16x16x32_bf16 v[136:139], a[240:243], v[68:71], v[136:139]
 ds_read_b64_tr_b16 a[238:239], v27 offset:14336
 v_cvt_pk_bf16_f32 v51, v54, v55
 v_mfma_f32_16x16x32_bf16 v[132:135], a[244:247], v[64:67], v[132:135]
 ds_read_b64_tr_b16 a[240:241], v24 offset:0
 s_waitcnt vmcnt(3)
 buffer_store_dword v11, v12, s[80:83], s68 offen sc1
 s_addk_i32 s68, 128
 buffer_store_dwordx4 v[48:51], v3, s[28:31], s36 offen offset:2048 sc1
 v_mfma_f32_16x16x32_bf16 v[140:143], a[244:247], v[68:71], v[140:143]
 ds_read_b64_tr_b16 a[242:243], v24 offset:2048
 v_accvgpr_read_b32 v56, a88
 v_mfma_f32_16x16x32_bf16 v[144:147], a[248:251], v[64:67], v[144:147]
 ds_read_b64_tr_b16 a[244:245], v25 offset:0
 ds_read_b32 v10, v9
 v_mfma_f32_16x16x32_bf16 v[152:155], a[248:251], v[68:71], v[152:155]
 ds_read_b64_tr_b16 a[246:247], v25 offset:2048
 v_accvgpr_read_b32 v57, a89
 v_mfma_f32_16x16x32_bf16 v[148:151], a[252:255], v[64:67], v[148:151]
 ds_read_b64_tr_b16 a[248:249], v26 offset:0
 s_waitcnt lgkmcnt(6)
 v_cvt_pk_bf16_f32 v52, v56, v57
 v_mfma_f32_16x16x32_bf16 v[156:159], a[252:255], v[68:71], v[156:159]
 ds_read_b64_tr_b16 a[250:251], v26 offset:2048
 v_accvgpr_read_b32 v58, a90
 v_mfma_f32_16x16x32_bf16 v[128:131], a[224:227], v[72:75], v[128:131]
 ds_read_b64_tr_b16 a[252:253], v27 offset:0
 v_accvgpr_read_b32 v59, a91
 v_mfma_f32_16x16x32_bf16 v[136:139], a[224:227], v[76:79], v[136:139]
 ds_read_b64_tr_b16 a[254:255], v27 offset:2048
 v_cvt_pk_bf16_f32 v53, v58, v59
 v_mfma_f32_16x16x32_bf16 v[132:135], a[228:231], v[72:75], v[132:135]
 ds_read_b64_tr_b16 a[224:225], v24 offset:4096
 v_accvgpr_read_b32 v60, a92
 v_mfma_f32_16x16x32_bf16 v[140:143], a[228:231], v[76:79], v[140:143]
 ds_read_b64_tr_b16 a[226:227], v24 offset:6144
 v_accvgpr_read_b32 v61, a93
 v_mfma_f32_16x16x32_bf16 v[144:147], a[232:235], v[72:75], v[144:147]
 ds_read_b64_tr_b16 a[228:229], v25 offset:4096
 v_cvt_pk_bf16_f32 v54, v60, v61
 v_mfma_f32_16x16x32_bf16 v[152:155], a[232:235], v[76:79], v[152:155]
 ds_read_b64_tr_b16 a[230:231], v25 offset:6144
 v_accvgpr_read_b32 v62, a94
 v_mfma_f32_16x16x32_bf16 v[148:151], a[236:239], v[72:75], v[148:151]
 ds_read_b64_tr_b16 a[232:233], v26 offset:4096
 s_waitcnt lgkmcnt(5)
 v_accvgpr_read_b32 v63, a95
 v_mfma_f32_16x16x32_bf16 v[156:159], a[236:239], v[76:79], v[156:159]
 ds_read_b64_tr_b16 a[234:235], v26 offset:6144
 v_cvt_pk_bf16_f32 v55, v62, v63
 v_mfma_f32_16x16x32_bf16 v[128:131], a[240:243], v[80:83], v[128:131]
 ds_read_b64_tr_b16 a[236:237], v27 offset:4096
 v_cmp_le_u32 vcc, 235, v10
 buffer_store_dwordx4 v[52:55], v3, s[28:31], s36 offen offset:3072 sc1
 v_mfma_f32_16x16x32_bf16 v[136:139], a[240:243], v[84:87], v[136:139]
 ds_read_b64_tr_b16 a[238:239], v27 offset:6144
 v_mfma_f32_16x16x32_bf16 v[132:135], a[244:247], v[80:83], v[132:135]
 s_cbranch_vccz L_cs1812
L_cb1812:
 ds_read_b64_tr_b16 a[240:241], v24 offset:16384
 v_mfma_f32_16x16x32_bf16 v[140:143], a[244:247], v[84:87], v[140:143]
 ds_read_b64_tr_b16 a[242:243], v24 offset:18432
 v_mfma_f32_16x16x32_bf16 v[144:147], a[248:251], v[80:83], v[144:147]
 ds_read_b64_tr_b16 a[244:245], v25 offset:16384
 v_mfma_f32_16x16x32_bf16 v[152:155], a[248:251], v[84:87], v[152:155]
 ds_read_b64_tr_b16 a[246:247], v25 offset:18432
 v_mfma_f32_16x16x32_bf16 v[148:151], a[252:255], v[80:83], v[148:151]
 ds_read_b64_tr_b16 a[248:249], v26 offset:16384
 s_waitcnt lgkmcnt(5)
 v_mfma_f32_16x16x32_bf16 v[156:159], a[252:255], v[84:87], v[156:159]
 ds_read_b64_tr_b16 a[250:251], v26 offset:18432
 v_mfma_f32_16x16x32_bf16 v[128:131], a[224:227], v[88:91], v[128:131]
 ds_read_b64_tr_b16 a[252:253], v27 offset:16384
 v_mfma_f32_16x16x32_bf16 v[136:139], a[224:227], v[92:95], v[136:139]
 ds_read_b64_tr_b16 a[254:255], v27 offset:18432
 v_mfma_f32_16x16x32_bf16 v[132:135], a[228:231], v[88:91], v[132:135]
 ds_read_b64_tr_b16 a[224:225], v24 offset:20480
 v_mfma_f32_16x16x32_bf16 v[140:143], a[228:231], v[92:95], v[140:143]
 ds_read_b64_tr_b16 a[226:227], v24 offset:22528
 v_add_u32 v24, 0xffff0000, v24
 v_mfma_f32_16x16x32_bf16 v[144:147], a[232:235], v[88:91], v[144:147]
 ds_read_b64_tr_b16 a[228:229], v25 offset:20480
 v_mfma_f32_16x16x32_bf16 v[152:155], a[232:235], v[92:95], v[152:155]
 ds_read_b64_tr_b16 a[230:231], v25 offset:22528
 v_add_u32 v25, 0xffff0000, v25
 v_mfma_f32_16x16x32_bf16 v[148:151], a[236:239], v[88:91], v[148:151]
 ds_read_b64_tr_b16 a[232:233], v26 offset:20480
 s_waitcnt lgkmcnt(5)
 v_mfma_f32_16x16x32_bf16 v[156:159], a[236:239], v[92:95], v[156:159]
 ds_read_b64_tr_b16 a[234:235], v26 offset:22528
 v_add_u32 v26, 0xffff0000, v26
 v_mfma_f32_16x16x32_bf16 v[128:131], a[240:243], v[96:99], v[128:131]
 ds_read_b64_tr_b16 a[236:237], v27 offset:20480
 v_mfma_f32_16x16x32_bf16 v[136:139], a[240:243], v[100:103], v[136:139]
 ds_read_b64_tr_b16 a[238:239], v27 offset:22528
 v_add_u32 v27, 0xffff0000, v27
 v_mfma_f32_16x16x32_bf16 v[132:135], a[244:247], v[96:99], v[132:135]
 ds_read_b64_tr_b16 a[240:241], v24 offset:40960
 v_mfma_f32_16x16x32_bf16 v[140:143], a[244:247], v[100:103], v[140:143]
 ds_read_b64_tr_b16 a[242:243], v24 offset:43008
 v_mfma_f32_16x16x32_bf16 v[144:147], a[248:251], v[96:99], v[144:147]
 ds_read_b64_tr_b16 a[244:245], v25 offset:40960
 v_mfma_f32_16x16x32_bf16 v[152:155], a[248:251], v[100:103], v[152:155]
 ds_read_b64_tr_b16 a[246:247], v25 offset:43008
 v_mfma_f32_16x16x32_bf16 v[148:151], a[252:255], v[96:99], v[148:151]
 ds_read_b64_tr_b16 a[248:249], v24 offset:45056
 s_waitcnt lgkmcnt(5)
 v_mfma_f32_16x16x32_bf16 v[156:159], a[252:255], v[100:103], v[156:159]
 ds_read_b64_tr_b16 a[250:251], v24 offset:47104
 v_mfma_f32_16x16x32_bf16 v[128:131], a[224:227], v[104:107], v[128:131]
 ds_read_b64_tr_b16 a[252:253], v25 offset:45056
 v_mfma_f32_16x16x32_bf16 v[136:139], a[224:227], v[108:111], v[136:139]
 ds_read_b64_tr_b16 a[254:255], v25 offset:47104
 v_mfma_f32_16x16x32_bf16 v[132:135], a[228:231], v[104:107], v[132:135]
 ds_read_b64_tr_b16 a[224:225], v26 offset:40960
 v_mfma_f32_16x16x32_bf16 v[140:143], a[228:231], v[108:111], v[140:143]
 ds_read_b64_tr_b16 a[226:227], v26 offset:43008
 v_mfma_f32_16x16x32_bf16 v[144:147], a[232:235], v[104:107], v[144:147]
 ds_read_b64_tr_b16 a[228:229], v27 offset:40960
 ds_read_b32 v10, v9
 v_mfma_f32_16x16x32_bf16 v[152:155], a[232:235], v[108:111], v[152:155]
 ds_read_b64_tr_b16 a[230:231], v27 offset:43008
 v_mfma_f32_16x16x32_bf16 v[148:151], a[236:239], v[104:107], v[148:151]
 ds_read_b64_tr_b16 a[232:233], v26 offset:45056
 s_waitcnt lgkmcnt(6)
 v_mfma_f32_16x16x32_bf16 v[156:159], a[236:239], v[108:111], v[156:159]
 ds_read_b64_tr_b16 a[234:235], v26 offset:47104
 v_mfma_f32_16x16x32_bf16 v[128:131], a[240:243], v[112:115], v[128:131]
 ds_read_b64_tr_b16 a[236:237], v27 offset:45056
 v_mfma_f32_16x16x32_bf16 v[136:139], a[240:243], v[116:119], v[136:139]
 ds_read_b64_tr_b16 a[238:239], v27 offset:47104
 v_mfma_f32_16x16x32_bf16 v[132:135], a[244:247], v[112:115], v[132:135]
 v_mfma_f32_16x16x32_bf16 v[140:143], a[244:247], v[116:119], v[140:143]
 v_mfma_f32_16x16x32_bf16 v[128:131], a[248:251], v[120:123], v[128:131]
 v_mfma_f32_16x16x32_bf16 v[136:139], a[248:251], v[124:127], v[136:139]
 v_mfma_f32_16x16x32_bf16 v[132:135], a[252:255], v[120:123], v[132:135]
 s_waitcnt lgkmcnt(0)
 v_mfma_f32_16x16x32_bf16 v[140:143], a[252:255], v[124:127], v[140:143]
 v_mfma_f32_16x16x32_bf16 v[144:147], a[224:227], v[112:115], v[144:147]
 v_cmp_le_u32 vcc, 237, v10
 v_mfma_f32_16x16x32_bf16 v[152:155], a[224:227], v[116:119], v[152:155]
 v_mfma_f32_16x16x32_bf16 v[148:151], a[228:231], v[112:115], v[148:151]
 s_cbranch_vccz L_cs1832
L_cb1832:
 ds_read_b64_tr_b16 a[224:225], v24 offset:32768
 v_mfma_f32_16x16x32_bf16 v[156:159], a[228:231], v[116:119], v[156:159]
 ds_read_b64_tr_b16 a[226:227], v24 offset:34816
 v_cvt_pk_bf16_f32 v128, v128, v129
 v_mfma_f32_16x16x32_bf16 v[144:147], a[232:235], v[120:123], v[144:147]
 ds_read_b64_tr_b16 a[228:229], v25 offset:32768
 v_cvt_pk_bf16_f32 v129, v130, v131
 v_mfma_f32_16x16x32_bf16 v[152:155], a[232:235], v[124:127], v[152:155]
 ds_read_b64_tr_b16 a[230:231], v25 offset:34816
 v_cvt_pk_bf16_f32 v130, v132, v133
 v_mfma_f32_16x16x32_bf16 v[148:151], a[236:239], v[120:123], v[148:151]
 ds_read_b64_tr_b16 a[232:233], v26 offset:32768
 v_mfma_f32_16x16x32_bf16 v[156:159], a[236:239], v[124:127], v[156:159]
 ds_read_b64_tr_b16 a[234:235], v26 offset:34816
 v_cvt_pk_bf16_f32 v131, v134, v135
 v_mfma_f32_16x16x32_bf16 v[160:163], v[18:21], a[16:19], 0
 ds_read_b64_tr_b16 a[236:237], v27 offset:32768
 v_mfma_f32_16x16x32_bf16 v[168:171], v[18:21], a[20:23], 0
 ds_read_b64_tr_b16 a[238:239], v27 offset:34816
 v_mfma_f32_16x16x32_bf16 v[164:167], v[16:19], a[16:19], 0
 ds_read_b64_tr_b16 a[240:241], v24 offset:36864
 v_mfma_f32_16x16x32_bf16 v[172:175], v[16:19], a[20:23], 0
 ds_read_b64_tr_b16 a[242:243], v24 offset:38912
 v_add_u32 v24, 0x10000, v24
 v_mfma_f32_16x16x32_bf16 v[176:179], v[18:21], a[24:27], 0
 ds_read_b64_tr_b16 a[244:245], v25 offset:36864
 v_mfma_f32_16x16x32_bf16 v[184:187], v[18:21], a[28:31], 0
 ds_read_b64_tr_b16 a[246:247], v25 offset:38912
 v_add_u32 v25, 0x10000, v25
 v_mfma_f32_16x16x32_bf16 v[180:183], v[16:19], a[24:27], 0
 ds_read_b64_tr_b16 a[248:249], v26 offset:36864
 s_waitcnt lgkmcnt(5)
 buffer_store_dwordx4 v[128:131], v3, s[28:31], s37 offen offset:0 sc1
 v_mfma_f32_16x16x32_bf16 v[188:191], v[16:19], a[28:31], 0
 ds_read_b64_tr_b16 a[250:251], v26 offset:38912
 v_add_u32 v26, 0x10000, v26
 v_mfma_f32_16x16x32_bf16 v[160:163], a[224:227], v[64:67], v[160:163]
 ds_read_b64_tr_b16 a[252:253], v27 offset:36864
 v_cvt_pk_bf16_f32 v132, v136, v137
 v_mfma_f32_16x16x32_bf16 v[168:171], a[224:227], v[68:71], v[168:171]
 ds_read_b64_tr_b16 a[254:255], v27 offset:38912
 v_add_u32 v27, 0x10000, v27
 v_cvt_pk_bf16_f32 v133, v138, v139
 v_mfma_f32_16x16x32_bf16 v[164:167], a[228:231], v[64:67], v[164:167]
 ds_read_b64_tr_b16 a[224:225], v24 offset:24576
 v_cvt_pk_bf16_f32 v134, v140, v141
 v_mfma_f32_16x16x32_bf16 v[172:175], a[228:231], v[68:71], v[172:175]
 ds_read_b64_tr_b16 a[226:227], v24 offset:26624
 v_cvt_pk_bf16_f32 v135, v142, v143
 v_mfma_f32_16x16x32_bf16 v[176:179], a[232:235], v[64:67], v[176:179]
 ds_read_b64_tr_b16 a[228:229], v25 offset:24576
 ds_read_b32 v10, v9
 buffer_store_dwordx4 v[132:135], v3, s[28:31], s37 offen offset:1024 sc1
 v_mfma_f32_16x16x32_bf16 v[184:187], a[232:235], v[68:71], v[184:187]
 ds_read_b64_tr_b16 a[230:231], v25 offset:26624
 v_cvt_pk_bf16_f32 v144, v144, v145
 v_mfma_f32_16x16x32_bf16 v[180:183], a[236:239], v[64:67], v[180:183]
 ds_read_b64_tr_b16 a[232:233], v26 offset:24576
 s_waitcnt lgkmcnt(6)
 v_mfma_f32_16x16x32_bf16 v[188:191], a[236:239], v[68:71], v[188:191]
 ds_read_b64_tr_b16 a[234:235], v26 offset:26624
 v_cvt_pk_bf16_f32 v145, v146, v147
 v_mfma_f32_16x16x32_bf16 v[160:163], a[240:243], v[72:75], v[160:163]
 ds_read_b64_tr_b16 a[236:237], v27 offset:24576
 v_cvt_pk_bf16_f32 v146, v148, v149
 v_mfma_f32_16x16x32_bf16 v[168:171], a[240:243], v[76:79], v[168:171]
 ds_read_b64_tr_b16 a[238:239], v27 offset:26624
 v_cvt_pk_bf16_f32 v147, v150, v151
 v_mfma_f32_16x16x32_bf16 v[164:167], a[244:247], v[72:75], v[164:167]
 ds_read_b64_tr_b16 a[240:241], v24 offset:28672
 buffer_store_dwordx4 v[144:147], v3, s[28:31], s37 offen offset:2048 sc1
 v_mfma_f32_16x16x32_bf16 v[172:175], a[244:247], v[76:79], v[172:175]
 ds_read_b64_tr_b16 a[242:243], v24 offset:30720
 v_cvt_pk_bf16_f32 v148, v152, v153
 v_mfma_f32_16x16x32_bf16 v[176:179], a[248:251], v[72:75], v[176:179]
 ds_read_b64_tr_b16 a[244:245], v25 offset:28672
 v_cvt_pk_bf16_f32 v149, v154, v155
 v_mfma_f32_16x16x32_bf16 v[184:187], a[248:251], v[76:79], v[184:187]
 ds_read_b64_tr_b16 a[246:247], v25 offset:30720
 v_cvt_pk_bf16_f32 v150, v156, v157
 v_mfma_f32_16x16x32_bf16 v[180:183], a[252:255], v[72:75], v[180:183]
 ds_read_b64_tr_b16 a[248:249], v26 offset:28672
 s_waitcnt lgkmcnt(5)
 v_cvt_pk_bf16_f32 v151, v158, v159
 v_mfma_f32_16x16x32_bf16 v[188:191], a[252:255], v[76:79], v[188:191]
 ds_read_b64_tr_b16 a[250:251], v26 offset:30720
 v_add_u32 v24, 0xffff0000, v24
 v_mfma_f32_16x16x32_bf16 v[160:163], a[224:227], v[80:83], v[160:163]
 ds_read_b64_tr_b16 a[252:253], v27 offset:28672
 v_cmp_le_u32 vcc, 239, v10
 buffer_store_dwordx4 v[148:151], v3, s[28:31], s37 offen offset:3072 sc1
 v_mfma_f32_16x16x32_bf16 v[168:171], a[224:227], v[84:87], v[168:171]
 ds_read_b64_tr_b16 a[254:255], v27 offset:30720
 v_add_u32 v25, 0xffff0000, v25
 v_mfma_f32_16x16x32_bf16 v[164:167], a[228:231], v[80:83], v[164:167]
 s_cbranch_vccz L_cs1848
L_cb1848:
 ds_read_b64_tr_b16 a[224:225], v24 offset:49152
 v_mfma_f32_16x16x32_bf16 v[172:175], a[228:231], v[84:87], v[172:175]
 ds_read_b64_tr_b16 a[226:227], v24 offset:51200
 v_add_u32 v26, 0xffff0000, v26
 v_mfma_f32_16x16x32_bf16 v[176:179], a[232:235], v[80:83], v[176:179]
 ds_read_b64_tr_b16 a[228:229], v25 offset:49152
 v_add_u32 v27, 0xffff0000, v27
 v_mfma_f32_16x16x32_bf16 v[184:187], a[232:235], v[84:87], v[184:187]
 ds_read_b64_tr_b16 a[230:231], v25 offset:51200
 v_mfma_f32_16x16x32_bf16 v[180:183], a[236:239], v[80:83], v[180:183]
 ds_read_b64_tr_b16 a[232:233], v26 offset:49152
 s_waitcnt lgkmcnt(5)
 v_mfma_f32_16x16x32_bf16 v[188:191], a[236:239], v[84:87], v[188:191]
 ds_read_b64_tr_b16 a[234:235], v26 offset:51200
 v_mfma_f32_16x16x32_bf16 v[160:163], a[240:243], v[88:91], v[160:163]
 ds_read_b64_tr_b16 a[236:237], v27 offset:49152
 v_mfma_f32_16x16x32_bf16 v[168:171], a[240:243], v[92:95], v[168:171]
 ds_read_b64_tr_b16 a[238:239], v27 offset:51200
 v_mfma_f32_16x16x32_bf16 v[164:167], a[244:247], v[88:91], v[164:167]
 ds_read_b64_tr_b16 a[240:241], v24 offset:53248
 v_mfma_f32_16x16x32_bf16 v[172:175], a[244:247], v[92:95], v[172:175]
 ds_read_b64_tr_b16 a[242:243], v24 offset:55296
 v_mfma_f32_16x16x32_bf16 v[176:179], a[248:251], v[88:91], v[176:179]
 ds_read_b64_tr_b16 a[244:245], v25 offset:53248
 v_mfma_f32_16x16x32_bf16 v[184:187], a[248:251], v[92:95], v[184:187]
 ds_read_b64_tr_b16 a[246:247], v25 offset:55296
 v_mfma_f32_16x16x32_bf16 v[180:183], a[252:255], v[88:91], v[180:183]
 ds_read_b64_tr_b16 a[248:249], v26 offset:53248
 s_waitcnt lgkmcnt(5)
 v_mfma_f32_16x16x32_bf16 v[188:191], a[252:255], v[92:95], v[188:191]
 ds_read_b64_tr_b16 a[250:251], v26 offset:55296
 v_mfma_f32_16x16x32_bf16 v[160:163], a[224:227], v[96:99], v[160:163]
 ds_read_b64_tr_b16 a[252:253], v27 offset:53248
 v_mfma_f32_16x16x32_bf16 v[168:171], a[224:227], v[100:103], v[168:171]
 ds_read_b64_tr_b16 a[254:255], v27 offset:55296
 v_mfma_f32_16x16x32_bf16 v[164:167], a[228:231], v[96:99], v[164:167]
 ds_read_b64_tr_b16 a[224:225], v24 offset:57344
 v_mfma_f32_16x16x32_bf16 v[172:175], a[228:231], v[100:103], v[172:175]
 ds_read_b64_tr_b16 a[226:227], v24 offset:59392
 v_mfma_f32_16x16x32_bf16 v[176:179], a[232:235], v[96:99], v[176:179]
 ds_read_b64_tr_b16 a[228:229], v25 offset:57344
 v_mfma_f32_16x16x32_bf16 v[184:187], a[232:235], v[100:103], v[184:187]
 ds_read_b64_tr_b16 a[230:231], v25 offset:59392
 v_mfma_f32_16x16x32_bf16 v[180:183], a[236:239], v[96:99], v[180:183]
 ds_read_b64_tr_b16 a[232:233], v24 offset:61440
 s_waitcnt lgkmcnt(5)
 v_mfma_f32_16x16x32_bf16 v[188:191], a[236:239], v[100:103], v[188:191]
 ds_read_b64_tr_b16 a[234:235], v24 offset:63488
 v_add_u32 v24, 0x10000, v24
 v_mfma_f32_16x16x32_bf16 v[160:163], a[240:243], v[104:107], v[160:163]
 ds_read_b64_tr_b16 a[236:237], v25 offset:61440
 v_mfma_f32_16x16x32_bf16 v[168:171], a[240:243], v[108:111], v[168:171]
 ds_read_b64_tr_b16 a[238:239], v25 offset:63488
 v_add_u32 v25, 0x10000, v25
 v_mfma_f32_16x16x32_bf16 v[164:167], a[244:247], v[104:107], v[164:167]
 ds_read_b64_tr_b16 a[240:241], v26 offset:57344
 v_mfma_f32_16x16x32_bf16 v[172:175], a[244:247], v[108:111], v[172:175]
 ds_read_b64_tr_b16 a[242:243], v26 offset:59392
 v_mfma_f32_16x16x32_bf16 v[176:179], a[248:251], v[104:107], v[176:179]
 ds_read_b64_tr_b16 a[244:245], v27 offset:57344
 ds_read_b32 v10, v9
 v_mfma_f32_16x16x32_bf16 v[184:187], a[248:251], v[108:111], v[184:187]
 ds_read_b64_tr_b16 a[246:247], v27 offset:59392
 v_mfma_f32_16x16x32_bf16 v[180:183], a[252:255], v[104:107], v[180:183]
 ds_read_b64_tr_b16 a[248:249], v26 offset:61440
 s_waitcnt lgkmcnt(6)
 v_mfma_f32_16x16x32_bf16 v[188:191], a[252:255], v[108:111], v[188:191]
 ds_read_b64_tr_b16 a[250:251], v26 offset:63488
 v_add_u32 v26, 0x10000, v26
 v_mfma_f32_16x16x32_bf16 v[160:163], a[224:227], v[112:115], v[160:163]
 ds_read_b64_tr_b16 a[252:253], v27 offset:61440
 v_mfma_f32_16x16x32_bf16 v[168:171], a[224:227], v[116:119], v[168:171]
 ds_read_b64_tr_b16 a[254:255], v27 offset:63488
 v_add_u32 v27, 0x10000, v27
 v_mfma_f32_16x16x32_bf16 v[164:167], a[228:231], v[112:115], v[164:167]
 v_mfma_f32_16x16x32_bf16 v[172:175], a[228:231], v[116:119], v[172:175]
 v_mfma_f32_16x16x32_bf16 v[160:163], a[232:235], v[120:123], v[160:163]
 v_mfma_f32_16x16x32_bf16 v[168:171], a[232:235], v[124:127], v[168:171]
 v_mfma_f32_16x16x32_bf16 v[164:167], a[236:239], v[120:123], v[164:167]
 s_waitcnt lgkmcnt(0)
 v_mfma_f32_16x16x32_bf16 v[172:175], a[236:239], v[124:127], v[172:175]
 v_mfma_f32_16x16x32_bf16 v[176:179], a[240:243], v[112:115], v[176:179]
 v_cmp_le_u32 vcc, 241, v10
 v_mfma_f32_16x16x32_bf16 v[184:187], a[240:243], v[116:119], v[184:187]
 v_mfma_f32_16x16x32_bf16 v[180:183], a[244:247], v[112:115], v[180:183]
 s_cbranch_vccz L_cs1868
L_cb1868:
 ds_read_b64_tr_b16 a[240:241], v24 offset:32768
 v_mfma_f32_16x16x32_bf16 v[188:191], a[244:247], v[116:119], v[188:191]
 ds_read_b64_tr_b16 a[242:243], v24 offset:34816
 v_cvt_pk_bf16_f32 v160, v160, v161
 v_mfma_f32_16x16x32_bf16 v[176:179], a[248:251], v[120:123], v[176:179]
 ds_read_b64_tr_b16 a[244:245], v25 offset:32768
 v_cvt_pk_bf16_f32 v161, v162, v163
 v_mfma_f32_16x16x32_bf16 v[184:187], a[248:251], v[124:127], v[184:187]
 ds_read_b64_tr_b16 a[246:247], v25 offset:34816
 v_cvt_pk_bf16_f32 v162, v164, v165
 v_mfma_f32_16x16x32_bf16 v[180:183], a[252:255], v[120:123], v[180:183]
 ds_read_b64_tr_b16 a[248:249], v26 offset:32768
 v_mfma_f32_16x16x32_bf16 v[188:191], a[252:255], v[124:127], v[188:191]
 ds_read_b64_tr_b16 a[250:251], v26 offset:34816
 v_cvt_pk_bf16_f32 v163, v166, v167
 v_mfma_f32_16x16x32_bf16 v[192:195], v[18:21], a[32:35], 0
 ds_read_b64_tr_b16 a[252:253], v27 offset:32768
 v_mfma_f32_16x16x32_bf16 v[200:203], v[18:21], a[36:39], 0
 ds_read_b64_tr_b16 a[254:255], v27 offset:34816
 v_mfma_f32_16x16x32_bf16 v[196:199], v[16:19], a[32:35], 0
 ds_read_b64_tr_b16 a[224:225], v24 offset:36864
 s_waitcnt vmcnt(0)
 buffer_store_dword v11, v12, s[80:83], s68 offen sc1
 s_addk_i32 s68, 128
 v_mfma_f32_16x16x32_bf16 v[204:207], v[16:19], a[36:39], 0
 ds_read_b64_tr_b16 a[226:227], v24 offset:38912
 v_mfma_f32_16x16x32_bf16 v[208:211], v[18:21], a[40:43], 0
 ds_read_b64_tr_b16 a[228:229], v25 offset:36864
 v_mfma_f32_16x16x32_bf16 v[216:219], v[18:21], a[44:47], 0
 ds_read_b64_tr_b16 a[230:231], v25 offset:38912
 v_mfma_f32_16x16x32_bf16 v[212:215], v[16:19], a[40:43], 0
 ds_read_b64_tr_b16 a[232:233], v26 offset:36864
 s_waitcnt lgkmcnt(5)
 buffer_store_dwordx4 v[160:163], v3, s[28:31], s38 offen offset:0 sc1
 v_mfma_f32_16x16x32_bf16 v[220:223], v[16:19], a[44:47], 0
 ds_read_b64_tr_b16 a[234:235], v26 offset:38912
 v_cvt_pk_bf16_f32 v164, v168, v169
 v_mfma_f32_16x16x32_bf16 v[192:195], a[240:243], v[64:67], v[192:195]
 ds_read_b64_tr_b16 a[236:237], v27 offset:36864
 v_cvt_pk_bf16_f32 v165, v170, v171
 v_mfma_f32_16x16x32_bf16 v[200:203], a[240:243], v[68:71], v[200:203]
 ds_read_b64_tr_b16 a[238:239], v27 offset:38912
 v_cvt_pk_bf16_f32 v166, v172, v173
 v_mfma_f32_16x16x32_bf16 v[196:199], a[244:247], v[64:67], v[196:199]
 ds_read_b64_tr_b16 a[240:241], v24 offset:40960
 v_cvt_pk_bf16_f32 v167, v174, v175
 v_mfma_f32_16x16x32_bf16 v[204:207], a[244:247], v[68:71], v[204:207]
 ds_read_b64_tr_b16 a[242:243], v24 offset:43008
 v_mfma_f32_16x16x32_bf16 v[208:211], a[248:251], v[64:67], v[208:211]
 ds_read_b64_tr_b16 a[244:245], v25 offset:40960
 ds_read_b32 v10, v9
 buffer_store_dwordx4 v[164:167], v3, s[28:31], s38 offen offset:1024 sc1
 v_mfma_f32_16x16x32_bf16 v[216:219], a[248:251], v[68:71], v[216:219]
 ds_read_b64_tr_b16 a[246:247], v25 offset:43008
 v_cvt_pk_bf16_f32 v176, v176, v177
 v_mfma_f32_16x16x32_bf16 v[212:215], a[252:255], v[64:67], v[212:215]
 ds_read_b64_tr_b16 a[248:249], v26 offset:40960
 s_waitcnt lgkmcnt(6)
 v_mfma_f32_16x16x32_bf16 v[220:223], a[252:255], v[68:71], v[220:223]
 ds_read_b64_tr_b16 a[250:251], v26 offset:43008
 v_cvt_pk_bf16_f32 v177, v178, v179
 v_mfma_f32_16x16x32_bf16 v[192:195], a[224:227], v[72:75], v[192:195]
 ds_read_b64_tr_b16 a[252:253], v27 offset:40960
 v_cvt_pk_bf16_f32 v178, v180, v181
 v_mfma_f32_16x16x32_bf16 v[200:203], a[224:227], v[76:79], v[200:203]
 ds_read_b64_tr_b16 a[254:255], v27 offset:43008
 v_cvt_pk_bf16_f32 v179, v182, v183
 v_mfma_f32_16x16x32_bf16 v[196:199], a[228:231], v[72:75], v[196:199]
 ds_read_b64_tr_b16 a[224:225], v24 offset:45056
 buffer_store_dwordx4 v[176:179], v3, s[28:31], s38 offen offset:2048 sc1
 v_mfma_f32_16x16x32_bf16 v[204:207], a[228:231], v[76:79], v[204:207]
 ds_read_b64_tr_b16 a[226:227], v24 offset:47104
 v_cvt_pk_bf16_f32 v180, v184, v185
 v_mfma_f32_16x16x32_bf16 v[208:211], a[232:235], v[72:75], v[208:211]
 ds_read_b64_tr_b16 a[228:229], v25 offset:45056
 v_cvt_pk_bf16_f32 v181, v186, v187
 v_mfma_f32_16x16x32_bf16 v[216:219], a[232:235], v[76:79], v[216:219]
 ds_read_b64_tr_b16 a[230:231], v25 offset:47104
 v_cvt_pk_bf16_f32 v182, v188, v189
 v_mfma_f32_16x16x32_bf16 v[212:215], a[236:239], v[72:75], v[212:215]
 ds_read_b64_tr_b16 a[232:233], v26 offset:45056
 s_waitcnt lgkmcnt(5)
 v_cvt_pk_bf16_f32 v183, v190, v191
 v_mfma_f32_16x16x32_bf16 v[220:223], a[236:239], v[76:79], v[220:223]
 ds_read_b64_tr_b16 a[234:235], v26 offset:47104
 v_add_u32 v24, 0xffff0000, v24
 v_mfma_f32_16x16x32_bf16 v[192:195], a[240:243], v[80:83], v[192:195]
 ds_read_b64_tr_b16 a[236:237], v27 offset:45056
 v_cmp_le_u32 vcc, 243, v10
 buffer_store_dwordx4 v[180:183], v3, s[28:31], s38 offen offset:3072 sc1
 v_mfma_f32_16x16x32_bf16 v[200:203], a[240:243], v[84:87], v[200:203]
 ds_read_b64_tr_b16 a[238:239], v27 offset:47104
 v_add_u32 v25, 0xffff0000, v25
 v_mfma_f32_16x16x32_bf16 v[196:199], a[244:247], v[80:83], v[196:199]
 s_cbranch_vccz L_cs1884
L_cb1884:
 ds_read_b64_tr_b16 a[240:241], v24 offset:0
 v_mfma_f32_16x16x32_bf16 v[204:207], a[244:247], v[84:87], v[204:207]
 ds_read_b64_tr_b16 a[242:243], v24 offset:2048
 v_add_u32 v26, 0xffff0000, v26
 v_mfma_f32_16x16x32_bf16 v[208:211], a[248:251], v[80:83], v[208:211]
 ds_read_b64_tr_b16 a[244:245], v25 offset:0
 v_add_u32 v27, 0xffff0000, v27
 v_mfma_f32_16x16x32_bf16 v[216:219], a[248:251], v[84:87], v[216:219]
 ds_read_b64_tr_b16 a[246:247], v25 offset:2048
 v_mfma_f32_16x16x32_bf16 v[212:215], a[252:255], v[80:83], v[212:215]
 ds_read_b64_tr_b16 a[248:249], v26 offset:0
 s_waitcnt lgkmcnt(5)
 v_mfma_f32_16x16x32_bf16 v[220:223], a[252:255], v[84:87], v[220:223]
 ds_read_b64_tr_b16 a[250:251], v26 offset:2048
 v_mfma_f32_16x16x32_bf16 v[192:195], a[224:227], v[88:91], v[192:195]
 ds_read_b64_tr_b16 a[252:253], v27 offset:0
 v_mfma_f32_16x16x32_bf16 v[200:203], a[224:227], v[92:95], v[200:203]
 ds_read_b64_tr_b16 a[254:255], v27 offset:2048
 v_mfma_f32_16x16x32_bf16 v[196:199], a[228:231], v[88:91], v[196:199]
 ds_read_b64_tr_b16 a[224:225], v24 offset:4096
 v_mfma_f32_16x16x32_bf16 v[204:207], a[228:231], v[92:95], v[204:207]
 ds_read_b64_tr_b16 a[226:227], v24 offset:6144
 v_mfma_f32_16x16x32_bf16 v[208:211], a[232:235], v[88:91], v[208:211]
 ds_read_b64_tr_b16 a[228:229], v25 offset:4096
 v_mfma_f32_16x16x32_bf16 v[216:219], a[232:235], v[92:95], v[216:219]
 ds_read_b64_tr_b16 a[230:231], v25 offset:6144
 v_mfma_f32_16x16x32_bf16 v[212:215], a[236:239], v[88:91], v[212:215]
 ds_read_b64_tr_b16 a[232:233], v26 offset:4096
 s_waitcnt lgkmcnt(5)
 v_mfma_f32_16x16x32_bf16 v[220:223], a[236:239], v[92:95], v[220:223]
 ds_read_b64_tr_b16 a[234:235], v26 offset:6144
 v_mfma_f32_16x16x32_bf16 v[192:195], a[240:243], v[96:99], v[192:195]
 ds_read_b64_tr_b16 a[236:237], v27 offset:4096
 v_mfma_f32_16x16x32_bf16 v[200:203], a[240:243], v[100:103], v[200:203]
 ds_read_b64_tr_b16 a[238:239], v27 offset:6144
 v_mfma_f32_16x16x32_bf16 v[196:199], a[244:247], v[96:99], v[196:199]
 ds_read_b64_tr_b16 a[240:241], v24 offset:8192
 v_mfma_f32_16x16x32_bf16 v[204:207], a[244:247], v[100:103], v[204:207]
 ds_read_b64_tr_b16 a[242:243], v24 offset:10240
 v_mfma_f32_16x16x32_bf16 v[208:211], a[248:251], v[96:99], v[208:211]
 ds_read_b64_tr_b16 a[244:245], v25 offset:8192
 v_mfma_f32_16x16x32_bf16 v[216:219], a[248:251], v[100:103], v[216:219]
 ds_read_b64_tr_b16 a[246:247], v25 offset:10240
 v_mfma_f32_16x16x32_bf16 v[212:215], a[252:255], v[96:99], v[212:215]
 ds_read_b64_tr_b16 a[248:249], v24 offset:12288
 s_waitcnt lgkmcnt(5)
 v_mfma_f32_16x16x32_bf16 v[220:223], a[252:255], v[100:103], v[220:223]
 ds_read_b64_tr_b16 a[250:251], v24 offset:14336
 v_add_u32 v24, 0x10000, v24
 v_mfma_f32_16x16x32_bf16 v[192:195], a[224:227], v[104:107], v[192:195]
 ds_read_b64_tr_b16 a[252:253], v25 offset:12288
 v_mfma_f32_16x16x32_bf16 v[200:203], a[224:227], v[108:111], v[200:203]
 ds_read_b64_tr_b16 a[254:255], v25 offset:14336
 v_add_u32 v25, 0x10000, v25
 v_mfma_f32_16x16x32_bf16 v[196:199], a[228:231], v[104:107], v[196:199]
 ds_read_b64_tr_b16 a[224:225], v26 offset:8192
 v_mfma_f32_16x16x32_bf16 v[204:207], a[228:231], v[108:111], v[204:207]
 ds_read_b64_tr_b16 a[226:227], v26 offset:10240
 v_mfma_f32_16x16x32_bf16 v[208:211], a[232:235], v[104:107], v[208:211]
 ds_read_b64_tr_b16 a[228:229], v27 offset:8192
 ds_read_b32 v10, v9
 v_mfma_f32_16x16x32_bf16 v[216:219], a[232:235], v[108:111], v[216:219]
 ds_read_b64_tr_b16 a[230:231], v27 offset:10240
 v_mfma_f32_16x16x32_bf16 v[212:215], a[236:239], v[104:107], v[212:215]
 ds_read_b64_tr_b16 a[232:233], v26 offset:12288
 s_waitcnt lgkmcnt(6)
 v_mfma_f32_16x16x32_bf16 v[220:223], a[236:239], v[108:111], v[220:223]
 ds_read_b64_tr_b16 a[234:235], v26 offset:14336
 v_add_u32 v26, 0x10000, v26
 v_mfma_f32_16x16x32_bf16 v[192:195], a[240:243], v[112:115], v[192:195]
 ds_read_b64_tr_b16 a[236:237], v27 offset:12288
 v_mfma_f32_16x16x32_bf16 v[200:203], a[240:243], v[116:119], v[200:203]
 ds_read_b64_tr_b16 a[238:239], v27 offset:14336
 v_add_u32 v27, 0x10000, v27
 v_mfma_f32_16x16x32_bf16 v[196:199], a[244:247], v[112:115], v[196:199]
 v_mfma_f32_16x16x32_bf16 v[204:207], a[244:247], v[116:119], v[204:207]
 v_mfma_f32_16x16x32_bf16 v[192:195], a[248:251], v[120:123], v[192:195]
 v_mfma_f32_16x16x32_bf16 v[200:203], a[248:251], v[124:127], v[200:203]
 v_mfma_f32_16x16x32_bf16 v[196:199], a[252:255], v[120:123], v[196:199]
 s_waitcnt lgkmcnt(0)
 v_mfma_f32_16x16x32_bf16 v[204:207], a[252:255], v[124:127], v[204:207]
 v_mfma_f32_16x16x32_bf16 v[208:211], a[224:227], v[112:115], v[208:211]
 v_cmp_le_u32 vcc, 245, v10
 v_mfma_f32_16x16x32_bf16 v[216:219], a[224:227], v[116:119], v[216:219]
 v_mfma_f32_16x16x32_bf16 v[212:215], a[228:231], v[112:115], v[212:215]
 s_cbranch_vccz L_cs1904
L_cb1904:
 ds_read_b64_tr_b16 a[224:225], v24 offset:49152
 v_mfma_f32_16x16x32_bf16 v[220:223], a[228:231], v[116:119], v[220:223]
 ds_read_b64_tr_b16 a[226:227], v24 offset:51200
 v_cvt_pk_bf16_f32 v192, v192, v193
 v_mfma_f32_16x16x32_bf16 v[208:211], a[232:235], v[120:123], v[208:211]
 ds_read_b64_tr_b16 a[228:229], v25 offset:49152
 v_cvt_pk_bf16_f32 v193, v194, v195
 v_mfma_f32_16x16x32_bf16 v[216:219], a[232:235], v[124:127], v[216:219]
 ds_read_b64_tr_b16 a[230:231], v25 offset:51200
 v_cvt_pk_bf16_f32 v194, v196, v197
 v_mfma_f32_16x16x32_bf16 v[212:215], a[236:239], v[120:123], v[212:215]
 ds_read_b64_tr_b16 a[232:233], v26 offset:49152
 v_mfma_f32_16x16x32_bf16 v[220:223], a[236:239], v[124:127], v[220:223]
 ds_read_b64_tr_b16 a[234:235], v26 offset:51200
 v_cvt_pk_bf16_f32 v195, v198, v199
 v_mfma_f32_16x16x32_bf16 v[224:227], v[18:21], a[48:51], 0
 ds_read_b64_tr_b16 a[236:237], v27 offset:49152
 v_mfma_f32_16x16x32_bf16 v[232:235], v[18:21], a[52:55], 0
 ds_read_b64_tr_b16 a[238:239], v27 offset:51200
 v_mfma_f32_16x16x32_bf16 v[228:231], v[16:19], a[48:51], 0
 ds_read_b64_tr_b16 a[240:241], v24 offset:53248
 v_mfma_f32_16x16x32_bf16 v[236:239], v[16:19], a[52:55], 0
 ds_read_b64_tr_b16 a[242:243], v24 offset:55296
 v_mfma_f32_16x16x32_bf16 v[240:243], v[18:21], a[56:59], 0
 ds_read_b64_tr_b16 a[244:245], v25 offset:53248
 v_mfma_f32_16x16x32_bf16 v[248:251], v[18:21], a[60:63], 0
 ds_read_b64_tr_b16 a[246:247], v25 offset:55296
 v_mfma_f32_16x16x32_bf16 v[244:247], v[16:19], a[56:59], 0
 ds_read_b64_tr_b16 a[248:249], v26 offset:53248
 s_waitcnt lgkmcnt(5)
 buffer_store_dwordx4 v[192:195], v3, s[28:31], s39 offen offset:0 sc1
 v_mfma_f32_16x16x32_bf16 v[252:255], v[16:19], a[60:63], 0
 ds_read_b64_tr_b16 a[250:251], v26 offset:55296
 v_cvt_pk_bf16_f32 v196, v200, v201
 v_mfma_f32_16x16x32_bf16 v[224:227], a[224:227], v[64:67], v[224:227]
 ds_read_b64_tr_b16 a[252:253], v27 offset:53248
 v_cvt_pk_bf16_f32 v197, v202, v203
 v_mfma_f32_16x16x32_bf16 v[232:235], a[224:227], v[68:71], v[232:235]
 ds_read_b64_tr_b16 a[254:255], v27 offset:55296
 v_cvt_pk_bf16_f32 v198, v204, v205
 v_mfma_f32_16x16x32_bf16 v[228:231], a[228:231], v[64:67], v[228:231]
 ds_read_b64_tr_b16 a[224:225], v24 offset:57344
 v_cvt_pk_bf16_f32 v199, v206, v207
 v_mfma_f32_16x16x32_bf16 v[236:239], a[228:231], v[68:71], v[236:239]
 ds_read_b64_tr_b16 a[226:227], v24 offset:59392
 v_mfma_f32_16x16x32_bf16 v[240:243], a[232:235], v[64:67], v[240:243]
 ds_read_b64_tr_b16 a[228:229], v25 offset:57344
 ds_read_b32 v10, v9
 buffer_store_dwordx4 v[196:199], v3, s[28:31], s39 offen offset:1024 sc1
 v_mfma_f32_16x16x32_bf16 v[248:251], a[232:235], v[68:71], v[248:251]
 ds_read_b64_tr_b16 a[230:231], v25 offset:59392
 v_cvt_pk_bf16_f32 v208, v208, v209
 v_mfma_f32_16x16x32_bf16 v[244:247], a[236:239], v[64:67], v[244:247]
 ds_read_b64_tr_b16 a[232:233], v26 offset:57344
 s_waitcnt lgkmcnt(6)
 v_mfma_f32_16x16x32_bf16 v[252:255], a[236:239], v[68:71], v[252:255]
 ds_read_b64_tr_b16 a[234:235], v26 offset:59392
 v_cvt_pk_bf16_f32 v209, v210, v211
 v_mfma_f32_16x16x32_bf16 v[224:227], a[240:243], v[72:75], v[224:227]
 ds_read_b64_tr_b16 a[236:237], v27 offset:57344
 v_cvt_pk_bf16_f32 v210, v212, v213
 v_mfma_f32_16x16x32_bf16 v[232:235], a[240:243], v[76:79], v[232:235]
 ds_read_b64_tr_b16 a[238:239], v27 offset:59392
 v_cvt_pk_bf16_f32 v211, v214, v215
 v_mfma_f32_16x16x32_bf16 v[228:231], a[244:247], v[72:75], v[228:231]
 ds_read_b64_tr_b16 a[240:241], v24 offset:61440
 buffer_store_dwordx4 v[208:211], v3, s[28:31], s39 offen offset:2048 sc1
 v_mfma_f32_16x16x32_bf16 v[236:239], a[244:247], v[76:79], v[236:239]
 ds_read_b64_tr_b16 a[242:243], v24 offset:63488
 v_cvt_pk_bf16_f32 v212, v216, v217
 v_mfma_f32_16x16x32_bf16 v[240:243], a[248:251], v[72:75], v[240:243]
 ds_read_b64_tr_b16 a[244:245], v25 offset:61440
 v_cvt_pk_bf16_f32 v213, v218, v219
 v_mfma_f32_16x16x32_bf16 v[248:251], a[248:251], v[76:79], v[248:251]
 ds_read_b64_tr_b16 a[246:247], v25 offset:63488
 v_cvt_pk_bf16_f32 v214, v220, v221
 v_mfma_f32_16x16x32_bf16 v[244:247], a[252:255], v[72:75], v[244:247]
 ds_read_b64_tr_b16 a[248:249], v26 offset:61440
 s_waitcnt lgkmcnt(5)
 v_cvt_pk_bf16_f32 v215, v222, v223
 v_mfma_f32_16x16x32_bf16 v[252:255], a[252:255], v[76:79], v[252:255]
 ds_read_b64_tr_b16 a[250:251], v26 offset:63488
 v_add_u32 v24, 0x10000, v24
 v_mfma_f32_16x16x32_bf16 v[224:227], a[224:227], v[80:83], v[224:227]
 ds_read_b64_tr_b16 a[252:253], v27 offset:61440
 v_cmp_le_u32 vcc, 247, v10
 buffer_store_dwordx4 v[212:215], v3, s[28:31], s39 offen offset:3072 sc1
 v_mfma_f32_16x16x32_bf16 v[232:235], a[224:227], v[84:87], v[232:235]
 ds_read_b64_tr_b16 a[254:255], v27 offset:63488
 v_add_u32 v25, 0x10000, v25
 v_mfma_f32_16x16x32_bf16 v[228:231], a[228:231], v[80:83], v[228:231]
 s_cbranch_vccz L_cs1920
L_cb1920:
 ds_read_b64_tr_b16 a[224:225], v24 offset:0
 v_mfma_f32_16x16x32_bf16 v[236:239], a[228:231], v[84:87], v[236:239]
 ds_read_b64_tr_b16 a[226:227], v24 offset:2048
 v_add_u32 v26, 0x10000, v26
 v_mfma_f32_16x16x32_bf16 v[240:243], a[232:235], v[80:83], v[240:243]
 ds_read_b64_tr_b16 a[228:229], v25 offset:0
 v_add_u32 v27, 0x10000, v27
 v_mfma_f32_16x16x32_bf16 v[248:251], a[232:235], v[84:87], v[248:251]
 ds_read_b64_tr_b16 a[230:231], v25 offset:2048
 v_mfma_f32_16x16x32_bf16 v[244:247], a[236:239], v[80:83], v[244:247]
 ds_read_b64_tr_b16 a[232:233], v26 offset:0
 s_waitcnt lgkmcnt(5)
 v_mfma_f32_16x16x32_bf16 v[252:255], a[236:239], v[84:87], v[252:255]
 ds_read_b64_tr_b16 a[234:235], v26 offset:2048
 v_mfma_f32_16x16x32_bf16 v[224:227], a[240:243], v[88:91], v[224:227]
 ds_read_b64_tr_b16 a[236:237], v27 offset:0
 v_mfma_f32_16x16x32_bf16 v[232:235], a[240:243], v[92:95], v[232:235]
 ds_read_b64_tr_b16 a[238:239], v27 offset:2048
 v_mfma_f32_16x16x32_bf16 v[228:231], a[244:247], v[88:91], v[228:231]
 ds_read_b64_tr_b16 a[240:241], v24 offset:4096
 v_mfma_f32_16x16x32_bf16 v[236:239], a[244:247], v[92:95], v[236:239]
 ds_read_b64_tr_b16 a[242:243], v24 offset:6144
 v_mfma_f32_16x16x32_bf16 v[240:243], a[248:251], v[88:91], v[240:243]
 ds_read_b64_tr_b16 a[244:245], v25 offset:4096
 v_mfma_f32_16x16x32_bf16 v[248:251], a[248:251], v[92:95], v[248:251]
 ds_read_b64_tr_b16 a[246:247], v25 offset:6144
 v_mfma_f32_16x16x32_bf16 v[244:247], a[252:255], v[88:91], v[244:247]
 ds_read_b64_tr_b16 a[248:249], v26 offset:4096
 s_waitcnt lgkmcnt(5)
 v_mfma_f32_16x16x32_bf16 v[252:255], a[252:255], v[92:95], v[252:255]
 ds_read_b64_tr_b16 a[250:251], v26 offset:6144
 v_mfma_f32_16x16x32_bf16 v[224:227], a[224:227], v[96:99], v[224:227]
 ds_read_b64_tr_b16 a[252:253], v27 offset:4096
 v_mfma_f32_16x16x32_bf16 v[232:235], a[224:227], v[100:103], v[232:235]
 ds_read_b64_tr_b16 a[254:255], v27 offset:6144
 v_mfma_f32_16x16x32_bf16 v[228:231], a[228:231], v[96:99], v[228:231]
 ds_read_b64_tr_b16 a[224:225], v24 offset:8192
 v_mfma_f32_16x16x32_bf16 v[236:239], a[228:231], v[100:103], v[236:239]
 ds_read_b64_tr_b16 a[226:227], v24 offset:10240
 v_mfma_f32_16x16x32_bf16 v[240:243], a[232:235], v[96:99], v[240:243]
 ds_read_b64_tr_b16 a[228:229], v25 offset:8192
 v_mfma_f32_16x16x32_bf16 v[248:251], a[232:235], v[100:103], v[248:251]
 ds_read_b64_tr_b16 a[230:231], v25 offset:10240
 v_mfma_f32_16x16x32_bf16 v[244:247], a[236:239], v[96:99], v[244:247]
 ds_read_b64_tr_b16 a[232:233], v24 offset:12288
 s_waitcnt lgkmcnt(5)
 v_mfma_f32_16x16x32_bf16 v[252:255], a[236:239], v[100:103], v[252:255]
 ds_read_b64_tr_b16 a[234:235], v24 offset:14336
 v_mfma_f32_16x16x32_bf16 v[224:227], a[240:243], v[104:107], v[224:227]
 ds_read_b64_tr_b16 a[236:237], v25 offset:12288
 v_mfma_f32_16x16x32_bf16 v[232:235], a[240:243], v[108:111], v[232:235]
 ds_read_b64_tr_b16 a[238:239], v25 offset:14336
 v_mfma_f32_16x16x32_bf16 v[228:231], a[244:247], v[104:107], v[228:231]
 ds_read_b64_tr_b16 a[240:241], v26 offset:8192
 v_mfma_f32_16x16x32_bf16 v[236:239], a[244:247], v[108:111], v[236:239]
 ds_read_b64_tr_b16 a[242:243], v26 offset:10240
 v_mfma_f32_16x16x32_bf16 v[240:243], a[248:251], v[104:107], v[240:243]
 ds_read_b64_tr_b16 a[244:245], v27 offset:8192
 v_mfma_f32_16x16x32_bf16 v[248:251], a[248:251], v[108:111], v[248:251]
 ds_read_b64_tr_b16 a[246:247], v27 offset:10240
 v_mfma_f32_16x16x32_bf16 v[244:247], a[252:255], v[104:107], v[244:247]
 ds_read_b64_tr_b16 a[248:249], v26 offset:12288
 s_waitcnt lgkmcnt(5)
 v_mfma_f32_16x16x32_bf16 v[252:255], a[252:255], v[108:111], v[252:255]
 ds_read_b64_tr_b16 a[250:251], v26 offset:14336
 v_mfma_f32_16x16x32_bf16 v[224:227], a[224:227], v[112:115], v[224:227]
 ds_read_b64_tr_b16 a[252:253], v27 offset:12288
 v_mfma_f32_16x16x32_bf16 v[232:235], a[224:227], v[116:119], v[232:235]
 ds_read_b64_tr_b16 a[254:255], v27 offset:14336
 v_mfma_f32_16x16x32_bf16 v[228:231], a[228:231], v[112:115], v[228:231]
 v_mfma_f32_16x16x32_bf16 v[236:239], a[228:231], v[116:119], v[236:239]
 v_mfma_f32_16x16x32_bf16 v[224:227], a[232:235], v[120:123], v[224:227]
 v_mfma_f32_16x16x32_bf16 v[232:235], a[232:235], v[124:127], v[232:235]
 v_mfma_f32_16x16x32_bf16 v[228:231], a[236:239], v[120:123], v[228:231]
 s_waitcnt lgkmcnt(0)
 v_mfma_f32_16x16x32_bf16 v[236:239], a[236:239], v[124:127], v[236:239]
 v_mfma_f32_16x16x32_bf16 v[240:243], a[240:243], v[112:115], v[240:243]
 v_mfma_f32_16x16x32_bf16 v[248:251], a[240:243], v[116:119], v[248:251]
 v_mfma_f32_16x16x32_bf16 v[244:247], a[244:247], v[112:115], v[244:247]
 v_cvt_pk_bf16_f32 v224, v224, v225
 v_cvt_pk_bf16_f32 v225, v226, v227
 v_mfma_f32_16x16x32_bf16 v[252:255], a[244:247], v[116:119], v[252:255]
 v_cvt_pk_bf16_f32 v226, v228, v229
 v_cvt_pk_bf16_f32 v227, v230, v231
 v_mfma_f32_16x16x32_bf16 v[240:243], a[248:251], v[120:123], v[240:243]
 buffer_store_dwordx4 v[224:227], v3, s[28:31], s40 offen offset:0 sc1
 v_mfma_f32_16x16x32_bf16 v[248:251], a[248:251], v[124:127], v[248:251]
 v_cvt_pk_bf16_f32 v228, v232, v233
 v_cvt_pk_bf16_f32 v229, v234, v235
 v_mfma_f32_16x16x32_bf16 v[244:247], a[252:255], v[120:123], v[244:247]
 v_cvt_pk_bf16_f32 v230, v236, v237
 v_cvt_pk_bf16_f32 v231, v238, v239
 v_mfma_f32_16x16x32_bf16 v[252:255], a[252:255], v[124:127], v[252:255]
 buffer_store_dwordx4 v[228:231], v3, s[28:31], s40 offen offset:1024 sc1
 v_cvt_pk_bf16_f32 v240, v240, v241
 v_cvt_pk_bf16_f32 v241, v242, v243
  s_nop 0
 v_cvt_pk_bf16_f32 v242, v244, v245
 v_cvt_pk_bf16_f32 v243, v246, v247
 buffer_store_dwordx4 v[240:243], v3, s[28:31], s40 offen offset:2048 sc1
 v_cvt_pk_bf16_f32 v244, v248, v249
 v_cvt_pk_bf16_f32 v245, v250, v251
 v_cvt_pk_bf16_f32 v246, v252, v253
 v_cvt_pk_bf16_f32 v247, v254, v255
 buffer_store_dwordx4 v[244:247], v3, s[28:31], s40 offen offset:3072 sc1
 v_lshrrev_b32 v64, 4, v3
 v_lshlrev_b32 v67, 2, v64
 s_mul_i32 s44, s5, 1536
 s_lshl_b32 s45, s3, 9
 s_add_u32 s45, s45, s44
 v_lshl_add_u32 v65, v64, 3, s45
 v_lshrrev_b32 v68, 12, v65
 v_lshlrev_b32 v68, 5, v68
 v_bfe_u32 v69, v65, 10, 1
 v_lshl_add_u32 v68, v69, 4, v68
 v_bfe_u32 v69, v65, 4, 4
 v_add_u32 v68, v68, v69
 v_mul_u32_u24 v66, 896, v68
 v_bfe_u32 v69, v65, 11, 1
 v_lshl_add_u32 v66, v69, 6, v66
 v_bfe_u32 v69, v65, 3, 1
 v_lshl_add_u32 v66, v69, 5, v66
 v_bfe_u32 v69, v65, 8, 2
 v_lshl_add_u32 v66, v69, 3, v66
 v_and_b32 v68, 15, v64
 v_mul_u32_u24 v70, 896, v68
 v_lshrrev_b32 v68, 4, v64
 v_lshl_add_u32 v70, v68, 3, v70
 s_bfe_u32 s41, s68, 0x50002
 s_lshl_b32 s41, 1, s41
 v_mov_b32 v72, 1
 v_mov_b32 v73, 1
 v_mov_b32 v74, 1
 v_lshlrev_b32 v76, 2, v64
 v_add_u32 v76, 161792, v76
 s_mul_i32 s44, s5, 12
 s_mul_i32 s41, s5, 3
 s_lshl_b32 s41, 7, s41
 s_waitcnt vmcnt(0)
 ds_add_rtn_u32 v75, v76, v72
 s_waitcnt lgkmcnt(0)
 v_readfirstlane_b32 s45, v75
 s_cmp_eq_u32 s45, 2
 s_cselect_b32 s41, s41, 0
 s_cbranch_scc0 L_noflag
 buffer_store_dwordx3 v[72:74], v12, s[80:83], s44 offen offset:256 sc1
L_noflag:
 s_mov_b32 s34, 0
 s_mov_b32 s35, 0
 s_branch L_gc
L_gcs:
L_gc:
 s_add_u32 s57, s57, 1
 s_cmp_gt_u32 s57, 0x100000
 s_cbranch_scc1 L_exit1
 buffer_load_dword v68, v67, s[80:83], s53 offen offset:256 sc1
 s_waitcnt vmcnt(0)
 v_cmp_eq_u32 vcc, 1, v68
 s_or_b32 s44, vcc_lo, s41
 s_lshr_b32 s46, s44, 1
 s_lshr_b32 s47, s44, 2
 s_and_b32 s44, s44, s46
 s_and_b32 s44, s44, s47
 s_and_b32 s44, s44, 0x249249
 s_andn2_b32 s44, s44, s34
 s_cbranch_scc0 L_gcn5
 s_or_b32 s34, s34, s44
 s_bitcmp1_b32 s44, 0
 s_cbranch_scc0 L_gck5_0
 s_add_u32 s45, s42, 0xc000
 buffer_load_dwordx4 v[128:131], v3, s[76:79], s45 offen sc1
L_gck5_0:
 s_bitcmp1_b32 s44, 3
 s_cbranch_scc0 L_gck5_1
 s_add_u32 s45, s42, 0x2ac000
 buffer_load_dwordx4 v[132:135], v3, s[76:79], s45 offen sc1
L_gck5_1:
 s_bitcmp1_b32 s44, 6
 s_cbranch_scc0 L_gck5_2
 s_add_u32 s45, s42, 0x54c000
 buffer_load_dwordx4 v[136:139], v3, s[76:79], s45 offen sc1
L_gck5_2:
 s_bitcmp1_b32 s44, 9
 s_cbranch_scc0 L_gck5_3
 s_add_u32 s45, s42, 0x7ec000
 buffer_load_dwordx4 v[140:143], v3, s[76:79], s45 offen sc1
L_gck5_3:
 s_bitcmp1_b32 s44, 12
 s_cbranch_scc0 L_gck5_4
 s_add_u32 s45, s42, 0xa8c000
 buffer_load_dwordx4 v[144:147], v3, s[76:79], s45 offen sc1
L_gck5_4:
 s_bitcmp1_b32 s44, 15
 s_cbranch_scc0 L_gck5_5
 s_add_u32 s45, s42, 0xd2c000
 buffer_load_dwordx4 v[148:151], v3, s[76:79], s45 offen sc1
L_gck5_5:
 s_bitcmp1_b32 s44, 18
 s_cbranch_scc0 L_gck5_6
 s_add_u32 s45, s42, 0xfcc000
 buffer_load_dwordx4 v[152:155], v3, s[76:79], s45 offen sc1
L_gck5_6:
 s_bitcmp1_b32 s44, 21
 s_cbranch_scc0 L_gck5_7
 s_add_u32 s45, s42, 0x126c000
 buffer_load_dwordx4 v[156:159], v3, s[76:79], s45 offen sc1
L_gck5_7:
L_gcn5:
 s_or_b32 s44, vcc_lo, s41
 s_lshr_b32 s46, s44, 1
 s_lshr_b32 s47, s44, 2
 s_and_b32 s44, s44, s46
 s_and_b32 s44, s44, s47
 s_and_b32 s44, s44, 0x249249
 s_andn2_b32 s44, s44, s35
 s_cbranch_scc0 L_gcn6
 s_or_b32 s35, s35, s44
 s_bitcmp1_b32 s44, 0
 s_cbranch_scc0 L_gck6_0
 s_mov_b32 s45, 0x12000
 buffer_load_dwordx2 v[96:97], v65, s[76:79], s45 offen sc1
L_gck6_0:
 s_bitcmp1_b32 s44, 3
 s_cbranch_scc0 L_gck6_1
 s_mov_b32 s45, 0x2b2000
 buffer_load_dwordx2 v[98:99], v65, s[76:79], s45 offen sc1
L_gck6_1:
 s_bitcmp1_b32 s44, 6
 s_cbranch_scc0 L_gck6_2
 s_mov_b32 s45, 0x552000
 buffer_load_dwordx2 v[100:101], v65, s[76:79], s45 offen sc1
L_gck6_2:
 s_bitcmp1_b32 s44, 9
 s_cbranch_scc0 L_gck6_3
 s_mov_b32 s45, 0x7f2000
 buffer_load_dwordx2 v[102:103], v65, s[76:79], s45 offen sc1
L_gck6_3:
 s_bitcmp1_b32 s44, 12
 s_cbranch_scc0 L_gck6_4
 s_mov_b32 s45, 0xa92000
 buffer_load_dwordx2 v[104:105], v65, s[76:79], s45 offen sc1
L_gck6_4:
 s_bitcmp1_b32 s44, 15
 s_cbranch_scc0 L_gck6_5
 s_mov_b32 s45, 0xd32000
 buffer_load_dwordx2 v[106:107], v65, s[76:79], s45 offen sc1
L_gck6_5:
 s_bitcmp1_b32 s44, 18
 s_cbranch_scc0 L_gck6_6
 s_mov_b32 s45, 0xfd2000
 buffer_load_dwordx2 v[108:109], v65, s[76:79], s45 offen sc1
L_gck6_6:
 s_bitcmp1_b32 s44, 21
 s_cbranch_scc0 L_gck6_7
 s_mov_b32 s45, 0x1272000
 buffer_load_dwordx2 v[110:111], v65, s[76:79], s45 offen sc1
L_gck6_7:
L_gcn6:
 s_cmp_eq_u32 s34, 0x249249
 s_cbranch_scc0 L_gcs
 s_cmp_eq_u32 s35, 0x249249
 s_cbranch_scc0 L_gcs
 s_waitcnt vmcnt(0)
 v_lshlrev_b32 v80, 16, v128
 v_and_b32 v81, s56, v128
 v_lshlrev_b32 v82, 16, v129
 v_and_b32 v83, s56, v129
 v_lshlrev_b32 v84, 16, v130
 v_and_b32 v85, s56, v130
 v_lshlrev_b32 v86, 16, v131
 v_and_b32 v87, s56, v131
 v_lshlrev_b32 v88, 16, v132
 v_and_b32 v89, s56, v132
 v_add_f32 v80, v80, v88
 v_add_f32 v81, v81, v89
 v_lshlrev_b32 v88, 16, v133
 v_and_b32 v89, s56, v133
 v_add_f32 v82, v82, v88
 v_add_f32 v83, v83, v89
 v_lshlrev_b32 v88, 16, v134
 v_and_b32 v89, s56, v134
 v_add_f32 v84, v84, v88
 v_add_f32 v85, v85, v89
 v_lshlrev_b32 v88, 16, v135
 v_and_b32 v89, s56, v135
 v_add_f32 v86, v86, v88
 v_add_f32 v87, v87, v89
 v_lshlrev_b32 v88, 16, v136
 v_and_b32 v89, s56, v136
 v_add_f32 v80, v80, v88
 v_add_f32 v81, v81, v89
 v_lshlrev_b32 v88, 16, v137
 v_and_b32 v89, s56, v137
 v_add_f32 v82, v82, v88
 v_add_f32 v83, v83, v89
 v_lshlrev_b32 v88, 16, v138
 v_and_b32 v89, s56, v138
 v_add_f32 v84, v84, v88
 v_add_f32 v85, v85, v89
 v_lshlrev_b32 v88, 16, v139
 v_and_b32 v89, s56, v139
 v_add_f32 v86, v86, v88
 v_add_f32 v87, v87, v89
 v_lshlrev_b32 v88, 16, v140
 v_and_b32 v89, s56, v140
 v_add_f32 v80, v80, v88
 v_add_f32 v81, v81, v89
 v_lshlrev_b32 v88, 16, v141
 v_and_b32 v89, s56, v141
 v_add_f32 v82, v82, v88
 v_add_f32 v83, v83, v89
 v_lshlrev_b32 v88, 16, v142
 v_and_b32 v89, s56, v142
 v_add_f32 v84, v84, v88
 v_add_f32 v85, v85, v89
 v_lshlrev_b32 v88, 16, v143
 v_and_b32 v89, s56, v143
 v_add_f32 v86, v86, v88
 v_add_f32 v87, v87, v89
 v_lshlrev_b32 v88, 16, v144
 v_and_b32 v89, s56, v144
 v_add_f32 v80, v80, v88
 v_add_f32 v81, v81, v89
 v_lshlrev_b32 v88, 16, v145
 v_and_b32 v89, s56, v145
 v_add_f32 v82, v82, v88
 v_add_f32 v83, v83, v89
 v_lshlrev_b32 v88, 16, v146
 v_and_b32 v89, s56, v146
 v_add_f32 v84, v84, v88
 v_add_f32 v85, v85, v89
 v_lshlrev_b32 v88, 16, v147
 v_and_b32 v89, s56, v147
 v_add_f32 v86, v86, v88
 v_add_f32 v87, v87, v89
 v_lshlrev_b32 v88, 16, v148
 v_and_b32 v89, s56, v148
 v_add_f32 v80, v80, v88
 v_add_f32 v81, v81, v89
 v_lshlrev_b32 v88, 16, v149
 v_and_b32 v89, s56, v149
 v_add_f32 v82, v82, v88
 v_add_f32 v83, v83, v89
 v_lshlrev_b32 v88, 16, v150
 v_and_b32 v89, s56, v150
 v_add_f32 v84, v84, v88
 v_add_f32 v85, v85, v89
 v_lshlrev_b32 v88, 16, v151
 v_and_b32 v89, s56, v151
 v_add_f32 v86, v86, v88
 v_add_f32 v87, v87, v89
 v_lshlrev_b32 v88, 16, v152
 v_and_b32 v89, s56, v152
 v_add_f32 v80, v80, v88
 v_add_f32 v81, v81, v89
 v_lshlrev_b32 v88, 16, v153
 v_and_b32 v89, s56, v153
 v_add_f32 v82, v82, v88
 v_add_f32 v83, v83, v89
 v_lshlrev_b32 v88, 16, v154
 v_and_b32 v89, s56, v154
 v_add_f32 v84, v84, v88
 v_add_f32 v85, v85, v89
 v_lshlrev_b32 v88, 16, v155
 v_and_b32 v89, s56, v155
 v_add_f32 v86, v86, v88
 v_add_f32 v87, v87, v89
 v_lshlrev_b32 v88, 16, v156
 v_and_b32 v89, s56, v156
 v_add_f32 v80, v80, v88
 v_add_f32 v81, v81, v89
 v_lshlrev_b32 v88, 16, v157
 v_and_b32 v89, s56, v157
 v_add_f32 v82, v82, v88
 v_add_f32 v83, v83, v89
 v_lshlrev_b32 v88, 16, v158
 v_and_b32 v89, s56, v158
 v_add_f32 v84, v84, v88
 v_add_f32 v85, v85, v89
 v_lshlrev_b32 v88, 16, v159
 v_and_b32 v89, s56, v159
 v_add_f32 v86, v86, v88
 v_add_f32 v87, v87, v89
 v_cvt_pk_bf16_f32 v80, v80, v81
 v_cvt_pk_bf16_f32 v81, v82, v83
 buffer_store_dwordx2 v[80:81], v70, s[84:87], s43 offen offset:512
 v_cvt_pk_bf16_f32 v84, v84, v85
 v_cvt_pk_bf16_f32 v85, v86, v87
 buffer_store_dwordx2 v[84:85], v70, s[84:87], s43 offen offset:544
 v_lshlrev_b32 v72, 16, v96
 v_and_b32 v73, s56, v96
 v_lshlrev_b32 v74, 16, v97
 v_and_b32 v75, s56, v97
 v_lshlrev_b32 v76, 16, v98
 v_and_b32 v77, s56, v98
 v_add_f32 v72, v72, v76
 v_add_f32 v73, v73, v77
 v_lshlrev_b32 v76, 16, v99
 v_and_b32 v77, s56, v99
 v_add_f32 v74, v74, v76
 v_add_f32 v75, v75, v77
 v_lshlrev_b32 v76, 16, v100
 v_and_b32 v77, s56, v100
 v_add_f32 v72, v72, v76
 v_add_f32 v73, v73, v77
 v_lshlrev_b32 v76, 16, v101
 v_and_b32 v77, s56, v101
 v_add_f32 v74, v74, v76
 v_add_f32 v75, v75, v77
 v_lshlrev_b32 v76, 16, v102
 v_and_b32 v77, s56, v102
 v_add_f32 v72, v72, v76
 v_add_f32 v73, v73, v77
 v_lshlrev_b32 v76, 16, v103
 v_and_b32 v77, s56, v103
 v_add_f32 v74, v74, v76
 v_add_f32 v75, v75, v77
 v_lshlrev_b32 v76, 16, v104
 v_and_b32 v77, s56, v104
 v_add_f32 v72, v72, v76
 v_add_f32 v73, v73, v77
 v_lshlrev_b32 v76, 16, v105
 v_and_b32 v77, s56, v105
 v_add_f32 v74, v74, v76
 v_add_f32 v75, v75, v77
 v_lshlrev_b32 v76, 16, v106
 v_and_b32 v77, s56, v106
 v_add_f32 v72, v72, v76
 v_add_f32 v73, v73, v77
 v_lshlrev_b32 v76, 16, v107
 v_and_b32 v77, s56, v107
 v_add_f32 v74, v74, v76
 v_add_f32 v75, v75, v77
 v_lshlrev_b32 v76, 16, v108
 v_and_b32 v77, s56, v108
 v_add_f32 v72, v72, v76
 v_add_f32 v73, v73, v77
 v_lshlrev_b32 v76, 16, v109
 v_and_b32 v77, s56, v109
 v_add_f32 v74, v74, v76
 v_add_f32 v75, v75, v77
 v_lshlrev_b32 v76, 16, v110
 v_and_b32 v77, s56, v110
 v_add_f32 v72, v72, v76
 v_add_f32 v73, v73, v77
 v_lshlrev_b32 v76, 16, v111
 v_and_b32 v77, s56, v111
 v_add_f32 v74, v74, v76
 v_add_f32 v75, v75, v77
 v_cvt_pk_bf16_f32 v72, v72, v73
 v_cvt_pk_bf16_f32 v73, v74, v75
 buffer_store_dwordx2 v[72:73], v66, s[84:87], 0 offen offset:768
L_exit1:
 s_endpgm
L_cslow:
L_cslow1:
 s_add_u32 s57, s57, 1
 s_cmp_gt_u32 s57, 0x100000
 s_cbranch_scc1 L_exit1
 ds_read_b32 v10, v9
 s_waitcnt lgkmcnt(0)
 v_readfirstlane_b32 s55, v10
 s_cmp_ge_u32 s55, s50
 s_cbranch_scc1 L_cslow2
 s_sleep 2
 s_branch L_cslow1
L_cslow2:
 s_setpc_b64 s[48:49]
L_cs0:
 s_movk_i32 s50, 2
 s_call_b64 s[48:49], L_cslow
 s_branch L_cb0
L_cs8:
 s_movk_i32 s50, 3
 s_call_b64 s[48:49], L_cslow
 s_branch L_cb8
L_cs16:
 s_movk_i32 s50, 4
 s_call_b64 s[48:49], L_cslow
 s_branch L_cb16
L_cs24:
 s_movk_i32 s50, 8
 s_call_b64 s[48:49], L_cslow
 s_branch L_cb24
L_cs40:
 s_movk_i32 s50, 10
 s_call_b64 s[48:49], L_cslow
 s_branch L_cb40
L_cs56:
 s_movk_i32 s50, 11
 s_call_b64 s[48:49], L_cslow
 s_branch L_cb56
L_cs64:
 s_movk_i32 s50, 17
 s_call_b64 s[48:49], L_cslow
 s_branch L_cb64
L_cs80:
 s_movk_i32 s50, 19
 s_call_b64 s[48:49], L_cslow
 s_branch L_cb80
L_cs96:
 s_movk_i32 s50, 21
 s_call_b64 s[48:49], L_cslow
 s_branch L_cb96
L_cs112:
 s_movk_i32 s50, 23
 s_call_b64 s[48:49], L_cslow
 s_branch L_cb112
L_cs128:
 s_movk_i32 s50, 25
 s_call_b64 s[48:49], L_cslow
 s_branch L_cb128
L_cs144:
 s_movk_i32 s50, 27
 s_call_b64 s[48:49], L_cslow
 s_branch L_cb144
L_cs160:
 s_movk_i32 s50, 29
 s_call_b64 s[48:49], L_cslow
 s_branch L_cb160
L_cs176:
 s_movk_i32 s50, 31
 s_call_b64 s[48:49], L_cslow
 s_branch L_cb176
L_cs192:
 s_movk_i32 s50, 33
 s_call_b64 s[48:49], L_cslow
 s_branch L_cb192
L_cs208:
 s_movk_i32 s50, 35
 s_call_b64 s[48:49], L_cslow
 s_branch L_cb208
L_cs224:
 s_movk_i32 s50, 37
 s_call_b64 s[48:49], L_cslow
 s_branch L_cb224
L_cs240:
 s_movk_i32 s50, 38
 s_call_b64 s[48:49], L_cslow
 s_branch L_cb240
L_cs248:
 s_movk_i32 s50, 42
 s_call_b64 s[48:49], L_cslow
 s_branch L_cb248
L_cs272:
 s_movk_i32 s50, 44
 s_call_b64 s[48:49], L_cslow
 s_branch L_cb272
L_rs0_1:
 s_call_b64 s[48:49], L_rescale1
 s_branch L_rb0_1
L_cs288:
 s_movk_i32 s50, 46
 s_call_b64 s[48:49], L_cslow
 s_branch L_cb288
L_cs304:
 s_movk_i32 s50, 48
 s_call_b64 s[48:49], L_cslow
 s_branch L_cb304
L_rs0_2:
 s_call_b64 s[48:49], L_rescale0
 s_branch L_rb0_2
L_cs320:
 s_movk_i32 s50, 50
 s_call_b64 s[48:49], L_cslow
 s_branch L_cb320
L_cs336:
 s_movk_i32 s50, 51
 s_call_b64 s[48:49], L_cslow
 s_branch L_cb336
L_rs0_3:
 s_call_b64 s[48:49], L_rescale1
 s_branch L_rb0_3
L_cs352:
 s_movk_i32 s50, 52
 s_call_b64 s[48:49], L_cslow
 s_branch L_cb352
L_cs360:
 s_movk_i32 s50, 56
 s_call_b64 s[48:49], L_cslow
 s_branch L_cb360
L_cs384:
 s_movk_i32 s50, 57
 s_call_b64 s[48:49], L_cslow
 s_branch L_cb384
L_rs0_4:
 s_call_b64 s[48:49], L_rescale0
 s_branch L_rb0_4
L_cs400:
 s_movk_i32 s50, 58
 s_call_b64 s[48:49], L_cslow
 s_branch L_cb400
L_cs408:
 s_movk_i32 s50, 62
 s_call_b64 s[48:49], L_cslow
 s_branch L_cb408
L_cs432:
 s_movk_i32 s50, 63
 s_call_b64 s[48:49], L_cslow
 s_branch L_cb432
L_rs0_5:
 s_call_b64 s[48:49], L_rescale1
 s_branch L_rb0_5
L_cs448:
 s_movk_i32 s50, 64
 s_call_b64 s[48:49], L_cslow
 s_branch L_cb448
L_cs456:
 s_movk_i32 s50, 68
 s_call_b64 s[48:49], L_cslow
 s_branch L_cb456
L_cs480:
 s_movk_i32 s50, 69
 s_call_b64 s[48:49], L_cslow
 s_branch L_cb480
L_rs0_6:
 s_call_b64 s[48:49], L_rescale0
 s_branch L_rb0_6
L_cs496:
 s_movk_i32 s50, 70
 s_call_b64 s[48:49], L_cslow
 s_branch L_cb496
L_cs504:
 s_movk_i32 s50, 74
 s_call_b64 s[48:49], L_cslow
 s_branch L_cb504
L_cs528:
 s_movk_i32 s50, 75
 s_call_b64 s[48:49], L_cslow
 s_branch L_cb528
L_rs0_7:
 s_call_b64 s[48:49], L_rescale1
 s_branch L_rb0_7
L_cs544:
 s_movk_i32 s50, 76
 s_call_b64 s[48:49], L_cslow
 s_branch L_cb544
L_cs552:
 s_movk_i32 s50, 80
 s_call_b64 s[48:49], L_cslow
 s_branch L_cb552
L_cs576:
 s_movk_i32 s50, 81
 s_call_b64 s[48:49], L_cslow
 s_branch L_cb576
L_rs0_8:
 s_call_b64 s[48:49], L_rescale0
 s_branch L_rb0_8
L_cs592:
 s_movk_i32 s50, 83
 s_call_b64 s[48:49], L_cslow
 s_branch L_cb592
L_cs608:
 s_movk_i32 s50, 86
 s_call_b64 s[48:49], L_cslow
 s_branch L_cb608
L_cs632:
 s_movk_i32 s50, 87
 s_call_b64 s[48:49], L_cslow
 s_branch L_cb632
L_rs0_9:
 s_call_b64 s[48:49], L_rescale1
 s_branch L_rb0_9
L_cs640:
 s_movk_i32 s50, 89
 s_call_b64 s[48:49], L_cslow
 s_branch L_cb640
L_cs656:
 s_movk_i32 s50, 92
 s_call_b64 s[48:49], L_cslow
 s_branch L_cb656
L_cs680:
 s_movk_i32 s50, 93
 s_call_b64 s[48:49], L_cslow
 s_branch L_cb680
L_rs0_10:
 s_call_b64 s[48:49], L_rescale0
 s_branch L_rb0_10
L_cs688:
 s_movk_i32 s50, 95
 s_call_b64 s[48:49], L_cslow
 s_branch L_cb688
L_cs704:
 s_movk_i32 s50, 98
 s_call_b64 s[48:49], L_cslow
 s_branch L_cb704
L_cs728:
 s_movk_i32 s50, 99
 s_call_b64 s[48:49], L_cslow
 s_branch L_cb728
L_rs0_11:
 s_call_b64 s[48:49], L_rescale1
 s_branch L_rb0_11
L_cs736:
 s_movk_i32 s50, 101
 s_call_b64 s[48:49], L_cslow
 s_branch L_cb736
L_cs752:
 s_movk_i32 s50, 102
 s_call_b64 s[48:49], L_cslow
 s_branch L_cb752
L_cs760:
 s_movk_i32 s50, 106
 s_call_b64 s[48:49], L_cslow
 s_branch L_cb760
L_cs784:
 s_movk_i32 s50, 107
 s_call_b64 s[48:49], L_cslow
 s_branch L_cb784
L_rs0_12:
 s_call_b64 s[48:49], L_rescale0
 s_branch L_rb0_12
L_cs800:
 s_movk_i32 s50, 108
 s_call_b64 s[48:49], L_cslow
 s_branch L_cb800
L_cs808:
 s_movk_i32 s50, 112
 s_call_b64 s[48:49], L_cslow
 s_branch L_cb808
L_cs832:
 s_movk_i32 s50, 113
 s_call_b64 s[48:49], L_cslow
 s_branch L_cb832
L_rs0_13:
 s_call_b64 s[48:49], L_rescale1
 s_branch L_rb0_13
L_cs848:
 s_movk_i32 s50, 114
 s_call_b64 s[48:49], L_cslow
 s_branch L_cb848
L_cs856:
 s_movk_i32 s50, 118
 s_call_b64 s[48:49], L_cslow
 s_branch L_cb856
L_cs880:
 s_movk_i32 s50, 119
 s_call_b64 s[48:49], L_cslow
 s_branch L_cb880
L_rs0_14:
 s_call_b64 s[48:49], L_rescale0
 s_branch L_rb0_14
L_cs896:
 s_movk_i32 s50, 121
 s_call_b64 s[48:49], L_cslow
 s_branch L_cb896
L_cs912:
 s_movk_i32 s50, 124
 s_call_b64 s[48:49], L_cslow
 s_branch L_cb912
L_cs936:
 s_movk_i32 s50, 126
 s_call_b64 s[48:49], L_cslow
 s_branch L_cb936
L_rs0_15:
 s_call_b64 s[48:49], L_rescale1
 s_branch L_rb0_15
L_cs952:
 s_movk_i32 s50, 128
 s_call_b64 s[48:49], L_cslow
 s_branch L_cb952
L_cs968:
 s_movk_i32 s50, 130
 s_call_b64 s[48:49], L_cslow
 s_branch L_cb968
L_cs984:
 s_movk_i32 s50, 132
 s_call_b64 s[48:49], L_cslow
 s_branch L_cb984
L_cs1000:
 s_movk_i32 s50, 133
 s_call_b64 s[48:49], L_cslow
 s_branch L_cb1000
L_rs1_1:
 s_call_b64 s[48:49], L_rescale1
 s_branch L_rb1_1
L_cs1008:
 s_movk_i32 s50, 134
 s_call_b64 s[48:49], L_cslow
 s_branch L_cb1008
L_cs1016:
 s_movk_i32 s50, 138
 s_call_b64 s[48:49], L_cslow
 s_branch L_cb1016
L_cs1040:
 s_movk_i32 s50, 139
 s_call_b64 s[48:49], L_cslow
 s_branch L_cb1040
L_rs1_2:
 s_call_b64 s[48:49], L_rescale0
 s_branch L_rb1_2
L_cs1056:
 s_movk_i32 s50, 142
 s_call_b64 s[48:49], L_cslow
 s_branch L_cb1056
L_cs1080:
 s_movk_i32 s50, 143
 s_call_b64 s[48:49], L_cslow
 s_branch L_cb1080
L_rs1_3:
 s_call_b64 s[48:49], L_rescale1
 s_branch L_rb1_3
L_cs1088:
 s_movk_i32 s50, 145
 s_call_b64 s[48:49], L_cslow
 s_branch L_cb1088
L_cs1104:
 s_movk_i32 s50, 148
 s_call_b64 s[48:49], L_cslow
 s_branch L_cb1104
L_cs1128:
 s_movk_i32 s50, 149
 s_call_b64 s[48:49], L_cslow
 s_branch L_cb1128
L_rs1_4:
 s_call_b64 s[48:49], L_rescale0
 s_branch L_rb1_4
L_cs1136:
 s_movk_i32 s50, 151
 s_call_b64 s[48:49], L_cslow
 s_branch L_cb1136
L_cs1152:
 s_movk_i32 s50, 154
 s_call_b64 s[48:49], L_cslow
 s_branch L_cb1152
L_cs1176:
 s_movk_i32 s50, 155
 s_call_b64 s[48:49], L_cslow
 s_branch L_cb1176
L_rs1_5:
 s_call_b64 s[48:49], L_rescale1
 s_branch L_rb1_5
L_cs1184:
 s_movk_i32 s50, 157
 s_call_b64 s[48:49], L_cslow
 s_branch L_cb1184
L_cs1200:
 s_movk_i32 s50, 160
 s_call_b64 s[48:49], L_cslow
 s_branch L_cb1200
L_cs1224:
 s_movk_i32 s50, 161
 s_call_b64 s[48:49], L_cslow
 s_branch L_cb1224
L_rs1_6:
 s_call_b64 s[48:49], L_rescale0
 s_branch L_rb1_6
L_cs1232:
 s_movk_i32 s50, 163
 s_call_b64 s[48:49], L_cslow
 s_branch L_cb1232
L_cs1248:
 s_movk_i32 s50, 166
 s_call_b64 s[48:49], L_cslow
 s_branch L_cb1248
L_cs1272:
 s_movk_i32 s50, 167
 s_call_b64 s[48:49], L_cslow
 s_branch L_cb1272
L_rs1_7:
 s_call_b64 s[48:49], L_rescale1
 s_branch L_rb1_7
L_cs1280:
 s_movk_i32 s50, 169
 s_call_b64 s[48:49], L_cslow
 s_branch L_cb1280
L_cs1296:
 s_movk_i32 s50, 172
 s_call_b64 s[48:49], L_cslow
 s_branch L_cb1296
L_cs1320:
 s_movk_i32 s50, 173
 s_call_b64 s[48:49], L_cslow
 s_branch L_cb1320
L_rs1_8:
 s_call_b64 s[48:49], L_rescale0
 s_branch L_rb1_8
L_cs1328:
 s_movk_i32 s50, 175
 s_call_b64 s[48:49], L_cslow
 s_branch L_cb1328
L_cs1344:
 s_movk_i32 s50, 178
 s_call_b64 s[48:49], L_cslow
 s_branch L_cb1344
L_cs1368:
 s_movk_i32 s50, 179
 s_call_b64 s[48:49], L_cslow
 s_branch L_cb1368
L_rs1_9:
 s_call_b64 s[48:49], L_rescale1
 s_branch L_rb1_9
L_cs1376:
 s_movk_i32 s50, 181
 s_call_b64 s[48:49], L_cslow
 s_branch L_cb1376
L_cs1392:
 s_movk_i32 s50, 184
 s_call_b64 s[48:49], L_cslow
 s_branch L_cb1392
L_cs1416:
 s_movk_i32 s50, 185
 s_call_b64 s[48:49], L_cslow
 s_branch L_cb1416
L_rs1_10:
 s_call_b64 s[48:49], L_rescale0
 s_branch L_rb1_10
L_cs1424:
 s_movk_i32 s50, 187
 s_call_b64 s[48:49], L_cslow
 s_branch L_cb1424
L_cs1440:
 s_movk_i32 s50, 190
 s_call_b64 s[48:49], L_cslow
 s_branch L_cb1440
L_cs1464:
 s_movk_i32 s50, 191
 s_call_b64 s[48:49], L_cslow
 s_branch L_cb1464
L_rs1_11:
 s_call_b64 s[48:49], L_rescale1
 s_branch L_rb1_11
L_cs1472:
 s_movk_i32 s50, 193
 s_call_b64 s[48:49], L_cslow
 s_branch L_cb1472
L_cs1488:
 s_movk_i32 s50, 196
 s_call_b64 s[48:49], L_cslow
 s_branch L_cb1488
L_cs1512:
 s_movk_i32 s50, 197
 s_call_b64 s[48:49], L_cslow
 s_branch L_cb1512
L_rs1_12:
 s_call_b64 s[48:49], L_rescale0
 s_branch L_rb1_12
L_cs1520:
 s_movk_i32 s50, 199
 s_call_b64 s[48:49], L_cslow
 s_branch L_cb1520
L_cs1536:
 s_movk_i32 s50, 202
 s_call_b64 s[48:49], L_cslow
 s_branch L_cb1536
L_cs1560:
 s_movk_i32 s50, 203
 s_call_b64 s[48:49], L_cslow
 s_branch L_cb1560
L_rs1_13:
 s_call_b64 s[48:49], L_rescale1
 s_branch L_rb1_13
L_cs1568:
 s_movk_i32 s50, 205
 s_call_b64 s[48:49], L_cslow
 s_branch L_cb1568
L_cs1584:
 s_movk_i32 s50, 208
 s_call_b64 s[48:49], L_cslow
 s_branch L_cb1584
L_cs1608:
 s_movk_i32 s50, 209
 s_call_b64 s[48:49], L_cslow
 s_branch L_cb1608
L_rs1_14:
 s_call_b64 s[48:49], L_rescale0
 s_branch L_rb1_14
L_cs1616:
 s_movk_i32 s50, 211
 s_call_b64 s[48:49], L_cslow
 s_branch L_cb1616
L_cs1632:
 s_movk_i32 s50, 214
 s_call_b64 s[48:49], L_cslow
 s_branch L_cb1632
L_cs1656:
 s_movk_i32 s50, 215
 s_call_b64 s[48:49], L_cslow
 s_branch L_cb1656
L_rs1_15:
 s_call_b64 s[48:49], L_rescale1
 s_branch L_rb1_15
L_cs1664:
 s_movk_i32 s50, 217
 s_call_b64 s[48:49], L_cslow
 s_branch L_cb1664
L_cs1680:
 s_movk_i32 s50, 219
 s_call_b64 s[48:49], L_cslow
 s_branch L_cb1680
L_cs1696:
 s_movk_i32 s50, 221
 s_call_b64 s[48:49], L_cslow
 s_branch L_cb1696
L_cs1712:
 s_movk_i32 s50, 223
 s_call_b64 s[48:49], L_cslow
 s_branch L_cb1712
L_cs1728:
 s_movk_i32 s50, 225
 s_call_b64 s[48:49], L_cslow
 s_branch L_cb1728
L_cs1744:
 s_movk_i32 s50, 227
 s_call_b64 s[48:49], L_cslow
 s_branch L_cb1744
L_cs1760:
 s_movk_i32 s50, 229
 s_call_b64 s[48:49], L_cslow
 s_branch L_cb1760
L_cs1776:
 s_movk_i32 s50, 231
 s_call_b64 s[48:49], L_cslow
 s_branch L_cb1776
L_cs1796:
 s_movk_i32 s50, 233
 s_call_b64 s[48:49], L_cslow
 s_branch L_cb1796
L_cs1812:
 s_movk_i32 s50, 235
 s_call_b64 s[48:49], L_cslow
 s_branch L_cb1812
L_cs1832:
 s_movk_i32 s50, 237
 s_call_b64 s[48:49], L_cslow
 s_branch L_cb1832
L_cs1848:
 s_movk_i32 s50, 239
 s_call_b64 s[48:49], L_cslow
 s_branch L_cb1848
L_cs1868:
 s_movk_i32 s50, 241
 s_call_b64 s[48:49], L_cslow
 s_branch L_cb1868
L_cs1884:
 s_movk_i32 s50, 243
 s_call_b64 s[48:49], L_cslow
 s_branch L_cb1884
L_cs1904:
 s_movk_i32 s50, 245
 s_call_b64 s[48:49], L_cslow
 s_branch L_cb1904
L_cs1920:
 s_movk_i32 s50, 247
 s_call_b64 s[48:49], L_cslow
 s_branch L_cb1920
L_end:
L_rescale0:
 s_nop 15
 v_mov_b32 v56, v11
 v_mov_b32 v57, v12
  s_nop 0
 v_permlane32_swap_b32 v56, v11
 v_permlane32_swap_b32 v57, v12
 v_max_f32 v11, v56, v11
 v_max_f32 v12, v57, v12
 v_mov_b32 v56, v11
 v_mov_b32 v57, v12
  s_nop 0
 v_permlane16_swap_b32 v56, v11
 v_permlane16_swap_b32 v57, v12
 v_max_f32 v11, v56, v11
 v_max_f32 v12, v57, v12
 v_ceil_f32 v11, v11
 v_max_f32 v11, 0, v11
 v_ceil_f32 v12, v12
 v_max_f32 v12, 0, v12
 v_sub_f32 v16, v16, v11
 v_sub_f32 v17, v17, v11
 v_sub_f32 v18, v18, v11
 v_sub_f32 v19, v19, v11
 v_sub_f32 v20, v20, v12
 v_sub_f32 v21, v21, v12
 v_sub_f32 v22, v22, v12
 v_sub_f32 v23, v23, v12
 v_sub_f32 v32, v32, v11
 v_sub_f32 v33, v33, v11
 v_sub_f32 v34, v34, v11
 v_sub_f32 v35, v35, v11
 v_sub_f32 v36, v36, v11
 v_sub_f32 v37, v37, v11
 v_sub_f32 v38, v38, v11
 v_sub_f32 v39, v39, v11
 v_sub_f32 v40, v40, v12
 v_sub_f32 v41, v41, v12
 v_sub_f32 v42, v42, v12
 v_sub_f32 v43, v43, v12
 v_sub_f32 v44, v44, v12
 v_sub_f32 v45, v45, v12
 v_sub_f32 v46, v46, v12
 v_sub_f32 v47, v47, v12
 v_exp_f32 v11, -v11
 v_exp_f32 v12, -v12
 s_nop 0
 v_lshlrev_b32 v56, 16, v48
 v_and_b32 v57, s56, v48
 v_mul_f32 v56, v56, v11
 v_mul_f32 v57, v57, v11
 v_cvt_pk_bf16_f32 v48, v56, v57
 v_lshlrev_b32 v56, 16, v49
 v_and_b32 v57, s56, v49
 v_mul_f32 v56, v56, v11
 v_mul_f32 v57, v57, v11
 v_cvt_pk_bf16_f32 v49, v56, v57
 v_lshlrev_b32 v56, 16, v50
 v_and_b32 v57, s56, v50
 v_mul_f32 v56, v56, v11
 v_mul_f32 v57, v57, v11
 v_cvt_pk_bf16_f32 v50, v56, v57
 v_lshlrev_b32 v56, 16, v51
 v_and_b32 v57, s56, v51
 v_mul_f32 v56, v56, v11
 v_mul_f32 v57, v57, v11
 v_cvt_pk_bf16_f32 v51, v56, v57
 v_lshlrev_b32 v56, 16, v52
 v_and_b32 v57, s56, v52
 v_mul_f32 v56, v56, v12
 v_mul_f32 v57, v57, v12
 v_cvt_pk_bf16_f32 v52, v56, v57
 v_lshlrev_b32 v56, 16, v53
 v_and_b32 v57, s56, v53
 v_mul_f32 v56, v56, v12
 v_mul_f32 v57, v57, v12
 v_cvt_pk_bf16_f32 v53, v56, v57
 v_lshlrev_b32 v56, 16, v54
 v_and_b32 v57, s56, v54
 v_mul_f32 v56, v56, v12
 v_mul_f32 v57, v57, v12
 v_cvt_pk_bf16_f32 v54, v56, v57
 v_lshlrev_b32 v56, 16, v55
 v_and_b32 v57, s56, v55
 v_mul_f32 v56, v56, v12
 v_mul_f32 v57, v57, v12
 v_cvt_pk_bf16_f32 v55, v56, v57
 s_branch L_rescale_o
L_rescale1:
 s_nop 15
 v_mov_b32 v40, v11
 v_mov_b32 v41, v12
  s_nop 0
 v_permlane32_swap_b32 v40, v11
 v_permlane32_swap_b32 v41, v12
 v_max_f32 v11, v40, v11
 v_max_f32 v12, v41, v12
 v_mov_b32 v40, v11
 v_mov_b32 v41, v12
  s_nop 0
 v_permlane16_swap_b32 v40, v11
 v_permlane16_swap_b32 v41, v12
 v_max_f32 v11, v40, v11
 v_max_f32 v12, v41, v12
 v_ceil_f32 v11, v11
 v_max_f32 v11, 0, v11
 v_ceil_f32 v12, v12
 v_max_f32 v12, 0, v12
 v_sub_f32 v16, v16, v11
 v_sub_f32 v17, v17, v11
 v_sub_f32 v18, v18, v11
 v_sub_f32 v19, v19, v11
 v_sub_f32 v20, v20, v12
 v_sub_f32 v21, v21, v12
 v_sub_f32 v22, v22, v12
 v_sub_f32 v23, v23, v12
 v_sub_f32 v48, v48, v11
 v_sub_f32 v49, v49, v11
 v_sub_f32 v50, v50, v11
 v_sub_f32 v51, v51, v11
 v_sub_f32 v52, v52, v11
 v_sub_f32 v53, v53, v11
 v_sub_f32 v54, v54, v11
 v_sub_f32 v55, v55, v11
 v_sub_f32 v56, v56, v12
 v_sub_f32 v57, v57, v12
 v_sub_f32 v58, v58, v12
 v_sub_f32 v59, v59, v12
 v_sub_f32 v60, v60, v12
 v_sub_f32 v61, v61, v12
 v_sub_f32 v62, v62, v12
 v_sub_f32 v63, v63, v12
 v_exp_f32 v11, -v11
 v_exp_f32 v12, -v12
 s_nop 0
 v_lshlrev_b32 v40, 16, v32
 v_and_b32 v41, s56, v32
 v_mul_f32 v40, v40, v11
 v_mul_f32 v41, v41, v11
 v_cvt_pk_bf16_f32 v32, v40, v41
 v_lshlrev_b32 v40, 16, v33
 v_and_b32 v41, s56, v33
 v_mul_f32 v40, v40, v11
 v_mul_f32 v41, v41, v11
 v_cvt_pk_bf16_f32 v33, v40, v41
 v_lshlrev_b32 v40, 16, v34
 v_and_b32 v41, s56, v34
 v_mul_f32 v40, v40, v11
 v_mul_f32 v41, v41, v11
 v_cvt_pk_bf16_f32 v34, v40, v41
 v_lshlrev_b32 v40, 16, v35
 v_and_b32 v41, s56, v35
 v_mul_f32 v40, v40, v11
 v_mul_f32 v41, v41, v11
 v_cvt_pk_bf16_f32 v35, v40, v41
 v_lshlrev_b32 v40, 16, v36
 v_and_b32 v41, s56, v36
 v_mul_f32 v40, v40, v12
 v_mul_f32 v41, v41, v12
 v_cvt_pk_bf16_f32 v36, v40, v41
 v_lshlrev_b32 v40, 16, v37
 v_and_b32 v41, s56, v37
 v_mul_f32 v40, v40, v12
 v_mul_f32 v41, v41, v12
 v_cvt_pk_bf16_f32 v37, v40, v41
 v_lshlrev_b32 v40, 16, v38
 v_and_b32 v41, s56, v38
 v_mul_f32 v40, v40, v12
 v_mul_f32 v41, v41, v12
 v_cvt_pk_bf16_f32 v38, v40, v41
 v_lshlrev_b32 v40, 16, v39
 v_and_b32 v41, s56, v39
 v_mul_f32 v40, v40, v12
 v_mul_f32 v41, v41, v12
 v_cvt_pk_bf16_f32 v39, v40, v41
L_rescale_o:
 v_mul_f32 v14, v14, v11
 v_mul_f32 v15, v15, v12
 v_mul_f32 v128, v128, v11
 v_mul_f32 v129, v129, v11
 v_mul_f32 v130, v130, v11
 v_mul_f32 v131, v131, v11
 v_mul_f32 v132, v132, v11
 v_mul_f32 v133, v133, v11
 v_mul_f32 v134, v134, v11
 v_mul_f32 v135, v135, v11
 v_mul_f32 v136, v136, v12
 v_mul_f32 v137, v137, v12
 v_mul_f32 v138, v138, v12
 v_mul_f32 v139, v139, v12
 v_mul_f32 v140, v140, v12
 v_mul_f32 v141, v141, v12
 v_mul_f32 v142, v142, v12
 v_mul_f32 v143, v143, v12
 v_mul_f32 v144, v144, v11
 v_mul_f32 v145, v145, v11
 v_mul_f32 v146, v146, v11
 v_mul_f32 v147, v147, v11
 v_mul_f32 v148, v148, v11
 v_mul_f32 v149, v149, v11
 v_mul_f32 v150, v150, v11
 v_mul_f32 v151, v151, v11
 v_mul_f32 v152, v152, v12
 v_mul_f32 v153, v153, v12
 v_mul_f32 v154, v154, v12
 v_mul_f32 v155, v155, v12
 v_mul_f32 v156, v156, v12
 v_mul_f32 v157, v157, v12
 v_mul_f32 v158, v158, v12
 v_mul_f32 v159, v159, v12
 v_mul_f32 v160, v160, v11
 v_mul_f32 v161, v161, v11
 v_mul_f32 v162, v162, v11
 v_mul_f32 v163, v163, v11
 v_mul_f32 v164, v164, v11
 v_mul_f32 v165, v165, v11
 v_mul_f32 v166, v166, v11
 v_mul_f32 v167, v167, v11
 v_mul_f32 v168, v168, v12
 v_mul_f32 v169, v169, v12
 v_mul_f32 v170, v170, v12
 v_mul_f32 v171, v171, v12
 v_mul_f32 v172, v172, v12
 v_mul_f32 v173, v173, v12
 v_mul_f32 v174, v174, v12
 v_mul_f32 v175, v175, v12
 v_mul_f32 v176, v176, v11
 v_mul_f32 v177, v177, v11
 v_mul_f32 v178, v178, v11
 v_mul_f32 v179, v179, v11
 v_mul_f32 v180, v180, v11
 v_mul_f32 v181, v181, v11
 v_mul_f32 v182, v182, v11
 v_mul_f32 v183, v183, v11
 v_mul_f32 v184, v184, v12
 v_mul_f32 v185, v185, v12
 v_mul_f32 v186, v186, v12
 v_mul_f32 v187, v187, v12
 v_mul_f32 v188, v188, v12
 v_mul_f32 v189, v189, v12
 v_mul_f32 v190, v190, v12
 v_mul_f32 v191, v191, v12
 v_mul_f32 v192, v192, v11
 v_mul_f32 v193, v193, v11
 v_mul_f32 v194, v194, v11
 v_mul_f32 v195, v195, v11
 v_mul_f32 v196, v196, v11
 v_mul_f32 v197, v197, v11
 v_mul_f32 v198, v198, v11
 v_mul_f32 v199, v199, v11
 v_mul_f32 v200, v200, v12
 v_mul_f32 v201, v201, v12
 v_mul_f32 v202, v202, v12
 v_mul_f32 v203, v203, v12
 v_mul_f32 v204, v204, v12
 v_mul_f32 v205, v205, v12
 v_mul_f32 v206, v206, v12
 v_mul_f32 v207, v207, v12
 v_mul_f32 v208, v208, v11
 v_mul_f32 v209, v209, v11
 v_mul_f32 v210, v210, v11
 v_mul_f32 v211, v211, v11
 v_mul_f32 v212, v212, v11
 v_mul_f32 v213, v213, v11
 v_mul_f32 v214, v214, v11
 v_mul_f32 v215, v215, v11
 v_mul_f32 v216, v216, v12
 v_mul_f32 v217, v217, v12
 v_mul_f32 v218, v218, v12
 v_mul_f32 v219, v219, v12
 v_mul_f32 v220, v220, v12
 v_mul_f32 v221, v221, v12
 v_mul_f32 v222, v222, v12
 v_mul_f32 v223, v223, v12
 v_mul_f32 v224, v224, v11
 v_mul_f32 v225, v225, v11
 v_mul_f32 v226, v226, v11
 v_mul_f32 v227, v227, v11
 v_mul_f32 v228, v228, v11
 v_mul_f32 v229, v229, v11
 v_mul_f32 v230, v230, v11
 v_mul_f32 v231, v231, v11
 v_mul_f32 v232, v232, v12
 v_mul_f32 v233, v233, v12
 v_mul_f32 v234, v234, v12
 v_mul_f32 v235, v235, v12
 v_mul_f32 v236, v236, v12
 v_mul_f32 v237, v237, v12
 v_mul_f32 v238, v238, v12
 v_mul_f32 v239, v239, v12
 v_mul_f32 v240, v240, v11
 v_mul_f32 v241, v241, v11
 v_mul_f32 v242, v242, v11
 v_mul_f32 v243, v243, v11
 v_mul_f32 v244, v244, v11
 v_mul_f32 v245, v245, v11
 v_mul_f32 v246, v246, v11
 v_mul_f32 v247, v247, v11
 v_mul_f32 v248, v248, v12
 v_mul_f32 v249, v249, v12
 v_mul_f32 v250, v250, v12
 v_mul_f32 v251, v251, v12
 v_mul_f32 v252, v252, v12
 v_mul_f32 v253, v253, v12
 v_mul_f32 v254, v254, v12
 v_mul_f32 v255, v255, v12
 s_nop 1
 s_setpc_b64 s[48:49]
.section .rodata,"a"
.p2align 6
.amdhsa_kernel standalone__mha_block_cached__near_ridge_kernel
  .amdhsa_next_free_vgpr 512
  .amdhsa_next_free_sgpr 102
  .amdhsa_accum_offset 256
  .amdhsa_group_segment_fixed_size 0
  .amdhsa_kernarg_size 64
  .amdhsa_user_sgpr_count 2
  .amdhsa_user_sgpr_kernarg_segment_ptr 1
  .amdhsa_system_sgpr_workgroup_id_x 1
.end_amdhsa_kernel
```
